```python
import torch

def _softmax(x, axis=-1):
    return torch.softmax(x, dim=axis)
def _gelu(x):
    return torch.nn.functional.gelu(x, approximate="tanh")
def _silu(x):
    return torch.nn.functional.silu(x)
def _sigmoid(x):
    return torch.sigmoid(x)
def _layernorm(x, axis=-1, eps=1e-5):
    m = x.mean(dim=axis, keepdim=True)
    v = x.var(dim=axis, keepdim=True, unbiased=False)
    return (x - m) / torch.sqrt(v + eps)
def _scatter_add(tgt, idx, src, axis=0):
    return tgt.clone().index_add_(axis, idx, src)
def _segment_sum(src, seg, n):
    out = torch.zeros((n,) + src.shape[1:], dtype=src.dtype)
    return out.index_add_(0, seg, src)
def _pad(x, pw):
    flat = tuple(v for pair in reversed(pw) for v in pair)
    return torch.nn.functional.pad(x, flat)

kernel_name = 'standalone__deep_cross_xdeepfm__recsys'

def setup_inputs():

    _w = (lambda a: (lambda t: t.to(torch.bfloat16) if t.is_floating_point() else t)(torch.as_tensor(a)))
    B, F, D, L = 4096, 26, 64, 3
    V = min(1000000, 100000)
    Din = F * D
    return {
        "idx": _w((lambda lo, hi, *s: torch.randint(lo, hi, s))(0, V, B, F).to(torch.int64)),
        "table": _w((lambda *s: torch.randn(*s, dtype=torch.bfloat16) * 0.8)(V, D)),
        "ws_cin": _w((lambda *s: torch.randn(*s, dtype=torch.bfloat16) * 0.2)(L, F, F, F) * (1.0 / F)),
        "w_cin_out": _w((lambda *s: torch.randn(*s, dtype=torch.bfloat16) * 0.2)(L * F) * ((L * F) ** -0.5)),
        "w_dnn1": _w((lambda *s: torch.randn(*s, dtype=torch.bfloat16) * 0.8)(Din, Din) * (Din ** -0.5)),
        "b_dnn1": _w((lambda *s: torch.randn(*s, dtype=torch.bfloat16) * 1.6)(Din) * 0.1),
        "w_dnn2": _w((lambda *s: torch.randn(*s, dtype=torch.bfloat16) * 0.2)(Din) * (Din ** -0.5)),
        "b_out": _w((lambda *s: torch.randn(*s, dtype=torch.bfloat16) * 0.2)(1)),
    }

def reference(idx, table, ws_cin, w_cin_out, w_dnn1, b_dnn1, w_dnn2, b_out):
    x0 = table[idx]
    B = x0.shape[0]
    L = ws_cin.shape[0]
    xk = x0
    pooled = []
    for l in range(L):
        xk = torch.einsum('bid,bjd,hij->bhd', xk, x0, ws_cin[l])
        pooled.append(xk.sum(axis=-1))
    p_plus = torch.stack(pooled, axis=1).reshape(B, -1)
    logit_cin = p_plus @ w_cin_out
    h = x0.reshape(B, -1)
    h = _gelu(h @ w_dnn1 + b_dnn1)
    logit_dnn = h @ w_dnn2
    return logit_cin + logit_dnn + b_out
```

```asm
; @launch grid=(256,1,1) block=(512,1,1) lds=163840
.amdgcn_target "amdgcn-amd-amdhsa--gfx950"
.text
.globl standalone__deep_cross_xdeepfm__recsys_kernel
.p2align 8
.type standalone__deep_cross_xdeepfm__recsys_kernel,@function
standalone__deep_cross_xdeepfm__recsys_kernel:
  s_cmp_ge_u32 s2, 256
  s_cbranch_scc1 L_end
  s_load_dwordx16 s[4:19], s[0:1], 0
  s_load_dwordx4 s[20:23], s[0:1], 64
  s_load_dwordx2 s[24:25], s[0:1], 80
  v_lshrrev_b32 v1, 6, v0
  s_getpc_b64 s[92:93]
L_pc:
  s_and_b32 s68, s2, 0xf8
  v_add_u32 v2, s68, v1
  v_lshlrev_b32 v2, 7, v2
  v_min_u32 v2, L_end-L_pc, v2
  v_mov_b32 v3, s93
  v_add_co_u32 v2, vcc, s92, v2
  s_nop 1
  v_addc_co_u32 v3, vcc, 0, v3, vcc
  global_load_dword v255, v[2:3], off
  v_and_b32 v0, 63, v0
  v_readfirstlane_b32 s3, v1
  s_and_b32 s68, s2, 7
  s_lshl_b32 s68, s68, 2
  s_lshr_b32 s26, s2, 6
  s_add_u32 s26, s26, s68
  s_bfe_u32 s27, s2, 0x30003
  s_and_b32 s80, s2, 0xf8
  s_add_u32 s80, s80, s3
  s_lshl_b32 s80, s80, 21
  s_cmp_ge_u32 s27, 5
  s_cbranch_scc1 L_cin
  s_mul_i32 s77, s27, 640
  s_mul_i32 s70, s3, 7
  v_min_u32 v132, 6, v0
  v_add_u32 v132, s70, v132
  v_min_u32 v132, 51, v132
  v_lshrrev_b32 v130, 1, v132
  v_mul_u32_u24 v130, 96, v130
  v_lshl_add_u32 v132, v132, 2, v130
  s_mul_i32 s78, s27, 26
  s_min_u32 s78, s78, 102
  s_lshl_b32 s71, s26, 7
  s_add_u32 s78, s78, s71
  s_mul_i32 s78, s78, 104
  s_and_b32 s70, s26, 3
  s_lshl_b32 s70, s70, 3
  s_add_u32 s70, s70, s3
  s_mul_i32 s70, s70, 3328
  s_add_u32 s81, s70, s77
  v_min_u32 v124, 15, v0
  v_lshrrev_b32 v130, 3, v124
  s_mov_b32 s70, 106496
  v_mul_u32_u24 v130, s70, v130
  v_and_b32 v124, 7, v124
  v_min_u32 v124, 4, v124
  v_lshl_add_u32 v124, v124, 7, v130
  s_waitcnt lgkmcnt(0)
  s_mov_b32 s28, s4
  s_and_b32 s29, s5, 0xffff
  s_mov_b32 s30, 425984
  s_mov_b32 s31, 0x20000
  buffer_load_dwordx3 v[120:122], v132, s[28:31], s78 offen
  s_mov_b32 s32, s6
  s_and_b32 s33, s7, 0xffff
  s_mov_b32 s34, 12800000
  s_mov_b32 s35, 0x20000
  v_mov_b32 v136, s80
  buffer_load_dword v255, v136, s[32:35], 0 offen
  v_lshlrev_b32 v37, 4, v0
  s_mov_b32 s48, s14
  s_and_b32 s49, s15, 0xffff
  s_mov_b32 s50, 3328
  s_mov_b32 s51, 0x20000
  s_mov_b32 s44, s12
  s_and_b32 s45, s13, 0xffff
  s_mov_b32 s46, 5537792
  s_mov_b32 s47, 0x20000
  buffer_load_dword v255, v124, s[44:47], s81 offen
  s_mov_b32 m0, 147456
  s_mov_b32 exec_hi, 0xff
  buffer_load_dwordx4 v37, s[48:51], s77 offen lds
  s_mov_b64 exec, -1
  s_lshr_b32 s68, s3, 2
  s_and_b32 s69, s3, 3
  s_lshl_b32 s70, s3, 4
  s_add_u32 s70, s70, s71
  v_lshrrev_b32 v128, 3, v0
  v_add_u32 v128, s70, v128
  v_mul_u32_u24 v13, 104, v128
  s_mul_i32 s71, s68, 192
  s_mov_b32 s70, 1639
  s_and_b32 s78, s69, 1
  s_lshl_b32 s78, s78, 2
  s_mov_b32 s81, 3328
  v_add_u32 v128, s71, v0
  v_mul_u32_u24 v129, s70, v128
  v_lshrrev_b32 v129, 16, v129
  v_mul_u32_u24 v132, 40, v129
  v_sub_u32 v132, v128, v132
  v_and_b32 v131, 2, v129
  v_or_b32 v131, s78, v131
  v_xor_b32 v132, v132, v131
  v_mul_u32_u24 v129, s81, v129
  v_lshl_add_u32 v32, v132, 4, v129
  v_add_u32 v128, 64, v128
  v_mul_u32_u24 v129, s70, v128
  v_lshrrev_b32 v129, 16, v129
  v_mul_u32_u24 v132, 40, v129
  v_sub_u32 v132, v128, v132
  v_and_b32 v131, 2, v129
  v_or_b32 v131, s78, v131
  v_xor_b32 v132, v132, v131
  v_mul_u32_u24 v129, s81, v129
  v_lshl_add_u32 v33, v132, 4, v129
  v_subrev_u32 v33, 1024, v33
  v_add_u32 v128, 64, v128
  v_mul_u32_u24 v129, s70, v128
  v_lshrrev_b32 v129, 16, v129
  v_mul_u32_u24 v132, 40, v129
  v_sub_u32 v132, v128, v132
  v_and_b32 v131, 2, v129
  v_or_b32 v131, s78, v131
  v_xor_b32 v132, v132, v131
  v_mul_u32_u24 v129, s81, v129
  v_lshl_add_u32 v34, v132, 4, v129
  v_subrev_u32 v34, 2048, v34
  s_mul_i32 s70, s69, 26624
  s_add_u32 s74, s70, s77
  s_mul_i32 s75, s69, 5120
  s_mul_i32 s70, s68, 3072
  s_add_u32 s75, s75, s70
  s_lshl_b32 s76, s3, 11
  v_and_b32 v132, 7, v0
  v_lshrrev_b32 v130, 4, v0
  v_xor_b32 v132, v132, v130
  v_lshlrev_b32 v14, 4, v132
  v_xor_b32 v15, 64, v14
  s_mov_b32 s52, s16
  s_and_b32 s53, s17, 0xffff
  s_mov_b32 s54, 3328
  s_mov_b32 s55, 0x20000
  s_lshr_b32 s70, s3, 1
  s_mul_i32 s71, s70, 5
  v_bfe_u32 v131, v0, 2, 2
  v_lshl_add_u32 v132, v130, 3, v131
  v_mul_u32_u24 v132, 640, v132
  v_and_b32 v131, 3, v0
  v_lshl_add_u32 v132, v131, 3, v132
  v_add_u32 v132, 65536, v132
  v_bfe_u32 v131, v0, 3, 2
  v_xor_b32 v128, s71, v131
  v_lshl_add_u32 v1, v128, 5, v132
  v_add_u32 v6, 40960, v1
  s_add_u32 s71, s71, 1
  v_xor_b32 v128, s71, v131
  v_lshl_add_u32 v2, v128, 5, v132
  v_add_u32 v7, 40960, v2
  s_add_u32 s71, s71, 1
  v_xor_b32 v128, s71, v131
  v_lshl_add_u32 v3, v128, 5, v132
  v_add_u32 v8, 40960, v3
  s_add_u32 s71, s71, 1
  v_xor_b32 v128, s71, v131
  v_lshl_add_u32 v4, v128, 5, v132
  v_add_u32 v9, 40960, v4
  s_add_u32 s71, s71, 1
  v_xor_b32 v128, s71, v131
  v_lshl_add_u32 v5, v128, 5, v132
  v_add_u32 v10, 40960, v5
  s_add_u32 s71, s71, 1
  s_mul_i32 s71, s70, 160
  s_add_u32 s71, s71, 147456
  v_lshlrev_b32 v132, 3, v130
  v_add_u32 v35, s71, v132
  v_and_b32 v132, 15, v0
  v_lshlrev_b32 v132, 7, v132
  v_bfe_u32 v131, v0, 1, 3
  v_xor_b32 v131, v131, v130
  v_lshl_add_u32 v132, v131, 4, v132
  s_lshl_b32 s71, s78, 11
  v_add_u32 v11, s71, v132
  v_xor_b32 v12, 64, v11
  s_lshl_b32 s70, s3, 8
  s_add_u32 s70, s70, 32768
  v_lshlrev_b32 v36, 2, v0
  v_add_u32 v36, s70, v36
  s_waitcnt vmcnt(3)
  v_lshlrev_b32 v120, 7, v120
  buffer_load_dwordx4 v[112:115], v13, s[28:31], 0 offen offset:0
  buffer_load_dwordx4 v[116:119], v13, s[28:31], 0 offen offset:832
  s_barrier
  buffer_load_dword v255, v120, s[32:35], 0 offen
  v_lshlrev_b32 v122, 7, v122
  buffer_load_dword v255, v122, s[32:35], 0 offen
  s_add_u32 m0, s75, 65536
  s_cmp_lg_u32 s68, 0
  buffer_load_dwordx4 v32, s[44:47], s74 offen offset:0 lds
  buffer_load_dwordx4 v33, s[44:47], s74 offen offset:1024 lds
  s_cbranch_scc1 L_wsk1
  buffer_load_dwordx4 v34, s[44:47], s74 offen offset:2048 lds
L_wsk1:
  s_add_u32 s74, s74, 106496
  s_waitcnt vmcnt(6)
  ds_read_b64 v[220:221], v35 offset:0
  ds_read_b64 v[222:223], v35 offset:32
  ds_read_b64 v[224:225], v35 offset:64
  ds_read_b64 v[226:227], v35 offset:96
  ds_read_b64 v[228:229], v35 offset:128
  s_waitcnt lgkmcnt(4)
  v_lshlrev_b32 v140, 16, v220
  v_and_b32 v141, 0xffff0000, v220
  v_lshlrev_b32 v142, 16, v221
  v_and_b32 v143, 0xffff0000, v221
  s_waitcnt lgkmcnt(3)
  v_lshlrev_b32 v156, 16, v222
  v_and_b32 v157, 0xffff0000, v222
  v_lshlrev_b32 v158, 16, v223
  v_and_b32 v159, 0xffff0000, v223
  s_waitcnt lgkmcnt(2)
  v_lshlrev_b32 v172, 16, v224
  v_and_b32 v173, 0xffff0000, v224
  v_lshlrev_b32 v174, 16, v225
  v_and_b32 v175, 0xffff0000, v225
  s_waitcnt lgkmcnt(1)
  v_lshlrev_b32 v188, 16, v226
  v_and_b32 v189, 0xffff0000, v226
  v_lshlrev_b32 v190, 16, v227
  v_and_b32 v191, 0xffff0000, v227
  s_waitcnt lgkmcnt(0)
  v_lshlrev_b32 v204, 16, v228
  v_and_b32 v205, 0xffff0000, v228
  v_lshlrev_b32 v206, 16, v229
  v_and_b32 v207, 0xffff0000, v229
  v_mov_b64 v[144:145], v[140:141]
  v_mov_b64 v[146:147], v[142:143]
  v_mov_b64 v[148:149], v[140:141]
  v_mov_b64 v[150:151], v[142:143]
  v_mov_b64 v[152:153], v[140:141]
  v_mov_b64 v[154:155], v[142:143]
  v_mov_b64 v[160:161], v[156:157]
  v_mov_b64 v[162:163], v[158:159]
  v_mov_b64 v[164:165], v[156:157]
  v_mov_b64 v[166:167], v[158:159]
  v_mov_b64 v[168:169], v[156:157]
  v_mov_b64 v[170:171], v[158:159]
  v_mov_b64 v[176:177], v[172:173]
  v_mov_b64 v[178:179], v[174:175]
  v_mov_b64 v[180:181], v[172:173]
  v_mov_b64 v[182:183], v[174:175]
  v_mov_b64 v[184:185], v[172:173]
  v_mov_b64 v[186:187], v[174:175]
  v_mov_b64 v[192:193], v[188:189]
  v_mov_b64 v[194:195], v[190:191]
  v_mov_b64 v[196:197], v[188:189]
  v_mov_b64 v[198:199], v[190:191]
  v_mov_b64 v[200:201], v[188:189]
  v_mov_b64 v[202:203], v[190:191]
  v_mov_b64 v[208:209], v[204:205]
  v_mov_b64 v[210:211], v[206:207]
  v_mov_b64 v[212:213], v[204:205]
  v_mov_b64 v[214:215], v[206:207]
  v_mov_b64 v[216:217], v[204:205]
  v_mov_b64 v[218:219], v[206:207]
  s_waitcnt vmcnt(5)
  v_lshl_add_u32 v24, v112, 7, v14
  s_add_u32 m0, s76, 0
  s_nop 0
  buffer_load_dwordx4 v24, s[32:35], 0 offen lds
  s_waitcnt vmcnt(5)
  v_lshl_add_u32 v25, v116, 7, v15
  s_add_u32 m0, s76, 1024
  s_nop 0
  buffer_load_dwordx4 v25, s[32:35], 0 offen lds
  s_barrier
  s_add_u32 m0, s75, 86016
  s_cmp_lg_u32 s68, 0
  buffer_load_dwordx4 v32, s[44:47], s74 offen offset:0 lds
  buffer_load_dwordx4 v33, s[44:47], s74 offen offset:1024 lds
  s_cbranch_scc1 L_wsk2
  buffer_load_dwordx4 v34, s[44:47], s74 offen offset:2048 lds
L_wsk2:
  s_add_u32 s74, s74, 106496
  v_lshl_add_u32 v26, v113, 7, v14
  s_add_u32 m0, s76, 16384
  s_nop 0
  buffer_load_dwordx4 v26, s[32:35], 0 offen lds
  v_lshl_add_u32 v27, v117, 7, v15
  s_add_u32 m0, s76, 17408
  s_nop 0
  buffer_load_dwordx4 v27, s[32:35], 0 offen lds
  v_lshl_add_u32 v28, v114, 7, v14
  v_lshl_add_u32 v29, v118, 7, v15
  v_lshl_add_u32 v30, v115, 7, v14
  v_lshl_add_u32 v31, v119, 7, v15
  buffer_load_dwordx4 v[16:19], v13, s[28:31], 0 offen offset:12
  buffer_load_dwordx4 v[20:23], v13, s[28:31], 0 offen offset:844
  s_mov_b32 s72, 0
  s_mov_b32 s73, 28
  s_waitcnt vmcnt(6) lgkmcnt(0)
  s_barrier
  ds_read_b128 v[80:83], v11 offset:0
  ds_read_b128 v[84:87], v11 offset:2048
  ds_read_b128 v[88:91], v11 offset:4096
  ds_read_b128 v[92:95], v11 offset:6144
  ds_read_b64_tr_b16 v[40:41], v1 offset:0
  ds_read_b64_tr_b16 v[42:43], v1 offset:2560
  ds_read_b64_tr_b16 v[44:45], v2 offset:0
  ds_read_b64_tr_b16 v[46:47], v2 offset:2560
  ds_read_b64_tr_b16 v[48:49], v3 offset:0
  ds_read_b64_tr_b16 v[50:51], v3 offset:2560
  ds_read_b64_tr_b16 v[52:53], v4 offset:0
  ds_read_b64_tr_b16 v[54:55], v4 offset:2560
  ds_read_b64_tr_b16 v[56:57], v5 offset:0
  ds_read_b64_tr_b16 v[58:59], v5 offset:2560
  s_add_u32 m0, s75, 106496
  s_cmp_lg_u32 s68, 0
  buffer_load_dwordx4 v32, s[44:47], s74 offen offset:0 lds
  buffer_load_dwordx4 v33, s[44:47], s74 offen offset:1024 lds
  s_cbranch_scc1 L_wsk3
  buffer_load_dwordx4 v34, s[44:47], s74 offen offset:2048 lds
L_wsk3:
  s_add_u32 s74, s74, 106496
  s_add_u32 m0, s76, 32768
  s_nop 0
  buffer_load_dwordx4 v28, s[32:35], 0 offen lds
  v_mov_b32 v31, v29
  s_cmp_lg_u32 s68, 0
  s_cbranch_scc1 L_dnn_h1
L_dnn_h0:
  s_waitcnt vmcnt(8) lgkmcnt(0)
L_dnn_loop0:
  s_barrier
  v_mfma_f32_16x16x32_bf16 v[140:143], v[40:43], v[80:83], v[140:143]
  v_mfma_f32_16x16x32_bf16 v[144:147], v[40:43], v[84:87], v[144:147]
  v_mfma_f32_16x16x32_bf16 v[148:151], v[40:43], v[88:91], v[148:151]
  v_mfma_f32_16x16x32_bf16 v[152:155], v[40:43], v[92:95], v[152:155]
  v_mfma_f32_16x16x32_bf16 v[168:171], v[44:47], v[92:95], v[168:171]
  v_mfma_f32_16x16x32_bf16 v[164:167], v[44:47], v[88:91], v[164:167]
  v_mfma_f32_16x16x32_bf16 v[160:163], v[44:47], v[84:87], v[160:163]
  v_mfma_f32_16x16x32_bf16 v[156:159], v[44:47], v[80:83], v[156:159]
  v_mfma_f32_16x16x32_bf16 v[172:175], v[48:51], v[80:83], v[172:175]
  v_mfma_f32_16x16x32_bf16 v[176:179], v[48:51], v[84:87], v[176:179]
  v_mfma_f32_16x16x32_bf16 v[180:183], v[48:51], v[88:91], v[180:183]
  v_mfma_f32_16x16x32_bf16 v[184:187], v[48:51], v[92:95], v[184:187]
  v_mfma_f32_16x16x32_bf16 v[200:203], v[52:55], v[92:95], v[200:203]
  v_mfma_f32_16x16x32_bf16 v[196:199], v[52:55], v[88:91], v[196:199]
  v_mfma_f32_16x16x32_bf16 v[192:195], v[52:55], v[84:87], v[192:195]
  v_mfma_f32_16x16x32_bf16 v[188:191], v[52:55], v[80:83], v[188:191]
  ds_read_b128 v[96:99], v12 offset:0
  s_add_u32 m0, s75, 126976
  s_nop 0
  buffer_load_dwordx4 v32, s[44:47], s74 offen offset:0 lds
  v_mfma_f32_16x16x32_bf16 v[204:207], v[56:59], v[80:83], v[204:207]
  ds_read_b128 v[100:103], v12 offset:2048
  ds_read_b128 v[104:107], v12 offset:4096
  v_mfma_f32_16x16x32_bf16 v[208:211], v[56:59], v[84:87], v[208:211]
  ds_read_b128 v[108:111], v12 offset:6144
  buffer_load_dwordx4 v33, s[44:47], s74 offen offset:1024 lds
  v_mfma_f32_16x16x32_bf16 v[212:215], v[56:59], v[88:91], v[212:215]
  ds_read_b64_tr_b16 v[60:61], v1 offset:20480
  ds_read_b64_tr_b16 v[62:63], v1 offset:23040
  v_mfma_f32_16x16x32_bf16 v[216:219], v[56:59], v[92:95], v[216:219]
  ds_read_b64_tr_b16 v[64:65], v2 offset:20480
  ds_read_b64_tr_b16 v[66:67], v2 offset:23040
  buffer_load_dwordx4 v34, s[44:47], s74 offen offset:2048 lds
  s_add_u32 s74, s74, 106496
  ds_read_b64_tr_b16 v[68:69], v3 offset:20480
  ds_read_b64_tr_b16 v[70:71], v3 offset:23040
  ds_read_b64_tr_b16 v[72:73], v4 offset:20480
  s_add_u32 m0, s76, 33792
  s_nop 0
  buffer_load_dwordx4 v31, s[32:35], 0 offen lds
  ds_read_b64_tr_b16 v[74:75], v4 offset:23040
  ds_read_b64_tr_b16 v[76:77], v5 offset:20480
  ds_read_b64_tr_b16 v[78:79], v5 offset:23040
  s_waitcnt vmcnt(9)
  v_lshl_add_u32 v24, v16, 7, v14
  s_waitcnt vmcnt(8)
  v_lshl_add_u32 v25, v20, 7, v15
  v_lshl_add_u32 v26, v17, 7, v14
  v_lshl_add_u32 v27, v21, 7, v15
  v_lshl_add_u32 v28, v18, 7, v14
  v_lshl_add_u32 v29, v22, 7, v15
  v_lshl_add_u32 v30, v19, 7, v14
  v_lshl_add_u32 v31, v23, 7, v15
  s_waitcnt vmcnt(5) lgkmcnt(0)
  s_barrier
  v_mfma_f32_16x16x32_bf16 v[140:143], v[60:63], v[96:99], v[140:143]
  v_mfma_f32_16x16x32_bf16 v[144:147], v[60:63], v[100:103], v[144:147]
  v_mfma_f32_16x16x32_bf16 v[148:151], v[60:63], v[104:107], v[148:151]
  v_mfma_f32_16x16x32_bf16 v[152:155], v[60:63], v[108:111], v[152:155]
  v_mfma_f32_16x16x32_bf16 v[168:171], v[64:67], v[108:111], v[168:171]
  v_mfma_f32_16x16x32_bf16 v[164:167], v[64:67], v[104:107], v[164:167]
  v_mfma_f32_16x16x32_bf16 v[160:163], v[64:67], v[100:103], v[160:163]
  v_mfma_f32_16x16x32_bf16 v[156:159], v[64:67], v[96:99], v[156:159]
  v_mfma_f32_16x16x32_bf16 v[172:175], v[68:71], v[96:99], v[172:175]
  v_mfma_f32_16x16x32_bf16 v[176:179], v[68:71], v[100:103], v[176:179]
  v_mfma_f32_16x16x32_bf16 v[180:183], v[68:71], v[104:107], v[180:183]
  v_mfma_f32_16x16x32_bf16 v[184:187], v[68:71], v[108:111], v[184:187]
  v_mfma_f32_16x16x32_bf16 v[200:203], v[72:75], v[108:111], v[200:203]
  v_mfma_f32_16x16x32_bf16 v[196:199], v[72:75], v[104:107], v[196:199]
  v_mfma_f32_16x16x32_bf16 v[192:195], v[72:75], v[100:103], v[192:195]
  v_mfma_f32_16x16x32_bf16 v[188:191], v[72:75], v[96:99], v[188:191]
  ds_read_b128 v[80:83], v11 offset:16384
  s_add_u32 m0, s75, 65536
  s_nop 0
  buffer_load_dwordx4 v32, s[44:47], s74 offen offset:0 lds
  v_mfma_f32_16x16x32_bf16 v[204:207], v[76:79], v[96:99], v[204:207]
  ds_read_b128 v[84:87], v11 offset:18432
  ds_read_b128 v[88:91], v11 offset:20480
  v_mfma_f32_16x16x32_bf16 v[208:211], v[76:79], v[100:103], v[208:211]
  ds_read_b128 v[92:95], v11 offset:22528
  buffer_load_dwordx4 v33, s[44:47], s74 offen offset:1024 lds
  v_mfma_f32_16x16x32_bf16 v[212:215], v[76:79], v[104:107], v[212:215]
  ds_read_b64_tr_b16 v[40:41], v6 offset:0
  ds_read_b64_tr_b16 v[42:43], v6 offset:2560
  v_mfma_f32_16x16x32_bf16 v[216:219], v[76:79], v[108:111], v[216:219]
  ds_read_b64_tr_b16 v[44:45], v7 offset:0
  ds_read_b64_tr_b16 v[46:47], v7 offset:2560
  buffer_load_dwordx4 v34, s[44:47], s74 offen offset:2048 lds
  s_add_u32 s74, s74, 106496
  ds_read_b64_tr_b16 v[48:49], v8 offset:0
  ds_read_b64_tr_b16 v[50:51], v8 offset:2560
  ds_read_b64_tr_b16 v[52:53], v9 offset:0
  s_add_u32 m0, s76, 49152
  s_nop 0
  buffer_load_dwordx4 v24, s[32:35], 0 offen lds
  ds_read_b64_tr_b16 v[54:55], v9 offset:2560
  ds_read_b64_tr_b16 v[56:57], v10 offset:0
  ds_read_b64_tr_b16 v[58:59], v10 offset:2560
  buffer_load_dwordx4 v[16:19], v13, s[28:31], s73 offen offset:0
  buffer_load_dwordx4 v[20:23], v13, s[28:31], s73 offen offset:832
  s_add_u32 s73, s73, 16
  s_waitcnt vmcnt(7) lgkmcnt(0)
  s_barrier
  v_mfma_f32_16x16x32_bf16 v[140:143], v[40:43], v[80:83], v[140:143]
  v_mfma_f32_16x16x32_bf16 v[144:147], v[40:43], v[84:87], v[144:147]
  v_mfma_f32_16x16x32_bf16 v[148:151], v[40:43], v[88:91], v[148:151]
  v_mfma_f32_16x16x32_bf16 v[152:155], v[40:43], v[92:95], v[152:155]
  v_mfma_f32_16x16x32_bf16 v[168:171], v[44:47], v[92:95], v[168:171]
  v_mfma_f32_16x16x32_bf16 v[164:167], v[44:47], v[88:91], v[164:167]
  v_mfma_f32_16x16x32_bf16 v[160:163], v[44:47], v[84:87], v[160:163]
  v_mfma_f32_16x16x32_bf16 v[156:159], v[44:47], v[80:83], v[156:159]
  v_mfma_f32_16x16x32_bf16 v[172:175], v[48:51], v[80:83], v[172:175]
  v_mfma_f32_16x16x32_bf16 v[176:179], v[48:51], v[84:87], v[176:179]
  v_mfma_f32_16x16x32_bf16 v[180:183], v[48:51], v[88:91], v[180:183]
  v_mfma_f32_16x16x32_bf16 v[184:187], v[48:51], v[92:95], v[184:187]
  v_mfma_f32_16x16x32_bf16 v[200:203], v[52:55], v[92:95], v[200:203]
  v_mfma_f32_16x16x32_bf16 v[196:199], v[52:55], v[88:91], v[196:199]
  v_mfma_f32_16x16x32_bf16 v[192:195], v[52:55], v[84:87], v[192:195]
  v_mfma_f32_16x16x32_bf16 v[188:191], v[52:55], v[80:83], v[188:191]
  ds_read_b128 v[96:99], v12 offset:16384
  s_add_u32 m0, s75, 86016
  s_nop 0
  buffer_load_dwordx4 v32, s[44:47], s74 offen offset:0 lds
  v_mfma_f32_16x16x32_bf16 v[204:207], v[56:59], v[80:83], v[204:207]
  ds_read_b128 v[100:103], v12 offset:18432
  ds_read_b128 v[104:107], v12 offset:20480
  v_mfma_f32_16x16x32_bf16 v[208:211], v[56:59], v[84:87], v[208:211]
  ds_read_b128 v[108:111], v12 offset:22528
  buffer_load_dwordx4 v33, s[44:47], s74 offen offset:1024 lds
  v_mfma_f32_16x16x32_bf16 v[212:215], v[56:59], v[88:91], v[212:215]
  ds_read_b64_tr_b16 v[60:61], v6 offset:20480
  ds_read_b64_tr_b16 v[62:63], v6 offset:23040
  v_mfma_f32_16x16x32_bf16 v[216:219], v[56:59], v[92:95], v[216:219]
  ds_read_b64_tr_b16 v[64:65], v7 offset:20480
  ds_read_b64_tr_b16 v[66:67], v7 offset:23040
  buffer_load_dwordx4 v34, s[44:47], s74 offen offset:2048 lds
  s_add_u32 s74, s74, 106496
  ds_read_b64_tr_b16 v[68:69], v8 offset:20480
  ds_read_b64_tr_b16 v[70:71], v8 offset:23040
  ds_read_b64_tr_b16 v[72:73], v9 offset:20480
  s_add_u32 m0, s76, 50176
  s_nop 0
  buffer_load_dwordx4 v25, s[32:35], 0 offen lds
  ds_read_b64_tr_b16 v[74:75], v9 offset:23040
  ds_read_b64_tr_b16 v[76:77], v10 offset:20480
  ds_read_b64_tr_b16 v[78:79], v10 offset:23040
  s_waitcnt vmcnt(7) lgkmcnt(0)
  s_barrier
  v_mfma_f32_16x16x32_bf16 v[140:143], v[60:63], v[96:99], v[140:143]
  v_mfma_f32_16x16x32_bf16 v[144:147], v[60:63], v[100:103], v[144:147]
  v_mfma_f32_16x16x32_bf16 v[148:151], v[60:63], v[104:107], v[148:151]
  v_mfma_f32_16x16x32_bf16 v[152:155], v[60:63], v[108:111], v[152:155]
  v_mfma_f32_16x16x32_bf16 v[168:171], v[64:67], v[108:111], v[168:171]
  v_mfma_f32_16x16x32_bf16 v[164:167], v[64:67], v[104:107], v[164:167]
  v_mfma_f32_16x16x32_bf16 v[160:163], v[64:67], v[100:103], v[160:163]
  v_mfma_f32_16x16x32_bf16 v[156:159], v[64:67], v[96:99], v[156:159]
  v_mfma_f32_16x16x32_bf16 v[172:175], v[68:71], v[96:99], v[172:175]
  v_mfma_f32_16x16x32_bf16 v[176:179], v[68:71], v[100:103], v[176:179]
  v_mfma_f32_16x16x32_bf16 v[180:183], v[68:71], v[104:107], v[180:183]
  v_mfma_f32_16x16x32_bf16 v[184:187], v[68:71], v[108:111], v[184:187]
  v_mfma_f32_16x16x32_bf16 v[200:203], v[72:75], v[108:111], v[200:203]
  v_mfma_f32_16x16x32_bf16 v[196:199], v[72:75], v[104:107], v[196:199]
  v_mfma_f32_16x16x32_bf16 v[192:195], v[72:75], v[100:103], v[192:195]
  v_mfma_f32_16x16x32_bf16 v[188:191], v[72:75], v[96:99], v[188:191]
  ds_read_b128 v[80:83], v11 offset:32768
  s_add_u32 m0, s75, 106496
  s_nop 0
  buffer_load_dwordx4 v32, s[44:47], s74 offen offset:0 lds
  v_mfma_f32_16x16x32_bf16 v[204:207], v[76:79], v[96:99], v[204:207]
  ds_read_b128 v[84:87], v11 offset:34816
  ds_read_b128 v[88:91], v11 offset:36864
  v_mfma_f32_16x16x32_bf16 v[208:211], v[76:79], v[100:103], v[208:211]
  ds_read_b128 v[92:95], v11 offset:38912
  buffer_load_dwordx4 v33, s[44:47], s74 offen offset:1024 lds
  v_mfma_f32_16x16x32_bf16 v[212:215], v[76:79], v[104:107], v[212:215]
  ds_read_b64_tr_b16 v[40:41], v1 offset:0
  ds_read_b64_tr_b16 v[42:43], v1 offset:2560
  v_mfma_f32_16x16x32_bf16 v[216:219], v[76:79], v[108:111], v[216:219]
  ds_read_b64_tr_b16 v[44:45], v2 offset:0
  ds_read_b64_tr_b16 v[46:47], v2 offset:2560
  buffer_load_dwordx4 v34, s[44:47], s74 offen offset:2048 lds
  s_add_u32 s74, s74, 106496
  ds_read_b64_tr_b16 v[48:49], v3 offset:0
  ds_read_b64_tr_b16 v[50:51], v3 offset:2560
  ds_read_b64_tr_b16 v[52:53], v4 offset:0
  s_add_u32 m0, s76, 0
  s_nop 0
  buffer_load_dwordx4 v26, s[32:35], 0 offen lds
  ds_read_b64_tr_b16 v[54:55], v4 offset:2560
  ds_read_b64_tr_b16 v[56:57], v5 offset:0
  ds_read_b64_tr_b16 v[58:59], v5 offset:2560
  s_waitcnt vmcnt(5) lgkmcnt(0)
  s_barrier
  v_mfma_f32_16x16x32_bf16 v[140:143], v[40:43], v[80:83], v[140:143]
  v_mfma_f32_16x16x32_bf16 v[144:147], v[40:43], v[84:87], v[144:147]
  v_mfma_f32_16x16x32_bf16 v[148:151], v[40:43], v[88:91], v[148:151]
  v_mfma_f32_16x16x32_bf16 v[152:155], v[40:43], v[92:95], v[152:155]
  v_mfma_f32_16x16x32_bf16 v[168:171], v[44:47], v[92:95], v[168:171]
  v_mfma_f32_16x16x32_bf16 v[164:167], v[44:47], v[88:91], v[164:167]
  v_mfma_f32_16x16x32_bf16 v[160:163], v[44:47], v[84:87], v[160:163]
  v_mfma_f32_16x16x32_bf16 v[156:159], v[44:47], v[80:83], v[156:159]
  v_mfma_f32_16x16x32_bf16 v[172:175], v[48:51], v[80:83], v[172:175]
  v_mfma_f32_16x16x32_bf16 v[176:179], v[48:51], v[84:87], v[176:179]
  v_mfma_f32_16x16x32_bf16 v[180:183], v[48:51], v[88:91], v[180:183]
  v_mfma_f32_16x16x32_bf16 v[184:187], v[48:51], v[92:95], v[184:187]
  v_mfma_f32_16x16x32_bf16 v[200:203], v[52:55], v[92:95], v[200:203]
  v_mfma_f32_16x16x32_bf16 v[196:199], v[52:55], v[88:91], v[196:199]
  v_mfma_f32_16x16x32_bf16 v[192:195], v[52:55], v[84:87], v[192:195]
  v_mfma_f32_16x16x32_bf16 v[188:191], v[52:55], v[80:83], v[188:191]
  ds_read_b128 v[96:99], v12 offset:32768
  s_add_u32 m0, s75, 126976
  s_nop 0
  buffer_load_dwordx4 v32, s[44:47], s74 offen offset:0 lds
  v_mfma_f32_16x16x32_bf16 v[204:207], v[56:59], v[80:83], v[204:207]
  ds_read_b128 v[100:103], v12 offset:34816
  ds_read_b128 v[104:107], v12 offset:36864
  v_mfma_f32_16x16x32_bf16 v[208:211], v[56:59], v[84:87], v[208:211]
  ds_read_b128 v[108:111], v12 offset:38912
  buffer_load_dwordx4 v33, s[44:47], s74 offen offset:1024 lds
  v_mfma_f32_16x16x32_bf16 v[212:215], v[56:59], v[88:91], v[212:215]
  ds_read_b64_tr_b16 v[60:61], v1 offset:20480
  ds_read_b64_tr_b16 v[62:63], v1 offset:23040
  v_mfma_f32_16x16x32_bf16 v[216:219], v[56:59], v[92:95], v[216:219]
  ds_read_b64_tr_b16 v[64:65], v2 offset:20480
  ds_read_b64_tr_b16 v[66:67], v2 offset:23040
  buffer_load_dwordx4 v34, s[44:47], s74 offen offset:2048 lds
  s_add_u32 s74, s74, 106496
  ds_read_b64_tr_b16 v[68:69], v3 offset:20480
  ds_read_b64_tr_b16 v[70:71], v3 offset:23040
  ds_read_b64_tr_b16 v[72:73], v4 offset:20480
  s_add_u32 m0, s76, 1024
  s_nop 0
  buffer_load_dwordx4 v27, s[32:35], 0 offen lds
  ds_read_b64_tr_b16 v[74:75], v4 offset:23040
  ds_read_b64_tr_b16 v[76:77], v5 offset:20480
  ds_read_b64_tr_b16 v[78:79], v5 offset:23040
  s_waitcnt vmcnt(5) lgkmcnt(0)
  s_barrier
  v_mfma_f32_16x16x32_bf16 v[140:143], v[60:63], v[96:99], v[140:143]
  v_mfma_f32_16x16x32_bf16 v[144:147], v[60:63], v[100:103], v[144:147]
  v_mfma_f32_16x16x32_bf16 v[148:151], v[60:63], v[104:107], v[148:151]
  v_mfma_f32_16x16x32_bf16 v[152:155], v[60:63], v[108:111], v[152:155]
  v_mfma_f32_16x16x32_bf16 v[168:171], v[64:67], v[108:111], v[168:171]
  v_mfma_f32_16x16x32_bf16 v[164:167], v[64:67], v[104:107], v[164:167]
  v_mfma_f32_16x16x32_bf16 v[160:163], v[64:67], v[100:103], v[160:163]
  v_mfma_f32_16x16x32_bf16 v[156:159], v[64:67], v[96:99], v[156:159]
  v_mfma_f32_16x16x32_bf16 v[172:175], v[68:71], v[96:99], v[172:175]
  v_mfma_f32_16x16x32_bf16 v[176:179], v[68:71], v[100:103], v[176:179]
  v_mfma_f32_16x16x32_bf16 v[180:183], v[68:71], v[104:107], v[180:183]
  v_mfma_f32_16x16x32_bf16 v[184:187], v[68:71], v[108:111], v[184:187]
  v_mfma_f32_16x16x32_bf16 v[200:203], v[72:75], v[108:111], v[200:203]
  v_mfma_f32_16x16x32_bf16 v[196:199], v[72:75], v[104:107], v[196:199]
  v_mfma_f32_16x16x32_bf16 v[192:195], v[72:75], v[100:103], v[192:195]
  v_mfma_f32_16x16x32_bf16 v[188:191], v[72:75], v[96:99], v[188:191]
  ds_read_b128 v[80:83], v11 offset:49152
  s_add_u32 m0, s75, 65536
  s_nop 0
  buffer_load_dwordx4 v32, s[44:47], s74 offen offset:0 lds
  v_mfma_f32_16x16x32_bf16 v[204:207], v[76:79], v[96:99], v[204:207]
  ds_read_b128 v[84:87], v11 offset:51200
  ds_read_b128 v[88:91], v11 offset:53248
  v_mfma_f32_16x16x32_bf16 v[208:211], v[76:79], v[100:103], v[208:211]
  ds_read_b128 v[92:95], v11 offset:55296
  buffer_load_dwordx4 v33, s[44:47], s74 offen offset:1024 lds
  v_mfma_f32_16x16x32_bf16 v[212:215], v[76:79], v[104:107], v[212:215]
  ds_read_b64_tr_b16 v[40:41], v6 offset:0
  ds_read_b64_tr_b16 v[42:43], v6 offset:2560
  v_mfma_f32_16x16x32_bf16 v[216:219], v[76:79], v[108:111], v[216:219]
  ds_read_b64_tr_b16 v[44:45], v7 offset:0
  ds_read_b64_tr_b16 v[46:47], v7 offset:2560
  buffer_load_dwordx4 v34, s[44:47], s74 offen offset:2048 lds
  s_add_u32 s74, s74, 106496
  ds_read_b64_tr_b16 v[48:49], v8 offset:0
  ds_read_b64_tr_b16 v[50:51], v8 offset:2560
  ds_read_b64_tr_b16 v[52:53], v9 offset:0
  s_add_u32 m0, s76, 16384
  s_nop 0
  buffer_load_dwordx4 v28, s[32:35], 0 offen lds
  ds_read_b64_tr_b16 v[54:55], v9 offset:2560
  ds_read_b64_tr_b16 v[56:57], v10 offset:0
  ds_read_b64_tr_b16 v[58:59], v10 offset:2560
  s_waitcnt vmcnt(5) lgkmcnt(0)
  s_barrier
  v_mfma_f32_16x16x32_bf16 v[140:143], v[40:43], v[80:83], v[140:143]
  v_mfma_f32_16x16x32_bf16 v[144:147], v[40:43], v[84:87], v[144:147]
  v_mfma_f32_16x16x32_bf16 v[148:151], v[40:43], v[88:91], v[148:151]
  v_mfma_f32_16x16x32_bf16 v[152:155], v[40:43], v[92:95], v[152:155]
  v_mfma_f32_16x16x32_bf16 v[168:171], v[44:47], v[92:95], v[168:171]
  v_mfma_f32_16x16x32_bf16 v[164:167], v[44:47], v[88:91], v[164:167]
  v_mfma_f32_16x16x32_bf16 v[160:163], v[44:47], v[84:87], v[160:163]
  v_mfma_f32_16x16x32_bf16 v[156:159], v[44:47], v[80:83], v[156:159]
  v_mfma_f32_16x16x32_bf16 v[172:175], v[48:51], v[80:83], v[172:175]
  v_mfma_f32_16x16x32_bf16 v[176:179], v[48:51], v[84:87], v[176:179]
  v_mfma_f32_16x16x32_bf16 v[180:183], v[48:51], v[88:91], v[180:183]
  v_mfma_f32_16x16x32_bf16 v[184:187], v[48:51], v[92:95], v[184:187]
  v_mfma_f32_16x16x32_bf16 v[200:203], v[52:55], v[92:95], v[200:203]
  v_mfma_f32_16x16x32_bf16 v[196:199], v[52:55], v[88:91], v[196:199]
  v_mfma_f32_16x16x32_bf16 v[192:195], v[52:55], v[84:87], v[192:195]
  v_mfma_f32_16x16x32_bf16 v[188:191], v[52:55], v[80:83], v[188:191]
  ds_read_b128 v[96:99], v12 offset:49152
  s_add_u32 m0, s75, 86016
  s_nop 0
  buffer_load_dwordx4 v32, s[44:47], s74 offen offset:0 lds
  v_mfma_f32_16x16x32_bf16 v[204:207], v[56:59], v[80:83], v[204:207]
  ds_read_b128 v[100:103], v12 offset:51200
  ds_read_b128 v[104:107], v12 offset:53248
  v_mfma_f32_16x16x32_bf16 v[208:211], v[56:59], v[84:87], v[208:211]
  ds_read_b128 v[108:111], v12 offset:55296
  buffer_load_dwordx4 v33, s[44:47], s74 offen offset:1024 lds
  v_mfma_f32_16x16x32_bf16 v[212:215], v[56:59], v[88:91], v[212:215]
  ds_read_b64_tr_b16 v[60:61], v6 offset:20480
  ds_read_b64_tr_b16 v[62:63], v6 offset:23040
  v_mfma_f32_16x16x32_bf16 v[216:219], v[56:59], v[92:95], v[216:219]
  ds_read_b64_tr_b16 v[64:65], v7 offset:20480
  ds_read_b64_tr_b16 v[66:67], v7 offset:23040
  buffer_load_dwordx4 v34, s[44:47], s74 offen offset:2048 lds
  s_add_u32 s74, s74, 106496
  ds_read_b64_tr_b16 v[68:69], v8 offset:20480
  ds_read_b64_tr_b16 v[70:71], v8 offset:23040
  ds_read_b64_tr_b16 v[72:73], v9 offset:20480
  s_add_u32 m0, s76, 17408
  s_nop 0
  buffer_load_dwordx4 v29, s[32:35], 0 offen lds
  ds_read_b64_tr_b16 v[74:75], v9 offset:23040
  ds_read_b64_tr_b16 v[76:77], v10 offset:20480
  ds_read_b64_tr_b16 v[78:79], v10 offset:23040
  s_waitcnt vmcnt(5) lgkmcnt(0)
  s_barrier
  v_mfma_f32_16x16x32_bf16 v[140:143], v[60:63], v[96:99], v[140:143]
  v_mfma_f32_16x16x32_bf16 v[144:147], v[60:63], v[100:103], v[144:147]
  v_mfma_f32_16x16x32_bf16 v[148:151], v[60:63], v[104:107], v[148:151]
  v_mfma_f32_16x16x32_bf16 v[152:155], v[60:63], v[108:111], v[152:155]
  v_mfma_f32_16x16x32_bf16 v[168:171], v[64:67], v[108:111], v[168:171]
  v_mfma_f32_16x16x32_bf16 v[164:167], v[64:67], v[104:107], v[164:167]
  v_mfma_f32_16x16x32_bf16 v[160:163], v[64:67], v[100:103], v[160:163]
  v_mfma_f32_16x16x32_bf16 v[156:159], v[64:67], v[96:99], v[156:159]
  v_mfma_f32_16x16x32_bf16 v[172:175], v[68:71], v[96:99], v[172:175]
  v_mfma_f32_16x16x32_bf16 v[176:179], v[68:71], v[100:103], v[176:179]
  v_mfma_f32_16x16x32_bf16 v[180:183], v[68:71], v[104:107], v[180:183]
  v_mfma_f32_16x16x32_bf16 v[184:187], v[68:71], v[108:111], v[184:187]
  v_mfma_f32_16x16x32_bf16 v[200:203], v[72:75], v[108:111], v[200:203]
  v_mfma_f32_16x16x32_bf16 v[196:199], v[72:75], v[104:107], v[196:199]
  v_mfma_f32_16x16x32_bf16 v[192:195], v[72:75], v[100:103], v[192:195]
  v_mfma_f32_16x16x32_bf16 v[188:191], v[72:75], v[96:99], v[188:191]
  ds_read_b128 v[80:83], v11 offset:0
  s_add_u32 m0, s75, 106496
  s_nop 0
  buffer_load_dwordx4 v32, s[44:47], s74 offen offset:0 lds
  v_mfma_f32_16x16x32_bf16 v[204:207], v[76:79], v[96:99], v[204:207]
  ds_read_b128 v[84:87], v11 offset:2048
  ds_read_b128 v[88:91], v11 offset:4096
  v_mfma_f32_16x16x32_bf16 v[208:211], v[76:79], v[100:103], v[208:211]
  ds_read_b128 v[92:95], v11 offset:6144
  buffer_load_dwordx4 v33, s[44:47], s74 offen offset:1024 lds
  v_mfma_f32_16x16x32_bf16 v[212:215], v[76:79], v[104:107], v[212:215]
  ds_read_b64_tr_b16 v[40:41], v1 offset:0
  ds_read_b64_tr_b16 v[42:43], v1 offset:2560
  v_mfma_f32_16x16x32_bf16 v[216:219], v[76:79], v[108:111], v[216:219]
  ds_read_b64_tr_b16 v[44:45], v2 offset:0
  ds_read_b64_tr_b16 v[46:47], v2 offset:2560
  buffer_load_dwordx4 v34, s[44:47], s74 offen offset:2048 lds
  s_add_u32 s74, s74, 106496
  ds_read_b64_tr_b16 v[48:49], v3 offset:0
  ds_read_b64_tr_b16 v[50:51], v3 offset:2560
  ds_read_b64_tr_b16 v[52:53], v4 offset:0
  s_add_u32 m0, s76, 32768
  s_nop 0
  buffer_load_dwordx4 v30, s[32:35], 0 offen lds
  ds_read_b64_tr_b16 v[54:55], v4 offset:2560
  ds_read_b64_tr_b16 v[56:57], v5 offset:0
  ds_read_b64_tr_b16 v[58:59], v5 offset:2560
  s_add_u32 s72, s72, 1
  s_cmp_lt_u32 s72, 6
  s_waitcnt vmcnt(5) lgkmcnt(0)
  s_cbranch_scc1 L_dnn_loop0
  s_barrier
  v_mfma_f32_16x16x32_bf16 v[140:143], v[40:43], v[80:83], v[140:143]
  v_mfma_f32_16x16x32_bf16 v[144:147], v[40:43], v[84:87], v[144:147]
  v_mfma_f32_16x16x32_bf16 v[148:151], v[40:43], v[88:91], v[148:151]
  v_mfma_f32_16x16x32_bf16 v[152:155], v[40:43], v[92:95], v[152:155]
  v_mfma_f32_16x16x32_bf16 v[168:171], v[44:47], v[92:95], v[168:171]
  v_mfma_f32_16x16x32_bf16 v[164:167], v[44:47], v[88:91], v[164:167]
  v_mfma_f32_16x16x32_bf16 v[160:163], v[44:47], v[84:87], v[160:163]
  v_mfma_f32_16x16x32_bf16 v[156:159], v[44:47], v[80:83], v[156:159]
  v_mfma_f32_16x16x32_bf16 v[172:175], v[48:51], v[80:83], v[172:175]
  v_mfma_f32_16x16x32_bf16 v[176:179], v[48:51], v[84:87], v[176:179]
  v_mfma_f32_16x16x32_bf16 v[180:183], v[48:51], v[88:91], v[180:183]
  v_mfma_f32_16x16x32_bf16 v[184:187], v[48:51], v[92:95], v[184:187]
  v_mfma_f32_16x16x32_bf16 v[200:203], v[52:55], v[92:95], v[200:203]
  v_mfma_f32_16x16x32_bf16 v[196:199], v[52:55], v[88:91], v[196:199]
  v_mfma_f32_16x16x32_bf16 v[192:195], v[52:55], v[84:87], v[192:195]
  v_mfma_f32_16x16x32_bf16 v[188:191], v[52:55], v[80:83], v[188:191]
  ds_read_b128 v[96:99], v12 offset:0
  s_add_u32 m0, s75, 126976
  s_nop 0
  buffer_load_dwordx4 v32, s[44:47], s74 offen offset:0 lds
  v_mfma_f32_16x16x32_bf16 v[204:207], v[56:59], v[80:83], v[204:207]
  ds_read_b128 v[100:103], v12 offset:2048
  ds_read_b128 v[104:107], v12 offset:4096
  v_mfma_f32_16x16x32_bf16 v[208:211], v[56:59], v[84:87], v[208:211]
  ds_read_b128 v[108:111], v12 offset:6144
  ds_read_b64_tr_b16 v[60:61], v1 offset:20480
  v_mfma_f32_16x16x32_bf16 v[212:215], v[56:59], v[88:91], v[212:215]
  buffer_load_dwordx4 v33, s[44:47], s74 offen offset:1024 lds
  ds_read_b64_tr_b16 v[62:63], v1 offset:23040
  v_mfma_f32_16x16x32_bf16 v[216:219], v[56:59], v[92:95], v[216:219]
  ds_read_b64_tr_b16 v[64:65], v2 offset:20480
  ds_read_b64_tr_b16 v[66:67], v2 offset:23040
  ds_read_b64_tr_b16 v[68:69], v3 offset:20480
  ds_read_b64_tr_b16 v[70:71], v3 offset:23040
  buffer_load_dwordx4 v34, s[44:47], s74 offen offset:2048 lds
  s_add_u32 s74, s74, 106496
  ds_read_b64_tr_b16 v[72:73], v4 offset:20480
  ds_read_b64_tr_b16 v[74:75], v4 offset:23040
  ds_read_b64_tr_b16 v[76:77], v5 offset:20480
  ds_read_b64_tr_b16 v[78:79], v5 offset:23040
  s_mov_b32 m0, 148096
  s_mov_b32 exec_hi, 0xff
  buffer_load_dwordx4 v37, s[52:55], s77 offen lds
  s_mov_b64 exec, -1
  s_mov_b32 s60, s24
  s_and_b32 s61, s25, 0xffff
  s_mov_b32 s62, 268435456
  s_mov_b32 s63, 0x20000
  s_mov_b32 s56, s20
  s_and_b32 s57, s21, 0xffff
  s_mov_b32 s58, 8192
  s_mov_b32 s59, 0x20000
  s_mov_b32 s64, s22
  s_and_b32 s65, s23, 0xffff
  s_mov_b32 s66, 256
  s_mov_b32 s67, 0x20000
  s_load_dword s80, s[18:19], 0
  v_mov_b32 v220, 0
  s_mov_b64 exec, 1
  s_mov_b32 s81, 0x80000
  buffer_load_dword v255, v220, s[60:63], s81 offen
  buffer_load_dword v255, v220, s[56:59], 0 offen
  buffer_load_dword v255, v220, s[64:67], 0 offen offset:128 sc1
  s_mov_b64 exec, -1
  s_waitcnt vmcnt(8) lgkmcnt(0)
  s_barrier
  v_mfma_f32_16x16x32_bf16 v[140:143], v[60:63], v[96:99], v[140:143]
  v_mfma_f32_16x16x32_bf16 v[144:147], v[60:63], v[100:103], v[144:147]
  v_mfma_f32_16x16x32_bf16 v[148:151], v[60:63], v[104:107], v[148:151]
  v_mfma_f32_16x16x32_bf16 v[152:155], v[60:63], v[108:111], v[152:155]
  v_mfma_f32_16x16x32_bf16 v[168:171], v[64:67], v[108:111], v[168:171]
  v_mfma_f32_16x16x32_bf16 v[164:167], v[64:67], v[104:107], v[164:167]
  v_mfma_f32_16x16x32_bf16 v[160:163], v[64:67], v[100:103], v[160:163]
  v_mfma_f32_16x16x32_bf16 v[156:159], v[64:67], v[96:99], v[156:159]
  v_mfma_f32_16x16x32_bf16 v[172:175], v[68:71], v[96:99], v[172:175]
  v_mfma_f32_16x16x32_bf16 v[176:179], v[68:71], v[100:103], v[176:179]
  v_mfma_f32_16x16x32_bf16 v[180:183], v[68:71], v[104:107], v[180:183]
  v_mfma_f32_16x16x32_bf16 v[184:187], v[68:71], v[108:111], v[184:187]
  v_mfma_f32_16x16x32_bf16 v[200:203], v[72:75], v[108:111], v[200:203]
  v_mfma_f32_16x16x32_bf16 v[196:199], v[72:75], v[104:107], v[196:199]
  v_mfma_f32_16x16x32_bf16 v[192:195], v[72:75], v[100:103], v[192:195]
  v_mfma_f32_16x16x32_bf16 v[188:191], v[72:75], v[96:99], v[188:191]
  ds_read_b128 v[80:83], v11 offset:16384
  ds_read_b128 v[84:87], v11 offset:18432
  v_mfma_f32_16x16x32_bf16 v[204:207], v[76:79], v[96:99], v[204:207]
  ds_read_b128 v[88:91], v11 offset:20480
  ds_read_b128 v[92:95], v11 offset:22528
  v_mfma_f32_16x16x32_bf16 v[208:211], v[76:79], v[100:103], v[208:211]
  ds_read_b64_tr_b16 v[40:41], v6 offset:0
  ds_read_b64_tr_b16 v[42:43], v6 offset:2560
  v_mfma_f32_16x16x32_bf16 v[212:215], v[76:79], v[104:107], v[212:215]
  ds_read_b64_tr_b16 v[44:45], v7 offset:0
  ds_read_b64_tr_b16 v[46:47], v7 offset:2560
  v_mfma_f32_16x16x32_bf16 v[216:219], v[76:79], v[108:111], v[216:219]
  ds_read_b64_tr_b16 v[48:49], v8 offset:0
  ds_read_b64_tr_b16 v[50:51], v8 offset:2560
  ds_read_b64_tr_b16 v[52:53], v9 offset:0
  ds_read_b64_tr_b16 v[54:55], v9 offset:2560
  ds_read_b64_tr_b16 v[56:57], v10 offset:0
  ds_read_b64_tr_b16 v[58:59], v10 offset:2560
  v_mov_b32 v232, 0xc0135761
  v_mov_b32 v233, 0xc0135761
  v_mov_b32 v234, 0xbdd2d3e8
  v_mov_b32 v235, 0xbdd2d3e8
  v_mov_b32 v236, 1.0
  v_mov_b32 v237, 1.0
  s_waitcnt vmcnt(0) lgkmcnt(0)
  s_barrier
  v_mfma_f32_16x16x32_bf16 v[140:143], v[40:43], v[80:83], v[140:143]
  v_mfma_f32_16x16x32_bf16 v[144:147], v[40:43], v[84:87], v[144:147]
  v_mfma_f32_16x16x32_bf16 v[148:151], v[40:43], v[88:91], v[148:151]
  v_mfma_f32_16x16x32_bf16 v[152:155], v[40:43], v[92:95], v[152:155]
  v_mfma_f32_16x16x32_bf16 v[168:171], v[44:47], v[92:95], v[168:171]
  v_mfma_f32_16x16x32_bf16 v[164:167], v[44:47], v[88:91], v[164:167]
  v_mfma_f32_16x16x32_bf16 v[160:163], v[44:47], v[84:87], v[160:163]
  v_mfma_f32_16x16x32_bf16 v[156:159], v[44:47], v[80:83], v[156:159]
  v_mfma_f32_16x16x32_bf16 v[172:175], v[48:51], v[80:83], v[172:175]
  v_mfma_f32_16x16x32_bf16 v[176:179], v[48:51], v[84:87], v[176:179]
  v_mfma_f32_16x16x32_bf16 v[180:183], v[48:51], v[88:91], v[180:183]
  v_mfma_f32_16x16x32_bf16 v[184:187], v[48:51], v[92:95], v[184:187]
  v_mfma_f32_16x16x32_bf16 v[200:203], v[52:55], v[92:95], v[200:203]
  v_mfma_f32_16x16x32_bf16 v[196:199], v[52:55], v[88:91], v[196:199]
  v_mfma_f32_16x16x32_bf16 v[192:195], v[52:55], v[84:87], v[192:195]
  v_mfma_f32_16x16x32_bf16 v[188:191], v[52:55], v[80:83], v[188:191]
  ds_read_b128 v[96:99], v12 offset:16384
  ds_read_b128 v[100:103], v12 offset:18432
  v_mfma_f32_16x16x32_bf16 v[204:207], v[56:59], v[80:83], v[204:207]
  ds_read_b128 v[104:107], v12 offset:20480
  ds_read_b128 v[108:111], v12 offset:22528
  v_mfma_f32_16x16x32_bf16 v[208:211], v[56:59], v[84:87], v[208:211]
  ds_read_b64_tr_b16 v[60:61], v6 offset:20480
  ds_read_b64_tr_b16 v[62:63], v6 offset:23040
  v_mfma_f32_16x16x32_bf16 v[212:215], v[56:59], v[88:91], v[212:215]
  ds_read_b64_tr_b16 v[64:65], v7 offset:20480
  ds_read_b64_tr_b16 v[66:67], v7 offset:23040
  v_mfma_f32_16x16x32_bf16 v[216:219], v[56:59], v[92:95], v[216:219]
  ds_read_b64_tr_b16 v[68:69], v8 offset:20480
  ds_read_b64_tr_b16 v[70:71], v8 offset:23040
  ds_read_b64_tr_b16 v[72:73], v9 offset:20480
  ds_read_b64_tr_b16 v[74:75], v9 offset:23040
  ds_read_b64_tr_b16 v[76:77], v10 offset:20480
  ds_read_b64_tr_b16 v[78:79], v10 offset:23040
  ds_read_b64 v[220:221], v35 offset:640
  ds_read_b64 v[222:223], v35 offset:672
  ds_read_b64 v[224:225], v35 offset:704
  ds_read_b64 v[226:227], v35 offset:736
  ds_read_b64 v[228:229], v35 offset:768
  s_waitcnt lgkmcnt(0)
  v_mfma_f32_16x16x32_bf16 v[140:143], v[60:63], v[96:99], v[140:143]
  v_mfma_f32_16x16x32_bf16 v[144:147], v[60:63], v[100:103], v[144:147]
  v_mfma_f32_16x16x32_bf16 v[148:151], v[60:63], v[104:107], v[148:151]
  v_mfma_f32_16x16x32_bf16 v[152:155], v[60:63], v[108:111], v[152:155]
  v_mfma_f32_16x16x32_bf16 v[168:171], v[64:67], v[108:111], v[168:171]
  v_mfma_f32_16x16x32_bf16 v[164:167], v[64:67], v[104:107], v[164:167]
  v_mfma_f32_16x16x32_bf16 v[160:163], v[64:67], v[100:103], v[160:163]
  v_mfma_f32_16x16x32_bf16 v[156:159], v[64:67], v[96:99], v[156:159]
  v_mfma_f32_16x16x32_bf16 v[172:175], v[68:71], v[96:99], v[172:175]
  v_mfma_f32_16x16x32_bf16 v[176:179], v[68:71], v[100:103], v[176:179]
  v_mfma_f32_16x16x32_bf16 v[180:183], v[68:71], v[104:107], v[180:183]
  v_mfma_f32_16x16x32_bf16 v[184:187], v[68:71], v[108:111], v[184:187]
  v_mfma_f32_16x16x32_bf16 v[200:203], v[72:75], v[108:111], v[200:203]
  v_mfma_f32_16x16x32_bf16 v[196:199], v[72:75], v[104:107], v[196:199]
  v_mfma_f32_16x16x32_bf16 v[192:195], v[72:75], v[100:103], v[192:195]
  v_mfma_f32_16x16x32_bf16 v[188:191], v[72:75], v[96:99], v[188:191]
  v_lshlrev_b32 v112, 16, v220
  v_and_b32 v113, 0xffff0000, v220
  v_mfma_f32_16x16x32_bf16 v[204:207], v[76:79], v[96:99], v[204:207]
  v_lshlrev_b32 v114, 16, v221
  v_and_b32 v115, 0xffff0000, v221
  v_mfma_f32_16x16x32_bf16 v[208:211], v[76:79], v[100:103], v[208:211]
  v_lshlrev_b32 v116, 16, v222
  v_and_b32 v117, 0xffff0000, v222
  v_mfma_f32_16x16x32_bf16 v[212:215], v[76:79], v[104:107], v[212:215]
  v_lshlrev_b32 v118, 16, v223
  v_and_b32 v119, 0xffff0000, v223
  v_mfma_f32_16x16x32_bf16 v[216:219], v[76:79], v[108:111], v[216:219]
  v_lshlrev_b32 v120, 16, v224
  v_and_b32 v121, 0xffff0000, v224
  v_lshlrev_b32 v122, 16, v225
  v_and_b32 v123, 0xffff0000, v225
  v_lshlrev_b32 v124, 16, v226
  v_and_b32 v125, 0xffff0000, v226
  v_lshlrev_b32 v126, 16, v227
  v_and_b32 v127, 0xffff0000, v227
  v_lshlrev_b32 v128, 16, v228
  v_and_b32 v129, 0xffff0000, v228
  v_lshlrev_b32 v130, 16, v229
  v_and_b32 v131, 0xffff0000, v229
  s_branch L_epi
L_dnn_h1:
  s_waitcnt vmcnt(7) lgkmcnt(0)
L_dnn_loop1:
  s_barrier
  ds_read_b128 v[96:99], v12 offset:0
  s_add_u32 m0, s75, 126976
  s_nop 0
  buffer_load_dwordx4 v32, s[44:47], s74 offen offset:0 lds
  ds_read_b128 v[100:103], v12 offset:2048
  ds_read_b128 v[104:107], v12 offset:4096
  ds_read_b128 v[108:111], v12 offset:6144
  ds_read_b64_tr_b16 v[60:61], v1 offset:20480
  buffer_load_dwordx4 v33, s[44:47], s74 offen offset:1024 lds
  s_add_u32 s74, s74, 106496
  ds_read_b64_tr_b16 v[62:63], v1 offset:23040
  ds_read_b64_tr_b16 v[64:65], v2 offset:20480
  ds_read_b64_tr_b16 v[66:67], v2 offset:23040
  ds_read_b64_tr_b16 v[68:69], v3 offset:20480
  ds_read_b64_tr_b16 v[70:71], v3 offset:23040
  s_add_u32 m0, s76, 33792
  s_nop 0
  buffer_load_dwordx4 v31, s[32:35], 0 offen lds
  ds_read_b64_tr_b16 v[72:73], v4 offset:20480
  ds_read_b64_tr_b16 v[74:75], v4 offset:23040
  ds_read_b64_tr_b16 v[76:77], v5 offset:20480
  ds_read_b64_tr_b16 v[78:79], v5 offset:23040
  s_waitcnt vmcnt(7)
  v_lshl_add_u32 v24, v16, 7, v14
  s_waitcnt vmcnt(6)
  v_lshl_add_u32 v25, v20, 7, v15
  v_lshl_add_u32 v26, v17, 7, v14
  v_lshl_add_u32 v27, v21, 7, v15
  v_lshl_add_u32 v28, v18, 7, v14
  v_lshl_add_u32 v29, v22, 7, v15
  v_lshl_add_u32 v30, v19, 7, v14
  v_lshl_add_u32 v31, v23, 7, v15
  v_mfma_f32_16x16x32_bf16 v[140:143], v[40:43], v[80:83], v[140:143]
  v_mfma_f32_16x16x32_bf16 v[144:147], v[40:43], v[84:87], v[144:147]
  v_mfma_f32_16x16x32_bf16 v[148:151], v[40:43], v[88:91], v[148:151]
  v_mfma_f32_16x16x32_bf16 v[152:155], v[40:43], v[92:95], v[152:155]
  v_mfma_f32_16x16x32_bf16 v[168:171], v[44:47], v[92:95], v[168:171]
  v_mfma_f32_16x16x32_bf16 v[164:167], v[44:47], v[88:91], v[164:167]
  v_mfma_f32_16x16x32_bf16 v[160:163], v[44:47], v[84:87], v[160:163]
  v_mfma_f32_16x16x32_bf16 v[156:159], v[44:47], v[80:83], v[156:159]
  v_mfma_f32_16x16x32_bf16 v[172:175], v[48:51], v[80:83], v[172:175]
  v_mfma_f32_16x16x32_bf16 v[176:179], v[48:51], v[84:87], v[176:179]
  v_mfma_f32_16x16x32_bf16 v[180:183], v[48:51], v[88:91], v[180:183]
  v_mfma_f32_16x16x32_bf16 v[184:187], v[48:51], v[92:95], v[184:187]
  v_mfma_f32_16x16x32_bf16 v[200:203], v[52:55], v[92:95], v[200:203]
  v_mfma_f32_16x16x32_bf16 v[196:199], v[52:55], v[88:91], v[196:199]
  v_mfma_f32_16x16x32_bf16 v[192:195], v[52:55], v[84:87], v[192:195]
  v_mfma_f32_16x16x32_bf16 v[188:191], v[52:55], v[80:83], v[188:191]
  v_mfma_f32_16x16x32_bf16 v[204:207], v[56:59], v[80:83], v[204:207]
  v_mfma_f32_16x16x32_bf16 v[208:211], v[56:59], v[84:87], v[208:211]
  v_mfma_f32_16x16x32_bf16 v[212:215], v[56:59], v[88:91], v[212:215]
  s_waitcnt vmcnt(4) lgkmcnt(0)
  v_mfma_f32_16x16x32_bf16 v[216:219], v[56:59], v[92:95], v[216:219]
  s_barrier
  ds_read_b128 v[80:83], v11 offset:16384
  s_add_u32 m0, s75, 65536
  s_nop 0
  buffer_load_dwordx4 v32, s[44:47], s74 offen offset:0 lds
  ds_read_b128 v[84:87], v11 offset:18432
  ds_read_b128 v[88:91], v11 offset:20480
  ds_read_b128 v[92:95], v11 offset:22528
  ds_read_b64_tr_b16 v[40:41], v6 offset:0
  buffer_load_dwordx4 v33, s[44:47], s74 offen offset:1024 lds
  s_add_u32 s74, s74, 106496
  ds_read_b64_tr_b16 v[42:43], v6 offset:2560
  ds_read_b64_tr_b16 v[44:45], v7 offset:0
  ds_read_b64_tr_b16 v[46:47], v7 offset:2560
  ds_read_b64_tr_b16 v[48:49], v8 offset:0
  ds_read_b64_tr_b16 v[50:51], v8 offset:2560
  s_add_u32 m0, s76, 49152
  s_nop 0
  buffer_load_dwordx4 v24, s[32:35], 0 offen lds
  ds_read_b64_tr_b16 v[52:53], v9 offset:0
  ds_read_b64_tr_b16 v[54:55], v9 offset:2560
  ds_read_b64_tr_b16 v[56:57], v10 offset:0
  ds_read_b64_tr_b16 v[58:59], v10 offset:2560
  buffer_load_dwordx4 v[16:19], v13, s[28:31], s73 offen offset:0
  buffer_load_dwordx4 v[20:23], v13, s[28:31], s73 offen offset:832
  s_add_u32 s73, s73, 16
  v_mfma_f32_16x16x32_bf16 v[140:143], v[60:63], v[96:99], v[140:143]
  v_mfma_f32_16x16x32_bf16 v[144:147], v[60:63], v[100:103], v[144:147]
  v_mfma_f32_16x16x32_bf16 v[148:151], v[60:63], v[104:107], v[148:151]
  v_mfma_f32_16x16x32_bf16 v[152:155], v[60:63], v[108:111], v[152:155]
  v_mfma_f32_16x16x32_bf16 v[168:171], v[64:67], v[108:111], v[168:171]
  v_mfma_f32_16x16x32_bf16 v[164:167], v[64:67], v[104:107], v[164:167]
  v_mfma_f32_16x16x32_bf16 v[160:163], v[64:67], v[100:103], v[160:163]
  v_mfma_f32_16x16x32_bf16 v[156:159], v[64:67], v[96:99], v[156:159]
  v_mfma_f32_16x16x32_bf16 v[172:175], v[68:71], v[96:99], v[172:175]
  v_mfma_f32_16x16x32_bf16 v[176:179], v[68:71], v[100:103], v[176:179]
  v_mfma_f32_16x16x32_bf16 v[180:183], v[68:71], v[104:107], v[180:183]
  v_mfma_f32_16x16x32_bf16 v[184:187], v[68:71], v[108:111], v[184:187]
  v_mfma_f32_16x16x32_bf16 v[200:203], v[72:75], v[108:111], v[200:203]
  v_mfma_f32_16x16x32_bf16 v[196:199], v[72:75], v[104:107], v[196:199]
  v_mfma_f32_16x16x32_bf16 v[192:195], v[72:75], v[100:103], v[192:195]
  v_mfma_f32_16x16x32_bf16 v[188:191], v[72:75], v[96:99], v[188:191]
  v_mfma_f32_16x16x32_bf16 v[204:207], v[76:79], v[96:99], v[204:207]
  v_mfma_f32_16x16x32_bf16 v[208:211], v[76:79], v[100:103], v[208:211]
  v_mfma_f32_16x16x32_bf16 v[212:215], v[76:79], v[104:107], v[212:215]
  s_waitcnt vmcnt(6) lgkmcnt(0)
  v_mfma_f32_16x16x32_bf16 v[216:219], v[76:79], v[108:111], v[216:219]
  s_barrier
  ds_read_b128 v[96:99], v12 offset:16384
  s_add_u32 m0, s75, 86016
  s_nop 0
  buffer_load_dwordx4 v32, s[44:47], s74 offen offset:0 lds
  ds_read_b128 v[100:103], v12 offset:18432
  ds_read_b128 v[104:107], v12 offset:20480
  ds_read_b128 v[108:111], v12 offset:22528
  ds_read_b64_tr_b16 v[60:61], v6 offset:20480
  buffer_load_dwordx4 v33, s[44:47], s74 offen offset:1024 lds
  s_add_u32 s74, s74, 106496
  ds_read_b64_tr_b16 v[62:63], v6 offset:23040
  ds_read_b64_tr_b16 v[64:65], v7 offset:20480
  ds_read_b64_tr_b16 v[66:67], v7 offset:23040
  ds_read_b64_tr_b16 v[68:69], v8 offset:20480
  ds_read_b64_tr_b16 v[70:71], v8 offset:23040
  s_add_u32 m0, s76, 50176
  s_nop 0
  buffer_load_dwordx4 v25, s[32:35], 0 offen lds
  ds_read_b64_tr_b16 v[72:73], v9 offset:20480
  ds_read_b64_tr_b16 v[74:75], v9 offset:23040
  ds_read_b64_tr_b16 v[76:77], v10 offset:20480
  ds_read_b64_tr_b16 v[78:79], v10 offset:23040
  v_mfma_f32_16x16x32_bf16 v[140:143], v[40:43], v[80:83], v[140:143]
  v_mfma_f32_16x16x32_bf16 v[144:147], v[40:43], v[84:87], v[144:147]
  v_mfma_f32_16x16x32_bf16 v[148:151], v[40:43], v[88:91], v[148:151]
  v_mfma_f32_16x16x32_bf16 v[152:155], v[40:43], v[92:95], v[152:155]
  v_mfma_f32_16x16x32_bf16 v[168:171], v[44:47], v[92:95], v[168:171]
  v_mfma_f32_16x16x32_bf16 v[164:167], v[44:47], v[88:91], v[164:167]
  v_mfma_f32_16x16x32_bf16 v[160:163], v[44:47], v[84:87], v[160:163]
  v_mfma_f32_16x16x32_bf16 v[156:159], v[44:47], v[80:83], v[156:159]
  v_mfma_f32_16x16x32_bf16 v[172:175], v[48:51], v[80:83], v[172:175]
  v_mfma_f32_16x16x32_bf16 v[176:179], v[48:51], v[84:87], v[176:179]
  v_mfma_f32_16x16x32_bf16 v[180:183], v[48:51], v[88:91], v[180:183]
  v_mfma_f32_16x16x32_bf16 v[184:187], v[48:51], v[92:95], v[184:187]
  v_mfma_f32_16x16x32_bf16 v[200:203], v[52:55], v[92:95], v[200:203]
  v_mfma_f32_16x16x32_bf16 v[196:199], v[52:55], v[88:91], v[196:199]
  v_mfma_f32_16x16x32_bf16 v[192:195], v[52:55], v[84:87], v[192:195]
  v_mfma_f32_16x16x32_bf16 v[188:191], v[52:55], v[80:83], v[188:191]
  v_mfma_f32_16x16x32_bf16 v[204:207], v[56:59], v[80:83], v[204:207]
  v_mfma_f32_16x16x32_bf16 v[208:211], v[56:59], v[84:87], v[208:211]
  v_mfma_f32_16x16x32_bf16 v[212:215], v[56:59], v[88:91], v[212:215]
  s_waitcnt vmcnt(6) lgkmcnt(0)
  v_mfma_f32_16x16x32_bf16 v[216:219], v[56:59], v[92:95], v[216:219]
  s_barrier
  ds_read_b128 v[80:83], v11 offset:32768
  s_add_u32 m0, s75, 106496
  s_nop 0
  buffer_load_dwordx4 v32, s[44:47], s74 offen offset:0 lds
  ds_read_b128 v[84:87], v11 offset:34816
  ds_read_b128 v[88:91], v11 offset:36864
  ds_read_b128 v[92:95], v11 offset:38912
  ds_read_b64_tr_b16 v[40:41], v1 offset:0
  buffer_load_dwordx4 v33, s[44:47], s74 offen offset:1024 lds
  s_add_u32 s74, s74, 106496
  ds_read_b64_tr_b16 v[42:43], v1 offset:2560
  ds_read_b64_tr_b16 v[44:45], v2 offset:0
  ds_read_b64_tr_b16 v[46:47], v2 offset:2560
  ds_read_b64_tr_b16 v[48:49], v3 offset:0
  ds_read_b64_tr_b16 v[50:51], v3 offset:2560
  s_add_u32 m0, s76, 0
  s_nop 0
  buffer_load_dwordx4 v26, s[32:35], 0 offen lds
  ds_read_b64_tr_b16 v[52:53], v4 offset:0
  ds_read_b64_tr_b16 v[54:55], v4 offset:2560
  ds_read_b64_tr_b16 v[56:57], v5 offset:0
  ds_read_b64_tr_b16 v[58:59], v5 offset:2560
  v_mfma_f32_16x16x32_bf16 v[140:143], v[60:63], v[96:99], v[140:143]
  v_mfma_f32_16x16x32_bf16 v[144:147], v[60:63], v[100:103], v[144:147]
  v_mfma_f32_16x16x32_bf16 v[148:151], v[60:63], v[104:107], v[148:151]
  v_mfma_f32_16x16x32_bf16 v[152:155], v[60:63], v[108:111], v[152:155]
  v_mfma_f32_16x16x32_bf16 v[168:171], v[64:67], v[108:111], v[168:171]
  v_mfma_f32_16x16x32_bf16 v[164:167], v[64:67], v[104:107], v[164:167]
  v_mfma_f32_16x16x32_bf16 v[160:163], v[64:67], v[100:103], v[160:163]
  v_mfma_f32_16x16x32_bf16 v[156:159], v[64:67], v[96:99], v[156:159]
  v_mfma_f32_16x16x32_bf16 v[172:175], v[68:71], v[96:99], v[172:175]
  v_mfma_f32_16x16x32_bf16 v[176:179], v[68:71], v[100:103], v[176:179]
  v_mfma_f32_16x16x32_bf16 v[180:183], v[68:71], v[104:107], v[180:183]
  v_mfma_f32_16x16x32_bf16 v[184:187], v[68:71], v[108:111], v[184:187]
  v_mfma_f32_16x16x32_bf16 v[200:203], v[72:75], v[108:111], v[200:203]
  v_mfma_f32_16x16x32_bf16 v[196:199], v[72:75], v[104:107], v[196:199]
  v_mfma_f32_16x16x32_bf16 v[192:195], v[72:75], v[100:103], v[192:195]
  v_mfma_f32_16x16x32_bf16 v[188:191], v[72:75], v[96:99], v[188:191]
  v_mfma_f32_16x16x32_bf16 v[204:207], v[76:79], v[96:99], v[204:207]
  v_mfma_f32_16x16x32_bf16 v[208:211], v[76:79], v[100:103], v[208:211]
  v_mfma_f32_16x16x32_bf16 v[212:215], v[76:79], v[104:107], v[212:215]
  s_waitcnt vmcnt(4) lgkmcnt(0)
  v_mfma_f32_16x16x32_bf16 v[216:219], v[76:79], v[108:111], v[216:219]
  s_barrier
  ds_read_b128 v[96:99], v12 offset:32768
  s_add_u32 m0, s75, 126976
  s_nop 0
  buffer_load_dwordx4 v32, s[44:47], s74 offen offset:0 lds
  ds_read_b128 v[100:103], v12 offset:34816
  ds_read_b128 v[104:107], v12 offset:36864
  ds_read_b128 v[108:111], v12 offset:38912
  ds_read_b64_tr_b16 v[60:61], v1 offset:20480
  buffer_load_dwordx4 v33, s[44:47], s74 offen offset:1024 lds
  s_add_u32 s74, s74, 106496
  ds_read_b64_tr_b16 v[62:63], v1 offset:23040
  ds_read_b64_tr_b16 v[64:65], v2 offset:20480
  ds_read_b64_tr_b16 v[66:67], v2 offset:23040
  ds_read_b64_tr_b16 v[68:69], v3 offset:20480
  ds_read_b64_tr_b16 v[70:71], v3 offset:23040
  s_add_u32 m0, s76, 1024
  s_nop 0
  buffer_load_dwordx4 v27, s[32:35], 0 offen lds
  ds_read_b64_tr_b16 v[72:73], v4 offset:20480
  ds_read_b64_tr_b16 v[74:75], v4 offset:23040
  ds_read_b64_tr_b16 v[76:77], v5 offset:20480
  ds_read_b64_tr_b16 v[78:79], v5 offset:23040
  v_mfma_f32_16x16x32_bf16 v[140:143], v[40:43], v[80:83], v[140:143]
  v_mfma_f32_16x16x32_bf16 v[144:147], v[40:43], v[84:87], v[144:147]
  v_mfma_f32_16x16x32_bf16 v[148:151], v[40:43], v[88:91], v[148:151]
  v_mfma_f32_16x16x32_bf16 v[152:155], v[40:43], v[92:95], v[152:155]
  v_mfma_f32_16x16x32_bf16 v[168:171], v[44:47], v[92:95], v[168:171]
  v_mfma_f32_16x16x32_bf16 v[164:167], v[44:47], v[88:91], v[164:167]
  v_mfma_f32_16x16x32_bf16 v[160:163], v[44:47], v[84:87], v[160:163]
  v_mfma_f32_16x16x32_bf16 v[156:159], v[44:47], v[80:83], v[156:159]
  v_mfma_f32_16x16x32_bf16 v[172:175], v[48:51], v[80:83], v[172:175]
  v_mfma_f32_16x16x32_bf16 v[176:179], v[48:51], v[84:87], v[176:179]
  v_mfma_f32_16x16x32_bf16 v[180:183], v[48:51], v[88:91], v[180:183]
  v_mfma_f32_16x16x32_bf16 v[184:187], v[48:51], v[92:95], v[184:187]
  v_mfma_f32_16x16x32_bf16 v[200:203], v[52:55], v[92:95], v[200:203]
  v_mfma_f32_16x16x32_bf16 v[196:199], v[52:55], v[88:91], v[196:199]
  v_mfma_f32_16x16x32_bf16 v[192:195], v[52:55], v[84:87], v[192:195]
  v_mfma_f32_16x16x32_bf16 v[188:191], v[52:55], v[80:83], v[188:191]
  v_mfma_f32_16x16x32_bf16 v[204:207], v[56:59], v[80:83], v[204:207]
  v_mfma_f32_16x16x32_bf16 v[208:211], v[56:59], v[84:87], v[208:211]
  v_mfma_f32_16x16x32_bf16 v[212:215], v[56:59], v[88:91], v[212:215]
  s_waitcnt vmcnt(4) lgkmcnt(0)
  v_mfma_f32_16x16x32_bf16 v[216:219], v[56:59], v[92:95], v[216:219]
  s_barrier
  ds_read_b128 v[80:83], v11 offset:49152
  s_add_u32 m0, s75, 65536
  s_nop 0
  buffer_load_dwordx4 v32, s[44:47], s74 offen offset:0 lds
  ds_read_b128 v[84:87], v11 offset:51200
  ds_read_b128 v[88:91], v11 offset:53248
  ds_read_b128 v[92:95], v11 offset:55296
  ds_read_b64_tr_b16 v[40:41], v6 offset:0
  buffer_load_dwordx4 v33, s[44:47], s74 offen offset:1024 lds
  s_add_u32 s74, s74, 106496
  ds_read_b64_tr_b16 v[42:43], v6 offset:2560
  ds_read_b64_tr_b16 v[44:45], v7 offset:0
  ds_read_b64_tr_b16 v[46:47], v7 offset:2560
  ds_read_b64_tr_b16 v[48:49], v8 offset:0
  ds_read_b64_tr_b16 v[50:51], v8 offset:2560
  s_add_u32 m0, s76, 16384
  s_nop 0
  buffer_load_dwordx4 v28, s[32:35], 0 offen lds
  ds_read_b64_tr_b16 v[52:53], v9 offset:0
  ds_read_b64_tr_b16 v[54:55], v9 offset:2560
  ds_read_b64_tr_b16 v[56:57], v10 offset:0
  ds_read_b64_tr_b16 v[58:59], v10 offset:2560
  v_mfma_f32_16x16x32_bf16 v[140:143], v[60:63], v[96:99], v[140:143]
  v_mfma_f32_16x16x32_bf16 v[144:147], v[60:63], v[100:103], v[144:147]
  v_mfma_f32_16x16x32_bf16 v[148:151], v[60:63], v[104:107], v[148:151]
  v_mfma_f32_16x16x32_bf16 v[152:155], v[60:63], v[108:111], v[152:155]
  v_mfma_f32_16x16x32_bf16 v[168:171], v[64:67], v[108:111], v[168:171]
  v_mfma_f32_16x16x32_bf16 v[164:167], v[64:67], v[104:107], v[164:167]
  v_mfma_f32_16x16x32_bf16 v[160:163], v[64:67], v[100:103], v[160:163]
  v_mfma_f32_16x16x32_bf16 v[156:159], v[64:67], v[96:99], v[156:159]
  v_mfma_f32_16x16x32_bf16 v[172:175], v[68:71], v[96:99], v[172:175]
  v_mfma_f32_16x16x32_bf16 v[176:179], v[68:71], v[100:103], v[176:179]
  v_mfma_f32_16x16x32_bf16 v[180:183], v[68:71], v[104:107], v[180:183]
  v_mfma_f32_16x16x32_bf16 v[184:187], v[68:71], v[108:111], v[184:187]
  v_mfma_f32_16x16x32_bf16 v[200:203], v[72:75], v[108:111], v[200:203]
  v_mfma_f32_16x16x32_bf16 v[196:199], v[72:75], v[104:107], v[196:199]
  v_mfma_f32_16x16x32_bf16 v[192:195], v[72:75], v[100:103], v[192:195]
  v_mfma_f32_16x16x32_bf16 v[188:191], v[72:75], v[96:99], v[188:191]
  v_mfma_f32_16x16x32_bf16 v[204:207], v[76:79], v[96:99], v[204:207]
  v_mfma_f32_16x16x32_bf16 v[208:211], v[76:79], v[100:103], v[208:211]
  v_mfma_f32_16x16x32_bf16 v[212:215], v[76:79], v[104:107], v[212:215]
  s_waitcnt vmcnt(4) lgkmcnt(0)
  v_mfma_f32_16x16x32_bf16 v[216:219], v[76:79], v[108:111], v[216:219]
  s_barrier
  ds_read_b128 v[96:99], v12 offset:49152
  s_add_u32 m0, s75, 86016
  s_nop 0
  buffer_load_dwordx4 v32, s[44:47], s74 offen offset:0 lds
  ds_read_b128 v[100:103], v12 offset:51200
  ds_read_b128 v[104:107], v12 offset:53248
  ds_read_b128 v[108:111], v12 offset:55296
  ds_read_b64_tr_b16 v[60:61], v6 offset:20480
  buffer_load_dwordx4 v33, s[44:47], s74 offen offset:1024 lds
  s_add_u32 s74, s74, 106496
  ds_read_b64_tr_b16 v[62:63], v6 offset:23040
  ds_read_b64_tr_b16 v[64:65], v7 offset:20480
  ds_read_b64_tr_b16 v[66:67], v7 offset:23040
  ds_read_b64_tr_b16 v[68:69], v8 offset:20480
  ds_read_b64_tr_b16 v[70:71], v8 offset:23040
  s_add_u32 m0, s76, 17408
  s_nop 0
  buffer_load_dwordx4 v29, s[32:35], 0 offen lds
  ds_read_b64_tr_b16 v[72:73], v9 offset:20480
  ds_read_b64_tr_b16 v[74:75], v9 offset:23040
  ds_read_b64_tr_b16 v[76:77], v10 offset:20480
  ds_read_b64_tr_b16 v[78:79], v10 offset:23040
  v_mfma_f32_16x16x32_bf16 v[140:143], v[40:43], v[80:83], v[140:143]
  v_mfma_f32_16x16x32_bf16 v[144:147], v[40:43], v[84:87], v[144:147]
  v_mfma_f32_16x16x32_bf16 v[148:151], v[40:43], v[88:91], v[148:151]
  v_mfma_f32_16x16x32_bf16 v[152:155], v[40:43], v[92:95], v[152:155]
  v_mfma_f32_16x16x32_bf16 v[168:171], v[44:47], v[92:95], v[168:171]
  v_mfma_f32_16x16x32_bf16 v[164:167], v[44:47], v[88:91], v[164:167]
  v_mfma_f32_16x16x32_bf16 v[160:163], v[44:47], v[84:87], v[160:163]
  v_mfma_f32_16x16x32_bf16 v[156:159], v[44:47], v[80:83], v[156:159]
  v_mfma_f32_16x16x32_bf16 v[172:175], v[48:51], v[80:83], v[172:175]
  v_mfma_f32_16x16x32_bf16 v[176:179], v[48:51], v[84:87], v[176:179]
  v_mfma_f32_16x16x32_bf16 v[180:183], v[48:51], v[88:91], v[180:183]
  v_mfma_f32_16x16x32_bf16 v[184:187], v[48:51], v[92:95], v[184:187]
  v_mfma_f32_16x16x32_bf16 v[200:203], v[52:55], v[92:95], v[200:203]
  v_mfma_f32_16x16x32_bf16 v[196:199], v[52:55], v[88:91], v[196:199]
  v_mfma_f32_16x16x32_bf16 v[192:195], v[52:55], v[84:87], v[192:195]
  v_mfma_f32_16x16x32_bf16 v[188:191], v[52:55], v[80:83], v[188:191]
  v_mfma_f32_16x16x32_bf16 v[204:207], v[56:59], v[80:83], v[204:207]
  v_mfma_f32_16x16x32_bf16 v[208:211], v[56:59], v[84:87], v[208:211]
  v_mfma_f32_16x16x32_bf16 v[212:215], v[56:59], v[88:91], v[212:215]
  s_waitcnt vmcnt(4) lgkmcnt(0)
  v_mfma_f32_16x16x32_bf16 v[216:219], v[56:59], v[92:95], v[216:219]
  s_barrier
  ds_read_b128 v[80:83], v11 offset:0
  s_add_u32 m0, s75, 106496
  s_nop 0
  buffer_load_dwordx4 v32, s[44:47], s74 offen offset:0 lds
  ds_read_b128 v[84:87], v11 offset:2048
  ds_read_b128 v[88:91], v11 offset:4096
  ds_read_b128 v[92:95], v11 offset:6144
  ds_read_b64_tr_b16 v[40:41], v1 offset:0
  buffer_load_dwordx4 v33, s[44:47], s74 offen offset:1024 lds
  s_add_u32 s74, s74, 106496
  ds_read_b64_tr_b16 v[42:43], v1 offset:2560
  ds_read_b64_tr_b16 v[44:45], v2 offset:0
  ds_read_b64_tr_b16 v[46:47], v2 offset:2560
  ds_read_b64_tr_b16 v[48:49], v3 offset:0
  ds_read_b64_tr_b16 v[50:51], v3 offset:2560
  s_add_u32 m0, s76, 32768
  s_nop 0
  buffer_load_dwordx4 v30, s[32:35], 0 offen lds
  ds_read_b64_tr_b16 v[52:53], v4 offset:0
  ds_read_b64_tr_b16 v[54:55], v4 offset:2560
  ds_read_b64_tr_b16 v[56:57], v5 offset:0
  ds_read_b64_tr_b16 v[58:59], v5 offset:2560
  s_add_u32 s72, s72, 1
  s_cmp_lt_u32 s72, 6
  v_mfma_f32_16x16x32_bf16 v[140:143], v[60:63], v[96:99], v[140:143]
  v_mfma_f32_16x16x32_bf16 v[144:147], v[60:63], v[100:103], v[144:147]
  v_mfma_f32_16x16x32_bf16 v[148:151], v[60:63], v[104:107], v[148:151]
  v_mfma_f32_16x16x32_bf16 v[152:155], v[60:63], v[108:111], v[152:155]
  v_mfma_f32_16x16x32_bf16 v[168:171], v[64:67], v[108:111], v[168:171]
  v_mfma_f32_16x16x32_bf16 v[164:167], v[64:67], v[104:107], v[164:167]
  v_mfma_f32_16x16x32_bf16 v[160:163], v[64:67], v[100:103], v[160:163]
  v_mfma_f32_16x16x32_bf16 v[156:159], v[64:67], v[96:99], v[156:159]
  v_mfma_f32_16x16x32_bf16 v[172:175], v[68:71], v[96:99], v[172:175]
  v_mfma_f32_16x16x32_bf16 v[176:179], v[68:71], v[100:103], v[176:179]
  v_mfma_f32_16x16x32_bf16 v[180:183], v[68:71], v[104:107], v[180:183]
  v_mfma_f32_16x16x32_bf16 v[184:187], v[68:71], v[108:111], v[184:187]
  v_mfma_f32_16x16x32_bf16 v[200:203], v[72:75], v[108:111], v[200:203]
  v_mfma_f32_16x16x32_bf16 v[196:199], v[72:75], v[104:107], v[196:199]
  v_mfma_f32_16x16x32_bf16 v[192:195], v[72:75], v[100:103], v[192:195]
  v_mfma_f32_16x16x32_bf16 v[188:191], v[72:75], v[96:99], v[188:191]
  v_mfma_f32_16x16x32_bf16 v[204:207], v[76:79], v[96:99], v[204:207]
  v_mfma_f32_16x16x32_bf16 v[208:211], v[76:79], v[100:103], v[208:211]
  v_mfma_f32_16x16x32_bf16 v[212:215], v[76:79], v[104:107], v[212:215]
  s_waitcnt vmcnt(4) lgkmcnt(0)
  v_mfma_f32_16x16x32_bf16 v[216:219], v[76:79], v[108:111], v[216:219]
  s_cbranch_scc1 L_dnn_loop1
  s_barrier
  ds_read_b128 v[96:99], v12 offset:0
  s_add_u32 m0, s75, 126976
  s_nop 0
  buffer_load_dwordx4 v32, s[44:47], s74 offen offset:0 lds
  ds_read_b128 v[100:103], v12 offset:2048
  ds_read_b128 v[104:107], v12 offset:4096
  ds_read_b128 v[108:111], v12 offset:6144
  ds_read_b64_tr_b16 v[60:61], v1 offset:20480
  ds_read_b64_tr_b16 v[62:63], v1 offset:23040
  ds_read_b64_tr_b16 v[64:65], v2 offset:20480
  ds_read_b64_tr_b16 v[66:67], v2 offset:23040
  buffer_load_dwordx4 v33, s[44:47], s74 offen offset:1024 lds
  s_add_u32 s74, s74, 106496
  ds_read_b64_tr_b16 v[68:69], v3 offset:20480
  ds_read_b64_tr_b16 v[70:71], v3 offset:23040
  ds_read_b64_tr_b16 v[72:73], v4 offset:20480
  ds_read_b64_tr_b16 v[74:75], v4 offset:23040
  ds_read_b64_tr_b16 v[76:77], v5 offset:20480
  ds_read_b64_tr_b16 v[78:79], v5 offset:23040
  s_mov_b32 m0, 148096
  s_mov_b32 exec_hi, 0xff
  buffer_load_dwordx4 v37, s[52:55], s77 offen lds
  s_mov_b64 exec, -1
  v_mfma_f32_16x16x32_bf16 v[140:143], v[40:43], v[80:83], v[140:143]
  v_mfma_f32_16x16x32_bf16 v[144:147], v[40:43], v[84:87], v[144:147]
  v_mfma_f32_16x16x32_bf16 v[148:151], v[40:43], v[88:91], v[148:151]
  v_mfma_f32_16x16x32_bf16 v[152:155], v[40:43], v[92:95], v[152:155]
  v_mfma_f32_16x16x32_bf16 v[168:171], v[44:47], v[92:95], v[168:171]
  v_mfma_f32_16x16x32_bf16 v[164:167], v[44:47], v[88:91], v[164:167]
  v_mfma_f32_16x16x32_bf16 v[160:163], v[44:47], v[84:87], v[160:163]
  v_mfma_f32_16x16x32_bf16 v[156:159], v[44:47], v[80:83], v[156:159]
  v_mfma_f32_16x16x32_bf16 v[172:175], v[48:51], v[80:83], v[172:175]
  v_mfma_f32_16x16x32_bf16 v[176:179], v[48:51], v[84:87], v[176:179]
  v_mfma_f32_16x16x32_bf16 v[180:183], v[48:51], v[88:91], v[180:183]
  v_mfma_f32_16x16x32_bf16 v[184:187], v[48:51], v[92:95], v[184:187]
  v_mfma_f32_16x16x32_bf16 v[200:203], v[52:55], v[92:95], v[200:203]
  v_mfma_f32_16x16x32_bf16 v[196:199], v[52:55], v[88:91], v[196:199]
  v_mfma_f32_16x16x32_bf16 v[192:195], v[52:55], v[84:87], v[192:195]
  v_mfma_f32_16x16x32_bf16 v[188:191], v[52:55], v[80:83], v[188:191]
  v_mfma_f32_16x16x32_bf16 v[204:207], v[56:59], v[80:83], v[204:207]
  v_mfma_f32_16x16x32_bf16 v[208:211], v[56:59], v[84:87], v[208:211]
  v_mfma_f32_16x16x32_bf16 v[212:215], v[56:59], v[88:91], v[212:215]
  s_waitcnt vmcnt(4) lgkmcnt(0)
  v_mfma_f32_16x16x32_bf16 v[216:219], v[56:59], v[92:95], v[216:219]
  s_barrier
  ds_read_b128 v[80:83], v11 offset:16384
  ds_read_b128 v[84:87], v11 offset:18432
  ds_read_b128 v[88:91], v11 offset:20480
  ds_read_b128 v[92:95], v11 offset:22528
  ds_read_b64_tr_b16 v[40:41], v6 offset:0
  ds_read_b64_tr_b16 v[42:43], v6 offset:2560
  ds_read_b64_tr_b16 v[44:45], v7 offset:0
  ds_read_b64_tr_b16 v[46:47], v7 offset:2560
  ds_read_b64_tr_b16 v[48:49], v8 offset:0
  ds_read_b64_tr_b16 v[50:51], v8 offset:2560
  ds_read_b64_tr_b16 v[52:53], v9 offset:0
  ds_read_b64_tr_b16 v[54:55], v9 offset:2560
  ds_read_b64_tr_b16 v[56:57], v10 offset:0
  ds_read_b64_tr_b16 v[58:59], v10 offset:2560
  v_mov_b32 v232, 0xc0135761
  v_mov_b32 v233, 0xc0135761
  v_mov_b32 v234, 0xbdd2d3e8
  v_mov_b32 v235, 0xbdd2d3e8
  v_mov_b32 v236, 1.0
  v_mov_b32 v237, 1.0
  v_mfma_f32_16x16x32_bf16 v[140:143], v[60:63], v[96:99], v[140:143]
  v_mfma_f32_16x16x32_bf16 v[144:147], v[60:63], v[100:103], v[144:147]
  v_mfma_f32_16x16x32_bf16 v[148:151], v[60:63], v[104:107], v[148:151]
  v_mfma_f32_16x16x32_bf16 v[152:155], v[60:63], v[108:111], v[152:155]
  v_mfma_f32_16x16x32_bf16 v[168:171], v[64:67], v[108:111], v[168:171]
  v_mfma_f32_16x16x32_bf16 v[164:167], v[64:67], v[104:107], v[164:167]
  v_mfma_f32_16x16x32_bf16 v[160:163], v[64:67], v[100:103], v[160:163]
  v_mfma_f32_16x16x32_bf16 v[156:159], v[64:67], v[96:99], v[156:159]
  v_mfma_f32_16x16x32_bf16 v[172:175], v[68:71], v[96:99], v[172:175]
  v_mfma_f32_16x16x32_bf16 v[176:179], v[68:71], v[100:103], v[176:179]
  v_mfma_f32_16x16x32_bf16 v[180:183], v[68:71], v[104:107], v[180:183]
  v_mfma_f32_16x16x32_bf16 v[184:187], v[68:71], v[108:111], v[184:187]
  v_mfma_f32_16x16x32_bf16 v[200:203], v[72:75], v[108:111], v[200:203]
  v_mfma_f32_16x16x32_bf16 v[196:199], v[72:75], v[104:107], v[196:199]
  v_mfma_f32_16x16x32_bf16 v[192:195], v[72:75], v[100:103], v[192:195]
  v_mfma_f32_16x16x32_bf16 v[188:191], v[72:75], v[96:99], v[188:191]
  v_mfma_f32_16x16x32_bf16 v[204:207], v[76:79], v[96:99], v[204:207]
  v_mfma_f32_16x16x32_bf16 v[208:211], v[76:79], v[100:103], v[208:211]
  v_mfma_f32_16x16x32_bf16 v[212:215], v[76:79], v[104:107], v[212:215]
  s_waitcnt vmcnt(0) lgkmcnt(0)
  v_mfma_f32_16x16x32_bf16 v[216:219], v[76:79], v[108:111], v[216:219]
  s_barrier
  ds_read_b128 v[96:99], v12 offset:16384
  ds_read_b128 v[100:103], v12 offset:18432
  ds_read_b128 v[104:107], v12 offset:20480
  ds_read_b128 v[108:111], v12 offset:22528
  ds_read_b64_tr_b16 v[60:61], v6 offset:20480
  ds_read_b64_tr_b16 v[62:63], v6 offset:23040
  ds_read_b64_tr_b16 v[64:65], v7 offset:20480
  ds_read_b64_tr_b16 v[66:67], v7 offset:23040
  ds_read_b64_tr_b16 v[68:69], v8 offset:20480
  ds_read_b64_tr_b16 v[70:71], v8 offset:23040
  ds_read_b64_tr_b16 v[72:73], v9 offset:20480
  ds_read_b64_tr_b16 v[74:75], v9 offset:23040
  ds_read_b64_tr_b16 v[76:77], v10 offset:20480
  ds_read_b64_tr_b16 v[78:79], v10 offset:23040
  ds_read_b64 v[220:221], v35 offset:640
  ds_read_b64 v[222:223], v35 offset:672
  ds_read_b64 v[224:225], v35 offset:704
  ds_read_b64 v[226:227], v35 offset:736
  ds_read_b64 v[228:229], v35 offset:768
  v_mfma_f32_16x16x32_bf16 v[140:143], v[40:43], v[80:83], v[140:143]
  v_mfma_f32_16x16x32_bf16 v[144:147], v[40:43], v[84:87], v[144:147]
  v_mfma_f32_16x16x32_bf16 v[148:151], v[40:43], v[88:91], v[148:151]
  v_mfma_f32_16x16x32_bf16 v[152:155], v[40:43], v[92:95], v[152:155]
  v_mfma_f32_16x16x32_bf16 v[168:171], v[44:47], v[92:95], v[168:171]
  v_mfma_f32_16x16x32_bf16 v[164:167], v[44:47], v[88:91], v[164:167]
  v_mfma_f32_16x16x32_bf16 v[160:163], v[44:47], v[84:87], v[160:163]
  v_mfma_f32_16x16x32_bf16 v[156:159], v[44:47], v[80:83], v[156:159]
  v_mfma_f32_16x16x32_bf16 v[172:175], v[48:51], v[80:83], v[172:175]
  v_mfma_f32_16x16x32_bf16 v[176:179], v[48:51], v[84:87], v[176:179]
  v_mfma_f32_16x16x32_bf16 v[180:183], v[48:51], v[88:91], v[180:183]
  v_mfma_f32_16x16x32_bf16 v[184:187], v[48:51], v[92:95], v[184:187]
  v_mfma_f32_16x16x32_bf16 v[200:203], v[52:55], v[92:95], v[200:203]
  v_mfma_f32_16x16x32_bf16 v[196:199], v[52:55], v[88:91], v[196:199]
  v_mfma_f32_16x16x32_bf16 v[192:195], v[52:55], v[84:87], v[192:195]
  v_mfma_f32_16x16x32_bf16 v[188:191], v[52:55], v[80:83], v[188:191]
  v_mfma_f32_16x16x32_bf16 v[204:207], v[56:59], v[80:83], v[204:207]
  v_mfma_f32_16x16x32_bf16 v[208:211], v[56:59], v[84:87], v[208:211]
  v_mfma_f32_16x16x32_bf16 v[212:215], v[56:59], v[88:91], v[212:215]
  s_waitcnt lgkmcnt(0)
  v_mfma_f32_16x16x32_bf16 v[216:219], v[56:59], v[92:95], v[216:219]
  s_setprio 3
  v_lshlrev_b32 v112, 16, v220
  v_and_b32 v113, 0xffff0000, v220
  v_lshlrev_b32 v114, 16, v221
  v_and_b32 v115, 0xffff0000, v221
  v_lshlrev_b32 v116, 16, v222
  v_and_b32 v117, 0xffff0000, v222
  v_lshlrev_b32 v118, 16, v223
  v_and_b32 v119, 0xffff0000, v223
  v_lshlrev_b32 v120, 16, v224
  v_and_b32 v121, 0xffff0000, v224
  v_lshlrev_b32 v122, 16, v225
  v_and_b32 v123, 0xffff0000, v225
  v_lshlrev_b32 v124, 16, v226
  v_and_b32 v125, 0xffff0000, v226
  v_lshlrev_b32 v126, 16, v227
  v_and_b32 v127, 0xffff0000, v227
  v_lshlrev_b32 v128, 16, v228
  v_and_b32 v129, 0xffff0000, v228
  v_lshlrev_b32 v130, 16, v229
  v_and_b32 v131, 0xffff0000, v229
  v_mfma_f32_16x16x32_bf16 v[140:143], v[60:63], v[96:99], v[140:143]
  v_mfma_f32_16x16x32_bf16 v[144:147], v[60:63], v[100:103], v[144:147]
  v_mfma_f32_16x16x32_bf16 v[148:151], v[60:63], v[104:107], v[148:151]
  v_mfma_f32_16x16x32_bf16 v[152:155], v[60:63], v[108:111], v[152:155]
  v_mfma_f32_16x16x32_bf16 v[168:171], v[64:67], v[108:111], v[168:171]
  v_mfma_f32_16x16x32_bf16 v[164:167], v[64:67], v[104:107], v[164:167]
  v_mfma_f32_16x16x32_bf16 v[160:163], v[64:67], v[100:103], v[160:163]
  v_mfma_f32_16x16x32_bf16 v[156:159], v[64:67], v[96:99], v[156:159]
  v_mfma_f32_16x16x32_bf16 v[172:175], v[68:71], v[96:99], v[172:175]
  v_mfma_f32_16x16x32_bf16 v[176:179], v[68:71], v[100:103], v[176:179]
  v_mfma_f32_16x16x32_bf16 v[180:183], v[68:71], v[104:107], v[180:183]
  v_mfma_f32_16x16x32_bf16 v[184:187], v[68:71], v[108:111], v[184:187]
  v_mfma_f32_16x16x32_bf16 v[200:203], v[72:75], v[108:111], v[200:203]
  v_mfma_f32_16x16x32_bf16 v[196:199], v[72:75], v[104:107], v[196:199]
  v_mfma_f32_16x16x32_bf16 v[192:195], v[72:75], v[100:103], v[192:195]
  v_mfma_f32_16x16x32_bf16 v[188:191], v[72:75], v[96:99], v[188:191]
  v_mfma_f32_16x16x32_bf16 v[204:207], v[76:79], v[96:99], v[204:207]
  v_mfma_f32_16x16x32_bf16 v[208:211], v[76:79], v[100:103], v[208:211]
  v_mfma_f32_16x16x32_bf16 v[212:215], v[76:79], v[104:107], v[212:215]
  v_mfma_f32_16x16x32_bf16 v[216:219], v[76:79], v[108:111], v[216:219]
  s_setprio 0
L_epi:
  s_mov_b32 s60, s24
  s_and_b32 s61, s25, 0xffff
  s_mov_b32 s62, 268435456
  s_mov_b32 s63, 0x20000
  s_mov_b32 s56, s20
  s_and_b32 s57, s21, 0xffff
  s_mov_b32 s58, 8192
  s_mov_b32 s59, 0x20000
  s_mov_b32 s64, s22
  s_and_b32 s65, s23, 0xffff
  s_mov_b32 s66, 256
  s_mov_b32 s67, 0x20000
  s_and_b32 s70, s2, 7
  s_lshl_b32 s68, s70, 14
  s_lshl_b32 s70, s70, 5
  s_lshl_b32 s69, s27, 11
  s_and_b32 s71, s26, 3
  s_lshl_b32 s71, s71, 9
  s_add_u32 s69, s69, s71
  s_add_u32 s69, s69, s68
  v_lshlrev_b32 v3, 3, v0
  v_add_u32 v2, 32768, v3
  v_lshlrev_b32 v4, 5, v0
  v_mov_b32 v5, 1
  v_mov_b32 v6, s70
  v_pk_mul_f32 v[40:41], v[140:141], v[140:141]
  v_pk_mul_f32 v[44:45], v[144:145], v[144:145]
  v_pk_mul_f32 v[48:49], v[148:149], v[148:149]
  v_pk_mul_f32 v[52:53], v[152:153], v[152:153]
  v_pk_fma_f32 v[40:41], v[40:41], v[234:235], v[232:233]
  v_pk_fma_f32 v[44:45], v[44:45], v[234:235], v[232:233]
  v_pk_fma_f32 v[48:49], v[48:49], v[234:235], v[232:233]
  v_pk_fma_f32 v[52:53], v[52:53], v[234:235], v[232:233]
  v_pk_mul_f32 v[40:41], v[40:41], v[140:141]
  v_pk_mul_f32 v[44:45], v[44:45], v[144:145]
  v_pk_mul_f32 v[48:49], v[48:49], v[148:149]
  v_pk_mul_f32 v[52:53], v[52:53], v[152:153]
  v_exp_f32 v40, v40
  v_exp_f32 v41, v41
  v_exp_f32 v44, v44
  v_exp_f32 v45, v45
  v_exp_f32 v48, v48
  v_exp_f32 v49, v49
  v_exp_f32 v52, v52
  v_exp_f32 v53, v53
  v_pk_mul_f32 v[42:43], v[140:141], v[112:113]
  v_pk_mul_f32 v[46:47], v[144:145], v[112:113]
  v_pk_mul_f32 v[50:51], v[148:149], v[112:113]
  v_pk_mul_f32 v[54:55], v[152:153], v[112:113]
  v_pk_add_f32 v[40:41], v[40:41], v[236:237]
  v_pk_add_f32 v[44:45], v[44:45], v[236:237]
  v_pk_add_f32 v[48:49], v[48:49], v[236:237]
  v_pk_add_f32 v[52:53], v[52:53], v[236:237]
  v_rcp_f32 v40, v40
  v_rcp_f32 v41, v41
  v_rcp_f32 v44, v44
  v_rcp_f32 v45, v45
  v_rcp_f32 v48, v48
  v_rcp_f32 v49, v49
  v_rcp_f32 v52, v52
  v_rcp_f32 v53, v53
  v_pk_mul_f32 v[16:17], v[40:41], v[42:43]
  v_pk_mul_f32 v[18:19], v[44:45], v[46:47]
  v_pk_mul_f32 v[20:21], v[48:49], v[50:51]
  v_pk_mul_f32 v[22:23], v[52:53], v[54:55]
  v_pk_mul_f32 v[56:57], v[142:143], v[142:143]
  v_pk_mul_f32 v[60:61], v[146:147], v[146:147]
  v_pk_mul_f32 v[64:65], v[150:151], v[150:151]
  v_pk_mul_f32 v[68:69], v[154:155], v[154:155]
  v_pk_fma_f32 v[56:57], v[56:57], v[234:235], v[232:233]
  v_pk_fma_f32 v[60:61], v[60:61], v[234:235], v[232:233]
  v_pk_fma_f32 v[64:65], v[64:65], v[234:235], v[232:233]
  v_pk_fma_f32 v[68:69], v[68:69], v[234:235], v[232:233]
  v_pk_mul_f32 v[56:57], v[56:57], v[142:143]
  v_pk_mul_f32 v[60:61], v[60:61], v[146:147]
  v_pk_mul_f32 v[64:65], v[64:65], v[150:151]
  v_pk_mul_f32 v[68:69], v[68:69], v[154:155]
  v_exp_f32 v56, v56
  v_exp_f32 v57, v57
  v_exp_f32 v60, v60
  v_exp_f32 v61, v61
  v_exp_f32 v64, v64
  v_exp_f32 v65, v65
  v_exp_f32 v68, v68
  v_exp_f32 v69, v69
  v_pk_mul_f32 v[58:59], v[142:143], v[114:115]
  v_pk_mul_f32 v[62:63], v[146:147], v[114:115]
  v_pk_mul_f32 v[66:67], v[150:151], v[114:115]
  v_pk_mul_f32 v[70:71], v[154:155], v[114:115]
  v_pk_add_f32 v[56:57], v[56:57], v[236:237]
  v_pk_add_f32 v[60:61], v[60:61], v[236:237]
  v_pk_add_f32 v[64:65], v[64:65], v[236:237]
  v_pk_add_f32 v[68:69], v[68:69], v[236:237]
  v_rcp_f32 v56, v56
  v_rcp_f32 v57, v57
  v_rcp_f32 v60, v60
  v_rcp_f32 v61, v61
  v_rcp_f32 v64, v64
  v_rcp_f32 v65, v65
  v_rcp_f32 v68, v68
  v_rcp_f32 v69, v69
  v_pk_fma_f32 v[16:17], v[56:57], v[58:59], v[16:17]
  v_pk_fma_f32 v[18:19], v[60:61], v[62:63], v[18:19]
  v_pk_fma_f32 v[20:21], v[64:65], v[66:67], v[20:21]
  v_pk_fma_f32 v[22:23], v[68:69], v[70:71], v[22:23]
  v_pk_mul_f32 v[40:41], v[156:157], v[156:157]
  v_pk_mul_f32 v[44:45], v[160:161], v[160:161]
  v_pk_mul_f32 v[48:49], v[164:165], v[164:165]
  v_pk_mul_f32 v[52:53], v[168:169], v[168:169]
  v_pk_fma_f32 v[40:41], v[40:41], v[234:235], v[232:233]
  v_pk_fma_f32 v[44:45], v[44:45], v[234:235], v[232:233]
  v_pk_fma_f32 v[48:49], v[48:49], v[234:235], v[232:233]
  v_pk_fma_f32 v[52:53], v[52:53], v[234:235], v[232:233]
  v_pk_mul_f32 v[40:41], v[40:41], v[156:157]
  v_pk_mul_f32 v[44:45], v[44:45], v[160:161]
  v_pk_mul_f32 v[48:49], v[48:49], v[164:165]
  v_pk_mul_f32 v[52:53], v[52:53], v[168:169]
  v_exp_f32 v40, v40
  v_exp_f32 v41, v41
  v_exp_f32 v44, v44
  v_exp_f32 v45, v45
  v_exp_f32 v48, v48
  v_exp_f32 v49, v49
  v_exp_f32 v52, v52
  v_exp_f32 v53, v53
  v_pk_mul_f32 v[42:43], v[156:157], v[116:117]
  v_pk_mul_f32 v[46:47], v[160:161], v[116:117]
  v_pk_mul_f32 v[50:51], v[164:165], v[116:117]
  v_pk_mul_f32 v[54:55], v[168:169], v[116:117]
  v_pk_add_f32 v[40:41], v[40:41], v[236:237]
  v_pk_add_f32 v[44:45], v[44:45], v[236:237]
  v_pk_add_f32 v[48:49], v[48:49], v[236:237]
  v_pk_add_f32 v[52:53], v[52:53], v[236:237]
  v_rcp_f32 v40, v40
  v_rcp_f32 v41, v41
  v_rcp_f32 v44, v44
  v_rcp_f32 v45, v45
  v_rcp_f32 v48, v48
  v_rcp_f32 v49, v49
  v_rcp_f32 v52, v52
  v_rcp_f32 v53, v53
  v_pk_fma_f32 v[16:17], v[40:41], v[42:43], v[16:17]
  v_pk_fma_f32 v[18:19], v[44:45], v[46:47], v[18:19]
  v_pk_fma_f32 v[20:21], v[48:49], v[50:51], v[20:21]
  v_pk_fma_f32 v[22:23], v[52:53], v[54:55], v[22:23]
  v_pk_mul_f32 v[56:57], v[158:159], v[158:159]
  v_pk_mul_f32 v[60:61], v[162:163], v[162:163]
  v_pk_mul_f32 v[64:65], v[166:167], v[166:167]
  v_pk_mul_f32 v[68:69], v[170:171], v[170:171]
  v_pk_fma_f32 v[56:57], v[56:57], v[234:235], v[232:233]
  v_pk_fma_f32 v[60:61], v[60:61], v[234:235], v[232:233]
  v_pk_fma_f32 v[64:65], v[64:65], v[234:235], v[232:233]
  v_pk_fma_f32 v[68:69], v[68:69], v[234:235], v[232:233]
  v_pk_mul_f32 v[56:57], v[56:57], v[158:159]
  v_pk_mul_f32 v[60:61], v[60:61], v[162:163]
  v_pk_mul_f32 v[64:65], v[64:65], v[166:167]
  v_pk_mul_f32 v[68:69], v[68:69], v[170:171]
  v_exp_f32 v56, v56
  v_exp_f32 v57, v57
  v_exp_f32 v60, v60
  v_exp_f32 v61, v61
  v_exp_f32 v64, v64
  v_exp_f32 v65, v65
  v_exp_f32 v68, v68
  v_exp_f32 v69, v69
  v_pk_mul_f32 v[58:59], v[158:159], v[118:119]
  v_pk_mul_f32 v[62:63], v[162:163], v[118:119]
  v_pk_mul_f32 v[66:67], v[166:167], v[118:119]
  v_pk_mul_f32 v[70:71], v[170:171], v[118:119]
  v_pk_add_f32 v[56:57], v[56:57], v[236:237]
  v_pk_add_f32 v[60:61], v[60:61], v[236:237]
  v_pk_add_f32 v[64:65], v[64:65], v[236:237]
  v_pk_add_f32 v[68:69], v[68:69], v[236:237]
  v_rcp_f32 v56, v56
  v_rcp_f32 v57, v57
  v_rcp_f32 v60, v60
  v_rcp_f32 v61, v61
  v_rcp_f32 v64, v64
  v_rcp_f32 v65, v65
  v_rcp_f32 v68, v68
  v_rcp_f32 v69, v69
  v_pk_fma_f32 v[16:17], v[56:57], v[58:59], v[16:17]
  v_pk_fma_f32 v[18:19], v[60:61], v[62:63], v[18:19]
  v_pk_fma_f32 v[20:21], v[64:65], v[66:67], v[20:21]
  v_pk_fma_f32 v[22:23], v[68:69], v[70:71], v[22:23]
  v_pk_mul_f32 v[40:41], v[172:173], v[172:173]
  v_pk_mul_f32 v[44:45], v[176:177], v[176:177]
  v_pk_mul_f32 v[48:49], v[180:181], v[180:181]
  v_pk_mul_f32 v[52:53], v[184:185], v[184:185]
  v_pk_fma_f32 v[40:41], v[40:41], v[234:235], v[232:233]
  v_pk_fma_f32 v[44:45], v[44:45], v[234:235], v[232:233]
  v_pk_fma_f32 v[48:49], v[48:49], v[234:235], v[232:233]
  v_pk_fma_f32 v[52:53], v[52:53], v[234:235], v[232:233]
  v_pk_mul_f32 v[40:41], v[40:41], v[172:173]
  v_pk_mul_f32 v[44:45], v[44:45], v[176:177]
  v_pk_mul_f32 v[48:49], v[48:49], v[180:181]
  v_pk_mul_f32 v[52:53], v[52:53], v[184:185]
  v_exp_f32 v40, v40
  v_exp_f32 v41, v41
  v_exp_f32 v44, v44
  v_exp_f32 v45, v45
  v_exp_f32 v48, v48
  v_exp_f32 v49, v49
  v_exp_f32 v52, v52
  v_exp_f32 v53, v53
  v_pk_mul_f32 v[42:43], v[172:173], v[120:121]
  v_pk_mul_f32 v[46:47], v[176:177], v[120:121]
  v_pk_mul_f32 v[50:51], v[180:181], v[120:121]
  v_pk_mul_f32 v[54:55], v[184:185], v[120:121]
  v_pk_add_f32 v[40:41], v[40:41], v[236:237]
  v_pk_add_f32 v[44:45], v[44:45], v[236:237]
  v_pk_add_f32 v[48:49], v[48:49], v[236:237]
  v_pk_add_f32 v[52:53], v[52:53], v[236:237]
  v_rcp_f32 v40, v40
  v_rcp_f32 v41, v41
  v_rcp_f32 v44, v44
  v_rcp_f32 v45, v45
  v_rcp_f32 v48, v48
  v_rcp_f32 v49, v49
  v_rcp_f32 v52, v52
  v_rcp_f32 v53, v53
  v_pk_fma_f32 v[16:17], v[40:41], v[42:43], v[16:17]
  v_pk_fma_f32 v[18:19], v[44:45], v[46:47], v[18:19]
  v_pk_fma_f32 v[20:21], v[48:49], v[50:51], v[20:21]
  v_pk_fma_f32 v[22:23], v[52:53], v[54:55], v[22:23]
  v_pk_mul_f32 v[56:57], v[174:175], v[174:175]
  v_pk_mul_f32 v[60:61], v[178:179], v[178:179]
  v_pk_mul_f32 v[64:65], v[182:183], v[182:183]
  v_pk_mul_f32 v[68:69], v[186:187], v[186:187]
  v_pk_fma_f32 v[56:57], v[56:57], v[234:235], v[232:233]
  v_pk_fma_f32 v[60:61], v[60:61], v[234:235], v[232:233]
  v_pk_fma_f32 v[64:65], v[64:65], v[234:235], v[232:233]
  v_pk_fma_f32 v[68:69], v[68:69], v[234:235], v[232:233]
  v_pk_mul_f32 v[56:57], v[56:57], v[174:175]
  v_pk_mul_f32 v[60:61], v[60:61], v[178:179]
  v_pk_mul_f32 v[64:65], v[64:65], v[182:183]
  v_pk_mul_f32 v[68:69], v[68:69], v[186:187]
  v_exp_f32 v56, v56
  v_exp_f32 v57, v57
  v_exp_f32 v60, v60
  v_exp_f32 v61, v61
  v_exp_f32 v64, v64
  v_exp_f32 v65, v65
  v_exp_f32 v68, v68
  v_exp_f32 v69, v69
  v_pk_mul_f32 v[58:59], v[174:175], v[122:123]
  v_pk_mul_f32 v[62:63], v[178:179], v[122:123]
  v_pk_mul_f32 v[66:67], v[182:183], v[122:123]
  v_pk_mul_f32 v[70:71], v[186:187], v[122:123]
  v_pk_add_f32 v[56:57], v[56:57], v[236:237]
  v_pk_add_f32 v[60:61], v[60:61], v[236:237]
  v_pk_add_f32 v[64:65], v[64:65], v[236:237]
  v_pk_add_f32 v[68:69], v[68:69], v[236:237]
  v_rcp_f32 v56, v56
  v_rcp_f32 v57, v57
  v_rcp_f32 v60, v60
  v_rcp_f32 v61, v61
  v_rcp_f32 v64, v64
  v_rcp_f32 v65, v65
  v_rcp_f32 v68, v68
  v_rcp_f32 v69, v69
  v_pk_fma_f32 v[16:17], v[56:57], v[58:59], v[16:17]
  v_pk_fma_f32 v[18:19], v[60:61], v[62:63], v[18:19]
  v_pk_fma_f32 v[20:21], v[64:65], v[66:67], v[20:21]
  v_pk_fma_f32 v[22:23], v[68:69], v[70:71], v[22:23]
  v_pk_mul_f32 v[40:41], v[188:189], v[188:189]
  v_pk_mul_f32 v[44:45], v[192:193], v[192:193]
  v_pk_mul_f32 v[48:49], v[196:197], v[196:197]
  v_pk_mul_f32 v[52:53], v[200:201], v[200:201]
  v_pk_fma_f32 v[40:41], v[40:41], v[234:235], v[232:233]
  v_pk_fma_f32 v[44:45], v[44:45], v[234:235], v[232:233]
  v_pk_fma_f32 v[48:49], v[48:49], v[234:235], v[232:233]
  v_pk_fma_f32 v[52:53], v[52:53], v[234:235], v[232:233]
  v_pk_mul_f32 v[40:41], v[40:41], v[188:189]
  v_pk_mul_f32 v[44:45], v[44:45], v[192:193]
  v_pk_mul_f32 v[48:49], v[48:49], v[196:197]
  v_pk_mul_f32 v[52:53], v[52:53], v[200:201]
  v_exp_f32 v40, v40
  v_exp_f32 v41, v41
  v_exp_f32 v44, v44
  v_exp_f32 v45, v45
  v_exp_f32 v48, v48
  v_exp_f32 v49, v49
  v_exp_f32 v52, v52
  v_exp_f32 v53, v53
  v_pk_mul_f32 v[42:43], v[188:189], v[124:125]
  v_pk_mul_f32 v[46:47], v[192:193], v[124:125]
  v_pk_mul_f32 v[50:51], v[196:197], v[124:125]
  v_pk_mul_f32 v[54:55], v[200:201], v[124:125]
  v_pk_add_f32 v[40:41], v[40:41], v[236:237]
  v_pk_add_f32 v[44:45], v[44:45], v[236:237]
  v_pk_add_f32 v[48:49], v[48:49], v[236:237]
  v_pk_add_f32 v[52:53], v[52:53], v[236:237]
  v_rcp_f32 v40, v40
  v_rcp_f32 v41, v41
  v_rcp_f32 v44, v44
  v_rcp_f32 v45, v45
  v_rcp_f32 v48, v48
  v_rcp_f32 v49, v49
  v_rcp_f32 v52, v52
  v_rcp_f32 v53, v53
  v_pk_fma_f32 v[16:17], v[40:41], v[42:43], v[16:17]
  v_pk_fma_f32 v[18:19], v[44:45], v[46:47], v[18:19]
  v_pk_fma_f32 v[20:21], v[48:49], v[50:51], v[20:21]
  v_pk_fma_f32 v[22:23], v[52:53], v[54:55], v[22:23]
  v_pk_mul_f32 v[56:57], v[190:191], v[190:191]
  v_pk_mul_f32 v[60:61], v[194:195], v[194:195]
  v_pk_mul_f32 v[64:65], v[198:199], v[198:199]
  v_pk_mul_f32 v[68:69], v[202:203], v[202:203]
  v_pk_fma_f32 v[56:57], v[56:57], v[234:235], v[232:233]
  v_pk_fma_f32 v[60:61], v[60:61], v[234:235], v[232:233]
  v_pk_fma_f32 v[64:65], v[64:65], v[234:235], v[232:233]
  v_pk_fma_f32 v[68:69], v[68:69], v[234:235], v[232:233]
  v_pk_mul_f32 v[56:57], v[56:57], v[190:191]
  v_pk_mul_f32 v[60:61], v[60:61], v[194:195]
  v_pk_mul_f32 v[64:65], v[64:65], v[198:199]
  v_pk_mul_f32 v[68:69], v[68:69], v[202:203]
  v_exp_f32 v56, v56
  v_exp_f32 v57, v57
  v_exp_f32 v60, v60
  v_exp_f32 v61, v61
  v_exp_f32 v64, v64
  v_exp_f32 v65, v65
  v_exp_f32 v68, v68
  v_exp_f32 v69, v69
  v_pk_mul_f32 v[58:59], v[190:191], v[126:127]
  v_pk_mul_f32 v[62:63], v[194:195], v[126:127]
  v_pk_mul_f32 v[66:67], v[198:199], v[126:127]
  v_pk_mul_f32 v[70:71], v[202:203], v[126:127]
  v_pk_add_f32 v[56:57], v[56:57], v[236:237]
  v_pk_add_f32 v[60:61], v[60:61], v[236:237]
  v_pk_add_f32 v[64:65], v[64:65], v[236:237]
  v_pk_add_f32 v[68:69], v[68:69], v[236:237]
  v_rcp_f32 v56, v56
  v_rcp_f32 v57, v57
  v_rcp_f32 v60, v60
  v_rcp_f32 v61, v61
  v_rcp_f32 v64, v64
  v_rcp_f32 v65, v65
  v_rcp_f32 v68, v68
  v_rcp_f32 v69, v69
  v_pk_fma_f32 v[16:17], v[56:57], v[58:59], v[16:17]
  v_pk_fma_f32 v[18:19], v[60:61], v[62:63], v[18:19]
  v_pk_fma_f32 v[20:21], v[64:65], v[66:67], v[20:21]
  v_pk_fma_f32 v[22:23], v[68:69], v[70:71], v[22:23]
  v_pk_mul_f32 v[40:41], v[204:205], v[204:205]
  v_pk_mul_f32 v[44:45], v[208:209], v[208:209]
  v_pk_mul_f32 v[48:49], v[212:213], v[212:213]
  v_pk_mul_f32 v[52:53], v[216:217], v[216:217]
  v_pk_fma_f32 v[40:41], v[40:41], v[234:235], v[232:233]
  v_pk_fma_f32 v[44:45], v[44:45], v[234:235], v[232:233]
  v_pk_fma_f32 v[48:49], v[48:49], v[234:235], v[232:233]
  v_pk_fma_f32 v[52:53], v[52:53], v[234:235], v[232:233]
  v_pk_mul_f32 v[40:41], v[40:41], v[204:205]
  v_pk_mul_f32 v[44:45], v[44:45], v[208:209]
  v_pk_mul_f32 v[48:49], v[48:49], v[212:213]
  v_pk_mul_f32 v[52:53], v[52:53], v[216:217]
  v_exp_f32 v40, v40
  v_exp_f32 v41, v41
  v_exp_f32 v44, v44
  v_exp_f32 v45, v45
  v_exp_f32 v48, v48
  v_exp_f32 v49, v49
  v_exp_f32 v52, v52
  v_exp_f32 v53, v53
  v_pk_mul_f32 v[42:43], v[204:205], v[128:129]
  v_pk_mul_f32 v[46:47], v[208:209], v[128:129]
  v_pk_mul_f32 v[50:51], v[212:213], v[128:129]
  v_pk_mul_f32 v[54:55], v[216:217], v[128:129]
  v_pk_add_f32 v[40:41], v[40:41], v[236:237]
  v_pk_add_f32 v[44:45], v[44:45], v[236:237]
  v_pk_add_f32 v[48:49], v[48:49], v[236:237]
  v_pk_add_f32 v[52:53], v[52:53], v[236:237]
  v_rcp_f32 v40, v40
  v_rcp_f32 v41, v41
  v_rcp_f32 v44, v44
  v_rcp_f32 v45, v45
  v_rcp_f32 v48, v48
  v_rcp_f32 v49, v49
  v_rcp_f32 v52, v52
  v_rcp_f32 v53, v53
  v_pk_fma_f32 v[16:17], v[40:41], v[42:43], v[16:17]
  v_pk_fma_f32 v[18:19], v[44:45], v[46:47], v[18:19]
  v_pk_fma_f32 v[20:21], v[48:49], v[50:51], v[20:21]
  v_pk_fma_f32 v[22:23], v[52:53], v[54:55], v[22:23]
  v_pk_mul_f32 v[56:57], v[206:207], v[206:207]
  v_pk_mul_f32 v[60:61], v[210:211], v[210:211]
  v_pk_mul_f32 v[64:65], v[214:215], v[214:215]
  v_pk_mul_f32 v[68:69], v[218:219], v[218:219]
  v_pk_fma_f32 v[56:57], v[56:57], v[234:235], v[232:233]
  v_pk_fma_f32 v[60:61], v[60:61], v[234:235], v[232:233]
  v_pk_fma_f32 v[64:65], v[64:65], v[234:235], v[232:233]
  v_pk_fma_f32 v[68:69], v[68:69], v[234:235], v[232:233]
  v_pk_mul_f32 v[56:57], v[56:57], v[206:207]
  v_pk_mul_f32 v[60:61], v[60:61], v[210:211]
  v_pk_mul_f32 v[64:65], v[64:65], v[214:215]
  v_pk_mul_f32 v[68:69], v[68:69], v[218:219]
  v_exp_f32 v56, v56
  v_exp_f32 v57, v57
  v_exp_f32 v60, v60
  v_exp_f32 v61, v61
  v_exp_f32 v64, v64
  v_exp_f32 v65, v65
  v_exp_f32 v68, v68
  v_exp_f32 v69, v69
  v_pk_mul_f32 v[58:59], v[206:207], v[130:131]
  v_pk_mul_f32 v[62:63], v[210:211], v[130:131]
  v_pk_mul_f32 v[66:67], v[214:215], v[130:131]
  v_pk_mul_f32 v[70:71], v[218:219], v[130:131]
  v_pk_add_f32 v[56:57], v[56:57], v[236:237]
  v_pk_add_f32 v[60:61], v[60:61], v[236:237]
  v_pk_add_f32 v[64:65], v[64:65], v[236:237]
  v_pk_add_f32 v[68:69], v[68:69], v[236:237]
  v_rcp_f32 v56, v56
  v_rcp_f32 v57, v57
  v_rcp_f32 v60, v60
  v_rcp_f32 v61, v61
  v_rcp_f32 v64, v64
  v_rcp_f32 v65, v65
  v_rcp_f32 v68, v68
  v_rcp_f32 v69, v69
  v_pk_fma_f32 v[16:17], v[56:57], v[58:59], v[16:17]
  v_pk_fma_f32 v[18:19], v[60:61], v[62:63], v[18:19]
  v_pk_fma_f32 v[20:21], v[64:65], v[66:67], v[20:21]
  v_pk_fma_f32 v[22:23], v[68:69], v[70:71], v[22:23]
  v_add_f32 v16, v16, v17
  v_add_f32 v18, v18, v19
  v_add_f32 v20, v20, v21
  v_add_f32 v22, v22, v23
  s_nop 0
  v_permlane32_swap_b32 v16, v20
  v_permlane32_swap_b32 v18, v22
  v_add_f32 v16, v16, v20
  v_add_f32 v18, v18, v22
  s_nop 1
  v_permlane16_swap_b32 v16, v18
  v_add_f32 v16, v16, v18
  ds_write_b32 v36, v16
  s_waitcnt lgkmcnt(0)
  s_barrier
  s_cmp_lg_u32 s3, 0
  s_cbranch_scc1 L_end
  ds_read_b64 v[64:65], v2 offset:0
  ds_read_b64 v[66:67], v2 offset:512
  ds_read_b64 v[68:69], v2 offset:1024
  ds_read_b64 v[70:71], v2 offset:1536
  s_waitcnt lgkmcnt(2)
  v_pk_add_f32 v[64:65], v[64:65], v[66:67]
  s_waitcnt lgkmcnt(0)
  v_pk_add_f32 v[68:69], v[68:69], v[70:71]
  v_pk_add_f32 v[64:65], v[64:65], v[68:69]
  buffer_store_dwordx2 v[64:65], v3, s[60:63], s69 offen sc1
L_pub:
  s_mov_b64 exec, 1
  s_waitcnt vmcnt(0)
  buffer_atomic_add v5, v6, s[64:67], 0 offen sc0
  s_waitcnt vmcnt(0)
  s_mov_b64 exec, -1
  v_readfirstlane_b32 s71, v5
  s_nop 0
  s_cmp_lg_u32 s71, 31
  s_cbranch_scc1 L_end
  buffer_load_dwordx4 v[64:67], v4, s[60:63], s68 offen offset:0 sc1
  buffer_load_dwordx4 v[68:71], v4, s[60:63], s68 offen offset:16 sc1
  buffer_load_dwordx4 v[72:75], v4, s[60:63], s68 offen offset:2048 sc1
  buffer_load_dwordx4 v[76:79], v4, s[60:63], s68 offen offset:2064 sc1
  s_add_u32 s68, s68, 4096
  buffer_load_dwordx4 v[80:83], v4, s[60:63], s68 offen offset:0 sc1
  buffer_load_dwordx4 v[84:87], v4, s[60:63], s68 offen offset:16 sc1
  buffer_load_dwordx4 v[88:91], v4, s[60:63], s68 offen offset:2048 sc1
  buffer_load_dwordx4 v[92:95], v4, s[60:63], s68 offen offset:2064 sc1
  s_add_u32 s68, s68, 4096
  buffer_load_dwordx4 v[96:99], v4, s[60:63], s68 offen offset:0 sc1
  buffer_load_dwordx4 v[100:103], v4, s[60:63], s68 offen offset:16 sc1
  buffer_load_dwordx4 v[104:107], v4, s[60:63], s68 offen offset:2048 sc1
  buffer_load_dwordx4 v[108:111], v4, s[60:63], s68 offen offset:2064 sc1
  s_add_u32 s68, s68, 4096
  buffer_load_dwordx4 v[112:115], v4, s[60:63], s68 offen offset:0 sc1
  buffer_load_dwordx4 v[116:119], v4, s[60:63], s68 offen offset:16 sc1
  s_lshl_b32 s68, s70, 5
  v_lshlrev_b32 v1, 4, v0
  s_waitcnt lgkmcnt(0)
  s_lshl_b32 s80, s80, 16
  s_waitcnt vmcnt(11)
  v_pk_add_f32 v[64:65], v[64:65], v[72:73]
  v_pk_add_f32 v[66:67], v[66:67], v[74:75]
  s_waitcnt vmcnt(10)
  v_pk_add_f32 v[68:69], v[68:69], v[76:77]
  v_pk_add_f32 v[70:71], v[70:71], v[78:79]
  s_waitcnt vmcnt(9)
  v_pk_add_f32 v[64:65], v[64:65], v[80:81]
  v_pk_add_f32 v[66:67], v[66:67], v[82:83]
  s_waitcnt vmcnt(8)
  v_pk_add_f32 v[68:69], v[68:69], v[84:85]
  v_pk_add_f32 v[70:71], v[70:71], v[86:87]
  s_waitcnt vmcnt(7)
  v_pk_add_f32 v[64:65], v[64:65], v[88:89]
  v_pk_add_f32 v[66:67], v[66:67], v[90:91]
  s_waitcnt vmcnt(6)
  v_pk_add_f32 v[68:69], v[68:69], v[92:93]
  v_pk_add_f32 v[70:71], v[70:71], v[94:95]
  s_waitcnt vmcnt(5)
  v_pk_add_f32 v[64:65], v[64:65], v[96:97]
  v_pk_add_f32 v[66:67], v[66:67], v[98:99]
  s_waitcnt vmcnt(4)
  v_pk_add_f32 v[68:69], v[68:69], v[100:101]
  v_pk_add_f32 v[70:71], v[70:71], v[102:103]
  s_waitcnt vmcnt(3)
  v_pk_add_f32 v[64:65], v[64:65], v[104:105]
  v_pk_add_f32 v[66:67], v[66:67], v[106:107]
  s_waitcnt vmcnt(2)
  v_pk_add_f32 v[68:69], v[68:69], v[108:109]
  v_pk_add_f32 v[70:71], v[70:71], v[110:111]
  s_waitcnt vmcnt(1)
  v_pk_add_f32 v[64:65], v[64:65], v[112:113]
  v_pk_add_f32 v[66:67], v[66:67], v[114:115]
  s_waitcnt vmcnt(0)
  v_pk_add_f32 v[68:69], v[68:69], v[116:117]
  v_pk_add_f32 v[70:71], v[70:71], v[118:119]
  v_add_f32 v64, s80, v64
  v_add_f32 v65, s80, v65
  v_add_f32 v66, s80, v66
  v_add_f32 v67, s80, v67
  v_add_f32 v68, s80, v68
  v_add_f32 v69, s80, v69
  v_add_f32 v70, s80, v70
  v_add_f32 v71, s80, v71
  v_cvt_pk_bf16_f32 v64, v64, v65
  v_cvt_pk_bf16_f32 v65, v66, v67
  v_cvt_pk_bf16_f32 v66, v68, v69
  v_cvt_pk_bf16_f32 v67, v70, v71
  buffer_store_dwordx4 v[64:67], v1, s[56:59], s68 offen
  s_endpgm
L_cin:
  s_and_b32 s68, s26, 3
  s_mul_i32 s68, s68, 3
  s_add_u32 s27, s68, s27
  s_sub_u32 s27, s27, 6
  s_cbranch_scc1 L_rem
  s_and_b32 s79, s3, 3
  s_lshr_b32 s84, s3, 2
  s_lshl_b32 s100, s27, 3
  s_add_u32 s100, s100, s3
  s_mul_i32 s68, s100, 1280
  v_min_u32 v40, 9, v0
  v_lshlrev_b32 v40, 7, v40
  v_lshlrev_b32 v48, 4, v0
  s_lshl_b32 s95, s79, 10
  s_cmp_eq_u32 s79, 2
  s_cselect_b64 s[82:83], 0x1fffff, -1
  s_cmp_eq_u32 s79, 3
  s_cselect_b32 s96, 0, 32768
  s_add_u32 s96, s96, s95
  s_mul_i32 s69, s27, 2979
  s_lshr_b32 s98, s69, 6
  s_add_u32 s69, s69, 2979
  s_lshr_b32 s69, s69, 6
  s_sub_u32 s26, s69, s98
  s_lshl_b32 s85, s3, 2
  s_add_u32 s85, s85, 110528
  s_and_b32 s70, s2, 7
  s_lshl_b32 s77, s70, 9
  s_add_u32 s77, s77, s98
  s_add_u32 s94, s77, s3
  s_mul_i32 s94, s94, 104
  s_sub_u32 s69, s26, 40
  s_cmp_lt_u32 s3, s69
  s_cselect_b32 s72, 6, 5
  v_lshrrev_b32 v43, 3, v0
  v_min_u32 v43, 6, v43
  v_lshlrev_b32 v17, 4, v43
  s_mul_i32 s70, s70, 88
  s_add_u32 s100, s100, s70
  s_add_u32 s101, s100, 1664
  s_lshl_b32 s101, s101, 7
  s_mov_b32 s71, 90112
  v_min_u32 v19, 13, v0
  v_mul_lo_u32 v19, s71, v19
  v_mov_b32 v2, 110464
  v_lshlrev_b32 v1, 20, v0
  v_add_u32 v1, 110464, v1
  v_and_b32 v44, 7, v0
  v_lshlrev_b32 v18, 4, v44
  v_and_b32 v44, 15, v0
  v_lshl_add_u32 v44, v44, 2, v2
  v_mov_b32 v3, 0
  ds_write_b32 v44, v3
  v_lshrrev_b32 v41, 5, v0
  v_and_b32 v42, 31, v0
  s_waitcnt lgkmcnt(0)
  v_mov_b32 v3, 1
  s_mov_b32 s32, s6
  s_and_b32 s33, s7, 0xffff
  s_mov_b32 s34, 12800000
  s_mov_b32 s35, 0x20000
  v_mov_b32 v45, s80
  buffer_load_dword v255, v45, s[32:35], 0 offen
  s_mov_b32 s36, s8
  s_and_b32 s37, s9, 0xffff
  s_mov_b32 s38, 105456
  s_mov_b32 s39, 0x20000
  buffer_load_dword v255, v40, s[36:39], s68 offen
  s_mov_b32 s44, s12
  s_and_b32 s45, s13, 0xffff
  s_mov_b32 s46, 5537792
  s_mov_b32 s47, 0x20000
  s_barrier
  s_mov_b64 exec, 16383
  buffer_load_dword v255, v19, s[44:47], s101 offen
  s_mov_b64 exec, -1
  s_add_u32 s101, s101, 1261568
  s_mov_b32 s28, s4
  s_and_b32 s29, s5, 0xffff
  s_mov_b32 s30, 425984
  s_mov_b32 s31, 0x20000
  s_cmp_lg_u32 s84, 0
  s_cbranch_scc1 L_g1a
  s_mov_b32 s40, s10
  s_and_b32 s41, s11, 0xffff
  s_mov_b32 s42, 156
  s_mov_b32 s43, 0x20000
  s_mov_b32 m0, 110272
  s_mov_b64 exec, 0x7ff
  buffer_load_dwordx4 v48, s[40:43], 0 offen lds
  s_mov_b64 exec, -1
  buffer_load_dwordx4 v[204:207], v17, s[28:31], s94 offen offset:416
  buffer_load_dwordx4 v[24:27], v17, s[28:31], s94 offen offset:0
  s_add_u32 s94, s94, 832
  s_add_u32 m0, s95, 71552
  s_add_u32 s81, s95, 70304
  buffer_load_dwordx4 v48, s[36:39], s81 offen lds
  s_add_u32 m0, s95, 75648
  s_add_u32 s81, s95, 74400
  buffer_load_dwordx4 v48, s[36:39], s81 offen lds
  s_add_u32 m0, s95, 79744
  s_add_u32 s81, s95, 78496
  buffer_load_dwordx4 v48, s[36:39], s81 offen lds
  s_add_u32 m0, s95, 83840
  s_add_u32 s81, s95, 82592
  buffer_load_dwordx4 v48, s[36:39], s81 offen lds
  s_add_u32 m0, s95, 87936
  s_add_u32 s81, s95, 86688
  buffer_load_dwordx4 v48, s[36:39], s81 offen lds
  s_add_u32 m0, s95, 92032
  s_add_u32 s81, s95, 90784
  buffer_load_dwordx4 v48, s[36:39], s81 offen lds
  s_add_u32 m0, s95, 96128
  s_add_u32 s81, s95, 94880
  buffer_load_dwordx4 v48, s[36:39], s81 offen lds
  s_add_u32 m0, s95, 100224
  s_add_u32 s81, s95, 98976
  buffer_load_dwordx4 v48, s[36:39], s81 offen lds
  s_add_u32 m0, s96, 71552
  s_add_u32 s81, s96, 70304
  s_mov_b64 exec, s[82:83]
  buffer_load_dwordx4 v48, s[36:39], s81 offen lds
  s_mov_b64 exec, -1
  s_add_u32 m0, s95, 36288
  s_add_u32 s81, s95, 35152
  buffer_load_dwordx4 v48, s[36:39], s81 offen lds
  s_add_u32 m0, s95, 40384
  s_add_u32 s81, s95, 39248
  buffer_load_dwordx4 v48, s[36:39], s81 offen lds
  s_add_u32 m0, s95, 44480
  s_add_u32 s81, s95, 43344
  buffer_load_dwordx4 v48, s[36:39], s81 offen lds
  s_add_u32 m0, s95, 48576
  s_add_u32 s81, s95, 47440
  buffer_load_dwordx4 v48, s[36:39], s81 offen lds
  s_branch L_addrc
L_g1a:
  s_setprio 1
  v_bfe_u32 v43, v0, 2, 2
  v_lshl_add_u32 v43, v41, 3, v43
  v_bfe_u32 v44, v0, 4, 1
  v_lshlrev_b32 v44, 5, v44
  v_and_b32 v45, 3, v0
  v_lshl_add_u32 v44, v45, 3, v44
  v_lshl_add_u32 v240, v43, 6, v44
  v_add_u32 v240, 106816, v240
  s_lshl_b32 s68, s79, 6
  s_add_u32 s68, s68, 36288
  v_add_u32 v44, s68, v44
  v_mul_u32_u24 v45, 1352, v43
  v_add_u32 v241, v44, v45
  v_add_u32 v45, 16, v43
  v_min_u32 v45, 25, v45
  v_mul_u32_u24 v45, 1352, v45
  v_add_u32 v242, v44, v45
  v_add_u32 v45, 20, v43
  v_min_u32 v45, 25, v45
  v_mul_u32_u24 v45, 1352, v45
  v_add_u32 v243, v44, v45
  s_lshl_b32 s68, s79, 5
  v_add_u32 v246, s68, v42
  v_mul_u32_u24 v43, 52, v246
  v_lshl_add_u32 v43, v41, 3, v43
  v_add_u32 v244, 71552, v43
  v_lshlrev_b32 v43, 1, v246
  v_add_u32 v245, 108864, v43
  v_mov_b32 v216, 0
  v_mov_b32 v217, 0
  v_lshlrev_b32 v43, 3, v0
  v_add_u32 v44, 108480, v43
  s_mov_b32 exec_hi, 0xffff
  ds_write_b64 v44, v[216:217]
  s_mov_b32 exec_hi, -1
  v_lshl_add_u32 v43, v41, 7, v246
  s_mov_b32 s69, 2521
  s_mov_b32 s70, 106816
  v_mul_u32_u24 v44, s69, v43
  v_lshrrev_b32 v44, 16, v44
  v_mad_u32_u24 v44, v44, 12, s70
  v_lshl_add_u32 v68, v43, 1, v44
  v_add_u32 v43, 256, v43
  v_mul_u32_u24 v44, s69, v43
  v_lshrrev_b32 v44, 16, v44
  v_mad_u32_u24 v44, v44, 12, s70
  v_lshl_add_u32 v69, v43, 1, v44
  v_add_u32 v43, 256, v43
  v_mul_u32_u24 v44, s69, v43
  v_lshrrev_b32 v44, 16, v44
  v_mad_u32_u24 v44, v44, 12, s70
  v_lshl_add_u32 v70, v43, 1, v44
  v_mov_b32 v44, 676
  v_cmp_gt_u32 s[92:93], v44, v43
  v_add_u32 v43, 0, v246
  v_mul_u32_u24 v44, s69, v43
  v_lshrrev_b32 v44, 16, v44
  v_lshl_add_u32 v44, v44, 2, v244
  v_add_u32 v72, 0, v44
  v_add_u32 v43, 128, v246
  v_mul_u32_u24 v44, s69, v43
  v_lshrrev_b32 v44, 16, v44
  v_lshl_add_u32 v44, v44, 2, v244
  v_add_u32 v73, 6656, v44
  v_add_u32 v43, 256, v246
  v_mul_u32_u24 v44, s69, v43
  v_lshrrev_b32 v44, 16, v44
  v_lshl_add_u32 v44, v44, 2, v244
  v_add_u32 v74, 13312, v44
  v_add_u32 v43, 384, v246
  v_mul_u32_u24 v44, s69, v43
  v_lshrrev_b32 v44, 16, v44
  v_lshl_add_u32 v44, v44, 2, v244
  v_add_u32 v75, 19968, v44
  v_add_u32 v43, 512, v246
  v_mul_u32_u24 v44, s69, v43
  v_lshrrev_b32 v44, 16, v44
  v_lshl_add_u32 v44, v44, 2, v244
  v_add_u32 v76, 26624, v44
  v_add_u32 v43, 640, v246
  v_mul_u32_u24 v44, s69, v43
  v_lshrrev_b32 v44, 16, v44
  v_lshl_add_u32 v44, v44, 2, v244
  v_add_u32 v77, 33280, v44
  v_lshlrev_b32 v78, 4, v41
  v_add_u32 v78, 110376, v78
  v_lshlrev_b32 v79, 1, v0
  v_add_u32 v79, 110272, v79
  v_lshlrev_b32 v80, 6, v0
  v_add_u32 v80, 106868, v80
L_addrc:
  s_and_b32 s70, s3, 1
  s_lshl_b32 s70, s70, 1
  v_add_u32 v46, s70, v41
  v_min_u32 v43, 25, v42
  s_mul_i32 s68, s84, 4
  s_add_u32 s68, s68, 1352
  s_mul_i32 s69, s84, 70528
  s_add_u32 s69, s69, 1024
  v_mul_u32_u24 v44, s68, v43
  v_add_u32 v44, s69, v44
  v_mul_u32_u24 v65, 52, v43
  v_lshl_add_u32 v65, v46, 1, v65
  v_add_u32 v65, 108864, v65
  v_lshlrev_b32 v67, 1, v43
  v_add_u32 v67, 110272, v67
  v_mad_u32_u24 v60, v46, 52, v44
  v_lshl_add_u32 v61, v46, 1, v44
  v_lshl_add_u32 v49, v46, 1, v60
  v_lshlrev_b32 v43, 3, v46
  s_mov_b32 s68, 0x01000100
  v_bfe_i32 v45, s68, v43, 8
  v_lshl_add_u32 v50, v45, 1, v60
  v_mad_i32_i24 v51, v45, 52, v61
  s_mov_b32 s68, 0xff00ff00
  v_bfe_i32 v45, s68, v43, 8
  v_lshl_add_u32 v52, v45, 1, v60
  v_mad_i32_i24 v53, v45, 52, v61
  s_mov_b32 s68, 0xff020100
  v_bfe_i32 v45, s68, v43, 8
  v_lshl_add_u32 v54, v45, 1, v60
  v_mad_i32_i24 v55, v45, 52, v61
  s_mov_b32 s68, 0x0b0a0100
  v_bfe_i32 v45, s68, v43, 8
  v_lshl_add_u32 v56, v45, 1, v60
  v_mad_i32_i24 v57, v45, 52, v61
  s_mov_b32 s68, 0xf3f20100
  v_bfe_i32 v45, s68, v43, 8
  v_lshl_add_u32 v58, v45, 1, v60
  v_mad_i32_i24 v59, v45, 52, v61
  s_mov_b32 s68, 0x00023600
  v_bfe_u32 v45, s68, v43, 8
  v_add_u32 v60, v45, v44
  v_add_u32 v61, 52, v44
  v_mov_b32 v47, 1048576
  v_cmp_eq_u32 vcc, 3, v46
  s_nop 1
  v_cndmask_b32 v60, v60, v47, vcc
  v_cndmask_b32 v67, v47, v67, vcc
  v_cmp_eq_u32 vcc, 2, v46
  s_nop 1
  v_cndmask_b32 v61, v47, v61, vcc
  v_cmp_gt_u32 vcc, 2, v46
  s_nop 1
  v_cndmask_b32 v64, v47, v65, vcc
  s_lshr_b32 s69, s79, 1
  s_mul_i32 s69, s69, 6144
  s_mul_i32 s68, s84, 35264
  s_add_u32 s68, s68, 1024
  s_lshl_b32 s70, s84, 4
  s_sub_u32 s71, s70, 36304
  v_lshlrev_b32 v45, 8, v46
  v_lshl_add_u32 v43, v42, 4, v45
  v_add_u32 v63, s68, v43
  v_add_u32 v66, 47552, v43
  v_bfe_u32 v43, v0, 2, 2
  v_lshl_add_u32 v45, v43, 4, v45
  v_and_b32 v43, 3, v0
  v_lshl_add_u32 v44, v43, 6, v45
  v_add_u32 v44, 48592, v44
  v_cmp_lt_u32 vcc, 15, v42
  s_nop 1
  v_cndmask_b32 v66, v66, v44, vcc
  v_add_u32 v44, s71, v44
  v_cndmask_b32 v63, v63, v44, vcc
  v_lshl_add_u32 v44, v43, 5, v45
  v_add_u32 v44, 23536, v44
  s_add_u32 s71, s70, 19
  v_cmp_lt_u32 vcc, s71, v42
  s_nop 1
  v_cndmask_b32 v63, v63, v44, vcc
  v_add_u32 v63, s69, v63
  v_cmp_lt_u32 vcc, 25, v42
  s_nop 1
  v_cndmask_b32 v63, v63, v47, vcc
  v_cndmask_b32 v66, v66, v47, vcc
  v_add_u32 v5, s70, v2
  v_add_u32 v6, s70, v1
  v_mov_b32 v62, 0
  s_mul_i32 s74, s3, 4224
  s_add_u32 s74, s74, 111040
  s_mov_b32 s75, -39488
  v_add_u32 v28, 1024, v48
  v_and_b32 v43, 11, v0
  v_cmp_eq_u32 vcc, 11, v43
  s_nop 1
  v_cndmask_b32 v31, v28, v47, vcc
  v_and_b32 v43, 3, v0
  v_cmp_eq_u32 vcc, 0, v43
  s_nop 1
  v_cndmask_b32 v30, v31, v47, vcc
  v_lshrrev_b32 v46, 4, v0
  v_bfe_u32 v43, v0, 1, 3
  v_lshlrev_b32 v45, 4, v43
  v_add_u32 v45, 23552, v45
  v_and_b32 v43, 10, v0
  v_cmp_eq_u32 vcc, 10, v43
  s_nop 1
  v_cndmask_b32 v45, v45, v47, vcc
  v_and_b32 v44, 1, v0
  v_lshl_add_u32 v29, v46, 9, v45
  v_lshl_add_u32 v29, v44, 2, v29
  v_add_u32 v29, 1024, v29
  v_lshl_add_u32 v22, v46, 8, v45
  v_lshl_add_u32 v22, v44, 20, v22
  v_and_b32 v47, 15, v0
  s_mov_b32 s68, 1056
  v_lshlrev_b32 v43, 1, v47
  v_add_u32 v43, s74, v43
  v_mad_u32_u24 v7, v46, s68, v43
  s_lshl_b32 s68, s3, 10
  s_add_u32 s68, s68, 144832
  v_add_u32 v10, s68, v48
  v_add_u32 v43, 256, v48
  v_and_b32 v43, 1023, v43
  v_add_u32 v11, s68, v43
  v_xor_b32 v43, 512, v48
  v_add_u32 v12, s68, v43
  v_lshlrev_b32 v13, 4, v41
  v_mov_b32 v32, 0
  v_mov_b32 v33, 0
  v_mov_b32 v34, 0
  v_mov_b32 v35, 0
  v_mov_b32 v36, 0
  v_mov_b32 v37, 0
  v_mov_b32 v38, 0
  v_mov_b32 v39, 0
  v_mov_b32 v216, 0
  v_mov_b32 v217, 0
  v_mov_b32 v218, 0
  v_mov_b32 v219, 0
  v_mov_b32 v220, 0
  v_mov_b32 v221, 0
  v_mov_b32 v222, 0
  v_mov_b32 v223, 0
  v_mov_b32 v224, 0
  v_mov_b32 v225, 0
  v_mov_b32 v226, 0
  v_mov_b32 v227, 0
  v_mov_b32 v228, 0
  v_mov_b32 v229, 0
  v_mov_b32 v230, 0
  v_mov_b32 v231, 0
  v_mov_b32 v232, 0
  v_mov_b32 v233, 0
  v_mov_b32 v234, 0
  v_mov_b32 v235, 0
  v_mov_b32 v236, 0
  v_mov_b32 v237, 0
  v_mov_b32 v238, 0
  v_mov_b32 v239, 0
  v_mul_u32_u24 v44, 1056, v46
  v_bfe_u32 v45, v0, 2, 2
  v_lshl_add_u32 v44, v45, 7, v44
  v_and_b32 v45, 3, v0
  v_lshl_add_u32 v9, v45, 3, v44
  v_add_u32 v8, s74, v9
  v_and_b32 v45, 1, v0
  s_mov_b32 s68, 0xaaaaaaaa
  v_mul_lo_u32 v16, s68, v45
  v_or_b32 v16, 0x44444444, v16
  v_lshlrev_b32 v15, 1, v0
  v_add_u32 v15, s74, v15
  v_mov_b32 v14, 0x3f80
  ds_write_b16 v15, v14 offset:4064
  v_add_u32 v15, s75, v15
  s_mul_i32 s71, s3, 6
  s_add_u32 s77, s77, s71
  s_mul_i32 s77, s77, 104
  s_add_u32 s73, s77, 80
  s_add_u32 s77, s77, 16
  s_mov_b32 s71, 10923
  v_min_u32 v43, 35, v0
  v_mul_u32_u24 v44, s71, v43
  v_lshrrev_b32 v44, 16, v44
  v_mul_u32_u24 v44, 80, v44
  v_lshl_add_u32 v20, v43, 2, v44
  s_cmp_eq_u32 s84, 0
  s_cbranch_scc1 L_g0pf
  s_add_u32 s94, s94, 832
  s_add_u32 s77, s77, 24
  buffer_load_dwordx4 v[24:27], v17, s[28:31], s94 offen offset:0
  s_add_u32 s94, s94, 832
  buffer_load_dword v21, v20, s[28:31], s77 offen
  s_cmp_eq_u32 s77, s73
  s_cselect_b32 s73, 0x7000000, s73
  s_cselect_b32 s77, 0x7000000, s77
  s_add_u32 s77, s77, 24
  s_min_u32 s77, s77, s73
L_csync1:
  ds_read_b32 v4, v2 offset:0
  s_waitcnt lgkmcnt(0)
  v_cmp_gt_u32 vcc, 4, v4
  s_cbranch_vccnz L_csync1
  ds_read_b64 v[132:133], v78 offset:0
  ds_read_b64 v[134:135], v78 offset:8
  ds_read_b64 v[136:137], v78 offset:32
  ds_read_b64 v[138:139], v78 offset:40
  ds_read_u16 v45, v79 offset:52
  ds_read_b64_tr_b16 v[84:85], v241 offset:35264
  ds_read_b64_tr_b16 v[86:87], v241 offset:40672
  ds_read_b64_tr_b16 v[88:89], v242 offset:35264
  ds_read_b64_tr_b16 v[90:91], v243 offset:35264
  ds_read_b64_tr_b16 v[92:93], v241 offset:35520
  ds_read_b64_tr_b16 v[94:95], v241 offset:40928
  ds_read_b64_tr_b16 v[96:97], v242 offset:35520
  ds_read_b64_tr_b16 v[98:99], v243 offset:35520
  ds_read_b64_tr_b16 v[100:101], v241 offset:35776
  ds_read_b64_tr_b16 v[102:103], v241 offset:41184
  ds_read_b64_tr_b16 v[104:105], v242 offset:35776
  ds_read_b64_tr_b16 v[106:107], v243 offset:35776
  ds_read_b64_tr_b16 v[108:109], v241 offset:36032
  ds_read_b64_tr_b16 v[110:111], v241 offset:41440
  ds_read_b64_tr_b16 v[112:113], v242 offset:36032
  ds_read_b64_tr_b16 v[114:115], v243 offset:36032
  s_waitcnt lgkmcnt(14)
  v_mfma_f32_32x32x16_bf16 v[140:155], v[132:135], v[84:87], 0
  s_waitcnt lgkmcnt(12)
  v_mfma_f32_32x32x16_bf16 v[140:155], v[136:139], v[88:91], v[140:155]
  ds_read_b64_tr_b16 v[116:117], v241 offset:36288
  ds_read_b64_tr_b16 v[118:119], v241 offset:41696
  ds_read_b64_tr_b16 v[120:121], v242 offset:36288
  ds_read_b64_tr_b16 v[122:123], v243 offset:36288
  s_waitcnt lgkmcnt(14)
  v_mfma_f32_32x32x16_bf16 v[156:171], v[132:135], v[92:95], 0
  s_waitcnt lgkmcnt(12)
  v_mfma_f32_32x32x16_bf16 v[156:171], v[136:139], v[96:99], v[156:171]
  ds_read_b64_tr_b16 v[124:125], v241 offset:36544
  ds_read_b64_tr_b16 v[126:127], v241 offset:41952
  ds_read_b64_tr_b16 v[128:129], v242 offset:36544
  ds_read_b64_tr_b16 v[130:131], v243 offset:36544
  s_waitcnt lgkmcnt(14)
  v_mfma_f32_32x32x16_bf16 v[172:187], v[132:135], v[100:103], 0
  s_waitcnt lgkmcnt(12)
  v_mfma_f32_32x32x16_bf16 v[172:187], v[136:139], v[104:107], v[172:187]
  v_cvt_pk_bf16_f32 v81, v140, 0
  s_waitcnt lgkmcnt(10)
  v_mfma_f32_32x32x16_bf16 v[188:203], v[132:135], v[108:111], 0
  s_waitcnt lgkmcnt(8)
  v_mfma_f32_32x32x16_bf16 v[188:203], v[136:139], v[112:115], v[188:203]
  s_mov_b32 exec_lo, 0
  v_cvt_pk_bf16_f32 v81, v156, 0
  s_mov_b32 exec_lo, -1
  ds_write_b16 v68, v81
  s_waitcnt lgkmcnt(7)
  v_mfma_f32_32x32x16_bf16 v[140:155], v[132:135], v[116:119], 0
  s_waitcnt lgkmcnt(5)
  v_mfma_f32_32x32x16_bf16 v[140:155], v[136:139], v[120:123], v[140:155]
  v_cvt_pk_bf16_f32 v82, v172, 0
  s_waitcnt lgkmcnt(3)
  v_mfma_f32_32x32x16_bf16 v[156:171], v[132:135], v[124:127], 0
  s_waitcnt lgkmcnt(1)
  v_mfma_f32_32x32x16_bf16 v[156:171], v[136:139], v[128:131], v[156:171]
  s_mov_b32 exec_lo, 0
  v_cvt_pk_bf16_f32 v82, v188, 0
  s_mov_b32 exec_lo, -1
  ds_write_b16 v69, v82
  s_nop 2
  v_cvt_pk_bf16_f32 v83, v140, 0
  s_mov_b32 exec_lo, 0
  s_nop 2
  v_cvt_pk_bf16_f32 v83, v156, 0
  s_mov_b64 exec, s[92:93]
  ds_write_b16 v70, v83
  s_mov_b64 exec, 0x3ffffff
  ds_write_b16 v80, v45
  s_mov_b64 exec, -1
  s_waitcnt lgkmcnt(0)
  ds_add_u32 v1, v3 offset:4
  v_cmp_gt_u32 s[92:93], 36, v246
L_csync2:
  ds_read_b32 v4, v2 offset:4
  s_waitcnt lgkmcnt(0)
  v_cmp_gt_u32 vcc, 8, v4
  s_cbranch_vccnz L_csync2
  ds_read_b64_tr_b16 v[132:133], v240 offset:0
  ds_read_b64_tr_b16 v[134:135], v240 offset:256
  ds_read_b64_tr_b16 v[136:137], v240 offset:1024
  ds_read_b64_tr_b16 v[138:139], v240 offset:1280
  ds_read_b64_tr_b16 v[84:85], v241 offset:0
  ds_read_b64_tr_b16 v[86:87], v241 offset:5408
  ds_read_b64_tr_b16 v[88:89], v242 offset:0
  ds_read_b64_tr_b16 v[90:91], v243 offset:0
  ds_read_b64_tr_b16 v[92:93], v241 offset:256
  ds_read_b64_tr_b16 v[94:95], v241 offset:5664
  ds_read_b64_tr_b16 v[96:97], v242 offset:256
  ds_read_b64_tr_b16 v[98:99], v243 offset:256
  ds_read_b64_tr_b16 v[100:101], v241 offset:512
  ds_read_b64_tr_b16 v[102:103], v241 offset:5920
  ds_read_b64_tr_b16 v[104:105], v242 offset:512
  ds_read_b64_tr_b16 v[106:107], v243 offset:512
  ds_read_b64_tr_b16 v[108:109], v241 offset:768
  ds_read_b64_tr_b16 v[110:111], v241 offset:6176
  ds_read_b64_tr_b16 v[112:113], v242 offset:768
  ds_read_b64_tr_b16 v[114:115], v243 offset:768
  s_waitcnt lgkmcnt(14)
  v_mfma_f32_32x32x16_bf16 v[140:155], v[132:135], v[84:87], 0
  s_waitcnt lgkmcnt(12)
  v_mfma_f32_32x32x16_bf16 v[140:155], v[136:139], v[88:91], v[140:155]
  ds_read_b64_tr_b16 v[116:117], v241 offset:1024
  ds_read_b64_tr_b16 v[118:119], v241 offset:6432
  ds_read_b64_tr_b16 v[120:121], v242 offset:1024
  ds_read_b64_tr_b16 v[122:123], v243 offset:1024
  s_waitcnt lgkmcnt(14)
  v_mfma_f32_32x32x16_bf16 v[156:171], v[132:135], v[92:95], 0
  s_waitcnt lgkmcnt(12)
  v_mfma_f32_32x32x16_bf16 v[156:171], v[136:139], v[96:99], v[156:171]
  ds_read_b64_tr_b16 v[124:125], v241 offset:1280
  ds_read_b64_tr_b16 v[126:127], v241 offset:6688
  ds_read_b64_tr_b16 v[128:129], v242 offset:1280
  ds_read_b64_tr_b16 v[130:131], v243 offset:1280
  s_waitcnt lgkmcnt(14)
  v_mfma_f32_32x32x16_bf16 v[172:187], v[132:135], v[100:103], 0
  s_waitcnt lgkmcnt(12)
  v_mfma_f32_32x32x16_bf16 v[172:187], v[136:139], v[104:107], v[172:187]
  v_cvt_pk_bf16_f32 v84, v140, v141
  v_cvt_pk_bf16_f32 v85, v142, v143
  v_cvt_pk_bf16_f32 v86, v144, v145
  v_cvt_pk_bf16_f32 v87, v146, v147
  v_cvt_pk_bf16_f32 v88, v148, v149
  v_cvt_pk_bf16_f32 v89, v150, v151
  v_cvt_pk_bf16_f32 v90, v152, v153
  v_cvt_pk_bf16_f32 v91, v154, v155
  ds_write2_b32 v72, v84, v85 offset0:0 offset1:1
  ds_write2_b32 v72, v86, v87 offset0:4 offset1:5
  ds_write2_b32 v72, v88, v89 offset0:8 offset1:9
  s_waitcnt lgkmcnt(13)
  v_mfma_f32_32x32x16_bf16 v[188:203], v[132:135], v[108:111], 0
  s_waitcnt lgkmcnt(11)
  v_mfma_f32_32x32x16_bf16 v[188:203], v[136:139], v[112:115], v[188:203]
  v_cvt_pk_bf16_f32 v92, v156, v157
  v_cvt_pk_bf16_f32 v93, v158, v159
  v_cvt_pk_bf16_f32 v94, v160, v161
  v_cvt_pk_bf16_f32 v95, v162, v163
  v_cvt_pk_bf16_f32 v96, v164, v165
  v_cvt_pk_bf16_f32 v97, v166, v167
  v_cvt_pk_bf16_f32 v98, v168, v169
  v_cvt_pk_bf16_f32 v99, v170, v171
  ds_write2_b32 v73, v92, v93 offset0:0 offset1:1
  ds_write2_b32 v73, v94, v95 offset0:4 offset1:5
  ds_write2_b32 v73, v96, v97 offset0:8 offset1:9
  s_waitcnt lgkmcnt(12)
  v_mfma_f32_32x32x16_bf16 v[140:155], v[132:135], v[116:119], 0
  s_waitcnt lgkmcnt(10)
  v_mfma_f32_32x32x16_bf16 v[140:155], v[136:139], v[120:123], v[140:155]
  v_cvt_pk_bf16_f32 v100, v172, v173
  v_cvt_pk_bf16_f32 v101, v174, v175
  v_cvt_pk_bf16_f32 v102, v176, v177
  v_cvt_pk_bf16_f32 v103, v178, v179
  v_cvt_pk_bf16_f32 v104, v180, v181
  v_cvt_pk_bf16_f32 v105, v182, v183
  v_cvt_pk_bf16_f32 v106, v184, v185
  v_cvt_pk_bf16_f32 v107, v186, v187
  ds_write2_b32 v74, v100, v101 offset0:0 offset1:1
  ds_write2_b32 v74, v102, v103 offset0:4 offset1:5
  ds_write2_b32 v74, v104, v105 offset0:8 offset1:9
  s_waitcnt lgkmcnt(11)
  v_mfma_f32_32x32x16_bf16 v[156:171], v[132:135], v[124:127], 0
  s_waitcnt lgkmcnt(9)
  v_mfma_f32_32x32x16_bf16 v[156:171], v[136:139], v[128:131], v[156:171]
  v_cvt_pk_bf16_f32 v108, v188, v189
  v_cvt_pk_bf16_f32 v109, v190, v191
  v_cvt_pk_bf16_f32 v110, v192, v193
  v_cvt_pk_bf16_f32 v111, v194, v195
  v_cvt_pk_bf16_f32 v112, v196, v197
  v_cvt_pk_bf16_f32 v113, v198, v199
  v_cvt_pk_bf16_f32 v114, v200, v201
  v_cvt_pk_bf16_f32 v115, v202, v203
  ds_write2_b32 v75, v108, v109 offset0:0 offset1:1
  ds_write2_b32 v75, v110, v111 offset0:4 offset1:5
  ds_write2_b32 v75, v112, v113 offset0:8 offset1:9
  v_cvt_pk_bf16_f32 v116, v140, v141
  v_cvt_pk_bf16_f32 v117, v142, v143
  v_cvt_pk_bf16_f32 v118, v144, v145
  v_cvt_pk_bf16_f32 v119, v146, v147
  v_cvt_pk_bf16_f32 v120, v148, v149
  v_cvt_pk_bf16_f32 v121, v150, v151
  v_cvt_pk_bf16_f32 v122, v152, v153
  v_cvt_pk_bf16_f32 v123, v154, v155
  ds_write2_b32 v76, v116, v117 offset0:0 offset1:1
  ds_write2_b32 v76, v118, v119 offset0:4 offset1:5
  ds_write2_b32 v76, v120, v121 offset0:8 offset1:9
  v_cvt_pk_bf16_f32 v124, v156, v157
  v_cvt_pk_bf16_f32 v125, v158, v159
  v_cvt_pk_bf16_f32 v126, v160, v161
  v_cvt_pk_bf16_f32 v127, v162, v163
  v_cvt_pk_bf16_f32 v128, v164, v165
  v_cvt_pk_bf16_f32 v129, v166, v167
  v_cvt_pk_bf16_f32 v130, v168, v169
  v_cvt_pk_bf16_f32 v131, v170, v171
  s_mov_b64 exec, s[92:93]
  ds_write2_b32 v77, v124, v125 offset0:0 offset1:1
  ds_write2_b32 v77, v126, v127 offset0:4 offset1:5
  ds_write2_b32 v77, v128, v129 offset0:8 offset1:9
  s_mov_b32 exec_hi, 0
  ds_write_b32 v77, v130 offset:48
  ds_write_b16 v245, v131 offset:1280
  s_mov_b32 exec_lo, -1
  ds_write_b32 v76, v122 offset:48
  ds_write_b16 v245, v123 offset:1024
  ds_write_b32 v75, v114 offset:48
  ds_write_b16 v245, v115 offset:768
  ds_write_b32 v74, v106 offset:48
  ds_write_b16 v245, v107 offset:512
  ds_write_b32 v73, v98 offset:48
  ds_write_b16 v245, v99 offset:256
  ds_write_b32 v72, v90 offset:48
  ds_write_b16 v245, v91 offset:0
  s_mov_b64 exec, -1
  s_waitcnt lgkmcnt(0)
  ds_add_u32 v6, v3 offset:8
  s_setprio 1
  s_branch L_bld
L_g0pf:
  buffer_load_dword v208, v20, s[28:31], s77 offen
  buffer_load_dword v209, v20, s[28:31], s77 offen offset:2496
  s_add_u32 s77, s77, 24
  buffer_load_dword v21, v20, s[28:31], s77 offen
  s_cmp_eq_u32 s77, s73
  s_cselect_b32 s73, 0x7000000, s73
  s_cselect_b32 s77, 0x7000000, s77
  s_add_u32 s77, s77, 24
  s_min_u32 s77, s77, s73
  s_waitcnt vmcnt(7) lgkmcnt(0)
  ds_add_u32 v1, v3 offset:0
  s_add_u32 m0, s95, 52672
  s_add_u32 s81, s95, 51536
  buffer_load_dwordx4 v48, s[36:39], s81 offen lds
  s_add_u32 m0, s95, 56768
  s_add_u32 s81, s95, 55632
  buffer_load_dwordx4 v48, s[36:39], s81 offen lds
  s_add_u32 m0, s95, 60864
  s_add_u32 s81, s95, 59728
  buffer_load_dwordx4 v48, s[36:39], s81 offen lds
  s_add_u32 m0, s95, 64960
  s_add_u32 s81, s95, 63824
  buffer_load_dwordx4 v48, s[36:39], s81 offen lds
  s_add_u32 m0, s96, 36288
  s_add_u32 s81, s96, 35152
  s_mov_b64 exec, s[82:83]
  buffer_load_dwordx4 v48, s[36:39], s81 offen lds
  s_mov_b64 exec, -1
  s_add_u32 m0, s95, 1024
  s_add_u32 s81, s95, 0
  buffer_load_dwordx4 v48, s[36:39], s81 offen lds
  s_add_u32 m0, s95, 5120
  s_add_u32 s81, s95, 4096
  buffer_load_dwordx4 v48, s[36:39], s81 offen lds
  s_add_u32 m0, s95, 9216
  s_add_u32 s81, s95, 8192
  buffer_load_dwordx4 v48, s[36:39], s81 offen lds
  s_add_u32 m0, s95, 13312
  s_add_u32 s81, s95, 12288
  buffer_load_dwordx4 v48, s[36:39], s81 offen lds
  s_waitcnt vmcnt(4) lgkmcnt(0)
  ds_add_u32 v1, v3 offset:4
  s_add_u32 m0, s95, 17408
  s_add_u32 s81, s95, 16384
  buffer_load_dwordx4 v48, s[36:39], s81 offen lds
  s_add_u32 m0, s95, 21504
  s_add_u32 s81, s95, 20480
  buffer_load_dwordx4 v48, s[36:39], s81 offen lds
  s_add_u32 m0, s95, 25600
  s_add_u32 s81, s95, 24576
  buffer_load_dwordx4 v48, s[36:39], s81 offen lds
  s_add_u32 m0, s95, 29696
  s_add_u32 s81, s95, 28672
  buffer_load_dwordx4 v48, s[36:39], s81 offen lds
  s_add_u32 m0, s96, 1024
  s_add_u32 s81, s96, 0
  s_mov_b64 exec, s[82:83]
  buffer_load_dwordx4 v48, s[36:39], s81 offen lds
  s_mov_b64 exec, -1
  v_lshl_add_u32 v24, v24, 7, v18
  v_lshl_add_u32 v25, v25, 7, v18
  s_mov_b32 exec_hi, 0x0000ffff
  v_lshl_add_u32 v26, v26, 7, v18
  v_lshl_add_u32 v27, v27, 7, v18
  s_mov_b32 exec_lo, 0
  s_mov_b32 exec_hi, 0xffff0000
  v_mov_b32 v27, v25
  v_mov_b32 v26, v25
  s_mov_b32 exec_hi, 0x00ff0000
  v_mov_b32 v26, v24
  s_mov_b64 exec, -1
  s_add_u32 m0, s74, 0
  s_nop 0
  buffer_load_dwordx4 v24, s[32:35], 0 offen lds
  s_add_u32 m0, s74, 1056
  s_nop 0
  buffer_load_dwordx4 v25, s[32:35], 0 offen lds
  s_add_u32 m0, s74, 2112
  s_nop 0
  buffer_load_dwordx4 v26, s[32:35], 0 offen lds
  s_add_u32 m0, s74, 3168
  s_mov_b32 exec_hi, 0x00ffffff
  buffer_load_dwordx4 v27, s[32:35], 0 offen lds
  s_mov_b32 exec_hi, -1
  v_lshl_add_u32 v204, v204, 7, v18
  v_lshl_add_u32 v205, v205, 7, v18
  s_mov_b32 exec_hi, 0x0000ffff
  v_lshl_add_u32 v206, v206, 7, v18
  v_lshl_add_u32 v207, v207, 7, v18
  s_mov_b32 exec_lo, 0
  s_mov_b32 exec_hi, 0xffff0000
  v_mov_b32 v207, v205
  v_mov_b32 v206, v205
  s_mov_b32 exec_hi, 0x00ff0000
  v_mov_b32 v206, v204
  s_mov_b64 exec, -1
  s_add_u32 m0, s74, 16896
  s_nop 0
  buffer_load_dwordx4 v204, s[32:35], 0 offen lds
  s_add_u32 m0, s74, 17952
  s_nop 0
  buffer_load_dwordx4 v205, s[32:35], 0 offen lds
  s_add_u32 m0, s74, 19008
  s_nop 0
  buffer_load_dwordx4 v206, s[32:35], 0 offen lds
  s_add_u32 m0, s74, 20064
  s_mov_b32 exec_hi, 0x00ffffff
  buffer_load_dwordx4 v207, s[32:35], 0 offen lds
  s_mov_b32 exec_hi, -1
  buffer_load_dwordx4 v[24:27], v17, s[28:31], s94 offen offset:0
  s_add_u32 s94, s94, 832
  v_lshlrev_b32 v208, 7, v208
  buffer_load_dword v255, v208, s[32:35], 0 offen
  v_lshlrev_b32 v209, 7, v209
  buffer_load_dword v255, v209, s[32:35], 0 offen
  s_waitcnt vmcnt(11) lgkmcnt(0)
  ds_add_u32 v6, v3 offset:8
L_bld:
L_csync3:
  ds_read_b32 v4, v5 offset:8
  s_waitcnt lgkmcnt(0)
  v_cmp_gt_u32 vcc, 4, v4
  s_cbranch_vccnz L_csync3
  s_cmp_ge_u32 s79, 2
  s_cbranch_scc1 L_chunk1
  ds_read_u16_d16_hi v216, v49 offset:0
  ds_read_u16_d16_hi v218, v49 offset:648
  ds_read_u16_d16_hi v220, v49 offset:216
  ds_read_u16_d16_hi v222, v49 offset:864
  ds_read_u16_d16_hi v224, v49 offset:432
  ds_read_u16_d16_hi v226, v49 offset:1080
  ds_read_u16_d16_hi v228, v49 offset:8
  ds_read_u16_d16_hi v229, v49 offset:208
  ds_read_u16_d16_hi v230, v49 offset:656
  ds_read_u16_d16_hi v231, v49 offset:856
  s_waitcnt lgkmcnt(8)
  v_mov_b32 v85, v218
  v_mov_b32 v84, v216
  v_max3_f32 v62, v62, abs(v84), abs(v85)
  ds_read_u16_d16_hi v232, v49 offset:32
  ds_read_u16_d16_hi v233, v49 offset:832
  ds_read_u16_d16_hi v234, v49 offset:632
  ds_read_u16_d16_hi v235, v49 offset:232
  s_waitcnt lgkmcnt(10)
  v_mov_b32 v87, v222
  v_mov_b32 v86, v220
  v_max3_f32 v62, v62, abs(v86), abs(v87)
  ds_read_u16_d16_hi v236, v49 offset:16
  ds_read_u16_d16_hi v237, v49 offset:416
  ds_read_u16_d16_hi v238, v49 offset:664
  ds_read_u16_d16_hi v239, v49 offset:1064
  s_waitcnt lgkmcnt(12)
  v_mov_b32 v89, v226
  v_mov_b32 v88, v224
  v_max3_f32 v62, v62, abs(v88), abs(v89)
  ds_read_u16_d16_hi v216, v49 offset:40
  ds_read_u16_d16_hi v217, v49 offset:1040
  ds_read_u16_d16_hi v218, v49 offset:640
  ds_read_u16_d16_hi v219, v49 offset:440
  s_waitcnt lgkmcnt(12)
  v_add_f32 v91, v230, v231
  v_add_f32 v90, v228, v229
  v_max3_f32 v62, v62, abs(v90), abs(v91)
  ds_read_u16_d16_hi v220, v49 offset:224
  ds_read_u16_d16_hi v221, v49 offset:424
  ds_read_u16_d16_hi v222, v49 offset:872
  ds_read_u16_d16_hi v223, v49 offset:1072
  s_waitcnt lgkmcnt(12)
  v_add_f32 v93, v234, v235
  v_add_f32 v92, v232, v233
  v_max3_f32 v62, v62, abs(v92), abs(v93)
  ds_read_u16_d16_hi v224, v49 offset:248
  ds_read_u16_d16_hi v225, v49 offset:1048
  ds_read_u16_d16_hi v226, v49 offset:848
  ds_read_u16_d16_hi v227, v49 offset:448
  s_waitcnt lgkmcnt(12)
  v_add_f32 v95, v238, v239
  v_add_f32 v94, v236, v237
  v_max3_f32 v62, v62, abs(v94), abs(v95)
  ds_read_u16_d16_hi v228, v50 offset:48
  ds_read_u16_d16_hi v229, v51 offset:1248
  ds_read_u16_d16_hi v230, v50 offset:672
  ds_read_u16_d16_hi v231, v51 offset:1272
  s_waitcnt lgkmcnt(12)
  v_add_f32 v97, v218, v219
  v_add_f32 v96, v216, v217
  v_max3_f32 v62, v62, abs(v96), abs(v97)
  ds_read_u16_d16_hi v232, v50 offset:256
  ds_read_u16_d16_hi v233, v51 offset:1256
  ds_read_u16_d16_hi v234, v50 offset:880
  ds_read_u16_d16_hi v235, v51 offset:1280
  s_waitcnt lgkmcnt(12)
  v_add_f32 v99, v222, v223
  v_add_f32 v98, v220, v221
  v_max3_f32 v62, v62, abs(v98), abs(v99)
  ds_read_u16_d16_hi v236, v50 offset:464
  ds_read_u16_d16_hi v237, v51 offset:1264
  ds_read_u16_d16_hi v238, v50 offset:1088
  ds_read_u16_d16_hi v239, v51 offset:1288
  s_waitcnt lgkmcnt(12)
  v_add_f32 v101, v226, v227
  v_add_f32 v100, v224, v225
  v_max3_f32 v62, v62, abs(v100), abs(v101)
  ds_read_u16_d16_hi v216, v49 offset:24
  ds_read_u16_d16_hi v217, v49 offset:624
  ds_read_u16_d16_hi v218, v49 offset:240
  ds_read_u16_d16_hi v219, v49 offset:840
  s_waitcnt lgkmcnt(12)
  v_add_f32 v103, v230, v231
  v_add_f32 v102, v228, v229
  v_max3_f32 v62, v62, abs(v102), abs(v103)
  ds_read_u16_d16_hi v220, v49 offset:456
  ds_read_u16_d16_hi v221, v49 offset:1056
  ds_read_u16_d16_hi v222, v60 offset:1296
  ds_read_u16_d16_hi v223, v61 offset:1296
  s_waitcnt lgkmcnt(12)
  v_add_f32 v105, v234, v235
  v_add_f32 v104, v232, v233
  v_max3_f32 v62, v62, abs(v104), abs(v105)
  ds_read_u16_d16_hi v224, v52 offset:50
  ds_read_u16_d16_hi v225, v53 offset:1300
  ds_read_u16_d16_hi v226, v52 offset:674
  ds_read_u16_d16_hi v227, v53 offset:1324
  s_waitcnt lgkmcnt(12)
  v_add_f32 v107, v238, v239
  v_add_f32 v106, v236, v237
  v_max3_f32 v62, v62, abs(v106), abs(v107)
  ds_read_u16_d16_hi v228, v52 offset:258
  ds_read_u16_d16_hi v229, v53 offset:1308
  ds_read_u16_d16_hi v230, v52 offset:882
  ds_read_u16_d16_hi v231, v53 offset:1332
  s_waitcnt lgkmcnt(12)
  v_add_f32 v109, v218, v219
  v_add_f32 v108, v216, v217
  v_max3_f32 v62, v62, abs(v108), abs(v109)
  ds_read_u16_d16_hi v232, v52 offset:466
  ds_read_u16_d16_hi v233, v53 offset:1316
  ds_read_u16_d16_hi v234, v52 offset:1090
  ds_read_u16_d16_hi v235, v53 offset:1340
  s_waitcnt lgkmcnt(12)
  v_add_f32 v111, v222, v223
  v_add_f32 v110, v220, v221
  v_max3_f32 v62, v62, abs(v110), abs(v111)
  ds_read_u16_d16_hi v236, v54 offset:2
  ds_read_u16_d16_hi v237, v55 offset:52
  ds_read_u16_d16_hi v238, v54 offset:650
  ds_read_u16_d16_hi v239, v55 offset:700
  s_waitcnt lgkmcnt(12)
  v_add_f32 v113, v226, v227
  v_add_f32 v112, v224, v225
  v_max3_f32 v62, v62, abs(v112), abs(v113)
  ds_read_u16_d16_hi v216, v54 offset:26
  ds_read_u16_d16_hi v217, v55 offset:676
  ds_read_u16_d16_hi v218, v54 offset:626
  ds_read_u16_d16_hi v219, v55 offset:76
  s_waitcnt lgkmcnt(12)
  v_add_f32 v115, v230, v231
  v_add_f32 v114, v228, v229
  v_max3_f32 v62, v62, abs(v114), abs(v115)
  ds_read_u16_d16_hi v220, v54 offset:10
  ds_read_u16_d16_hi v221, v55 offset:260
  ds_read_u16_d16_hi v222, v54 offset:658
  ds_read_u16_d16_hi v223, v55 offset:908
  s_waitcnt lgkmcnt(12)
  v_add_f32 v117, v234, v235
  v_add_f32 v116, v232, v233
  v_max3_f32 v62, v62, abs(v116), abs(v117)
  ds_read_u16_d16_hi v224, v54 offset:34
  ds_read_u16_d16_hi v225, v55 offset:884
  ds_read_u16_d16_hi v226, v54 offset:634
  ds_read_u16_d16_hi v227, v55 offset:284
  s_waitcnt lgkmcnt(12)
  v_add_f32 v119, v238, v239
  v_add_f32 v118, v236, v237
  v_max3_f32 v62, v62, abs(v118), abs(v119)
  ds_read_u16_d16_hi v228, v54 offset:18
  ds_read_u16_d16_hi v229, v55 offset:468
  ds_read_u16_d16_hi v230, v54 offset:666
  ds_read_u16_d16_hi v231, v55 offset:1116
  s_waitcnt lgkmcnt(12)
  v_add_f32 v121, v218, v219
  v_add_f32 v120, v216, v217
  v_max3_f32 v62, v62, abs(v120), abs(v121)
  ds_read_u16_d16_hi v232, v54 offset:42
  ds_read_u16_d16_hi v233, v55 offset:1092
  ds_read_u16_d16_hi v234, v54 offset:642
  ds_read_u16_d16_hi v235, v55 offset:492
  s_waitcnt lgkmcnt(12)
  v_add_f32 v123, v222, v223
  v_add_f32 v122, v220, v221
  v_max3_f32 v62, v62, abs(v122), abs(v123)
  ds_read_u16_d16_hi v236, v54 offset:210
  ds_read_u16_d16_hi v237, v55 offset:60
  ds_read_u16_d16_hi v238, v54 offset:858
  ds_read_u16_d16_hi v239, v55 offset:708
  s_waitcnt lgkmcnt(12)
  v_add_f32 v125, v226, v227
  v_add_f32 v124, v224, v225
  v_max3_f32 v62, v62, abs(v124), abs(v125)
  s_waitcnt lgkmcnt(8)
  v_add_f32 v127, v230, v231
  v_add_f32 v126, v228, v229
  v_max3_f32 v62, v62, abs(v126), abs(v127)
  s_waitcnt lgkmcnt(4)
  v_add_f32 v129, v234, v235
  v_add_f32 v128, v232, v233
  v_max3_f32 v62, v62, abs(v128), abs(v129)
  s_waitcnt lgkmcnt(0)
  v_add_f32 v131, v238, v239
  v_add_f32 v130, v236, v237
  v_max3_f32 v62, v62, abs(v130), abs(v131)
  s_branch L_conv
L_chunk1:
  ds_read_u16_d16_hi v216, v54 offset:234
  ds_read_u16_d16_hi v217, v55 offset:684
  ds_read_u16_d16_hi v218, v54 offset:834
  ds_read_u16_d16_hi v219, v55 offset:84
  ds_read_u16_d16_hi v220, v54 offset:218
  ds_read_u16_d16_hi v221, v55 offset:268
  ds_read_u16_d16_hi v222, v54 offset:866
  ds_read_u16_d16_hi v223, v55 offset:916
  ds_read_u16_d16_hi v224, v54 offset:242
  ds_read_u16_d16_hi v225, v55 offset:892
  ds_read_u16_d16_hi v226, v54 offset:842
  ds_read_u16_d16_hi v227, v55 offset:292
  ds_read_u16_d16_hi v228, v54 offset:226
  ds_read_u16_d16_hi v229, v55 offset:476
  ds_read_u16_d16_hi v230, v54 offset:874
  ds_read_u16_d16_hi v231, v55 offset:1124
  s_waitcnt lgkmcnt(12)
  v_add_f32 v85, v218, v219
  v_add_f32 v84, v216, v217
  v_max3_f32 v62, v62, abs(v84), abs(v85)
  ds_read_u16_d16_hi v232, v54 offset:250
  ds_read_u16_d16_hi v233, v55 offset:1100
  ds_read_u16_d16_hi v234, v54 offset:850
  ds_read_u16_d16_hi v235, v55 offset:500
  s_waitcnt lgkmcnt(12)
  v_add_f32 v87, v222, v223
  v_add_f32 v86, v220, v221
  v_max3_f32 v62, v62, abs(v86), abs(v87)
  ds_read_u16_d16_hi v236, v54 offset:418
  ds_read_u16_d16_hi v237, v55 offset:68
  ds_read_u16_d16_hi v238, v54 offset:1066
  ds_read_u16_d16_hi v239, v55 offset:716
  s_waitcnt lgkmcnt(12)
  v_add_f32 v89, v226, v227
  v_add_f32 v88, v224, v225
  v_max3_f32 v62, v62, abs(v88), abs(v89)
  ds_read_u16_d16_hi v216, v54 offset:442
  ds_read_u16_d16_hi v217, v55 offset:692
  ds_read_u16_d16_hi v218, v54 offset:1042
  ds_read_u16_d16_hi v219, v55 offset:92
  s_waitcnt lgkmcnt(12)
  v_add_f32 v91, v230, v231
  v_add_f32 v90, v228, v229
  v_max3_f32 v62, v62, abs(v90), abs(v91)
  ds_read_u16_d16_hi v220, v54 offset:426
  ds_read_u16_d16_hi v221, v55 offset:276
  ds_read_u16_d16_hi v222, v54 offset:1074
  ds_read_u16_d16_hi v223, v55 offset:924
  s_waitcnt lgkmcnt(12)
  v_add_f32 v93, v234, v235
  v_add_f32 v92, v232, v233
  v_max3_f32 v62, v62, abs(v92), abs(v93)
  ds_read_u16_d16_hi v224, v54 offset:450
  ds_read_u16_d16_hi v225, v55 offset:900
  ds_read_u16_d16_hi v226, v54 offset:1050
  ds_read_u16_d16_hi v227, v55 offset:300
  s_waitcnt lgkmcnt(12)
  v_add_f32 v95, v238, v239
  v_add_f32 v94, v236, v237
  v_max3_f32 v62, v62, abs(v94), abs(v95)
  ds_read_u16_d16_hi v228, v54 offset:434
  ds_read_u16_d16_hi v229, v55 offset:484
  ds_read_u16_d16_hi v230, v54 offset:1082
  ds_read_u16_d16_hi v231, v55 offset:1132
  s_waitcnt lgkmcnt(12)
  v_add_f32 v97, v218, v219
  v_add_f32 v96, v216, v217
  v_max3_f32 v62, v62, abs(v96), abs(v97)
  ds_read_u16_d16_hi v232, v54 offset:458
  ds_read_u16_d16_hi v233, v55 offset:1108
  ds_read_u16_d16_hi v234, v54 offset:1058
  ds_read_u16_d16_hi v235, v55 offset:508
  s_waitcnt lgkmcnt(12)
  v_add_f32 v99, v222, v223
  v_add_f32 v98, v220, v221
  v_max3_f32 v62, v62, abs(v98), abs(v99)
  ds_read_u16_d16_hi v236, v56 offset:4
  ds_read_u16_d16_hi v237, v57 offset:104
  ds_read_u16_d16_hi v238, v58 offset:652
  ds_read_u16_d16_hi v239, v59 offset:752
  s_waitcnt lgkmcnt(12)
  v_add_f32 v101, v226, v227
  v_add_f32 v100, v224, v225
  v_max3_f32 v62, v62, abs(v100), abs(v101)
  ds_read_u16_d16_hi v216, v56 offset:220
  ds_read_u16_d16_hi v217, v57 offset:320
  ds_read_u16_d16_hi v218, v58 offset:868
  ds_read_u16_d16_hi v219, v59 offset:968
  s_waitcnt lgkmcnt(12)
  v_add_f32 v103, v230, v231
  v_add_f32 v102, v228, v229
  v_max3_f32 v62, v62, abs(v102), abs(v103)
  ds_read_u16_d16_hi v220, v56 offset:436
  ds_read_u16_d16_hi v221, v57 offset:536
  ds_read_u16_d16_hi v222, v58 offset:1084
  ds_read_u16_d16_hi v223, v59 offset:1184
  s_waitcnt lgkmcnt(12)
  v_add_f32 v105, v234, v235
  v_add_f32 v104, v232, v233
  v_max3_f32 v62, v62, abs(v104), abs(v105)
  ds_read_u16_d16_hi v224, v56 offset:12
  ds_read_u16_d16_hi v225, v57 offset:312
  ds_read_u16_d16_hi v226, v58 offset:660
  ds_read_u16_d16_hi v227, v59 offset:960
  s_waitcnt lgkmcnt(12)
  v_add_f32 v107, v238, v239
  v_add_f32 v106, v236, v237
  v_max3_f32 v62, v62, abs(v106), abs(v107)
  ds_read_u16_d16_hi v228, v58 offset:36
  ds_read_u16_d16_hi v229, v59 offset:936
  ds_read_u16_d16_hi v230, v56 offset:636
  ds_read_u16_d16_hi v231, v57 offset:336
  s_waitcnt lgkmcnt(12)
  v_add_f32 v109, v218, v219
  v_add_f32 v108, v216, v217
  v_max3_f32 v62, v62, abs(v108), abs(v109)
  ds_read_u16_d16_hi v232, v56 offset:20
  ds_read_u16_d16_hi v233, v57 offset:520
  ds_read_u16_d16_hi v234, v58 offset:668
  ds_read_u16_d16_hi v235, v59 offset:1168
  s_waitcnt lgkmcnt(12)
  v_add_f32 v111, v222, v223
  v_add_f32 v110, v220, v221
  v_max3_f32 v62, v62, abs(v110), abs(v111)
  ds_read_u16_d16_hi v236, v58 offset:44
  ds_read_u16_d16_hi v237, v59 offset:1144
  ds_read_u16_d16_hi v238, v56 offset:644
  ds_read_u16_d16_hi v239, v57 offset:544
  s_waitcnt lgkmcnt(12)
  v_add_f32 v113, v226, v227
  v_add_f32 v112, v224, v225
  v_max3_f32 v62, v62, abs(v112), abs(v113)
  ds_read_u16_d16_hi v216, v56 offset:228
  ds_read_u16_d16_hi v217, v57 offset:528
  ds_read_u16_d16_hi v218, v58 offset:876
  ds_read_u16_d16_hi v219, v59 offset:1176
  s_waitcnt lgkmcnt(12)
  v_add_f32 v115, v230, v231
  v_add_f32 v114, v228, v229
  v_max3_f32 v62, v62, abs(v114), abs(v115)
  ds_read_u16_d16_hi v220, v58 offset:252
  ds_read_u16_d16_hi v221, v59 offset:1152
  ds_read_u16_d16_hi v222, v56 offset:852
  ds_read_u16_d16_hi v223, v57 offset:552
  s_waitcnt lgkmcnt(12)
  v_add_f32 v117, v234, v235
  v_add_f32 v116, v232, v233
  v_max3_f32 v62, v62, abs(v116), abs(v117)
  s_waitcnt lgkmcnt(8)
  v_add_f32 v119, v238, v239
  v_add_f32 v118, v236, v237
  v_max3_f32 v62, v62, abs(v118), abs(v119)
  s_waitcnt lgkmcnt(4)
  v_add_f32 v121, v218, v219
  v_add_f32 v120, v216, v217
  v_max3_f32 v62, v62, abs(v120), abs(v121)
  s_waitcnt lgkmcnt(0)
  v_add_f32 v123, v222, v223
  v_add_f32 v122, v220, v221
  v_max3_f32 v62, v62, abs(v122), abs(v123)
  ds_read_u16_d16_hi v216, v65 offset:0
  ds_read_u16_d16_hi v217, v65 offset:8
  ds_read_u16_d16_hi v218, v65 offset:16
  ds_read_u16_d16_hi v219, v65 offset:24
  ds_read_u16_d16_hi v220, v65 offset:32
  ds_read_u16_d16_hi v221, v65 offset:40
  ds_read_u16_d16_hi v222, v64 offset:48
  ds_read_u16_d16_hi v223, v67
L_conv:
  s_nop 0
  v_max_u32_dpp v62, v62, v62 row_shr:1 row_mask:0xf bank_mask:0xf
  s_nop 1
  v_max_u32_dpp v62, v62, v62 row_shr:2 row_mask:0xf bank_mask:0xf
  s_nop 1
  v_max_u32_dpp v62, v62, v62 row_shr:4 row_mask:0xf bank_mask:0xf
  s_nop 1
  v_max_u32_dpp v62, v62, v62 row_shr:8 row_mask:0xf bank_mask:0xf
  s_nop 1
  v_max_u32_dpp v62, v62, v62 row_bcast:15 row_mask:0xa bank_mask:0xf
  s_nop 1
  v_max_u32_dpp v62, v62, v62 row_bcast:31 row_mask:0xc bank_mask:0xf
  s_nop 0
  v_readlane_b32 s68, v62, 63
  s_nop 1
  v_mov_b32 v62, s68
  ds_max_u32 v6, v62 offset:20
  s_waitcnt vmcnt(3)
  ds_add_u32 v6, v3 offset:16
L_csync4:
  ds_read_b64 v[40:41], v5 offset:16
  s_waitcnt lgkmcnt(0)
  v_cmp_gt_u32 vcc, 4, v40
  s_cbranch_vccnz L_csync4
  v_readfirstlane_b32 s71, v41
  s_nop 0
  s_lshr_b32 s71, s71, 23
  s_sub_i32 s71, 141, s71
  s_min_i32 s71, s71, 40
  s_add_i32 s51, s71, 127
  s_lshl_b32 s51, s51, 23
  v_fma_mixlo_f16 v132, v84, s51, 0
  v_fma_mixlo_f16 v133, v86, s51, 0
  v_fma_mixlo_f16 v134, v88, s51, 0
  v_fma_mixlo_f16 v135, v90, s51, 0
  v_fma_mixhi_f16 v132, v85, s51, 0
  v_fma_mixhi_f16 v133, v87, s51, 0
  v_fma_mixhi_f16 v134, v89, s51, 0
  v_fma_mixhi_f16 v135, v91, s51, 0
  v_fma_mixlo_f16 v136, v92, s51, 0
  v_fma_mixlo_f16 v137, v94, s51, 0
  v_fma_mixlo_f16 v138, v96, s51, 0
  v_fma_mixlo_f16 v139, v98, s51, 0
  v_fma_mixhi_f16 v136, v93, s51, 0
  v_fma_mixhi_f16 v137, v95, s51, 0
  v_fma_mixhi_f16 v138, v97, s51, 0
  v_fma_mixhi_f16 v139, v99, s51, 0
L_csync5:
  ds_read_b64 v[40:41], v2 offset:16
  s_waitcnt lgkmcnt(0)
  v_cmp_gt_u32 vcc, 4, v40
  s_cbranch_vccnz L_csync5
  v_readfirstlane_b32 s70, v41
  s_nop 0
  s_lshr_b32 s70, s70, 23
  s_sub_i32 s70, 141, s70
  s_min_i32 s70, s70, 40
  ds_write_b128 v63, v[132:135] offset:0
  v_fma_mixlo_f16 v140, v100, s51, 0
  v_fma_mixlo_f16 v141, v102, s51, 0
  v_fma_mixlo_f16 v142, v104, s51, 0
  v_fma_mixlo_f16 v143, v106, s51, 0
  v_fma_mixhi_f16 v140, v101, s51, 0
  v_fma_mixhi_f16 v141, v103, s51, 0
  v_fma_mixhi_f16 v142, v105, s51, 0
  v_fma_mixhi_f16 v143, v107, s51, 0
  ds_write_b128 v63, v[136:139] offset:1024
  v_fma_mixlo_f16 v144, v108, s51, 0
  v_fma_mixlo_f16 v145, v110, s51, 0
  v_fma_mixlo_f16 v146, v112, s51, 0
  v_fma_mixlo_f16 v147, v114, s51, 0
  v_fma_mixhi_f16 v144, v109, s51, 0
  v_fma_mixhi_f16 v145, v111, s51, 0
  v_fma_mixhi_f16 v146, v113, s51, 0
  v_fma_mixhi_f16 v147, v115, s51, 0
  ds_write_b128 v63, v[140:143] offset:2048
  v_fma_mixlo_f16 v148, v116, s51, 0
  v_fma_mixlo_f16 v149, v118, s51, 0
  v_fma_mixlo_f16 v150, v120, s51, 0
  v_fma_mixlo_f16 v151, v122, s51, 0
  v_fma_mixhi_f16 v148, v117, s51, 0
  v_fma_mixhi_f16 v149, v119, s51, 0
  v_fma_mixhi_f16 v150, v121, s51, 0
  v_fma_mixhi_f16 v151, v123, s51, 0
  ds_write_b128 v63, v[144:147] offset:3072
  ds_write_b128 v63, v[148:151] offset:4096
  s_cmp_ge_u32 s79, 2
  s_cbranch_scc1 L_cvl
  v_fma_mixlo_f16 v152, v124, s51, 0
  v_fma_mixlo_f16 v153, v126, s51, 0
  v_fma_mixlo_f16 v154, v128, s51, 0
  v_fma_mixlo_f16 v155, v130, s51, 0
  v_fma_mixhi_f16 v152, v125, s51, 0
  v_fma_mixhi_f16 v153, v127, s51, 0
  v_fma_mixhi_f16 v154, v129, s51, 0
  v_fma_mixhi_f16 v155, v131, s51, 0
  ds_write_b128 v63, v[152:155] offset:5120
  s_branch L_built
L_cvl:
  s_cmp_eq_u32 s84, 0
  s_cbranch_scc1 L_built
  v_mul_f32 v216, s51, v216
  v_mul_f32 v217, s51, v217
  v_mul_f32 v218, s51, v218
  v_mul_f32 v219, s51, v219
  v_mul_f32 v220, s51, v220
  v_mul_f32 v221, s51, v221
  v_mul_f32 v222, s51, v222
  v_mul_f32 v223, s51, v223
  v_cvt_pk_bf16_f32 v152, v216, v217
  v_cvt_pk_bf16_f32 v153, v218, v219
  v_cvt_pk_bf16_f32 v154, v220, v221
  v_cvt_pk_bf16_f32 v155, v222, v223
  ds_write_b128 v66, v[152:155]
L_built:
  ds_read_u16_d16_hi v32, v7 offset:0
  ds_read_u16_d16_hi v33, v7 offset:128
  ds_read_u16_d16_hi v34, v7 offset:256
  ds_read_u16_d16_hi v35, v7 offset:384
  ds_read_u16_d16_hi v36, v7 offset:512
  ds_read_u16_d16_hi v37, v7 offset:640
  ds_read_u16_d16_hi v38, v7 offset:768
  ds_read_u16_d16_hi v39, v7 offset:896
  s_waitcnt lgkmcnt(0)
  v_cvt_pk_f16_f32 v43, v38, v39
  v_cvt_pk_f16_f32 v40, v32, v35
  v_cvt_pk_f16_f32 v41, v33, v36
  v_cvt_pk_f16_f32 v42, v34, v37
  ds_read_b64_tr_b16 v[52:53], v8 offset:0
  ds_read_b64_tr_b16 v[54:55], v8 offset:512
  ds_write_b128 v10, v[40:43]
  ds_read_b128 v[44:47], v11
  ds_read_b128 v[48:51], v12
  v_pk_mul_f16 v56, v40, v40 op_sel:[0,0] op_sel_hi:[1,1]
  v_pk_mul_f16 v57, v41, v41 op_sel:[0,0] op_sel_hi:[1,1]
  v_pk_mul_f16 v58, v42, v42 op_sel:[0,0] op_sel_hi:[1,1]
  v_pk_mul_f16 v59, v40, v41 op_sel:[0,0] op_sel_hi:[1,1]
  v_pk_mul_f16 v60, v40, v41 op_sel:[0,1] op_sel_hi:[1,0]
  v_pk_mul_f16 v61, v40, v42 op_sel:[0,0] op_sel_hi:[1,1]
  v_pk_mul_f16 v62, v40, v42 op_sel:[0,1] op_sel_hi:[1,0]
  v_pk_mul_f16 v63, v41, v42 op_sel:[0,0] op_sel_hi:[1,1]
  s_waitcnt lgkmcnt(0)
  v_alignbit_b32 v48, v48, v48, v13
  v_alignbit_b32 v49, v49, v49, v13
  s_waitcnt vmcnt(0)
  v_lshlrev_b32 v21, 7, v21
  buffer_load_dword v255, v21, s[32:35], 0 offen
  buffer_load_dword v21, v20, s[28:31], s77 offen
  s_cmp_eq_u32 s77, s73
  s_cselect_b32 s73, 0x7000000, s73
  s_cselect_b32 s77, 0x7000000, s77
  s_add_u32 s77, s77, 24
  s_min_u32 s77, s77, s73
  buffer_load_dword v255, v19, s[44:47], s101 offen
  s_add_u32 s101, s101, 1261568
  s_waitcnt lgkmcnt(0)
  s_barrier
  s_setprio 1
  ds_read_b128 v[216:219], v22
  ds_read_b128 v[240:243], v28 offset:46528
  ds_read_b128 v[84:87], v28 offset:0
  ds_read_b128 v[244:247], v30 offset:47552
  ds_read_b128 v[128:131], v28 offset:35264
  ds_read_b128 v[88:91], v28 offset:1024
  ds_read_b128 v[172:175], v31 offset:11264
  ds_read_b128 v[132:135], v28 offset:36288
  ds_read_b128 v[92:95], v28 offset:2048
  ds_read_b128 v[176:179], v31 offset:12288
  s_cmp_lg_u32 s84, 0
  s_cbranch_scc1 L_prf
  s_setprio 2
L_prf:
  s_waitcnt lgkmcnt(9)
  v_mfma_f32_16x16x32_f16 v[80:83], v[216:219], v[56:59], 0
  ds_read2_b32 v[220:221], v29 offset0:0 offset1:2
  ds_read2_b32 v[222:223], v29 offset0:64 offset1:66
  v_add_u32 v29, 2048, v29
  s_waitcnt lgkmcnt(10)
  v_mfma_f32_16x16x32_bf16 v[72:75], v[240:243], v[52:55], 0
  ds_read_b128 v[136:139], v28 offset:37312
  v_pk_mul_f16 v64, v41, v42 op_sel:[0,1] op_sel_hi:[1,0]
  v_pk_mul_f16 v65, v40, v43 op_sel:[0,0] op_sel_hi:[1,0]
  s_waitcnt lgkmcnt(10)
  v_mfma_f32_16x16x32_f16 v[68:71], v[84:87], v[56:59], 0
  ds_read_b128 v[180:183], v31 offset:13312
  s_waitcnt lgkmcnt(10)
  v_mfma_f32_16x16x32_bf16 v[76:79], v[244:247], v[52:55], 0
  ds_read_b128 v[96:99], v28 offset:3072
  v_pk_mul_f16 v66, v41, v43 op_sel:[0,0] op_sel_hi:[1,0]
  v_pk_mul_f16 v67, v42, v43 op_sel:[0,0] op_sel_hi:[1,0]
  s_waitcnt lgkmcnt(10)
  v_mfma_f32_16x16x32_f16 v[72:75], v[128:131], v[56:59], v[72:75]
  ds_read_b128 v[140:143], v28 offset:38336
  v_alignbit_b32 v50, v50, v50, v13
  s_waitcnt lgkmcnt(10)
  v_mfma_f32_16x16x32_f16 v[68:71], v[88:91], v[60:63], v[68:71]
  ds_read_b128 v[184:187], v31 offset:14336
  v_mul_f16_sdwa v52, v40, v40 dst_sel:WORD_0 dst_unused:UNUSED_PAD src0_sel:WORD_0 src1_sel:WORD_1
  v_mul_f16_sdwa v53, v42, v42 dst_sel:WORD_0 dst_unused:UNUSED_PAD src0_sel:WORD_0 src1_sel:WORD_1
  s_waitcnt lgkmcnt(10)
  v_mfma_f32_16x16x32_f16 v[76:79], v[172:175], v[56:59], v[76:79]
  ds_read2_b32 v[224:225], v29 offset0:0 offset1:2
  ds_read2_b32 v[226:227], v29 offset0:64 offset1:66
  v_add_u32 v29, 2048, v29
  s_waitcnt lgkmcnt(11)
  v_mfma_f32_16x16x32_f16 v[72:75], v[132:135], v[60:63], v[72:75]
  ds_read_b128 v[100:103], v28 offset:4096
  v_mul_f16_sdwa v52, v41, v41 dst_sel:WORD_1 dst_unused:UNUSED_PRESERVE src0_sel:WORD_0 src1_sel:WORD_1
  v_mul_f16_sdwa v53, v43, v43 dst_sel:WORD_1 dst_unused:UNUSED_PRESERVE src0_sel:WORD_0 src1_sel:WORD_1
  s_waitcnt lgkmcnt(11)
  v_mfma_f32_16x16x32_f16 v[68:71], v[92:95], v[64:67], v[68:71]
  ds_read_b128 v[144:147], v28 offset:39360
  v_pk_mul_f16 v54, v40, v47 op_sel:[0,0] op_sel_hi:[1,0]
  s_waitcnt lgkmcnt(11)
  v_mfma_f32_16x16x32_f16 v[76:79], v[176:179], v[60:63], v[76:79]
  ds_read_b128 v[188:191], v31 offset:15360
  v_pk_mul_f16 v55, v41, v47 op_sel:[0,0] op_sel_hi:[1,0]
  v_pk_mul_f16 v56, v42, v47 op_sel:[0,0] op_sel_hi:[1,0]
  s_waitcnt lgkmcnt(10)
  v_smfmac_f32_16x16x64_f16 v[80:83], v[220:223], v[60:67], v16
  ds_read_b128 v[104:107], v28 offset:5120
  v_pk_mul_f16 v57, v40, v44 op_sel:[0,0] op_sel_hi:[1,1]
  s_waitcnt lgkmcnt(10)
  v_mfma_f32_16x16x32_f16 v[72:75], v[136:139], v[64:67], v[72:75]
  ds_read_b128 v[148:151], v28 offset:40384
  v_pk_mul_f16 v58, v40, v44 op_sel:[0,1] op_sel_hi:[1,0]
  v_pk_mul_f16 v59, v40, v45 op_sel:[0,0] op_sel_hi:[1,1]
  s_waitcnt lgkmcnt(10)
  v_mfma_f32_16x16x32_f16 v[76:79], v[180:183], v[64:67], v[76:79]
  ds_read_b128 v[192:195], v31 offset:16384
  v_pk_mul_f16 v60, v40, v45 op_sel:[0,1] op_sel_hi:[1,0]
  s_waitcnt lgkmcnt(10)
  v_mfma_f32_16x16x32_f16 v[68:71], v[96:99], v[52:55], v[68:71]
  ds_read2_b32 v[228:229], v29 offset0:0 offset1:2
  ds_read2_b32 v[230:231], v29 offset0:64 offset1:66
  v_add_u32 v29, 2048, v29
  v_pk_mul_f16 v61, v40, v46 op_sel:[0,0] op_sel_hi:[1,1]
  v_pk_mul_f16 v62, v40, v46 op_sel:[0,1] op_sel_hi:[1,0]
  s_waitcnt lgkmcnt(11)
  v_mfma_f32_16x16x32_f16 v[72:75], v[140:143], v[52:55], v[72:75]
  ds_read_b128 v[108:111], v28 offset:6144
  v_pk_mul_f16 v63, v41, v44 op_sel:[0,0] op_sel_hi:[1,1]
  s_waitcnt lgkmcnt(11)
  v_mfma_f32_16x16x32_f16 v[76:79], v[184:187], v[52:55], v[76:79]
  ds_read_b128 v[152:155], v28 offset:41408
  ds_read_b32 v4, v2 offset:36
  ds_write_b16 v15, v14 offset:4064
  s_waitcnt vmcnt(5)
  v_lshl_add_u32 v24, v24, 7, v18
  v_lshl_add_u32 v25, v25, 7, v18
  s_mov_b32 exec_hi, 0x0000ffff
  v_lshl_add_u32 v26, v26, 7, v18
  v_lshl_add_u32 v27, v27, 7, v18
  s_mov_b32 exec_lo, 0
  s_mov_b32 exec_hi, 0xffff0000
  v_mov_b32 v27, v25
  v_mov_b32 v26, v25
  s_mov_b32 exec_hi, 0x00ff0000
  v_mov_b32 v26, v24
  s_mov_b64 exec, -1
  s_add_u32 m0, s74, -39488
  s_nop 0
  buffer_load_dwordx4 v24, s[32:35], 0 offen lds
  s_add_u32 m0, s74, -38432
  s_nop 0
  buffer_load_dwordx4 v25, s[32:35], 0 offen lds
  s_add_u32 m0, s74, -37376
  s_nop 0
  buffer_load_dwordx4 v26, s[32:35], 0 offen lds
  s_add_u32 m0, s74, -36320
  s_mov_b32 exec_hi, 0x00ffffff
  buffer_load_dwordx4 v27, s[32:35], 0 offen lds
  s_mov_b32 exec_hi, -1
  buffer_load_dwordx4 v[24:27], v17, s[28:31], s94 offen offset:0
  s_add_u32 s94, s94, 832
  s_waitcnt lgkmcnt(1)
  v_readfirstlane_b32 s71, v4
  s_nop 0
  s_lshr_b32 s71, s71, 23
  s_sub_i32 s71, 141, s71
  s_min_i32 s71, s71, 40
  s_add_i32 s48, s70, s71
  s_sub_i32 s48, 0, s48
  s_mov_b32 s49, s48
  s_mov_b32 s97, 1
  s_mov_b32 s50, 1
  s_mov_b32 s60, s24
  s_and_b32 s61, s25, 0xffff
  s_mov_b32 s62, 268435456
  s_mov_b32 s63, 0x20000
  s_mov_b32 s56, s20
  s_and_b32 s57, s21, 0xffff
  s_mov_b32 s58, 8192
  s_mov_b32 s59, 0x20000
  s_mov_b32 s64, s22
  s_and_b32 s65, s23, 0xffff
  s_mov_b32 s66, 256
  s_mov_b32 s67, 0x20000
  s_and_b32 s70, s2, 7
  s_lshl_b32 s68, s70, 14
  s_lshl_b32 s70, s70, 5
  s_cmp_lg_u32 s3, 7
  s_cbranch_scc1 L_nw0
  s_mov_b32 s60, s24
  s_and_b32 s61, s25, 0xffff
  s_mov_b32 s62, 268435456
  s_mov_b32 s63, 0x20000
  s_mov_b32 s56, s20
  s_and_b32 s57, s21, 0xffff
  s_mov_b32 s58, 8192
  s_mov_b32 s59, 0x20000
  s_mov_b32 s64, s22
  s_and_b32 s65, s23, 0xffff
  s_mov_b32 s66, 256
  s_mov_b32 s67, 0x20000
  s_load_dword s80, s[18:19], 0
  v_mov_b32 v22, 0
  s_mov_b64 exec, 1
  s_mov_b32 s81, 0x80000
  buffer_load_dword v255, v22, s[60:63], s81 offen
  buffer_load_dword v255, v22, s[56:59], 0 offen
  buffer_load_dword v255, v22, s[64:67], 0 offen offset:128 sc1
  s_mov_b64 exec, -1
  s_mov_b32 s52, s16
  s_and_b32 s53, s17, 0xffff
  s_mov_b32 s54, 3328
  s_mov_b32 s55, 0x20000
  v_lshlrev_b32 v22, 7, v0
  buffer_load_dword v255, v22, s[52:55], 0 offen
  s_waitcnt lgkmcnt(0)
L_nw0:
  v_pk_mul_f16 v64, v41, v44 op_sel:[0,1] op_sel_hi:[1,0]
  v_pk_mul_f16 v65, v41, v45 op_sel:[0,0] op_sel_hi:[1,1]
  v_smfmac_f32_16x16x64_f16 v[80:83], v[224:227], v[52:59], v16
  ds_read_b128 v[196:199], v31 offset:17408
  v_pk_mul_f16 v66, v41, v45 op_sel:[0,1] op_sel_hi:[1,0]
  v_pk_mul_f16 v67, v41, v46 op_sel:[0,0] op_sel_hi:[1,1]
  v_mfma_f32_16x16x32_f16 v[68:71], v[100:103], v[56:59], v[68:71]
  ds_read_b128 v[112:115], v28 offset:7168
  v_pk_mul_f16 v52, v41, v46 op_sel:[0,1] op_sel_hi:[1,0]
  v_pk_mul_f16 v53, v42, v44 op_sel:[0,0] op_sel_hi:[1,1]
  v_mfma_f32_16x16x32_f16 v[72:75], v[144:147], v[56:59], v[72:75]
  ds_read_b128 v[156:159], v28 offset:42432
  v_pk_mul_f16 v54, v42, v44 op_sel:[0,1] op_sel_hi:[1,0]
  v_pk_mul_f16 v55, v42, v45 op_sel:[0,0] op_sel_hi:[1,1]
  v_mfma_f32_16x16x32_f16 v[76:79], v[188:191], v[56:59], v[76:79]
  ds_read_b128 v[200:203], v31 offset:18432
  ds_read_u16_d16_hi v32, v7 offset:32
  ds_read_u16_d16_hi v33, v7 offset:160
  v_mfma_f32_16x16x32_f16 v[68:71], v[104:107], v[60:63], v[68:71]
  ds_read2_b32 v[232:233], v29 offset0:0 offset1:2
  ds_read2_b32 v[234:235], v29 offset0:64 offset1:66
  v_add_u32 v29, 2048, v29
  ds_read_u16_d16_hi v34, v7 offset:288
  ds_read_u16_d16_hi v35, v7 offset:416
  v_mfma_f32_16x16x32_f16 v[72:75], v[148:151], v[60:63], v[72:75]
  ds_read_b128 v[116:119], v28 offset:8192
  ds_read_u16_d16_hi v36, v7 offset:544
  ds_read_u16_d16_hi v37, v7 offset:672
  v_mfma_f32_16x16x32_f16 v[76:79], v[192:195], v[60:63], v[76:79]
  ds_read_b128 v[160:163], v28 offset:43456
  ds_read_u16_d16_hi v38, v7 offset:800
  ds_read_u16_d16_hi v39, v7 offset:928
  v_smfmac_f32_16x16x64_f16 v[80:83], v[228:231], v[60:67], v16
  ds_read_b128 v[204:207], v31 offset:19456
  v_pk_mul_f16 v56, v42, v45 op_sel:[0,1] op_sel_hi:[1,0]
  v_pk_mul_f16 v57, v42, v46 op_sel:[0,0] op_sel_hi:[1,1]
  v_mfma_f32_16x16x32_f16 v[68:71], v[108:111], v[64:67], v[68:71]
  ds_read_b128 v[120:123], v28 offset:9216
  v_pk_mul_f16 v58, v42, v46 op_sel:[0,1] op_sel_hi:[1,0]
  v_pk_mul_f16 v59, v40, v48 op_sel:[0,0] op_sel_hi:[1,1]
  v_mfma_f32_16x16x32_f16 v[72:75], v[152:155], v[64:67], v[72:75]
  ds_read_b128 v[164:167], v28 offset:44480
  v_pk_mul_f16 v60, v41, v49 op_sel:[0,0] op_sel_hi:[1,1]
  v_pk_mul_f16 v61, v42, v50 op_sel:[0,0] op_sel_hi:[1,1]
  s_waitcnt lgkmcnt(14)
  v_mfma_f32_16x16x32_f16 v[76:79], v[196:199], v[64:67], v[76:79]
  ds_read_b128 v[208:211], v31 offset:20480
  v_pk_mul_f16 v62, v40, v49 op_sel:[0,0] op_sel_hi:[1,1]
  v_pk_mul_f16 v63, v40, v49 op_sel:[0,1] op_sel_hi:[1,0]
  v_mfma_f32_16x16x32_f16 v[68:71], v[112:115], v[52:55], v[68:71]
  ds_read2_b32 v[236:237], v29 offset0:0 offset1:2
  ds_read2_b32 v[238:239], v29 offset0:64 offset1:66
  v_add_u32 v29, 2048, v29
  v_pk_mul_f16 v64, v40, v50 op_sel:[0,0] op_sel_hi:[1,1]
  v_pk_mul_f16 v65, v40, v50 op_sel:[0,1] op_sel_hi:[1,0]
  v_mfma_f32_16x16x32_f16 v[72:75], v[156:159], v[52:55], v[72:75]
  ds_read_b128 v[124:127], v28 offset:10240
  v_pk_mul_f16 v66, v41, v50 op_sel:[0,0] op_sel_hi:[1,1]
  v_pk_mul_f16 v67, v41, v50 op_sel:[0,1] op_sel_hi:[1,0]
  v_mfma_f32_16x16x32_f16 v[76:79], v[200:203], v[52:55], v[76:79]
  ds_read_b128 v[168:171], v28 offset:45504
  s_waitcnt lgkmcnt(8)
  v_cvt_pk_f16_f32 v43, v38, v39
  v_cvt_pk_f16_f32 v40, v32, v35
  v_smfmac_f32_16x16x64_f16 v[80:83], v[232:235], v[52:59], v16
  ds_read_b128 v[212:215], v31 offset:21504
  ds_read_b64_tr_b16 v[52:53], v8 offset:32
  ds_read_b64_tr_b16 v[54:55], v8 offset:544
  v_mfma_f32_16x16x32_f16 v[68:71], v[116:119], v[56:59], v[68:71]
  v_cvt_pk_f16_f32 v41, v33, v36
  v_cvt_pk_f16_f32 v42, v34, v37
  v_mfma_f32_16x16x32_f16 v[72:75], v[160:163], v[56:59], v[72:75]
  ds_write_b128 v10, v[40:43]
  s_waitcnt lgkmcnt(11)
  v_mfma_f32_16x16x32_f16 v[76:79], v[204:207], v[56:59], v[76:79]
  v_pk_mul_f16 v56, v40, v40 op_sel:[0,0] op_sel_hi:[1,1]
  v_pk_mul_f16 v57, v41, v41 op_sel:[0,0] op_sel_hi:[1,1]
  s_waitcnt lgkmcnt(10)
  v_mfma_f32_16x16x32_f16 v[68:71], v[120:123], v[60:63], v[68:71]
  v_pk_mul_f16 v58, v42, v42 op_sel:[0,0] op_sel_hi:[1,1]
  v_pk_mul_f16 v59, v40, v41 op_sel:[0,0] op_sel_hi:[1,1]
  s_waitcnt lgkmcnt(9)
  v_mfma_f32_16x16x32_f16 v[72:75], v[164:167], v[60:63], v[72:75]
  ds_read_b128 v[44:47], v11
  ds_read_b128 v[48:51], v12
  s_waitcnt lgkmcnt(10)
  v_mfma_f32_16x16x32_f16 v[76:79], v[208:211], v[60:63], v[76:79]
  v_or3_b32 v15, v56, v57, v58
  s_waitcnt lgkmcnt(8)
  v_smfmac_f32_16x16x64_f16 v[80:83], v[236:239], v[60:67], v16
  v_pk_mul_f16 v60, v40, v41 op_sel:[0,1] op_sel_hi:[1,0]
  v_pk_mul_f16 v61, v40, v42 op_sel:[0,0] op_sel_hi:[1,1]
  s_waitcnt lgkmcnt(7)
  v_mfma_f32_16x16x32_f16 v[68:71], v[124:127], v[64:67], v[68:71]
  v_pk_mul_f16 v62, v40, v42 op_sel:[0,1] op_sel_hi:[1,0]
  v_pk_mul_f16 v63, v41, v42 op_sel:[0,0] op_sel_hi:[1,1]
  s_waitcnt lgkmcnt(6)
  v_mfma_f32_16x16x32_f16 v[72:75], v[168:171], v[64:67], v[72:75]
  v_and_b32 v15, 0x60006000, v15
  v_cmp_ne_u32 s[90:91], 0, v15
  s_waitcnt lgkmcnt(5)
  v_mfma_f32_16x16x32_f16 v[76:79], v[212:215], v[64:67], v[76:79]
  v_add_f32 v22, v80, v81
  v_add_f32 v23, v82, v83
  ds_add_u32 v1, v3 offset:12
  s_branch L_grp1
L_prime:
  v_mov_b32 v68, 0
  v_mov_b32 v69, 0
  v_mov_b32 v70, 0
  v_mov_b32 v71, 0
  v_mov_b32 v72, 0
  v_mov_b32 v73, 0
  v_mov_b32 v74, 0
  v_mov_b32 v75, 0
  v_mov_b32 v76, 0
  v_mov_b32 v77, 0
  v_mov_b32 v78, 0
  v_mov_b32 v79, 0
  v_mov_b32 v80, 0
  v_mov_b32 v81, 0
  v_mov_b32 v82, 0
  v_mov_b32 v83, 0
  v_mov_b32 v22, 0
  v_mov_b32 v23, 0
  ds_read_u16_d16_hi v32, v7 offset:0
  ds_read_u16_d16_hi v33, v7 offset:128
  ds_read_u16_d16_hi v34, v7 offset:256
  ds_read_u16_d16_hi v35, v7 offset:384
  ds_read_u16_d16_hi v36, v7 offset:512
  ds_read_u16_d16_hi v37, v7 offset:640
  ds_read_u16_d16_hi v38, v7 offset:768
  ds_read_u16_d16_hi v39, v7 offset:896
  s_waitcnt lgkmcnt(0)
  v_cvt_pk_f16_f32 v43, v38, v39
  v_cvt_pk_f16_f32 v40, v32, v35
  v_cvt_pk_f16_f32 v41, v33, v36
  v_cvt_pk_f16_f32 v42, v34, v37
  ds_read_b64_tr_b16 v[52:53], v8 offset:0
  ds_read_b64_tr_b16 v[54:55], v8 offset:512
  ds_write_b128 v10, v[40:43]
  ds_read_b128 v[44:47], v11
  ds_read_b128 v[48:51], v12
  v_pk_mul_f16 v56, v40, v40 op_sel:[0,0] op_sel_hi:[1,1]
  v_pk_mul_f16 v57, v41, v41 op_sel:[0,0] op_sel_hi:[1,1]
  v_pk_mul_f16 v58, v42, v42 op_sel:[0,0] op_sel_hi:[1,1]
  v_pk_mul_f16 v59, v40, v41 op_sel:[0,0] op_sel_hi:[1,1]
  v_pk_mul_f16 v60, v40, v41 op_sel:[0,1] op_sel_hi:[1,0]
  v_pk_mul_f16 v61, v40, v42 op_sel:[0,0] op_sel_hi:[1,1]
  v_pk_mul_f16 v62, v40, v42 op_sel:[0,1] op_sel_hi:[1,0]
  v_pk_mul_f16 v63, v41, v42 op_sel:[0,0] op_sel_hi:[1,1]
  s_waitcnt lgkmcnt(0)
  v_alignbit_b32 v48, v48, v48, v13
  v_alignbit_b32 v49, v49, v49, v13
L_cin_loop:
  s_cmp_lg_u32 s84, 0
  s_cbranch_scc1 L_pr0
  s_setprio 2
L_pr0:
  v_mfma_f32_16x16x32_f16 v[80:83], v[216:219], v[56:59], 0
  v_fmac_f32 v14, v68, v72
  v_fmac_f32 v14, v69, v73
  v_fmac_f32 v14, v70, v74
  v_fmac_f32 v14, v71, v75
  v_mfma_f32_16x16x32_bf16 v[72:75], v[240:243], v[52:55], 0
  v_pk_mul_f16 v64, v41, v42 op_sel:[0,1] op_sel_hi:[1,0]
  v_pk_mul_f16 v65, v40, v43 op_sel:[0,0] op_sel_hi:[1,0]
  v_mfma_f32_16x16x32_f16 v[68:71], v[84:87], v[56:59], 0
  v_fmac_f32 v14, v76, v77
  v_fmac_f32 v14, v22, v78
  v_fmac_f32 v14, v23, v79
  v_mfma_f32_16x16x32_bf16 v[76:79], v[244:247], v[52:55], 0
  v_pk_mul_f16 v66, v41, v43 op_sel:[0,0] op_sel_hi:[1,0]
  v_pk_mul_f16 v67, v42, v43 op_sel:[0,0] op_sel_hi:[1,0]
  v_mfma_f32_16x16x32_f16 v[72:75], v[128:131], v[56:59], v[72:75]
  v_add_f32_dpp v14, v14, v14 row_shr:1 row_mask:0xf bank_mask:0xf
  v_alignbit_b32 v50, v50, v50, v13
  v_mfma_f32_16x16x32_f16 v[68:71], v[88:91], v[60:63], v[68:71]
  v_mul_f16_sdwa v52, v40, v40 dst_sel:WORD_0 dst_unused:UNUSED_PAD src0_sel:WORD_0 src1_sel:WORD_1
  v_mul_f16_sdwa v53, v42, v42 dst_sel:WORD_0 dst_unused:UNUSED_PAD src0_sel:WORD_0 src1_sel:WORD_1
  v_mfma_f32_16x16x32_f16 v[76:79], v[172:175], v[56:59], v[76:79]
  v_add_f32_dpp v14, v14, v14 row_shr:2 row_mask:0xf bank_mask:0xf
  v_mfma_f32_16x16x32_f16 v[72:75], v[132:135], v[60:63], v[72:75]
  v_mul_f16_sdwa v52, v41, v41 dst_sel:WORD_1 dst_unused:UNUSED_PRESERVE src0_sel:WORD_0 src1_sel:WORD_1
  v_mul_f16_sdwa v53, v43, v43 dst_sel:WORD_1 dst_unused:UNUSED_PRESERVE src0_sel:WORD_0 src1_sel:WORD_1
  v_mfma_f32_16x16x32_f16 v[68:71], v[92:95], v[64:67], v[68:71]
  v_add_f32_dpp v14, v14, v14 row_shr:4 row_mask:0xf bank_mask:0xf
  v_pk_mul_f16 v54, v40, v47 op_sel:[0,0] op_sel_hi:[1,0]
  v_mfma_f32_16x16x32_f16 v[76:79], v[176:179], v[60:63], v[76:79]
  v_pk_mul_f16 v55, v41, v47 op_sel:[0,0] op_sel_hi:[1,0]
  v_pk_mul_f16 v56, v42, v47 op_sel:[0,0] op_sel_hi:[1,0]
  v_smfmac_f32_16x16x64_f16 v[80:83], v[220:223], v[60:67], v16
  v_add_f32_dpp v14, v14, v14 row_shr:8 row_mask:0xf bank_mask:0xf
  v_pk_mul_f16 v57, v40, v44 op_sel:[0,0] op_sel_hi:[1,1]
  v_mfma_f32_16x16x32_f16 v[72:75], v[136:139], v[64:67], v[72:75]
  v_pk_mul_f16 v58, v40, v44 op_sel:[0,1] op_sel_hi:[1,0]
  v_pk_mul_f16 v59, v40, v45 op_sel:[0,0] op_sel_hi:[1,1]
  v_mfma_f32_16x16x32_f16 v[76:79], v[180:183], v[64:67], v[76:79]
  v_add_f32_dpp v14, v14, v14 row_bcast:15 row_mask:0xa bank_mask:0xf
  v_pk_mul_f16 v60, v40, v45 op_sel:[0,1] op_sel_hi:[1,0]
  v_mfma_f32_16x16x32_f16 v[68:71], v[96:99], v[52:55], v[68:71]
  v_pk_mul_f16 v61, v40, v46 op_sel:[0,0] op_sel_hi:[1,1]
  v_pk_mul_f16 v62, v40, v46 op_sel:[0,1] op_sel_hi:[1,0]
  v_mfma_f32_16x16x32_f16 v[72:75], v[140:143], v[52:55], v[72:75]
  v_add_f32_dpp v14, v14, v14 row_bcast:31 row_mask:0xc bank_mask:0xf
  v_pk_mul_f16 v63, v41, v44 op_sel:[0,0] op_sel_hi:[1,1]
  v_mfma_f32_16x16x32_f16 v[76:79], v[184:187], v[52:55], v[76:79]
  s_waitcnt vmcnt(0)
  s_cmp_le_u32 s72, 2
  s_cbranch_scc1 L_blk
  v_lshlrev_b32 v21, 7, v21
  buffer_load_dword v255, v21, s[32:35], 0 offen
  buffer_load_dword v21, v20, s[28:31], s77 offen
  s_cmp_eq_u32 s77, s73
  s_cselect_b32 s73, 0x7000000, s73
  s_cselect_b32 s77, 0x7000000, s77
  s_add_u32 s77, s77, 24
  s_min_u32 s77, s77, s73
  buffer_load_dword v255, v19, s[44:47], s101 offen
  s_add_u32 s101, s101, 1261568
L_blk:
  s_cmp_eq_u32 s50, 0
  s_cbranch_scc1 L_blkend
  v_readlane_b32 s81, v14, 63
  v_ldexp_f32 v14, v14, s49
  v_mov_b32 v22, s85
  s_cmp_eq_u32 s50, 2
  s_cbranch_scc1 L_good
  s_cmp_eq_u64 s[90:91], 0
  s_cbranch_scc1 L_slow
  s_bfe_u32 s81, s81, 0x80017
  s_cmp_eq_u32 s81, 255
  s_cbranch_scc1 L_slow
L_good:
  s_mov_b32 exec_lo, 0
  s_mov_b32 exec_hi, 0x80000000
  ds_write_b32 v22, v14
  s_mov_b64 exec, -1
  s_add_u32 s85, s85, 32
  s_sub_u32 s72, s72, 1
  s_cmp_eq_u32 s72, 0
  s_cbranch_scc1 L_cin_done
  s_cmp_eq_u32 s72, 1
  s_cbranch_scc1 L_nodma
  v_lshl_add_u32 v24, v24, 7, v18
  v_lshl_add_u32 v25, v25, 7, v18
  s_mov_b32 exec_hi, 0x0000ffff
  v_lshl_add_u32 v26, v26, 7, v18
  v_lshl_add_u32 v27, v27, 7, v18
  s_mov_b32 exec_lo, 0
  s_mov_b32 exec_hi, 0xffff0000
  v_mov_b32 v27, v25
  v_mov_b32 v26, v25
  s_mov_b32 exec_hi, 0x00ff0000
  v_mov_b32 v26, v24
  s_mov_b64 exec, -1
  s_add_u32 m0, s74, 0
  s_nop 0
  buffer_load_dwordx4 v24, s[32:35], 0 offen lds
  s_add_u32 m0, s74, 1056
  s_nop 0
  buffer_load_dwordx4 v25, s[32:35], 0 offen lds
  s_add_u32 m0, s74, 2112
  s_nop 0
  buffer_load_dwordx4 v26, s[32:35], 0 offen lds
  s_add_u32 m0, s74, 3168
  s_mov_b32 exec_hi, 0x00ffffff
  buffer_load_dwordx4 v27, s[32:35], 0 offen lds
  s_mov_b32 exec_hi, -1
  buffer_load_dwordx4 v[24:27], v17, s[28:31], s94 offen offset:0
  s_add_u32 s94, s94, 832
L_nodma:
  s_add_u32 s74, s74, s75
  s_sub_u32 s75, 0, s75
  s_mov_b32 s49, s48
  s_mov_b32 s97, 1
L_blkend:
  s_mov_b32 s50, s97
  v_pk_mul_f16 v64, v41, v44 op_sel:[0,1] op_sel_hi:[1,0]
  v_pk_mul_f16 v65, v41, v45 op_sel:[0,0] op_sel_hi:[1,1]
  v_smfmac_f32_16x16x64_f16 v[80:83], v[224:227], v[52:59], v16
  v_pk_mul_f16 v66, v41, v45 op_sel:[0,1] op_sel_hi:[1,0]
  v_pk_mul_f16 v67, v41, v46 op_sel:[0,0] op_sel_hi:[1,1]
  v_mfma_f32_16x16x32_f16 v[68:71], v[100:103], v[56:59], v[68:71]
  v_pk_mul_f16 v52, v41, v46 op_sel:[0,1] op_sel_hi:[1,0]
  v_pk_mul_f16 v53, v42, v44 op_sel:[0,0] op_sel_hi:[1,1]
  v_mfma_f32_16x16x32_f16 v[72:75], v[144:147], v[56:59], v[72:75]
  v_pk_mul_f16 v54, v42, v44 op_sel:[0,1] op_sel_hi:[1,0]
  v_pk_mul_f16 v55, v42, v45 op_sel:[0,0] op_sel_hi:[1,1]
  v_mfma_f32_16x16x32_f16 v[76:79], v[188:191], v[56:59], v[76:79]
  ds_read_u16_d16_hi v32, v7 offset:32
  ds_read_u16_d16_hi v33, v7 offset:160
  v_mfma_f32_16x16x32_f16 v[68:71], v[104:107], v[60:63], v[68:71]
  ds_read_u16_d16_hi v34, v7 offset:288
  ds_read_u16_d16_hi v35, v7 offset:416
  v_mfma_f32_16x16x32_f16 v[72:75], v[148:151], v[60:63], v[72:75]
  ds_read_u16_d16_hi v36, v7 offset:544
  ds_read_u16_d16_hi v37, v7 offset:672
  v_mfma_f32_16x16x32_f16 v[76:79], v[192:195], v[60:63], v[76:79]
  ds_read_u16_d16_hi v38, v7 offset:800
  ds_read_u16_d16_hi v39, v7 offset:928
  v_smfmac_f32_16x16x64_f16 v[80:83], v[228:231], v[60:67], v16
  v_pk_mul_f16 v56, v42, v45 op_sel:[0,1] op_sel_hi:[1,0]
  v_pk_mul_f16 v57, v42, v46 op_sel:[0,0] op_sel_hi:[1,1]
  v_mfma_f32_16x16x32_f16 v[68:71], v[108:111], v[64:67], v[68:71]
  v_pk_mul_f16 v58, v42, v46 op_sel:[0,1] op_sel_hi:[1,0]
  v_pk_mul_f16 v59, v40, v48 op_sel:[0,0] op_sel_hi:[1,1]
  v_mfma_f32_16x16x32_f16 v[72:75], v[152:155], v[64:67], v[72:75]
  v_pk_mul_f16 v60, v41, v49 op_sel:[0,0] op_sel_hi:[1,1]
  v_pk_mul_f16 v61, v42, v50 op_sel:[0,0] op_sel_hi:[1,1]
  v_mfma_f32_16x16x32_f16 v[76:79], v[196:199], v[64:67], v[76:79]
  v_pk_mul_f16 v62, v40, v49 op_sel:[0,0] op_sel_hi:[1,1]
  v_pk_mul_f16 v63, v40, v49 op_sel:[0,1] op_sel_hi:[1,0]
  v_mfma_f32_16x16x32_f16 v[68:71], v[112:115], v[52:55], v[68:71]
  v_pk_mul_f16 v64, v40, v50 op_sel:[0,0] op_sel_hi:[1,1]
  v_pk_mul_f16 v65, v40, v50 op_sel:[0,1] op_sel_hi:[1,0]
  v_mfma_f32_16x16x32_f16 v[72:75], v[156:159], v[52:55], v[72:75]
  v_pk_mul_f16 v66, v41, v50 op_sel:[0,0] op_sel_hi:[1,1]
  v_pk_mul_f16 v67, v41, v50 op_sel:[0,1] op_sel_hi:[1,0]
  v_mfma_f32_16x16x32_f16 v[76:79], v[200:203], v[52:55], v[76:79]
  s_waitcnt lgkmcnt(0)
  v_cvt_pk_f16_f32 v43, v38, v39
  v_cvt_pk_f16_f32 v40, v32, v35
  v_smfmac_f32_16x16x64_f16 v[80:83], v[232:235], v[52:59], v16
  ds_read_b64_tr_b16 v[52:53], v8 offset:32
  ds_read_b64_tr_b16 v[54:55], v8 offset:544
  v_mfma_f32_16x16x32_f16 v[68:71], v[116:119], v[56:59], v[68:71]
  v_cvt_pk_f16_f32 v41, v33, v36
  v_cvt_pk_f16_f32 v42, v34, v37
  v_mfma_f32_16x16x32_f16 v[72:75], v[160:163], v[56:59], v[72:75]
  ds_write_b128 v10, v[40:43]
  v_mfma_f32_16x16x32_f16 v[76:79], v[204:207], v[56:59], v[76:79]
  v_pk_mul_f16 v56, v40, v40 op_sel:[0,0] op_sel_hi:[1,1]
  v_pk_mul_f16 v57, v41, v41 op_sel:[0,0] op_sel_hi:[1,1]
  v_mfma_f32_16x16x32_f16 v[68:71], v[120:123], v[60:63], v[68:71]
  v_pk_mul_f16 v58, v42, v42 op_sel:[0,0] op_sel_hi:[1,1]
  v_pk_mul_f16 v59, v40, v41 op_sel:[0,0] op_sel_hi:[1,1]
  v_mfma_f32_16x16x32_f16 v[72:75], v[164:167], v[60:63], v[72:75]
  ds_read_b128 v[44:47], v11
  ds_read_b128 v[48:51], v12
  v_mfma_f32_16x16x32_f16 v[76:79], v[208:211], v[60:63], v[76:79]
  v_or3_b32 v15, v56, v57, v58
  v_smfmac_f32_16x16x64_f16 v[80:83], v[236:239], v[60:67], v16
  v_pk_mul_f16 v60, v40, v41 op_sel:[0,1] op_sel_hi:[1,0]
  v_pk_mul_f16 v61, v40, v42 op_sel:[0,0] op_sel_hi:[1,1]
  v_mfma_f32_16x16x32_f16 v[68:71], v[124:127], v[64:67], v[68:71]
  v_pk_mul_f16 v62, v40, v42 op_sel:[0,1] op_sel_hi:[1,0]
  v_pk_mul_f16 v63, v41, v42 op_sel:[0,0] op_sel_hi:[1,1]
  v_mfma_f32_16x16x32_f16 v[72:75], v[168:171], v[64:67], v[72:75]
  v_and_b32 v15, 0x60006000, v15
  v_cmp_ne_u32 s[90:91], 0, v15
  v_mfma_f32_16x16x32_f16 v[76:79], v[212:215], v[64:67], v[76:79]
  v_add_f32 v22, v80, v81
  v_add_f32 v23, v82, v83
L_grp1:
  v_mfma_f32_16x16x32_f16 v[80:83], v[216:219], v[56:59], 0
  s_nop 1
  v_mul_f32 v14, v68, v72
  v_fmac_f32 v14, v69, v73
  v_fmac_f32 v14, v70, v74
  v_fmac_f32 v14, v71, v75
  s_waitcnt lgkmcnt(3)
  v_mfma_f32_16x16x32_bf16 v[72:75], v[240:243], v[52:55], 0
  v_pk_mul_f16 v64, v41, v42 op_sel:[0,1] op_sel_hi:[1,0]
  v_pk_mul_f16 v65, v40, v43 op_sel:[0,0] op_sel_hi:[1,0]
  v_mfma_f32_16x16x32_f16 v[68:71], v[84:87], v[56:59], 0
  v_fmac_f32 v14, v76, v77
  v_fmac_f32 v14, v22, v78
  v_fmac_f32 v14, v23, v79
  v_mfma_f32_16x16x32_bf16 v[76:79], v[244:247], v[52:55], 0
  v_pk_mul_f16 v66, v41, v43 op_sel:[0,0] op_sel_hi:[1,0]
  v_pk_mul_f16 v67, v42, v43 op_sel:[0,0] op_sel_hi:[1,0]
  v_mfma_f32_16x16x32_f16 v[72:75], v[128:131], v[56:59], v[72:75]
  v_mul_f16_sdwa v52, v40, v40 dst_sel:WORD_0 dst_unused:UNUSED_PAD src0_sel:WORD_0 src1_sel:WORD_1
  v_mul_f16_sdwa v53, v42, v42 dst_sel:WORD_0 dst_unused:UNUSED_PAD src0_sel:WORD_0 src1_sel:WORD_1
  v_mfma_f32_16x16x32_f16 v[68:71], v[88:91], v[60:63], v[68:71]
  v_mul_f16_sdwa v52, v41, v41 dst_sel:WORD_1 dst_unused:UNUSED_PRESERVE src0_sel:WORD_0 src1_sel:WORD_1
  v_mul_f16_sdwa v53, v43, v43 dst_sel:WORD_1 dst_unused:UNUSED_PRESERVE src0_sel:WORD_0 src1_sel:WORD_1
  v_mfma_f32_16x16x32_f16 v[76:79], v[172:175], v[56:59], v[76:79]
  s_waitcnt lgkmcnt(1)
  v_pk_mul_f16 v54, v40, v47 op_sel:[0,0] op_sel_hi:[1,0]
  v_pk_mul_f16 v55, v41, v47 op_sel:[0,0] op_sel_hi:[1,0]
  v_mfma_f32_16x16x32_f16 v[72:75], v[132:135], v[60:63], v[72:75]
  v_pk_mul_f16 v56, v42, v47 op_sel:[0,0] op_sel_hi:[1,0]
  v_pk_mul_f16 v57, v40, v44 op_sel:[0,0] op_sel_hi:[1,1]
  v_mfma_f32_16x16x32_f16 v[68:71], v[92:95], v[64:67], v[68:71]
  v_pk_mul_f16 v58, v40, v44 op_sel:[0,1] op_sel_hi:[1,0]
  v_pk_mul_f16 v59, v40, v45 op_sel:[0,0] op_sel_hi:[1,1]
  v_mfma_f32_16x16x32_f16 v[76:79], v[176:179], v[60:63], v[76:79]
  s_waitcnt lgkmcnt(0)
  v_alignbit_b32 v48, v48, v48, v13
  v_alignbit_b32 v49, v49, v49, v13
  v_smfmac_f32_16x16x64_f16 v[80:83], v[220:223], v[60:67], v16
  v_pk_mul_f16 v60, v40, v45 op_sel:[0,1] op_sel_hi:[1,0]
  v_pk_mul_f16 v61, v40, v46 op_sel:[0,0] op_sel_hi:[1,1]
  v_mfma_f32_16x16x32_f16 v[72:75], v[136:139], v[64:67], v[72:75]
  v_pk_mul_f16 v62, v40, v46 op_sel:[0,1] op_sel_hi:[1,0]
  v_pk_mul_f16 v63, v41, v44 op_sel:[0,0] op_sel_hi:[1,1]
  v_mfma_f32_16x16x32_f16 v[76:79], v[180:183], v[64:67], v[76:79]
  v_alignbit_b32 v50, v50, v50, v13
  v_pk_mul_f16 v64, v41, v44 op_sel:[0,1] op_sel_hi:[1,0]
  v_mfma_f32_16x16x32_f16 v[68:71], v[96:99], v[52:55], v[68:71]
  v_pk_mul_f16 v65, v41, v45 op_sel:[0,0] op_sel_hi:[1,1]
  v_pk_mul_f16 v66, v41, v45 op_sel:[0,1] op_sel_hi:[1,0]
  v_mfma_f32_16x16x32_f16 v[72:75], v[140:143], v[52:55], v[72:75]
  v_pk_mul_f16 v67, v41, v46 op_sel:[0,0] op_sel_hi:[1,1]
  ds_read_u16_d16_hi v32, v7 offset:64
  v_mfma_f32_16x16x32_f16 v[76:79], v[184:187], v[52:55], v[76:79]
  ds_read_u16_d16_hi v33, v7 offset:192
  ds_read_u16_d16_hi v34, v7 offset:320
  v_smfmac_f32_16x16x64_f16 v[80:83], v[224:227], v[52:59], v16
  v_pk_mul_f16 v52, v41, v46 op_sel:[0,1] op_sel_hi:[1,0]
  v_pk_mul_f16 v53, v42, v44 op_sel:[0,0] op_sel_hi:[1,1]
  v_mfma_f32_16x16x32_f16 v[68:71], v[100:103], v[56:59], v[68:71]
  v_pk_mul_f16 v54, v42, v44 op_sel:[0,1] op_sel_hi:[1,0]
  v_pk_mul_f16 v55, v42, v45 op_sel:[0,0] op_sel_hi:[1,1]
  v_mfma_f32_16x16x32_f16 v[72:75], v[144:147], v[56:59], v[72:75]
  ds_read_u16_d16_hi v35, v7 offset:448
  ds_read_u16_d16_hi v36, v7 offset:576
  v_mfma_f32_16x16x32_f16 v[76:79], v[188:191], v[56:59], v[76:79]
  ds_read_u16_d16_hi v37, v7 offset:704
  ds_read_u16_d16_hi v38, v7 offset:832
  v_mfma_f32_16x16x32_f16 v[68:71], v[104:107], v[60:63], v[68:71]
  ds_read_u16_d16_hi v39, v7 offset:960
  v_pk_mul_f16 v56, v42, v45 op_sel:[0,1] op_sel_hi:[1,0]
  v_mfma_f32_16x16x32_f16 v[72:75], v[148:151], v[60:63], v[72:75]
  v_pk_mul_f16 v57, v42, v46 op_sel:[0,0] op_sel_hi:[1,1]
  v_pk_mul_f16 v58, v42, v46 op_sel:[0,1] op_sel_hi:[1,0]
  v_mfma_f32_16x16x32_f16 v[76:79], v[192:195], v[60:63], v[76:79]
  v_pk_mul_f16 v59, v40, v48 op_sel:[0,0] op_sel_hi:[1,1]
  v_smfmac_f32_16x16x64_f16 v[80:83], v[228:231], v[60:67], v16
  v_pk_mul_f16 v60, v41, v49 op_sel:[0,0] op_sel_hi:[1,1]
  v_pk_mul_f16 v61, v42, v50 op_sel:[0,0] op_sel_hi:[1,1]
  v_mfma_f32_16x16x32_f16 v[68:71], v[108:111], v[64:67], v[68:71]
  v_pk_mul_f16 v62, v40, v49 op_sel:[0,0] op_sel_hi:[1,1]
  v_pk_mul_f16 v63, v40, v49 op_sel:[0,1] op_sel_hi:[1,0]
  v_mfma_f32_16x16x32_f16 v[72:75], v[152:155], v[64:67], v[72:75]
  v_mfma_f32_16x16x32_f16 v[76:79], v[196:199], v[64:67], v[76:79]
  v_pk_mul_f16 v64, v40, v50 op_sel:[0,0] op_sel_hi:[1,1]
  v_pk_mul_f16 v65, v40, v50 op_sel:[0,1] op_sel_hi:[1,0]
  v_mfma_f32_16x16x32_f16 v[68:71], v[112:115], v[52:55], v[68:71]
  v_pk_mul_f16 v66, v41, v50 op_sel:[0,0] op_sel_hi:[1,1]
  v_pk_mul_f16 v67, v41, v50 op_sel:[0,1] op_sel_hi:[1,0]
  v_mfma_f32_16x16x32_f16 v[72:75], v[156:159], v[52:55], v[72:75]
  s_waitcnt lgkmcnt(0)
  v_cvt_pk_f16_f32 v43, v38, v39
  v_cvt_pk_f16_f32 v40, v32, v35
  v_mfma_f32_16x16x32_f16 v[76:79], v[200:203], v[52:55], v[76:79]
  v_cvt_pk_f16_f32 v41, v33, v36
  v_cvt_pk_f16_f32 v42, v34, v37
  v_smfmac_f32_16x16x64_f16 v[80:83], v[232:235], v[52:59], v16
  ds_read_b64_tr_b16 v[52:53], v8 offset:64
  ds_read_b64_tr_b16 v[54:55], v8 offset:576
  v_mfma_f32_16x16x32_f16 v[68:71], v[116:119], v[56:59], v[68:71]
  ds_write_b128 v10, v[40:43]
  v_mfma_f32_16x16x32_f16 v[72:75], v[160:163], v[56:59], v[72:75]
  ds_read_b128 v[44:47], v11
  ds_read_b128 v[48:51], v12
  v_mfma_f32_16x16x32_f16 v[76:79], v[204:207], v[56:59], v[76:79]
  v_pk_mul_f16 v56, v40, v40 op_sel:[0,0] op_sel_hi:[1,1]
  v_pk_mul_f16 v57, v41, v41 op_sel:[0,0] op_sel_hi:[1,1]
  v_mfma_f32_16x16x32_f16 v[68:71], v[120:123], v[60:63], v[68:71]
  v_pk_mul_f16 v58, v42, v42 op_sel:[0,0] op_sel_hi:[1,1]
  v_pk_mul_f16 v59, v40, v41 op_sel:[0,0] op_sel_hi:[1,1]
  v_mfma_f32_16x16x32_f16 v[72:75], v[164:167], v[60:63], v[72:75]
  v_mfma_f32_16x16x32_f16 v[76:79], v[208:211], v[60:63], v[76:79]
  v_smfmac_f32_16x16x64_f16 v[80:83], v[236:239], v[60:67], v16
  v_pk_mul_f16 v60, v40, v41 op_sel:[0,1] op_sel_hi:[1,0]
  v_pk_mul_f16 v61, v40, v42 op_sel:[0,0] op_sel_hi:[1,1]
  v_mfma_f32_16x16x32_f16 v[68:71], v[124:127], v[64:67], v[68:71]
  v_pk_mul_f16 v62, v40, v42 op_sel:[0,1] op_sel_hi:[1,0]
  v_pk_mul_f16 v63, v41, v42 op_sel:[0,0] op_sel_hi:[1,1]
  v_mfma_f32_16x16x32_f16 v[72:75], v[168:171], v[64:67], v[72:75]
  s_waitcnt lgkmcnt(0)
  v_alignbit_b32 v48, v48, v48, v13
  v_alignbit_b32 v49, v49, v49, v13
  v_mfma_f32_16x16x32_f16 v[76:79], v[212:215], v[64:67], v[76:79]
  v_add_f32 v22, v80, v81
  v_add_f32 v23, v82, v83
  v_mfma_f32_16x16x32_f16 v[80:83], v[216:219], v[56:59], 0
  s_nop 0
  v_fmac_f32 v14, v68, v72
  v_fmac_f32 v14, v69, v73
  v_fmac_f32 v14, v70, v74
  v_fmac_f32 v14, v71, v75
  v_mfma_f32_16x16x32_bf16 v[72:75], v[240:243], v[52:55], 0
  v_pk_mul_f16 v64, v41, v42 op_sel:[0,1] op_sel_hi:[1,0]
  v_pk_mul_f16 v65, v40, v43 op_sel:[0,0] op_sel_hi:[1,0]
  v_mfma_f32_16x16x32_f16 v[68:71], v[84:87], v[56:59], 0
  v_fmac_f32 v14, v76, v77
  v_fmac_f32 v14, v22, v78
  v_fmac_f32 v14, v23, v79
  v_mfma_f32_16x16x32_bf16 v[76:79], v[244:247], v[52:55], 0
  v_pk_mul_f16 v66, v41, v43 op_sel:[0,0] op_sel_hi:[1,0]
  v_pk_mul_f16 v67, v42, v43 op_sel:[0,0] op_sel_hi:[1,0]
  v_mfma_f32_16x16x32_f16 v[72:75], v[128:131], v[56:59], v[72:75]
  v_mul_f16_sdwa v52, v40, v40 dst_sel:WORD_0 dst_unused:UNUSED_PAD src0_sel:WORD_0 src1_sel:WORD_1
  v_mul_f16_sdwa v53, v42, v42 dst_sel:WORD_0 dst_unused:UNUSED_PAD src0_sel:WORD_0 src1_sel:WORD_1
  v_mfma_f32_16x16x32_f16 v[68:71], v[88:91], v[60:63], v[68:71]
  v_mul_f16_sdwa v52, v41, v41 dst_sel:WORD_1 dst_unused:UNUSED_PRESERVE src0_sel:WORD_0 src1_sel:WORD_1
  v_mul_f16_sdwa v53, v43, v43 dst_sel:WORD_1 dst_unused:UNUSED_PRESERVE src0_sel:WORD_0 src1_sel:WORD_1
  v_mfma_f32_16x16x32_f16 v[76:79], v[172:175], v[56:59], v[76:79]
  v_pk_mul_f16 v54, v40, v47 op_sel:[0,0] op_sel_hi:[1,0]
  v_pk_mul_f16 v55, v41, v47 op_sel:[0,0] op_sel_hi:[1,0]
  v_mfma_f32_16x16x32_f16 v[72:75], v[132:135], v[60:63], v[72:75]
  v_pk_mul_f16 v56, v42, v47 op_sel:[0,0] op_sel_hi:[1,0]
  v_pk_mul_f16 v57, v40, v44 op_sel:[0,0] op_sel_hi:[1,1]
  v_mfma_f32_16x16x32_f16 v[68:71], v[92:95], v[64:67], v[68:71]
  v_pk_mul_f16 v58, v40, v44 op_sel:[0,1] op_sel_hi:[1,0]
  v_pk_mul_f16 v59, v40, v45 op_sel:[0,0] op_sel_hi:[1,1]
  v_mfma_f32_16x16x32_f16 v[76:79], v[176:179], v[60:63], v[76:79]
  v_alignbit_b32 v50, v50, v50, v13
  ds_read_u16_d16_hi v32, v7 offset:96
  v_smfmac_f32_16x16x64_f16 v[80:83], v[220:223], v[60:67], v16
  v_pk_mul_f16 v60, v40, v45 op_sel:[0,1] op_sel_hi:[1,0]
  v_pk_mul_f16 v61, v40, v46 op_sel:[0,0] op_sel_hi:[1,1]
  v_mfma_f32_16x16x32_f16 v[72:75], v[136:139], v[64:67], v[72:75]
  v_pk_mul_f16 v62, v40, v46 op_sel:[0,1] op_sel_hi:[1,0]
  v_pk_mul_f16 v63, v41, v44 op_sel:[0,0] op_sel_hi:[1,1]
  v_mfma_f32_16x16x32_f16 v[76:79], v[180:183], v[64:67], v[76:79]
  v_pk_mul_f16 v64, v41, v44 op_sel:[0,1] op_sel_hi:[1,0]
  v_pk_mul_f16 v65, v41, v45 op_sel:[0,0] op_sel_hi:[1,1]
  v_mfma_f32_16x16x32_f16 v[68:71], v[96:99], v[52:55], v[68:71]
  v_pk_mul_f16 v66, v41, v45 op_sel:[0,1] op_sel_hi:[1,0]
  v_pk_mul_f16 v67, v41, v46 op_sel:[0,0] op_sel_hi:[1,1]
  v_mfma_f32_16x16x32_f16 v[72:75], v[140:143], v[52:55], v[72:75]
  ds_read_u16_d16_hi v33, v7 offset:224
  ds_read_u16_d16_hi v34, v7 offset:352
  v_mfma_f32_16x16x32_f16 v[76:79], v[184:187], v[52:55], v[76:79]
  ds_read_u16_d16_hi v35, v7 offset:480
  ds_read_u16_d16_hi v36, v7 offset:608
  v_smfmac_f32_16x16x64_f16 v[80:83], v[224:227], v[52:59], v16
  v_pk_mul_f16 v52, v41, v46 op_sel:[0,1] op_sel_hi:[1,0]
  v_pk_mul_f16 v53, v42, v44 op_sel:[0,0] op_sel_hi:[1,1]
  v_mfma_f32_16x16x32_f16 v[68:71], v[100:103], v[56:59], v[68:71]
  v_pk_mul_f16 v54, v42, v44 op_sel:[0,1] op_sel_hi:[1,0]
  v_pk_mul_f16 v55, v42, v45 op_sel:[0,0] op_sel_hi:[1,1]
  v_mfma_f32_16x16x32_f16 v[72:75], v[144:147], v[56:59], v[72:75]
  ds_read_u16_d16_hi v37, v7 offset:736
  ds_read_u16_d16_hi v38, v7 offset:864
  v_mfma_f32_16x16x32_f16 v[76:79], v[188:191], v[56:59], v[76:79]
  ds_read_u16_d16_hi v39, v7 offset:992
  v_pk_mul_f16 v56, v42, v45 op_sel:[0,1] op_sel_hi:[1,0]
  v_mfma_f32_16x16x32_f16 v[68:71], v[104:107], v[60:63], v[68:71]
  v_pk_mul_f16 v57, v42, v46 op_sel:[0,0] op_sel_hi:[1,1]
  v_pk_mul_f16 v58, v42, v46 op_sel:[0,1] op_sel_hi:[1,0]
  v_mfma_f32_16x16x32_f16 v[72:75], v[148:151], v[60:63], v[72:75]
  v_pk_mul_f16 v59, v40, v48 op_sel:[0,0] op_sel_hi:[1,1]
  v_mfma_f32_16x16x32_f16 v[76:79], v[192:195], v[60:63], v[76:79]
  v_smfmac_f32_16x16x64_f16 v[80:83], v[228:231], v[60:67], v16
  v_pk_mul_f16 v60, v41, v49 op_sel:[0,0] op_sel_hi:[1,1]
  v_pk_mul_f16 v61, v42, v50 op_sel:[0,0] op_sel_hi:[1,1]
  v_mfma_f32_16x16x32_f16 v[68:71], v[108:111], v[64:67], v[68:71]
  v_pk_mul_f16 v62, v40, v49 op_sel:[0,0] op_sel_hi:[1,1]
  v_pk_mul_f16 v63, v40, v49 op_sel:[0,1] op_sel_hi:[1,0]
  v_mfma_f32_16x16x32_f16 v[72:75], v[152:155], v[64:67], v[72:75]
  v_mfma_f32_16x16x32_f16 v[76:79], v[196:199], v[64:67], v[76:79]
  v_pk_mul_f16 v64, v40, v50 op_sel:[0,0] op_sel_hi:[1,1]
  v_pk_mul_f16 v65, v40, v50 op_sel:[0,1] op_sel_hi:[1,0]
  v_mfma_f32_16x16x32_f16 v[68:71], v[112:115], v[52:55], v[68:71]
  v_pk_mul_f16 v66, v41, v50 op_sel:[0,0] op_sel_hi:[1,1]
  v_pk_mul_f16 v67, v41, v50 op_sel:[0,1] op_sel_hi:[1,0]
  v_mfma_f32_16x16x32_f16 v[72:75], v[156:159], v[52:55], v[72:75]
  s_waitcnt lgkmcnt(0)
  v_cvt_pk_f16_f32 v43, v38, v39
  v_cvt_pk_f16_f32 v40, v32, v35
  v_mfma_f32_16x16x32_f16 v[76:79], v[200:203], v[52:55], v[76:79]
  v_cvt_pk_f16_f32 v41, v33, v36
  v_cvt_pk_f16_f32 v42, v34, v37
  v_smfmac_f32_16x16x64_f16 v[80:83], v[232:235], v[52:59], v16
  ds_read_b64_tr_b16 v[52:53], v8 offset:96
  ds_read_b64_tr_b16 v[54:55], v8 offset:608
  v_mfma_f32_16x16x32_f16 v[68:71], v[116:119], v[56:59], v[68:71]
  ds_write_b128 v10, v[40:43]
  v_mfma_f32_16x16x32_f16 v[72:75], v[160:163], v[56:59], v[72:75]
  ds_read_b128 v[44:47], v11
  ds_read_b128 v[48:51], v12
  v_mfma_f32_16x16x32_f16 v[76:79], v[204:207], v[56:59], v[76:79]
  v_pk_mul_f16 v56, v40, v40 op_sel:[0,0] op_sel_hi:[1,1]
  v_pk_mul_f16 v57, v41, v41 op_sel:[0,0] op_sel_hi:[1,1]
  v_mfma_f32_16x16x32_f16 v[68:71], v[120:123], v[60:63], v[68:71]
  v_pk_mul_f16 v58, v42, v42 op_sel:[0,0] op_sel_hi:[1,1]
  v_pk_mul_f16 v59, v40, v41 op_sel:[0,0] op_sel_hi:[1,1]
  v_mfma_f32_16x16x32_f16 v[72:75], v[164:167], v[60:63], v[72:75]
  v_mfma_f32_16x16x32_f16 v[76:79], v[208:211], v[60:63], v[76:79]
  v_smfmac_f32_16x16x64_f16 v[80:83], v[236:239], v[60:67], v16
  v_pk_mul_f16 v60, v40, v41 op_sel:[0,1] op_sel_hi:[1,0]
  v_pk_mul_f16 v61, v40, v42 op_sel:[0,0] op_sel_hi:[1,1]
  v_mfma_f32_16x16x32_f16 v[68:71], v[124:127], v[64:67], v[68:71]
  v_pk_mul_f16 v62, v40, v42 op_sel:[0,1] op_sel_hi:[1,0]
  v_pk_mul_f16 v63, v41, v42 op_sel:[0,0] op_sel_hi:[1,1]
  v_mfma_f32_16x16x32_f16 v[72:75], v[168:171], v[64:67], v[72:75]
  s_waitcnt lgkmcnt(0)
  v_alignbit_b32 v48, v48, v48, v13
  v_alignbit_b32 v49, v49, v49, v13
  v_mfma_f32_16x16x32_f16 v[76:79], v[212:215], v[64:67], v[76:79]
  v_add_f32 v22, v80, v81
  v_add_f32 v23, v82, v83
  s_cmp_lg_u32 s84, 0
  s_cbranch_scc1 L_pr123
  s_setprio 0
L_pr123:
  v_mfma_f32_16x16x32_f16 v[80:83], v[216:219], v[56:59], 0
  v_fmac_f32 v14, v68, v72
  v_fmac_f32 v14, v69, v73
  v_fmac_f32 v14, v70, v74
  v_fmac_f32 v14, v71, v75
  v_mfma_f32_16x16x32_bf16 v[72:75], v[240:243], v[52:55], 0
  v_pk_mul_f16 v64, v41, v42 op_sel:[0,1] op_sel_hi:[1,0]
  v_pk_mul_f16 v65, v40, v43 op_sel:[0,0] op_sel_hi:[1,0]
  v_mfma_f32_16x16x32_f16 v[68:71], v[84:87], v[56:59], 0
  v_fmac_f32 v14, v76, v77
  v_fmac_f32 v14, v22, v78
  v_fmac_f32 v14, v23, v79
  v_mfma_f32_16x16x32_bf16 v[76:79], v[244:247], v[52:55], 0
  v_pk_mul_f16 v66, v41, v43 op_sel:[0,0] op_sel_hi:[1,0]
  v_pk_mul_f16 v67, v42, v43 op_sel:[0,0] op_sel_hi:[1,0]
  v_mfma_f32_16x16x32_f16 v[72:75], v[128:131], v[56:59], v[72:75]
  v_mul_f16_sdwa v52, v40, v40 dst_sel:WORD_0 dst_unused:UNUSED_PAD src0_sel:WORD_0 src1_sel:WORD_1
  v_mul_f16_sdwa v53, v42, v42 dst_sel:WORD_0 dst_unused:UNUSED_PAD src0_sel:WORD_0 src1_sel:WORD_1
  v_mfma_f32_16x16x32_f16 v[68:71], v[88:91], v[60:63], v[68:71]
  v_mul_f16_sdwa v52, v41, v41 dst_sel:WORD_1 dst_unused:UNUSED_PRESERVE src0_sel:WORD_0 src1_sel:WORD_1
  v_mul_f16_sdwa v53, v43, v43 dst_sel:WORD_1 dst_unused:UNUSED_PRESERVE src0_sel:WORD_0 src1_sel:WORD_1
  v_mfma_f32_16x16x32_f16 v[76:79], v[172:175], v[56:59], v[76:79]
  v_add_u32 v7, s75, v7
  s_waitcnt vmcnt(1)
  v_pk_mul_f16 v54, v40, v47 op_sel:[0,0] op_sel_hi:[1,0]
  v_mfma_f32_16x16x32_f16 v[72:75], v[132:135], v[60:63], v[72:75]
  v_pk_mul_f16 v55, v41, v47 op_sel:[0,0] op_sel_hi:[1,0]
  v_pk_mul_f16 v56, v42, v47 op_sel:[0,0] op_sel_hi:[1,0]
  v_mfma_f32_16x16x32_f16 v[68:71], v[92:95], v[64:67], v[68:71]
  v_pk_mul_f16 v57, v40, v44 op_sel:[0,0] op_sel_hi:[1,1]
  v_pk_mul_f16 v58, v40, v44 op_sel:[0,1] op_sel_hi:[1,0]
  v_mfma_f32_16x16x32_f16 v[76:79], v[176:179], v[60:63], v[76:79]
  v_pk_mul_f16 v59, v40, v45 op_sel:[0,0] op_sel_hi:[1,1]
  v_alignbit_b32 v50, v50, v50, v13
  v_smfmac_f32_16x16x64_f16 v[80:83], v[220:223], v[60:67], v16
  v_pk_mul_f16 v60, v40, v45 op_sel:[0,1] op_sel_hi:[1,0]
  v_pk_mul_f16 v61, v40, v46 op_sel:[0,0] op_sel_hi:[1,1]
  v_mfma_f32_16x16x32_f16 v[72:75], v[136:139], v[64:67], v[72:75]
  v_pk_mul_f16 v62, v40, v46 op_sel:[0,1] op_sel_hi:[1,0]
  v_pk_mul_f16 v63, v41, v44 op_sel:[0,0] op_sel_hi:[1,1]
  v_mfma_f32_16x16x32_f16 v[76:79], v[180:183], v[64:67], v[76:79]
  v_pk_mul_f16 v64, v41, v44 op_sel:[0,1] op_sel_hi:[1,0]
  v_pk_mul_f16 v65, v41, v45 op_sel:[0,0] op_sel_hi:[1,1]
  v_mfma_f32_16x16x32_f16 v[68:71], v[96:99], v[52:55], v[68:71]
  v_pk_mul_f16 v66, v41, v45 op_sel:[0,1] op_sel_hi:[1,0]
  v_pk_mul_f16 v67, v41, v46 op_sel:[0,0] op_sel_hi:[1,1]
  v_mfma_f32_16x16x32_f16 v[72:75], v[140:143], v[52:55], v[72:75]
  ds_read_u16_d16_hi v32, v7 offset:0
  ds_read_u16_d16_hi v33, v7 offset:128
  v_mfma_f32_16x16x32_f16 v[76:79], v[184:187], v[52:55], v[76:79]
  ds_read_u16_d16_hi v34, v7 offset:256
  ds_read_u16_d16_hi v35, v7 offset:384
  v_smfmac_f32_16x16x64_f16 v[80:83], v[224:227], v[52:59], v16
  v_pk_mul_f16 v52, v41, v46 op_sel:[0,1] op_sel_hi:[1,0]
  v_pk_mul_f16 v53, v42, v44 op_sel:[0,0] op_sel_hi:[1,1]
  v_mfma_f32_16x16x32_f16 v[68:71], v[100:103], v[56:59], v[68:71]
  v_pk_mul_f16 v54, v42, v44 op_sel:[0,1] op_sel_hi:[1,0]
  v_pk_mul_f16 v55, v42, v45 op_sel:[0,0] op_sel_hi:[1,1]
  v_mfma_f32_16x16x32_f16 v[72:75], v[144:147], v[56:59], v[72:75]
  ds_read_u16_d16_hi v36, v7 offset:512
  ds_read_u16_d16_hi v37, v7 offset:640
  v_mfma_f32_16x16x32_f16 v[76:79], v[188:191], v[56:59], v[76:79]
  ds_read_u16_d16_hi v38, v7 offset:768
  ds_read_u16_d16_hi v39, v7 offset:896
  v_mfma_f32_16x16x32_f16 v[68:71], v[104:107], v[60:63], v[68:71]
  v_pk_mul_f16 v56, v42, v45 op_sel:[0,1] op_sel_hi:[1,0]
  v_pk_mul_f16 v57, v42, v46 op_sel:[0,0] op_sel_hi:[1,1]
  v_mfma_f32_16x16x32_f16 v[72:75], v[148:151], v[60:63], v[72:75]
  v_pk_mul_f16 v58, v42, v46 op_sel:[0,1] op_sel_hi:[1,0]
  v_pk_mul_f16 v59, v40, v48 op_sel:[0,0] op_sel_hi:[1,1]
  v_mfma_f32_16x16x32_f16 v[76:79], v[192:195], v[60:63], v[76:79]
  s_add_u32 s81, s74, s75
  v_add_u32 v8, s81, v9
  v_smfmac_f32_16x16x64_f16 v[80:83], v[228:231], v[60:67], v16
  v_pk_mul_f16 v60, v41, v49 op_sel:[0,0] op_sel_hi:[1,1]
  v_pk_mul_f16 v61, v42, v50 op_sel:[0,0] op_sel_hi:[1,1]
  v_mfma_f32_16x16x32_f16 v[68:71], v[108:111], v[64:67], v[68:71]
  v_pk_mul_f16 v62, v40, v49 op_sel:[0,0] op_sel_hi:[1,1]
  v_pk_mul_f16 v63, v40, v49 op_sel:[0,1] op_sel_hi:[1,0]
  v_mfma_f32_16x16x32_f16 v[72:75], v[152:155], v[64:67], v[72:75]
  v_mfma_f32_16x16x32_f16 v[76:79], v[196:199], v[64:67], v[76:79]
  v_pk_mul_f16 v64, v40, v50 op_sel:[0,0] op_sel_hi:[1,1]
  v_pk_mul_f16 v65, v40, v50 op_sel:[0,1] op_sel_hi:[1,0]
  v_mfma_f32_16x16x32_f16 v[68:71], v[112:115], v[52:55], v[68:71]
  v_pk_mul_f16 v66, v41, v50 op_sel:[0,0] op_sel_hi:[1,1]
  v_pk_mul_f16 v67, v41, v50 op_sel:[0,1] op_sel_hi:[1,0]
  v_mfma_f32_16x16x32_f16 v[72:75], v[156:159], v[52:55], v[72:75]
  s_waitcnt lgkmcnt(0)
  v_cvt_pk_f16_f32 v43, v38, v39
  v_cvt_pk_f16_f32 v40, v32, v35
  v_mfma_f32_16x16x32_f16 v[76:79], v[200:203], v[52:55], v[76:79]
  v_cvt_pk_f16_f32 v41, v33, v36
  v_cvt_pk_f16_f32 v42, v34, v37
  v_smfmac_f32_16x16x64_f16 v[80:83], v[232:235], v[52:59], v16
  ds_read_b64_tr_b16 v[52:53], v8 offset:0
  ds_read_b64_tr_b16 v[54:55], v8 offset:512
  v_mfma_f32_16x16x32_f16 v[68:71], v[116:119], v[56:59], v[68:71]
  ds_write_b128 v10, v[40:43]
  v_mfma_f32_16x16x32_f16 v[72:75], v[160:163], v[56:59], v[72:75]
  ds_read_b128 v[44:47], v11
  ds_read_b128 v[48:51], v12
  v_mfma_f32_16x16x32_f16 v[76:79], v[204:207], v[56:59], v[76:79]
  v_pk_mul_f16 v56, v40, v40 op_sel:[0,0] op_sel_hi:[1,1]
  v_pk_mul_f16 v57, v41, v41 op_sel:[0,0] op_sel_hi:[1,1]
  v_mfma_f32_16x16x32_f16 v[68:71], v[120:123], v[60:63], v[68:71]
  v_pk_mul_f16 v58, v42, v42 op_sel:[0,0] op_sel_hi:[1,1]
  v_pk_mul_f16 v59, v40, v41 op_sel:[0,0] op_sel_hi:[1,1]
  v_mfma_f32_16x16x32_f16 v[72:75], v[164:167], v[60:63], v[72:75]
  v_mfma_f32_16x16x32_f16 v[76:79], v[208:211], v[60:63], v[76:79]
  v_smfmac_f32_16x16x64_f16 v[80:83], v[236:239], v[60:67], v16
  v_pk_mul_f16 v60, v40, v41 op_sel:[0,1] op_sel_hi:[1,0]
  v_pk_mul_f16 v61, v40, v42 op_sel:[0,0] op_sel_hi:[1,1]
  v_mfma_f32_16x16x32_f16 v[68:71], v[124:127], v[64:67], v[68:71]
  v_pk_mul_f16 v62, v40, v42 op_sel:[0,1] op_sel_hi:[1,0]
  v_pk_mul_f16 v63, v41, v42 op_sel:[0,0] op_sel_hi:[1,1]
  v_mfma_f32_16x16x32_f16 v[72:75], v[168:171], v[64:67], v[72:75]
  s_waitcnt lgkmcnt(0)
  v_alignbit_b32 v48, v48, v48, v13
  v_alignbit_b32 v49, v49, v49, v13
  v_mfma_f32_16x16x32_f16 v[76:79], v[212:215], v[64:67], v[76:79]
  v_add_f32 v22, v80, v81
  v_add_f32 v23, v82, v83
  s_cmp_lg_u32 s72, 1
  s_cbranch_scc1 L_cin_loop
  v_fmac_f32 v14, v68, v72
  v_fmac_f32 v14, v69, v73
  v_fmac_f32 v14, v70, v74
  v_fmac_f32 v14, v71, v75
  v_fmac_f32 v14, v76, v77
  v_fmac_f32 v14, v22, v78
  v_fmac_f32 v14, v23, v79
  s_nop 1
  v_add_f32_dpp v14, v14, v14 row_shr:1 row_mask:0xf bank_mask:0xf
  s_nop 1
  v_add_f32_dpp v14, v14, v14 row_shr:2 row_mask:0xf bank_mask:0xf
  s_nop 1
  v_add_f32_dpp v14, v14, v14 row_shr:4 row_mask:0xf bank_mask:0xf
  s_nop 1
  v_add_f32_dpp v14, v14, v14 row_shr:8 row_mask:0xf bank_mask:0xf
  s_nop 1
  v_add_f32_dpp v14, v14, v14 row_bcast:15 row_mask:0xa bank_mask:0xf
  s_nop 1
  v_add_f32_dpp v14, v14, v14 row_bcast:31 row_mask:0xc bank_mask:0xf
  s_branch L_blk
L_slow:
  v_lshlrev_b32 v22, 1, v0
  v_add_u32 v23, s74, v22
  s_mul_i32 s81, s3, 4224
  s_add_u32 s81, s81, 1024
  v_add_u32 v22, s81, v22
  v_add_u32 v8, s81, v9
  v_subrev_u32 v7, s75, v7
L_csync6:
  ds_read_b32 v4, v2 offset:12
  s_waitcnt lgkmcnt(0)
  v_cmp_gt_u32 vcc, 8, v4
  s_cbranch_vccnz L_csync6
  ds_read_u16 v52, v23 offset:0
  ds_read_u16 v53, v23 offset:128
  ds_read_u16 v54, v23 offset:256
  ds_read_u16 v55, v23 offset:384
  ds_read_u16 v56, v23 offset:512
  ds_read_u16 v57, v23 offset:640
  ds_read_u16 v58, v23 offset:768
  ds_read_u16 v59, v23 offset:896
  ds_read_u16 v60, v23 offset:1056
  ds_read_u16 v61, v23 offset:1184
  ds_read_u16 v62, v23 offset:1312
  ds_read_u16 v63, v23 offset:1440
  ds_read_u16 v64, v23 offset:1568
  ds_read_u16 v65, v23 offset:1696
  ds_read_u16 v66, v23 offset:1824
  ds_read_u16 v67, v23 offset:1952
  ds_read_u16 v68, v23 offset:2112
  ds_read_u16 v69, v23 offset:2240
  ds_read_u16 v70, v23 offset:2368
  ds_read_u16 v71, v23 offset:2496
  ds_read_u16 v72, v23 offset:2624
  ds_read_u16 v73, v23 offset:2752
  ds_read_u16 v74, v23 offset:2880
  ds_read_u16 v75, v23 offset:3008
  ds_read_u16 v76, v23 offset:3168
  ds_read_u16 v77, v23 offset:3296
  ds_read_u16 v78, v23 offset:3424
  ds_read_u16 v79, v23 offset:3552
  ds_read_u16 v80, v23 offset:3680
  ds_read_u16 v81, v23 offset:3808
  ds_read_u16 v82, v23 offset:3936
  s_waitcnt lgkmcnt(14)
  v_lshlrev_b32 v52, 16, v52
  v_lshlrev_b32 v53, 16, v53
  v_lshlrev_b32 v54, 16, v54
  v_lshlrev_b32 v55, 16, v55
  v_lshlrev_b32 v56, 16, v56
  v_lshlrev_b32 v57, 16, v57
  v_lshlrev_b32 v58, 16, v58
  v_lshlrev_b32 v59, 16, v59
  v_lshlrev_b32 v60, 16, v60
  v_lshlrev_b32 v61, 16, v61
  v_lshlrev_b32 v62, 16, v62
  v_lshlrev_b32 v63, 16, v63
  v_lshlrev_b32 v64, 16, v64
  v_lshlrev_b32 v65, 16, v65
  v_lshlrev_b32 v66, 16, v66
  v_lshlrev_b32 v67, 16, v67
  v_lshlrev_b32 v68, 16, v68
  s_waitcnt lgkmcnt(13)
  v_lshlrev_b32 v69, 16, v69
  s_waitcnt lgkmcnt(12)
  v_lshlrev_b32 v70, 16, v70
  s_waitcnt lgkmcnt(11)
  v_lshlrev_b32 v71, 16, v71
  s_waitcnt lgkmcnt(10)
  v_lshlrev_b32 v72, 16, v72
  s_waitcnt lgkmcnt(9)
  v_lshlrev_b32 v73, 16, v73
  s_waitcnt lgkmcnt(8)
  v_lshlrev_b32 v74, 16, v74
  s_waitcnt lgkmcnt(7)
  v_lshlrev_b32 v75, 16, v75
  s_waitcnt lgkmcnt(6)
  v_lshlrev_b32 v76, 16, v76
  s_waitcnt lgkmcnt(5)
  v_lshlrev_b32 v77, 16, v77
  s_waitcnt lgkmcnt(4)
  v_lshlrev_b32 v78, 16, v78
  s_waitcnt lgkmcnt(3)
  v_lshlrev_b32 v79, 16, v79
  s_waitcnt lgkmcnt(2)
  v_lshlrev_b32 v80, 16, v80
  s_waitcnt lgkmcnt(1)
  v_lshlrev_b32 v81, 16, v81
  s_waitcnt lgkmcnt(0)
  v_lshlrev_b32 v82, 16, v82
  v_max3_f32 v14, abs(v52), abs(v53), abs(v54)
  v_max3_f32 v14, v14, abs(v55), abs(v56)
  v_max3_f32 v14, v14, abs(v57), abs(v58)
  v_max3_f32 v14, v14, abs(v59), abs(v60)
  v_max3_f32 v14, v14, abs(v61), abs(v62)
  v_max3_f32 v14, v14, abs(v63), abs(v64)
  v_max3_f32 v14, v14, abs(v65), abs(v66)
  v_max3_f32 v14, v14, abs(v67), abs(v68)
  v_max3_f32 v14, v14, abs(v69), abs(v70)
  v_max3_f32 v14, v14, abs(v71), abs(v72)
  v_max3_f32 v14, v14, abs(v73), abs(v74)
  v_max3_f32 v14, v14, abs(v75), abs(v76)
  v_max3_f32 v14, v14, abs(v77), abs(v78)
  v_max3_f32 v14, v14, abs(v79), abs(v80)
  v_max3_f32 v14, v14, abs(v81), abs(v82)
  s_nop 1
  v_max_u32_dpp v14, v14, v14 row_shr:1 row_mask:0xf bank_mask:0xf
  s_nop 1
  v_max_u32_dpp v14, v14, v14 row_shr:2 row_mask:0xf bank_mask:0xf
  s_nop 1
  v_max_u32_dpp v14, v14, v14 row_shr:4 row_mask:0xf bank_mask:0xf
  s_nop 1
  v_max_u32_dpp v14, v14, v14 row_shr:8 row_mask:0xf bank_mask:0xf
  s_nop 1
  v_max_u32_dpp v14, v14, v14 row_bcast:15 row_mask:0xa bank_mask:0xf
  s_nop 1
  v_max_u32_dpp v14, v14, v14 row_bcast:31 row_mask:0xc bank_mask:0xf
  s_nop 0
  v_readlane_b32 s81, v14, 63
  s_nop 0
  s_lshr_b32 s81, s81, 23
  s_sub_i32 s81, 134, s81
  s_min_i32 s81, s81, 16
  s_lshl_b32 s49, s81, 2
  s_sub_i32 s49, s48, s49
  s_add_i32 s81, s81, 127
  s_lshl_b32 s81, s81, 23
  v_mov_b32 v83, s81
  v_mul_f32 v52, s81, v52
  v_mul_f32 v53, s81, v53
  v_mul_f32 v54, s81, v54
  v_mul_f32 v55, s81, v55
  v_mul_f32 v56, s81, v56
  v_mul_f32 v57, s81, v57
  v_mul_f32 v58, s81, v58
  v_mul_f32 v59, s81, v59
  v_mul_f32 v60, s81, v60
  v_mul_f32 v61, s81, v61
  v_mul_f32 v62, s81, v62
  v_mul_f32 v63, s81, v63
  v_mul_f32 v64, s81, v64
  v_mul_f32 v65, s81, v65
  v_mul_f32 v66, s81, v66
  v_mul_f32 v67, s81, v67
  v_mul_f32 v68, s81, v68
  v_mul_f32 v69, s81, v69
  v_mul_f32 v70, s81, v70
  v_mul_f32 v71, s81, v71
  v_mul_f32 v72, s81, v72
  v_mul_f32 v73, s81, v73
  v_mul_f32 v74, s81, v74
  v_mul_f32 v75, s81, v75
  v_mul_f32 v76, s81, v76
  v_mul_f32 v77, s81, v77
  v_mul_f32 v78, s81, v78
  v_mul_f32 v79, s81, v79
  v_mul_f32 v80, s81, v80
  v_mul_f32 v81, s81, v81
  v_mul_f32 v82, s81, v82
  ds_write_b16_d16_hi v23, v52 offset:0
  ds_write_b16_d16_hi v23, v53 offset:128
  ds_write_b16_d16_hi v23, v54 offset:256
  ds_write_b16_d16_hi v23, v55 offset:384
  ds_write_b16_d16_hi v23, v56 offset:512
  ds_write_b16_d16_hi v23, v57 offset:640
  ds_write_b16_d16_hi v23, v58 offset:768
  ds_write_b16_d16_hi v23, v59 offset:896
  ds_write_b16_d16_hi v23, v60 offset:1056
  ds_write_b16_d16_hi v23, v61 offset:1184
  ds_write_b16_d16_hi v23, v62 offset:1312
  ds_write_b16_d16_hi v23, v63 offset:1440
  ds_write_b16_d16_hi v23, v64 offset:1568
  ds_write_b16_d16_hi v23, v65 offset:1696
  ds_write_b16_d16_hi v23, v66 offset:1824
  ds_write_b16_d16_hi v23, v67 offset:1952
  ds_write_b16_d16_hi v23, v68 offset:2112
  ds_write_b16_d16_hi v23, v69 offset:2240
  ds_write_b16_d16_hi v23, v70 offset:2368
  ds_write_b16_d16_hi v23, v71 offset:2496
  ds_write_b16_d16_hi v23, v72 offset:2624
  ds_write_b16_d16_hi v23, v73 offset:2752
  ds_write_b16_d16_hi v23, v74 offset:2880
  ds_write_b16_d16_hi v23, v75 offset:3008
  ds_write_b16_d16_hi v23, v76 offset:3168
  ds_write_b16_d16_hi v23, v77 offset:3296
  ds_write_b16_d16_hi v23, v78 offset:3424
  ds_write_b16_d16_hi v23, v79 offset:3552
  ds_write_b16_d16_hi v23, v80 offset:3680
  ds_write_b16_d16_hi v23, v81 offset:3808
  ds_write_b16_d16_hi v23, v82 offset:3936
  v_mul_f32 v52, s81, v52
  v_mul_f32 v53, s81, v53
  v_mul_f32 v54, s81, v54
  v_mul_f32 v55, s81, v55
  v_mul_f32 v56, s81, v56
  v_mul_f32 v57, s81, v57
  v_mul_f32 v58, s81, v58
  v_mul_f32 v59, s81, v59
  v_mul_f32 v60, s81, v60
  v_mul_f32 v61, s81, v61
  v_mul_f32 v62, s81, v62
  v_mul_f32 v63, s81, v63
  v_mul_f32 v64, s81, v64
  v_mul_f32 v65, s81, v65
  v_mul_f32 v66, s81, v66
  v_mul_f32 v67, s81, v67
  v_mul_f32 v68, s81, v68
  v_mul_f32 v69, s81, v69
  v_mul_f32 v70, s81, v70
  v_mul_f32 v71, s81, v71
  v_mul_f32 v72, s81, v72
  v_mul_f32 v73, s81, v73
  v_mul_f32 v74, s81, v74
  v_mul_f32 v75, s81, v75
  v_mul_f32 v76, s81, v76
  v_mul_f32 v77, s81, v77
  v_mul_f32 v78, s81, v78
  v_mul_f32 v79, s81, v79
  v_mul_f32 v80, s81, v80
  v_mul_f32 v81, s81, v81
  v_mul_f32 v82, s81, v82
  v_mul_f32 v83, s81, v83
  ds_write_b16_d16_hi v22, v52 offset:0
  ds_write_b16_d16_hi v22, v53 offset:128
  ds_write_b16_d16_hi v22, v54 offset:256
  ds_write_b16_d16_hi v22, v55 offset:384
  ds_write_b16_d16_hi v22, v56 offset:512
  ds_write_b16_d16_hi v22, v57 offset:640
  ds_write_b16_d16_hi v22, v58 offset:768
  ds_write_b16_d16_hi v22, v59 offset:896
  ds_write_b16_d16_hi v22, v60 offset:1056
  ds_write_b16_d16_hi v22, v61 offset:1184
  ds_write_b16_d16_hi v22, v62 offset:1312
  ds_write_b16_d16_hi v22, v63 offset:1440
  ds_write_b16_d16_hi v22, v64 offset:1568
  ds_write_b16_d16_hi v22, v65 offset:1696
  ds_write_b16_d16_hi v22, v66 offset:1824
  ds_write_b16_d16_hi v22, v67 offset:1952
  ds_write_b16_d16_hi v22, v68 offset:2112
  ds_write_b16_d16_hi v22, v69 offset:2240
  ds_write_b16_d16_hi v22, v70 offset:2368
  ds_write_b16_d16_hi v22, v71 offset:2496
  ds_write_b16_d16_hi v22, v72 offset:2624
  ds_write_b16_d16_hi v22, v73 offset:2752
  ds_write_b16_d16_hi v22, v74 offset:2880
  ds_write_b16_d16_hi v22, v75 offset:3008
  ds_write_b16_d16_hi v22, v76 offset:3168
  ds_write_b16_d16_hi v22, v77 offset:3296
  ds_write_b16_d16_hi v22, v78 offset:3424
  ds_write_b16_d16_hi v22, v79 offset:3552
  ds_write_b16_d16_hi v22, v80 offset:3680
  ds_write_b16_d16_hi v22, v81 offset:3808
  ds_write_b16_d16_hi v22, v82 offset:3936
  ds_write_b16_d16_hi v22, v83 offset:4064
  s_mov_b32 s50, 0
  s_mov_b32 s97, 2
  s_waitcnt lgkmcnt(0)
  s_branch L_prime
L_cin_done:
  s_waitcnt lgkmcnt(0)
  s_barrier
  s_cmp_lg_u32 s3, 7
  s_cbranch_scc1 L_end
  v_lshlrev_b32 v3, 2, v0
  v_add_u32 v2, 110528, v3
  ds_read_b32 v1, v2
  s_lshl_b32 s69, s98, 2
  s_add_u32 s69, s69, s68
  s_add_u32 s69, s69, 12288
  s_bfm_b64 s[92:93], s26, 0
  v_lshlrev_b32 v4, 5, v0
  v_mov_b32 v5, 1
  v_mov_b32 v6, s70
  s_mov_b64 exec, s[92:93]
  s_waitcnt lgkmcnt(0)
  buffer_store_dword v1, v3, s[60:63], s69 offen sc1
  s_branch L_pub
L_rem:
  s_and_b32 s68, s2, 7
  s_lshl_b32 s68, s68, 3
  s_add_u32 s68, s68, s3
  s_mul_i32 s68, s68, 6656
  s_lshl_b32 s76, s3, 14
  v_lshlrev_b32 v248, 4, v0
  v_lshrrev_b32 v246, 4, v0
  v_lshrrev_b32 v247, 3, v0
  v_mul_u32_u24 v13, 3328, v247
  v_and_b32 v247, 2, v247
  s_and_b32 s69, s3, 1
  s_lshl_b32 s69, s69, 2
  v_or_b32 v247, s69, v247
  v_and_b32 v9, 7, v0
  v_xor_b32 v247, v247, v9
  v_lshl_add_u32 v13, v247, 4, v13
  s_mul_i32 s74, s3, 26624
  s_add_u32 s74, s74, 3200
  s_lshl_b32 s75, s3, 10
  s_add_u32 s75, s75, 131072
  s_waitcnt lgkmcnt(0)
  s_mov_b32 s28, s4
  s_and_b32 s29, s5, 0xffff
  s_mov_b32 s30, 425984
  s_mov_b32 s31, 0x20000
  s_add_u32 m0, s76, 8192
  s_nop 0
  buffer_load_dwordx4 v248, s[28:31], s68 offen lds
  s_add_u32 s68, s68, 1024
  s_add_u32 m0, s76, 9216
  s_nop 0
  buffer_load_dwordx4 v248, s[28:31], s68 offen lds
  s_add_u32 s68, s68, 1024
  s_add_u32 m0, s76, 10240
  s_nop 0
  buffer_load_dwordx4 v248, s[28:31], s68 offen lds
  s_add_u32 s68, s68, 1024
  s_add_u32 m0, s76, 11264
  s_nop 0
  buffer_load_dwordx4 v248, s[28:31], s68 offen lds
  s_add_u32 s68, s68, 1024
  s_add_u32 m0, s76, 12288
  s_nop 0
  buffer_load_dwordx4 v248, s[28:31], s68 offen lds
  s_add_u32 s68, s68, 1024
  s_add_u32 m0, s76, 13312
  s_nop 0
  buffer_load_dwordx4 v248, s[28:31], s68 offen lds
  s_add_u32 s68, s68, 1024
  s_add_u32 m0, s76, 14336
  s_nop 0
  buffer_load_dwordx4 v248, s[28:31], s68 offen lds
  s_add_u32 s68, s68, 1024
  s_mov_b32 s44, s12
  s_and_b32 s45, s13, 0xffff
  s_mov_b32 s46, 5537792
  s_mov_b32 s47, 0x20000
  s_add_u32 m0, s75, 0
  s_nop 0
  buffer_load_dwordx4 v13, s[44:47], s74 offen lds
  s_add_u32 s74, s74, 212992
  s_add_u32 m0, s75, 8192
  s_nop 0
  buffer_load_dwordx4 v13, s[44:47], s74 offen lds
  s_add_u32 s74, s74, 212992
  s_add_u32 m0, s75, 16384
  s_nop 0
  buffer_load_dwordx4 v13, s[44:47], s74 offen lds
  s_add_u32 s74, s74, 212992
  s_mov_b32 s48, s14
  s_and_b32 s49, s15, 0xffff
  s_mov_b32 s50, 3328
  s_mov_b32 s51, 0x20000
  s_mov_b32 s52, s16
  s_and_b32 s53, s17, 0xffff
  s_mov_b32 s54, 3328
  s_mov_b32 s55, 0x20000
  s_mov_b32 s32, s6
  s_and_b32 s33, s7, 0xffff
  s_mov_b32 s34, 12800000
  s_mov_b32 s35, 0x20000
  v_lshlrev_b32 v248, 3, v246
  buffer_load_dwordx2 v[128:129], v248, s[48:51], 0 offen offset:3200
  buffer_load_dwordx2 v[130:131], v248, s[48:51], 0 offen offset:3232
  buffer_load_dwordx2 v[132:133], v248, s[48:51], 0 offen offset:3264
  buffer_load_dwordx2 v[134:135], v248, s[48:51], 0 offen offset:3296
  buffer_load_dwordx2 v[136:137], v248, s[52:55], 0 offen offset:3200
  buffer_load_dwordx2 v[138:139], v248, s[52:55], 0 offen offset:3232
  buffer_load_dwordx2 v[140:141], v248, s[52:55], 0 offen offset:3264
  buffer_load_dwordx2 v[142:143], v248, s[52:55], 0 offen offset:3296
  v_xor_b32 v248, v9, v246
  v_lshlrev_b32 v14, 4, v248
  v_xor_b32 v15, 64, v14
  v_bfe_u32 v247, v0, 2, 2
  v_lshl_add_u32 v248, v246, 3, v247
  v_lshlrev_b32 v248, 7, v248
  v_and_b32 v247, 3, v0
  v_lshl_add_u32 v248, v247, 3, v248
  v_add_u32 v248, 131072, v248
  v_bfe_u32 v247, v0, 3, 2
  v_lshl_add_u32 v1, v247, 5, v248
  v_xor_b32 v2, 32, v1
  v_xor_b32 v7, 64, v1
  v_xor_b32 v8, 96, v1
  v_and_b32 v248, 15, v0
  v_lshlrev_b32 v248, 7, v248
  v_bfe_u32 v247, v0, 1, 3
  v_xor_b32 v247, v247, v246
  v_lshl_add_u32 v248, v247, 4, v248
  v_add_u32 v11, s76, v248
  v_xor_b32 v12, 64, v11
  v_lshrrev_b32 v247, 3, v0
  v_lshl_add_u32 v248, v9, 3, v247
  v_mul_u32_u24 v248, 104, v248
  v_add_u32 v248, s76, v248
  v_mov_b32 v240, 0xc0135761
  v_mov_b32 v241, 0xc0135761
  v_mov_b32 v242, 0xbdd2d3e8
  v_mov_b32 v243, 0xbdd2d3e8
  v_mov_b32 v244, 1.0
  v_mov_b32 v245, 1.0
  s_waitcnt vmcnt(11)
  ds_read_b64 v[32:33], v248 offset:8192
  ds_read_b64 v[34:35], v248 offset:8200
  ds_read_b64 v[36:37], v248 offset:8208
  ds_read_b64 v[38:39], v248 offset:8216
  ds_read_b64 v[40:41], v248 offset:8224
  ds_read_b64 v[42:43], v248 offset:8232
  ds_read_b64 v[44:45], v248 offset:8240
  ds_read_b64 v[46:47], v248 offset:8248
  ds_read_b64 v[48:49], v248 offset:8256
  ds_read_b64 v[50:51], v248 offset:8264
  ds_read_b64 v[52:53], v248 offset:8272
  ds_read_b64 v[54:55], v248 offset:8280
  ds_read_b64 v[56:57], v248 offset:8288
  v_mov_b32 v24, 0
  v_mov_b32 v25, 0
  v_mov_b32 v26, 0
  v_mov_b32 v27, 0
  v_mov_b32 v28, 0
  v_mov_b32 v29, 0
  v_mov_b32 v30, 0
  v_mov_b32 v31, 0
  s_waitcnt lgkmcnt(12)
  v_lshlrev_b32 v32, 7, v32
  s_nop 1
  v_add_u32_dpp v24, v32, v14 row_newbcast:0 row_mask:0xf bank_mask:0x3
  v_add_u32_dpp v25, v32, v15 row_newbcast:1 row_mask:0xf bank_mask:0x3
  v_add_u32_dpp v26, v32, v14 row_newbcast:2 row_mask:0xf bank_mask:0x3
  v_add_u32_dpp v27, v32, v15 row_newbcast:3 row_mask:0xf bank_mask:0x3
  v_add_u32_dpp v24, v32, v14 row_newbcast:8 row_mask:0xf bank_mask:0xc
  v_add_u32_dpp v25, v32, v15 row_newbcast:9 row_mask:0xf bank_mask:0xc
  v_add_u32_dpp v26, v32, v14 row_newbcast:10 row_mask:0xf bank_mask:0xc
  v_add_u32_dpp v27, v32, v15 row_newbcast:11 row_mask:0xf bank_mask:0xc
  s_add_u32 m0, s76, 0
  s_nop 0
  buffer_load_dwordx4 v24, s[32:35], 0 offen lds
  s_add_u32 m0, s76, 1024
  s_nop 0
  buffer_load_dwordx4 v25, s[32:35], 0 offen lds
  s_add_u32 m0, s76, 2048
  s_nop 0
  buffer_load_dwordx4 v26, s[32:35], 0 offen lds
  s_add_u32 m0, s76, 3072
  s_nop 0
  buffer_load_dwordx4 v27, s[32:35], 0 offen lds
  v_add_u32_dpp v28, v32, v14 row_newbcast:4 row_mask:0xf bank_mask:0x3
  v_add_u32_dpp v29, v32, v15 row_newbcast:5 row_mask:0xf bank_mask:0x3
  v_add_u32_dpp v30, v32, v14 row_newbcast:6 row_mask:0xf bank_mask:0x3
  v_add_u32_dpp v31, v32, v15 row_newbcast:7 row_mask:0xf bank_mask:0x3
  v_add_u32_dpp v28, v32, v14 row_newbcast:12 row_mask:0xf bank_mask:0xc
  v_add_u32_dpp v29, v32, v15 row_newbcast:13 row_mask:0xf bank_mask:0xc
  v_add_u32_dpp v30, v32, v14 row_newbcast:14 row_mask:0xf bank_mask:0xc
  v_add_u32_dpp v31, v32, v15 row_newbcast:15 row_mask:0xf bank_mask:0xc
  s_add_u32 m0, s76, 4096
  s_nop 0
  buffer_load_dwordx4 v28, s[32:35], 0 offen lds
  s_add_u32 m0, s76, 5120
  s_nop 0
  buffer_load_dwordx4 v29, s[32:35], 0 offen lds
  s_add_u32 m0, s76, 6144
  s_nop 0
  buffer_load_dwordx4 v30, s[32:35], 0 offen lds
  s_add_u32 m0, s76, 7168
  s_nop 0
  buffer_load_dwordx4 v31, s[32:35], 0 offen lds
  s_waitcnt lgkmcnt(0)
  v_lshlrev_b32 v57, 7, v57
  v_lshlrev_b32 v56, 7, v56
  v_lshlrev_b32 v55, 7, v55
  v_lshlrev_b32 v54, 7, v54
  v_lshlrev_b32 v53, 7, v53
  v_lshlrev_b32 v52, 7, v52
  v_lshlrev_b32 v51, 7, v51
  v_lshlrev_b32 v50, 7, v50
  v_lshlrev_b32 v49, 7, v49
  v_lshlrev_b32 v48, 7, v48
  v_lshlrev_b32 v47, 7, v47
  v_lshlrev_b32 v46, 7, v46
  v_lshlrev_b32 v45, 7, v45
  v_lshlrev_b32 v44, 7, v44
  v_lshlrev_b32 v43, 7, v43
  v_lshlrev_b32 v42, 7, v42
  v_lshlrev_b32 v41, 7, v41
  v_lshlrev_b32 v40, 7, v40
  v_lshlrev_b32 v39, 7, v39
  v_lshlrev_b32 v38, 7, v38
  v_lshlrev_b32 v37, 7, v37
  v_lshlrev_b32 v36, 7, v36
  v_lshlrev_b32 v35, 7, v35
  v_lshlrev_b32 v34, 7, v34
  v_lshlrev_b32 v33, 7, v33
  s_nop 1
  v_add_u32_dpp v24, v33, v14 row_newbcast:0 row_mask:0xf bank_mask:0x3
  v_add_u32_dpp v25, v33, v15 row_newbcast:1 row_mask:0xf bank_mask:0x3
  v_add_u32_dpp v26, v33, v14 row_newbcast:2 row_mask:0xf bank_mask:0x3
  v_add_u32_dpp v27, v33, v15 row_newbcast:3 row_mask:0xf bank_mask:0x3
  v_add_u32_dpp v24, v33, v14 row_newbcast:8 row_mask:0xf bank_mask:0xc
  v_add_u32_dpp v25, v33, v15 row_newbcast:9 row_mask:0xf bank_mask:0xc
  v_add_u32_dpp v26, v33, v14 row_newbcast:10 row_mask:0xf bank_mask:0xc
  v_add_u32_dpp v27, v33, v15 row_newbcast:11 row_mask:0xf bank_mask:0xc
  s_add_u32 m0, s76, 8192
  s_nop 0
  buffer_load_dwordx4 v24, s[32:35], 0 offen lds
  s_add_u32 m0, s76, 9216
  s_nop 0
  buffer_load_dwordx4 v25, s[32:35], 0 offen lds
  s_add_u32 m0, s76, 10240
  s_nop 0
  buffer_load_dwordx4 v26, s[32:35], 0 offen lds
  s_add_u32 m0, s76, 11264
  s_nop 0
  buffer_load_dwordx4 v27, s[32:35], 0 offen lds
  v_add_u32_dpp v28, v33, v14 row_newbcast:4 row_mask:0xf bank_mask:0x3
  v_add_u32_dpp v29, v33, v15 row_newbcast:5 row_mask:0xf bank_mask:0x3
  v_add_u32_dpp v30, v33, v14 row_newbcast:6 row_mask:0xf bank_mask:0x3
  v_add_u32_dpp v31, v33, v15 row_newbcast:7 row_mask:0xf bank_mask:0x3
  v_add_u32_dpp v28, v33, v14 row_newbcast:12 row_mask:0xf bank_mask:0xc
  v_add_u32_dpp v29, v33, v15 row_newbcast:13 row_mask:0xf bank_mask:0xc
  v_add_u32_dpp v30, v33, v14 row_newbcast:14 row_mask:0xf bank_mask:0xc
  v_add_u32_dpp v31, v33, v15 row_newbcast:15 row_mask:0xf bank_mask:0xc
  s_add_u32 m0, s76, 12288
  s_nop 0
  buffer_load_dwordx4 v28, s[32:35], 0 offen lds
  s_add_u32 m0, s76, 13312
  s_nop 0
  buffer_load_dwordx4 v29, s[32:35], 0 offen lds
  s_add_u32 m0, s76, 14336
  s_nop 0
  buffer_load_dwordx4 v30, s[32:35], 0 offen lds
  s_add_u32 m0, s76, 15360
  s_nop 0
  buffer_load_dwordx4 v31, s[32:35], 0 offen lds
  s_waitcnt vmcnt(23)
  v_lshlrev_b32 v160, 16, v128
  v_and_b32 v161, 0xffff0000, v128
  s_waitcnt vmcnt(19)
  v_lshlrev_b32 v224, 16, v136
  v_and_b32 v225, 0xffff0000, v136
  v_lshlrev_b32 v162, 16, v129
  v_and_b32 v163, 0xffff0000, v129
  v_lshlrev_b32 v226, 16, v137
  v_and_b32 v227, 0xffff0000, v137
  v_lshlrev_b32 v176, 16, v130
  v_and_b32 v177, 0xffff0000, v130
  s_waitcnt vmcnt(18)
  v_lshlrev_b32 v228, 16, v138
  v_and_b32 v229, 0xffff0000, v138
  v_lshlrev_b32 v178, 16, v131
  v_and_b32 v179, 0xffff0000, v131
  v_lshlrev_b32 v230, 16, v139
  v_and_b32 v231, 0xffff0000, v139
  v_lshlrev_b32 v192, 16, v132
  v_and_b32 v193, 0xffff0000, v132
  s_waitcnt vmcnt(17)
  v_lshlrev_b32 v232, 16, v140
  v_and_b32 v233, 0xffff0000, v140
  v_lshlrev_b32 v194, 16, v133
  v_and_b32 v195, 0xffff0000, v133
  v_lshlrev_b32 v234, 16, v141
  v_and_b32 v235, 0xffff0000, v141
  v_lshlrev_b32 v208, 16, v134
  v_and_b32 v209, 0xffff0000, v134
  s_waitcnt vmcnt(16)
  v_lshlrev_b32 v236, 16, v142
  v_and_b32 v237, 0xffff0000, v142
  v_lshlrev_b32 v210, 16, v135
  v_and_b32 v211, 0xffff0000, v135
  v_lshlrev_b32 v238, 16, v143
  v_and_b32 v239, 0xffff0000, v143
  v_mov_b64 v[164:165], v[160:161]
  v_mov_b64 v[166:167], v[162:163]
  v_mov_b64 v[168:169], v[160:161]
  v_mov_b64 v[170:171], v[162:163]
  v_mov_b64 v[172:173], v[160:161]
  v_mov_b64 v[174:175], v[162:163]
  v_mov_b64 v[180:181], v[176:177]
  v_mov_b64 v[182:183], v[178:179]
  v_mov_b64 v[184:185], v[176:177]
  v_mov_b64 v[186:187], v[178:179]
  v_mov_b64 v[188:189], v[176:177]
  v_mov_b64 v[190:191], v[178:179]
  v_mov_b64 v[196:197], v[192:193]
  v_mov_b64 v[198:199], v[194:195]
  v_mov_b64 v[200:201], v[192:193]
  v_mov_b64 v[202:203], v[194:195]
  v_mov_b64 v[204:205], v[192:193]
  v_mov_b64 v[206:207], v[194:195]
  v_mov_b64 v[212:213], v[208:209]
  v_mov_b64 v[214:215], v[210:211]
  v_mov_b64 v[216:217], v[208:209]
  v_mov_b64 v[218:219], v[210:211]
  v_mov_b64 v[220:221], v[208:209]
  v_mov_b64 v[222:223], v[210:211]
  s_mov_b32 s73, 2
  s_waitcnt vmcnt(8)
  s_barrier
  ds_read_b128 v[96:99], v11 offset:0
  ds_read_b128 v[100:103], v11 offset:2048
  ds_read_b128 v[104:107], v11 offset:4096
  ds_read_b128 v[108:111], v11 offset:6144
  ds_read_b128 v[112:115], v12 offset:0
  ds_read_b128 v[116:119], v12 offset:2048
  ds_read_b128 v[120:123], v12 offset:4096
  ds_read_b128 v[124:127], v12 offset:6144
  ds_read_b64_tr_b16 v[64:65], v1 offset:0
  ds_read_b64_tr_b16 v[66:67], v1 offset:512
  ds_read_b64_tr_b16 v[68:69], v2 offset:0
  ds_read_b64_tr_b16 v[70:71], v2 offset:512
  ds_read_b64_tr_b16 v[72:73], v7 offset:0
  ds_read_b64_tr_b16 v[74:75], v7 offset:512
  ds_read_b64_tr_b16 v[76:77], v8 offset:0
  ds_read_b64_tr_b16 v[78:79], v8 offset:512
L_rem_loop:
  s_min_u32 s81, s73, 25
  s_set_gpr_idx_on s81, gpr_idx(SRC0)
  s_nop 0
  v_mov_b32 v9, v32
  s_set_gpr_idx_off
  s_add_u32 s73, s73, 1
  s_waitcnt lgkmcnt(6)
  v_mfma_f32_16x16x32_bf16 v[160:163], v[64:67], v[96:99], v[160:163]
  v_add_u32_dpp v24, v9, v14 row_newbcast:0 row_mask:0xf bank_mask:0x3
  v_add_u32_dpp v25, v9, v15 row_newbcast:1 row_mask:0xf bank_mask:0x3
  v_add_u32_dpp v26, v9, v14 row_newbcast:2 row_mask:0xf bank_mask:0x3
  v_add_u32_dpp v27, v9, v15 row_newbcast:3 row_mask:0xf bank_mask:0x3
  v_add_u32_dpp v24, v9, v14 row_newbcast:8 row_mask:0xf bank_mask:0xc
  v_add_u32_dpp v25, v9, v15 row_newbcast:9 row_mask:0xf bank_mask:0xc
  v_add_u32_dpp v26, v9, v14 row_newbcast:10 row_mask:0xf bank_mask:0xc
  v_add_u32_dpp v27, v9, v15 row_newbcast:11 row_mask:0xf bank_mask:0xc
  ds_read_b64_tr_b16 v[80:81], v1 offset:4096
  v_mfma_f32_16x16x32_bf16 v[164:167], v[64:67], v[100:103], v[164:167]
  s_add_u32 m0, s76, 0
  s_nop 0
  buffer_load_dwordx4 v24, s[32:35], 0 offen lds
  v_mfma_f32_16x16x32_bf16 v[168:171], v[64:67], v[104:107], v[168:171]
  ds_read_b64_tr_b16 v[82:83], v1 offset:4608
  v_mfma_f32_16x16x32_bf16 v[172:175], v[64:67], v[108:111], v[172:175]
  s_add_u32 m0, s76, 1024
  s_nop 0
  buffer_load_dwordx4 v25, s[32:35], 0 offen lds
  s_waitcnt lgkmcnt(6)
  v_mfma_f32_16x16x32_bf16 v[188:191], v[68:71], v[108:111], v[188:191]
  ds_read_b64_tr_b16 v[84:85], v2 offset:4096
  v_mfma_f32_16x16x32_bf16 v[184:187], v[68:71], v[104:107], v[184:187]
  s_add_u32 m0, s76, 2048
  s_nop 0
  buffer_load_dwordx4 v26, s[32:35], 0 offen lds
  v_mfma_f32_16x16x32_bf16 v[180:183], v[68:71], v[100:103], v[180:183]
  ds_read_b64_tr_b16 v[86:87], v2 offset:4608
  v_mfma_f32_16x16x32_bf16 v[176:179], v[68:71], v[96:99], v[176:179]
  s_add_u32 m0, s76, 3072
  s_nop 0
  buffer_load_dwordx4 v27, s[32:35], 0 offen lds
  s_waitcnt lgkmcnt(6)
  v_mfma_f32_16x16x32_bf16 v[192:195], v[72:75], v[96:99], v[192:195]
  v_add_u32_dpp v28, v9, v14 row_newbcast:4 row_mask:0xf bank_mask:0x3
  v_add_u32_dpp v29, v9, v15 row_newbcast:5 row_mask:0xf bank_mask:0x3
  v_add_u32_dpp v30, v9, v14 row_newbcast:6 row_mask:0xf bank_mask:0x3
  v_add_u32_dpp v31, v9, v15 row_newbcast:7 row_mask:0xf bank_mask:0x3
  v_add_u32_dpp v28, v9, v14 row_newbcast:12 row_mask:0xf bank_mask:0xc
  v_add_u32_dpp v29, v9, v15 row_newbcast:13 row_mask:0xf bank_mask:0xc
  v_add_u32_dpp v30, v9, v14 row_newbcast:14 row_mask:0xf bank_mask:0xc
  v_add_u32_dpp v31, v9, v15 row_newbcast:15 row_mask:0xf bank_mask:0xc
  ds_read_b64_tr_b16 v[88:89], v7 offset:4096
  v_mfma_f32_16x16x32_bf16 v[196:199], v[72:75], v[100:103], v[196:199]
  s_add_u32 m0, s76, 4096
  s_nop 0
  buffer_load_dwordx4 v28, s[32:35], 0 offen lds
  v_mfma_f32_16x16x32_bf16 v[200:203], v[72:75], v[104:107], v[200:203]
  ds_read_b64_tr_b16 v[90:91], v7 offset:4608
  v_mfma_f32_16x16x32_bf16 v[204:207], v[72:75], v[108:111], v[204:207]
  s_add_u32 m0, s76, 5120
  s_nop 0
  buffer_load_dwordx4 v29, s[32:35], 0 offen lds
  s_waitcnt lgkmcnt(6)
  v_mfma_f32_16x16x32_bf16 v[220:223], v[76:79], v[108:111], v[220:223]
  ds_read_b64_tr_b16 v[92:93], v8 offset:4096
  v_mfma_f32_16x16x32_bf16 v[216:219], v[76:79], v[104:107], v[216:219]
  s_add_u32 m0, s76, 6144
  s_nop 0
  buffer_load_dwordx4 v30, s[32:35], 0 offen lds
  v_mfma_f32_16x16x32_bf16 v[212:215], v[76:79], v[100:103], v[212:215]
  ds_read_b64_tr_b16 v[94:95], v8 offset:4608
  v_mfma_f32_16x16x32_bf16 v[208:211], v[76:79], v[96:99], v[208:211]
  s_add_u32 m0, s76, 7168
  s_nop 0
  buffer_load_dwordx4 v31, s[32:35], 0 offen lds
  s_waitcnt vmcnt(8) lgkmcnt(0)
  s_barrier
  v_mfma_f32_16x16x32_bf16 v[160:163], v[80:83], v[112:115], v[160:163]
  s_xor_b32 s75, s75, 16384
  s_add_u32 m0, s75, 8192
  s_nop 0
  buffer_load_dwordx4 v13, s[44:47], s74 offen lds
  s_add_u32 s74, s74, 212992
  s_xor_b32 s75, s75, 16384
  ds_read_b128 v[128:131], v11 offset:8192
  v_mfma_f32_16x16x32_bf16 v[164:167], v[80:83], v[116:119], v[164:167]
  ds_read_b128 v[132:135], v11 offset:10240
  v_mfma_f32_16x16x32_bf16 v[168:171], v[80:83], v[120:123], v[168:171]
  ds_read_b128 v[136:139], v11 offset:12288
  v_mfma_f32_16x16x32_bf16 v[172:175], v[80:83], v[124:127], v[172:175]
  ds_read_b128 v[140:143], v11 offset:14336
  v_mfma_f32_16x16x32_bf16 v[188:191], v[84:87], v[124:127], v[188:191]
  ds_read_b128 v[144:147], v12 offset:8192
  v_mfma_f32_16x16x32_bf16 v[184:187], v[84:87], v[120:123], v[184:187]
  ds_read_b128 v[148:151], v12 offset:10240
  v_mfma_f32_16x16x32_bf16 v[180:183], v[84:87], v[116:119], v[180:183]
  ds_read_b128 v[152:155], v12 offset:12288
  v_mfma_f32_16x16x32_bf16 v[176:179], v[84:87], v[112:115], v[176:179]
  ds_read_b128 v[156:159], v12 offset:14336
  v_mfma_f32_16x16x32_bf16 v[192:195], v[88:91], v[112:115], v[192:195]
  ds_read_b64_tr_b16 v[64:65], v1 offset:8192
  v_mfma_f32_16x16x32_bf16 v[196:199], v[88:91], v[116:119], v[196:199]
  ds_read_b64_tr_b16 v[66:67], v1 offset:8704
  v_mfma_f32_16x16x32_bf16 v[200:203], v[88:91], v[120:123], v[200:203]
  ds_read_b64_tr_b16 v[68:69], v2 offset:8192
  v_mfma_f32_16x16x32_bf16 v[204:207], v[88:91], v[124:127], v[204:207]
  ds_read_b64_tr_b16 v[70:71], v2 offset:8704
  v_mfma_f32_16x16x32_bf16 v[220:223], v[92:95], v[124:127], v[220:223]
  ds_read_b64_tr_b16 v[72:73], v7 offset:8192
  v_mfma_f32_16x16x32_bf16 v[216:219], v[92:95], v[120:123], v[216:219]
  ds_read_b64_tr_b16 v[74:75], v7 offset:8704
  v_mfma_f32_16x16x32_bf16 v[212:215], v[92:95], v[116:119], v[212:215]
  ds_read_b64_tr_b16 v[76:77], v8 offset:8192
  v_mfma_f32_16x16x32_bf16 v[208:211], v[92:95], v[112:115], v[208:211]
  ds_read_b64_tr_b16 v[78:79], v8 offset:8704
  s_min_u32 s81, s73, 25
  s_set_gpr_idx_on s81, gpr_idx(SRC0)
  s_nop 0
  v_mov_b32 v9, v32
  s_set_gpr_idx_off
  s_add_u32 s73, s73, 1
  s_waitcnt lgkmcnt(6)
  v_mfma_f32_16x16x32_bf16 v[160:163], v[64:67], v[128:131], v[160:163]
  v_add_u32_dpp v24, v9, v14 row_newbcast:0 row_mask:0xf bank_mask:0x3
  v_add_u32_dpp v25, v9, v15 row_newbcast:1 row_mask:0xf bank_mask:0x3
  v_add_u32_dpp v26, v9, v14 row_newbcast:2 row_mask:0xf bank_mask:0x3
  v_add_u32_dpp v27, v9, v15 row_newbcast:3 row_mask:0xf bank_mask:0x3
  v_add_u32_dpp v24, v9, v14 row_newbcast:8 row_mask:0xf bank_mask:0xc
  v_add_u32_dpp v25, v9, v15 row_newbcast:9 row_mask:0xf bank_mask:0xc
  v_add_u32_dpp v26, v9, v14 row_newbcast:10 row_mask:0xf bank_mask:0xc
  v_add_u32_dpp v27, v9, v15 row_newbcast:11 row_mask:0xf bank_mask:0xc
  ds_read_b64_tr_b16 v[80:81], v1 offset:12288
  v_mfma_f32_16x16x32_bf16 v[164:167], v[64:67], v[132:135], v[164:167]
  s_add_u32 m0, s76, 8192
  s_nop 0
  buffer_load_dwordx4 v24, s[32:35], 0 offen lds
  v_mfma_f32_16x16x32_bf16 v[168:171], v[64:67], v[136:139], v[168:171]
  ds_read_b64_tr_b16 v[82:83], v1 offset:12800
  v_mfma_f32_16x16x32_bf16 v[172:175], v[64:67], v[140:143], v[172:175]
  s_add_u32 m0, s76, 9216
  s_nop 0
  buffer_load_dwordx4 v25, s[32:35], 0 offen lds
  s_waitcnt lgkmcnt(6)
  v_mfma_f32_16x16x32_bf16 v[188:191], v[68:71], v[140:143], v[188:191]
  ds_read_b64_tr_b16 v[84:85], v2 offset:12288
  v_mfma_f32_16x16x32_bf16 v[184:187], v[68:71], v[136:139], v[184:187]
  s_add_u32 m0, s76, 10240
  s_nop 0
  buffer_load_dwordx4 v26, s[32:35], 0 offen lds
  v_mfma_f32_16x16x32_bf16 v[180:183], v[68:71], v[132:135], v[180:183]
  ds_read_b64_tr_b16 v[86:87], v2 offset:12800
  v_mfma_f32_16x16x32_bf16 v[176:179], v[68:71], v[128:131], v[176:179]
  s_add_u32 m0, s76, 11264
  s_nop 0
  buffer_load_dwordx4 v27, s[32:35], 0 offen lds
  s_waitcnt lgkmcnt(6)
  v_mfma_f32_16x16x32_bf16 v[192:195], v[72:75], v[128:131], v[192:195]
  v_add_u32_dpp v28, v9, v14 row_newbcast:4 row_mask:0xf bank_mask:0x3
  v_add_u32_dpp v29, v9, v15 row_newbcast:5 row_mask:0xf bank_mask:0x3
  v_add_u32_dpp v30, v9, v14 row_newbcast:6 row_mask:0xf bank_mask:0x3
  v_add_u32_dpp v31, v9, v15 row_newbcast:7 row_mask:0xf bank_mask:0x3
  v_add_u32_dpp v28, v9, v14 row_newbcast:12 row_mask:0xf bank_mask:0xc
  v_add_u32_dpp v29, v9, v15 row_newbcast:13 row_mask:0xf bank_mask:0xc
  v_add_u32_dpp v30, v9, v14 row_newbcast:14 row_mask:0xf bank_mask:0xc
  v_add_u32_dpp v31, v9, v15 row_newbcast:15 row_mask:0xf bank_mask:0xc
  ds_read_b64_tr_b16 v[88:89], v7 offset:12288
  v_mfma_f32_16x16x32_bf16 v[196:199], v[72:75], v[132:135], v[196:199]
  s_add_u32 m0, s76, 12288
  s_nop 0
  buffer_load_dwordx4 v28, s[32:35], 0 offen lds
  v_mfma_f32_16x16x32_bf16 v[200:203], v[72:75], v[136:139], v[200:203]
  ds_read_b64_tr_b16 v[90:91], v7 offset:12800
  v_mfma_f32_16x16x32_bf16 v[204:207], v[72:75], v[140:143], v[204:207]
  s_add_u32 m0, s76, 13312
  s_nop 0
  buffer_load_dwordx4 v29, s[32:35], 0 offen lds
  s_waitcnt lgkmcnt(6)
  v_mfma_f32_16x16x32_bf16 v[220:223], v[76:79], v[140:143], v[220:223]
  ds_read_b64_tr_b16 v[92:93], v8 offset:12288
  v_mfma_f32_16x16x32_bf16 v[216:219], v[76:79], v[136:139], v[216:219]
  s_add_u32 m0, s76, 14336
  s_nop 0
  buffer_load_dwordx4 v30, s[32:35], 0 offen lds
  v_mfma_f32_16x16x32_bf16 v[212:215], v[76:79], v[132:135], v[212:215]
  ds_read_b64_tr_b16 v[94:95], v8 offset:12800
  v_mfma_f32_16x16x32_bf16 v[208:211], v[76:79], v[128:131], v[208:211]
  s_add_u32 m0, s76, 15360
  s_nop 0
  buffer_load_dwordx4 v31, s[32:35], 0 offen lds
  s_waitcnt vmcnt(9) lgkmcnt(0)
  s_barrier
  v_xor_b32 v1, 16384, v1
  v_xor_b32 v2, 16384, v2
  v_xor_b32 v7, 16384, v7
  v_xor_b32 v8, 16384, v8
  v_mfma_f32_16x16x32_bf16 v[160:163], v[80:83], v[144:147], v[160:163]
  s_add_u32 m0, s75, 0
  s_nop 0
  buffer_load_dwordx4 v13, s[44:47], s74 offen lds
  s_add_u32 s74, s74, 212992
  s_xor_b32 s75, s75, 16384
  ds_read_b128 v[96:99], v11 offset:0
  v_mfma_f32_16x16x32_bf16 v[164:167], v[80:83], v[148:151], v[164:167]
  ds_read_b128 v[100:103], v11 offset:2048
  v_mfma_f32_16x16x32_bf16 v[168:171], v[80:83], v[152:155], v[168:171]
  ds_read_b128 v[104:107], v11 offset:4096
  v_mfma_f32_16x16x32_bf16 v[172:175], v[80:83], v[156:159], v[172:175]
  ds_read_b128 v[108:111], v11 offset:6144
  v_mfma_f32_16x16x32_bf16 v[188:191], v[84:87], v[156:159], v[188:191]
  ds_read_b128 v[112:115], v12 offset:0
  v_mfma_f32_16x16x32_bf16 v[184:187], v[84:87], v[152:155], v[184:187]
  ds_read_b128 v[116:119], v12 offset:2048
  v_mfma_f32_16x16x32_bf16 v[180:183], v[84:87], v[148:151], v[180:183]
  ds_read_b128 v[120:123], v12 offset:4096
  v_mfma_f32_16x16x32_bf16 v[176:179], v[84:87], v[144:147], v[176:179]
  ds_read_b128 v[124:127], v12 offset:6144
  v_mfma_f32_16x16x32_bf16 v[192:195], v[88:91], v[144:147], v[192:195]
  ds_read_b64_tr_b16 v[64:65], v1 offset:0
  v_mfma_f32_16x16x32_bf16 v[196:199], v[88:91], v[148:151], v[196:199]
  ds_read_b64_tr_b16 v[66:67], v1 offset:512
  v_mfma_f32_16x16x32_bf16 v[200:203], v[88:91], v[152:155], v[200:203]
  ds_read_b64_tr_b16 v[68:69], v2 offset:0
  v_mfma_f32_16x16x32_bf16 v[204:207], v[88:91], v[156:159], v[204:207]
  ds_read_b64_tr_b16 v[70:71], v2 offset:512
  v_mfma_f32_16x16x32_bf16 v[220:223], v[92:95], v[156:159], v[220:223]
  ds_read_b64_tr_b16 v[72:73], v7 offset:0
  v_mfma_f32_16x16x32_bf16 v[216:219], v[92:95], v[152:155], v[216:219]
  ds_read_b64_tr_b16 v[74:75], v7 offset:512
  v_mfma_f32_16x16x32_bf16 v[212:215], v[92:95], v[148:151], v[212:215]
  ds_read_b64_tr_b16 v[76:77], v8 offset:0
  v_mfma_f32_16x16x32_bf16 v[208:211], v[92:95], v[144:147], v[208:211]
  ds_read_b64_tr_b16 v[78:79], v8 offset:512
  s_cmp_lt_u32 s73, 28
  s_cbranch_scc1 L_rem_loop
  s_mov_b32 s60, s24
  s_and_b32 s61, s25, 0xffff
  s_mov_b32 s62, 268435456
  s_mov_b32 s63, 0x20000
  s_mov_b32 s56, s20
  s_and_b32 s57, s21, 0xffff
  s_mov_b32 s58, 8192
  s_mov_b32 s59, 0x20000
  s_mov_b32 s64, s22
  s_and_b32 s65, s23, 0xffff
  s_mov_b32 s66, 256
  s_mov_b32 s67, 0x20000
  s_and_b32 s70, s2, 7
  s_lshl_b32 s68, s70, 14
  s_lshl_b32 s70, s70, 5
  s_load_dword s80, s[18:19], 0
  s_lshl_b32 s69, s3, 8
  s_add_u32 s69, s69, s68
  s_add_u32 s69, s69, 10240
  v_lshlrev_b32 v3, 2, v0
  s_waitcnt lgkmcnt(0)
  v_lshlrev_b32 v4, 5, v0
  v_mov_b32 v5, 1
  v_mov_b32 v6, s70
  v_pk_mul_f32 v[64:65], v[160:161], v[160:161]
  v_pk_mul_f32 v[68:69], v[164:165], v[164:165]
  v_pk_mul_f32 v[72:73], v[168:169], v[168:169]
  v_pk_mul_f32 v[76:77], v[172:173], v[172:173]
  v_pk_fma_f32 v[64:65], v[64:65], v[242:243], v[240:241]
  v_pk_fma_f32 v[68:69], v[68:69], v[242:243], v[240:241]
  v_pk_fma_f32 v[72:73], v[72:73], v[242:243], v[240:241]
  v_pk_fma_f32 v[76:77], v[76:77], v[242:243], v[240:241]
  v_pk_mul_f32 v[64:65], v[64:65], v[160:161]
  v_pk_mul_f32 v[68:69], v[68:69], v[164:165]
  v_pk_mul_f32 v[72:73], v[72:73], v[168:169]
  v_pk_mul_f32 v[76:77], v[76:77], v[172:173]
  v_exp_f32 v64, v64
  v_exp_f32 v65, v65
  v_exp_f32 v68, v68
  v_exp_f32 v69, v69
  v_exp_f32 v72, v72
  v_exp_f32 v73, v73
  v_exp_f32 v76, v76
  v_exp_f32 v77, v77
  v_pk_mul_f32 v[66:67], v[160:161], v[224:225]
  v_pk_mul_f32 v[70:71], v[164:165], v[224:225]
  v_pk_mul_f32 v[74:75], v[168:169], v[224:225]
  v_pk_mul_f32 v[78:79], v[172:173], v[224:225]
  v_pk_add_f32 v[64:65], v[64:65], v[244:245]
  v_pk_add_f32 v[68:69], v[68:69], v[244:245]
  v_pk_add_f32 v[72:73], v[72:73], v[244:245]
  v_pk_add_f32 v[76:77], v[76:77], v[244:245]
  v_rcp_f32 v64, v64
  v_rcp_f32 v65, v65
  v_rcp_f32 v68, v68
  v_rcp_f32 v69, v69
  v_rcp_f32 v72, v72
  v_rcp_f32 v73, v73
  v_rcp_f32 v76, v76
  v_rcp_f32 v77, v77
  v_pk_mul_f32 v[16:17], v[64:65], v[66:67]
  v_pk_mul_f32 v[18:19], v[68:69], v[70:71]
  v_pk_mul_f32 v[20:21], v[72:73], v[74:75]
  v_pk_mul_f32 v[22:23], v[76:77], v[78:79]
  v_pk_mul_f32 v[80:81], v[162:163], v[162:163]
  v_pk_mul_f32 v[84:85], v[166:167], v[166:167]
  v_pk_mul_f32 v[88:89], v[170:171], v[170:171]
  v_pk_mul_f32 v[92:93], v[174:175], v[174:175]
  v_pk_fma_f32 v[80:81], v[80:81], v[242:243], v[240:241]
  v_pk_fma_f32 v[84:85], v[84:85], v[242:243], v[240:241]
  v_pk_fma_f32 v[88:89], v[88:89], v[242:243], v[240:241]
  v_pk_fma_f32 v[92:93], v[92:93], v[242:243], v[240:241]
  v_pk_mul_f32 v[80:81], v[80:81], v[162:163]
  v_pk_mul_f32 v[84:85], v[84:85], v[166:167]
  v_pk_mul_f32 v[88:89], v[88:89], v[170:171]
  v_pk_mul_f32 v[92:93], v[92:93], v[174:175]
  v_exp_f32 v80, v80
  v_exp_f32 v81, v81
  v_exp_f32 v84, v84
  v_exp_f32 v85, v85
  v_exp_f32 v88, v88
  v_exp_f32 v89, v89
  v_exp_f32 v92, v92
  v_exp_f32 v93, v93
  v_pk_mul_f32 v[82:83], v[162:163], v[226:227]
  v_pk_mul_f32 v[86:87], v[166:167], v[226:227]
  v_pk_mul_f32 v[90:91], v[170:171], v[226:227]
  v_pk_mul_f32 v[94:95], v[174:175], v[226:227]
  v_pk_add_f32 v[80:81], v[80:81], v[244:245]
  v_pk_add_f32 v[84:85], v[84:85], v[244:245]
  v_pk_add_f32 v[88:89], v[88:89], v[244:245]
  v_pk_add_f32 v[92:93], v[92:93], v[244:245]
  v_rcp_f32 v80, v80
  v_rcp_f32 v81, v81
  v_rcp_f32 v84, v84
  v_rcp_f32 v85, v85
  v_rcp_f32 v88, v88
  v_rcp_f32 v89, v89
  v_rcp_f32 v92, v92
  v_rcp_f32 v93, v93
  v_pk_fma_f32 v[16:17], v[80:81], v[82:83], v[16:17]
  v_pk_fma_f32 v[18:19], v[84:85], v[86:87], v[18:19]
  v_pk_fma_f32 v[20:21], v[88:89], v[90:91], v[20:21]
  v_pk_fma_f32 v[22:23], v[92:93], v[94:95], v[22:23]
  v_pk_mul_f32 v[64:65], v[176:177], v[176:177]
  v_pk_mul_f32 v[68:69], v[180:181], v[180:181]
  v_pk_mul_f32 v[72:73], v[184:185], v[184:185]
  v_pk_mul_f32 v[76:77], v[188:189], v[188:189]
  v_pk_fma_f32 v[64:65], v[64:65], v[242:243], v[240:241]
  v_pk_fma_f32 v[68:69], v[68:69], v[242:243], v[240:241]
  v_pk_fma_f32 v[72:73], v[72:73], v[242:243], v[240:241]
  v_pk_fma_f32 v[76:77], v[76:77], v[242:243], v[240:241]
  v_pk_mul_f32 v[64:65], v[64:65], v[176:177]
  v_pk_mul_f32 v[68:69], v[68:69], v[180:181]
  v_pk_mul_f32 v[72:73], v[72:73], v[184:185]
  v_pk_mul_f32 v[76:77], v[76:77], v[188:189]
  v_exp_f32 v64, v64
  v_exp_f32 v65, v65
  v_exp_f32 v68, v68
  v_exp_f32 v69, v69
  v_exp_f32 v72, v72
  v_exp_f32 v73, v73
  v_exp_f32 v76, v76
  v_exp_f32 v77, v77
  v_pk_mul_f32 v[66:67], v[176:177], v[228:229]
  v_pk_mul_f32 v[70:71], v[180:181], v[228:229]
  v_pk_mul_f32 v[74:75], v[184:185], v[228:229]
  v_pk_mul_f32 v[78:79], v[188:189], v[228:229]
  v_pk_add_f32 v[64:65], v[64:65], v[244:245]
  v_pk_add_f32 v[68:69], v[68:69], v[244:245]
  v_pk_add_f32 v[72:73], v[72:73], v[244:245]
  v_pk_add_f32 v[76:77], v[76:77], v[244:245]
  v_rcp_f32 v64, v64
  v_rcp_f32 v65, v65
  v_rcp_f32 v68, v68
  v_rcp_f32 v69, v69
  v_rcp_f32 v72, v72
  v_rcp_f32 v73, v73
  v_rcp_f32 v76, v76
  v_rcp_f32 v77, v77
  v_pk_fma_f32 v[16:17], v[64:65], v[66:67], v[16:17]
  v_pk_fma_f32 v[18:19], v[68:69], v[70:71], v[18:19]
  v_pk_fma_f32 v[20:21], v[72:73], v[74:75], v[20:21]
  v_pk_fma_f32 v[22:23], v[76:77], v[78:79], v[22:23]
  v_pk_mul_f32 v[80:81], v[178:179], v[178:179]
  v_pk_mul_f32 v[84:85], v[182:183], v[182:183]
  v_pk_mul_f32 v[88:89], v[186:187], v[186:187]
  v_pk_mul_f32 v[92:93], v[190:191], v[190:191]
  v_pk_fma_f32 v[80:81], v[80:81], v[242:243], v[240:241]
  v_pk_fma_f32 v[84:85], v[84:85], v[242:243], v[240:241]
  v_pk_fma_f32 v[88:89], v[88:89], v[242:243], v[240:241]
  v_pk_fma_f32 v[92:93], v[92:93], v[242:243], v[240:241]
  v_pk_mul_f32 v[80:81], v[80:81], v[178:179]
  v_pk_mul_f32 v[84:85], v[84:85], v[182:183]
  v_pk_mul_f32 v[88:89], v[88:89], v[186:187]
  v_pk_mul_f32 v[92:93], v[92:93], v[190:191]
  v_exp_f32 v80, v80
  v_exp_f32 v81, v81
  v_exp_f32 v84, v84
  v_exp_f32 v85, v85
  v_exp_f32 v88, v88
  v_exp_f32 v89, v89
  v_exp_f32 v92, v92
  v_exp_f32 v93, v93
  v_pk_mul_f32 v[82:83], v[178:179], v[230:231]
  v_pk_mul_f32 v[86:87], v[182:183], v[230:231]
  v_pk_mul_f32 v[90:91], v[186:187], v[230:231]
  v_pk_mul_f32 v[94:95], v[190:191], v[230:231]
  v_pk_add_f32 v[80:81], v[80:81], v[244:245]
  v_pk_add_f32 v[84:85], v[84:85], v[244:245]
  v_pk_add_f32 v[88:89], v[88:89], v[244:245]
  v_pk_add_f32 v[92:93], v[92:93], v[244:245]
  v_rcp_f32 v80, v80
  v_rcp_f32 v81, v81
  v_rcp_f32 v84, v84
  v_rcp_f32 v85, v85
  v_rcp_f32 v88, v88
  v_rcp_f32 v89, v89
  v_rcp_f32 v92, v92
  v_rcp_f32 v93, v93
  v_pk_fma_f32 v[16:17], v[80:81], v[82:83], v[16:17]
  v_pk_fma_f32 v[18:19], v[84:85], v[86:87], v[18:19]
  v_pk_fma_f32 v[20:21], v[88:89], v[90:91], v[20:21]
  v_pk_fma_f32 v[22:23], v[92:93], v[94:95], v[22:23]
  v_pk_mul_f32 v[64:65], v[192:193], v[192:193]
  v_pk_mul_f32 v[68:69], v[196:197], v[196:197]
  v_pk_mul_f32 v[72:73], v[200:201], v[200:201]
  v_pk_mul_f32 v[76:77], v[204:205], v[204:205]
  v_pk_fma_f32 v[64:65], v[64:65], v[242:243], v[240:241]
  v_pk_fma_f32 v[68:69], v[68:69], v[242:243], v[240:241]
  v_pk_fma_f32 v[72:73], v[72:73], v[242:243], v[240:241]
  v_pk_fma_f32 v[76:77], v[76:77], v[242:243], v[240:241]
  v_pk_mul_f32 v[64:65], v[64:65], v[192:193]
  v_pk_mul_f32 v[68:69], v[68:69], v[196:197]
  v_pk_mul_f32 v[72:73], v[72:73], v[200:201]
  v_pk_mul_f32 v[76:77], v[76:77], v[204:205]
  v_exp_f32 v64, v64
  v_exp_f32 v65, v65
  v_exp_f32 v68, v68
  v_exp_f32 v69, v69
  v_exp_f32 v72, v72
  v_exp_f32 v73, v73
  v_exp_f32 v76, v76
  v_exp_f32 v77, v77
  v_pk_mul_f32 v[66:67], v[192:193], v[232:233]
  v_pk_mul_f32 v[70:71], v[196:197], v[232:233]
  v_pk_mul_f32 v[74:75], v[200:201], v[232:233]
  v_pk_mul_f32 v[78:79], v[204:205], v[232:233]
  v_pk_add_f32 v[64:65], v[64:65], v[244:245]
  v_pk_add_f32 v[68:69], v[68:69], v[244:245]
  v_pk_add_f32 v[72:73], v[72:73], v[244:245]
  v_pk_add_f32 v[76:77], v[76:77], v[244:245]
  v_rcp_f32 v64, v64
  v_rcp_f32 v65, v65
  v_rcp_f32 v68, v68
  v_rcp_f32 v69, v69
  v_rcp_f32 v72, v72
  v_rcp_f32 v73, v73
  v_rcp_f32 v76, v76
  v_rcp_f32 v77, v77
  v_pk_fma_f32 v[16:17], v[64:65], v[66:67], v[16:17]
  v_pk_fma_f32 v[18:19], v[68:69], v[70:71], v[18:19]
  v_pk_fma_f32 v[20:21], v[72:73], v[74:75], v[20:21]
  v_pk_fma_f32 v[22:23], v[76:77], v[78:79], v[22:23]
  v_pk_mul_f32 v[80:81], v[194:195], v[194:195]
  v_pk_mul_f32 v[84:85], v[198:199], v[198:199]
  v_pk_mul_f32 v[88:89], v[202:203], v[202:203]
  v_pk_mul_f32 v[92:93], v[206:207], v[206:207]
  v_pk_fma_f32 v[80:81], v[80:81], v[242:243], v[240:241]
  v_pk_fma_f32 v[84:85], v[84:85], v[242:243], v[240:241]
  v_pk_fma_f32 v[88:89], v[88:89], v[242:243], v[240:241]
  v_pk_fma_f32 v[92:93], v[92:93], v[242:243], v[240:241]
  v_pk_mul_f32 v[80:81], v[80:81], v[194:195]
  v_pk_mul_f32 v[84:85], v[84:85], v[198:199]
  v_pk_mul_f32 v[88:89], v[88:89], v[202:203]
  v_pk_mul_f32 v[92:93], v[92:93], v[206:207]
  v_exp_f32 v80, v80
  v_exp_f32 v81, v81
  v_exp_f32 v84, v84
  v_exp_f32 v85, v85
  v_exp_f32 v88, v88
  v_exp_f32 v89, v89
  v_exp_f32 v92, v92
  v_exp_f32 v93, v93
  v_pk_mul_f32 v[82:83], v[194:195], v[234:235]
  v_pk_mul_f32 v[86:87], v[198:199], v[234:235]
  v_pk_mul_f32 v[90:91], v[202:203], v[234:235]
  v_pk_mul_f32 v[94:95], v[206:207], v[234:235]
  v_pk_add_f32 v[80:81], v[80:81], v[244:245]
  v_pk_add_f32 v[84:85], v[84:85], v[244:245]
  v_pk_add_f32 v[88:89], v[88:89], v[244:245]
  v_pk_add_f32 v[92:93], v[92:93], v[244:245]
  v_rcp_f32 v80, v80
  v_rcp_f32 v81, v81
  v_rcp_f32 v84, v84
  v_rcp_f32 v85, v85
  v_rcp_f32 v88, v88
  v_rcp_f32 v89, v89
  v_rcp_f32 v92, v92
  v_rcp_f32 v93, v93
  v_pk_fma_f32 v[16:17], v[80:81], v[82:83], v[16:17]
  v_pk_fma_f32 v[18:19], v[84:85], v[86:87], v[18:19]
  v_pk_fma_f32 v[20:21], v[88:89], v[90:91], v[20:21]
  v_pk_fma_f32 v[22:23], v[92:93], v[94:95], v[22:23]
  v_pk_mul_f32 v[64:65], v[208:209], v[208:209]
  v_pk_mul_f32 v[68:69], v[212:213], v[212:213]
  v_pk_mul_f32 v[72:73], v[216:217], v[216:217]
  v_pk_mul_f32 v[76:77], v[220:221], v[220:221]
  v_pk_fma_f32 v[64:65], v[64:65], v[242:243], v[240:241]
  v_pk_fma_f32 v[68:69], v[68:69], v[242:243], v[240:241]
  v_pk_fma_f32 v[72:73], v[72:73], v[242:243], v[240:241]
  v_pk_fma_f32 v[76:77], v[76:77], v[242:243], v[240:241]
  v_pk_mul_f32 v[64:65], v[64:65], v[208:209]
  v_pk_mul_f32 v[68:69], v[68:69], v[212:213]
  v_pk_mul_f32 v[72:73], v[72:73], v[216:217]
  v_pk_mul_f32 v[76:77], v[76:77], v[220:221]
  v_exp_f32 v64, v64
  v_exp_f32 v65, v65
  v_exp_f32 v68, v68
  v_exp_f32 v69, v69
  v_exp_f32 v72, v72
  v_exp_f32 v73, v73
  v_exp_f32 v76, v76
  v_exp_f32 v77, v77
  v_pk_mul_f32 v[66:67], v[208:209], v[236:237]
  v_pk_mul_f32 v[70:71], v[212:213], v[236:237]
  v_pk_mul_f32 v[74:75], v[216:217], v[236:237]
  v_pk_mul_f32 v[78:79], v[220:221], v[236:237]
  v_pk_add_f32 v[64:65], v[64:65], v[244:245]
  v_pk_add_f32 v[68:69], v[68:69], v[244:245]
  v_pk_add_f32 v[72:73], v[72:73], v[244:245]
  v_pk_add_f32 v[76:77], v[76:77], v[244:245]
  v_rcp_f32 v64, v64
  v_rcp_f32 v65, v65
  v_rcp_f32 v68, v68
  v_rcp_f32 v69, v69
  v_rcp_f32 v72, v72
  v_rcp_f32 v73, v73
  v_rcp_f32 v76, v76
  v_rcp_f32 v77, v77
  v_pk_fma_f32 v[16:17], v[64:65], v[66:67], v[16:17]
  v_pk_fma_f32 v[18:19], v[68:69], v[70:71], v[18:19]
  v_pk_fma_f32 v[20:21], v[72:73], v[74:75], v[20:21]
  v_pk_fma_f32 v[22:23], v[76:77], v[78:79], v[22:23]
  v_pk_mul_f32 v[80:81], v[210:211], v[210:211]
  v_pk_mul_f32 v[84:85], v[214:215], v[214:215]
  v_pk_mul_f32 v[88:89], v[218:219], v[218:219]
  v_pk_mul_f32 v[92:93], v[222:223], v[222:223]
  v_pk_fma_f32 v[80:81], v[80:81], v[242:243], v[240:241]
  v_pk_fma_f32 v[84:85], v[84:85], v[242:243], v[240:241]
  v_pk_fma_f32 v[88:89], v[88:89], v[242:243], v[240:241]
  v_pk_fma_f32 v[92:93], v[92:93], v[242:243], v[240:241]
  v_pk_mul_f32 v[80:81], v[80:81], v[210:211]
  v_pk_mul_f32 v[84:85], v[84:85], v[214:215]
  v_pk_mul_f32 v[88:89], v[88:89], v[218:219]
  v_pk_mul_f32 v[92:93], v[92:93], v[222:223]
  v_exp_f32 v80, v80
  v_exp_f32 v81, v81
  v_exp_f32 v84, v84
  v_exp_f32 v85, v85
  v_exp_f32 v88, v88
  v_exp_f32 v89, v89
  v_exp_f32 v92, v92
  v_exp_f32 v93, v93
  v_pk_mul_f32 v[82:83], v[210:211], v[238:239]
  v_pk_mul_f32 v[86:87], v[214:215], v[238:239]
  v_pk_mul_f32 v[90:91], v[218:219], v[238:239]
  v_pk_mul_f32 v[94:95], v[222:223], v[238:239]
  v_pk_add_f32 v[80:81], v[80:81], v[244:245]
  v_pk_add_f32 v[84:85], v[84:85], v[244:245]
  v_pk_add_f32 v[88:89], v[88:89], v[244:245]
  v_pk_add_f32 v[92:93], v[92:93], v[244:245]
  v_rcp_f32 v80, v80
  v_rcp_f32 v81, v81
  v_rcp_f32 v84, v84
  v_rcp_f32 v85, v85
  v_rcp_f32 v88, v88
  v_rcp_f32 v89, v89
  v_rcp_f32 v92, v92
  v_rcp_f32 v93, v93
  v_pk_fma_f32 v[16:17], v[80:81], v[82:83], v[16:17]
  v_pk_fma_f32 v[18:19], v[84:85], v[86:87], v[18:19]
  v_pk_fma_f32 v[20:21], v[88:89], v[90:91], v[20:21]
  v_pk_fma_f32 v[22:23], v[92:93], v[94:95], v[22:23]
  v_add_f32 v16, v16, v17
  v_add_f32 v18, v18, v19
  v_add_f32 v20, v20, v21
  v_add_f32 v22, v22, v23
  s_nop 0
  v_permlane32_swap_b32 v16, v20
  v_permlane32_swap_b32 v18, v22
  v_add_f32 v16, v16, v20
  v_add_f32 v18, v18, v22
  s_nop 1
  v_permlane16_swap_b32 v16, v18
  v_add_f32 v16, v16, v18
  buffer_store_dword v16, v3, s[60:63], s69 offen sc1
  s_waitcnt vmcnt(0)
  s_barrier
  s_cmp_lg_u32 s3, 0
  s_cbranch_scc1 L_end
  s_branch L_pub
L_end:
  s_endpgm
.section .rodata,"a"
.p2align 6
.amdhsa_kernel standalone__deep_cross_xdeepfm__recsys_kernel
  .amdhsa_next_free_vgpr 256
  .amdhsa_next_free_sgpr 102
  .amdhsa_accum_offset 256
  .amdhsa_group_segment_fixed_size 0
  .amdhsa_kernarg_size 88
  .amdhsa_user_sgpr_count 2
  .amdhsa_user_sgpr_kernarg_segment_ptr 1
  .amdhsa_system_sgpr_workgroup_id_x 1
  .amdhsa_float_denorm_mode_32 3
.end_amdhsa_kernel
```

```asm
; @launch grid=(256,1,1) block=(512,1,1) lds=163840
.amdgcn_target "amdgcn-amd-amdhsa--gfx950"
.text
.globl standalone__deep_cross_xdeepfm__recsys_kernel
.p2align 8
.type standalone__deep_cross_xdeepfm__recsys_kernel,@function
standalone__deep_cross_xdeepfm__recsys_kernel:
  s_cmp_ge_u32 s2, 256
  s_cbranch_scc1 L_end
  s_load_dwordx16 s[4:19], s[0:1], 0
  s_load_dwordx4 s[20:23], s[0:1], 64
  s_load_dwordx2 s[24:25], s[0:1], 80
  v_lshrrev_b32 v1, 6, v0
  s_getpc_b64 s[92:93]
L_pc:
  s_and_b32 s68, s2, 0xf8
  v_add_u32 v2, s68, v1
  v_lshlrev_b32 v2, 7, v2
  v_min_u32 v2, L_end-L_pc, v2
  v_mov_b32 v3, s93
  v_add_co_u32 v2, vcc, s92, v2
  s_nop 1
  v_addc_co_u32 v3, vcc, 0, v3, vcc
  global_load_dword v255, v[2:3], off
  v_and_b32 v0, 63, v0
  v_readfirstlane_b32 s3, v1
  s_and_b32 s68, s2, 7
  s_lshl_b32 s68, s68, 2
  s_lshr_b32 s26, s2, 6
  s_add_u32 s26, s26, s68
  s_bfe_u32 s27, s2, 0x30003
  s_and_b32 s80, s2, 0xf8
  s_add_u32 s80, s80, s3
  s_lshl_b32 s80, s80, 21
  s_cmp_ge_u32 s27, 5
  s_cbranch_scc1 L_cin
  s_mul_i32 s77, s27, 640
  s_mul_i32 s70, s3, 7
  v_min_u32 v132, 6, v0
  v_add_u32 v132, s70, v132
  v_min_u32 v132, 51, v132
  v_lshrrev_b32 v130, 1, v132
  v_mul_u32_u24 v130, 96, v130
  v_lshl_add_u32 v132, v132, 2, v130
  s_mul_i32 s78, s27, 26
  s_min_u32 s78, s78, 102
  s_lshl_b32 s71, s26, 7
  s_add_u32 s78, s78, s71
  s_mul_i32 s78, s78, 104
  s_and_b32 s70, s26, 3
  s_lshl_b32 s70, s70, 3
  s_add_u32 s70, s70, s3
  s_mul_i32 s70, s70, 3328
  s_add_u32 s81, s70, s77
  v_min_u32 v124, 15, v0
  v_lshrrev_b32 v130, 3, v124
  s_mov_b32 s70, 106496
  v_mul_u32_u24 v130, s70, v130
  v_and_b32 v124, 7, v124
  v_min_u32 v124, 4, v124
  v_lshl_add_u32 v124, v124, 7, v130
  s_waitcnt lgkmcnt(0)
  s_mov_b32 s28, s4
  s_and_b32 s29, s5, 0xffff
  s_mov_b32 s30, 425984
  s_mov_b32 s31, 0x20000
  buffer_load_dwordx3 v[120:122], v132, s[28:31], s78 offen
  s_mov_b32 s32, s6
  s_and_b32 s33, s7, 0xffff
  s_mov_b32 s34, 12800000
  s_mov_b32 s35, 0x20000
  v_mov_b32 v136, s80
  buffer_load_dword v255, v136, s[32:35], 0 offen
  v_lshlrev_b32 v37, 4, v0
  s_mov_b32 s48, s14
  s_and_b32 s49, s15, 0xffff
  s_mov_b32 s50, 3328
  s_mov_b32 s51, 0x20000
  s_mov_b32 s44, s12
  s_and_b32 s45, s13, 0xffff
  s_mov_b32 s46, 5537792
  s_mov_b32 s47, 0x20000
  buffer_load_dword v255, v124, s[44:47], s81 offen
  s_mov_b32 m0, 147456
  s_mov_b32 exec_hi, 0xff
  buffer_load_dwordx4 v37, s[48:51], s77 offen lds
  s_mov_b64 exec, -1
  s_lshr_b32 s68, s3, 2
  s_and_b32 s69, s3, 3
  s_lshl_b32 s70, s3, 4
  s_add_u32 s70, s70, s71
  v_lshrrev_b32 v128, 3, v0
  v_add_u32 v128, s70, v128
  v_mul_u32_u24 v13, 104, v128
  s_mul_i32 s71, s68, 192
  s_mov_b32 s70, 1639
  s_and_b32 s78, s69, 1
  s_lshl_b32 s78, s78, 2
  s_mov_b32 s81, 3328
  v_add_u32 v128, s71, v0
  v_mul_u32_u24 v129, s70, v128
  v_lshrrev_b32 v129, 16, v129
  v_mul_u32_u24 v132, 40, v129
  v_sub_u32 v132, v128, v132
  v_and_b32 v131, 2, v129
  v_or_b32 v131, s78, v131
  v_xor_b32 v132, v132, v131
  v_mul_u32_u24 v129, s81, v129
  v_lshl_add_u32 v32, v132, 4, v129
  v_add_u32 v128, 64, v128
  v_mul_u32_u24 v129, s70, v128
  v_lshrrev_b32 v129, 16, v129
  v_mul_u32_u24 v132, 40, v129
  v_sub_u32 v132, v128, v132
  v_and_b32 v131, 2, v129
  v_or_b32 v131, s78, v131
  v_xor_b32 v132, v132, v131
  v_mul_u32_u24 v129, s81, v129
  v_lshl_add_u32 v33, v132, 4, v129
  v_subrev_u32 v33, 1024, v33
  v_add_u32 v128, 64, v128
  v_mul_u32_u24 v129, s70, v128
  v_lshrrev_b32 v129, 16, v129
  v_mul_u32_u24 v132, 40, v129
  v_sub_u32 v132, v128, v132
  v_and_b32 v131, 2, v129
  v_or_b32 v131, s78, v131
  v_xor_b32 v132, v132, v131
  v_mul_u32_u24 v129, s81, v129
  v_lshl_add_u32 v34, v132, 4, v129
  v_subrev_u32 v34, 2048, v34
  s_mul_i32 s70, s69, 26624
  s_add_u32 s74, s70, s77
  s_mul_i32 s75, s69, 5120
  s_mul_i32 s70, s68, 3072
  s_add_u32 s75, s75, s70
  s_lshl_b32 s76, s3, 11
  v_and_b32 v132, 7, v0
  v_lshrrev_b32 v130, 4, v0
  v_xor_b32 v132, v132, v130
  v_lshlrev_b32 v14, 4, v132
  v_xor_b32 v15, 64, v14
  s_mov_b32 s52, s16
  s_and_b32 s53, s17, 0xffff
  s_mov_b32 s54, 3328
  s_mov_b32 s55, 0x20000
  s_lshr_b32 s70, s3, 1
  s_mul_i32 s71, s70, 5
  v_bfe_u32 v131, v0, 2, 2
  v_lshl_add_u32 v132, v130, 3, v131
  v_mul_u32_u24 v132, 640, v132
  v_and_b32 v131, 3, v0
  v_lshl_add_u32 v132, v131, 3, v132
  v_add_u32 v132, 65536, v132
  v_bfe_u32 v131, v0, 3, 2
  v_xor_b32 v128, s71, v131
  v_lshl_add_u32 v1, v128, 5, v132
  v_add_u32 v6, 40960, v1
  s_add_u32 s71, s71, 1
  v_xor_b32 v128, s71, v131
  v_lshl_add_u32 v2, v128, 5, v132
  v_add_u32 v7, 40960, v2
  s_add_u32 s71, s71, 1
  v_xor_b32 v128, s71, v131
  v_lshl_add_u32 v3, v128, 5, v132
  v_add_u32 v8, 40960, v3
  s_add_u32 s71, s71, 1
  v_xor_b32 v128, s71, v131
  v_lshl_add_u32 v4, v128, 5, v132
  v_add_u32 v9, 40960, v4
  s_add_u32 s71, s71, 1
  v_xor_b32 v128, s71, v131
  v_lshl_add_u32 v5, v128, 5, v132
  v_add_u32 v10, 40960, v5
  s_add_u32 s71, s71, 1
  s_mul_i32 s71, s70, 160
  s_add_u32 s71, s71, 147456
  v_lshlrev_b32 v132, 3, v130
  v_add_u32 v35, s71, v132
  v_and_b32 v132, 15, v0
  v_lshlrev_b32 v132, 7, v132
  v_bfe_u32 v131, v0, 1, 3
  v_xor_b32 v131, v131, v130
  v_lshl_add_u32 v132, v131, 4, v132
  s_lshl_b32 s71, s78, 11
  v_add_u32 v11, s71, v132
  v_xor_b32 v12, 64, v11
  s_lshl_b32 s70, s3, 8
  s_add_u32 s70, s70, 32768
  v_lshlrev_b32 v36, 2, v0
  v_add_u32 v36, s70, v36
  s_waitcnt vmcnt(3)
  v_lshlrev_b32 v120, 7, v120
  buffer_load_dwordx4 v[112:115], v13, s[28:31], 0 offen offset:0
  buffer_load_dwordx4 v[116:119], v13, s[28:31], 0 offen offset:832
  s_barrier
  buffer_load_dword v255, v120, s[32:35], 0 offen
  v_lshlrev_b32 v122, 7, v122
  buffer_load_dword v255, v122, s[32:35], 0 offen
  s_add_u32 m0, s75, 65536
  s_cmp_lg_u32 s68, 0
  buffer_load_dwordx4 v32, s[44:47], s74 offen offset:0 lds
  buffer_load_dwordx4 v33, s[44:47], s74 offen offset:1024 lds
  s_cbranch_scc1 L_wsk1
  buffer_load_dwordx4 v34, s[44:47], s74 offen offset:2048 lds
L_wsk1:
  s_add_u32 s74, s74, 106496
  s_waitcnt vmcnt(6)
  ds_read_b64 v[220:221], v35 offset:0
  ds_read_b64 v[222:223], v35 offset:32
  ds_read_b64 v[224:225], v35 offset:64
  ds_read_b64 v[226:227], v35 offset:96
  ds_read_b64 v[228:229], v35 offset:128
  s_waitcnt lgkmcnt(4)
  v_lshlrev_b32 v140, 16, v220
  v_and_b32 v141, 0xffff0000, v220
  v_lshlrev_b32 v142, 16, v221
  v_and_b32 v143, 0xffff0000, v221
  s_waitcnt lgkmcnt(3)
  v_lshlrev_b32 v156, 16, v222
  v_and_b32 v157, 0xffff0000, v222
  v_lshlrev_b32 v158, 16, v223
  v_and_b32 v159, 0xffff0000, v223
  s_waitcnt lgkmcnt(2)
  v_lshlrev_b32 v172, 16, v224
  v_and_b32 v173, 0xffff0000, v224
  v_lshlrev_b32 v174, 16, v225
  v_and_b32 v175, 0xffff0000, v225
  s_waitcnt lgkmcnt(1)
  v_lshlrev_b32 v188, 16, v226
  v_and_b32 v189, 0xffff0000, v226
  v_lshlrev_b32 v190, 16, v227
  v_and_b32 v191, 0xffff0000, v227
  s_waitcnt lgkmcnt(0)
  v_lshlrev_b32 v204, 16, v228
  v_and_b32 v205, 0xffff0000, v228
  v_lshlrev_b32 v206, 16, v229
  v_and_b32 v207, 0xffff0000, v229
  v_mov_b64 v[144:145], v[140:141]
  v_mov_b64 v[146:147], v[142:143]
  v_mov_b64 v[148:149], v[140:141]
  v_mov_b64 v[150:151], v[142:143]
  v_mov_b64 v[152:153], v[140:141]
  v_mov_b64 v[154:155], v[142:143]
  v_mov_b64 v[160:161], v[156:157]
  v_mov_b64 v[162:163], v[158:159]
  v_mov_b64 v[164:165], v[156:157]
  v_mov_b64 v[166:167], v[158:159]
  v_mov_b64 v[168:169], v[156:157]
  v_mov_b64 v[170:171], v[158:159]
  v_mov_b64 v[176:177], v[172:173]
  v_mov_b64 v[178:179], v[174:175]
  v_mov_b64 v[180:181], v[172:173]
  v_mov_b64 v[182:183], v[174:175]
  v_mov_b64 v[184:185], v[172:173]
  v_mov_b64 v[186:187], v[174:175]
  v_mov_b64 v[192:193], v[188:189]
  v_mov_b64 v[194:195], v[190:191]
  v_mov_b64 v[196:197], v[188:189]
  v_mov_b64 v[198:199], v[190:191]
  v_mov_b64 v[200:201], v[188:189]
  v_mov_b64 v[202:203], v[190:191]
  v_mov_b64 v[208:209], v[204:205]
  v_mov_b64 v[210:211], v[206:207]
  v_mov_b64 v[212:213], v[204:205]
  v_mov_b64 v[214:215], v[206:207]
  v_mov_b64 v[216:217], v[204:205]
  v_mov_b64 v[218:219], v[206:207]
  s_waitcnt vmcnt(5)
  v_lshl_add_u32 v24, v112, 7, v14
  s_add_u32 m0, s76, 0
  s_nop 0
  buffer_load_dwordx4 v24, s[32:35], 0 offen lds
  s_waitcnt vmcnt(5)
  v_lshl_add_u32 v25, v116, 7, v15
  s_add_u32 m0, s76, 1024
  s_nop 0
  buffer_load_dwordx4 v25, s[32:35], 0 offen lds
  s_barrier
  s_add_u32 m0, s75, 86016
  s_cmp_lg_u32 s68, 0
  buffer_load_dwordx4 v32, s[44:47], s74 offen offset:0 lds
  buffer_load_dwordx4 v33, s[44:47], s74 offen offset:1024 lds
  s_cbranch_scc1 L_wsk2
  buffer_load_dwordx4 v34, s[44:47], s74 offen offset:2048 lds
L_wsk2:
  s_add_u32 s74, s74, 106496
  v_lshl_add_u32 v26, v113, 7, v14
  s_add_u32 m0, s76, 16384
  s_nop 0
  buffer_load_dwordx4 v26, s[32:35], 0 offen lds
  v_lshl_add_u32 v27, v117, 7, v15
  s_add_u32 m0, s76, 17408
  s_nop 0
  buffer_load_dwordx4 v27, s[32:35], 0 offen lds
  v_lshl_add_u32 v28, v114, 7, v14
  v_lshl_add_u32 v29, v118, 7, v15
  v_lshl_add_u32 v30, v115, 7, v14
  v_lshl_add_u32 v31, v119, 7, v15
  buffer_load_dwordx4 v[16:19], v13, s[28:31], 0 offen offset:12
  buffer_load_dwordx4 v[20:23], v13, s[28:31], 0 offen offset:844
  s_mov_b32 s72, 0
  s_mov_b32 s73, 28
  s_waitcnt vmcnt(6) lgkmcnt(0)
  s_barrier
  ds_read_b128 v[80:83], v11 offset:0
  ds_read_b128 v[84:87], v11 offset:2048
  ds_read_b128 v[88:91], v11 offset:4096
  ds_read_b128 v[92:95], v11 offset:6144
  ds_read_b64_tr_b16 v[40:41], v1 offset:0
  ds_read_b64_tr_b16 v[42:43], v1 offset:2560
  ds_read_b64_tr_b16 v[44:45], v2 offset:0
  ds_read_b64_tr_b16 v[46:47], v2 offset:2560
  ds_read_b64_tr_b16 v[48:49], v3 offset:0
  ds_read_b64_tr_b16 v[50:51], v3 offset:2560
  ds_read_b64_tr_b16 v[52:53], v4 offset:0
  ds_read_b64_tr_b16 v[54:55], v4 offset:2560
  ds_read_b64_tr_b16 v[56:57], v5 offset:0
  ds_read_b64_tr_b16 v[58:59], v5 offset:2560
  s_add_u32 m0, s75, 106496
  s_cmp_lg_u32 s68, 0
  buffer_load_dwordx4 v32, s[44:47], s74 offen offset:0 lds
  buffer_load_dwordx4 v33, s[44:47], s74 offen offset:1024 lds
  s_cbranch_scc1 L_wsk3
  buffer_load_dwordx4 v34, s[44:47], s74 offen offset:2048 lds
L_wsk3:
  s_add_u32 s74, s74, 106496
  s_add_u32 m0, s76, 32768
  s_nop 0
  buffer_load_dwordx4 v28, s[32:35], 0 offen lds
  v_mov_b32 v31, v29
  s_cmp_lg_u32 s68, 0
  s_cbranch_scc1 L_dnn_h1
L_dnn_h0:
  s_waitcnt vmcnt(8) lgkmcnt(0)
L_dnn_loop0:
  s_barrier
  v_mfma_f32_16x16x32_bf16 v[140:143], v[40:43], v[80:83], v[140:143]
  v_mfma_f32_16x16x32_bf16 v[144:147], v[40:43], v[84:87], v[144:147]
  v_mfma_f32_16x16x32_bf16 v[148:151], v[40:43], v[88:91], v[148:151]
  v_mfma_f32_16x16x32_bf16 v[152:155], v[40:43], v[92:95], v[152:155]
  v_mfma_f32_16x16x32_bf16 v[168:171], v[44:47], v[92:95], v[168:171]
  v_mfma_f32_16x16x32_bf16 v[164:167], v[44:47], v[88:91], v[164:167]
  v_mfma_f32_16x16x32_bf16 v[160:163], v[44:47], v[84:87], v[160:163]
  v_mfma_f32_16x16x32_bf16 v[156:159], v[44:47], v[80:83], v[156:159]
  v_mfma_f32_16x16x32_bf16 v[172:175], v[48:51], v[80:83], v[172:175]
  v_mfma_f32_16x16x32_bf16 v[176:179], v[48:51], v[84:87], v[176:179]
  v_mfma_f32_16x16x32_bf16 v[180:183], v[48:51], v[88:91], v[180:183]
  v_mfma_f32_16x16x32_bf16 v[184:187], v[48:51], v[92:95], v[184:187]
  v_mfma_f32_16x16x32_bf16 v[200:203], v[52:55], v[92:95], v[200:203]
  v_mfma_f32_16x16x32_bf16 v[196:199], v[52:55], v[88:91], v[196:199]
  v_mfma_f32_16x16x32_bf16 v[192:195], v[52:55], v[84:87], v[192:195]
  v_mfma_f32_16x16x32_bf16 v[188:191], v[52:55], v[80:83], v[188:191]
  v_mfma_f32_16x16x32_bf16 v[204:207], v[56:59], v[80:83], v[204:207]
  v_mfma_f32_16x16x32_bf16 v[208:211], v[56:59], v[84:87], v[208:211]
  ds_read_b128 v[96:99], v12 offset:0
  s_add_u32 m0, s75, 126976
  s_nop 0
  buffer_load_dwordx4 v32, s[44:47], s74 offen offset:0 lds
  v_mfma_f32_16x16x32_bf16 v[212:215], v[56:59], v[88:91], v[212:215]
  ds_read_b128 v[100:103], v12 offset:2048
  ds_read_b128 v[104:107], v12 offset:4096
  v_mfma_f32_16x16x32_bf16 v[216:219], v[56:59], v[92:95], v[216:219]
  ds_read_b128 v[108:111], v12 offset:6144
  buffer_load_dwordx4 v33, s[44:47], s74 offen offset:1024 lds
  ds_read_b64_tr_b16 v[60:61], v1 offset:20480
  ds_read_b64_tr_b16 v[62:63], v1 offset:23040
  ds_read_b64_tr_b16 v[64:65], v2 offset:20480
  ds_read_b64_tr_b16 v[66:67], v2 offset:23040
  buffer_load_dwordx4 v34, s[44:47], s74 offen offset:2048 lds
  s_add_u32 s74, s74, 106496
  ds_read_b64_tr_b16 v[68:69], v3 offset:20480
  ds_read_b64_tr_b16 v[70:71], v3 offset:23040
  ds_read_b64_tr_b16 v[72:73], v4 offset:20480
  s_add_u32 m0, s76, 33792
  s_nop 0
  buffer_load_dwordx4 v31, s[32:35], 0 offen lds
  ds_read_b64_tr_b16 v[74:75], v4 offset:23040
  ds_read_b64_tr_b16 v[76:77], v5 offset:20480
  ds_read_b64_tr_b16 v[78:79], v5 offset:23040
  s_waitcnt vmcnt(9)
  v_lshl_add_u32 v24, v16, 7, v14
  s_waitcnt vmcnt(8)
  v_lshl_add_u32 v25, v20, 7, v15
  v_lshl_add_u32 v26, v17, 7, v14
  v_lshl_add_u32 v27, v21, 7, v15
  v_lshl_add_u32 v28, v18, 7, v14
  v_lshl_add_u32 v29, v22, 7, v15
  v_lshl_add_u32 v30, v19, 7, v14
  v_lshl_add_u32 v31, v23, 7, v15
  s_waitcnt vmcnt(5) lgkmcnt(0)
  s_barrier
  v_mfma_f32_16x16x32_bf16 v[140:143], v[60:63], v[96:99], v[140:143]
  v_mfma_f32_16x16x32_bf16 v[144:147], v[60:63], v[100:103], v[144:147]
  v_mfma_f32_16x16x32_bf16 v[148:151], v[60:63], v[104:107], v[148:151]
  v_mfma_f32_16x16x32_bf16 v[152:155], v[60:63], v[108:111], v[152:155]
  v_mfma_f32_16x16x32_bf16 v[168:171], v[64:67], v[108:111], v[168:171]
  v_mfma_f32_16x16x32_bf16 v[164:167], v[64:67], v[104:107], v[164:167]
  v_mfma_f32_16x16x32_bf16 v[160:163], v[64:67], v[100:103], v[160:163]
  v_mfma_f32_16x16x32_bf16 v[156:159], v[64:67], v[96:99], v[156:159]
  v_mfma_f32_16x16x32_bf16 v[172:175], v[68:71], v[96:99], v[172:175]
  v_mfma_f32_16x16x32_bf16 v[176:179], v[68:71], v[100:103], v[176:179]
  v_mfma_f32_16x16x32_bf16 v[180:183], v[68:71], v[104:107], v[180:183]
  v_mfma_f32_16x16x32_bf16 v[184:187], v[68:71], v[108:111], v[184:187]
  v_mfma_f32_16x16x32_bf16 v[200:203], v[72:75], v[108:111], v[200:203]
  v_mfma_f32_16x16x32_bf16 v[196:199], v[72:75], v[104:107], v[196:199]
  v_mfma_f32_16x16x32_bf16 v[192:195], v[72:75], v[100:103], v[192:195]
  v_mfma_f32_16x16x32_bf16 v[188:191], v[72:75], v[96:99], v[188:191]
  v_mfma_f32_16x16x32_bf16 v[204:207], v[76:79], v[96:99], v[204:207]
  v_mfma_f32_16x16x32_bf16 v[208:211], v[76:79], v[100:103], v[208:211]
  ds_read_b128 v[80:83], v11 offset:16384
  s_add_u32 m0, s75, 65536
  s_nop 0
  buffer_load_dwordx4 v32, s[44:47], s74 offen offset:0 lds
  v_mfma_f32_16x16x32_bf16 v[212:215], v[76:79], v[104:107], v[212:215]
  ds_read_b128 v[84:87], v11 offset:18432
  ds_read_b128 v[88:91], v11 offset:20480
  v_mfma_f32_16x16x32_bf16 v[216:219], v[76:79], v[108:111], v[216:219]
  ds_read_b128 v[92:95], v11 offset:22528
  buffer_load_dwordx4 v33, s[44:47], s74 offen offset:1024 lds
  ds_read_b64_tr_b16 v[40:41], v6 offset:0
  ds_read_b64_tr_b16 v[42:43], v6 offset:2560
  ds_read_b64_tr_b16 v[44:45], v7 offset:0
  ds_read_b64_tr_b16 v[46:47], v7 offset:2560
  buffer_load_dwordx4 v34, s[44:47], s74 offen offset:2048 lds
  s_add_u32 s74, s74, 106496
  ds_read_b64_tr_b16 v[48:49], v8 offset:0
  ds_read_b64_tr_b16 v[50:51], v8 offset:2560
  ds_read_b64_tr_b16 v[52:53], v9 offset:0
  s_add_u32 m0, s76, 49152
  s_nop 0
  buffer_load_dwordx4 v24, s[32:35], 0 offen lds
  ds_read_b64_tr_b16 v[54:55], v9 offset:2560
  ds_read_b64_tr_b16 v[56:57], v10 offset:0
  ds_read_b64_tr_b16 v[58:59], v10 offset:2560
  buffer_load_dwordx4 v[16:19], v13, s[28:31], s73 offen offset:0
  buffer_load_dwordx4 v[20:23], v13, s[28:31], s73 offen offset:832
  s_add_u32 s73, s73, 16
  s_waitcnt vmcnt(7) lgkmcnt(0)
  s_barrier
  v_mfma_f32_16x16x32_bf16 v[140:143], v[40:43], v[80:83], v[140:143]
  v_mfma_f32_16x16x32_bf16 v[144:147], v[40:43], v[84:87], v[144:147]
  v_mfma_f32_16x16x32_bf16 v[148:151], v[40:43], v[88:91], v[148:151]
  v_mfma_f32_16x16x32_bf16 v[152:155], v[40:43], v[92:95], v[152:155]
  v_mfma_f32_16x16x32_bf16 v[168:171], v[44:47], v[92:95], v[168:171]
  v_mfma_f32_16x16x32_bf16 v[164:167], v[44:47], v[88:91], v[164:167]
  v_mfma_f32_16x16x32_bf16 v[160:163], v[44:47], v[84:87], v[160:163]
  v_mfma_f32_16x16x32_bf16 v[156:159], v[44:47], v[80:83], v[156:159]
  v_mfma_f32_16x16x32_bf16 v[172:175], v[48:51], v[80:83], v[172:175]
  v_mfma_f32_16x16x32_bf16 v[176:179], v[48:51], v[84:87], v[176:179]
  v_mfma_f32_16x16x32_bf16 v[180:183], v[48:51], v[88:91], v[180:183]
  v_mfma_f32_16x16x32_bf16 v[184:187], v[48:51], v[92:95], v[184:187]
  v_mfma_f32_16x16x32_bf16 v[200:203], v[52:55], v[92:95], v[200:203]
  v_mfma_f32_16x16x32_bf16 v[196:199], v[52:55], v[88:91], v[196:199]
  v_mfma_f32_16x16x32_bf16 v[192:195], v[52:55], v[84:87], v[192:195]
  v_mfma_f32_16x16x32_bf16 v[188:191], v[52:55], v[80:83], v[188:191]
  v_mfma_f32_16x16x32_bf16 v[204:207], v[56:59], v[80:83], v[204:207]
  v_mfma_f32_16x16x32_bf16 v[208:211], v[56:59], v[84:87], v[208:211]
  ds_read_b128 v[96:99], v12 offset:16384
  s_add_u32 m0, s75, 86016
  s_nop 0
  buffer_load_dwordx4 v32, s[44:47], s74 offen offset:0 lds
  v_mfma_f32_16x16x32_bf16 v[212:215], v[56:59], v[88:91], v[212:215]
  ds_read_b128 v[100:103], v12 offset:18432
  ds_read_b128 v[104:107], v12 offset:20480
  v_mfma_f32_16x16x32_bf16 v[216:219], v[56:59], v[92:95], v[216:219]
  ds_read_b128 v[108:111], v12 offset:22528
  buffer_load_dwordx4 v33, s[44:47], s74 offen offset:1024 lds
  ds_read_b64_tr_b16 v[60:61], v6 offset:20480
  ds_read_b64_tr_b16 v[62:63], v6 offset:23040
  ds_read_b64_tr_b16 v[64:65], v7 offset:20480
  ds_read_b64_tr_b16 v[66:67], v7 offset:23040
  buffer_load_dwordx4 v34, s[44:47], s74 offen offset:2048 lds
  s_add_u32 s74, s74, 106496
  ds_read_b64_tr_b16 v[68:69], v8 offset:20480
  ds_read_b64_tr_b16 v[70:71], v8 offset:23040
  ds_read_b64_tr_b16 v[72:73], v9 offset:20480
  s_add_u32 m0, s76, 50176
  s_nop 0
  buffer_load_dwordx4 v25, s[32:35], 0 offen lds
  ds_read_b64_tr_b16 v[74:75], v9 offset:23040
  ds_read_b64_tr_b16 v[76:77], v10 offset:20480
  ds_read_b64_tr_b16 v[78:79], v10 offset:23040
  s_waitcnt vmcnt(7) lgkmcnt(0)
  s_barrier
  v_mfma_f32_16x16x32_bf16 v[140:143], v[60:63], v[96:99], v[140:143]
  v_mfma_f32_16x16x32_bf16 v[144:147], v[60:63], v[100:103], v[144:147]
  v_mfma_f32_16x16x32_bf16 v[148:151], v[60:63], v[104:107], v[148:151]
  v_mfma_f32_16x16x32_bf16 v[152:155], v[60:63], v[108:111], v[152:155]
  v_mfma_f32_16x16x32_bf16 v[168:171], v[64:67], v[108:111], v[168:171]
  v_mfma_f32_16x16x32_bf16 v[164:167], v[64:67], v[104:107], v[164:167]
  v_mfma_f32_16x16x32_bf16 v[160:163], v[64:67], v[100:103], v[160:163]
  v_mfma_f32_16x16x32_bf16 v[156:159], v[64:67], v[96:99], v[156:159]
  v_mfma_f32_16x16x32_bf16 v[172:175], v[68:71], v[96:99], v[172:175]
  v_mfma_f32_16x16x32_bf16 v[176:179], v[68:71], v[100:103], v[176:179]
  v_mfma_f32_16x16x32_bf16 v[180:183], v[68:71], v[104:107], v[180:183]
  v_mfma_f32_16x16x32_bf16 v[184:187], v[68:71], v[108:111], v[184:187]
  v_mfma_f32_16x16x32_bf16 v[200:203], v[72:75], v[108:111], v[200:203]
  v_mfma_f32_16x16x32_bf16 v[196:199], v[72:75], v[104:107], v[196:199]
  v_mfma_f32_16x16x32_bf16 v[192:195], v[72:75], v[100:103], v[192:195]
  v_mfma_f32_16x16x32_bf16 v[188:191], v[72:75], v[96:99], v[188:191]
  v_mfma_f32_16x16x32_bf16 v[204:207], v[76:79], v[96:99], v[204:207]
  v_mfma_f32_16x16x32_bf16 v[208:211], v[76:79], v[100:103], v[208:211]
  ds_read_b128 v[80:83], v11 offset:32768
  s_add_u32 m0, s75, 106496
  s_nop 0
  buffer_load_dwordx4 v32, s[44:47], s74 offen offset:0 lds
  v_mfma_f32_16x16x32_bf16 v[212:215], v[76:79], v[104:107], v[212:215]
  ds_read_b128 v[84:87], v11 offset:34816
  ds_read_b128 v[88:91], v11 offset:36864
  v_mfma_f32_16x16x32_bf16 v[216:219], v[76:79], v[108:111], v[216:219]
  ds_read_b128 v[92:95], v11 offset:38912
  buffer_load_dwordx4 v33, s[44:47], s74 offen offset:1024 lds
  ds_read_b64_tr_b16 v[40:41], v1 offset:0
  ds_read_b64_tr_b16 v[42:43], v1 offset:2560
  ds_read_b64_tr_b16 v[44:45], v2 offset:0
  ds_read_b64_tr_b16 v[46:47], v2 offset:2560
  buffer_load_dwordx4 v34, s[44:47], s74 offen offset:2048 lds
  s_add_u32 s74, s74, 106496
  ds_read_b64_tr_b16 v[48:49], v3 offset:0
  ds_read_b64_tr_b16 v[50:51], v3 offset:2560
  ds_read_b64_tr_b16 v[52:53], v4 offset:0
  s_add_u32 m0, s76, 0
  s_nop 0
  buffer_load_dwordx4 v26, s[32:35], 0 offen lds
  ds_read_b64_tr_b16 v[54:55], v4 offset:2560
  ds_read_b64_tr_b16 v[56:57], v5 offset:0
  ds_read_b64_tr_b16 v[58:59], v5 offset:2560
  s_waitcnt vmcnt(5) lgkmcnt(0)
  s_barrier
  v_mfma_f32_16x16x32_bf16 v[140:143], v[40:43], v[80:83], v[140:143]
  v_mfma_f32_16x16x32_bf16 v[144:147], v[40:43], v[84:87], v[144:147]
  v_mfma_f32_16x16x32_bf16 v[148:151], v[40:43], v[88:91], v[148:151]
  v_mfma_f32_16x16x32_bf16 v[152:155], v[40:43], v[92:95], v[152:155]
  v_mfma_f32_16x16x32_bf16 v[168:171], v[44:47], v[92:95], v[168:171]
  v_mfma_f32_16x16x32_bf16 v[164:167], v[44:47], v[88:91], v[164:167]
  v_mfma_f32_16x16x32_bf16 v[160:163], v[44:47], v[84:87], v[160:163]
  v_mfma_f32_16x16x32_bf16 v[156:159], v[44:47], v[80:83], v[156:159]
  v_mfma_f32_16x16x32_bf16 v[172:175], v[48:51], v[80:83], v[172:175]
  v_mfma_f32_16x16x32_bf16 v[176:179], v[48:51], v[84:87], v[176:179]
  v_mfma_f32_16x16x32_bf16 v[180:183], v[48:51], v[88:91], v[180:183]
  v_mfma_f32_16x16x32_bf16 v[184:187], v[48:51], v[92:95], v[184:187]
  v_mfma_f32_16x16x32_bf16 v[200:203], v[52:55], v[92:95], v[200:203]
  v_mfma_f32_16x16x32_bf16 v[196:199], v[52:55], v[88:91], v[196:199]
  v_mfma_f32_16x16x32_bf16 v[192:195], v[52:55], v[84:87], v[192:195]
  v_mfma_f32_16x16x32_bf16 v[188:191], v[52:55], v[80:83], v[188:191]
  v_mfma_f32_16x16x32_bf16 v[204:207], v[56:59], v[80:83], v[204:207]
  v_mfma_f32_16x16x32_bf16 v[208:211], v[56:59], v[84:87], v[208:211]
  ds_read_b128 v[96:99], v12 offset:32768
  s_add_u32 m0, s75, 126976
  s_nop 0
  buffer_load_dwordx4 v32, s[44:47], s74 offen offset:0 lds
  v_mfma_f32_16x16x32_bf16 v[212:215], v[56:59], v[88:91], v[212:215]
  ds_read_b128 v[100:103], v12 offset:34816
  ds_read_b128 v[104:107], v12 offset:36864
  v_mfma_f32_16x16x32_bf16 v[216:219], v[56:59], v[92:95], v[216:219]
  ds_read_b128 v[108:111], v12 offset:38912
  buffer_load_dwordx4 v33, s[44:47], s74 offen offset:1024 lds
  ds_read_b64_tr_b16 v[60:61], v1 offset:20480
  ds_read_b64_tr_b16 v[62:63], v1 offset:23040
  ds_read_b64_tr_b16 v[64:65], v2 offset:20480
  ds_read_b64_tr_b16 v[66:67], v2 offset:23040
  buffer_load_dwordx4 v34, s[44:47], s74 offen offset:2048 lds
  s_add_u32 s74, s74, 106496
  ds_read_b64_tr_b16 v[68:69], v3 offset:20480
  ds_read_b64_tr_b16 v[70:71], v3 offset:23040
  ds_read_b64_tr_b16 v[72:73], v4 offset:20480
  s_add_u32 m0, s76, 1024
  s_nop 0
  buffer_load_dwordx4 v27, s[32:35], 0 offen lds
  ds_read_b64_tr_b16 v[74:75], v4 offset:23040
  ds_read_b64_tr_b16 v[76:77], v5 offset:20480
  ds_read_b64_tr_b16 v[78:79], v5 offset:23040
  s_waitcnt vmcnt(5) lgkmcnt(0)
  s_barrier
  v_mfma_f32_16x16x32_bf16 v[140:143], v[60:63], v[96:99], v[140:143]
  v_mfma_f32_16x16x32_bf16 v[144:147], v[60:63], v[100:103], v[144:147]
  v_mfma_f32_16x16x32_bf16 v[148:151], v[60:63], v[104:107], v[148:151]
  v_mfma_f32_16x16x32_bf16 v[152:155], v[60:63], v[108:111], v[152:155]
  v_mfma_f32_16x16x32_bf16 v[168:171], v[64:67], v[108:111], v[168:171]
  v_mfma_f32_16x16x32_bf16 v[164:167], v[64:67], v[104:107], v[164:167]
  v_mfma_f32_16x16x32_bf16 v[160:163], v[64:67], v[100:103], v[160:163]
  v_mfma_f32_16x16x32_bf16 v[156:159], v[64:67], v[96:99], v[156:159]
  v_mfma_f32_16x16x32_bf16 v[172:175], v[68:71], v[96:99], v[172:175]
  v_mfma_f32_16x16x32_bf16 v[176:179], v[68:71], v[100:103], v[176:179]
  v_mfma_f32_16x16x32_bf16 v[180:183], v[68:71], v[104:107], v[180:183]
  v_mfma_f32_16x16x32_bf16 v[184:187], v[68:71], v[108:111], v[184:187]
  v_mfma_f32_16x16x32_bf16 v[200:203], v[72:75], v[108:111], v[200:203]
  v_mfma_f32_16x16x32_bf16 v[196:199], v[72:75], v[104:107], v[196:199]
  v_mfma_f32_16x16x32_bf16 v[192:195], v[72:75], v[100:103], v[192:195]
  v_mfma_f32_16x16x32_bf16 v[188:191], v[72:75], v[96:99], v[188:191]
  v_mfma_f32_16x16x32_bf16 v[204:207], v[76:79], v[96:99], v[204:207]
  v_mfma_f32_16x16x32_bf16 v[208:211], v[76:79], v[100:103], v[208:211]
  ds_read_b128 v[80:83], v11 offset:49152
  s_add_u32 m0, s75, 65536
  s_nop 0
  buffer_load_dwordx4 v32, s[44:47], s74 offen offset:0 lds
  v_mfma_f32_16x16x32_bf16 v[212:215], v[76:79], v[104:107], v[212:215]
  ds_read_b128 v[84:87], v11 offset:51200
  ds_read_b128 v[88:91], v11 offset:53248
  v_mfma_f32_16x16x32_bf16 v[216:219], v[76:79], v[108:111], v[216:219]
  ds_read_b128 v[92:95], v11 offset:55296
  buffer_load_dwordx4 v33, s[44:47], s74 offen offset:1024 lds
  ds_read_b64_tr_b16 v[40:41], v6 offset:0
  ds_read_b64_tr_b16 v[42:43], v6 offset:2560
  ds_read_b64_tr_b16 v[44:45], v7 offset:0
  ds_read_b64_tr_b16 v[46:47], v7 offset:2560
  buffer_load_dwordx4 v34, s[44:47], s74 offen offset:2048 lds
  s_add_u32 s74, s74, 106496
  ds_read_b64_tr_b16 v[48:49], v8 offset:0
  ds_read_b64_tr_b16 v[50:51], v8 offset:2560
  ds_read_b64_tr_b16 v[52:53], v9 offset:0
  s_add_u32 m0, s76, 16384
  s_nop 0
  buffer_load_dwordx4 v28, s[32:35], 0 offen lds
  ds_read_b64_tr_b16 v[54:55], v9 offset:2560
  ds_read_b64_tr_b16 v[56:57], v10 offset:0
  ds_read_b64_tr_b16 v[58:59], v10 offset:2560
  s_waitcnt vmcnt(5) lgkmcnt(0)
  s_barrier
  v_mfma_f32_16x16x32_bf16 v[140:143], v[40:43], v[80:83], v[140:143]
  v_mfma_f32_16x16x32_bf16 v[144:147], v[40:43], v[84:87], v[144:147]
  v_mfma_f32_16x16x32_bf16 v[148:151], v[40:43], v[88:91], v[148:151]
  v_mfma_f32_16x16x32_bf16 v[152:155], v[40:43], v[92:95], v[152:155]
  v_mfma_f32_16x16x32_bf16 v[168:171], v[44:47], v[92:95], v[168:171]
  v_mfma_f32_16x16x32_bf16 v[164:167], v[44:47], v[88:91], v[164:167]
  v_mfma_f32_16x16x32_bf16 v[160:163], v[44:47], v[84:87], v[160:163]
  v_mfma_f32_16x16x32_bf16 v[156:159], v[44:47], v[80:83], v[156:159]
  v_mfma_f32_16x16x32_bf16 v[172:175], v[48:51], v[80:83], v[172:175]
  v_mfma_f32_16x16x32_bf16 v[176:179], v[48:51], v[84:87], v[176:179]
  v_mfma_f32_16x16x32_bf16 v[180:183], v[48:51], v[88:91], v[180:183]
  v_mfma_f32_16x16x32_bf16 v[184:187], v[48:51], v[92:95], v[184:187]
  v_mfma_f32_16x16x32_bf16 v[200:203], v[52:55], v[92:95], v[200:203]
  v_mfma_f32_16x16x32_bf16 v[196:199], v[52:55], v[88:91], v[196:199]
  v_mfma_f32_16x16x32_bf16 v[192:195], v[52:55], v[84:87], v[192:195]
  v_mfma_f32_16x16x32_bf16 v[188:191], v[52:55], v[80:83], v[188:191]
  v_mfma_f32_16x16x32_bf16 v[204:207], v[56:59], v[80:83], v[204:207]
  v_mfma_f32_16x16x32_bf16 v[208:211], v[56:59], v[84:87], v[208:211]
  ds_read_b128 v[96:99], v12 offset:49152
  s_add_u32 m0, s75, 86016
  s_nop 0
  buffer_load_dwordx4 v32, s[44:47], s74 offen offset:0 lds
  v_mfma_f32_16x16x32_bf16 v[212:215], v[56:59], v[88:91], v[212:215]
  ds_read_b128 v[100:103], v12 offset:51200
  ds_read_b128 v[104:107], v12 offset:53248
  v_mfma_f32_16x16x32_bf16 v[216:219], v[56:59], v[92:95], v[216:219]
  ds_read_b128 v[108:111], v12 offset:55296
  buffer_load_dwordx4 v33, s[44:47], s74 offen offset:1024 lds
  ds_read_b64_tr_b16 v[60:61], v6 offset:20480
  ds_read_b64_tr_b16 v[62:63], v6 offset:23040
  ds_read_b64_tr_b16 v[64:65], v7 offset:20480
  ds_read_b64_tr_b16 v[66:67], v7 offset:23040
  buffer_load_dwordx4 v34, s[44:47], s74 offen offset:2048 lds
  s_add_u32 s74, s74, 106496
  ds_read_b64_tr_b16 v[68:69], v8 offset:20480
  ds_read_b64_tr_b16 v[70:71], v8 offset:23040
  ds_read_b64_tr_b16 v[72:73], v9 offset:20480
  s_add_u32 m0, s76, 17408
  s_nop 0
  buffer_load_dwordx4 v29, s[32:35], 0 offen lds
  ds_read_b64_tr_b16 v[74:75], v9 offset:23040
  ds_read_b64_tr_b16 v[76:77], v10 offset:20480
  ds_read_b64_tr_b16 v[78:79], v10 offset:23040
  s_waitcnt vmcnt(5) lgkmcnt(0)
  s_barrier
  v_mfma_f32_16x16x32_bf16 v[140:143], v[60:63], v[96:99], v[140:143]
  v_mfma_f32_16x16x32_bf16 v[144:147], v[60:63], v[100:103], v[144:147]
  v_mfma_f32_16x16x32_bf16 v[148:151], v[60:63], v[104:107], v[148:151]
  v_mfma_f32_16x16x32_bf16 v[152:155], v[60:63], v[108:111], v[152:155]
  v_mfma_f32_16x16x32_bf16 v[168:171], v[64:67], v[108:111], v[168:171]
  v_mfma_f32_16x16x32_bf16 v[164:167], v[64:67], v[104:107], v[164:167]
  v_mfma_f32_16x16x32_bf16 v[160:163], v[64:67], v[100:103], v[160:163]
  v_mfma_f32_16x16x32_bf16 v[156:159], v[64:67], v[96:99], v[156:159]
  v_mfma_f32_16x16x32_bf16 v[172:175], v[68:71], v[96:99], v[172:175]
  v_mfma_f32_16x16x32_bf16 v[176:179], v[68:71], v[100:103], v[176:179]
  v_mfma_f32_16x16x32_bf16 v[180:183], v[68:71], v[104:107], v[180:183]
  v_mfma_f32_16x16x32_bf16 v[184:187], v[68:71], v[108:111], v[184:187]
  v_mfma_f32_16x16x32_bf16 v[200:203], v[72:75], v[108:111], v[200:203]
  v_mfma_f32_16x16x32_bf16 v[196:199], v[72:75], v[104:107], v[196:199]
  v_mfma_f32_16x16x32_bf16 v[192:195], v[72:75], v[100:103], v[192:195]
  v_mfma_f32_16x16x32_bf16 v[188:191], v[72:75], v[96:99], v[188:191]
  v_mfma_f32_16x16x32_bf16 v[204:207], v[76:79], v[96:99], v[204:207]
  v_mfma_f32_16x16x32_bf16 v[208:211], v[76:79], v[100:103], v[208:211]
  ds_read_b128 v[80:83], v11 offset:0
  s_add_u32 m0, s75, 106496
  s_nop 0
  buffer_load_dwordx4 v32, s[44:47], s74 offen offset:0 lds
  v_mfma_f32_16x16x32_bf16 v[212:215], v[76:79], v[104:107], v[212:215]
  ds_read_b128 v[84:87], v11 offset:2048
  ds_read_b128 v[88:91], v11 offset:4096
  v_mfma_f32_16x16x32_bf16 v[216:219], v[76:79], v[108:111], v[216:219]
  ds_read_b128 v[92:95], v11 offset:6144
  buffer_load_dwordx4 v33, s[44:47], s74 offen offset:1024 lds
  ds_read_b64_tr_b16 v[40:41], v1 offset:0
  ds_read_b64_tr_b16 v[42:43], v1 offset:2560
  ds_read_b64_tr_b16 v[44:45], v2 offset:0
  ds_read_b64_tr_b16 v[46:47], v2 offset:2560
  buffer_load_dwordx4 v34, s[44:47], s74 offen offset:2048 lds
  s_add_u32 s74, s74, 106496
  ds_read_b64_tr_b16 v[48:49], v3 offset:0
  ds_read_b64_tr_b16 v[50:51], v3 offset:2560
  ds_read_b64_tr_b16 v[52:53], v4 offset:0
  s_add_u32 m0, s76, 32768
  s_nop 0
  buffer_load_dwordx4 v30, s[32:35], 0 offen lds
  ds_read_b64_tr_b16 v[54:55], v4 offset:2560
  ds_read_b64_tr_b16 v[56:57], v5 offset:0
  ds_read_b64_tr_b16 v[58:59], v5 offset:2560
  s_add_u32 s72, s72, 1
  s_cmp_lt_u32 s72, 6
  s_waitcnt vmcnt(5) lgkmcnt(0)
  s_cbranch_scc1 L_dnn_loop0
  s_barrier
  v_mfma_f32_16x16x32_bf16 v[140:143], v[40:43], v[80:83], v[140:143]
  v_mfma_f32_16x16x32_bf16 v[144:147], v[40:43], v[84:87], v[144:147]
  v_mfma_f32_16x16x32_bf16 v[148:151], v[40:43], v[88:91], v[148:151]
  v_mfma_f32_16x16x32_bf16 v[152:155], v[40:43], v[92:95], v[152:155]
  v_mov_b32 v232, 0xc0135761
  v_mfma_f32_16x16x32_bf16 v[168:171], v[44:47], v[92:95], v[168:171]
  v_mfma_f32_16x16x32_bf16 v[164:167], v[44:47], v[88:91], v[164:167]
  v_mfma_f32_16x16x32_bf16 v[160:163], v[44:47], v[84:87], v[160:163]
  v_mov_b32 v233, 0xc0135761
  v_mfma_f32_16x16x32_bf16 v[156:159], v[44:47], v[80:83], v[156:159]
  v_mfma_f32_16x16x32_bf16 v[172:175], v[48:51], v[80:83], v[172:175]
  v_mfma_f32_16x16x32_bf16 v[176:179], v[48:51], v[84:87], v[176:179]
  v_mfma_f32_16x16x32_bf16 v[180:183], v[48:51], v[88:91], v[180:183]
  v_mov_b32 v234, 0xbdd2d3e8
  v_mfma_f32_16x16x32_bf16 v[184:187], v[48:51], v[92:95], v[184:187]
  v_mfma_f32_16x16x32_bf16 v[200:203], v[52:55], v[92:95], v[200:203]
  v_mfma_f32_16x16x32_bf16 v[196:199], v[52:55], v[88:91], v[196:199]
  v_mov_b32 v235, 0xbdd2d3e8
  v_mfma_f32_16x16x32_bf16 v[192:195], v[52:55], v[84:87], v[192:195]
  v_mfma_f32_16x16x32_bf16 v[188:191], v[52:55], v[80:83], v[188:191]
  v_mfma_f32_16x16x32_bf16 v[204:207], v[56:59], v[80:83], v[204:207]
  v_mov_b32 v236, 0x71800000
  v_mfma_f32_16x16x32_bf16 v[208:211], v[56:59], v[84:87], v[208:211]
  ds_read_b128 v[96:99], v12 offset:0
  s_add_u32 m0, s75, 126976
  s_nop 0
  buffer_load_dwordx4 v32, s[44:47], s74 offen offset:0 lds
  v_mfma_f32_16x16x32_bf16 v[212:215], v[56:59], v[88:91], v[212:215]
  ds_read_b128 v[100:103], v12 offset:2048
  ds_read_b128 v[104:107], v12 offset:4096
  v_mfma_f32_16x16x32_bf16 v[216:219], v[56:59], v[92:95], v[216:219]
  ds_read_b128 v[108:111], v12 offset:6144
  ds_read_b64_tr_b16 v[60:61], v1 offset:20480
  ds_read_b64_tr_b16 v[62:63], v1 offset:23040
  ds_read_b64_tr_b16 v[64:65], v2 offset:20480
  buffer_load_dwordx4 v33, s[44:47], s74 offen offset:1024 lds
  ds_read_b64_tr_b16 v[66:67], v2 offset:23040
  ds_read_b64_tr_b16 v[68:69], v3 offset:20480
  ds_read_b64_tr_b16 v[70:71], v3 offset:23040
  ds_read_b64_tr_b16 v[72:73], v4 offset:20480
  ds_read_b64_tr_b16 v[74:75], v4 offset:23040
  ds_read_b64_tr_b16 v[76:77], v5 offset:20480
  buffer_load_dwordx4 v34, s[44:47], s74 offen offset:2048 lds
  s_add_u32 s74, s74, 106496
  ds_read_b64_tr_b16 v[78:79], v5 offset:23040
  ds_read_b64 v[220:221], v35 offset:640
  ds_read_b64 v[222:223], v35 offset:672
  ds_read_b64 v[224:225], v35 offset:704
  ds_read_b64 v[226:227], v35 offset:736
  ds_read_b64 v[228:229], v35 offset:768
  s_mov_b32 s60, s24
  s_and_b32 s61, s25, 0xffff
  s_mov_b32 s62, 268435456
  s_mov_b32 s63, 0x20000
  s_mov_b32 s64, s22
  s_and_b32 s65, s23, 0xffff
  s_mov_b32 s66, 256
  s_mov_b32 s67, 0x20000
  v_mov_b32 v24, 0
  s_mov_b64 exec, 1
  s_mov_b32 s81, 0x80000
  buffer_load_dword v255, v24, s[60:63], s81 offen
  buffer_load_dword v37, v24, s[64:67], 0 offen offset:128 sc1
  s_mov_b64 exec, -1
  s_waitcnt vmcnt(6) lgkmcnt(0)
  s_barrier
  v_mfma_f32_16x16x32_bf16 v[140:143], v[60:63], v[96:99], v[140:143]
  v_lshlrev_b32 v112, 16, v220
  v_mfma_f32_16x16x32_bf16 v[144:147], v[60:63], v[100:103], v[144:147]
  v_and_b32 v113, 0xffff0000, v220
  v_mfma_f32_16x16x32_bf16 v[148:151], v[60:63], v[104:107], v[148:151]
  v_lshlrev_b32 v114, 16, v221
  v_and_b32 v115, 0xffff0000, v221
  v_mfma_f32_16x16x32_bf16 v[152:155], v[60:63], v[108:111], v[152:155]
  v_lshlrev_b32 v116, 16, v222
  v_mfma_f32_16x16x32_bf16 v[168:171], v[64:67], v[108:111], v[168:171]
  v_and_b32 v117, 0xffff0000, v222
  v_lshlrev_b32 v118, 16, v223
  v_mfma_f32_16x16x32_bf16 v[164:167], v[64:67], v[104:107], v[164:167]
  v_and_b32 v119, 0xffff0000, v223
  v_mfma_f32_16x16x32_bf16 v[160:163], v[64:67], v[100:103], v[160:163]
  v_lshlrev_b32 v120, 16, v224
  v_mfma_f32_16x16x32_bf16 v[156:159], v[64:67], v[96:99], v[156:159]
  v_and_b32 v121, 0xffff0000, v224
  v_lshlrev_b32 v122, 16, v225
  v_mfma_f32_16x16x32_bf16 v[172:175], v[68:71], v[96:99], v[172:175]
  v_and_b32 v123, 0xffff0000, v225
  v_mfma_f32_16x16x32_bf16 v[176:179], v[68:71], v[100:103], v[176:179]
  v_lshlrev_b32 v124, 16, v226
  v_and_b32 v125, 0xffff0000, v226
  v_mfma_f32_16x16x32_bf16 v[180:183], v[68:71], v[104:107], v[180:183]
  v_lshlrev_b32 v126, 16, v227
  v_mfma_f32_16x16x32_bf16 v[184:187], v[68:71], v[108:111], v[184:187]
  v_and_b32 v127, 0xffff0000, v227
  v_mfma_f32_16x16x32_bf16 v[200:203], v[72:75], v[108:111], v[200:203]
  v_lshlrev_b32 v128, 16, v228
  v_and_b32 v129, 0xffff0000, v228
  v_mfma_f32_16x16x32_bf16 v[196:199], v[72:75], v[104:107], v[196:199]
  v_lshlrev_b32 v130, 16, v229
  v_mfma_f32_16x16x32_bf16 v[192:195], v[72:75], v[100:103], v[192:195]
  v_and_b32 v131, 0xffff0000, v229
  v_rcp_f32 v112, v112
  v_mfma_f32_16x16x32_bf16 v[188:191], v[72:75], v[96:99], v[188:191]
  v_rcp_f32 v113, v113
  v_mfma_f32_16x16x32_bf16 v[204:207], v[76:79], v[96:99], v[204:207]
  v_rcp_f32 v114, v114
  v_rcp_f32 v115, v115
  v_mfma_f32_16x16x32_bf16 v[208:211], v[76:79], v[100:103], v[208:211]
  ds_read_b128 v[80:83], v11 offset:16384
  ds_read_b128 v[84:87], v11 offset:18432
  v_mfma_f32_16x16x32_bf16 v[212:215], v[76:79], v[104:107], v[212:215]
  ds_read_b128 v[88:91], v11 offset:20480
  ds_read_b128 v[92:95], v11 offset:22528
  v_mfma_f32_16x16x32_bf16 v[216:219], v[76:79], v[108:111], v[216:219]
  ds_read_b64_tr_b16 v[40:41], v6 offset:0
  ds_read_b64_tr_b16 v[42:43], v6 offset:2560
  ds_read_b64_tr_b16 v[44:45], v7 offset:0
  ds_read_b64_tr_b16 v[46:47], v7 offset:2560
  ds_read_b64_tr_b16 v[48:49], v8 offset:0
  ds_read_b64_tr_b16 v[50:51], v8 offset:2560
  ds_read_b64_tr_b16 v[52:53], v9 offset:0
  ds_read_b64_tr_b16 v[54:55], v9 offset:2560
  ds_read_b64_tr_b16 v[56:57], v10 offset:0
  ds_read_b64_tr_b16 v[58:59], v10 offset:2560
  s_waitcnt vmcnt(0) lgkmcnt(0)
  s_barrier
  v_mfma_f32_16x16x32_bf16 v[140:143], v[40:43], v[80:83], v[140:143]
  v_mfma_f32_16x16x32_bf16 v[144:147], v[40:43], v[84:87], v[144:147]
  v_rcp_f32 v116, v116
  v_mfma_f32_16x16x32_bf16 v[148:151], v[40:43], v[88:91], v[148:151]
  v_rcp_f32 v117, v117
  v_mfma_f32_16x16x32_bf16 v[152:155], v[40:43], v[92:95], v[152:155]
  v_rcp_f32 v118, v118
  v_mfma_f32_16x16x32_bf16 v[168:171], v[44:47], v[92:95], v[168:171]
  v_rcp_f32 v119, v119
  v_mfma_f32_16x16x32_bf16 v[164:167], v[44:47], v[88:91], v[164:167]
  v_mfma_f32_16x16x32_bf16 v[160:163], v[44:47], v[84:87], v[160:163]
  v_rcp_f32 v120, v120
  v_mfma_f32_16x16x32_bf16 v[156:159], v[44:47], v[80:83], v[156:159]
  v_rcp_f32 v121, v121
  v_mfma_f32_16x16x32_bf16 v[172:175], v[48:51], v[80:83], v[172:175]
  v_rcp_f32 v122, v122
  v_mfma_f32_16x16x32_bf16 v[176:179], v[48:51], v[84:87], v[176:179]
  v_rcp_f32 v123, v123
  v_mfma_f32_16x16x32_bf16 v[180:183], v[48:51], v[88:91], v[180:183]
  v_rcp_f32 v124, v124
  v_mfma_f32_16x16x32_bf16 v[184:187], v[48:51], v[92:95], v[184:187]
  v_mfma_f32_16x16x32_bf16 v[200:203], v[52:55], v[92:95], v[200:203]
  v_rcp_f32 v125, v125
  v_mfma_f32_16x16x32_bf16 v[196:199], v[52:55], v[88:91], v[196:199]
  v_rcp_f32 v126, v126
  v_mfma_f32_16x16x32_bf16 v[192:195], v[52:55], v[84:87], v[192:195]
  v_rcp_f32 v127, v127
  v_mfma_f32_16x16x32_bf16 v[188:191], v[52:55], v[80:83], v[188:191]
  v_rcp_f32 v128, v128
  v_mfma_f32_16x16x32_bf16 v[204:207], v[56:59], v[80:83], v[204:207]
  v_rcp_f32 v129, v129
  v_mfma_f32_16x16x32_bf16 v[208:211], v[56:59], v[84:87], v[208:211]
  ds_read_b128 v[96:99], v12 offset:16384
  ds_read_b128 v[100:103], v12 offset:18432
  v_mfma_f32_16x16x32_bf16 v[212:215], v[56:59], v[88:91], v[212:215]
  ds_read_b128 v[104:107], v12 offset:20480
  ds_read_b128 v[108:111], v12 offset:22528
  v_mfma_f32_16x16x32_bf16 v[216:219], v[56:59], v[92:95], v[216:219]
  ds_read_b64_tr_b16 v[60:61], v6 offset:20480
  ds_read_b64_tr_b16 v[62:63], v6 offset:23040
  ds_read_b64_tr_b16 v[64:65], v7 offset:20480
  ds_read_b64_tr_b16 v[66:67], v7 offset:23040
  ds_read_b64_tr_b16 v[68:69], v8 offset:20480
  ds_read_b64_tr_b16 v[70:71], v8 offset:23040
  ds_read_b64_tr_b16 v[72:73], v9 offset:20480
  ds_read_b64_tr_b16 v[74:75], v9 offset:23040
  ds_read_b64_tr_b16 v[76:77], v10 offset:20480
  ds_read_b64_tr_b16 v[78:79], v10 offset:23040
  s_waitcnt lgkmcnt(0)
  v_mfma_f32_16x16x32_bf16 v[140:143], v[60:63], v[96:99], v[140:143]
  v_rcp_f32 v130, v130
  v_mfma_f32_16x16x32_bf16 v[144:147], v[60:63], v[100:103], v[144:147]
  v_rcp_f32 v131, v131
  v_mfma_f32_16x16x32_bf16 v[148:151], v[60:63], v[104:107], v[148:151]
  v_med3_f32 v112, v112, -v236, v236
  v_mfma_f32_16x16x32_bf16 v[152:155], v[60:63], v[108:111], v[152:155]
  v_med3_f32 v113, v113, -v236, v236
  v_med3_f32 v114, v114, -v236, v236
  v_mfma_f32_16x16x32_bf16 v[168:171], v[64:67], v[108:111], v[168:171]
  v_med3_f32 v115, v115, -v236, v236
  v_mfma_f32_16x16x32_bf16 v[164:167], v[64:67], v[104:107], v[164:167]
  v_med3_f32 v116, v116, -v236, v236
  v_mfma_f32_16x16x32_bf16 v[160:163], v[64:67], v[100:103], v[160:163]
  v_med3_f32 v117, v117, -v236, v236
  v_med3_f32 v118, v118, -v236, v236
  v_mfma_f32_16x16x32_bf16 v[156:159], v[64:67], v[96:99], v[156:159]
  v_med3_f32 v119, v119, -v236, v236
  v_mfma_f32_16x16x32_bf16 v[172:175], v[68:71], v[96:99], v[172:175]
  v_med3_f32 v120, v120, -v236, v236
  v_mfma_f32_16x16x32_bf16 v[176:179], v[68:71], v[100:103], v[176:179]
  v_med3_f32 v121, v121, -v236, v236
  v_mfma_f32_16x16x32_bf16 v[180:183], v[68:71], v[104:107], v[180:183]
  v_med3_f32 v122, v122, -v236, v236
  v_med3_f32 v123, v123, -v236, v236
  v_mfma_f32_16x16x32_bf16 v[184:187], v[68:71], v[108:111], v[184:187]
  v_med3_f32 v124, v124, -v236, v236
  v_mfma_f32_16x16x32_bf16 v[200:203], v[72:75], v[108:111], v[200:203]
  v_med3_f32 v125, v125, -v236, v236
  v_mfma_f32_16x16x32_bf16 v[196:199], v[72:75], v[104:107], v[196:199]
  v_med3_f32 v126, v126, -v236, v236
  v_med3_f32 v127, v127, -v236, v236
  v_mfma_f32_16x16x32_bf16 v[192:195], v[72:75], v[100:103], v[192:195]
  v_med3_f32 v128, v128, -v236, v236
  v_mfma_f32_16x16x32_bf16 v[188:191], v[72:75], v[96:99], v[188:191]
  v_med3_f32 v129, v129, -v236, v236
  v_mfma_f32_16x16x32_bf16 v[204:207], v[76:79], v[96:99], v[204:207]
  v_med3_f32 v130, v130, -v236, v236
  v_med3_f32 v131, v131, -v236, v236
  v_mfma_f32_16x16x32_bf16 v[208:211], v[76:79], v[100:103], v[208:211]
  v_mfma_f32_16x16x32_bf16 v[212:215], v[76:79], v[104:107], v[212:215]
  v_mfma_f32_16x16x32_bf16 v[216:219], v[76:79], v[108:111], v[216:219]
  s_branch L_epi
L_dnn_h1:
  s_waitcnt vmcnt(7) lgkmcnt(0)
L_dnn_loop1:
  s_barrier
  ds_read_b128 v[96:99], v12 offset:0
  s_add_u32 m0, s75, 126976
  s_nop 0
  buffer_load_dwordx4 v32, s[44:47], s74 offen offset:0 lds
  ds_read_b128 v[100:103], v12 offset:2048
  ds_read_b128 v[104:107], v12 offset:4096
  ds_read_b128 v[108:111], v12 offset:6144
  ds_read_b64_tr_b16 v[60:61], v1 offset:20480
  buffer_load_dwordx4 v33, s[44:47], s74 offen offset:1024 lds
  s_add_u32 s74, s74, 106496
  ds_read_b64_tr_b16 v[62:63], v1 offset:23040
  ds_read_b64_tr_b16 v[64:65], v2 offset:20480
  ds_read_b64_tr_b16 v[66:67], v2 offset:23040
  ds_read_b64_tr_b16 v[68:69], v3 offset:20480
  ds_read_b64_tr_b16 v[70:71], v3 offset:23040
  s_add_u32 m0, s76, 33792
  s_nop 0
  buffer_load_dwordx4 v31, s[32:35], 0 offen lds
  ds_read_b64_tr_b16 v[72:73], v4 offset:20480
  ds_read_b64_tr_b16 v[74:75], v4 offset:23040
  ds_read_b64_tr_b16 v[76:77], v5 offset:20480
  ds_read_b64_tr_b16 v[78:79], v5 offset:23040
  v_mfma_f32_16x16x32_bf16 v[140:143], v[40:43], v[80:83], v[140:143]
  v_mfma_f32_16x16x32_bf16 v[144:147], v[40:43], v[84:87], v[144:147]
  v_mfma_f32_16x16x32_bf16 v[148:151], v[40:43], v[88:91], v[148:151]
  s_waitcnt vmcnt(7)
  v_lshl_add_u32 v24, v16, 7, v14
  v_mfma_f32_16x16x32_bf16 v[152:155], v[40:43], v[92:95], v[152:155]
  v_mfma_f32_16x16x32_bf16 v[168:171], v[44:47], v[92:95], v[168:171]
  s_waitcnt vmcnt(6)
  v_lshl_add_u32 v25, v20, 7, v15
  v_mfma_f32_16x16x32_bf16 v[164:167], v[44:47], v[88:91], v[164:167]
  v_mfma_f32_16x16x32_bf16 v[160:163], v[44:47], v[84:87], v[160:163]
  v_mfma_f32_16x16x32_bf16 v[156:159], v[44:47], v[80:83], v[156:159]
  v_lshl_add_u32 v26, v17, 7, v14
  v_mfma_f32_16x16x32_bf16 v[172:175], v[48:51], v[80:83], v[172:175]
  v_mfma_f32_16x16x32_bf16 v[176:179], v[48:51], v[84:87], v[176:179]
  v_lshl_add_u32 v27, v21, 7, v15
  v_mfma_f32_16x16x32_bf16 v[180:183], v[48:51], v[88:91], v[180:183]
  v_mfma_f32_16x16x32_bf16 v[184:187], v[48:51], v[92:95], v[184:187]
  v_lshl_add_u32 v28, v18, 7, v14
  v_mfma_f32_16x16x32_bf16 v[200:203], v[52:55], v[92:95], v[200:203]
  v_mfma_f32_16x16x32_bf16 v[196:199], v[52:55], v[88:91], v[196:199]
  v_mfma_f32_16x16x32_bf16 v[192:195], v[52:55], v[84:87], v[192:195]
  v_lshl_add_u32 v29, v22, 7, v15
  v_mfma_f32_16x16x32_bf16 v[188:191], v[52:55], v[80:83], v[188:191]
  v_mfma_f32_16x16x32_bf16 v[204:207], v[56:59], v[80:83], v[204:207]
  v_lshl_add_u32 v30, v19, 7, v14
  v_mfma_f32_16x16x32_bf16 v[208:211], v[56:59], v[84:87], v[208:211]
  s_waitcnt vmcnt(4) lgkmcnt(0)
  v_mfma_f32_16x16x32_bf16 v[212:215], v[56:59], v[88:91], v[212:215]
  v_lshl_add_u32 v31, v23, 7, v15
  v_mfma_f32_16x16x32_bf16 v[216:219], v[56:59], v[92:95], v[216:219]
  s_barrier
  ds_read_b128 v[80:83], v11 offset:16384
  s_add_u32 m0, s75, 65536
  s_nop 0
  buffer_load_dwordx4 v32, s[44:47], s74 offen offset:0 lds
  ds_read_b128 v[84:87], v11 offset:18432
  ds_read_b128 v[88:91], v11 offset:20480
  ds_read_b128 v[92:95], v11 offset:22528
  ds_read_b64_tr_b16 v[40:41], v6 offset:0
  buffer_load_dwordx4 v33, s[44:47], s74 offen offset:1024 lds
  s_add_u32 s74, s74, 106496
  ds_read_b64_tr_b16 v[42:43], v6 offset:2560
  ds_read_b64_tr_b16 v[44:45], v7 offset:0
  ds_read_b64_tr_b16 v[46:47], v7 offset:2560
  ds_read_b64_tr_b16 v[48:49], v8 offset:0
  ds_read_b64_tr_b16 v[50:51], v8 offset:2560
  s_add_u32 m0, s76, 49152
  s_nop 0
  buffer_load_dwordx4 v24, s[32:35], 0 offen lds
  ds_read_b64_tr_b16 v[52:53], v9 offset:0
  ds_read_b64_tr_b16 v[54:55], v9 offset:2560
  ds_read_b64_tr_b16 v[56:57], v10 offset:0
  ds_read_b64_tr_b16 v[58:59], v10 offset:2560
  buffer_load_dwordx4 v[16:19], v13, s[28:31], s73 offen offset:0
  buffer_load_dwordx4 v[20:23], v13, s[28:31], s73 offen offset:832
  s_add_u32 s73, s73, 16
  v_mfma_f32_16x16x32_bf16 v[140:143], v[60:63], v[96:99], v[140:143]
  v_mfma_f32_16x16x32_bf16 v[144:147], v[60:63], v[100:103], v[144:147]
  v_mfma_f32_16x16x32_bf16 v[148:151], v[60:63], v[104:107], v[148:151]
  v_mfma_f32_16x16x32_bf16 v[152:155], v[60:63], v[108:111], v[152:155]
  v_mfma_f32_16x16x32_bf16 v[168:171], v[64:67], v[108:111], v[168:171]
  v_mfma_f32_16x16x32_bf16 v[164:167], v[64:67], v[104:107], v[164:167]
  v_mfma_f32_16x16x32_bf16 v[160:163], v[64:67], v[100:103], v[160:163]
  v_mfma_f32_16x16x32_bf16 v[156:159], v[64:67], v[96:99], v[156:159]
  v_mfma_f32_16x16x32_bf16 v[172:175], v[68:71], v[96:99], v[172:175]
  v_mfma_f32_16x16x32_bf16 v[176:179], v[68:71], v[100:103], v[176:179]
  v_mfma_f32_16x16x32_bf16 v[180:183], v[68:71], v[104:107], v[180:183]
  v_mfma_f32_16x16x32_bf16 v[184:187], v[68:71], v[108:111], v[184:187]
  v_mfma_f32_16x16x32_bf16 v[200:203], v[72:75], v[108:111], v[200:203]
  v_mfma_f32_16x16x32_bf16 v[196:199], v[72:75], v[104:107], v[196:199]
  v_mfma_f32_16x16x32_bf16 v[192:195], v[72:75], v[100:103], v[192:195]
  v_mfma_f32_16x16x32_bf16 v[188:191], v[72:75], v[96:99], v[188:191]
  v_mfma_f32_16x16x32_bf16 v[204:207], v[76:79], v[96:99], v[204:207]
  v_mfma_f32_16x16x32_bf16 v[208:211], v[76:79], v[100:103], v[208:211]
  s_waitcnt vmcnt(6) lgkmcnt(0)
  v_mfma_f32_16x16x32_bf16 v[212:215], v[76:79], v[104:107], v[212:215]
  v_mfma_f32_16x16x32_bf16 v[216:219], v[76:79], v[108:111], v[216:219]
  s_barrier
  ds_read_b128 v[96:99], v12 offset:16384
  s_add_u32 m0, s75, 86016
  s_nop 0
  buffer_load_dwordx4 v32, s[44:47], s74 offen offset:0 lds
  ds_read_b128 v[100:103], v12 offset:18432
  ds_read_b128 v[104:107], v12 offset:20480
  ds_read_b128 v[108:111], v12 offset:22528
  ds_read_b64_tr_b16 v[60:61], v6 offset:20480
  buffer_load_dwordx4 v33, s[44:47], s74 offen offset:1024 lds
  s_add_u32 s74, s74, 106496
  ds_read_b64_tr_b16 v[62:63], v6 offset:23040
  ds_read_b64_tr_b16 v[64:65], v7 offset:20480
  ds_read_b64_tr_b16 v[66:67], v7 offset:23040
  ds_read_b64_tr_b16 v[68:69], v8 offset:20480
  ds_read_b64_tr_b16 v[70:71], v8 offset:23040
  s_add_u32 m0, s76, 50176
  s_nop 0
  buffer_load_dwordx4 v25, s[32:35], 0 offen lds
  ds_read_b64_tr_b16 v[72:73], v9 offset:20480
  ds_read_b64_tr_b16 v[74:75], v9 offset:23040
  ds_read_b64_tr_b16 v[76:77], v10 offset:20480
  ds_read_b64_tr_b16 v[78:79], v10 offset:23040
  v_mfma_f32_16x16x32_bf16 v[140:143], v[40:43], v[80:83], v[140:143]
  v_mfma_f32_16x16x32_bf16 v[144:147], v[40:43], v[84:87], v[144:147]
  v_mfma_f32_16x16x32_bf16 v[148:151], v[40:43], v[88:91], v[148:151]
  v_mfma_f32_16x16x32_bf16 v[152:155], v[40:43], v[92:95], v[152:155]
  v_mfma_f32_16x16x32_bf16 v[168:171], v[44:47], v[92:95], v[168:171]
  v_mfma_f32_16x16x32_bf16 v[164:167], v[44:47], v[88:91], v[164:167]
  v_mfma_f32_16x16x32_bf16 v[160:163], v[44:47], v[84:87], v[160:163]
  v_mfma_f32_16x16x32_bf16 v[156:159], v[44:47], v[80:83], v[156:159]
  v_mfma_f32_16x16x32_bf16 v[172:175], v[48:51], v[80:83], v[172:175]
  v_mfma_f32_16x16x32_bf16 v[176:179], v[48:51], v[84:87], v[176:179]
  v_mfma_f32_16x16x32_bf16 v[180:183], v[48:51], v[88:91], v[180:183]
  v_mfma_f32_16x16x32_bf16 v[184:187], v[48:51], v[92:95], v[184:187]
  v_mfma_f32_16x16x32_bf16 v[200:203], v[52:55], v[92:95], v[200:203]
  v_mfma_f32_16x16x32_bf16 v[196:199], v[52:55], v[88:91], v[196:199]
  v_mfma_f32_16x16x32_bf16 v[192:195], v[52:55], v[84:87], v[192:195]
  v_mfma_f32_16x16x32_bf16 v[188:191], v[52:55], v[80:83], v[188:191]
  v_mfma_f32_16x16x32_bf16 v[204:207], v[56:59], v[80:83], v[204:207]
  v_mfma_f32_16x16x32_bf16 v[208:211], v[56:59], v[84:87], v[208:211]
  s_waitcnt vmcnt(6) lgkmcnt(0)
  v_mfma_f32_16x16x32_bf16 v[212:215], v[56:59], v[88:91], v[212:215]
  v_mfma_f32_16x16x32_bf16 v[216:219], v[56:59], v[92:95], v[216:219]
  s_barrier
  ds_read_b128 v[80:83], v11 offset:32768
  s_add_u32 m0, s75, 106496
  s_nop 0
  buffer_load_dwordx4 v32, s[44:47], s74 offen offset:0 lds
  ds_read_b128 v[84:87], v11 offset:34816
  ds_read_b128 v[88:91], v11 offset:36864
  ds_read_b128 v[92:95], v11 offset:38912
  ds_read_b64_tr_b16 v[40:41], v1 offset:0
  buffer_load_dwordx4 v33, s[44:47], s74 offen offset:1024 lds
  s_add_u32 s74, s74, 106496
  ds_read_b64_tr_b16 v[42:43], v1 offset:2560
  ds_read_b64_tr_b16 v[44:45], v2 offset:0
  ds_read_b64_tr_b16 v[46:47], v2 offset:2560
  ds_read_b64_tr_b16 v[48:49], v3 offset:0
  ds_read_b64_tr_b16 v[50:51], v3 offset:2560
  s_add_u32 m0, s76, 0
  s_nop 0
  buffer_load_dwordx4 v26, s[32:35], 0 offen lds
  ds_read_b64_tr_b16 v[52:53], v4 offset:0
  ds_read_b64_tr_b16 v[54:55], v4 offset:2560
  ds_read_b64_tr_b16 v[56:57], v5 offset:0
  ds_read_b64_tr_b16 v[58:59], v5 offset:2560
  v_mfma_f32_16x16x32_bf16 v[140:143], v[60:63], v[96:99], v[140:143]
  v_mfma_f32_16x16x32_bf16 v[144:147], v[60:63], v[100:103], v[144:147]
  v_mfma_f32_16x16x32_bf16 v[148:151], v[60:63], v[104:107], v[148:151]
  v_mfma_f32_16x16x32_bf16 v[152:155], v[60:63], v[108:111], v[152:155]
  v_mfma_f32_16x16x32_bf16 v[168:171], v[64:67], v[108:111], v[168:171]
  v_mfma_f32_16x16x32_bf16 v[164:167], v[64:67], v[104:107], v[164:167]
  v_mfma_f32_16x16x32_bf16 v[160:163], v[64:67], v[100:103], v[160:163]
  v_mfma_f32_16x16x32_bf16 v[156:159], v[64:67], v[96:99], v[156:159]
  v_mfma_f32_16x16x32_bf16 v[172:175], v[68:71], v[96:99], v[172:175]
  v_mfma_f32_16x16x32_bf16 v[176:179], v[68:71], v[100:103], v[176:179]
  v_mfma_f32_16x16x32_bf16 v[180:183], v[68:71], v[104:107], v[180:183]
  v_mfma_f32_16x16x32_bf16 v[184:187], v[68:71], v[108:111], v[184:187]
  v_mfma_f32_16x16x32_bf16 v[200:203], v[72:75], v[108:111], v[200:203]
  v_mfma_f32_16x16x32_bf16 v[196:199], v[72:75], v[104:107], v[196:199]
  v_mfma_f32_16x16x32_bf16 v[192:195], v[72:75], v[100:103], v[192:195]
  v_mfma_f32_16x16x32_bf16 v[188:191], v[72:75], v[96:99], v[188:191]
  v_mfma_f32_16x16x32_bf16 v[204:207], v[76:79], v[96:99], v[204:207]
  v_mfma_f32_16x16x32_bf16 v[208:211], v[76:79], v[100:103], v[208:211]
  s_waitcnt vmcnt(4) lgkmcnt(0)
  v_mfma_f32_16x16x32_bf16 v[212:215], v[76:79], v[104:107], v[212:215]
  v_mfma_f32_16x16x32_bf16 v[216:219], v[76:79], v[108:111], v[216:219]
  s_barrier
  ds_read_b128 v[96:99], v12 offset:32768
  s_add_u32 m0, s75, 126976
  s_nop 0
  buffer_load_dwordx4 v32, s[44:47], s74 offen offset:0 lds
  ds_read_b128 v[100:103], v12 offset:34816
  ds_read_b128 v[104:107], v12 offset:36864
  ds_read_b128 v[108:111], v12 offset:38912
  ds_read_b64_tr_b16 v[60:61], v1 offset:20480
  buffer_load_dwordx4 v33, s[44:47], s74 offen offset:1024 lds
  s_add_u32 s74, s74, 106496
  ds_read_b64_tr_b16 v[62:63], v1 offset:23040
  ds_read_b64_tr_b16 v[64:65], v2 offset:20480
  ds_read_b64_tr_b16 v[66:67], v2 offset:23040
  ds_read_b64_tr_b16 v[68:69], v3 offset:20480
  ds_read_b64_tr_b16 v[70:71], v3 offset:23040
  s_add_u32 m0, s76, 1024
  s_nop 0
  buffer_load_dwordx4 v27, s[32:35], 0 offen lds
  ds_read_b64_tr_b16 v[72:73], v4 offset:20480
  ds_read_b64_tr_b16 v[74:75], v4 offset:23040
  ds_read_b64_tr_b16 v[76:77], v5 offset:20480
  ds_read_b64_tr_b16 v[78:79], v5 offset:23040
  s_mov_b32 m0, 148096
  s_mov_b32 exec_hi, 0xff
  buffer_load_dwordx4 v37, s[52:55], s77 offen lds
  s_mov_b64 exec, -1
  v_mfma_f32_16x16x32_bf16 v[140:143], v[40:43], v[80:83], v[140:143]
  v_mfma_f32_16x16x32_bf16 v[144:147], v[40:43], v[84:87], v[144:147]
  v_mfma_f32_16x16x32_bf16 v[148:151], v[40:43], v[88:91], v[148:151]
  v_mfma_f32_16x16x32_bf16 v[152:155], v[40:43], v[92:95], v[152:155]
  v_mfma_f32_16x16x32_bf16 v[168:171], v[44:47], v[92:95], v[168:171]
  v_mfma_f32_16x16x32_bf16 v[164:167], v[44:47], v[88:91], v[164:167]
  v_mfma_f32_16x16x32_bf16 v[160:163], v[44:47], v[84:87], v[160:163]
  v_mfma_f32_16x16x32_bf16 v[156:159], v[44:47], v[80:83], v[156:159]
  v_mfma_f32_16x16x32_bf16 v[172:175], v[48:51], v[80:83], v[172:175]
  v_mfma_f32_16x16x32_bf16 v[176:179], v[48:51], v[84:87], v[176:179]
  v_mfma_f32_16x16x32_bf16 v[180:183], v[48:51], v[88:91], v[180:183]
  v_mfma_f32_16x16x32_bf16 v[184:187], v[48:51], v[92:95], v[184:187]
  v_mfma_f32_16x16x32_bf16 v[200:203], v[52:55], v[92:95], v[200:203]
  v_mfma_f32_16x16x32_bf16 v[196:199], v[52:55], v[88:91], v[196:199]
  v_mfma_f32_16x16x32_bf16 v[192:195], v[52:55], v[84:87], v[192:195]
  v_mfma_f32_16x16x32_bf16 v[188:191], v[52:55], v[80:83], v[188:191]
  v_mfma_f32_16x16x32_bf16 v[204:207], v[56:59], v[80:83], v[204:207]
  v_mfma_f32_16x16x32_bf16 v[208:211], v[56:59], v[84:87], v[208:211]
  s_waitcnt vmcnt(5) lgkmcnt(0)
  v_mfma_f32_16x16x32_bf16 v[212:215], v[56:59], v[88:91], v[212:215]
  v_mfma_f32_16x16x32_bf16 v[216:219], v[56:59], v[92:95], v[216:219]
  s_barrier
  ds_read_b128 v[80:83], v11 offset:49152
  s_add_u32 m0, s75, 65536
  s_nop 0
  buffer_load_dwordx4 v32, s[44:47], s74 offen offset:0 lds
  ds_read_b128 v[84:87], v11 offset:51200
  ds_read_b128 v[88:91], v11 offset:53248
  ds_read_b128 v[92:95], v11 offset:55296
  ds_read_b64_tr_b16 v[40:41], v6 offset:0
  buffer_load_dwordx4 v33, s[44:47], s74 offen offset:1024 lds
  s_add_u32 s74, s74, 106496
  ds_read_b64_tr_b16 v[42:43], v6 offset:2560
  ds_read_b64_tr_b16 v[44:45], v7 offset:0
  ds_read_b64_tr_b16 v[46:47], v7 offset:2560
  ds_read_b64_tr_b16 v[48:49], v8 offset:0
  ds_read_b64_tr_b16 v[50:51], v8 offset:2560
  s_add_u32 m0, s76, 16384
  s_nop 0
  buffer_load_dwordx4 v28, s[32:35], 0 offen lds
  ds_read_b64_tr_b16 v[52:53], v9 offset:0
  ds_read_b64_tr_b16 v[54:55], v9 offset:2560
  ds_read_b64_tr_b16 v[56:57], v10 offset:0
  ds_read_b64_tr_b16 v[58:59], v10 offset:2560
  v_mfma_f32_16x16x32_bf16 v[140:143], v[60:63], v[96:99], v[140:143]
  v_mfma_f32_16x16x32_bf16 v[144:147], v[60:63], v[100:103], v[144:147]
  v_mfma_f32_16x16x32_bf16 v[148:151], v[60:63], v[104:107], v[148:151]
  v_mfma_f32_16x16x32_bf16 v[152:155], v[60:63], v[108:111], v[152:155]
  v_mfma_f32_16x16x32_bf16 v[168:171], v[64:67], v[108:111], v[168:171]
  v_mfma_f32_16x16x32_bf16 v[164:167], v[64:67], v[104:107], v[164:167]
  v_mfma_f32_16x16x32_bf16 v[160:163], v[64:67], v[100:103], v[160:163]
  v_mfma_f32_16x16x32_bf16 v[156:159], v[64:67], v[96:99], v[156:159]
  v_mfma_f32_16x16x32_bf16 v[172:175], v[68:71], v[96:99], v[172:175]
  v_mfma_f32_16x16x32_bf16 v[176:179], v[68:71], v[100:103], v[176:179]
  v_mfma_f32_16x16x32_bf16 v[180:183], v[68:71], v[104:107], v[180:183]
  v_mfma_f32_16x16x32_bf16 v[184:187], v[68:71], v[108:111], v[184:187]
  v_mfma_f32_16x16x32_bf16 v[200:203], v[72:75], v[108:111], v[200:203]
  v_mfma_f32_16x16x32_bf16 v[196:199], v[72:75], v[104:107], v[196:199]
  v_mfma_f32_16x16x32_bf16 v[192:195], v[72:75], v[100:103], v[192:195]
  v_mfma_f32_16x16x32_bf16 v[188:191], v[72:75], v[96:99], v[188:191]
  v_mfma_f32_16x16x32_bf16 v[204:207], v[76:79], v[96:99], v[204:207]
  v_mfma_f32_16x16x32_bf16 v[208:211], v[76:79], v[100:103], v[208:211]
  s_waitcnt vmcnt(5) lgkmcnt(0)
  v_mfma_f32_16x16x32_bf16 v[212:215], v[76:79], v[104:107], v[212:215]
  v_mfma_f32_16x16x32_bf16 v[216:219], v[76:79], v[108:111], v[216:219]
  s_barrier
  ds_read_b128 v[96:99], v12 offset:49152
  s_add_u32 m0, s75, 86016
  s_nop 0
  buffer_load_dwordx4 v32, s[44:47], s74 offen offset:0 lds
  ds_read_b128 v[100:103], v12 offset:51200
  ds_read_b128 v[104:107], v12 offset:53248
  ds_read_b128 v[108:111], v12 offset:55296
  ds_read_b64_tr_b16 v[60:61], v6 offset:20480
  buffer_load_dwordx4 v33, s[44:47], s74 offen offset:1024 lds
  s_add_u32 s74, s74, 106496
  ds_read_b64_tr_b16 v[62:63], v6 offset:23040
  ds_read_b64_tr_b16 v[64:65], v7 offset:20480
  ds_read_b64_tr_b16 v[66:67], v7 offset:23040
  ds_read_b64_tr_b16 v[68:69], v8 offset:20480
  ds_read_b64_tr_b16 v[70:71], v8 offset:23040
  s_add_u32 m0, s76, 17408
  s_nop 0
  buffer_load_dwordx4 v29, s[32:35], 0 offen lds
  ds_read_b64_tr_b16 v[72:73], v9 offset:20480
  ds_read_b64_tr_b16 v[74:75], v9 offset:23040
  ds_read_b64_tr_b16 v[76:77], v10 offset:20480
  ds_read_b64_tr_b16 v[78:79], v10 offset:23040
  v_mfma_f32_16x16x32_bf16 v[140:143], v[40:43], v[80:83], v[140:143]
  v_mfma_f32_16x16x32_bf16 v[144:147], v[40:43], v[84:87], v[144:147]
  v_mfma_f32_16x16x32_bf16 v[148:151], v[40:43], v[88:91], v[148:151]
  v_mfma_f32_16x16x32_bf16 v[152:155], v[40:43], v[92:95], v[152:155]
  v_mfma_f32_16x16x32_bf16 v[168:171], v[44:47], v[92:95], v[168:171]
  v_mfma_f32_16x16x32_bf16 v[164:167], v[44:47], v[88:91], v[164:167]
  v_mfma_f32_16x16x32_bf16 v[160:163], v[44:47], v[84:87], v[160:163]
  v_mfma_f32_16x16x32_bf16 v[156:159], v[44:47], v[80:83], v[156:159]
  v_mfma_f32_16x16x32_bf16 v[172:175], v[48:51], v[80:83], v[172:175]
  v_mfma_f32_16x16x32_bf16 v[176:179], v[48:51], v[84:87], v[176:179]
  v_mfma_f32_16x16x32_bf16 v[180:183], v[48:51], v[88:91], v[180:183]
  v_mfma_f32_16x16x32_bf16 v[184:187], v[48:51], v[92:95], v[184:187]
  v_mfma_f32_16x16x32_bf16 v[200:203], v[52:55], v[92:95], v[200:203]
  v_mfma_f32_16x16x32_bf16 v[196:199], v[52:55], v[88:91], v[196:199]
  v_mfma_f32_16x16x32_bf16 v[192:195], v[52:55], v[84:87], v[192:195]
  v_mfma_f32_16x16x32_bf16 v[188:191], v[52:55], v[80:83], v[188:191]
  v_mfma_f32_16x16x32_bf16 v[204:207], v[56:59], v[80:83], v[204:207]
  v_mfma_f32_16x16x32_bf16 v[208:211], v[56:59], v[84:87], v[208:211]
  s_waitcnt vmcnt(4) lgkmcnt(0)
  v_mfma_f32_16x16x32_bf16 v[212:215], v[56:59], v[88:91], v[212:215]
  v_mfma_f32_16x16x32_bf16 v[216:219], v[56:59], v[92:95], v[216:219]
  s_barrier
  ds_read_b128 v[80:83], v11 offset:0
  s_add_u32 m0, s75, 106496
  s_nop 0
  buffer_load_dwordx4 v32, s[44:47], s74 offen offset:0 lds
  ds_read_b128 v[84:87], v11 offset:2048
  ds_read_b128 v[88:91], v11 offset:4096
  ds_read_b128 v[92:95], v11 offset:6144
  ds_read_b64_tr_b16 v[40:41], v1 offset:0
  buffer_load_dwordx4 v33, s[44:47], s74 offen offset:1024 lds
  s_add_u32 s74, s74, 106496
  ds_read_b64_tr_b16 v[42:43], v1 offset:2560
  ds_read_b64_tr_b16 v[44:45], v2 offset:0
  ds_read_b64_tr_b16 v[46:47], v2 offset:2560
  ds_read_b64_tr_b16 v[48:49], v3 offset:0
  ds_read_b64_tr_b16 v[50:51], v3 offset:2560
  s_add_u32 m0, s76, 32768
  s_nop 0
  buffer_load_dwordx4 v30, s[32:35], 0 offen lds
  ds_read_b64_tr_b16 v[52:53], v4 offset:0
  ds_read_b64_tr_b16 v[54:55], v4 offset:2560
  ds_read_b64_tr_b16 v[56:57], v5 offset:0
  ds_read_b64_tr_b16 v[58:59], v5 offset:2560
  s_add_u32 s72, s72, 1
  s_cmp_lt_u32 s72, 6
  v_mfma_f32_16x16x32_bf16 v[140:143], v[60:63], v[96:99], v[140:143]
  v_mfma_f32_16x16x32_bf16 v[144:147], v[60:63], v[100:103], v[144:147]
  v_mfma_f32_16x16x32_bf16 v[148:151], v[60:63], v[104:107], v[148:151]
  v_mfma_f32_16x16x32_bf16 v[152:155], v[60:63], v[108:111], v[152:155]
  v_mfma_f32_16x16x32_bf16 v[168:171], v[64:67], v[108:111], v[168:171]
  v_mfma_f32_16x16x32_bf16 v[164:167], v[64:67], v[104:107], v[164:167]
  v_mfma_f32_16x16x32_bf16 v[160:163], v[64:67], v[100:103], v[160:163]
  v_mfma_f32_16x16x32_bf16 v[156:159], v[64:67], v[96:99], v[156:159]
  v_mfma_f32_16x16x32_bf16 v[172:175], v[68:71], v[96:99], v[172:175]
  v_mfma_f32_16x16x32_bf16 v[176:179], v[68:71], v[100:103], v[176:179]
  v_mfma_f32_16x16x32_bf16 v[180:183], v[68:71], v[104:107], v[180:183]
  v_mfma_f32_16x16x32_bf16 v[184:187], v[68:71], v[108:111], v[184:187]
  v_mfma_f32_16x16x32_bf16 v[200:203], v[72:75], v[108:111], v[200:203]
  v_mfma_f32_16x16x32_bf16 v[196:199], v[72:75], v[104:107], v[196:199]
  v_mfma_f32_16x16x32_bf16 v[192:195], v[72:75], v[100:103], v[192:195]
  v_mfma_f32_16x16x32_bf16 v[188:191], v[72:75], v[96:99], v[188:191]
  v_mfma_f32_16x16x32_bf16 v[204:207], v[76:79], v[96:99], v[204:207]
  v_mfma_f32_16x16x32_bf16 v[208:211], v[76:79], v[100:103], v[208:211]
  s_waitcnt vmcnt(4) lgkmcnt(0)
  v_mfma_f32_16x16x32_bf16 v[212:215], v[76:79], v[104:107], v[212:215]
  v_mfma_f32_16x16x32_bf16 v[216:219], v[76:79], v[108:111], v[216:219]
  s_cbranch_scc1 L_dnn_loop1
  s_barrier
  ds_read_b128 v[96:99], v12 offset:0
  s_add_u32 m0, s75, 126976
  s_nop 0
  buffer_load_dwordx4 v32, s[44:47], s74 offen offset:0 lds
  ds_read_b128 v[100:103], v12 offset:2048
  ds_read_b128 v[104:107], v12 offset:4096
  ds_read_b128 v[108:111], v12 offset:6144
  ds_read_b64_tr_b16 v[60:61], v1 offset:20480
  ds_read_b64_tr_b16 v[62:63], v1 offset:23040
  ds_read_b64_tr_b16 v[64:65], v2 offset:20480
  ds_read_b64_tr_b16 v[66:67], v2 offset:23040
  ds_read_b64_tr_b16 v[68:69], v3 offset:20480
  ds_read_b64_tr_b16 v[70:71], v3 offset:23040
  buffer_load_dwordx4 v33, s[44:47], s74 offen offset:1024 lds
  s_add_u32 s74, s74, 106496
  ds_read_b64_tr_b16 v[72:73], v4 offset:20480
  ds_read_b64_tr_b16 v[74:75], v4 offset:23040
  ds_read_b64_tr_b16 v[76:77], v5 offset:20480
  ds_read_b64_tr_b16 v[78:79], v5 offset:23040
  ds_read_b64 v[220:221], v35 offset:640
  ds_read_b64 v[222:223], v35 offset:672
  ds_read_b64 v[224:225], v35 offset:704
  ds_read_b64 v[226:227], v35 offset:736
  ds_read_b64 v[228:229], v35 offset:768
  v_mfma_f32_16x16x32_bf16 v[140:143], v[40:43], v[80:83], v[140:143]
  v_mfma_f32_16x16x32_bf16 v[144:147], v[40:43], v[84:87], v[144:147]
  v_mfma_f32_16x16x32_bf16 v[148:151], v[40:43], v[88:91], v[148:151]
  v_mfma_f32_16x16x32_bf16 v[152:155], v[40:43], v[92:95], v[152:155]
  v_mov_b32 v232, 0xc0135761
  v_mfma_f32_16x16x32_bf16 v[168:171], v[44:47], v[92:95], v[168:171]
  v_mfma_f32_16x16x32_bf16 v[164:167], v[44:47], v[88:91], v[164:167]
  v_mfma_f32_16x16x32_bf16 v[160:163], v[44:47], v[84:87], v[160:163]
  v_mfma_f32_16x16x32_bf16 v[156:159], v[44:47], v[80:83], v[156:159]
  v_mov_b32 v233, 0xc0135761
  v_mfma_f32_16x16x32_bf16 v[172:175], v[48:51], v[80:83], v[172:175]
  v_mfma_f32_16x16x32_bf16 v[176:179], v[48:51], v[84:87], v[176:179]
  v_mfma_f32_16x16x32_bf16 v[180:183], v[48:51], v[88:91], v[180:183]
  v_mfma_f32_16x16x32_bf16 v[184:187], v[48:51], v[92:95], v[184:187]
  v_mov_b32 v234, 0xbdd2d3e8
  v_mfma_f32_16x16x32_bf16 v[200:203], v[52:55], v[92:95], v[200:203]
  v_mfma_f32_16x16x32_bf16 v[196:199], v[52:55], v[88:91], v[196:199]
  v_mfma_f32_16x16x32_bf16 v[192:195], v[52:55], v[84:87], v[192:195]
  v_mfma_f32_16x16x32_bf16 v[188:191], v[52:55], v[80:83], v[188:191]
  v_mov_b32 v235, 0xbdd2d3e8
  v_mfma_f32_16x16x32_bf16 v[204:207], v[56:59], v[80:83], v[204:207]
  v_mfma_f32_16x16x32_bf16 v[208:211], v[56:59], v[84:87], v[208:211]
  s_waitcnt vmcnt(3) lgkmcnt(0)
  v_mfma_f32_16x16x32_bf16 v[212:215], v[56:59], v[88:91], v[212:215]
  v_mov_b32 v236, 0x71800000
  v_mfma_f32_16x16x32_bf16 v[216:219], v[56:59], v[92:95], v[216:219]
  s_barrier
  ds_read_b128 v[80:83], v11 offset:16384
  ds_read_b128 v[84:87], v11 offset:18432
  ds_read_b128 v[88:91], v11 offset:20480
  ds_read_b128 v[92:95], v11 offset:22528
  ds_read_b64_tr_b16 v[40:41], v6 offset:0
  ds_read_b64_tr_b16 v[42:43], v6 offset:2560
  ds_read_b64_tr_b16 v[44:45], v7 offset:0
  ds_read_b64_tr_b16 v[46:47], v7 offset:2560
  ds_read_b64_tr_b16 v[48:49], v8 offset:0
  ds_read_b64_tr_b16 v[50:51], v8 offset:2560
  ds_read_b64_tr_b16 v[52:53], v9 offset:0
  ds_read_b64_tr_b16 v[54:55], v9 offset:2560
  ds_read_b64_tr_b16 v[56:57], v10 offset:0
  ds_read_b64_tr_b16 v[58:59], v10 offset:2560
  v_mfma_f32_16x16x32_bf16 v[140:143], v[60:63], v[96:99], v[140:143]
  v_lshlrev_b32 v112, 16, v220
  v_mfma_f32_16x16x32_bf16 v[144:147], v[60:63], v[100:103], v[144:147]
  v_and_b32 v113, 0xffff0000, v220
  v_mfma_f32_16x16x32_bf16 v[148:151], v[60:63], v[104:107], v[148:151]
  v_lshlrev_b32 v114, 16, v221
  v_mfma_f32_16x16x32_bf16 v[152:155], v[60:63], v[108:111], v[152:155]
  v_and_b32 v115, 0xffff0000, v221
  v_lshlrev_b32 v116, 16, v222
  v_mfma_f32_16x16x32_bf16 v[168:171], v[64:67], v[108:111], v[168:171]
  v_and_b32 v117, 0xffff0000, v222
  v_mfma_f32_16x16x32_bf16 v[164:167], v[64:67], v[104:107], v[164:167]
  v_lshlrev_b32 v118, 16, v223
  v_mfma_f32_16x16x32_bf16 v[160:163], v[64:67], v[100:103], v[160:163]
  v_and_b32 v119, 0xffff0000, v223
  v_mfma_f32_16x16x32_bf16 v[156:159], v[64:67], v[96:99], v[156:159]
  v_lshlrev_b32 v120, 16, v224
  v_and_b32 v121, 0xffff0000, v224
  v_mfma_f32_16x16x32_bf16 v[172:175], v[68:71], v[96:99], v[172:175]
  v_lshlrev_b32 v122, 16, v225
  v_mfma_f32_16x16x32_bf16 v[176:179], v[68:71], v[100:103], v[176:179]
  v_and_b32 v123, 0xffff0000, v225
  v_mfma_f32_16x16x32_bf16 v[180:183], v[68:71], v[104:107], v[180:183]
  v_lshlrev_b32 v124, 16, v226
  v_mfma_f32_16x16x32_bf16 v[184:187], v[68:71], v[108:111], v[184:187]
  v_and_b32 v125, 0xffff0000, v226
  v_lshlrev_b32 v126, 16, v227
  v_mfma_f32_16x16x32_bf16 v[200:203], v[72:75], v[108:111], v[200:203]
  v_and_b32 v127, 0xffff0000, v227
  v_mfma_f32_16x16x32_bf16 v[196:199], v[72:75], v[104:107], v[196:199]
  v_lshlrev_b32 v128, 16, v228
  v_mfma_f32_16x16x32_bf16 v[192:195], v[72:75], v[100:103], v[192:195]
  v_and_b32 v129, 0xffff0000, v228
  v_mfma_f32_16x16x32_bf16 v[188:191], v[72:75], v[96:99], v[188:191]
  v_lshlrev_b32 v130, 16, v229
  v_and_b32 v131, 0xffff0000, v229
  v_mfma_f32_16x16x32_bf16 v[204:207], v[76:79], v[96:99], v[204:207]
  v_rcp_f32 v112, v112
  v_mfma_f32_16x16x32_bf16 v[208:211], v[76:79], v[100:103], v[208:211]
  v_rcp_f32 v113, v113
  s_waitcnt vmcnt(0) lgkmcnt(0)
  v_mfma_f32_16x16x32_bf16 v[212:215], v[76:79], v[104:107], v[212:215]
  v_rcp_f32 v114, v114
  v_rcp_f32 v115, v115
  v_mfma_f32_16x16x32_bf16 v[216:219], v[76:79], v[108:111], v[216:219]
  s_barrier
  ds_read_b128 v[96:99], v12 offset:16384
  ds_read_b128 v[100:103], v12 offset:18432
  ds_read_b128 v[104:107], v12 offset:20480
  ds_read_b128 v[108:111], v12 offset:22528
  ds_read_b64_tr_b16 v[60:61], v6 offset:20480
  ds_read_b64_tr_b16 v[62:63], v6 offset:23040
  ds_read_b64_tr_b16 v[64:65], v7 offset:20480
  ds_read_b64_tr_b16 v[66:67], v7 offset:23040
  ds_read_b64_tr_b16 v[68:69], v8 offset:20480
  ds_read_b64_tr_b16 v[70:71], v8 offset:23040
  ds_read_b64_tr_b16 v[72:73], v9 offset:20480
  ds_read_b64_tr_b16 v[74:75], v9 offset:23040
  ds_read_b64_tr_b16 v[76:77], v10 offset:20480
  ds_read_b64_tr_b16 v[78:79], v10 offset:23040
  v_mfma_f32_16x16x32_bf16 v[140:143], v[40:43], v[80:83], v[140:143]
  v_mfma_f32_16x16x32_bf16 v[144:147], v[40:43], v[84:87], v[144:147]
  v_rcp_f32 v116, v116
  v_mfma_f32_16x16x32_bf16 v[148:151], v[40:43], v[88:91], v[148:151]
  v_rcp_f32 v117, v117
  v_mfma_f32_16x16x32_bf16 v[152:155], v[40:43], v[92:95], v[152:155]
  v_mfma_f32_16x16x32_bf16 v[168:171], v[44:47], v[92:95], v[168:171]
  v_rcp_f32 v118, v118
  v_mfma_f32_16x16x32_bf16 v[164:167], v[44:47], v[88:91], v[164:167]
  v_rcp_f32 v119, v119
  v_mfma_f32_16x16x32_bf16 v[160:163], v[44:47], v[84:87], v[160:163]
  v_rcp_f32 v120, v120
  v_mfma_f32_16x16x32_bf16 v[156:159], v[44:47], v[80:83], v[156:159]
  v_mfma_f32_16x16x32_bf16 v[172:175], v[48:51], v[80:83], v[172:175]
  v_rcp_f32 v121, v121
  v_mfma_f32_16x16x32_bf16 v[176:179], v[48:51], v[84:87], v[176:179]
  v_rcp_f32 v122, v122
  v_mfma_f32_16x16x32_bf16 v[180:183], v[48:51], v[88:91], v[180:183]
  v_rcp_f32 v123, v123
  v_mfma_f32_16x16x32_bf16 v[184:187], v[48:51], v[92:95], v[184:187]
  v_mfma_f32_16x16x32_bf16 v[200:203], v[52:55], v[92:95], v[200:203]
  v_rcp_f32 v124, v124
  v_mfma_f32_16x16x32_bf16 v[196:199], v[52:55], v[88:91], v[196:199]
  v_rcp_f32 v125, v125
  v_mfma_f32_16x16x32_bf16 v[192:195], v[52:55], v[84:87], v[192:195]
  v_rcp_f32 v126, v126
  v_mfma_f32_16x16x32_bf16 v[188:191], v[52:55], v[80:83], v[188:191]
  v_mfma_f32_16x16x32_bf16 v[204:207], v[56:59], v[80:83], v[204:207]
  v_rcp_f32 v127, v127
  v_mfma_f32_16x16x32_bf16 v[208:211], v[56:59], v[84:87], v[208:211]
  v_rcp_f32 v128, v128
  s_waitcnt lgkmcnt(0)
  v_mfma_f32_16x16x32_bf16 v[212:215], v[56:59], v[88:91], v[212:215]
  v_rcp_f32 v129, v129
  v_mfma_f32_16x16x32_bf16 v[216:219], v[56:59], v[92:95], v[216:219]
  s_setprio 3
  v_mfma_f32_16x16x32_bf16 v[140:143], v[60:63], v[96:99], v[140:143]
  v_rcp_f32 v130, v130
  v_mfma_f32_16x16x32_bf16 v[144:147], v[60:63], v[100:103], v[144:147]
  v_rcp_f32 v131, v131
  v_mfma_f32_16x16x32_bf16 v[148:151], v[60:63], v[104:107], v[148:151]
  v_med3_f32 v112, v112, -v236, v236
  v_mfma_f32_16x16x32_bf16 v[152:155], v[60:63], v[108:111], v[152:155]
  v_med3_f32 v113, v113, -v236, v236
  v_mfma_f32_16x16x32_bf16 v[168:171], v[64:67], v[108:111], v[168:171]
  v_med3_f32 v114, v114, -v236, v236
  v_mfma_f32_16x16x32_bf16 v[164:167], v[64:67], v[104:107], v[164:167]
  v_med3_f32 v115, v115, -v236, v236
  v_mfma_f32_16x16x32_bf16 v[160:163], v[64:67], v[100:103], v[160:163]
  v_med3_f32 v116, v116, -v236, v236
  v_med3_f32 v117, v117, -v236, v236
  v_mfma_f32_16x16x32_bf16 v[156:159], v[64:67], v[96:99], v[156:159]
  v_med3_f32 v118, v118, -v236, v236
  v_mfma_f32_16x16x32_bf16 v[172:175], v[68:71], v[96:99], v[172:175]
  v_med3_f32 v119, v119, -v236, v236
  v_mfma_f32_16x16x32_bf16 v[176:179], v[68:71], v[100:103], v[176:179]
  v_med3_f32 v120, v120, -v236, v236
  v_mfma_f32_16x16x32_bf16 v[180:183], v[68:71], v[104:107], v[180:183]
  v_med3_f32 v121, v121, -v236, v236
  v_mfma_f32_16x16x32_bf16 v[184:187], v[68:71], v[108:111], v[184:187]
  v_med3_f32 v122, v122, -v236, v236
  v_mfma_f32_16x16x32_bf16 v[200:203], v[72:75], v[108:111], v[200:203]
  v_med3_f32 v123, v123, -v236, v236
  v_med3_f32 v124, v124, -v236, v236
  v_mfma_f32_16x16x32_bf16 v[196:199], v[72:75], v[104:107], v[196:199]
  v_med3_f32 v125, v125, -v236, v236
  v_mfma_f32_16x16x32_bf16 v[192:195], v[72:75], v[100:103], v[192:195]
  v_med3_f32 v126, v126, -v236, v236
  v_mfma_f32_16x16x32_bf16 v[188:191], v[72:75], v[96:99], v[188:191]
  v_med3_f32 v127, v127, -v236, v236
  v_mfma_f32_16x16x32_bf16 v[204:207], v[76:79], v[96:99], v[204:207]
  v_med3_f32 v128, v128, -v236, v236
  v_mfma_f32_16x16x32_bf16 v[208:211], v[76:79], v[100:103], v[208:211]
  v_med3_f32 v129, v129, -v236, v236
  v_mfma_f32_16x16x32_bf16 v[212:215], v[76:79], v[104:107], v[212:215]
  v_med3_f32 v130, v130, -v236, v236
  v_med3_f32 v131, v131, -v236, v236
  v_mfma_f32_16x16x32_bf16 v[216:219], v[76:79], v[108:111], v[216:219]
  s_setprio 0
L_epi:
  s_lshl_b32 s69, s27, 11
  s_and_b32 s71, s26, 3
  s_lshl_b32 s71, s71, 9
  s_add_u32 s69, s69, s71
  s_lshr_b32 s68, s26, 2
  s_lshl_b32 s68, s68, 14
  s_add_u32 s69, s69, s68
  v_lshlrev_b32 v3, 3, v0
  v_add_u32 v2, 32768, v3
  v_pk_mul_f32 v[40:41], v[140:141], v[140:141]
  v_pk_mul_f32 v[44:45], v[144:145], v[144:145]
  v_pk_mul_f32 v[48:49], v[148:149], v[148:149]
  v_pk_mul_f32 v[52:53], v[152:153], v[152:153]
  v_pk_fma_f32 v[40:41], v[40:41], v[234:235], v[232:233]
  v_pk_fma_f32 v[44:45], v[44:45], v[234:235], v[232:233]
  v_pk_fma_f32 v[48:49], v[48:49], v[234:235], v[232:233]
  v_pk_fma_f32 v[52:53], v[52:53], v[234:235], v[232:233]
  v_pk_mul_f32 v[40:41], v[40:41], v[140:141]
  v_pk_mul_f32 v[44:45], v[44:45], v[144:145]
  v_pk_mul_f32 v[48:49], v[48:49], v[148:149]
  v_pk_mul_f32 v[52:53], v[52:53], v[152:153]
  v_exp_f32 v40, v40
  v_exp_f32 v41, v41
  v_exp_f32 v44, v44
  v_exp_f32 v45, v45
  v_exp_f32 v48, v48
  v_exp_f32 v49, v49
  v_exp_f32 v52, v52
  v_exp_f32 v53, v53
  v_pk_fma_f32 v[40:41], v[40:41], v[112:113], v[112:113]
  v_pk_fma_f32 v[44:45], v[44:45], v[112:113], v[112:113]
  v_pk_fma_f32 v[48:49], v[48:49], v[112:113], v[112:113]
  v_pk_fma_f32 v[52:53], v[52:53], v[112:113], v[112:113]
  v_rcp_f32 v40, v40
  v_rcp_f32 v41, v41
  v_rcp_f32 v44, v44
  v_rcp_f32 v45, v45
  v_rcp_f32 v48, v48
  v_rcp_f32 v49, v49
  v_rcp_f32 v52, v52
  v_rcp_f32 v53, v53
  v_pk_mul_f32 v[16:17], v[40:41], v[140:141]
  v_pk_mul_f32 v[18:19], v[44:45], v[144:145]
  v_pk_mul_f32 v[20:21], v[48:49], v[148:149]
  v_pk_mul_f32 v[22:23], v[52:53], v[152:153]
  v_pk_mul_f32 v[56:57], v[142:143], v[142:143]
  v_pk_mul_f32 v[60:61], v[146:147], v[146:147]
  v_pk_mul_f32 v[64:65], v[150:151], v[150:151]
  v_pk_mul_f32 v[68:69], v[154:155], v[154:155]
  v_pk_fma_f32 v[56:57], v[56:57], v[234:235], v[232:233]
  v_pk_fma_f32 v[60:61], v[60:61], v[234:235], v[232:233]
  v_pk_fma_f32 v[64:65], v[64:65], v[234:235], v[232:233]
  v_pk_fma_f32 v[68:69], v[68:69], v[234:235], v[232:233]
  v_pk_mul_f32 v[56:57], v[56:57], v[142:143]
  v_pk_mul_f32 v[60:61], v[60:61], v[146:147]
  v_pk_mul_f32 v[64:65], v[64:65], v[150:151]
  v_pk_mul_f32 v[68:69], v[68:69], v[154:155]
  v_exp_f32 v56, v56
  v_exp_f32 v57, v57
  v_exp_f32 v60, v60
  v_exp_f32 v61, v61
  v_exp_f32 v64, v64
  v_exp_f32 v65, v65
  v_exp_f32 v68, v68
  v_exp_f32 v69, v69
  v_pk_fma_f32 v[56:57], v[56:57], v[114:115], v[114:115]
  v_pk_fma_f32 v[60:61], v[60:61], v[114:115], v[114:115]
  v_pk_fma_f32 v[64:65], v[64:65], v[114:115], v[114:115]
  v_pk_fma_f32 v[68:69], v[68:69], v[114:115], v[114:115]
  v_rcp_f32 v56, v56
  v_rcp_f32 v57, v57
  v_rcp_f32 v60, v60
  v_rcp_f32 v61, v61
  v_rcp_f32 v64, v64
  v_rcp_f32 v65, v65
  v_rcp_f32 v68, v68
  v_rcp_f32 v69, v69
  v_pk_fma_f32 v[16:17], v[56:57], v[142:143], v[16:17]
  v_pk_fma_f32 v[18:19], v[60:61], v[146:147], v[18:19]
  v_pk_fma_f32 v[20:21], v[64:65], v[150:151], v[20:21]
  v_pk_fma_f32 v[22:23], v[68:69], v[154:155], v[22:23]
  v_pk_mul_f32 v[40:41], v[156:157], v[156:157]
  v_pk_mul_f32 v[44:45], v[160:161], v[160:161]
  v_pk_mul_f32 v[48:49], v[164:165], v[164:165]
  v_pk_mul_f32 v[52:53], v[168:169], v[168:169]
  v_pk_fma_f32 v[40:41], v[40:41], v[234:235], v[232:233]
  v_pk_fma_f32 v[44:45], v[44:45], v[234:235], v[232:233]
  v_pk_fma_f32 v[48:49], v[48:49], v[234:235], v[232:233]
  v_pk_fma_f32 v[52:53], v[52:53], v[234:235], v[232:233]
  v_pk_mul_f32 v[40:41], v[40:41], v[156:157]
  v_pk_mul_f32 v[44:45], v[44:45], v[160:161]
  v_pk_mul_f32 v[48:49], v[48:49], v[164:165]
  v_pk_mul_f32 v[52:53], v[52:53], v[168:169]
  v_exp_f32 v40, v40
  v_exp_f32 v41, v41
  v_exp_f32 v44, v44
  v_exp_f32 v45, v45
  v_exp_f32 v48, v48
  v_exp_f32 v49, v49
  v_exp_f32 v52, v52
  v_exp_f32 v53, v53
  v_pk_fma_f32 v[40:41], v[40:41], v[116:117], v[116:117]
  v_pk_fma_f32 v[44:45], v[44:45], v[116:117], v[116:117]
  v_pk_fma_f32 v[48:49], v[48:49], v[116:117], v[116:117]
  v_pk_fma_f32 v[52:53], v[52:53], v[116:117], v[116:117]
  v_rcp_f32 v40, v40
  v_rcp_f32 v41, v41
  v_rcp_f32 v44, v44
  v_rcp_f32 v45, v45
  v_rcp_f32 v48, v48
  v_rcp_f32 v49, v49
  v_rcp_f32 v52, v52
  v_rcp_f32 v53, v53
  v_pk_fma_f32 v[16:17], v[40:41], v[156:157], v[16:17]
  v_pk_fma_f32 v[18:19], v[44:45], v[160:161], v[18:19]
  v_pk_fma_f32 v[20:21], v[48:49], v[164:165], v[20:21]
  v_pk_fma_f32 v[22:23], v[52:53], v[168:169], v[22:23]
  v_pk_mul_f32 v[56:57], v[158:159], v[158:159]
  v_pk_mul_f32 v[60:61], v[162:163], v[162:163]
  v_pk_mul_f32 v[64:65], v[166:167], v[166:167]
  v_pk_mul_f32 v[68:69], v[170:171], v[170:171]
  v_pk_fma_f32 v[56:57], v[56:57], v[234:235], v[232:233]
  v_pk_fma_f32 v[60:61], v[60:61], v[234:235], v[232:233]
  v_pk_fma_f32 v[64:65], v[64:65], v[234:235], v[232:233]
  v_pk_fma_f32 v[68:69], v[68:69], v[234:235], v[232:233]
  v_pk_mul_f32 v[56:57], v[56:57], v[158:159]
  v_pk_mul_f32 v[60:61], v[60:61], v[162:163]
  v_pk_mul_f32 v[64:65], v[64:65], v[166:167]
  v_pk_mul_f32 v[68:69], v[68:69], v[170:171]
  v_exp_f32 v56, v56
  v_exp_f32 v57, v57
  v_exp_f32 v60, v60
  v_exp_f32 v61, v61
  v_exp_f32 v64, v64
  v_exp_f32 v65, v65
  v_exp_f32 v68, v68
  v_exp_f32 v69, v69
  v_pk_fma_f32 v[56:57], v[56:57], v[118:119], v[118:119]
  v_pk_fma_f32 v[60:61], v[60:61], v[118:119], v[118:119]
  v_pk_fma_f32 v[64:65], v[64:65], v[118:119], v[118:119]
  v_pk_fma_f32 v[68:69], v[68:69], v[118:119], v[118:119]
  v_rcp_f32 v56, v56
  v_rcp_f32 v57, v57
  v_rcp_f32 v60, v60
  v_rcp_f32 v61, v61
  v_rcp_f32 v64, v64
  v_rcp_f32 v65, v65
  v_rcp_f32 v68, v68
  v_rcp_f32 v69, v69
  v_pk_fma_f32 v[16:17], v[56:57], v[158:159], v[16:17]
  v_pk_fma_f32 v[18:19], v[60:61], v[162:163], v[18:19]
  v_pk_fma_f32 v[20:21], v[64:65], v[166:167], v[20:21]
  v_pk_fma_f32 v[22:23], v[68:69], v[170:171], v[22:23]
  v_pk_mul_f32 v[40:41], v[172:173], v[172:173]
  v_pk_mul_f32 v[44:45], v[176:177], v[176:177]
  v_pk_mul_f32 v[48:49], v[180:181], v[180:181]
  v_pk_mul_f32 v[52:53], v[184:185], v[184:185]
  v_pk_fma_f32 v[40:41], v[40:41], v[234:235], v[232:233]
  v_pk_fma_f32 v[44:45], v[44:45], v[234:235], v[232:233]
  v_pk_fma_f32 v[48:49], v[48:49], v[234:235], v[232:233]
  v_pk_fma_f32 v[52:53], v[52:53], v[234:235], v[232:233]
  v_pk_mul_f32 v[40:41], v[40:41], v[172:173]
  v_pk_mul_f32 v[44:45], v[44:45], v[176:177]
  v_pk_mul_f32 v[48:49], v[48:49], v[180:181]
  v_pk_mul_f32 v[52:53], v[52:53], v[184:185]
  v_exp_f32 v40, v40
  v_exp_f32 v41, v41
  v_exp_f32 v44, v44
  v_exp_f32 v45, v45
  v_exp_f32 v48, v48
  v_exp_f32 v49, v49
  v_exp_f32 v52, v52
  v_exp_f32 v53, v53
  v_pk_fma_f32 v[40:41], v[40:41], v[120:121], v[120:121]
  v_pk_fma_f32 v[44:45], v[44:45], v[120:121], v[120:121]
  v_pk_fma_f32 v[48:49], v[48:49], v[120:121], v[120:121]
  v_pk_fma_f32 v[52:53], v[52:53], v[120:121], v[120:121]
  v_rcp_f32 v40, v40
  v_rcp_f32 v41, v41
  v_rcp_f32 v44, v44
  v_rcp_f32 v45, v45
  v_rcp_f32 v48, v48
  v_rcp_f32 v49, v49
  v_rcp_f32 v52, v52
  v_rcp_f32 v53, v53
  v_pk_fma_f32 v[16:17], v[40:41], v[172:173], v[16:17]
  v_pk_fma_f32 v[18:19], v[44:45], v[176:177], v[18:19]
  v_pk_fma_f32 v[20:21], v[48:49], v[180:181], v[20:21]
  v_pk_fma_f32 v[22:23], v[52:53], v[184:185], v[22:23]
  v_pk_mul_f32 v[56:57], v[174:175], v[174:175]
  v_pk_mul_f32 v[60:61], v[178:179], v[178:179]
  v_pk_mul_f32 v[64:65], v[182:183], v[182:183]
  v_pk_mul_f32 v[68:69], v[186:187], v[186:187]
  v_pk_fma_f32 v[56:57], v[56:57], v[234:235], v[232:233]
  v_pk_fma_f32 v[60:61], v[60:61], v[234:235], v[232:233]
  v_pk_fma_f32 v[64:65], v[64:65], v[234:235], v[232:233]
  v_pk_fma_f32 v[68:69], v[68:69], v[234:235], v[232:233]
  v_pk_mul_f32 v[56:57], v[56:57], v[174:175]
  v_pk_mul_f32 v[60:61], v[60:61], v[178:179]
  v_pk_mul_f32 v[64:65], v[64:65], v[182:183]
  v_pk_mul_f32 v[68:69], v[68:69], v[186:187]
  v_exp_f32 v56, v56
  v_exp_f32 v57, v57
  v_exp_f32 v60, v60
  v_exp_f32 v61, v61
  v_exp_f32 v64, v64
  v_exp_f32 v65, v65
  v_exp_f32 v68, v68
  v_exp_f32 v69, v69
  v_pk_fma_f32 v[56:57], v[56:57], v[122:123], v[122:123]
  v_pk_fma_f32 v[60:61], v[60:61], v[122:123], v[122:123]
  v_pk_fma_f32 v[64:65], v[64:65], v[122:123], v[122:123]
  v_pk_fma_f32 v[68:69], v[68:69], v[122:123], v[122:123]
  v_rcp_f32 v56, v56
  v_rcp_f32 v57, v57
  v_rcp_f32 v60, v60
  v_rcp_f32 v61, v61
  v_rcp_f32 v64, v64
  v_rcp_f32 v65, v65
  v_rcp_f32 v68, v68
  v_rcp_f32 v69, v69
  v_pk_fma_f32 v[16:17], v[56:57], v[174:175], v[16:17]
  v_pk_fma_f32 v[18:19], v[60:61], v[178:179], v[18:19]
  v_pk_fma_f32 v[20:21], v[64:65], v[182:183], v[20:21]
  v_pk_fma_f32 v[22:23], v[68:69], v[186:187], v[22:23]
  v_pk_mul_f32 v[40:41], v[188:189], v[188:189]
  v_pk_mul_f32 v[44:45], v[192:193], v[192:193]
  v_pk_mul_f32 v[48:49], v[196:197], v[196:197]
  v_pk_mul_f32 v[52:53], v[200:201], v[200:201]
  v_pk_fma_f32 v[40:41], v[40:41], v[234:235], v[232:233]
  v_pk_fma_f32 v[44:45], v[44:45], v[234:235], v[232:233]
  v_pk_fma_f32 v[48:49], v[48:49], v[234:235], v[232:233]
  v_pk_fma_f32 v[52:53], v[52:53], v[234:235], v[232:233]
  v_pk_mul_f32 v[40:41], v[40:41], v[188:189]
  v_pk_mul_f32 v[44:45], v[44:45], v[192:193]
  v_pk_mul_f32 v[48:49], v[48:49], v[196:197]
  v_pk_mul_f32 v[52:53], v[52:53], v[200:201]
  v_exp_f32 v40, v40
  v_exp_f32 v41, v41
  v_exp_f32 v44, v44
  v_exp_f32 v45, v45
  v_exp_f32 v48, v48
  v_exp_f32 v49, v49
  v_exp_f32 v52, v52
  v_exp_f32 v53, v53
  v_pk_fma_f32 v[40:41], v[40:41], v[124:125], v[124:125]
  v_pk_fma_f32 v[44:45], v[44:45], v[124:125], v[124:125]
  v_pk_fma_f32 v[48:49], v[48:49], v[124:125], v[124:125]
  v_pk_fma_f32 v[52:53], v[52:53], v[124:125], v[124:125]
  v_rcp_f32 v40, v40
  v_rcp_f32 v41, v41
  v_rcp_f32 v44, v44
  v_rcp_f32 v45, v45
  v_rcp_f32 v48, v48
  v_rcp_f32 v49, v49
  v_rcp_f32 v52, v52
  v_rcp_f32 v53, v53
  v_pk_fma_f32 v[16:17], v[40:41], v[188:189], v[16:17]
  v_pk_fma_f32 v[18:19], v[44:45], v[192:193], v[18:19]
  v_pk_fma_f32 v[20:21], v[48:49], v[196:197], v[20:21]
  v_pk_fma_f32 v[22:23], v[52:53], v[200:201], v[22:23]
  v_pk_mul_f32 v[56:57], v[190:191], v[190:191]
  v_pk_mul_f32 v[60:61], v[194:195], v[194:195]
  v_pk_mul_f32 v[64:65], v[198:199], v[198:199]
  v_pk_mul_f32 v[68:69], v[202:203], v[202:203]
  v_pk_fma_f32 v[56:57], v[56:57], v[234:235], v[232:233]
  v_pk_fma_f32 v[60:61], v[60:61], v[234:235], v[232:233]
  v_pk_fma_f32 v[64:65], v[64:65], v[234:235], v[232:233]
  v_pk_fma_f32 v[68:69], v[68:69], v[234:235], v[232:233]
  v_pk_mul_f32 v[56:57], v[56:57], v[190:191]
  v_pk_mul_f32 v[60:61], v[60:61], v[194:195]
  v_pk_mul_f32 v[64:65], v[64:65], v[198:199]
  v_pk_mul_f32 v[68:69], v[68:69], v[202:203]
  v_exp_f32 v56, v56
  v_exp_f32 v57, v57
  v_exp_f32 v60, v60
  v_exp_f32 v61, v61
  v_exp_f32 v64, v64
  v_exp_f32 v65, v65
  v_exp_f32 v68, v68
  v_exp_f32 v69, v69
  v_pk_fma_f32 v[56:57], v[56:57], v[126:127], v[126:127]
  v_pk_fma_f32 v[60:61], v[60:61], v[126:127], v[126:127]
  v_pk_fma_f32 v[64:65], v[64:65], v[126:127], v[126:127]
  v_pk_fma_f32 v[68:69], v[68:69], v[126:127], v[126:127]
  v_rcp_f32 v56, v56
  v_rcp_f32 v57, v57
  v_rcp_f32 v60, v60
  v_rcp_f32 v61, v61
  v_rcp_f32 v64, v64
  v_rcp_f32 v65, v65
  v_rcp_f32 v68, v68
  v_rcp_f32 v69, v69
  v_pk_fma_f32 v[16:17], v[56:57], v[190:191], v[16:17]
  v_pk_fma_f32 v[18:19], v[60:61], v[194:195], v[18:19]
  v_pk_fma_f32 v[20:21], v[64:65], v[198:199], v[20:21]
  v_pk_fma_f32 v[22:23], v[68:69], v[202:203], v[22:23]
  v_pk_mul_f32 v[40:41], v[204:205], v[204:205]
  v_pk_mul_f32 v[44:45], v[208:209], v[208:209]
  v_pk_mul_f32 v[48:49], v[212:213], v[212:213]
  v_pk_mul_f32 v[52:53], v[216:217], v[216:217]
  v_pk_fma_f32 v[40:41], v[40:41], v[234:235], v[232:233]
  v_pk_fma_f32 v[44:45], v[44:45], v[234:235], v[232:233]
  v_pk_fma_f32 v[48:49], v[48:49], v[234:235], v[232:233]
  v_pk_fma_f32 v[52:53], v[52:53], v[234:235], v[232:233]
  v_pk_mul_f32 v[40:41], v[40:41], v[204:205]
  v_pk_mul_f32 v[44:45], v[44:45], v[208:209]
  v_pk_mul_f32 v[48:49], v[48:49], v[212:213]
  v_pk_mul_f32 v[52:53], v[52:53], v[216:217]
  v_exp_f32 v40, v40
  v_exp_f32 v41, v41
  v_exp_f32 v44, v44
  v_exp_f32 v45, v45
  v_exp_f32 v48, v48
  v_exp_f32 v49, v49
  v_exp_f32 v52, v52
  v_exp_f32 v53, v53
  v_pk_fma_f32 v[40:41], v[40:41], v[128:129], v[128:129]
  v_pk_fma_f32 v[44:45], v[44:45], v[128:129], v[128:129]
  v_pk_fma_f32 v[48:49], v[48:49], v[128:129], v[128:129]
  v_pk_fma_f32 v[52:53], v[52:53], v[128:129], v[128:129]
  v_rcp_f32 v40, v40
  v_rcp_f32 v41, v41
  v_rcp_f32 v44, v44
  v_rcp_f32 v45, v45
  v_rcp_f32 v48, v48
  v_rcp_f32 v49, v49
  v_rcp_f32 v52, v52
  v_rcp_f32 v53, v53
  v_pk_fma_f32 v[16:17], v[40:41], v[204:205], v[16:17]
  v_pk_fma_f32 v[18:19], v[44:45], v[208:209], v[18:19]
  v_pk_fma_f32 v[20:21], v[48:49], v[212:213], v[20:21]
  v_pk_fma_f32 v[22:23], v[52:53], v[216:217], v[22:23]
  v_pk_mul_f32 v[56:57], v[206:207], v[206:207]
  v_pk_mul_f32 v[60:61], v[210:211], v[210:211]
  v_pk_mul_f32 v[64:65], v[214:215], v[214:215]
  v_pk_mul_f32 v[68:69], v[218:219], v[218:219]
  v_pk_fma_f32 v[56:57], v[56:57], v[234:235], v[232:233]
  v_pk_fma_f32 v[60:61], v[60:61], v[234:235], v[232:233]
  v_pk_fma_f32 v[64:65], v[64:65], v[234:235], v[232:233]
  v_pk_fma_f32 v[68:69], v[68:69], v[234:235], v[232:233]
  v_pk_mul_f32 v[56:57], v[56:57], v[206:207]
  v_pk_mul_f32 v[60:61], v[60:61], v[210:211]
  v_pk_mul_f32 v[64:65], v[64:65], v[214:215]
  v_pk_mul_f32 v[68:69], v[68:69], v[218:219]
  v_exp_f32 v56, v56
  v_exp_f32 v57, v57
  v_exp_f32 v60, v60
  v_exp_f32 v61, v61
  v_exp_f32 v64, v64
  v_exp_f32 v65, v65
  v_exp_f32 v68, v68
  v_exp_f32 v69, v69
  v_pk_fma_f32 v[56:57], v[56:57], v[130:131], v[130:131]
  v_pk_fma_f32 v[60:61], v[60:61], v[130:131], v[130:131]
  v_pk_fma_f32 v[64:65], v[64:65], v[130:131], v[130:131]
  v_pk_fma_f32 v[68:69], v[68:69], v[130:131], v[130:131]
  v_rcp_f32 v56, v56
  v_rcp_f32 v57, v57
  v_rcp_f32 v60, v60
  v_rcp_f32 v61, v61
  v_rcp_f32 v64, v64
  v_rcp_f32 v65, v65
  v_rcp_f32 v68, v68
  v_rcp_f32 v69, v69
  v_pk_fma_f32 v[16:17], v[56:57], v[206:207], v[16:17]
  v_pk_fma_f32 v[18:19], v[60:61], v[210:211], v[18:19]
  v_pk_fma_f32 v[20:21], v[64:65], v[214:215], v[20:21]
  v_pk_fma_f32 v[22:23], v[68:69], v[218:219], v[22:23]
  v_add_f32 v16, v16, v17
  v_add_f32 v18, v18, v19
  v_add_f32 v20, v20, v21
  v_add_f32 v22, v22, v23
  s_nop 0
  v_permlane32_swap_b32 v16, v20
  v_permlane32_swap_b32 v18, v22
  v_add_f32 v16, v16, v20
  v_add_f32 v18, v18, v22
  s_nop 1
  v_permlane16_swap_b32 v16, v18
  v_add_f32 v16, v16, v18
  ds_write_b32 v36, v16
  s_waitcnt lgkmcnt(0)
  s_cmp_eq_u32 s3, 0
  s_cbranch_scc1 L_dpub
  s_barrier
  s_endpgm
L_dpub:
  s_mov_b32 s60, s24
  s_and_b32 s61, s25, 0xffff
  s_mov_b32 s62, 268435456
  s_mov_b32 s63, 0x20000
  s_mov_b32 s64, s22
  s_and_b32 s65, s23, 0xffff
  s_mov_b32 s66, 256
  s_mov_b32 s67, 0x20000
  v_readfirstlane_b32 s81, v37
  s_nop 0
  s_cmp_ge_u32 s81, 56
  s_cbranch_scc1 L_dclr_ok
  v_mov_b32 v4, 0
  s_mov_b32 s78, 0x40000
L_dclr:
  s_sub_u32 s78, s78, 1
  s_cbranch_scc1 L_end
  buffer_load_dword v37, v4, s[64:67], 0 offen offset:128 sc1
  s_waitcnt vmcnt(0)
  v_readfirstlane_b32 s81, v37
  s_nop 0
  s_cmp_lt_u32 s81, 56
  s_cbranch_scc1 L_dclr
L_dclr_ok:
  s_barrier
  ds_read_b64 v[64:65], v2 offset:0
  ds_read_b64 v[66:67], v2 offset:512
  ds_read_b64 v[68:69], v2 offset:1024
  ds_read_b64 v[70:71], v2 offset:1536
  s_waitcnt lgkmcnt(2)
  v_pk_add_f32 v[64:65], v[64:65], v[66:67]
  s_waitcnt lgkmcnt(0)
  v_pk_add_f32 v[68:69], v[68:69], v[70:71]
  v_pk_add_f32 v[64:65], v[64:65], v[68:69]
  v_and_b32 v64, -2, v64
  v_and_b32 v65, -2, v65
  buffer_store_dwordx2 v[64:65], v3, s[60:63], s69 offen sc1
  s_endpgm
L_cin:
  s_and_b32 s68, s26, 3
  s_mul_i32 s68, s68, 3
  s_add_u32 s27, s68, s27
  s_sub_u32 s27, s27, 6
  s_cbranch_scc1 L_rem
  s_and_b32 s79, s3, 3
  s_lshr_b32 s84, s3, 2
  s_lshl_b32 s100, s27, 3
  s_add_u32 s100, s100, s3
  s_mul_i32 s68, s100, 1280
  v_min_u32 v40, 9, v0
  v_lshlrev_b32 v40, 7, v40
  v_lshlrev_b32 v48, 4, v0
  s_lshl_b32 s95, s79, 10
  s_cmp_eq_u32 s79, 2
  s_cselect_b64 s[82:83], 0x1fffff, -1
  s_cmp_eq_u32 s79, 3
  s_cselect_b32 s96, 0, 32768
  s_add_u32 s96, s96, s95
  s_mul_i32 s69, s27, 2979
  s_lshr_b32 s69, s69, 6
  s_mul_i32 s98, s27, 44
  s_and_b32 s70, s2, 7
  s_add_u32 s85, s98, s3
  s_lshl_b32 s85, s85, 2
  s_lshl_b32 s98, s70, 14
  s_add_u32 s85, s85, s98
  s_add_u32 s85, s85, 10240
  s_mul_i32 s98, s27, 44
  s_lshl_b32 s77, s70, 9
  s_add_u32 s94, s77, s98
  s_add_u32 s77, s77, s69
  s_add_u32 s94, s94, s3
  s_mul_i32 s94, s94, 104
  s_lshl_b32 s98, s27, 2
  s_add_u32 s98, s98, s3
  s_add_u32 s98, s98, s70
  s_and_b32 s98, s98, 7
  s_mul_i32 s98, s98, 16640
  s_add_u32 s98, s98, 12288
  s_sub_u32 s72, 6, s84
  s_lshl_b32 s99, s84, 1
  s_mov_b32 s26, -1
  v_lshrrev_b32 v43, 3, v0
  v_min_u32 v43, 6, v43
  v_lshlrev_b32 v17, 4, v43
  s_mul_i32 s70, s70, 88
  s_add_u32 s70, s100, s70
  s_mov_b32 s71, 704
  v_mov_b32 v44, s70
  v_mad_u32_u24 v19, v0, s71, v44
  s_mul_i32 s70, s100, 104
  s_sub_u32 s70, s70, 313
  v_min_u32 v44, 16, v0
  v_mul_u32_u24 v45, 26, v44
  v_add_u32 v45, s70, v45
  v_cmp_lt_u32 vcc, 12, v44
  s_nop 1
  v_cndmask_b32 v19, v19, v45, vcc
  v_lshlrev_b32 v19, 7, v19
  s_mov_b32 s101, 212992
  v_mov_b32 v2, 110464
  v_lshlrev_b32 v1, 20, v0
  v_add_u32 v1, 110464, v1
  v_and_b32 v44, 7, v0
  v_lshlrev_b32 v18, 4, v44
  v_and_b32 v44, 15, v0
  v_lshl_add_u32 v44, v44, 2, v2
  v_mov_b32 v3, 0
  ds_write_b32 v44, v3
  v_lshrrev_b32 v41, 5, v0
  v_and_b32 v42, 31, v0
  s_waitcnt lgkmcnt(0)
  v_mov_b32 v3, 1
  s_mov_b32 s32, s6
  s_and_b32 s33, s7, 0xffff
  s_mov_b32 s34, 12800000
  s_mov_b32 s35, 0x20000
  v_mov_b32 v45, s80
  buffer_load_dword v255, v45, s[32:35], 0 offen
  s_mov_b32 s36, s8
  s_and_b32 s37, s9, 0xffff
  s_mov_b32 s38, 105456
  s_mov_b32 s39, 0x20000
  buffer_load_dword v255, v40, s[36:39], s68 offen
  s_mov_b32 s44, s12
  s_and_b32 s45, s13, 0xffff
  s_mov_b32 s46, 5537792
  s_mov_b32 s47, 0x20000
  s_barrier
  s_mov_b64 exec, 131071
  buffer_load_dword v255, v19, s[44:47], s101 offen
  s_mov_b64 exec, -1
  s_add_u32 s101, s101, 1171456
  s_mov_b32 s28, s4
  s_and_b32 s29, s5, 0xffff
  s_mov_b32 s30, 425984
  s_mov_b32 s31, 0x20000
  s_cmp_lg_u32 s84, 0
  s_cbranch_scc1 L_g1a
  s_mov_b32 s40, s10
  s_and_b32 s41, s11, 0xffff
  s_mov_b32 s42, 156
  s_mov_b32 s43, 0x20000
  s_mov_b32 m0, 110272
  s_mov_b64 exec, 0x7ff
  buffer_load_dwordx4 v48, s[40:43], 0 offen lds
  s_mov_b64 exec, -1
  buffer_load_dwordx4 v[204:207], v17, s[28:31], s94 offen offset:416
  buffer_load_dwordx4 v[24:27], v17, s[28:31], s94 offen offset:0
  s_add_u32 s94, s94, 832
  s_add_u32 m0, s95, 71552
  s_add_u32 s81, s95, 70304
  buffer_load_dwordx4 v48, s[36:39], s81 offen lds
  s_add_u32 m0, s95, 75648
  s_add_u32 s81, s95, 74400
  buffer_load_dwordx4 v48, s[36:39], s81 offen lds
  s_add_u32 m0, s95, 79744
  s_add_u32 s81, s95, 78496
  buffer_load_dwordx4 v48, s[36:39], s81 offen lds
  s_add_u32 m0, s95, 83840
  s_add_u32 s81, s95, 82592
  buffer_load_dwordx4 v48, s[36:39], s81 offen lds
  s_add_u32 m0, s95, 87936
  s_add_u32 s81, s95, 86688
  buffer_load_dwordx4 v48, s[36:39], s81 offen lds
  s_add_u32 m0, s95, 92032
  s_add_u32 s81, s95, 90784
  buffer_load_dwordx4 v48, s[36:39], s81 offen lds
  s_add_u32 m0, s95, 96128
  s_add_u32 s81, s95, 94880
  buffer_load_dwordx4 v48, s[36:39], s81 offen lds
  s_add_u32 m0, s95, 100224
  s_add_u32 s81, s95, 98976
  buffer_load_dwordx4 v48, s[36:39], s81 offen lds
  s_add_u32 m0, s96, 71552
  s_add_u32 s81, s96, 70304
  s_mov_b64 exec, s[82:83]
  buffer_load_dwordx4 v48, s[36:39], s81 offen lds
  s_mov_b64 exec, -1
  s_add_u32 m0, s95, 36288
  s_add_u32 s81, s95, 35152
  buffer_load_dwordx4 v48, s[36:39], s81 offen lds
  s_add_u32 m0, s95, 40384
  s_add_u32 s81, s95, 39248
  buffer_load_dwordx4 v48, s[36:39], s81 offen lds
  s_add_u32 m0, s95, 44480
  s_add_u32 s81, s95, 43344
  buffer_load_dwordx4 v48, s[36:39], s81 offen lds
  s_add_u32 m0, s95, 48576
  s_add_u32 s81, s95, 47440
  buffer_load_dwordx4 v48, s[36:39], s81 offen lds
  s_branch L_addrc
L_g1a:
  s_setprio 1
  v_bfe_u32 v43, v0, 2, 2
  v_lshl_add_u32 v43, v41, 3, v43
  v_bfe_u32 v44, v0, 4, 1
  v_lshlrev_b32 v44, 5, v44
  v_and_b32 v45, 3, v0
  v_lshl_add_u32 v44, v45, 3, v44
  v_lshl_add_u32 v240, v43, 6, v44
  v_add_u32 v240, 106816, v240
  s_lshl_b32 s68, s79, 6
  s_add_u32 s68, s68, 36288
  v_add_u32 v44, s68, v44
  v_mul_u32_u24 v45, 1352, v43
  v_add_u32 v241, v44, v45
  v_add_u32 v45, 16, v43
  v_min_u32 v45, 25, v45
  v_mul_u32_u24 v45, 1352, v45
  v_add_u32 v242, v44, v45
  v_add_u32 v45, 20, v43
  v_min_u32 v45, 25, v45
  v_mul_u32_u24 v45, 1352, v45
  v_add_u32 v243, v44, v45
  s_lshl_b32 s68, s79, 5
  v_add_u32 v246, s68, v42
  v_mul_u32_u24 v43, 52, v246
  v_lshl_add_u32 v43, v41, 3, v43
  v_add_u32 v244, 71552, v43
  v_lshlrev_b32 v43, 1, v246
  v_add_u32 v245, 108864, v43
  v_mov_b32 v216, 0
  v_mov_b32 v217, 0
  v_lshlrev_b32 v43, 3, v0
  v_add_u32 v44, 108480, v43
  s_mov_b32 exec_hi, 0xffff
  ds_write_b64 v44, v[216:217]
  s_mov_b32 exec_hi, -1
  v_lshl_add_u32 v43, v41, 7, v246
  s_mov_b32 s69, 2521
  s_mov_b32 s70, 106816
  v_mul_u32_u24 v44, s69, v43
  v_lshrrev_b32 v44, 16, v44
  v_mad_u32_u24 v44, v44, 12, s70
  v_lshl_add_u32 v68, v43, 1, v44
  v_add_u32 v43, 256, v43
  v_mul_u32_u24 v44, s69, v43
  v_lshrrev_b32 v44, 16, v44
  v_mad_u32_u24 v44, v44, 12, s70
  v_lshl_add_u32 v69, v43, 1, v44
  v_add_u32 v43, 256, v43
  v_mul_u32_u24 v44, s69, v43
  v_lshrrev_b32 v44, 16, v44
  v_mad_u32_u24 v44, v44, 12, s70
  v_lshl_add_u32 v70, v43, 1, v44
  v_mov_b32 v44, 676
  v_cmp_gt_u32 s[92:93], v44, v43
  v_add_u32 v43, 0, v246
  v_mul_u32_u24 v44, s69, v43
  v_lshrrev_b32 v44, 16, v44
  v_lshl_add_u32 v44, v44, 2, v244
  v_add_u32 v72, 0, v44
  v_add_u32 v43, 128, v246
  v_mul_u32_u24 v44, s69, v43
  v_lshrrev_b32 v44, 16, v44
  v_lshl_add_u32 v44, v44, 2, v244
  v_add_u32 v73, 6656, v44
  v_add_u32 v43, 256, v246
  v_mul_u32_u24 v44, s69, v43
  v_lshrrev_b32 v44, 16, v44
  v_lshl_add_u32 v44, v44, 2, v244
  v_add_u32 v74, 13312, v44
  v_add_u32 v43, 384, v246
  v_mul_u32_u24 v44, s69, v43
  v_lshrrev_b32 v44, 16, v44
  v_lshl_add_u32 v44, v44, 2, v244
  v_add_u32 v75, 19968, v44
  v_add_u32 v43, 512, v246
  v_mul_u32_u24 v44, s69, v43
  v_lshrrev_b32 v44, 16, v44
  v_lshl_add_u32 v44, v44, 2, v244
  v_add_u32 v76, 26624, v44
  v_add_u32 v43, 640, v246
  v_mul_u32_u24 v44, s69, v43
  v_lshrrev_b32 v44, 16, v44
  v_lshl_add_u32 v44, v44, 2, v244
  v_add_u32 v77, 33280, v44
  v_lshlrev_b32 v78, 4, v41
  v_add_u32 v78, 110376, v78
  v_lshlrev_b32 v79, 1, v0
  v_add_u32 v79, 110272, v79
  v_lshlrev_b32 v80, 6, v0
  v_add_u32 v80, 106868, v80
L_addrc:
  s_and_b32 s70, s3, 1
  s_lshl_b32 s70, s70, 1
  v_add_u32 v46, s70, v41
  v_min_u32 v43, 25, v42
  s_mul_i32 s68, s84, 4
  s_add_u32 s68, s68, 1352
  s_mul_i32 s69, s84, 70528
  s_add_u32 s69, s69, 1024
  v_mul_u32_u24 v44, s68, v43
  v_add_u32 v44, s69, v44
  v_mul_u32_u24 v65, 52, v43
  v_lshl_add_u32 v65, v46, 1, v65
  v_add_u32 v65, 108864, v65
  v_lshlrev_b32 v67, 1, v43
  v_add_u32 v67, 110272, v67
  v_mad_u32_u24 v60, v46, 52, v44
  v_lshl_add_u32 v61, v46, 1, v44
  v_lshl_add_u32 v49, v46, 1, v60
  v_lshlrev_b32 v43, 3, v46
  s_mov_b32 s68, 0x01000100
  v_bfe_i32 v45, s68, v43, 8
  v_lshl_add_u32 v50, v45, 1, v60
  v_mad_i32_i24 v51, v45, 52, v61
  s_mov_b32 s68, 0xff00ff00
  v_bfe_i32 v45, s68, v43, 8
  v_lshl_add_u32 v52, v45, 1, v60
  v_mad_i32_i24 v53, v45, 52, v61
  s_mov_b32 s68, 0xff020100
  v_bfe_i32 v45, s68, v43, 8
  v_lshl_add_u32 v54, v45, 1, v60
  v_mad_i32_i24 v55, v45, 52, v61
  s_mov_b32 s68, 0x0b0a0100
  v_bfe_i32 v45, s68, v43, 8
  v_lshl_add_u32 v56, v45, 1, v60
  v_mad_i32_i24 v57, v45, 52, v61
  s_mov_b32 s68, 0xf3f20100
  v_bfe_i32 v45, s68, v43, 8
  v_lshl_add_u32 v58, v45, 1, v60
  v_mad_i32_i24 v59, v45, 52, v61
  s_mov_b32 s68, 0x00023600
  v_bfe_u32 v45, s68, v43, 8
  v_add_u32 v60, v45, v44
  v_add_u32 v61, 52, v44
  v_mov_b32 v47, 1048576
  v_cmp_eq_u32 vcc, 3, v46
  s_nop 1
  v_cndmask_b32 v60, v60, v47, vcc
  v_cndmask_b32 v67, v47, v67, vcc
  v_cmp_eq_u32 vcc, 2, v46
  s_nop 1
  v_cndmask_b32 v61, v47, v61, vcc
  v_cmp_gt_u32 vcc, 2, v46
  s_nop 1
  v_cndmask_b32 v64, v47, v65, vcc
  s_lshr_b32 s69, s79, 1
  s_mul_i32 s69, s69, 6144
  s_mul_i32 s68, s84, 35264
  s_add_u32 s68, s68, 1024
  s_lshl_b32 s70, s84, 4
  s_sub_u32 s71, s70, 36304
  v_lshlrev_b32 v45, 8, v46
  v_lshl_add_u32 v43, v42, 4, v45
  v_add_u32 v63, s68, v43
  v_add_u32 v66, 47552, v43
  v_bfe_u32 v43, v0, 2, 2
  v_lshl_add_u32 v45, v43, 4, v45
  v_and_b32 v43, 3, v0
  v_lshl_add_u32 v44, v43, 6, v45
  v_add_u32 v44, 48592, v44
  v_cmp_lt_u32 vcc, 15, v42
  s_nop 1
  v_cndmask_b32 v66, v66, v44, vcc
  v_add_u32 v44, s71, v44
  v_cndmask_b32 v63, v63, v44, vcc
  v_lshl_add_u32 v44, v43, 5, v45
  v_add_u32 v44, 23536, v44
  s_add_u32 s71, s70, 19
  v_cmp_lt_u32 vcc, s71, v42
  s_nop 1
  v_cndmask_b32 v63, v63, v44, vcc
  v_add_u32 v63, s69, v63
  v_cmp_lt_u32 vcc, 25, v42
  s_nop 1
  v_cndmask_b32 v63, v63, v47, vcc
  v_cndmask_b32 v66, v66, v47, vcc
  v_add_u32 v5, s70, v2
  v_add_u32 v6, s70, v1
  v_mov_b32 v62, 0
  s_mul_i32 s74, s3, 4224
  s_add_u32 s74, s74, 111040
  s_mov_b32 s75, -39488
  v_add_u32 v28, 1024, v48
  v_and_b32 v43, 11, v0
  v_cmp_eq_u32 vcc, 11, v43
  s_nop 1
  v_cndmask_b32 v31, v28, v47, vcc
  v_and_b32 v43, 3, v0
  v_cmp_eq_u32 vcc, 0, v43
  s_nop 1
  v_cndmask_b32 v30, v31, v47, vcc
  v_lshrrev_b32 v46, 4, v0
  v_bfe_u32 v43, v0, 1, 3
  v_lshlrev_b32 v45, 4, v43
  v_add_u32 v45, 23552, v45
  v_and_b32 v43, 10, v0
  v_cmp_eq_u32 vcc, 10, v43
  s_nop 1
  v_cndmask_b32 v45, v45, v47, vcc
  v_and_b32 v44, 1, v0
  v_lshl_add_u32 v29, v46, 9, v45
  v_lshl_add_u32 v29, v44, 2, v29
  v_add_u32 v29, 1024, v29
  v_lshl_add_u32 v22, v46, 8, v45
  v_lshl_add_u32 v22, v44, 20, v22
  v_and_b32 v47, 15, v0
  s_mov_b32 s68, 1056
  v_lshlrev_b32 v43, 1, v47
  v_add_u32 v43, s74, v43
  v_mad_u32_u24 v7, v46, s68, v43
  s_lshl_b32 s68, s3, 10
  s_add_u32 s68, s68, 144832
  v_add_u32 v10, s68, v48
  v_add_u32 v43, 256, v48
  v_and_b32 v43, 1023, v43
  v_add_u32 v11, s68, v43
  v_xor_b32 v43, 512, v48
  v_add_u32 v12, s68, v43
  v_lshlrev_b32 v13, 4, v41
  v_mov_b32 v32, 0
  v_mov_b32 v33, 0
  v_mov_b32 v34, 0
  v_mov_b32 v35, 0
  v_mov_b32 v36, 0
  v_mov_b32 v37, 0
  v_mov_b32 v38, 0
  v_mov_b32 v39, 0
  v_mov_b32 v216, 0
  v_mov_b32 v217, 0
  v_mov_b32 v218, 0
  v_mov_b32 v219, 0
  v_mov_b32 v220, 0
  v_mov_b32 v221, 0
  v_mov_b32 v222, 0
  v_mov_b32 v223, 0
  v_mov_b32 v224, 0
  v_mov_b32 v225, 0
  v_mov_b32 v226, 0
  v_mov_b32 v227, 0
  v_mov_b32 v228, 0
  v_mov_b32 v229, 0
  v_mov_b32 v230, 0
  v_mov_b32 v231, 0
  v_mov_b32 v232, 0
  v_mov_b32 v233, 0
  v_mov_b32 v234, 0
  v_mov_b32 v235, 0
  v_mov_b32 v236, 0
  v_mov_b32 v237, 0
  v_mov_b32 v238, 0
  v_mov_b32 v239, 0
  v_mul_u32_u24 v44, 1056, v46
  v_bfe_u32 v45, v0, 2, 2
  v_lshl_add_u32 v44, v45, 7, v44
  v_and_b32 v45, 3, v0
  v_lshl_add_u32 v9, v45, 3, v44
  v_add_u32 v8, s74, v9
  v_and_b32 v45, 1, v0
  s_mov_b32 s68, 0xaaaaaaaa
  v_mul_lo_u32 v16, s68, v45
  v_or_b32 v16, 0x44444444, v16
  v_lshlrev_b32 v15, 1, v0
  v_add_u32 v15, s74, v15
  v_mov_b32 v14, 0x3f80
  ds_write_b16 v15, v14 offset:4064
  v_add_u32 v15, s75, v15
  s_mul_i32 s71, s3, 6
  s_add_u32 s77, s77, s71
  s_mul_i32 s77, s77, 104
  s_add_u32 s73, s77, 80
  s_add_u32 s77, s77, 16
  s_mov_b32 s71, 10923
  v_min_u32 v43, 35, v0
  v_mul_u32_u24 v44, s71, v43
  v_lshrrev_b32 v44, 16, v44
  v_mul_u32_u24 v44, 80, v44
  v_lshl_add_u32 v20, v43, 2, v44
  s_cmp_eq_u32 s84, 0
  s_cbranch_scc1 L_g0pf
  s_add_u32 s94, s94, 832
  s_add_u32 s77, s77, 24
  buffer_load_dwordx4 v[24:27], v17, s[28:31], s94 offen offset:0
  s_add_u32 s94, s94, 832
  buffer_load_dword v21, v20, s[28:31], s77 offen
  s_cmp_eq_u32 s77, s73
  s_cselect_b32 s73, 0x7000000, s73
  s_cselect_b32 s77, 0x7000000, s77
  s_add_u32 s77, s77, 24
  s_min_u32 s77, s77, s73
  s_cmp_lg_u32 s3, 7
  s_cbranch_scc1 L_nclr
  s_cmp_ge_u32 s27, 7
  s_cbranch_scc1 L_nclr
  s_mov_b32 s60, s24
  s_and_b32 s61, s25, 0xffff
  s_mov_b32 s62, 268435456
  s_mov_b32 s63, 0x20000
  s_mov_b32 s64, s22
  s_and_b32 s65, s23, 0xffff
  s_mov_b32 s66, 256
  s_mov_b32 s67, 0x20000
  v_mov_b32 v84, -1
  v_mov_b32 v85, -1
  v_mov_b32 v86, -1
  v_mov_b32 v87, -1
  s_and_b32 s68, s2, 7
  s_lshl_b32 s68, s68, 3
  s_add_u32 s68, s68, s27
  s_lshl_b32 s68, s68, 11
  buffer_store_dwordx4 v[84:87], v48, s[60:63], s68 offen sc1
  buffer_store_dwordx4 v[84:87], v48, s[60:63], s68 offen offset:1024 sc1
  s_waitcnt vmcnt(0)
  s_mov_b64 exec, 1
  buffer_atomic_add v3, v48, s[64:67], 0 offen offset:128
  s_mov_b64 exec, -1
L_nclr:
L_csync1:
  ds_read_b32 v4, v2 offset:0
  s_waitcnt lgkmcnt(0)
  v_cmp_gt_u32 vcc, 4, v4
  s_cbranch_vccnz L_csync1
  ds_read_b64 v[132:133], v78 offset:0
  ds_read_b64 v[134:135], v78 offset:8
  ds_read_b64 v[136:137], v78 offset:32
  ds_read_b64 v[138:139], v78 offset:40
  ds_read_u16 v45, v79 offset:52
  ds_read_b64_tr_b16 v[84:85], v241 offset:35264
  ds_read_b64_tr_b16 v[86:87], v241 offset:40672
  ds_read_b64_tr_b16 v[88:89], v242 offset:35264
  ds_read_b64_tr_b16 v[90:91], v243 offset:35264
  ds_read_b64_tr_b16 v[92:93], v241 offset:35520
  ds_read_b64_tr_b16 v[94:95], v241 offset:40928
  ds_read_b64_tr_b16 v[96:97], v242 offset:35520
  ds_read_b64_tr_b16 v[98:99], v243 offset:35520
  ds_read_b64_tr_b16 v[100:101], v241 offset:35776
  ds_read_b64_tr_b16 v[102:103], v241 offset:41184
  ds_read_b64_tr_b16 v[104:105], v242 offset:35776
  ds_read_b64_tr_b16 v[106:107], v243 offset:35776
  ds_read_b64_tr_b16 v[108:109], v241 offset:36032
  ds_read_b64_tr_b16 v[110:111], v241 offset:41440
  ds_read_b64_tr_b16 v[112:113], v242 offset:36032
  ds_read_b64_tr_b16 v[114:115], v243 offset:36032
  s_waitcnt lgkmcnt(14)
  v_mfma_f32_32x32x16_bf16 v[140:155], v[132:135], v[84:87], 0
  s_waitcnt lgkmcnt(12)
  v_mfma_f32_32x32x16_bf16 v[140:155], v[136:139], v[88:91], v[140:155]
  ds_read_b64_tr_b16 v[116:117], v241 offset:36288
  ds_read_b64_tr_b16 v[118:119], v241 offset:41696
  ds_read_b64_tr_b16 v[120:121], v242 offset:36288
  ds_read_b64_tr_b16 v[122:123], v243 offset:36288
  s_waitcnt lgkmcnt(14)
  v_mfma_f32_32x32x16_bf16 v[156:171], v[132:135], v[92:95], 0
  s_waitcnt lgkmcnt(12)
  v_mfma_f32_32x32x16_bf16 v[156:171], v[136:139], v[96:99], v[156:171]
  ds_read_b64_tr_b16 v[124:125], v241 offset:36544
  ds_read_b64_tr_b16 v[126:127], v241 offset:41952
  ds_read_b64_tr_b16 v[128:129], v242 offset:36544
  ds_read_b64_tr_b16 v[130:131], v243 offset:36544
  s_waitcnt lgkmcnt(14)
  v_mfma_f32_32x32x16_bf16 v[172:187], v[132:135], v[100:103], 0
  s_waitcnt lgkmcnt(12)
  v_mfma_f32_32x32x16_bf16 v[172:187], v[136:139], v[104:107], v[172:187]
  v_cvt_pk_bf16_f32 v81, v140, 0
  s_waitcnt lgkmcnt(10)
  v_mfma_f32_32x32x16_bf16 v[188:203], v[132:135], v[108:111], 0
  s_waitcnt lgkmcnt(8)
  v_mfma_f32_32x32x16_bf16 v[188:203], v[136:139], v[112:115], v[188:203]
  s_mov_b32 exec_lo, 0
  v_cvt_pk_bf16_f32 v81, v156, 0
  s_mov_b32 exec_lo, -1
  ds_write_b16 v68, v81
  s_waitcnt lgkmcnt(7)
  v_mfma_f32_32x32x16_bf16 v[140:155], v[132:135], v[116:119], 0
  s_waitcnt lgkmcnt(5)
  v_mfma_f32_32x32x16_bf16 v[140:155], v[136:139], v[120:123], v[140:155]
  v_cvt_pk_bf16_f32 v82, v172, 0
  s_waitcnt lgkmcnt(3)
  v_mfma_f32_32x32x16_bf16 v[156:171], v[132:135], v[124:127], 0
  s_waitcnt lgkmcnt(1)
  v_mfma_f32_32x32x16_bf16 v[156:171], v[136:139], v[128:131], v[156:171]
  s_mov_b32 exec_lo, 0
  v_cvt_pk_bf16_f32 v82, v188, 0
  s_mov_b32 exec_lo, -1
  ds_write_b16 v69, v82
  s_nop 2
  v_cvt_pk_bf16_f32 v83, v140, 0
  s_mov_b32 exec_lo, 0
  s_nop 2
  v_cvt_pk_bf16_f32 v83, v156, 0
  s_mov_b64 exec, s[92:93]
  ds_write_b16 v70, v83
  s_mov_b64 exec, 0x3ffffff
  ds_write_b16 v80, v45
  s_mov_b64 exec, -1
  s_waitcnt lgkmcnt(0)
  ds_add_u32 v1, v3 offset:4
  v_cmp_gt_u32 s[92:93], 36, v246
L_csync2:
  ds_read_b32 v4, v2 offset:4
  s_waitcnt lgkmcnt(0)
  v_cmp_gt_u32 vcc, 8, v4
  s_cbranch_vccnz L_csync2
  ds_read_b64_tr_b16 v[132:133], v240 offset:0
  ds_read_b64_tr_b16 v[134:135], v240 offset:256
  ds_read_b64_tr_b16 v[136:137], v240 offset:1024
  ds_read_b64_tr_b16 v[138:139], v240 offset:1280
  ds_read_b64_tr_b16 v[84:85], v241 offset:0
  ds_read_b64_tr_b16 v[86:87], v241 offset:5408
  ds_read_b64_tr_b16 v[88:89], v242 offset:0
  ds_read_b64_tr_b16 v[90:91], v243 offset:0
  ds_read_b64_tr_b16 v[92:93], v241 offset:256
  ds_read_b64_tr_b16 v[94:95], v241 offset:5664
  ds_read_b64_tr_b16 v[96:97], v242 offset:256
  ds_read_b64_tr_b16 v[98:99], v243 offset:256
  ds_read_b64_tr_b16 v[100:101], v241 offset:512
  ds_read_b64_tr_b16 v[102:103], v241 offset:5920
  ds_read_b64_tr_b16 v[104:105], v242 offset:512
  ds_read_b64_tr_b16 v[106:107], v243 offset:512
  ds_read_b64_tr_b16 v[108:109], v241 offset:768
  ds_read_b64_tr_b16 v[110:111], v241 offset:6176
  ds_read_b64_tr_b16 v[112:113], v242 offset:768
  ds_read_b64_tr_b16 v[114:115], v243 offset:768
  s_waitcnt lgkmcnt(14)
  v_mfma_f32_32x32x16_bf16 v[140:155], v[132:135], v[84:87], 0
  s_waitcnt lgkmcnt(12)
  v_mfma_f32_32x32x16_bf16 v[140:155], v[136:139], v[88:91], v[140:155]
  ds_read_b64_tr_b16 v[116:117], v241 offset:1024
  ds_read_b64_tr_b16 v[118:119], v241 offset:6432
  ds_read_b64_tr_b16 v[120:121], v242 offset:1024
  ds_read_b64_tr_b16 v[122:123], v243 offset:1024
  s_waitcnt lgkmcnt(14)
  v_mfma_f32_32x32x16_bf16 v[156:171], v[132:135], v[92:95], 0
  s_waitcnt lgkmcnt(12)
  v_mfma_f32_32x32x16_bf16 v[156:171], v[136:139], v[96:99], v[156:171]
  ds_read_b64_tr_b16 v[124:125], v241 offset:1280
  ds_read_b64_tr_b16 v[126:127], v241 offset:6688
  ds_read_b64_tr_b16 v[128:129], v242 offset:1280
  ds_read_b64_tr_b16 v[130:131], v243 offset:1280
  s_waitcnt lgkmcnt(14)
  v_mfma_f32_32x32x16_bf16 v[172:187], v[132:135], v[100:103], 0
  s_waitcnt lgkmcnt(12)
  v_mfma_f32_32x32x16_bf16 v[172:187], v[136:139], v[104:107], v[172:187]
  v_cvt_pk_bf16_f32 v84, v140, v141
  v_cvt_pk_bf16_f32 v85, v142, v143
  v_cvt_pk_bf16_f32 v86, v144, v145
  v_cvt_pk_bf16_f32 v87, v146, v147
  v_cvt_pk_bf16_f32 v88, v148, v149
  v_cvt_pk_bf16_f32 v89, v150, v151
  v_cvt_pk_bf16_f32 v90, v152, v153
  v_cvt_pk_bf16_f32 v91, v154, v155
  ds_write2_b32 v72, v84, v85 offset0:0 offset1:1
  ds_write2_b32 v72, v86, v87 offset0:4 offset1:5
  ds_write2_b32 v72, v88, v89 offset0:8 offset1:9
  s_waitcnt lgkmcnt(13)
  v_mfma_f32_32x32x16_bf16 v[188:203], v[132:135], v[108:111], 0
  s_waitcnt lgkmcnt(11)
  v_mfma_f32_32x32x16_bf16 v[188:203], v[136:139], v[112:115], v[188:203]
  v_cvt_pk_bf16_f32 v92, v156, v157
  v_cvt_pk_bf16_f32 v93, v158, v159
  v_cvt_pk_bf16_f32 v94, v160, v161
  v_cvt_pk_bf16_f32 v95, v162, v163
  v_cvt_pk_bf16_f32 v96, v164, v165
  v_cvt_pk_bf16_f32 v97, v166, v167
  v_cvt_pk_bf16_f32 v98, v168, v169
  v_cvt_pk_bf16_f32 v99, v170, v171
  ds_write2_b32 v73, v92, v93 offset0:0 offset1:1
  ds_write2_b32 v73, v94, v95 offset0:4 offset1:5
  ds_write2_b32 v73, v96, v97 offset0:8 offset1:9
  s_waitcnt lgkmcnt(12)
  v_mfma_f32_32x32x16_bf16 v[140:155], v[132:135], v[116:119], 0
  s_waitcnt lgkmcnt(10)
  v_mfma_f32_32x32x16_bf16 v[140:155], v[136:139], v[120:123], v[140:155]
  v_cvt_pk_bf16_f32 v100, v172, v173
  v_cvt_pk_bf16_f32 v101, v174, v175
  v_cvt_pk_bf16_f32 v102, v176, v177
  v_cvt_pk_bf16_f32 v103, v178, v179
  v_cvt_pk_bf16_f32 v104, v180, v181
  v_cvt_pk_bf16_f32 v105, v182, v183
  v_cvt_pk_bf16_f32 v106, v184, v185
  v_cvt_pk_bf16_f32 v107, v186, v187
  ds_write2_b32 v74, v100, v101 offset0:0 offset1:1
  ds_write2_b32 v74, v102, v103 offset0:4 offset1:5
  ds_write2_b32 v74, v104, v105 offset0:8 offset1:9
  s_waitcnt lgkmcnt(11)
  v_mfma_f32_32x32x16_bf16 v[156:171], v[132:135], v[124:127], 0
  s_waitcnt lgkmcnt(9)
  v_mfma_f32_32x32x16_bf16 v[156:171], v[136:139], v[128:131], v[156:171]
  v_cvt_pk_bf16_f32 v108, v188, v189
  v_cvt_pk_bf16_f32 v109, v190, v191
  v_cvt_pk_bf16_f32 v110, v192, v193
  v_cvt_pk_bf16_f32 v111, v194, v195
  v_cvt_pk_bf16_f32 v112, v196, v197
  v_cvt_pk_bf16_f32 v113, v198, v199
  v_cvt_pk_bf16_f32 v114, v200, v201
  v_cvt_pk_bf16_f32 v115, v202, v203
  ds_write2_b32 v75, v108, v109 offset0:0 offset1:1
  ds_write2_b32 v75, v110, v111 offset0:4 offset1:5
  ds_write2_b32 v75, v112, v113 offset0:8 offset1:9
  v_cvt_pk_bf16_f32 v116, v140, v141
  v_cvt_pk_bf16_f32 v117, v142, v143
  v_cvt_pk_bf16_f32 v118, v144, v145
  v_cvt_pk_bf16_f32 v119, v146, v147
  v_cvt_pk_bf16_f32 v120, v148, v149
  v_cvt_pk_bf16_f32 v121, v150, v151
  v_cvt_pk_bf16_f32 v122, v152, v153
  v_cvt_pk_bf16_f32 v123, v154, v155
  ds_write2_b32 v76, v116, v117 offset0:0 offset1:1
  ds_write2_b32 v76, v118, v119 offset0:4 offset1:5
  ds_write2_b32 v76, v120, v121 offset0:8 offset1:9
  v_cvt_pk_bf16_f32 v124, v156, v157
  v_cvt_pk_bf16_f32 v125, v158, v159
  v_cvt_pk_bf16_f32 v126, v160, v161
  v_cvt_pk_bf16_f32 v127, v162, v163
  v_cvt_pk_bf16_f32 v128, v164, v165
  v_cvt_pk_bf16_f32 v129, v166, v167
  v_cvt_pk_bf16_f32 v130, v168, v169
  v_cvt_pk_bf16_f32 v131, v170, v171
  s_mov_b64 exec, s[92:93]
  ds_write2_b32 v77, v124, v125 offset0:0 offset1:1
  ds_write2_b32 v77, v126, v127 offset0:4 offset1:5
  ds_write2_b32 v77, v128, v129 offset0:8 offset1:9
  s_mov_b32 exec_hi, 0
  ds_write_b32 v77, v130 offset:48
  ds_write_b16 v245, v131 offset:1280
  s_mov_b32 exec_lo, -1
  ds_write_b32 v76, v122 offset:48
  ds_write_b16 v245, v123 offset:1024
  ds_write_b32 v75, v114 offset:48
  ds_write_b16 v245, v115 offset:768
  ds_write_b32 v74, v106 offset:48
  ds_write_b16 v245, v107 offset:512
  ds_write_b32 v73, v98 offset:48
  ds_write_b16 v245, v99 offset:256
  ds_write_b32 v72, v90 offset:48
  ds_write_b16 v245, v91 offset:0
  s_mov_b64 exec, -1
  s_waitcnt lgkmcnt(0)
  ds_add_u32 v6, v3 offset:8
  s_setprio 1
  s_branch L_bld
L_g0pf:
  buffer_load_dword v208, v20, s[28:31], s77 offen
  buffer_load_dword v209, v20, s[28:31], s77 offen offset:2496
  s_add_u32 s77, s77, 24
  buffer_load_dword v21, v20, s[28:31], s77 offen
  s_cmp_eq_u32 s77, s73
  s_cselect_b32 s73, 0x7000000, s73
  s_cselect_b32 s77, 0x7000000, s77
  s_add_u32 s77, s77, 24
  s_min_u32 s77, s77, s73
  s_waitcnt vmcnt(7) lgkmcnt(0)
  ds_add_u32 v1, v3 offset:0
  s_add_u32 m0, s95, 52672
  s_add_u32 s81, s95, 51536
  buffer_load_dwordx4 v48, s[36:39], s81 offen lds
  s_add_u32 m0, s95, 56768
  s_add_u32 s81, s95, 55632
  buffer_load_dwordx4 v48, s[36:39], s81 offen lds
  s_add_u32 m0, s95, 60864
  s_add_u32 s81, s95, 59728
  buffer_load_dwordx4 v48, s[36:39], s81 offen lds
  s_add_u32 m0, s95, 64960
  s_add_u32 s81, s95, 63824
  buffer_load_dwordx4 v48, s[36:39], s81 offen lds
  s_add_u32 m0, s96, 36288
  s_add_u32 s81, s96, 35152
  s_mov_b64 exec, s[82:83]
  buffer_load_dwordx4 v48, s[36:39], s81 offen lds
  s_mov_b64 exec, -1
  s_add_u32 m0, s95, 1024
  s_add_u32 s81, s95, 0
  buffer_load_dwordx4 v48, s[36:39], s81 offen lds
  s_add_u32 m0, s95, 5120
  s_add_u32 s81, s95, 4096
  buffer_load_dwordx4 v48, s[36:39], s81 offen lds
  s_add_u32 m0, s95, 9216
  s_add_u32 s81, s95, 8192
  buffer_load_dwordx4 v48, s[36:39], s81 offen lds
  s_add_u32 m0, s95, 13312
  s_add_u32 s81, s95, 12288
  buffer_load_dwordx4 v48, s[36:39], s81 offen lds
  s_waitcnt vmcnt(4) lgkmcnt(0)
  ds_add_u32 v1, v3 offset:4
  s_add_u32 m0, s95, 17408
  s_add_u32 s81, s95, 16384
  buffer_load_dwordx4 v48, s[36:39], s81 offen lds
  s_add_u32 m0, s95, 21504
  s_add_u32 s81, s95, 20480
  buffer_load_dwordx4 v48, s[36:39], s81 offen lds
  s_add_u32 m0, s95, 25600
  s_add_u32 s81, s95, 24576
  buffer_load_dwordx4 v48, s[36:39], s81 offen lds
  s_add_u32 m0, s95, 29696
  s_add_u32 s81, s95, 28672
  buffer_load_dwordx4 v48, s[36:39], s81 offen lds
  s_add_u32 m0, s96, 1024
  s_add_u32 s81, s96, 0
  s_mov_b64 exec, s[82:83]
  buffer_load_dwordx4 v48, s[36:39], s81 offen lds
  s_mov_b64 exec, -1
  v_lshl_add_u32 v24, v24, 7, v18
  v_lshl_add_u32 v25, v25, 7, v18
  s_mov_b32 exec_hi, 0x0000ffff
  v_lshl_add_u32 v26, v26, 7, v18
  v_lshl_add_u32 v27, v27, 7, v18
  s_mov_b32 exec_lo, 0
  s_mov_b32 exec_hi, 0xffff0000
  v_mov_b32 v27, v25
  v_mov_b32 v26, v25
  s_mov_b32 exec_hi, 0x00ff0000
  v_mov_b32 v26, v24
  s_mov_b64 exec, -1
  s_add_u32 m0, s74, 0
  s_nop 0
  buffer_load_dwordx4 v24, s[32:35], 0 offen lds
  s_add_u32 m0, s74, 1056
  s_nop 0
  buffer_load_dwordx4 v25, s[32:35], 0 offen lds
  s_add_u32 m0, s74, 2112
  s_nop 0
  buffer_load_dwordx4 v26, s[32:35], 0 offen lds
  s_add_u32 m0, s74, 3168
  s_mov_b32 exec_hi, 0x00ffffff
  buffer_load_dwordx4 v27, s[32:35], 0 offen lds
  s_mov_b32 exec_hi, -1
  v_lshl_add_u32 v204, v204, 7, v18
  v_lshl_add_u32 v205, v205, 7, v18
  s_mov_b32 exec_hi, 0x0000ffff
  v_lshl_add_u32 v206, v206, 7, v18
  v_lshl_add_u32 v207, v207, 7, v18
  s_mov_b32 exec_lo, 0
  s_mov_b32 exec_hi, 0xffff0000
  v_mov_b32 v207, v205
  v_mov_b32 v206, v205
  s_mov_b32 exec_hi, 0x00ff0000
  v_mov_b32 v206, v204
  s_mov_b64 exec, -1
  s_add_u32 m0, s74, 16896
  s_nop 0
  buffer_load_dwordx4 v204, s[32:35], 0 offen lds
  s_add_u32 m0, s74, 17952
  s_nop 0
  buffer_load_dwordx4 v205, s[32:35], 0 offen lds
  s_add_u32 m0, s74, 19008
  s_nop 0
  buffer_load_dwordx4 v206, s[32:35], 0 offen lds
  s_add_u32 m0, s74, 20064
  s_mov_b32 exec_hi, 0x00ffffff
  buffer_load_dwordx4 v207, s[32:35], 0 offen lds
  s_mov_b32 exec_hi, -1
  buffer_load_dwordx4 v[24:27], v17, s[28:31], s94 offen offset:0
  s_add_u32 s94, s94, 832
  v_lshlrev_b32 v208, 7, v208
  buffer_load_dword v255, v208, s[32:35], 0 offen
  v_lshlrev_b32 v209, 7, v209
  buffer_load_dword v255, v209, s[32:35], 0 offen
  s_waitcnt vmcnt(11) lgkmcnt(0)
  ds_add_u32 v6, v3 offset:8
L_bld:
L_csync3:
  ds_read_b32 v4, v5 offset:8
  s_waitcnt lgkmcnt(0)
  v_cmp_gt_u32 vcc, 4, v4
  s_cbranch_vccnz L_csync3
  s_cmp_ge_u32 s79, 2
  s_cbranch_scc1 L_chunk1
  ds_read_u16_d16_hi v216, v49 offset:0
  ds_read_u16_d16_hi v218, v49 offset:648
  ds_read_u16_d16_hi v220, v49 offset:216
  ds_read_u16_d16_hi v222, v49 offset:864
  ds_read_u16_d16_hi v224, v49 offset:432
  ds_read_u16_d16_hi v226, v49 offset:1080
  ds_read_u16_d16_hi v228, v49 offset:8
  ds_read_u16_d16_hi v229, v49 offset:208
  ds_read_u16_d16_hi v230, v49 offset:656
  ds_read_u16_d16_hi v231, v49 offset:856
  s_waitcnt lgkmcnt(8)
  v_mov_b32 v85, v218
  v_mov_b32 v84, v216
  v_max3_f32 v62, v62, abs(v84), abs(v85)
  ds_read_u16_d16_hi v232, v49 offset:32
  ds_read_u16_d16_hi v233, v49 offset:832
  ds_read_u16_d16_hi v234, v49 offset:632
  ds_read_u16_d16_hi v235, v49 offset:232
  s_waitcnt lgkmcnt(10)
  v_mov_b32 v87, v222
  v_mov_b32 v86, v220
  v_max3_f32 v62, v62, abs(v86), abs(v87)
  ds_read_u16_d16_hi v236, v49 offset:16
  ds_read_u16_d16_hi v237, v49 offset:416
  ds_read_u16_d16_hi v238, v49 offset:664
  ds_read_u16_d16_hi v239, v49 offset:1064
  s_waitcnt lgkmcnt(12)
  v_mov_b32 v89, v226
  v_mov_b32 v88, v224
  v_max3_f32 v62, v62, abs(v88), abs(v89)
  ds_read_u16_d16_hi v216, v49 offset:40
  ds_read_u16_d16_hi v217, v49 offset:1040
  ds_read_u16_d16_hi v218, v49 offset:640
  ds_read_u16_d16_hi v219, v49 offset:440
  s_waitcnt lgkmcnt(12)
  v_add_f32 v91, v230, v231
  v_add_f32 v90, v228, v229
  v_max3_f32 v62, v62, abs(v90), abs(v91)
  ds_read_u16_d16_hi v220, v49 offset:224
  ds_read_u16_d16_hi v221, v49 offset:424
  ds_read_u16_d16_hi v222, v49 offset:872
  ds_read_u16_d16_hi v223, v49 offset:1072
  s_waitcnt lgkmcnt(12)
  v_add_f32 v93, v234, v235
  v_add_f32 v92, v232, v233
  v_max3_f32 v62, v62, abs(v92), abs(v93)
  ds_read_u16_d16_hi v224, v49 offset:248
  ds_read_u16_d16_hi v225, v49 offset:1048
  ds_read_u16_d16_hi v226, v49 offset:848
  ds_read_u16_d16_hi v227, v49 offset:448
  s_waitcnt lgkmcnt(12)
  v_add_f32 v95, v238, v239
  v_add_f32 v94, v236, v237
  v_max3_f32 v62, v62, abs(v94), abs(v95)
  ds_read_u16_d16_hi v228, v50 offset:48
  ds_read_u16_d16_hi v229, v51 offset:1248
  ds_read_u16_d16_hi v230, v50 offset:672
  ds_read_u16_d16_hi v231, v51 offset:1272
  s_waitcnt lgkmcnt(12)
  v_add_f32 v97, v218, v219
  v_add_f32 v96, v216, v217
  v_max3_f32 v62, v62, abs(v96), abs(v97)
  ds_read_u16_d16_hi v232, v50 offset:256
  ds_read_u16_d16_hi v233, v51 offset:1256
  ds_read_u16_d16_hi v234, v50 offset:880
  ds_read_u16_d16_hi v235, v51 offset:1280
  s_waitcnt lgkmcnt(12)
  v_add_f32 v99, v222, v223
  v_add_f32 v98, v220, v221
  v_max3_f32 v62, v62, abs(v98), abs(v99)
  ds_read_u16_d16_hi v236, v50 offset:464
  ds_read_u16_d16_hi v237, v51 offset:1264
  ds_read_u16_d16_hi v238, v50 offset:1088
  ds_read_u16_d16_hi v239, v51 offset:1288
  s_waitcnt lgkmcnt(12)
  v_add_f32 v101, v226, v227
  v_add_f32 v100, v224, v225
  v_max3_f32 v62, v62, abs(v100), abs(v101)
  ds_read_u16_d16_hi v216, v49 offset:24
  ds_read_u16_d16_hi v217, v49 offset:624
  ds_read_u16_d16_hi v218, v49 offset:240
  ds_read_u16_d16_hi v219, v49 offset:840
  s_waitcnt lgkmcnt(12)
  v_add_f32 v103, v230, v231
  v_add_f32 v102, v228, v229
  v_max3_f32 v62, v62, abs(v102), abs(v103)
  ds_read_u16_d16_hi v220, v49 offset:456
  ds_read_u16_d16_hi v221, v49 offset:1056
  ds_read_u16_d16_hi v222, v60 offset:1296
  ds_read_u16_d16_hi v223, v61 offset:1296
  s_waitcnt lgkmcnt(12)
  v_add_f32 v105, v234, v235
  v_add_f32 v104, v232, v233
  v_max3_f32 v62, v62, abs(v104), abs(v105)
  ds_read_u16_d16_hi v224, v52 offset:50
  ds_read_u16_d16_hi v225, v53 offset:1300
  ds_read_u16_d16_hi v226, v52 offset:674
  ds_read_u16_d16_hi v227, v53 offset:1324
  s_waitcnt lgkmcnt(12)
  v_add_f32 v107, v238, v239
  v_add_f32 v106, v236, v237
  v_max3_f32 v62, v62, abs(v106), abs(v107)
  ds_read_u16_d16_hi v228, v52 offset:258
  ds_read_u16_d16_hi v229, v53 offset:1308
  ds_read_u16_d16_hi v230, v52 offset:882
  ds_read_u16_d16_hi v231, v53 offset:1332
  s_waitcnt lgkmcnt(12)
  v_add_f32 v109, v218, v219
  v_add_f32 v108, v216, v217
  v_max3_f32 v62, v62, abs(v108), abs(v109)
  ds_read_u16_d16_hi v232, v52 offset:466
  ds_read_u16_d16_hi v233, v53 offset:1316
  ds_read_u16_d16_hi v234, v52 offset:1090
  ds_read_u16_d16_hi v235, v53 offset:1340
  s_waitcnt lgkmcnt(12)
  v_add_f32 v111, v222, v223
  v_add_f32 v110, v220, v221
  v_max3_f32 v62, v62, abs(v110), abs(v111)
  ds_read_u16_d16_hi v236, v54 offset:2
  ds_read_u16_d16_hi v237, v55 offset:52
  ds_read_u16_d16_hi v238, v54 offset:650
  ds_read_u16_d16_hi v239, v55 offset:700
  s_waitcnt lgkmcnt(12)
  v_add_f32 v113, v226, v227
  v_add_f32 v112, v224, v225
  v_max3_f32 v62, v62, abs(v112), abs(v113)
  ds_read_u16_d16_hi v216, v54 offset:26
  ds_read_u16_d16_hi v217, v55 offset:676
  ds_read_u16_d16_hi v218, v54 offset:626
  ds_read_u16_d16_hi v219, v55 offset:76
  s_waitcnt lgkmcnt(12)
  v_add_f32 v115, v230, v231
  v_add_f32 v114, v228, v229
  v_max3_f32 v62, v62, abs(v114), abs(v115)
  ds_read_u16_d16_hi v220, v54 offset:10
  ds_read_u16_d16_hi v221, v55 offset:260
  ds_read_u16_d16_hi v222, v54 offset:658
  ds_read_u16_d16_hi v223, v55 offset:908
  s_waitcnt lgkmcnt(12)
  v_add_f32 v117, v234, v235
  v_add_f32 v116, v232, v233
  v_max3_f32 v62, v62, abs(v116), abs(v117)
  ds_read_u16_d16_hi v224, v54 offset:34
  ds_read_u16_d16_hi v225, v55 offset:884
  ds_read_u16_d16_hi v226, v54 offset:634
  ds_read_u16_d16_hi v227, v55 offset:284
  s_waitcnt lgkmcnt(12)
  v_add_f32 v119, v238, v239
  v_add_f32 v118, v236, v237
  v_max3_f32 v62, v62, abs(v118), abs(v119)
  ds_read_u16_d16_hi v228, v54 offset:18
  ds_read_u16_d16_hi v229, v55 offset:468
  ds_read_u16_d16_hi v230, v54 offset:666
  ds_read_u16_d16_hi v231, v55 offset:1116
  s_waitcnt lgkmcnt(12)
  v_add_f32 v121, v218, v219
  v_add_f32 v120, v216, v217
  v_max3_f32 v62, v62, abs(v120), abs(v121)
  ds_read_u16_d16_hi v232, v54 offset:42
  ds_read_u16_d16_hi v233, v55 offset:1092
  ds_read_u16_d16_hi v234, v54 offset:642
  ds_read_u16_d16_hi v235, v55 offset:492
  s_waitcnt lgkmcnt(12)
  v_add_f32 v123, v222, v223
  v_add_f32 v122, v220, v221
  v_max3_f32 v62, v62, abs(v122), abs(v123)
  ds_read_u16_d16_hi v236, v54 offset:210
  ds_read_u16_d16_hi v237, v55 offset:60
  ds_read_u16_d16_hi v238, v54 offset:858
  ds_read_u16_d16_hi v239, v55 offset:708
  s_waitcnt lgkmcnt(12)
  v_add_f32 v125, v226, v227
  v_add_f32 v124, v224, v225
  v_max3_f32 v62, v62, abs(v124), abs(v125)
  s_waitcnt lgkmcnt(8)
  v_add_f32 v127, v230, v231
  v_add_f32 v126, v228, v229
  v_max3_f32 v62, v62, abs(v126), abs(v127)
  s_waitcnt lgkmcnt(4)
  v_add_f32 v129, v234, v235
  v_add_f32 v128, v232, v233
  v_max3_f32 v62, v62, abs(v128), abs(v129)
  s_waitcnt lgkmcnt(0)
  v_add_f32 v131, v238, v239
  v_add_f32 v130, v236, v237
  v_max3_f32 v62, v62, abs(v130), abs(v131)
  s_branch L_conv
L_chunk1:
  ds_read_u16_d16_hi v216, v54 offset:234
  ds_read_u16_d16_hi v217, v55 offset:684
  ds_read_u16_d16_hi v218, v54 offset:834
  ds_read_u16_d16_hi v219, v55 offset:84
  ds_read_u16_d16_hi v220, v54 offset:218
  ds_read_u16_d16_hi v221, v55 offset:268
  ds_read_u16_d16_hi v222, v54 offset:866
  ds_read_u16_d16_hi v223, v55 offset:916
  ds_read_u16_d16_hi v224, v54 offset:242
  ds_read_u16_d16_hi v225, v55 offset:892
  ds_read_u16_d16_hi v226, v54 offset:842
  ds_read_u16_d16_hi v227, v55 offset:292
  ds_read_u16_d16_hi v228, v54 offset:226
  ds_read_u16_d16_hi v229, v55 offset:476
  ds_read_u16_d16_hi v230, v54 offset:874
  ds_read_u16_d16_hi v231, v55 offset:1124
  s_waitcnt lgkmcnt(12)
  v_add_f32 v85, v218, v219
  v_add_f32 v84, v216, v217
  v_max3_f32 v62, v62, abs(v84), abs(v85)
  ds_read_u16_d16_hi v232, v54 offset:250
  ds_read_u16_d16_hi v233, v55 offset:1100
  ds_read_u16_d16_hi v234, v54 offset:850
  ds_read_u16_d16_hi v235, v55 offset:500
  s_waitcnt lgkmcnt(12)
  v_add_f32 v87, v222, v223
  v_add_f32 v86, v220, v221
  v_max3_f32 v62, v62, abs(v86), abs(v87)
  ds_read_u16_d16_hi v236, v54 offset:418
  ds_read_u16_d16_hi v237, v55 offset:68
  ds_read_u16_d16_hi v238, v54 offset:1066
  ds_read_u16_d16_hi v239, v55 offset:716
  s_waitcnt lgkmcnt(12)
  v_add_f32 v89, v226, v227
  v_add_f32 v88, v224, v225
  v_max3_f32 v62, v62, abs(v88), abs(v89)
  ds_read_u16_d16_hi v216, v54 offset:442
  ds_read_u16_d16_hi v217, v55 offset:692
  ds_read_u16_d16_hi v218, v54 offset:1042
  ds_read_u16_d16_hi v219, v55 offset:92
  s_waitcnt lgkmcnt(12)
  v_add_f32 v91, v230, v231
  v_add_f32 v90, v228, v229
  v_max3_f32 v62, v62, abs(v90), abs(v91)
  ds_read_u16_d16_hi v220, v54 offset:426
  ds_read_u16_d16_hi v221, v55 offset:276
  ds_read_u16_d16_hi v222, v54 offset:1074
  ds_read_u16_d16_hi v223, v55 offset:924
  s_waitcnt lgkmcnt(12)
  v_add_f32 v93, v234, v235
  v_add_f32 v92, v232, v233
  v_max3_f32 v62, v62, abs(v92), abs(v93)
  ds_read_u16_d16_hi v224, v54 offset:450
  ds_read_u16_d16_hi v225, v55 offset:900
  ds_read_u16_d16_hi v226, v54 offset:1050
  ds_read_u16_d16_hi v227, v55 offset:300
  s_waitcnt lgkmcnt(12)
  v_add_f32 v95, v238, v239
  v_add_f32 v94, v236, v237
  v_max3_f32 v62, v62, abs(v94), abs(v95)
  ds_read_u16_d16_hi v228, v54 offset:434
  ds_read_u16_d16_hi v229, v55 offset:484
  ds_read_u16_d16_hi v230, v54 offset:1082
  ds_read_u16_d16_hi v231, v55 offset:1132
  s_waitcnt lgkmcnt(12)
  v_add_f32 v97, v218, v219
  v_add_f32 v96, v216, v217
  v_max3_f32 v62, v62, abs(v96), abs(v97)
  ds_read_u16_d16_hi v232, v54 offset:458
  ds_read_u16_d16_hi v233, v55 offset:1108
  ds_read_u16_d16_hi v234, v54 offset:1058
  ds_read_u16_d16_hi v235, v55 offset:508
  s_waitcnt lgkmcnt(12)
  v_add_f32 v99, v222, v223
  v_add_f32 v98, v220, v221
  v_max3_f32 v62, v62, abs(v98), abs(v99)
  ds_read_u16_d16_hi v236, v56 offset:4
  ds_read_u16_d16_hi v237, v57 offset:104
  ds_read_u16_d16_hi v238, v58 offset:652
  ds_read_u16_d16_hi v239, v59 offset:752
  s_waitcnt lgkmcnt(12)
  v_add_f32 v101, v226, v227
  v_add_f32 v100, v224, v225
  v_max3_f32 v62, v62, abs(v100), abs(v101)
  ds_read_u16_d16_hi v216, v56 offset:220
  ds_read_u16_d16_hi v217, v57 offset:320
  ds_read_u16_d16_hi v218, v58 offset:868
  ds_read_u16_d16_hi v219, v59 offset:968
  s_waitcnt lgkmcnt(12)
  v_add_f32 v103, v230, v231
  v_add_f32 v102, v228, v229
  v_max3_f32 v62, v62, abs(v102), abs(v103)
  ds_read_u16_d16_hi v220, v56 offset:436
  ds_read_u16_d16_hi v221, v57 offset:536
  ds_read_u16_d16_hi v222, v58 offset:1084
  ds_read_u16_d16_hi v223, v59 offset:1184
  s_waitcnt lgkmcnt(12)
  v_add_f32 v105, v234, v235
  v_add_f32 v104, v232, v233
  v_max3_f32 v62, v62, abs(v104), abs(v105)
  ds_read_u16_d16_hi v224, v56 offset:12
  ds_read_u16_d16_hi v225, v57 offset:312
  ds_read_u16_d16_hi v226, v58 offset:660
  ds_read_u16_d16_hi v227, v59 offset:960
  s_waitcnt lgkmcnt(12)
  v_add_f32 v107, v238, v239
  v_add_f32 v106, v236, v237
  v_max3_f32 v62, v62, abs(v106), abs(v107)
  ds_read_u16_d16_hi v228, v58 offset:36
  ds_read_u16_d16_hi v229, v59 offset:936
  ds_read_u16_d16_hi v230, v56 offset:636
  ds_read_u16_d16_hi v231, v57 offset:336
  s_waitcnt lgkmcnt(12)
  v_add_f32 v109, v218, v219
  v_add_f32 v108, v216, v217
  v_max3_f32 v62, v62, abs(v108), abs(v109)
  ds_read_u16_d16_hi v232, v56 offset:20
  ds_read_u16_d16_hi v233, v57 offset:520
  ds_read_u16_d16_hi v234, v58 offset:668
  ds_read_u16_d16_hi v235, v59 offset:1168
  s_waitcnt lgkmcnt(12)
  v_add_f32 v111, v222, v223
  v_add_f32 v110, v220, v221
  v_max3_f32 v62, v62, abs(v110), abs(v111)
  ds_read_u16_d16_hi v236, v58 offset:44
  ds_read_u16_d16_hi v237, v59 offset:1144
  ds_read_u16_d16_hi v238, v56 offset:644
  ds_read_u16_d16_hi v239, v57 offset:544
  s_waitcnt lgkmcnt(12)
  v_add_f32 v113, v226, v227
  v_add_f32 v112, v224, v225
  v_max3_f32 v62, v62, abs(v112), abs(v113)
  ds_read_u16_d16_hi v216, v56 offset:228
  ds_read_u16_d16_hi v217, v57 offset:528
  ds_read_u16_d16_hi v218, v58 offset:876
  ds_read_u16_d16_hi v219, v59 offset:1176
  s_waitcnt lgkmcnt(12)
  v_add_f32 v115, v230, v231
  v_add_f32 v114, v228, v229
  v_max3_f32 v62, v62, abs(v114), abs(v115)
  ds_read_u16_d16_hi v220, v58 offset:252
  ds_read_u16_d16_hi v221, v59 offset:1152
  ds_read_u16_d16_hi v222, v56 offset:852
  ds_read_u16_d16_hi v223, v57 offset:552
  s_waitcnt lgkmcnt(12)
  v_add_f32 v117, v234, v235
  v_add_f32 v116, v232, v233
  v_max3_f32 v62, v62, abs(v116), abs(v117)
  s_waitcnt lgkmcnt(8)
  v_add_f32 v119, v238, v239
  v_add_f32 v118, v236, v237
  v_max3_f32 v62, v62, abs(v118), abs(v119)
  s_waitcnt lgkmcnt(4)
  v_add_f32 v121, v218, v219
  v_add_f32 v120, v216, v217
  v_max3_f32 v62, v62, abs(v120), abs(v121)
  s_waitcnt lgkmcnt(0)
  v_add_f32 v123, v222, v223
  v_add_f32 v122, v220, v221
  v_max3_f32 v62, v62, abs(v122), abs(v123)
  ds_read_u16_d16_hi v216, v65 offset:0
  ds_read_u16_d16_hi v217, v65 offset:8
  ds_read_u16_d16_hi v218, v65 offset:16
  ds_read_u16_d16_hi v219, v65 offset:24
  ds_read_u16_d16_hi v220, v65 offset:32
  ds_read_u16_d16_hi v221, v65 offset:40
  ds_read_u16_d16_hi v222, v64 offset:48
  ds_read_u16_d16_hi v223, v67
L_conv:
  s_nop 0
  v_max_u32_dpp v62, v62, v62 row_shr:1 row_mask:0xf bank_mask:0xf
  s_nop 1
  v_max_u32_dpp v62, v62, v62 row_shr:2 row_mask:0xf bank_mask:0xf
  s_nop 1
  v_max_u32_dpp v62, v62, v62 row_shr:4 row_mask:0xf bank_mask:0xf
  s_nop 1
  v_max_u32_dpp v62, v62, v62 row_shr:8 row_mask:0xf bank_mask:0xf
  s_nop 1
  v_max_u32_dpp v62, v62, v62 row_bcast:15 row_mask:0xa bank_mask:0xf
  s_nop 1
  v_max_u32_dpp v62, v62, v62 row_bcast:31 row_mask:0xc bank_mask:0xf
  s_nop 0
  v_readlane_b32 s68, v62, 63
  s_nop 1
  v_mov_b32 v62, s68
  ds_max_u32 v6, v62 offset:20
  s_waitcnt vmcnt(3)
  ds_add_u32 v6, v3 offset:16
L_csync4:
  ds_read_b64 v[40:41], v5 offset:16
  s_waitcnt lgkmcnt(0)
  v_cmp_gt_u32 vcc, 4, v40
  s_cbranch_vccnz L_csync4
  v_readfirstlane_b32 s71, v41
  s_nop 0
  s_lshr_b32 s71, s71, 23
  s_sub_i32 s71, 141, s71
  s_min_i32 s71, s71, 40
  s_add_i32 s51, s71, 127
  s_lshl_b32 s51, s51, 23
  v_fma_mixlo_f16 v132, v84, s51, 0
  v_fma_mixlo_f16 v133, v86, s51, 0
  v_fma_mixlo_f16 v134, v88, s51, 0
  v_fma_mixlo_f16 v135, v90, s51, 0
  v_fma_mixhi_f16 v132, v85, s51, 0
  v_fma_mixhi_f16 v133, v87, s51, 0
  v_fma_mixhi_f16 v134, v89, s51, 0
  v_fma_mixhi_f16 v135, v91, s51, 0
  v_fma_mixlo_f16 v136, v92, s51, 0
  v_fma_mixlo_f16 v137, v94, s51, 0
  v_fma_mixlo_f16 v138, v96, s51, 0
  v_fma_mixlo_f16 v139, v98, s51, 0
  v_fma_mixhi_f16 v136, v93, s51, 0
  v_fma_mixhi_f16 v137, v95, s51, 0
  v_fma_mixhi_f16 v138, v97, s51, 0
  v_fma_mixhi_f16 v139, v99, s51, 0
L_csync5:
  ds_read_b64 v[40:41], v2 offset:16
  s_waitcnt lgkmcnt(0)
  v_cmp_gt_u32 vcc, 4, v40
  s_cbranch_vccnz L_csync5
  v_readfirstlane_b32 s70, v41
  s_nop 0
  s_lshr_b32 s70, s70, 23
  s_sub_i32 s70, 141, s70
  s_min_i32 s70, s70, 40
  ds_write_b128 v63, v[132:135] offset:0
  v_fma_mixlo_f16 v140, v100, s51, 0
  v_fma_mixlo_f16 v141, v102, s51, 0
  v_fma_mixlo_f16 v142, v104, s51, 0
  v_fma_mixlo_f16 v143, v106, s51, 0
  v_fma_mixhi_f16 v140, v101, s51, 0
  v_fma_mixhi_f16 v141, v103, s51, 0
  v_fma_mixhi_f16 v142, v105, s51, 0
  v_fma_mixhi_f16 v143, v107, s51, 0
  ds_write_b128 v63, v[136:139] offset:1024
  v_fma_mixlo_f16 v144, v108, s51, 0
  v_fma_mixlo_f16 v145, v110, s51, 0
  v_fma_mixlo_f16 v146, v112, s51, 0
  v_fma_mixlo_f16 v147, v114, s51, 0
  v_fma_mixhi_f16 v144, v109, s51, 0
  v_fma_mixhi_f16 v145, v111, s51, 0
  v_fma_mixhi_f16 v146, v113, s51, 0
  v_fma_mixhi_f16 v147, v115, s51, 0
  ds_write_b128 v63, v[140:143] offset:2048
  v_fma_mixlo_f16 v148, v116, s51, 0
  v_fma_mixlo_f16 v149, v118, s51, 0
  v_fma_mixlo_f16 v150, v120, s51, 0
  v_fma_mixlo_f16 v151, v122, s51, 0
  v_fma_mixhi_f16 v148, v117, s51, 0
  v_fma_mixhi_f16 v149, v119, s51, 0
  v_fma_mixhi_f16 v150, v121, s51, 0
  v_fma_mixhi_f16 v151, v123, s51, 0
  ds_write_b128 v63, v[144:147] offset:3072
  ds_write_b128 v63, v[148:151] offset:4096
  s_cmp_ge_u32 s79, 2
  s_cbranch_scc1 L_cvl
  v_fma_mixlo_f16 v152, v124, s51, 0
  v_fma_mixlo_f16 v153, v126, s51, 0
  v_fma_mixlo_f16 v154, v128, s51, 0
  v_fma_mixlo_f16 v155, v130, s51, 0
  v_fma_mixhi_f16 v152, v125, s51, 0
  v_fma_mixhi_f16 v153, v127, s51, 0
  v_fma_mixhi_f16 v154, v129, s51, 0
  v_fma_mixhi_f16 v155, v131, s51, 0
  ds_write_b128 v63, v[152:155] offset:5120
  s_branch L_built
L_cvl:
  s_cmp_eq_u32 s84, 0
  s_cbranch_scc1 L_built
  v_mul_f32 v216, s51, v216
  v_mul_f32 v217, s51, v217
  v_mul_f32 v218, s51, v218
  v_mul_f32 v219, s51, v219
  v_mul_f32 v220, s51, v220
  v_mul_f32 v221, s51, v221
  v_mul_f32 v222, s51, v222
  v_mul_f32 v223, s51, v223
  v_cvt_pk_bf16_f32 v152, v216, v217
  v_cvt_pk_bf16_f32 v153, v218, v219
  v_cvt_pk_bf16_f32 v154, v220, v221
  v_cvt_pk_bf16_f32 v155, v222, v223
  ds_write_b128 v66, v[152:155]
L_built:
  s_mov_b32 s60, s24
  s_and_b32 s61, s25, 0xffff
  s_mov_b32 s62, 268435456
  s_mov_b32 s63, 0x20000
  s_mov_b32 s64, s22
  s_and_b32 s65, s23, 0xffff
  s_mov_b32 s66, 256
  s_mov_b32 s67, 0x20000
  v_mov_b32 v251, 0
  s_mov_b64 exec, 1
  s_mov_b32 s81, 0x80000
  buffer_load_dword v255, v251, s[60:63], s81 offen
  buffer_load_dword v250, v251, s[64:67], 0 offen offset:128 sc1
  s_mov_b64 exec, -1
  ds_read_u16_d16_hi v32, v7 offset:0
  ds_read_u16_d16_hi v33, v7 offset:128
  ds_read_u16_d16_hi v34, v7 offset:256
  ds_read_u16_d16_hi v35, v7 offset:384
  ds_read_u16_d16_hi v36, v7 offset:512
  ds_read_u16_d16_hi v37, v7 offset:640
  ds_read_u16_d16_hi v38, v7 offset:768
  ds_read_u16_d16_hi v39, v7 offset:896
  s_waitcnt lgkmcnt(0)
  v_cvt_pk_f16_f32 v43, v38, v39
  v_cvt_pk_f16_f32 v40, v32, v35
  v_cvt_pk_f16_f32 v41, v33, v36
  v_cvt_pk_f16_f32 v42, v34, v37
  ds_read_b64_tr_b16 v[52:53], v8 offset:0
  ds_read_b64_tr_b16 v[54:55], v8 offset:512
  ds_write_b128 v10, v[40:43]
  ds_read_b128 v[44:47], v11
  ds_read_b128 v[48:51], v12
  v_pk_mul_f16 v56, v40, v40 op_sel:[0,0] op_sel_hi:[1,1]
  v_pk_mul_f16 v57, v41, v41 op_sel:[0,0] op_sel_hi:[1,1]
  v_pk_mul_f16 v58, v42, v42 op_sel:[0,0] op_sel_hi:[1,1]
  v_pk_mul_f16 v59, v40, v41 op_sel:[0,0] op_sel_hi:[1,1]
  v_pk_mul_f16 v60, v40, v41 op_sel:[0,1] op_sel_hi:[1,0]
  v_pk_mul_f16 v61, v40, v42 op_sel:[0,0] op_sel_hi:[1,1]
  v_pk_mul_f16 v62, v40, v42 op_sel:[0,1] op_sel_hi:[1,0]
  v_pk_mul_f16 v63, v41, v42 op_sel:[0,0] op_sel_hi:[1,1]
  s_waitcnt lgkmcnt(0)
  v_alignbit_b32 v48, v48, v48, v13
  v_alignbit_b32 v49, v49, v49, v13
  s_waitcnt vmcnt(2)
  v_lshlrev_b32 v21, 7, v21
  buffer_load_dword v255, v21, s[32:35], 0 offen
  buffer_load_dword v21, v20, s[28:31], s77 offen
  s_cmp_eq_u32 s77, s73
  s_cselect_b32 s73, 0x7000000, s73
  s_cselect_b32 s77, 0x7000000, s77
  s_add_u32 s77, s77, 24
  s_min_u32 s77, s77, s73
  s_mov_b64 exec, 131071
  buffer_load_dword v255, v19, s[44:47], s101 offen
  s_mov_b64 exec, -1
  s_add_u32 s101, s101, 1171456
  s_waitcnt lgkmcnt(0)
  s_barrier
  s_setprio 1
  ds_read_b128 v[216:219], v22
  ds_read_b128 v[240:243], v28 offset:46528
  ds_read_b128 v[84:87], v28 offset:0
  ds_read_b128 v[244:247], v30 offset:47552
  ds_read_b128 v[128:131], v28 offset:35264
  ds_read_b128 v[88:91], v28 offset:1024
  ds_read_b128 v[172:175], v31 offset:11264
  ds_read_b128 v[132:135], v28 offset:36288
  ds_read_b128 v[92:95], v28 offset:2048
  ds_read_b128 v[176:179], v31 offset:12288
  s_cmp_lg_u32 s84, 0
  s_cbranch_scc1 L_prf
  s_setprio 2
L_prf:
  s_waitcnt lgkmcnt(9)
  v_mfma_f32_16x16x32_f16 v[80:83], v[216:219], v[56:59], 0
  ds_read2_b32 v[220:221], v29 offset0:0 offset1:2
  ds_read2_b32 v[222:223], v29 offset0:64 offset1:66
  v_add_u32 v29, 2048, v29
  s_waitcnt lgkmcnt(10)
  v_mfma_f32_16x16x32_bf16 v[72:75], v[240:243], v[52:55], 0
  ds_read_b128 v[136:139], v28 offset:37312
  v_pk_mul_f16 v64, v41, v42 op_sel:[0,1] op_sel_hi:[1,0]
  v_pk_mul_f16 v65, v40, v43 op_sel:[0,0] op_sel_hi:[1,0]
  s_waitcnt lgkmcnt(10)
  v_mfma_f32_16x16x32_f16 v[68:71], v[84:87], v[56:59], 0
  ds_read_b128 v[180:183], v31 offset:13312
  s_waitcnt lgkmcnt(10)
  v_mfma_f32_16x16x32_bf16 v[76:79], v[244:247], v[52:55], 0
  ds_read_b128 v[96:99], v28 offset:3072
  v_pk_mul_f16 v66, v41, v43 op_sel:[0,0] op_sel_hi:[1,0]
  v_pk_mul_f16 v67, v42, v43 op_sel:[0,0] op_sel_hi:[1,0]
  s_waitcnt lgkmcnt(10)
  v_mfma_f32_16x16x32_f16 v[72:75], v[128:131], v[56:59], v[72:75]
  ds_read_b128 v[140:143], v28 offset:38336
  v_alignbit_b32 v50, v50, v50, v13
  s_waitcnt lgkmcnt(10)
  v_mfma_f32_16x16x32_f16 v[68:71], v[88:91], v[60:63], v[68:71]
  ds_read_b128 v[184:187], v31 offset:14336
  v_mul_f16_sdwa v52, v40, v40 dst_sel:WORD_0 dst_unused:UNUSED_PAD src0_sel:WORD_0 src1_sel:WORD_1
  v_mul_f16_sdwa v53, v42, v42 dst_sel:WORD_0 dst_unused:UNUSED_PAD src0_sel:WORD_0 src1_sel:WORD_1
  s_waitcnt lgkmcnt(10)
  v_mfma_f32_16x16x32_f16 v[76:79], v[172:175], v[56:59], v[76:79]
  ds_read2_b32 v[224:225], v29 offset0:0 offset1:2
  ds_read2_b32 v[226:227], v29 offset0:64 offset1:66
  v_add_u32 v29, 2048, v29
  s_waitcnt lgkmcnt(11)
  v_mfma_f32_16x16x32_f16 v[72:75], v[132:135], v[60:63], v[72:75]
  ds_read_b128 v[100:103], v28 offset:4096
  v_mul_f16_sdwa v52, v41, v41 dst_sel:WORD_1 dst_unused:UNUSED_PRESERVE src0_sel:WORD_0 src1_sel:WORD_1
  v_mul_f16_sdwa v53, v43, v43 dst_sel:WORD_1 dst_unused:UNUSED_PRESERVE src0_sel:WORD_0 src1_sel:WORD_1
  s_waitcnt lgkmcnt(11)
  v_mfma_f32_16x16x32_f16 v[68:71], v[92:95], v[64:67], v[68:71]
  ds_read_b128 v[144:147], v28 offset:39360
  v_pk_mul_f16 v54, v40, v47 op_sel:[0,0] op_sel_hi:[1,0]
  s_waitcnt lgkmcnt(11)
  v_mfma_f32_16x16x32_f16 v[76:79], v[176:179], v[60:63], v[76:79]
  ds_read_b128 v[188:191], v31 offset:15360
  v_pk_mul_f16 v55, v41, v47 op_sel:[0,0] op_sel_hi:[1,0]
  v_pk_mul_f16 v56, v42, v47 op_sel:[0,0] op_sel_hi:[1,0]
  s_waitcnt lgkmcnt(10)
  v_smfmac_f32_16x16x64_f16 v[80:83], v[220:223], v[60:67], v16
  ds_read_b128 v[104:107], v28 offset:5120
  v_pk_mul_f16 v57, v40, v44 op_sel:[0,0] op_sel_hi:[1,1]
  s_waitcnt lgkmcnt(10)
  v_mfma_f32_16x16x32_f16 v[72:75], v[136:139], v[64:67], v[72:75]
  ds_read_b128 v[148:151], v28 offset:40384
  v_pk_mul_f16 v58, v40, v44 op_sel:[0,1] op_sel_hi:[1,0]
  v_pk_mul_f16 v59, v40, v45 op_sel:[0,0] op_sel_hi:[1,1]
  s_waitcnt lgkmcnt(10)
  v_mfma_f32_16x16x32_f16 v[76:79], v[180:183], v[64:67], v[76:79]
  ds_read_b128 v[192:195], v31 offset:16384
  v_pk_mul_f16 v60, v40, v45 op_sel:[0,1] op_sel_hi:[1,0]
  s_waitcnt lgkmcnt(10)
  v_mfma_f32_16x16x32_f16 v[68:71], v[96:99], v[52:55], v[68:71]
  ds_read2_b32 v[228:229], v29 offset0:0 offset1:2
  ds_read2_b32 v[230:231], v29 offset0:64 offset1:66
  v_add_u32 v29, 2048, v29
  v_pk_mul_f16 v61, v40, v46 op_sel:[0,0] op_sel_hi:[1,1]
  v_pk_mul_f16 v62, v40, v46 op_sel:[0,1] op_sel_hi:[1,0]
  s_waitcnt lgkmcnt(11)
  v_mfma_f32_16x16x32_f16 v[72:75], v[140:143], v[52:55], v[72:75]
  ds_read_b128 v[108:111], v28 offset:6144
  v_pk_mul_f16 v63, v41, v44 op_sel:[0,0] op_sel_hi:[1,1]
  s_waitcnt lgkmcnt(11)
  v_mfma_f32_16x16x32_f16 v[76:79], v[184:187], v[52:55], v[76:79]
  ds_read_b128 v[152:155], v28 offset:41408
  ds_read_b32 v4, v2 offset:36
  ds_write_b16 v15, v14 offset:4064
  s_waitcnt vmcnt(3)
  v_readfirstlane_b32 s81, v250
  s_nop 0
  s_cmp_ge_u32 s81, 56
  s_cbranch_scc1 L_cclr_ok
  v_mov_b32 v251, 0
  s_mov_b32 s78, 0x40000
L_cclr:
  s_sub_u32 s78, s78, 1
  s_cbranch_scc1 L_end
  buffer_load_dword v250, v251, s[64:67], 0 offen offset:128 sc1
  s_waitcnt vmcnt(0)
  v_readfirstlane_b32 s81, v250
  s_nop 0
  s_cmp_lt_u32 s81, 56
  s_cbranch_scc1 L_cclr
L_cclr_ok:
  v_lshl_add_u32 v24, v24, 7, v18
  v_lshl_add_u32 v25, v25, 7, v18
  s_mov_b32 exec_hi, 0x0000ffff
  v_lshl_add_u32 v26, v26, 7, v18
  v_lshl_add_u32 v27, v27, 7, v18
  s_mov_b32 exec_lo, 0
  s_mov_b32 exec_hi, 0xffff0000
  v_mov_b32 v27, v25
  v_mov_b32 v26, v25
  s_mov_b32 exec_hi, 0x00ff0000
  v_mov_b32 v26, v24
  s_mov_b64 exec, -1
  s_add_u32 m0, s74, -39488
  s_nop 0
  buffer_load_dwordx4 v24, s[32:35], 0 offen lds
  s_add_u32 m0, s74, -38432
  s_nop 0
  buffer_load_dwordx4 v25, s[32:35], 0 offen lds
  s_add_u32 m0, s74, -37376
  s_nop 0
  buffer_load_dwordx4 v26, s[32:35], 0 offen lds
  s_add_u32 m0, s74, -36320
  s_mov_b32 exec_hi, 0x00ffffff
  buffer_load_dwordx4 v27, s[32:35], 0 offen lds
  s_mov_b32 exec_hi, -1
  s_mov_b64 exec, 131071
  buffer_load_dword v255, v19, s[44:47], s101 offen
  s_mov_b64 exec, -1
  s_add_u32 s101, s101, 1171456
  s_waitcnt lgkmcnt(1)
  v_readfirstlane_b32 s71, v4
  s_nop 0
  s_lshr_b32 s71, s71, 23
  s_sub_i32 s71, 141, s71
  s_min_i32 s71, s71, 40
  s_add_i32 s48, s70, s71
  s_sub_i32 s48, 0, s48
  s_mov_b32 s49, s48
  s_mov_b32 s97, 1
  s_mov_b32 s50, 1
  s_cmp_lg_u32 s3, 7
  s_cbranch_scc1 L_nw0
  s_mov_b32 s52, s16
  s_and_b32 s53, s17, 0xffff
  s_mov_b32 s54, 3328
  s_mov_b32 s55, 0x20000
  v_lshlrev_b32 v22, 7, v0
  buffer_load_dword v255, v22, s[52:55], 0 offen
L_nw0:
  v_pk_mul_f16 v64, v41, v44 op_sel:[0,1] op_sel_hi:[1,0]
  v_pk_mul_f16 v65, v41, v45 op_sel:[0,0] op_sel_hi:[1,1]
  v_smfmac_f32_16x16x64_f16 v[80:83], v[224:227], v[52:59], v16
  ds_read_b128 v[196:199], v31 offset:17408
  v_pk_mul_f16 v66, v41, v45 op_sel:[0,1] op_sel_hi:[1,0]
  v_pk_mul_f16 v67, v41, v46 op_sel:[0,0] op_sel_hi:[1,1]
  v_mfma_f32_16x16x32_f16 v[68:71], v[100:103], v[56:59], v[68:71]
  ds_read_b128 v[112:115], v28 offset:7168
  v_pk_mul_f16 v52, v41, v46 op_sel:[0,1] op_sel_hi:[1,0]
  v_pk_mul_f16 v53, v42, v44 op_sel:[0,0] op_sel_hi:[1,1]
  v_mfma_f32_16x16x32_f16 v[72:75], v[144:147], v[56:59], v[72:75]
  ds_read_b128 v[156:159], v28 offset:42432
  v_pk_mul_f16 v54, v42, v44 op_sel:[0,1] op_sel_hi:[1,0]
  v_pk_mul_f16 v55, v42, v45 op_sel:[0,0] op_sel_hi:[1,1]
  v_mfma_f32_16x16x32_f16 v[76:79], v[188:191], v[56:59], v[76:79]
  ds_read_b128 v[200:203], v31 offset:18432
  ds_read_u16_d16_hi v32, v7 offset:32
  ds_read_u16_d16_hi v33, v7 offset:160
  v_mfma_f32_16x16x32_f16 v[68:71], v[104:107], v[60:63], v[68:71]
  ds_read2_b32 v[232:233], v29 offset0:0 offset1:2
  ds_read2_b32 v[234:235], v29 offset0:64 offset1:66
  v_add_u32 v29, 2048, v29
  ds_read_u16_d16_hi v34, v7 offset:288
  ds_read_u16_d16_hi v35, v7 offset:416
  v_mfma_f32_16x16x32_f16 v[72:75], v[148:151], v[60:63], v[72:75]
  ds_read_b128 v[116:119], v28 offset:8192
  ds_read_u16_d16_hi v36, v7 offset:544
  ds_read_u16_d16_hi v37, v7 offset:672
  v_mfma_f32_16x16x32_f16 v[76:79], v[192:195], v[60:63], v[76:79]
  ds_read_b128 v[160:163], v28 offset:43456
  ds_read_u16_d16_hi v38, v7 offset:800
  ds_read_u16_d16_hi v39, v7 offset:928
  v_smfmac_f32_16x16x64_f16 v[80:83], v[228:231], v[60:67], v16
  ds_read_b128 v[204:207], v31 offset:19456
  v_pk_mul_f16 v56, v42, v45 op_sel:[0,1] op_sel_hi:[1,0]
  v_pk_mul_f16 v57, v42, v46 op_sel:[0,0] op_sel_hi:[1,1]
  v_mfma_f32_16x16x32_f16 v[68:71], v[108:111], v[64:67], v[68:71]
  ds_read_b128 v[120:123], v28 offset:9216
  v_pk_mul_f16 v58, v42, v46 op_sel:[0,1] op_sel_hi:[1,0]
  v_pk_mul_f16 v59, v40, v48 op_sel:[0,0] op_sel_hi:[1,1]
  v_mfma_f32_16x16x32_f16 v[72:75], v[152:155], v[64:67], v[72:75]
  ds_read_b128 v[164:167], v28 offset:44480
  v_pk_mul_f16 v60, v41, v49 op_sel:[0,0] op_sel_hi:[1,1]
  v_pk_mul_f16 v61, v42, v50 op_sel:[0,0] op_sel_hi:[1,1]
  s_waitcnt lgkmcnt(14)
  v_mfma_f32_16x16x32_f16 v[76:79], v[196:199], v[64:67], v[76:79]
  ds_read_b128 v[208:211], v31 offset:20480
  v_pk_mul_f16 v62, v40, v49 op_sel:[0,0] op_sel_hi:[1,1]
  v_pk_mul_f16 v63, v40, v49 op_sel:[0,1] op_sel_hi:[1,0]
  v_mfma_f32_16x16x32_f16 v[68:71], v[112:115], v[52:55], v[68:71]
  ds_read2_b32 v[236:237], v29 offset0:0 offset1:2
  ds_read2_b32 v[238:239], v29 offset0:64 offset1:66
  v_add_u32 v29, 2048, v29
  v_pk_mul_f16 v64, v40, v50 op_sel:[0,0] op_sel_hi:[1,1]
  v_pk_mul_f16 v65, v40, v50 op_sel:[0,1] op_sel_hi:[1,0]
  v_mfma_f32_16x16x32_f16 v[72:75], v[156:159], v[52:55], v[72:75]
  ds_read_b128 v[124:127], v28 offset:10240
  v_pk_mul_f16 v66, v41, v50 op_sel:[0,0] op_sel_hi:[1,1]
  v_pk_mul_f16 v67, v41, v50 op_sel:[0,1] op_sel_hi:[1,0]
  v_mfma_f32_16x16x32_f16 v[76:79], v[200:203], v[52:55], v[76:79]
  ds_read_b128 v[168:171], v28 offset:45504
  s_waitcnt lgkmcnt(8)
  v_cvt_pk_f16_f32 v43, v38, v39
  v_cvt_pk_f16_f32 v40, v32, v35
  v_smfmac_f32_16x16x64_f16 v[80:83], v[232:235], v[52:59], v16
  ds_read_b128 v[212:215], v31 offset:21504
  ds_read_b64_tr_b16 v[52:53], v8 offset:32
  ds_read_b64_tr_b16 v[54:55], v8 offset:544
  v_mfma_f32_16x16x32_f16 v[68:71], v[116:119], v[56:59], v[68:71]
  v_cvt_pk_f16_f32 v41, v33, v36
  v_cvt_pk_f16_f32 v42, v34, v37
  v_mfma_f32_16x16x32_f16 v[72:75], v[160:163], v[56:59], v[72:75]
  ds_write_b128 v10, v[40:43]
  s_waitcnt lgkmcnt(11)
  v_mfma_f32_16x16x32_f16 v[76:79], v[204:207], v[56:59], v[76:79]
  v_pk_mul_f16 v56, v40, v40 op_sel:[0,0] op_sel_hi:[1,1]
  v_pk_mul_f16 v57, v41, v41 op_sel:[0,0] op_sel_hi:[1,1]
  s_waitcnt lgkmcnt(10)
  v_mfma_f32_16x16x32_f16 v[68:71], v[120:123], v[60:63], v[68:71]
  v_pk_mul_f16 v58, v42, v42 op_sel:[0,0] op_sel_hi:[1,1]
  v_pk_mul_f16 v59, v40, v41 op_sel:[0,0] op_sel_hi:[1,1]
  s_waitcnt lgkmcnt(9)
  v_mfma_f32_16x16x32_f16 v[72:75], v[164:167], v[60:63], v[72:75]
  ds_read_b128 v[44:47], v11
  ds_read_b128 v[48:51], v12
  s_waitcnt lgkmcnt(10)
  v_mfma_f32_16x16x32_f16 v[76:79], v[208:211], v[60:63], v[76:79]
  v_or3_b32 v15, v56, v57, v58
  s_waitcnt lgkmcnt(8)
  v_smfmac_f32_16x16x64_f16 v[80:83], v[236:239], v[60:67], v16
  v_pk_mul_f16 v60, v40, v41 op_sel:[0,1] op_sel_hi:[1,0]
  v_pk_mul_f16 v61, v40, v42 op_sel:[0,0] op_sel_hi:[1,1]
  s_waitcnt lgkmcnt(7)
  v_mfma_f32_16x16x32_f16 v[68:71], v[124:127], v[64:67], v[68:71]
  v_pk_mul_f16 v62, v40, v42 op_sel:[0,1] op_sel_hi:[1,0]
  v_pk_mul_f16 v63, v41, v42 op_sel:[0,0] op_sel_hi:[1,1]
  s_waitcnt lgkmcnt(6)
  v_mfma_f32_16x16x32_f16 v[72:75], v[168:171], v[64:67], v[72:75]
  v_and_b32 v15, 0x60006000, v15
  v_cmp_ne_u32 s[90:91], 0, v15
  s_waitcnt lgkmcnt(5)
  v_mfma_f32_16x16x32_f16 v[76:79], v[212:215], v[64:67], v[76:79]
  v_add_f32 v22, v80, v81
  v_add_f32 v23, v82, v83
  ds_add_u32 v1, v3 offset:12
  s_branch L_grp1
L_prime:
  v_mov_b32 v68, 0
  v_mov_b32 v69, 0
  v_mov_b32 v70, 0
  v_mov_b32 v71, 0
  v_mov_b32 v72, 0
  v_mov_b32 v73, 0
  v_mov_b32 v74, 0
  v_mov_b32 v75, 0
  v_mov_b32 v76, 0
  v_mov_b32 v77, 0
  v_mov_b32 v78, 0
  v_mov_b32 v79, 0
  v_mov_b32 v80, 0
  v_mov_b32 v81, 0
  v_mov_b32 v82, 0
  v_mov_b32 v83, 0
  v_mov_b32 v22, 0
  v_mov_b32 v23, 0
  ds_read_u16_d16_hi v32, v7 offset:0
  ds_read_u16_d16_hi v33, v7 offset:128
  ds_read_u16_d16_hi v34, v7 offset:256
  ds_read_u16_d16_hi v35, v7 offset:384
  ds_read_u16_d16_hi v36, v7 offset:512
  ds_read_u16_d16_hi v37, v7 offset:640
  ds_read_u16_d16_hi v38, v7 offset:768
  ds_read_u16_d16_hi v39, v7 offset:896
  s_waitcnt lgkmcnt(0)
  v_cvt_pk_f16_f32 v43, v38, v39
  v_cvt_pk_f16_f32 v40, v32, v35
  v_cvt_pk_f16_f32 v41, v33, v36
  v_cvt_pk_f16_f32 v42, v34, v37
  ds_read_b64_tr_b16 v[52:53], v8 offset:0
  ds_read_b64_tr_b16 v[54:55], v8 offset:512
  ds_write_b128 v10, v[40:43]
  ds_read_b128 v[44:47], v11
  ds_read_b128 v[48:51], v12
  v_pk_mul_f16 v56, v40, v40 op_sel:[0,0] op_sel_hi:[1,1]
  v_pk_mul_f16 v57, v41, v41 op_sel:[0,0] op_sel_hi:[1,1]
  v_pk_mul_f16 v58, v42, v42 op_sel:[0,0] op_sel_hi:[1,1]
  v_pk_mul_f16 v59, v40, v41 op_sel:[0,0] op_sel_hi:[1,1]
  v_pk_mul_f16 v60, v40, v41 op_sel:[0,1] op_sel_hi:[1,0]
  v_pk_mul_f16 v61, v40, v42 op_sel:[0,0] op_sel_hi:[1,1]
  v_pk_mul_f16 v62, v40, v42 op_sel:[0,1] op_sel_hi:[1,0]
  v_pk_mul_f16 v63, v41, v42 op_sel:[0,0] op_sel_hi:[1,1]
  s_waitcnt lgkmcnt(0)
  v_alignbit_b32 v48, v48, v48, v13
  v_alignbit_b32 v49, v49, v49, v13
L_cin_loop:
  s_cmp_lg_u32 s84, 0
  s_cbranch_scc1 L_pr0
  s_setprio 2
L_pr0:
  v_mfma_f32_16x16x32_f16 v[80:83], v[216:219], v[56:59], 0
  v_fmac_f32 v14, v68, v72
  v_fmac_f32 v14, v69, v73
  v_fmac_f32 v14, v70, v74
  v_fmac_f32 v14, v71, v75
  v_mfma_f32_16x16x32_bf16 v[72:75], v[240:243], v[52:55], 0
  v_pk_mul_f16 v64, v41, v42 op_sel:[0,1] op_sel_hi:[1,0]
  v_pk_mul_f16 v65, v40, v43 op_sel:[0,0] op_sel_hi:[1,0]
  v_mfma_f32_16x16x32_f16 v[68:71], v[84:87], v[56:59], 0
  v_fmac_f32 v14, v76, v77
  v_fmac_f32 v14, v22, v78
  v_fmac_f32 v14, v23, v79
  v_mfma_f32_16x16x32_bf16 v[76:79], v[244:247], v[52:55], 0
  v_pk_mul_f16 v66, v41, v43 op_sel:[0,0] op_sel_hi:[1,0]
  v_pk_mul_f16 v67, v42, v43 op_sel:[0,0] op_sel_hi:[1,0]
  v_mfma_f32_16x16x32_f16 v[72:75], v[128:131], v[56:59], v[72:75]
  v_add_f32_dpp v14, v14, v14 row_shr:1 row_mask:0xf bank_mask:0xf
  v_alignbit_b32 v50, v50, v50, v13
  v_mfma_f32_16x16x32_f16 v[68:71], v[88:91], v[60:63], v[68:71]
  v_mul_f16_sdwa v52, v40, v40 dst_sel:WORD_0 dst_unused:UNUSED_PAD src0_sel:WORD_0 src1_sel:WORD_1
  v_mul_f16_sdwa v53, v42, v42 dst_sel:WORD_0 dst_unused:UNUSED_PAD src0_sel:WORD_0 src1_sel:WORD_1
  v_mfma_f32_16x16x32_f16 v[76:79], v[172:175], v[56:59], v[76:79]
  v_add_f32_dpp v14, v14, v14 row_shr:2 row_mask:0xf bank_mask:0xf
  v_mfma_f32_16x16x32_f16 v[72:75], v[132:135], v[60:63], v[72:75]
  v_mul_f16_sdwa v52, v41, v41 dst_sel:WORD_1 dst_unused:UNUSED_PRESERVE src0_sel:WORD_0 src1_sel:WORD_1
  v_mul_f16_sdwa v53, v43, v43 dst_sel:WORD_1 dst_unused:UNUSED_PRESERVE src0_sel:WORD_0 src1_sel:WORD_1
  v_mfma_f32_16x16x32_f16 v[68:71], v[92:95], v[64:67], v[68:71]
  v_add_f32_dpp v14, v14, v14 row_shr:4 row_mask:0xf bank_mask:0xf
  v_pk_mul_f16 v54, v40, v47 op_sel:[0,0] op_sel_hi:[1,0]
  v_mfma_f32_16x16x32_f16 v[76:79], v[176:179], v[60:63], v[76:79]
  v_pk_mul_f16 v55, v41, v47 op_sel:[0,0] op_sel_hi:[1,0]
  v_pk_mul_f16 v56, v42, v47 op_sel:[0,0] op_sel_hi:[1,0]
  v_smfmac_f32_16x16x64_f16 v[80:83], v[220:223], v[60:67], v16
  v_add_f32_dpp v14, v14, v14 row_shr:8 row_mask:0xf bank_mask:0xf
  v_pk_mul_f16 v57, v40, v44 op_sel:[0,0] op_sel_hi:[1,1]
  v_mfma_f32_16x16x32_f16 v[72:75], v[136:139], v[64:67], v[72:75]
  v_pk_mul_f16 v58, v40, v44 op_sel:[0,1] op_sel_hi:[1,0]
  v_pk_mul_f16 v59, v40, v45 op_sel:[0,0] op_sel_hi:[1,1]
  v_mfma_f32_16x16x32_f16 v[76:79], v[180:183], v[64:67], v[76:79]
  v_add_f32_dpp v14, v14, v14 row_bcast:15 row_mask:0xa bank_mask:0xf
  v_pk_mul_f16 v60, v40, v45 op_sel:[0,1] op_sel_hi:[1,0]
  v_mfma_f32_16x16x32_f16 v[68:71], v[96:99], v[52:55], v[68:71]
  v_pk_mul_f16 v61, v40, v46 op_sel:[0,0] op_sel_hi:[1,1]
  v_pk_mul_f16 v62, v40, v46 op_sel:[0,1] op_sel_hi:[1,0]
  v_mfma_f32_16x16x32_f16 v[72:75], v[140:143], v[52:55], v[72:75]
  v_add_f32_dpp v14, v14, v14 row_bcast:31 row_mask:0xc bank_mask:0xf
  v_pk_mul_f16 v63, v41, v44 op_sel:[0,0] op_sel_hi:[1,1]
  v_mfma_f32_16x16x32_f16 v[76:79], v[184:187], v[52:55], v[76:79]
  s_waitcnt vmcnt(0)
  s_cmp_le_u32 s72, 3
  s_cbranch_scc1 L_blk
  v_lshlrev_b32 v21, 7, v21
  buffer_load_dword v255, v21, s[32:35], 0 offen
  buffer_load_dword v21, v20, s[28:31], s77 offen
  s_cmp_eq_u32 s77, s73
  s_cselect_b32 s73, 0x7000000, s73
  s_cselect_b32 s77, 0x7000000, s77
  s_add_u32 s77, s77, 24
  s_min_u32 s77, s77, s73
  s_mov_b64 exec, 131071
  buffer_load_dword v255, v19, s[44:47], s101 offen
  s_mov_b64 exec, -1
  s_add_u32 s101, s101, 1171456
L_blk:
  s_cmp_eq_u32 s50, 0
  s_cbranch_scc1 L_blkend
  v_readlane_b32 s81, v14, 63
  v_ldexp_f32 v14, v14, s49
  v_and_b32 v14, -2, v14
  s_cmp_eq_u32 s50, 2
  s_cbranch_scc1 L_good
  s_cmp_eq_u64 s[90:91], 0
  s_cbranch_scc1 L_slow
  s_bfe_u32 s81, s81, 0x80017
  s_cmp_eq_u32 s81, 255
  s_cbranch_scc1 L_slow
L_good:
  s_mov_b32 exec_lo, 0
  s_mov_b32 exec_hi, 0x80000000
  buffer_store_dword v14, v251, s[60:63], s85 offen sc1
  s_mov_b64 exec, -1
  s_add_u32 s85, s85, 32
  s_sub_u32 s72, s72, 1
  s_cmp_eq_u32 s72, 0
  s_cbranch_scc1 L_cin_done
  s_cmp_eq_u32 s72, 1
  s_cbranch_scc1 L_lastnext
  v_lshl_add_u32 v24, v24, 7, v18
  v_lshl_add_u32 v25, v25, 7, v18
  s_mov_b32 exec_hi, 0x0000ffff
  v_lshl_add_u32 v26, v26, 7, v18
  v_lshl_add_u32 v27, v27, 7, v18
  s_mov_b32 exec_lo, 0
  s_mov_b32 exec_hi, 0xffff0000
  v_mov_b32 v27, v25
  v_mov_b32 v26, v25
  s_mov_b32 exec_hi, 0x00ff0000
  v_mov_b32 v26, v24
  s_mov_b64 exec, -1
  s_add_u32 m0, s74, 0
  s_nop 0
  buffer_load_dwordx4 v24, s[32:35], 0 offen lds
  s_add_u32 m0, s74, 1056
  s_nop 0
  buffer_load_dwordx4 v25, s[32:35], 0 offen lds
  s_add_u32 m0, s74, 2112
  s_nop 0
  buffer_load_dwordx4 v26, s[32:35], 0 offen lds
  s_add_u32 m0, s74, 3168
  s_mov_b32 exec_hi, 0x00ffffff
  buffer_load_dwordx4 v27, s[32:35], 0 offen lds
  s_mov_b32 exec_hi, -1
  s_add_u32 s94, s94, 832
  s_cmp_lg_u32 s72, s99
  s_cbranch_scc1 L_nodma
  v_mov_b32 v250, 1
  s_mov_b64 exec, 1
  buffer_atomic_add v250, v251, s[60:63], s98 offen sc0
  s_mov_b64 exec, -1
  s_mov_b32 s99, 8
  s_branch L_nodma
L_lastnext:
  s_cmp_lt_i32 s26, 0
  s_cselect_b32 s85, s85, s26
L_nodma:
  s_add_u32 s74, s74, s75
  s_sub_u32 s75, 0, s75
  s_mov_b32 s49, s48
  s_mov_b32 s97, 1
L_blkend:
  s_mov_b32 s50, s97
  v_pk_mul_f16 v64, v41, v44 op_sel:[0,1] op_sel_hi:[1,0]
  v_pk_mul_f16 v65, v41, v45 op_sel:[0,0] op_sel_hi:[1,1]
  v_smfmac_f32_16x16x64_f16 v[80:83], v[224:227], v[52:59], v16
  v_pk_mul_f16 v66, v41, v45 op_sel:[0,1] op_sel_hi:[1,0]
  v_pk_mul_f16 v67, v41, v46 op_sel:[0,0] op_sel_hi:[1,1]
  v_mfma_f32_16x16x32_f16 v[68:71], v[100:103], v[56:59], v[68:71]
  v_pk_mul_f16 v52, v41, v46 op_sel:[0,1] op_sel_hi:[1,0]
  v_pk_mul_f16 v53, v42, v44 op_sel:[0,0] op_sel_hi:[1,1]
  v_mfma_f32_16x16x32_f16 v[72:75], v[144:147], v[56:59], v[72:75]
  v_pk_mul_f16 v54, v42, v44 op_sel:[0,1] op_sel_hi:[1,0]
  v_pk_mul_f16 v55, v42, v45 op_sel:[0,0] op_sel_hi:[1,1]
  v_mfma_f32_16x16x32_f16 v[76:79], v[188:191], v[56:59], v[76:79]
  ds_read_u16_d16_hi v32, v7 offset:32
  ds_read_u16_d16_hi v33, v7 offset:160
  v_mfma_f32_16x16x32_f16 v[68:71], v[104:107], v[60:63], v[68:71]
  ds_read_u16_d16_hi v34, v7 offset:288
  ds_read_u16_d16_hi v35, v7 offset:416
  v_mfma_f32_16x16x32_f16 v[72:75], v[148:151], v[60:63], v[72:75]
  ds_read_u16_d16_hi v36, v7 offset:544
  ds_read_u16_d16_hi v37, v7 offset:672
  v_mfma_f32_16x16x32_f16 v[76:79], v[192:195], v[60:63], v[76:79]
  ds_read_u16_d16_hi v38, v7 offset:800
  ds_read_u16_d16_hi v39, v7 offset:928
  v_smfmac_f32_16x16x64_f16 v[80:83], v[228:231], v[60:67], v16
  v_pk_mul_f16 v56, v42, v45 op_sel:[0,1] op_sel_hi:[1,0]
  v_pk_mul_f16 v57, v42, v46 op_sel:[0,0] op_sel_hi:[1,1]
  v_mfma_f32_16x16x32_f16 v[68:71], v[108:111], v[64:67], v[68:71]
  v_pk_mul_f16 v58, v42, v46 op_sel:[0,1] op_sel_hi:[1,0]
  v_pk_mul_f16 v59, v40, v48 op_sel:[0,0] op_sel_hi:[1,1]
  v_mfma_f32_16x16x32_f16 v[72:75], v[152:155], v[64:67], v[72:75]
  v_pk_mul_f16 v60, v41, v49 op_sel:[0,0] op_sel_hi:[1,1]
  v_pk_mul_f16 v61, v42, v50 op_sel:[0,0] op_sel_hi:[1,1]
  v_mfma_f32_16x16x32_f16 v[76:79], v[196:199], v[64:67], v[76:79]
  v_pk_mul_f16 v62, v40, v49 op_sel:[0,0] op_sel_hi:[1,1]
  v_pk_mul_f16 v63, v40, v49 op_sel:[0,1] op_sel_hi:[1,0]
  v_mfma_f32_16x16x32_f16 v[68:71], v[112:115], v[52:55], v[68:71]
  v_pk_mul_f16 v64, v40, v50 op_sel:[0,0] op_sel_hi:[1,1]
  v_pk_mul_f16 v65, v40, v50 op_sel:[0,1] op_sel_hi:[1,0]
  v_mfma_f32_16x16x32_f16 v[72:75], v[156:159], v[52:55], v[72:75]
  v_pk_mul_f16 v66, v41, v50 op_sel:[0,0] op_sel_hi:[1,1]
  v_pk_mul_f16 v67, v41, v50 op_sel:[0,1] op_sel_hi:[1,0]
  v_mfma_f32_16x16x32_f16 v[76:79], v[200:203], v[52:55], v[76:79]
  s_waitcnt lgkmcnt(0)
  v_cvt_pk_f16_f32 v43, v38, v39
  v_cvt_pk_f16_f32 v40, v32, v35
  v_smfmac_f32_16x16x64_f16 v[80:83], v[232:235], v[52:59], v16
  ds_read_b64_tr_b16 v[52:53], v8 offset:32
  ds_read_b64_tr_b16 v[54:55], v8 offset:544
  v_mfma_f32_16x16x32_f16 v[68:71], v[116:119], v[56:59], v[68:71]
  v_cvt_pk_f16_f32 v41, v33, v36
  v_cvt_pk_f16_f32 v42, v34, v37
  v_mfma_f32_16x16x32_f16 v[72:75], v[160:163], v[56:59], v[72:75]
  ds_write_b128 v10, v[40:43]
  v_mfma_f32_16x16x32_f16 v[76:79], v[204:207], v[56:59], v[76:79]
  v_pk_mul_f16 v56, v40, v40 op_sel:[0,0] op_sel_hi:[1,1]
  v_pk_mul_f16 v57, v41, v41 op_sel:[0,0] op_sel_hi:[1,1]
  v_mfma_f32_16x16x32_f16 v[68:71], v[120:123], v[60:63], v[68:71]
  v_pk_mul_f16 v58, v42, v42 op_sel:[0,0] op_sel_hi:[1,1]
  v_pk_mul_f16 v59, v40, v41 op_sel:[0,0] op_sel_hi:[1,1]
  v_mfma_f32_16x16x32_f16 v[72:75], v[164:167], v[60:63], v[72:75]
  ds_read_b128 v[44:47], v11
  ds_read_b128 v[48:51], v12
  v_mfma_f32_16x16x32_f16 v[76:79], v[208:211], v[60:63], v[76:79]
  v_or3_b32 v15, v56, v57, v58
  v_smfmac_f32_16x16x64_f16 v[80:83], v[236:239], v[60:67], v16
  v_pk_mul_f16 v60, v40, v41 op_sel:[0,1] op_sel_hi:[1,0]
  v_pk_mul_f16 v61, v40, v42 op_sel:[0,0] op_sel_hi:[1,1]
  v_mfma_f32_16x16x32_f16 v[68:71], v[124:127], v[64:67], v[68:71]
  v_pk_mul_f16 v62, v40, v42 op_sel:[0,1] op_sel_hi:[1,0]
  v_pk_mul_f16 v63, v41, v42 op_sel:[0,0] op_sel_hi:[1,1]
  v_mfma_f32_16x16x32_f16 v[72:75], v[168:171], v[64:67], v[72:75]
  v_and_b32 v15, 0x60006000, v15
  v_cmp_ne_u32 s[90:91], 0, v15
  v_mfma_f32_16x16x32_f16 v[76:79], v[212:215], v[64:67], v[76:79]
  v_add_f32 v22, v80, v81
  v_add_f32 v23, v82, v83
L_grp1:
  v_mfma_f32_16x16x32_f16 v[80:83], v[216:219], v[56:59], 0
  s_nop 1
  v_mul_f32 v14, v68, v72
  v_fmac_f32 v14, v69, v73
  v_fmac_f32 v14, v70, v74
  v_fmac_f32 v14, v71, v75
  s_waitcnt lgkmcnt(3)
  v_mfma_f32_16x16x32_bf16 v[72:75], v[240:243], v[52:55], 0
  v_pk_mul_f16 v64, v41, v42 op_sel:[0,1] op_sel_hi:[1,0]
  v_pk_mul_f16 v65, v40, v43 op_sel:[0,0] op_sel_hi:[1,0]
  v_mfma_f32_16x16x32_f16 v[68:71], v[84:87], v[56:59], 0
  v_fmac_f32 v14, v76, v77
  v_fmac_f32 v14, v22, v78
  v_fmac_f32 v14, v23, v79
  v_mfma_f32_16x16x32_bf16 v[76:79], v[244:247], v[52:55], 0
  v_pk_mul_f16 v66, v41, v43 op_sel:[0,0] op_sel_hi:[1,0]
  v_pk_mul_f16 v67, v42, v43 op_sel:[0,0] op_sel_hi:[1,0]
  v_mfma_f32_16x16x32_f16 v[72:75], v[128:131], v[56:59], v[72:75]
  v_mul_f16_sdwa v52, v40, v40 dst_sel:WORD_0 dst_unused:UNUSED_PAD src0_sel:WORD_0 src1_sel:WORD_1
  v_mul_f16_sdwa v53, v42, v42 dst_sel:WORD_0 dst_unused:UNUSED_PAD src0_sel:WORD_0 src1_sel:WORD_1
  v_mfma_f32_16x16x32_f16 v[68:71], v[88:91], v[60:63], v[68:71]
  v_mul_f16_sdwa v52, v41, v41 dst_sel:WORD_1 dst_unused:UNUSED_PRESERVE src0_sel:WORD_0 src1_sel:WORD_1
  v_mul_f16_sdwa v53, v43, v43 dst_sel:WORD_1 dst_unused:UNUSED_PRESERVE src0_sel:WORD_0 src1_sel:WORD_1
  v_mfma_f32_16x16x32_f16 v[76:79], v[172:175], v[56:59], v[76:79]
  s_waitcnt lgkmcnt(1)
  v_pk_mul_f16 v54, v40, v47 op_sel:[0,0] op_sel_hi:[1,0]
  v_pk_mul_f16 v55, v41, v47 op_sel:[0,0] op_sel_hi:[1,0]
  v_mfma_f32_16x16x32_f16 v[72:75], v[132:135], v[60:63], v[72:75]
  v_pk_mul_f16 v56, v42, v47 op_sel:[0,0] op_sel_hi:[1,0]
  v_pk_mul_f16 v57, v40, v44 op_sel:[0,0] op_sel_hi:[1,1]
  v_mfma_f32_16x16x32_f16 v[68:71], v[92:95], v[64:67], v[68:71]
  v_pk_mul_f16 v58, v40, v44 op_sel:[0,1] op_sel_hi:[1,0]
  v_pk_mul_f16 v59, v40, v45 op_sel:[0,0] op_sel_hi:[1,1]
  v_mfma_f32_16x16x32_f16 v[76:79], v[176:179], v[60:63], v[76:79]
  s_waitcnt lgkmcnt(0)
  v_alignbit_b32 v48, v48, v48, v13
  v_alignbit_b32 v49, v49, v49, v13
  v_smfmac_f32_16x16x64_f16 v[80:83], v[220:223], v[60:67], v16
  v_pk_mul_f16 v60, v40, v45 op_sel:[0,1] op_sel_hi:[1,0]
  v_pk_mul_f16 v61, v40, v46 op_sel:[0,0] op_sel_hi:[1,1]
  v_mfma_f32_16x16x32_f16 v[72:75], v[136:139], v[64:67], v[72:75]
  v_pk_mul_f16 v62, v40, v46 op_sel:[0,1] op_sel_hi:[1,0]
  v_pk_mul_f16 v63, v41, v44 op_sel:[0,0] op_sel_hi:[1,1]
  v_mfma_f32_16x16x32_f16 v[76:79], v[180:183], v[64:67], v[76:79]
  v_alignbit_b32 v50, v50, v50, v13
  v_pk_mul_f16 v64, v41, v44 op_sel:[0,1] op_sel_hi:[1,0]
  v_mfma_f32_16x16x32_f16 v[68:71], v[96:99], v[52:55], v[68:71]
  v_pk_mul_f16 v65, v41, v45 op_sel:[0,0] op_sel_hi:[1,1]
  v_pk_mul_f16 v66, v41, v45 op_sel:[0,1] op_sel_hi:[1,0]
  v_mfma_f32_16x16x32_f16 v[72:75], v[140:143], v[52:55], v[72:75]
  v_pk_mul_f16 v67, v41, v46 op_sel:[0,0] op_sel_hi:[1,1]
  ds_read_u16_d16_hi v32, v7 offset:64
  v_mfma_f32_16x16x32_f16 v[76:79], v[184:187], v[52:55], v[76:79]
  ds_read_u16_d16_hi v33, v7 offset:192
  ds_read_u16_d16_hi v34, v7 offset:320
  v_smfmac_f32_16x16x64_f16 v[80:83], v[224:227], v[52:59], v16
  v_pk_mul_f16 v52, v41, v46 op_sel:[0,1] op_sel_hi:[1,0]
  v_pk_mul_f16 v53, v42, v44 op_sel:[0,0] op_sel_hi:[1,1]
  v_mfma_f32_16x16x32_f16 v[68:71], v[100:103], v[56:59], v[68:71]
  v_pk_mul_f16 v54, v42, v44 op_sel:[0,1] op_sel_hi:[1,0]
  v_pk_mul_f16 v55, v42, v45 op_sel:[0,0] op_sel_hi:[1,1]
  v_mfma_f32_16x16x32_f16 v[72:75], v[144:147], v[56:59], v[72:75]
  ds_read_u16_d16_hi v35, v7 offset:448
  ds_read_u16_d16_hi v36, v7 offset:576
  v_mfma_f32_16x16x32_f16 v[76:79], v[188:191], v[56:59], v[76:79]
  ds_read_u16_d16_hi v37, v7 offset:704
  ds_read_u16_d16_hi v38, v7 offset:832
  v_mfma_f32_16x16x32_f16 v[68:71], v[104:107], v[60:63], v[68:71]
  ds_read_u16_d16_hi v39, v7 offset:960
  v_pk_mul_f16 v56, v42, v45 op_sel:[0,1] op_sel_hi:[1,0]
  v_mfma_f32_16x16x32_f16 v[72:75], v[148:151], v[60:63], v[72:75]
  v_pk_mul_f16 v57, v42, v46 op_sel:[0,0] op_sel_hi:[1,1]
  v_pk_mul_f16 v58, v42, v46 op_sel:[0,1] op_sel_hi:[1,0]
  v_mfma_f32_16x16x32_f16 v[76:79], v[192:195], v[60:63], v[76:79]
  v_pk_mul_f16 v59, v40, v48 op_sel:[0,0] op_sel_hi:[1,1]
  v_smfmac_f32_16x16x64_f16 v[80:83], v[228:231], v[60:67], v16
  v_pk_mul_f16 v60, v41, v49 op_sel:[0,0] op_sel_hi:[1,1]
  v_pk_mul_f16 v61, v42, v50 op_sel:[0,0] op_sel_hi:[1,1]
  v_mfma_f32_16x16x32_f16 v[68:71], v[108:111], v[64:67], v[68:71]
  v_pk_mul_f16 v62, v40, v49 op_sel:[0,0] op_sel_hi:[1,1]
  v_pk_mul_f16 v63, v40, v49 op_sel:[0,1] op_sel_hi:[1,0]
  v_mfma_f32_16x16x32_f16 v[72:75], v[152:155], v[64:67], v[72:75]
  v_mfma_f32_16x16x32_f16 v[76:79], v[196:199], v[64:67], v[76:79]
  v_pk_mul_f16 v64, v40, v50 op_sel:[0,0] op_sel_hi:[1,1]
  v_pk_mul_f16 v65, v40, v50 op_sel:[0,1] op_sel_hi:[1,0]
  v_mfma_f32_16x16x32_f16 v[68:71], v[112:115], v[52:55], v[68:71]
  v_pk_mul_f16 v66, v41, v50 op_sel:[0,0] op_sel_hi:[1,1]
  v_pk_mul_f16 v67, v41, v50 op_sel:[0,1] op_sel_hi:[1,0]
  v_mfma_f32_16x16x32_f16 v[72:75], v[156:159], v[52:55], v[72:75]
  s_waitcnt lgkmcnt(0)
  v_cvt_pk_f16_f32 v43, v38, v39
  v_cvt_pk_f16_f32 v40, v32, v35
  v_mfma_f32_16x16x32_f16 v[76:79], v[200:203], v[52:55], v[76:79]
  v_cvt_pk_f16_f32 v41, v33, v36
  v_cvt_pk_f16_f32 v42, v34, v37
  v_smfmac_f32_16x16x64_f16 v[80:83], v[232:235], v[52:59], v16
  ds_read_b64_tr_b16 v[52:53], v8 offset:64
  ds_read_b64_tr_b16 v[54:55], v8 offset:576
  v_mfma_f32_16x16x32_f16 v[68:71], v[116:119], v[56:59], v[68:71]
  ds_write_b128 v10, v[40:43]
  v_mfma_f32_16x16x32_f16 v[72:75], v[160:163], v[56:59], v[72:75]
  ds_read_b128 v[44:47], v11
  ds_read_b128 v[48:51], v12
  v_mfma_f32_16x16x32_f16 v[76:79], v[204:207], v[56:59], v[76:79]
  v_pk_mul_f16 v56, v40, v40 op_sel:[0,0] op_sel_hi:[1,1]
  v_pk_mul_f16 v57, v41, v41 op_sel:[0,0] op_sel_hi:[1,1]
  v_mfma_f32_16x16x32_f16 v[68:71], v[120:123], v[60:63], v[68:71]
  v_pk_mul_f16 v58, v42, v42 op_sel:[0,0] op_sel_hi:[1,1]
  v_pk_mul_f16 v59, v40, v41 op_sel:[0,0] op_sel_hi:[1,1]
  v_mfma_f32_16x16x32_f16 v[72:75], v[164:167], v[60:63], v[72:75]
  v_mfma_f32_16x16x32_f16 v[76:79], v[208:211], v[60:63], v[76:79]
  v_smfmac_f32_16x16x64_f16 v[80:83], v[236:239], v[60:67], v16
  v_pk_mul_f16 v60, v40, v41 op_sel:[0,1] op_sel_hi:[1,0]
  v_pk_mul_f16 v61, v40, v42 op_sel:[0,0] op_sel_hi:[1,1]
  v_mfma_f32_16x16x32_f16 v[68:71], v[124:127], v[64:67], v[68:71]
  v_pk_mul_f16 v62, v40, v42 op_sel:[0,1] op_sel_hi:[1,0]
  v_pk_mul_f16 v63, v41, v42 op_sel:[0,0] op_sel_hi:[1,1]
  v_mfma_f32_16x16x32_f16 v[72:75], v[168:171], v[64:67], v[72:75]
  s_waitcnt lgkmcnt(0)
  v_alignbit_b32 v48, v48, v48, v13
  v_alignbit_b32 v49, v49, v49, v13
  v_mfma_f32_16x16x32_f16 v[76:79], v[212:215], v[64:67], v[76:79]
  v_add_f32 v22, v80, v81
  v_add_f32 v23, v82, v83
  v_mfma_f32_16x16x32_f16 v[80:83], v[216:219], v[56:59], 0
  s_nop 0
  v_fmac_f32 v14, v68, v72
  v_fmac_f32 v14, v69, v73
  v_fmac_f32 v14, v70, v74
  v_fmac_f32 v14, v71, v75
  v_mfma_f32_16x16x32_bf16 v[72:75], v[240:243], v[52:55], 0
  v_pk_mul_f16 v64, v41, v42 op_sel:[0,1] op_sel_hi:[1,0]
  v_pk_mul_f16 v65, v40, v43 op_sel:[0,0] op_sel_hi:[1,0]
  v_mfma_f32_16x16x32_f16 v[68:71], v[84:87], v[56:59], 0
  v_fmac_f32 v14, v76, v77
  v_fmac_f32 v14, v22, v78
  v_fmac_f32 v14, v23, v79
  v_mfma_f32_16x16x32_bf16 v[76:79], v[244:247], v[52:55], 0
  v_pk_mul_f16 v66, v41, v43 op_sel:[0,0] op_sel_hi:[1,0]
  v_pk_mul_f16 v67, v42, v43 op_sel:[0,0] op_sel_hi:[1,0]
  v_mfma_f32_16x16x32_f16 v[72:75], v[128:131], v[56:59], v[72:75]
  v_mul_f16_sdwa v52, v40, v40 dst_sel:WORD_0 dst_unused:UNUSED_PAD src0_sel:WORD_0 src1_sel:WORD_1
  v_mul_f16_sdwa v53, v42, v42 dst_sel:WORD_0 dst_unused:UNUSED_PAD src0_sel:WORD_0 src1_sel:WORD_1
  v_mfma_f32_16x16x32_f16 v[68:71], v[88:91], v[60:63], v[68:71]
  v_mul_f16_sdwa v52, v41, v41 dst_sel:WORD_1 dst_unused:UNUSED_PRESERVE src0_sel:WORD_0 src1_sel:WORD_1
  v_mul_f16_sdwa v53, v43, v43 dst_sel:WORD_1 dst_unused:UNUSED_PRESERVE src0_sel:WORD_0 src1_sel:WORD_1
  v_mfma_f32_16x16x32_f16 v[76:79], v[172:175], v[56:59], v[76:79]
  v_pk_mul_f16 v54, v40, v47 op_sel:[0,0] op_sel_hi:[1,0]
  v_pk_mul_f16 v55, v41, v47 op_sel:[0,0] op_sel_hi:[1,0]
  v_mfma_f32_16x16x32_f16 v[72:75], v[132:135], v[60:63], v[72:75]
  v_pk_mul_f16 v56, v42, v47 op_sel:[0,0] op_sel_hi:[1,0]
  v_pk_mul_f16 v57, v40, v44 op_sel:[0,0] op_sel_hi:[1,1]
  v_mfma_f32_16x16x32_f16 v[68:71], v[92:95], v[64:67], v[68:71]
  v_pk_mul_f16 v58, v40, v44 op_sel:[0,1] op_sel_hi:[1,0]
  v_pk_mul_f16 v59, v40, v45 op_sel:[0,0] op_sel_hi:[1,1]
  v_mfma_f32_16x16x32_f16 v[76:79], v[176:179], v[60:63], v[76:79]
  v_alignbit_b32 v50, v50, v50, v13
  ds_read_u16_d16_hi v32, v7 offset:96
  v_smfmac_f32_16x16x64_f16 v[80:83], v[220:223], v[60:67], v16
  v_pk_mul_f16 v60, v40, v45 op_sel:[0,1] op_sel_hi:[1,0]
  v_pk_mul_f16 v61, v40, v46 op_sel:[0,0] op_sel_hi:[1,1]
  v_mfma_f32_16x16x32_f16 v[72:75], v[136:139], v[64:67], v[72:75]
  v_pk_mul_f16 v62, v40, v46 op_sel:[0,1] op_sel_hi:[1,0]
  v_pk_mul_f16 v63, v41, v44 op_sel:[0,0] op_sel_hi:[1,1]
  v_mfma_f32_16x16x32_f16 v[76:79], v[180:183], v[64:67], v[76:79]
  v_pk_mul_f16 v64, v41, v44 op_sel:[0,1] op_sel_hi:[1,0]
  v_pk_mul_f16 v65, v41, v45 op_sel:[0,0] op_sel_hi:[1,1]
  v_mfma_f32_16x16x32_f16 v[68:71], v[96:99], v[52:55], v[68:71]
  v_pk_mul_f16 v66, v41, v45 op_sel:[0,1] op_sel_hi:[1,0]
  v_pk_mul_f16 v67, v41, v46 op_sel:[0,0] op_sel_hi:[1,1]
  v_mfma_f32_16x16x32_f16 v[72:75], v[140:143], v[52:55], v[72:75]
  ds_read_u16_d16_hi v33, v7 offset:224
  ds_read_u16_d16_hi v34, v7 offset:352
  v_mfma_f32_16x16x32_f16 v[76:79], v[184:187], v[52:55], v[76:79]
  ds_read_u16_d16_hi v35, v7 offset:480
  ds_read_u16_d16_hi v36, v7 offset:608
  v_smfmac_f32_16x16x64_f16 v[80:83], v[224:227], v[52:59], v16
  v_pk_mul_f16 v52, v41, v46 op_sel:[0,1] op_sel_hi:[1,0]
  v_pk_mul_f16 v53, v42, v44 op_sel:[0,0] op_sel_hi:[1,1]
  v_mfma_f32_16x16x32_f16 v[68:71], v[100:103], v[56:59], v[68:71]
  v_pk_mul_f16 v54, v42, v44 op_sel:[0,1] op_sel_hi:[1,0]
  v_pk_mul_f16 v55, v42, v45 op_sel:[0,0] op_sel_hi:[1,1]
  s_cmp_lg_u32 s99, 8
  s_cbranch_scc1 L_hk
  s_waitcnt vmcnt(0)
  v_readfirstlane_b32 s81, v250
  s_mov_b32 s99, 0
  s_add_u32 s81, s81, 485
  s_cmp_ge_u32 s81, 512
  s_cbranch_scc1 L_hk
  s_add_u32 s72, s72, 1
  s_lshr_b32 s94, s98, 14
  s_lshl_b32 s26, s94, 12
  s_add_u32 s26, s26, s81
  s_lshl_b32 s26, s26, 2
  s_add_u32 s26, s26, 10240
  s_lshl_b32 s94, s94, 9
  s_add_u32 s94, s94, s81
  s_mul_i32 s94, s94, 104
L_hk:
  buffer_load_dwordx4 v[24:27], v17, s[28:31], s94 offen offset:0
  v_mfma_f32_16x16x32_f16 v[72:75], v[144:147], v[56:59], v[72:75]
  ds_read_u16_d16_hi v37, v7 offset:736
  ds_read_u16_d16_hi v38, v7 offset:864
  v_mfma_f32_16x16x32_f16 v[76:79], v[188:191], v[56:59], v[76:79]
  ds_read_u16_d16_hi v39, v7 offset:992
  v_pk_mul_f16 v56, v42, v45 op_sel:[0,1] op_sel_hi:[1,0]
  v_mfma_f32_16x16x32_f16 v[68:71], v[104:107], v[60:63], v[68:71]
  v_pk_mul_f16 v57, v42, v46 op_sel:[0,0] op_sel_hi:[1,1]
  v_pk_mul_f16 v58, v42, v46 op_sel:[0,1] op_sel_hi:[1,0]
  v_mfma_f32_16x16x32_f16 v[72:75], v[148:151], v[60:63], v[72:75]
  v_pk_mul_f16 v59, v40, v48 op_sel:[0,0] op_sel_hi:[1,1]
  v_mfma_f32_16x16x32_f16 v[76:79], v[192:195], v[60:63], v[76:79]
  v_smfmac_f32_16x16x64_f16 v[80:83], v[228:231], v[60:67], v16
  v_pk_mul_f16 v60, v41, v49 op_sel:[0,0] op_sel_hi:[1,1]
  v_pk_mul_f16 v61, v42, v50 op_sel:[0,0] op_sel_hi:[1,1]
  v_mfma_f32_16x16x32_f16 v[68:71], v[108:111], v[64:67], v[68:71]
  v_pk_mul_f16 v62, v40, v49 op_sel:[0,0] op_sel_hi:[1,1]
  v_pk_mul_f16 v63, v40, v49 op_sel:[0,1] op_sel_hi:[1,0]
  v_mfma_f32_16x16x32_f16 v[72:75], v[152:155], v[64:67], v[72:75]
  v_mfma_f32_16x16x32_f16 v[76:79], v[196:199], v[64:67], v[76:79]
  v_pk_mul_f16 v64, v40, v50 op_sel:[0,0] op_sel_hi:[1,1]
  v_pk_mul_f16 v65, v40, v50 op_sel:[0,1] op_sel_hi:[1,0]
  v_mfma_f32_16x16x32_f16 v[68:71], v[112:115], v[52:55], v[68:71]
  v_pk_mul_f16 v66, v41, v50 op_sel:[0,0] op_sel_hi:[1,1]
  v_pk_mul_f16 v67, v41, v50 op_sel:[0,1] op_sel_hi:[1,0]
  v_mfma_f32_16x16x32_f16 v[72:75], v[156:159], v[52:55], v[72:75]
  s_waitcnt lgkmcnt(0)
  v_cvt_pk_f16_f32 v43, v38, v39
  v_cvt_pk_f16_f32 v40, v32, v35
  v_mfma_f32_16x16x32_f16 v[76:79], v[200:203], v[52:55], v[76:79]
  v_cvt_pk_f16_f32 v41, v33, v36
  v_cvt_pk_f16_f32 v42, v34, v37
  v_smfmac_f32_16x16x64_f16 v[80:83], v[232:235], v[52:59], v16
  ds_read_b64_tr_b16 v[52:53], v8 offset:96
  ds_read_b64_tr_b16 v[54:55], v8 offset:608
  v_mfma_f32_16x16x32_f16 v[68:71], v[116:119], v[56:59], v[68:71]
  ds_write_b128 v10, v[40:43]
  v_mfma_f32_16x16x32_f16 v[72:75], v[160:163], v[56:59], v[72:75]
  ds_read_b128 v[44:47], v11
  ds_read_b128 v[48:51], v12
  v_mfma_f32_16x16x32_f16 v[76:79], v[204:207], v[56:59], v[76:79]
  v_pk_mul_f16 v56, v40, v40 op_sel:[0,0] op_sel_hi:[1,1]
  v_pk_mul_f16 v57, v41, v41 op_sel:[0,0] op_sel_hi:[1,1]
  v_mfma_f32_16x16x32_f16 v[68:71], v[120:123], v[60:63], v[68:71]
  v_pk_mul_f16 v58, v42, v42 op_sel:[0,0] op_sel_hi:[1,1]
  v_pk_mul_f16 v59, v40, v41 op_sel:[0,0] op_sel_hi:[1,1]
  v_mfma_f32_16x16x32_f16 v[72:75], v[164:167], v[60:63], v[72:75]
  v_mfma_f32_16x16x32_f16 v[76:79], v[208:211], v[60:63], v[76:79]
  v_smfmac_f32_16x16x64_f16 v[80:83], v[236:239], v[60:67], v16
  v_pk_mul_f16 v60, v40, v41 op_sel:[0,1] op_sel_hi:[1,0]
  v_pk_mul_f16 v61, v40, v42 op_sel:[0,0] op_sel_hi:[1,1]
  v_mfma_f32_16x16x32_f16 v[68:71], v[124:127], v[64:67], v[68:71]
  v_pk_mul_f16 v62, v40, v42 op_sel:[0,1] op_sel_hi:[1,0]
  v_pk_mul_f16 v63, v41, v42 op_sel:[0,0] op_sel_hi:[1,1]
  v_mfma_f32_16x16x32_f16 v[72:75], v[168:171], v[64:67], v[72:75]
  s_waitcnt lgkmcnt(0)
  v_alignbit_b32 v48, v48, v48, v13
  v_alignbit_b32 v49, v49, v49, v13
  v_mfma_f32_16x16x32_f16 v[76:79], v[212:215], v[64:67], v[76:79]
  v_add_f32 v22, v80, v81
  v_add_f32 v23, v82, v83
  s_cmp_lg_u32 s84, 0
  s_cbranch_scc1 L_pr123
  s_setprio 0
L_pr123:
  v_mfma_f32_16x16x32_f16 v[80:83], v[216:219], v[56:59], 0
  v_fmac_f32 v14, v68, v72
  v_fmac_f32 v14, v69, v73
  v_fmac_f32 v14, v70, v74
  v_fmac_f32 v14, v71, v75
  v_mfma_f32_16x16x32_bf16 v[72:75], v[240:243], v[52:55], 0
  v_pk_mul_f16 v64, v41, v42 op_sel:[0,1] op_sel_hi:[1,0]
  v_pk_mul_f16 v65, v40, v43 op_sel:[0,0] op_sel_hi:[1,0]
  v_mfma_f32_16x16x32_f16 v[68:71], v[84:87], v[56:59], 0
  v_fmac_f32 v14, v76, v77
  v_fmac_f32 v14, v22, v78
  v_fmac_f32 v14, v23, v79
  v_mfma_f32_16x16x32_bf16 v[76:79], v[244:247], v[52:55], 0
  v_pk_mul_f16 v66, v41, v43 op_sel:[0,0] op_sel_hi:[1,0]
  v_pk_mul_f16 v67, v42, v43 op_sel:[0,0] op_sel_hi:[1,0]
  v_mfma_f32_16x16x32_f16 v[72:75], v[128:131], v[56:59], v[72:75]
  v_mul_f16_sdwa v52, v40, v40 dst_sel:WORD_0 dst_unused:UNUSED_PAD src0_sel:WORD_0 src1_sel:WORD_1
  v_mul_f16_sdwa v53, v42, v42 dst_sel:WORD_0 dst_unused:UNUSED_PAD src0_sel:WORD_0 src1_sel:WORD_1
  v_mfma_f32_16x16x32_f16 v[68:71], v[88:91], v[60:63], v[68:71]
  v_mul_f16_sdwa v52, v41, v41 dst_sel:WORD_1 dst_unused:UNUSED_PRESERVE src0_sel:WORD_0 src1_sel:WORD_1
  v_mul_f16_sdwa v53, v43, v43 dst_sel:WORD_1 dst_unused:UNUSED_PRESERVE src0_sel:WORD_0 src1_sel:WORD_1
  v_mfma_f32_16x16x32_f16 v[76:79], v[172:175], v[56:59], v[76:79]
  v_add_u32 v7, s75, v7
  s_waitcnt vmcnt(1)
  v_pk_mul_f16 v54, v40, v47 op_sel:[0,0] op_sel_hi:[1,0]
  v_mfma_f32_16x16x32_f16 v[72:75], v[132:135], v[60:63], v[72:75]
  v_pk_mul_f16 v55, v41, v47 op_sel:[0,0] op_sel_hi:[1,0]
  v_pk_mul_f16 v56, v42, v47 op_sel:[0,0] op_sel_hi:[1,0]
  v_mfma_f32_16x16x32_f16 v[68:71], v[92:95], v[64:67], v[68:71]
  v_pk_mul_f16 v57, v40, v44 op_sel:[0,0] op_sel_hi:[1,1]
  v_pk_mul_f16 v58, v40, v44 op_sel:[0,1] op_sel_hi:[1,0]
  v_mfma_f32_16x16x32_f16 v[76:79], v[176:179], v[60:63], v[76:79]
  v_pk_mul_f16 v59, v40, v45 op_sel:[0,0] op_sel_hi:[1,1]
  v_alignbit_b32 v50, v50, v50, v13
  v_smfmac_f32_16x16x64_f16 v[80:83], v[220:223], v[60:67], v16
  v_pk_mul_f16 v60, v40, v45 op_sel:[0,1] op_sel_hi:[1,0]
  v_pk_mul_f16 v61, v40, v46 op_sel:[0,0] op_sel_hi:[1,1]
  v_mfma_f32_16x16x32_f16 v[72:75], v[136:139], v[64:67], v[72:75]
  v_pk_mul_f16 v62, v40, v46 op_sel:[0,1] op_sel_hi:[1,0]
  v_pk_mul_f16 v63, v41, v44 op_sel:[0,0] op_sel_hi:[1,1]
  v_mfma_f32_16x16x32_f16 v[76:79], v[180:183], v[64:67], v[76:79]
  v_pk_mul_f16 v64, v41, v44 op_sel:[0,1] op_sel_hi:[1,0]
  v_pk_mul_f16 v65, v41, v45 op_sel:[0,0] op_sel_hi:[1,1]
  v_mfma_f32_16x16x32_f16 v[68:71], v[96:99], v[52:55], v[68:71]
  v_pk_mul_f16 v66, v41, v45 op_sel:[0,1] op_sel_hi:[1,0]
  v_pk_mul_f16 v67, v41, v46 op_sel:[0,0] op_sel_hi:[1,1]
  v_mfma_f32_16x16x32_f16 v[72:75], v[140:143], v[52:55], v[72:75]
  ds_read_u16_d16_hi v32, v7 offset:0
  ds_read_u16_d16_hi v33, v7 offset:128
  v_mfma_f32_16x16x32_f16 v[76:79], v[184:187], v[52:55], v[76:79]
  ds_read_u16_d16_hi v34, v7 offset:256
  ds_read_u16_d16_hi v35, v7 offset:384
  v_smfmac_f32_16x16x64_f16 v[80:83], v[224:227], v[52:59], v16
  v_pk_mul_f16 v52, v41, v46 op_sel:[0,1] op_sel_hi:[1,0]
  v_pk_mul_f16 v53, v42, v44 op_sel:[0,0] op_sel_hi:[1,1]
  v_mfma_f32_16x16x32_f16 v[68:71], v[100:103], v[56:59], v[68:71]
  v_pk_mul_f16 v54, v42, v44 op_sel:[0,1] op_sel_hi:[1,0]
  v_pk_mul_f16 v55, v42, v45 op_sel:[0,0] op_sel_hi:[1,1]
  v_mfma_f32_16x16x32_f16 v[72:75], v[144:147], v[56:59], v[72:75]
  ds_read_u16_d16_hi v36, v7 offset:512
  ds_read_u16_d16_hi v37, v7 offset:640
  v_mfma_f32_16x16x32_f16 v[76:79], v[188:191], v[56:59], v[76:79]
  ds_read_u16_d16_hi v38, v7 offset:768
  ds_read_u16_d16_hi v39, v7 offset:896
  v_mfma_f32_16x16x32_f16 v[68:71], v[104:107], v[60:63], v[68:71]
  v_pk_mul_f16 v56, v42, v45 op_sel:[0,1] op_sel_hi:[1,0]
  v_pk_mul_f16 v57, v42, v46 op_sel:[0,0] op_sel_hi:[1,1]
  v_mfma_f32_16x16x32_f16 v[72:75], v[148:151], v[60:63], v[72:75]
  v_pk_mul_f16 v58, v42, v46 op_sel:[0,1] op_sel_hi:[1,0]
  v_pk_mul_f16 v59, v40, v48 op_sel:[0,0] op_sel_hi:[1,1]
  v_mfma_f32_16x16x32_f16 v[76:79], v[192:195], v[60:63], v[76:79]
  s_add_u32 s81, s74, s75
  v_add_u32 v8, s81, v9
  v_smfmac_f32_16x16x64_f16 v[80:83], v[228:231], v[60:67], v16
  v_pk_mul_f16 v60, v41, v49 op_sel:[0,0] op_sel_hi:[1,1]
  v_pk_mul_f16 v61, v42, v50 op_sel:[0,0] op_sel_hi:[1,1]
  v_mfma_f32_16x16x32_f16 v[68:71], v[108:111], v[64:67], v[68:71]
  v_pk_mul_f16 v62, v40, v49 op_sel:[0,0] op_sel_hi:[1,1]
  v_pk_mul_f16 v63, v40, v49 op_sel:[0,1] op_sel_hi:[1,0]
  v_mfma_f32_16x16x32_f16 v[72:75], v[152:155], v[64:67], v[72:75]
  v_mfma_f32_16x16x32_f16 v[76:79], v[196:199], v[64:67], v[76:79]
  v_pk_mul_f16 v64, v40, v50 op_sel:[0,0] op_sel_hi:[1,1]
  v_pk_mul_f16 v65, v40, v50 op_sel:[0,1] op_sel_hi:[1,0]
  v_mfma_f32_16x16x32_f16 v[68:71], v[112:115], v[52:55], v[68:71]
  v_pk_mul_f16 v66, v41, v50 op_sel:[0,0] op_sel_hi:[1,1]
  v_pk_mul_f16 v67, v41, v50 op_sel:[0,1] op_sel_hi:[1,0]
  v_mfma_f32_16x16x32_f16 v[72:75], v[156:159], v[52:55], v[72:75]
  s_waitcnt lgkmcnt(0)
  v_cvt_pk_f16_f32 v43, v38, v39
  v_cvt_pk_f16_f32 v40, v32, v35
  v_mfma_f32_16x16x32_f16 v[76:79], v[200:203], v[52:55], v[76:79]
  v_cvt_pk_f16_f32 v41, v33, v36
  v_cvt_pk_f16_f32 v42, v34, v37
  v_smfmac_f32_16x16x64_f16 v[80:83], v[232:235], v[52:59], v16
  ds_read_b64_tr_b16 v[52:53], v8 offset:0
  ds_read_b64_tr_b16 v[54:55], v8 offset:512
  v_mfma_f32_16x16x32_f16 v[68:71], v[116:119], v[56:59], v[68:71]
  ds_write_b128 v10, v[40:43]
  v_mfma_f32_16x16x32_f16 v[72:75], v[160:163], v[56:59], v[72:75]
  ds_read_b128 v[44:47], v11
  ds_read_b128 v[48:51], v12
  v_mfma_f32_16x16x32_f16 v[76:79], v[204:207], v[56:59], v[76:79]
  v_pk_mul_f16 v56, v40, v40 op_sel:[0,0] op_sel_hi:[1,1]
  v_pk_mul_f16 v57, v41, v41 op_sel:[0,0] op_sel_hi:[1,1]
  v_mfma_f32_16x16x32_f16 v[68:71], v[120:123], v[60:63], v[68:71]
  v_pk_mul_f16 v58, v42, v42 op_sel:[0,0] op_sel_hi:[1,1]
  v_pk_mul_f16 v59, v40, v41 op_sel:[0,0] op_sel_hi:[1,1]
  v_mfma_f32_16x16x32_f16 v[72:75], v[164:167], v[60:63], v[72:75]
  v_mfma_f32_16x16x32_f16 v[76:79], v[208:211], v[60:63], v[76:79]
  v_smfmac_f32_16x16x64_f16 v[80:83], v[236:239], v[60:67], v16
  v_pk_mul_f16 v60, v40, v41 op_sel:[0,1] op_sel_hi:[1,0]
  v_pk_mul_f16 v61, v40, v42 op_sel:[0,0] op_sel_hi:[1,1]
  v_mfma_f32_16x16x32_f16 v[68:71], v[124:127], v[64:67], v[68:71]
  v_pk_mul_f16 v62, v40, v42 op_sel:[0,1] op_sel_hi:[1,0]
  v_pk_mul_f16 v63, v41, v42 op_sel:[0,0] op_sel_hi:[1,1]
  v_mfma_f32_16x16x32_f16 v[72:75], v[168:171], v[64:67], v[72:75]
  s_waitcnt lgkmcnt(0)
  v_alignbit_b32 v48, v48, v48, v13
  v_alignbit_b32 v49, v49, v49, v13
  v_mfma_f32_16x16x32_f16 v[76:79], v[212:215], v[64:67], v[76:79]
  v_add_f32 v22, v80, v81
  v_add_f32 v23, v82, v83
  s_cmp_lg_u32 s72, 1
  s_cbranch_scc1 L_cin_loop
  v_fmac_f32 v14, v68, v72
  v_fmac_f32 v14, v69, v73
  v_fmac_f32 v14, v70, v74
  v_fmac_f32 v14, v71, v75
  v_fmac_f32 v14, v76, v77
  v_fmac_f32 v14, v22, v78
  v_fmac_f32 v14, v23, v79
  s_nop 1
  v_add_f32_dpp v14, v14, v14 row_shr:1 row_mask:0xf bank_mask:0xf
  s_nop 1
  v_add_f32_dpp v14, v14, v14 row_shr:2 row_mask:0xf bank_mask:0xf
  s_nop 1
  v_add_f32_dpp v14, v14, v14 row_shr:4 row_mask:0xf bank_mask:0xf
  s_nop 1
  v_add_f32_dpp v14, v14, v14 row_shr:8 row_mask:0xf bank_mask:0xf
  s_nop 1
  v_add_f32_dpp v14, v14, v14 row_bcast:15 row_mask:0xa bank_mask:0xf
  s_nop 1
  v_add_f32_dpp v14, v14, v14 row_bcast:31 row_mask:0xc bank_mask:0xf
  s_branch L_blk
L_slow:
  v_lshlrev_b32 v22, 1, v0
  v_add_u32 v23, s74, v22
  s_mul_i32 s81, s3, 4224
  s_add_u32 s81, s81, 1024
  v_add_u32 v22, s81, v22
  v_add_u32 v8, s81, v9
  v_subrev_u32 v7, s75, v7
L_csync6:
  ds_read_b32 v4, v2 offset:12
  s_waitcnt lgkmcnt(0)
  v_cmp_gt_u32 vcc, 8, v4
  s_cbranch_vccnz L_csync6
  ds_read_u16 v52, v23 offset:0
  ds_read_u16 v53, v23 offset:128
  ds_read_u16 v54, v23 offset:256
  ds_read_u16 v55, v23 offset:384
  ds_read_u16 v56, v23 offset:512
  ds_read_u16 v57, v23 offset:640
  ds_read_u16 v58, v23 offset:768
  ds_read_u16 v59, v23 offset:896
  ds_read_u16 v60, v23 offset:1056
  ds_read_u16 v61, v23 offset:1184
  ds_read_u16 v62, v23 offset:1312
  ds_read_u16 v63, v23 offset:1440
  ds_read_u16 v64, v23 offset:1568
  ds_read_u16 v65, v23 offset:1696
  ds_read_u16 v66, v23 offset:1824
  ds_read_u16 v67, v23 offset:1952
  ds_read_u16 v68, v23 offset:2112
  ds_read_u16 v69, v23 offset:2240
  ds_read_u16 v70, v23 offset:2368
  ds_read_u16 v71, v23 offset:2496
  ds_read_u16 v72, v23 offset:2624
  ds_read_u16 v73, v23 offset:2752
  ds_read_u16 v74, v23 offset:2880
  ds_read_u16 v75, v23 offset:3008
  ds_read_u16 v76, v23 offset:3168
  ds_read_u16 v77, v23 offset:3296
  ds_read_u16 v78, v23 offset:3424
  ds_read_u16 v79, v23 offset:3552
  ds_read_u16 v80, v23 offset:3680
  ds_read_u16 v81, v23 offset:3808
  ds_read_u16 v82, v23 offset:3936
  s_waitcnt lgkmcnt(14)
  v_lshlrev_b32 v52, 16, v52
  v_lshlrev_b32 v53, 16, v53
  v_lshlrev_b32 v54, 16, v54
  v_lshlrev_b32 v55, 16, v55
  v_lshlrev_b32 v56, 16, v56
  v_lshlrev_b32 v57, 16, v57
  v_lshlrev_b32 v58, 16, v58
  v_lshlrev_b32 v59, 16, v59
  v_lshlrev_b32 v60, 16, v60
  v_lshlrev_b32 v61, 16, v61
  v_lshlrev_b32 v62, 16, v62
  v_lshlrev_b32 v63, 16, v63
  v_lshlrev_b32 v64, 16, v64
  v_lshlrev_b32 v65, 16, v65
  v_lshlrev_b32 v66, 16, v66
  v_lshlrev_b32 v67, 16, v67
  v_lshlrev_b32 v68, 16, v68
  s_waitcnt lgkmcnt(13)
  v_lshlrev_b32 v69, 16, v69
  s_waitcnt lgkmcnt(12)
  v_lshlrev_b32 v70, 16, v70
  s_waitcnt lgkmcnt(11)
  v_lshlrev_b32 v71, 16, v71
  s_waitcnt lgkmcnt(10)
  v_lshlrev_b32 v72, 16, v72
  s_waitcnt lgkmcnt(9)
  v_lshlrev_b32 v73, 16, v73
  s_waitcnt lgkmcnt(8)
  v_lshlrev_b32 v74, 16, v74
  s_waitcnt lgkmcnt(7)
  v_lshlrev_b32 v75, 16, v75
  s_waitcnt lgkmcnt(6)
  v_lshlrev_b32 v76, 16, v76
  s_waitcnt lgkmcnt(5)
  v_lshlrev_b32 v77, 16, v77
  s_waitcnt lgkmcnt(4)
  v_lshlrev_b32 v78, 16, v78
  s_waitcnt lgkmcnt(3)
  v_lshlrev_b32 v79, 16, v79
  s_waitcnt lgkmcnt(2)
  v_lshlrev_b32 v80, 16, v80
  s_waitcnt lgkmcnt(1)
  v_lshlrev_b32 v81, 16, v81
  s_waitcnt lgkmcnt(0)
  v_lshlrev_b32 v82, 16, v82
  v_max3_f32 v14, abs(v52), abs(v53), abs(v54)
  v_max3_f32 v14, v14, abs(v55), abs(v56)
  v_max3_f32 v14, v14, abs(v57), abs(v58)
  v_max3_f32 v14, v14, abs(v59), abs(v60)
  v_max3_f32 v14, v14, abs(v61), abs(v62)
  v_max3_f32 v14, v14, abs(v63), abs(v64)
  v_max3_f32 v14, v14, abs(v65), abs(v66)
  v_max3_f32 v14, v14, abs(v67), abs(v68)
  v_max3_f32 v14, v14, abs(v69), abs(v70)
  v_max3_f32 v14, v14, abs(v71), abs(v72)
  v_max3_f32 v14, v14, abs(v73), abs(v74)
  v_max3_f32 v14, v14, abs(v75), abs(v76)
  v_max3_f32 v14, v14, abs(v77), abs(v78)
  v_max3_f32 v14, v14, abs(v79), abs(v80)
  v_max3_f32 v14, v14, abs(v81), abs(v82)
  s_nop 1
  v_max_u32_dpp v14, v14, v14 row_shr:1 row_mask:0xf bank_mask:0xf
  s_nop 1
  v_max_u32_dpp v14, v14, v14 row_shr:2 row_mask:0xf bank_mask:0xf
  s_nop 1
  v_max_u32_dpp v14, v14, v14 row_shr:4 row_mask:0xf bank_mask:0xf
  s_nop 1
  v_max_u32_dpp v14, v14, v14 row_shr:8 row_mask:0xf bank_mask:0xf
  s_nop 1
  v_max_u32_dpp v14, v14, v14 row_bcast:15 row_mask:0xa bank_mask:0xf
  s_nop 1
  v_max_u32_dpp v14, v14, v14 row_bcast:31 row_mask:0xc bank_mask:0xf
  s_nop 0
  v_readlane_b32 s81, v14, 63
  s_nop 0
  s_lshr_b32 s81, s81, 23
  s_sub_i32 s81, 134, s81
  s_min_i32 s81, s81, 16
  s_lshl_b32 s49, s81, 2
  s_sub_i32 s49, s48, s49
  s_add_i32 s81, s81, 127
  s_lshl_b32 s81, s81, 23
  v_mov_b32 v83, s81
  v_mul_f32 v52, s81, v52
  v_mul_f32 v53, s81, v53
  v_mul_f32 v54, s81, v54
  v_mul_f32 v55, s81, v55
  v_mul_f32 v56, s81, v56
  v_mul_f32 v57, s81, v57
  v_mul_f32 v58, s81, v58
  v_mul_f32 v59, s81, v59
  v_mul_f32 v60, s81, v60
  v_mul_f32 v61, s81, v61
  v_mul_f32 v62, s81, v62
  v_mul_f32 v63, s81, v63
  v_mul_f32 v64, s81, v64
  v_mul_f32 v65, s81, v65
  v_mul_f32 v66, s81, v66
  v_mul_f32 v67, s81, v67
  v_mul_f32 v68, s81, v68
  v_mul_f32 v69, s81, v69
  v_mul_f32 v70, s81, v70
  v_mul_f32 v71, s81, v71
  v_mul_f32 v72, s81, v72
  v_mul_f32 v73, s81, v73
  v_mul_f32 v74, s81, v74
  v_mul_f32 v75, s81, v75
  v_mul_f32 v76, s81, v76
  v_mul_f32 v77, s81, v77
  v_mul_f32 v78, s81, v78
  v_mul_f32 v79, s81, v79
  v_mul_f32 v80, s81, v80
  v_mul_f32 v81, s81, v81
  v_mul_f32 v82, s81, v82
  ds_write_b16_d16_hi v23, v52 offset:0
  ds_write_b16_d16_hi v23, v53 offset:128
  ds_write_b16_d16_hi v23, v54 offset:256
  ds_write_b16_d16_hi v23, v55 offset:384
  ds_write_b16_d16_hi v23, v56 offset:512
  ds_write_b16_d16_hi v23, v57 offset:640
  ds_write_b16_d16_hi v23, v58 offset:768
  ds_write_b16_d16_hi v23, v59 offset:896
  ds_write_b16_d16_hi v23, v60 offset:1056
  ds_write_b16_d16_hi v23, v61 offset:1184
  ds_write_b16_d16_hi v23, v62 offset:1312
  ds_write_b16_d16_hi v23, v63 offset:1440
  ds_write_b16_d16_hi v23, v64 offset:1568
  ds_write_b16_d16_hi v23, v65 offset:1696
  ds_write_b16_d16_hi v23, v66 offset:1824
  ds_write_b16_d16_hi v23, v67 offset:1952
  ds_write_b16_d16_hi v23, v68 offset:2112
  ds_write_b16_d16_hi v23, v69 offset:2240
  ds_write_b16_d16_hi v23, v70 offset:2368
  ds_write_b16_d16_hi v23, v71 offset:2496
  ds_write_b16_d16_hi v23, v72 offset:2624
  ds_write_b16_d16_hi v23, v73 offset:2752
  ds_write_b16_d16_hi v23, v74 offset:2880
  ds_write_b16_d16_hi v23, v75 offset:3008
  ds_write_b16_d16_hi v23, v76 offset:3168
  ds_write_b16_d16_hi v23, v77 offset:3296
  ds_write_b16_d16_hi v23, v78 offset:3424
  ds_write_b16_d16_hi v23, v79 offset:3552
  ds_write_b16_d16_hi v23, v80 offset:3680
  ds_write_b16_d16_hi v23, v81 offset:3808
  ds_write_b16_d16_hi v23, v82 offset:3936
  v_mul_f32 v52, s81, v52
  v_mul_f32 v53, s81, v53
  v_mul_f32 v54, s81, v54
  v_mul_f32 v55, s81, v55
  v_mul_f32 v56, s81, v56
  v_mul_f32 v57, s81, v57
  v_mul_f32 v58, s81, v58
  v_mul_f32 v59, s81, v59
  v_mul_f32 v60, s81, v60
  v_mul_f32 v61, s81, v61
  v_mul_f32 v62, s81, v62
  v_mul_f32 v63, s81, v63
  v_mul_f32 v64, s81, v64
  v_mul_f32 v65, s81, v65
  v_mul_f32 v66, s81, v66
  v_mul_f32 v67, s81, v67
  v_mul_f32 v68, s81, v68
  v_mul_f32 v69, s81, v69
  v_mul_f32 v70, s81, v70
  v_mul_f32 v71, s81, v71
  v_mul_f32 v72, s81, v72
  v_mul_f32 v73, s81, v73
  v_mul_f32 v74, s81, v74
  v_mul_f32 v75, s81, v75
  v_mul_f32 v76, s81, v76
  v_mul_f32 v77, s81, v77
  v_mul_f32 v78, s81, v78
  v_mul_f32 v79, s81, v79
  v_mul_f32 v80, s81, v80
  v_mul_f32 v81, s81, v81
  v_mul_f32 v82, s81, v82
  v_mul_f32 v83, s81, v83
  ds_write_b16_d16_hi v22, v52 offset:0
  ds_write_b16_d16_hi v22, v53 offset:128
  ds_write_b16_d16_hi v22, v54 offset:256
  ds_write_b16_d16_hi v22, v55 offset:384
  ds_write_b16_d16_hi v22, v56 offset:512
  ds_write_b16_d16_hi v22, v57 offset:640
  ds_write_b16_d16_hi v22, v58 offset:768
  ds_write_b16_d16_hi v22, v59 offset:896
  ds_write_b16_d16_hi v22, v60 offset:1056
  ds_write_b16_d16_hi v22, v61 offset:1184
  ds_write_b16_d16_hi v22, v62 offset:1312
  ds_write_b16_d16_hi v22, v63 offset:1440
  ds_write_b16_d16_hi v22, v64 offset:1568
  ds_write_b16_d16_hi v22, v65 offset:1696
  ds_write_b16_d16_hi v22, v66 offset:1824
  ds_write_b16_d16_hi v22, v67 offset:1952
  ds_write_b16_d16_hi v22, v68 offset:2112
  ds_write_b16_d16_hi v22, v69 offset:2240
  ds_write_b16_d16_hi v22, v70 offset:2368
  ds_write_b16_d16_hi v22, v71 offset:2496
  ds_write_b16_d16_hi v22, v72 offset:2624
  ds_write_b16_d16_hi v22, v73 offset:2752
  ds_write_b16_d16_hi v22, v74 offset:2880
  ds_write_b16_d16_hi v22, v75 offset:3008
  ds_write_b16_d16_hi v22, v76 offset:3168
  ds_write_b16_d16_hi v22, v77 offset:3296
  ds_write_b16_d16_hi v22, v78 offset:3424
  ds_write_b16_d16_hi v22, v79 offset:3552
  ds_write_b16_d16_hi v22, v80 offset:3680
  ds_write_b16_d16_hi v22, v81 offset:3808
  ds_write_b16_d16_hi v22, v82 offset:3936
  ds_write_b16_d16_hi v22, v83 offset:4064
  s_mov_b32 s50, 0
  s_mov_b32 s97, 2
  s_waitcnt lgkmcnt(0)
  s_branch L_prime
L_cin_done:
  s_endpgm
L_rem:
  s_lshr_b32 s84, s3, 2
  s_and_b32 s68, s2, 7
  s_lshl_b32 s68, s68, 3
  s_add_u32 s68, s68, s3
  s_mul_i32 s68, s68, 6656
  s_lshl_b32 s76, s3, 14
  v_lshlrev_b32 v248, 4, v0
  v_lshrrev_b32 v246, 4, v0
  v_lshrrev_b32 v247, 3, v0
  v_mul_u32_u24 v13, 3328, v247
  v_and_b32 v247, 2, v247
  s_and_b32 s69, s3, 1
  s_lshl_b32 s69, s69, 2
  v_or_b32 v247, s69, v247
  v_and_b32 v9, 7, v0
  v_xor_b32 v247, v247, v9
  v_lshl_add_u32 v13, v247, 4, v13
  s_mul_i32 s74, s3, 26624
  s_add_u32 s74, s74, 3200
  s_lshl_b32 s75, s3, 10
  s_add_u32 s75, s75, 131072
  s_waitcnt lgkmcnt(0)
  s_mov_b32 s28, s4
  s_and_b32 s29, s5, 0xffff
  s_mov_b32 s30, 425984
  s_mov_b32 s31, 0x20000
  s_add_u32 m0, s76, 8192
  s_nop 0
  buffer_load_dwordx4 v248, s[28:31], s68 offen lds
  s_add_u32 s68, s68, 1024
  s_add_u32 m0, s76, 9216
  s_nop 0
  buffer_load_dwordx4 v248, s[28:31], s68 offen lds
  s_add_u32 s68, s68, 1024
  s_add_u32 m0, s76, 10240
  s_nop 0
  buffer_load_dwordx4 v248, s[28:31], s68 offen lds
  s_add_u32 s68, s68, 1024
  s_add_u32 m0, s76, 11264
  s_nop 0
  buffer_load_dwordx4 v248, s[28:31], s68 offen lds
  s_add_u32 s68, s68, 1024
  s_add_u32 m0, s76, 12288
  s_nop 0
  buffer_load_dwordx4 v248, s[28:31], s68 offen lds
  s_add_u32 s68, s68, 1024
  s_add_u32 m0, s76, 13312
  s_nop 0
  buffer_load_dwordx4 v248, s[28:31], s68 offen lds
  s_add_u32 s68, s68, 1024
  s_add_u32 m0, s76, 14336
  s_nop 0
  buffer_load_dwordx4 v248, s[28:31], s68 offen lds
  s_add_u32 s68, s68, 1024
  s_mov_b32 s44, s12
  s_and_b32 s45, s13, 0xffff
  s_mov_b32 s46, 5537792
  s_mov_b32 s47, 0x20000
  s_add_u32 m0, s75, 0
  s_nop 0
  buffer_load_dwordx4 v13, s[44:47], s74 offen lds
  s_add_u32 s74, s74, 212992
  s_mov_b32 s48, s14
  s_and_b32 s49, s15, 0xffff
  s_mov_b32 s50, 3328
  s_mov_b32 s51, 0x20000
  s_mov_b32 s52, s16
  s_and_b32 s53, s17, 0xffff
  s_mov_b32 s54, 3328
  s_mov_b32 s55, 0x20000
  s_mov_b32 s32, s6
  s_and_b32 s33, s7, 0xffff
  s_mov_b32 s34, 12800000
  s_mov_b32 s35, 0x20000
  v_xor_b32 v248, v9, v246
  v_lshlrev_b32 v14, 4, v248
  v_xor_b32 v15, 64, v14
  v_bfe_u32 v247, v0, 2, 2
  v_lshl_add_u32 v248, v246, 3, v247
  v_lshlrev_b32 v248, 7, v248
  v_and_b32 v247, 3, v0
  v_lshl_add_u32 v248, v247, 3, v248
  v_add_u32 v248, 131072, v248
  v_bfe_u32 v247, v0, 3, 2
  v_lshl_add_u32 v1, v247, 5, v248
  v_xor_b32 v2, 32, v1
  v_xor_b32 v7, 64, v1
  v_xor_b32 v8, 96, v1
  v_and_b32 v248, 15, v0
  v_lshlrev_b32 v248, 7, v248
  v_bfe_u32 v247, v0, 1, 3
  v_xor_b32 v247, v247, v246
  v_lshl_add_u32 v248, v247, 4, v248
  v_add_u32 v11, s76, v248
  v_xor_b32 v12, 64, v11
  v_lshrrev_b32 v247, 3, v0
  v_lshl_add_u32 v248, v9, 3, v247
  v_mul_u32_u24 v248, 104, v248
  v_add_u32 v248, s76, v248
  v_mov_b32 v240, 0xc0135761
  v_mov_b32 v241, 0xc0135761
  v_mov_b32 v242, 0xbdd2d3e8
  v_mov_b32 v243, 0xbdd2d3e8
  v_mov_b32 v244, 0x71800000
  v_mov_b32 v160, 0
  v_mov_b32 v161, 0
  v_mov_b32 v162, 0
  v_mov_b32 v163, 0
  v_mov_b32 v164, 0
  v_mov_b32 v165, 0
  v_mov_b32 v166, 0
  v_mov_b32 v167, 0
  v_mov_b32 v168, 0
  v_mov_b32 v169, 0
  v_mov_b32 v170, 0
  v_mov_b32 v171, 0
  v_mov_b32 v172, 0
  v_mov_b32 v173, 0
  v_mov_b32 v174, 0
  v_mov_b32 v175, 0
  v_mov_b32 v176, 0
  v_mov_b32 v177, 0
  v_mov_b32 v178, 0
  v_mov_b32 v179, 0
  v_mov_b32 v180, 0
  v_mov_b32 v181, 0
  v_mov_b32 v182, 0
  v_mov_b32 v183, 0
  v_mov_b32 v184, 0
  v_mov_b32 v185, 0
  v_mov_b32 v186, 0
  v_mov_b32 v187, 0
  v_mov_b32 v188, 0
  v_mov_b32 v189, 0
  v_mov_b32 v190, 0
  v_mov_b32 v191, 0
  v_mov_b32 v192, 0
  v_mov_b32 v193, 0
  v_mov_b32 v194, 0
  v_mov_b32 v195, 0
  v_mov_b32 v196, 0
  v_mov_b32 v197, 0
  v_mov_b32 v198, 0
  v_mov_b32 v199, 0
  v_mov_b32 v200, 0
  v_mov_b32 v201, 0
  v_mov_b32 v202, 0
  v_mov_b32 v203, 0
  v_mov_b32 v204, 0
  v_mov_b32 v205, 0
  v_mov_b32 v206, 0
  v_mov_b32 v207, 0
  v_mov_b32 v208, 0
  v_mov_b32 v209, 0
  v_mov_b32 v210, 0
  v_mov_b32 v211, 0
  v_mov_b32 v212, 0
  v_mov_b32 v213, 0
  v_mov_b32 v214, 0
  v_mov_b32 v215, 0
  v_mov_b32 v216, 0
  v_mov_b32 v217, 0
  v_mov_b32 v218, 0
  v_mov_b32 v219, 0
  v_mov_b32 v220, 0
  v_mov_b32 v221, 0
  v_mov_b32 v222, 0
  v_mov_b32 v223, 0
  s_waitcnt vmcnt(1)
  ds_read_b64 v[32:33], v248 offset:8192
  ds_read_b64 v[34:35], v248 offset:8200
  ds_read_b64 v[36:37], v248 offset:8208
  ds_read_b64 v[38:39], v248 offset:8216
  ds_read_b64 v[40:41], v248 offset:8224
  ds_read_b64 v[42:43], v248 offset:8232
  ds_read_b64 v[44:45], v248 offset:8240
  ds_read_b64 v[46:47], v248 offset:8248
  ds_read_b64 v[48:49], v248 offset:8256
  ds_read_b64 v[50:51], v248 offset:8264
  ds_read_b64 v[52:53], v248 offset:8272
  ds_read_b64 v[54:55], v248 offset:8280
  ds_read_b64 v[56:57], v248 offset:8288
  v_mov_b32 v24, 0
  v_mov_b32 v25, 0
  v_mov_b32 v26, 0
  v_mov_b32 v27, 0
  v_mov_b32 v28, 0
  v_mov_b32 v29, 0
  v_mov_b32 v30, 0
  v_mov_b32 v31, 0
  v_mov_b32 v58, 0x7f000000
  v_mov_b32 v59, 0x7f000000
  s_waitcnt lgkmcnt(12)
  v_lshlrev_b32 v32, 7, v32
  s_nop 1
  v_add_u32_dpp v24, v32, v14 row_newbcast:0 row_mask:0xf bank_mask:0x3
  v_add_u32_dpp v25, v32, v15 row_newbcast:1 row_mask:0xf bank_mask:0x3
  v_add_u32_dpp v26, v32, v14 row_newbcast:2 row_mask:0xf bank_mask:0x3
  v_add_u32_dpp v27, v32, v15 row_newbcast:3 row_mask:0xf bank_mask:0x3
  v_add_u32_dpp v24, v32, v14 row_newbcast:8 row_mask:0xf bank_mask:0xc
  v_add_u32_dpp v25, v32, v15 row_newbcast:9 row_mask:0xf bank_mask:0xc
  v_add_u32_dpp v26, v32, v14 row_newbcast:10 row_mask:0xf bank_mask:0xc
  v_add_u32_dpp v27, v32, v15 row_newbcast:11 row_mask:0xf bank_mask:0xc
  s_add_u32 m0, s76, 0
  s_nop 0
  buffer_load_dwordx4 v24, s[32:35], 0 offen lds
  s_add_u32 m0, s76, 1024
  s_nop 0
  buffer_load_dwordx4 v25, s[32:35], 0 offen lds
  s_add_u32 m0, s76, 2048
  s_nop 0
  buffer_load_dwordx4 v26, s[32:35], 0 offen lds
  s_add_u32 m0, s76, 3072
  s_nop 0
  buffer_load_dwordx4 v27, s[32:35], 0 offen lds
  v_add_u32_dpp v28, v32, v14 row_newbcast:4 row_mask:0xf bank_mask:0x3
  v_add_u32_dpp v29, v32, v15 row_newbcast:5 row_mask:0xf bank_mask:0x3
  v_add_u32_dpp v30, v32, v14 row_newbcast:6 row_mask:0xf bank_mask:0x3
  v_add_u32_dpp v31, v32, v15 row_newbcast:7 row_mask:0xf bank_mask:0x3
  v_add_u32_dpp v28, v32, v14 row_newbcast:12 row_mask:0xf bank_mask:0xc
  v_add_u32_dpp v29, v32, v15 row_newbcast:13 row_mask:0xf bank_mask:0xc
  v_add_u32_dpp v30, v32, v14 row_newbcast:14 row_mask:0xf bank_mask:0xc
  v_add_u32_dpp v31, v32, v15 row_newbcast:15 row_mask:0xf bank_mask:0xc
  s_add_u32 m0, s76, 4096
  s_nop 0
  buffer_load_dwordx4 v28, s[32:35], 0 offen lds
  s_add_u32 m0, s76, 5120
  s_nop 0
  buffer_load_dwordx4 v29, s[32:35], 0 offen lds
  s_add_u32 m0, s76, 6144
  s_nop 0
  buffer_load_dwordx4 v30, s[32:35], 0 offen lds
  s_add_u32 m0, s76, 7168
  s_nop 0
  buffer_load_dwordx4 v31, s[32:35], 0 offen lds
  s_add_u32 m0, s75, 8192
  s_nop 0
  buffer_load_dwordx4 v13, s[44:47], s74 offen lds
  s_add_u32 s74, s74, 212992
  s_waitcnt lgkmcnt(0)
  v_lshlrev_b32 v57, 7, v57
  v_lshlrev_b32 v56, 7, v56
  v_lshlrev_b32 v55, 7, v55
  v_lshlrev_b32 v54, 7, v54
  v_lshlrev_b32 v53, 7, v53
  v_lshlrev_b32 v52, 7, v52
  v_lshlrev_b32 v51, 7, v51
  v_lshlrev_b32 v50, 7, v50
  v_lshlrev_b32 v49, 7, v49
  v_lshlrev_b32 v48, 7, v48
  v_lshlrev_b32 v47, 7, v47
  v_lshlrev_b32 v46, 7, v46
  v_lshlrev_b32 v45, 7, v45
  v_lshlrev_b32 v44, 7, v44
  v_lshlrev_b32 v43, 7, v43
  v_lshlrev_b32 v42, 7, v42
  v_lshlrev_b32 v41, 7, v41
  v_lshlrev_b32 v40, 7, v40
  v_lshlrev_b32 v39, 7, v39
  v_lshlrev_b32 v38, 7, v38
  v_lshlrev_b32 v37, 7, v37
  v_lshlrev_b32 v36, 7, v36
  v_lshlrev_b32 v35, 7, v35
  v_lshlrev_b32 v34, 7, v34
  v_lshlrev_b32 v33, 7, v33
  s_nop 1
  v_add_u32_dpp v24, v33, v14 row_newbcast:0 row_mask:0xf bank_mask:0x3
  v_add_u32_dpp v25, v33, v15 row_newbcast:1 row_mask:0xf bank_mask:0x3
  v_add_u32_dpp v26, v33, v14 row_newbcast:2 row_mask:0xf bank_mask:0x3
  v_add_u32_dpp v27, v33, v15 row_newbcast:3 row_mask:0xf bank_mask:0x3
  v_add_u32_dpp v24, v33, v14 row_newbcast:8 row_mask:0xf bank_mask:0xc
  v_add_u32_dpp v25, v33, v15 row_newbcast:9 row_mask:0xf bank_mask:0xc
  v_add_u32_dpp v26, v33, v14 row_newbcast:10 row_mask:0xf bank_mask:0xc
  v_add_u32_dpp v27, v33, v15 row_newbcast:11 row_mask:0xf bank_mask:0xc
  s_add_u32 m0, s76, 8192
  s_nop 0
  buffer_load_dwordx4 v24, s[32:35], 0 offen lds
  s_add_u32 m0, s76, 9216
  s_nop 0
  buffer_load_dwordx4 v25, s[32:35], 0 offen lds
  s_add_u32 m0, s76, 10240
  s_nop 0
  buffer_load_dwordx4 v26, s[32:35], 0 offen lds
  s_add_u32 m0, s76, 11264
  s_nop 0
  buffer_load_dwordx4 v27, s[32:35], 0 offen lds
  v_add_u32_dpp v28, v33, v14 row_newbcast:4 row_mask:0xf bank_mask:0x3
  v_add_u32_dpp v29, v33, v15 row_newbcast:5 row_mask:0xf bank_mask:0x3
  v_add_u32_dpp v30, v33, v14 row_newbcast:6 row_mask:0xf bank_mask:0x3
  v_add_u32_dpp v31, v33, v15 row_newbcast:7 row_mask:0xf bank_mask:0x3
  v_add_u32_dpp v28, v33, v14 row_newbcast:12 row_mask:0xf bank_mask:0xc
  v_add_u32_dpp v29, v33, v15 row_newbcast:13 row_mask:0xf bank_mask:0xc
  v_add_u32_dpp v30, v33, v14 row_newbcast:14 row_mask:0xf bank_mask:0xc
  v_add_u32_dpp v31, v33, v15 row_newbcast:15 row_mask:0xf bank_mask:0xc
  s_add_u32 m0, s76, 12288
  s_nop 0
  buffer_load_dwordx4 v28, s[32:35], 0 offen lds
  s_add_u32 m0, s76, 13312
  s_nop 0
  buffer_load_dwordx4 v29, s[32:35], 0 offen lds
  s_add_u32 m0, s76, 14336
  s_nop 0
  buffer_load_dwordx4 v30, s[32:35], 0 offen lds
  s_add_u32 m0, s76, 15360
  s_nop 0
  buffer_load_dwordx4 v31, s[32:35], 0 offen lds
  s_add_u32 m0, s75, 16384
  s_nop 0
  buffer_load_dwordx4 v13, s[44:47], s74 offen lds
  s_add_u32 s74, s74, 212992
  v_lshlrev_b32 v248, 3, v246
  s_mov_b32 s73, 3
  v_mov_b32 v9, v34
  s_nop 1
  v_add_u32_dpp v24, v9, v14 row_newbcast:0 row_mask:0xf bank_mask:0x3
  v_add_u32_dpp v25, v9, v15 row_newbcast:1 row_mask:0xf bank_mask:0x3
  v_add_u32_dpp v26, v9, v14 row_newbcast:2 row_mask:0xf bank_mask:0x3
  v_add_u32_dpp v27, v9, v15 row_newbcast:3 row_mask:0xf bank_mask:0x3
  v_add_u32_dpp v24, v9, v14 row_newbcast:8 row_mask:0xf bank_mask:0xc
  v_add_u32_dpp v25, v9, v15 row_newbcast:9 row_mask:0xf bank_mask:0xc
  v_add_u32_dpp v26, v9, v14 row_newbcast:10 row_mask:0xf bank_mask:0xc
  v_add_u32_dpp v27, v9, v15 row_newbcast:11 row_mask:0xf bank_mask:0xc
  s_waitcnt vmcnt(14)
  s_barrier
  ds_read_b128 v[76:79], v12 offset:2048
  ds_read_b128 v[72:75], v11 offset:2048
  ds_read_b128 v[68:71], v12 offset:0
  ds_read_b128 v[64:67], v11 offset:0
  ds_read_b64_tr_b16 v[96:97], v1 offset:0
  ds_read_b64_tr_b16 v[98:99], v1 offset:512
  ds_read_b64_tr_b16 v[100:101], v1 offset:4096
  ds_read_b64_tr_b16 v[102:103], v1 offset:4608
  ds_read_b64_tr_b16 v[104:105], v2 offset:0
  ds_read_b64_tr_b16 v[106:107], v2 offset:512
  ds_read_b64_tr_b16 v[108:109], v2 offset:4096
  ds_read_b64_tr_b16 v[110:111], v2 offset:4608
  ds_read_b64_tr_b16 v[112:113], v7 offset:0
  ds_read_b64_tr_b16 v[114:115], v7 offset:512
  ds_read_b64_tr_b16 v[116:117], v7 offset:4096
  ds_read_b64_tr_b16 v[118:119], v7 offset:4608
  ds_read_b64_tr_b16 v[120:121], v8 offset:0
  ds_read_b64_tr_b16 v[122:123], v8 offset:512
  ds_read_b64_tr_b16 v[124:125], v8 offset:4096
  ds_read_b64_tr_b16 v[126:127], v8 offset:4608
L_rem_loop:
  s_waitcnt vmcnt(9)
  s_barrier
  s_waitcnt lgkmcnt(8)
  v_mfma_f32_16x16x32_bf16 v[160:163], v[96:99], v[64:67], v[160:163]
  ds_read_b128 v[92:95], v12 offset:6144
  ds_read_b128 v[88:91], v11 offset:6144
  s_waitcnt lgkmcnt(14)
  v_mfma_f32_16x16x32_bf16 v[160:163], v[100:103], v[68:71], v[160:163]
  ds_read_b128 v[84:87], v12 offset:4096
  s_add_u32 m0, s76, 0
  s_nop 0
  buffer_load_dwordx4 v24, s[32:35], 0 offen lds
  v_mfma_f32_16x16x32_bf16 v[164:167], v[96:99], v[72:75], v[164:167]
  ds_read_b128 v[80:83], v11 offset:4096
  v_mfma_f32_16x16x32_bf16 v[164:167], v[100:103], v[76:79], v[164:167]
  ds_read_b64_tr_b16 v[128:129], v1 offset:8192
  s_waitcnt lgkmcnt(14)
  v_mfma_f32_16x16x32_bf16 v[176:179], v[104:107], v[64:67], v[176:179]
  ds_read_b64_tr_b16 v[130:131], v1 offset:8704
  s_add_u32 m0, s76, 1024
  s_nop 0
  buffer_load_dwordx4 v25, s[32:35], 0 offen lds
  s_waitcnt lgkmcnt(14)
  v_mfma_f32_16x16x32_bf16 v[176:179], v[108:111], v[68:71], v[176:179]
  ds_read_b64_tr_b16 v[132:133], v1 offset:12288
  v_mfma_f32_16x16x32_bf16 v[180:183], v[104:107], v[72:75], v[180:183]
  ds_read_b64_tr_b16 v[134:135], v1 offset:12800
  v_mfma_f32_16x16x32_bf16 v[180:183], v[108:111], v[76:79], v[180:183]
  ds_read_b64_tr_b16 v[136:137], v2 offset:8192
  s_waitcnt lgkmcnt(14)
  v_mfma_f32_16x16x32_bf16 v[192:195], v[112:115], v[64:67], v[192:195]
  ds_read_b64_tr_b16 v[138:139], v2 offset:8704
  s_add_u32 m0, s76, 2048
  s_nop 0
  buffer_load_dwordx4 v26, s[32:35], 0 offen lds
  s_waitcnt lgkmcnt(14)
  v_mfma_f32_16x16x32_bf16 v[192:195], v[116:119], v[68:71], v[192:195]
  ds_read_b64_tr_b16 v[140:141], v2 offset:12288
  v_mfma_f32_16x16x32_bf16 v[196:199], v[112:115], v[72:75], v[196:199]
  ds_read_b64_tr_b16 v[142:143], v2 offset:12800
  v_mfma_f32_16x16x32_bf16 v[196:199], v[116:119], v[76:79], v[196:199]
  v_add_u32_dpp v28, v9, v14 row_newbcast:4 row_mask:0xf bank_mask:0x3
  v_add_u32_dpp v29, v9, v15 row_newbcast:5 row_mask:0xf bank_mask:0x3
  s_waitcnt lgkmcnt(14)
  v_mfma_f32_16x16x32_bf16 v[208:211], v[120:123], v[64:67], v[208:211]
  s_add_u32 m0, s76, 3072
  s_nop 0
  buffer_load_dwordx4 v27, s[32:35], 0 offen lds
  v_add_u32_dpp v30, v9, v14 row_newbcast:6 row_mask:0xf bank_mask:0x3
  v_add_u32_dpp v31, v9, v15 row_newbcast:7 row_mask:0xf bank_mask:0x3
  s_waitcnt lgkmcnt(12)
  v_mfma_f32_16x16x32_bf16 v[208:211], v[124:127], v[68:71], v[208:211]
  v_add_u32_dpp v28, v9, v14 row_newbcast:12 row_mask:0xf bank_mask:0xc
  v_mfma_f32_16x16x32_bf16 v[212:215], v[120:123], v[72:75], v[212:215]
  v_add_u32_dpp v29, v9, v15 row_newbcast:13 row_mask:0xf bank_mask:0xc
  v_add_u32_dpp v30, v9, v14 row_newbcast:14 row_mask:0xf bank_mask:0xc
  v_mfma_f32_16x16x32_bf16 v[212:215], v[124:127], v[76:79], v[212:215]
  v_add_u32_dpp v31, v9, v15 row_newbcast:15 row_mask:0xf bank_mask:0xc
  s_waitcnt vmcnt(9)
  s_waitcnt lgkmcnt(8)
  v_mfma_f32_16x16x32_bf16 v[168:171], v[96:99], v[80:83], v[168:171]
  ds_read_b128 v[76:79], v12 offset:10240
  ds_read_b128 v[72:75], v11 offset:10240
  v_mfma_f32_16x16x32_bf16 v[168:171], v[100:103], v[84:87], v[168:171]
  ds_read_b128 v[68:71], v12 offset:8192
  s_add_u32 m0, s76, 4096
  s_nop 0
  buffer_load_dwordx4 v28, s[32:35], 0 offen lds
  v_mfma_f32_16x16x32_bf16 v[172:175], v[96:99], v[88:91], v[172:175]
  ds_read_b128 v[64:67], v11 offset:8192
  v_mfma_f32_16x16x32_bf16 v[172:175], v[100:103], v[92:95], v[172:175]
  ds_read_b64_tr_b16 v[144:145], v7 offset:8192
  v_mfma_f32_16x16x32_bf16 v[184:187], v[104:107], v[80:83], v[184:187]
  ds_read_b64_tr_b16 v[146:147], v7 offset:8704
  s_add_u32 m0, s76, 5120
  s_nop 0
  buffer_load_dwordx4 v29, s[32:35], 0 offen lds
  v_mfma_f32_16x16x32_bf16 v[184:187], v[108:111], v[84:87], v[184:187]
  ds_read_b64_tr_b16 v[148:149], v7 offset:12288
  v_mfma_f32_16x16x32_bf16 v[188:191], v[104:107], v[88:91], v[188:191]
  ds_read_b64_tr_b16 v[150:151], v7 offset:12800
  v_mfma_f32_16x16x32_bf16 v[188:191], v[108:111], v[92:95], v[188:191]
  ds_read_b64_tr_b16 v[152:153], v8 offset:8192
  s_add_u32 m0, s76, 6144
  s_nop 0
  buffer_load_dwordx4 v30, s[32:35], 0 offen lds
  v_mfma_f32_16x16x32_bf16 v[200:203], v[112:115], v[80:83], v[200:203]
  ds_read_b64_tr_b16 v[154:155], v8 offset:8704
  v_mfma_f32_16x16x32_bf16 v[200:203], v[116:119], v[84:87], v[200:203]
  ds_read_b64_tr_b16 v[156:157], v8 offset:12288
  v_mfma_f32_16x16x32_bf16 v[204:207], v[112:115], v[88:91], v[204:207]
  ds_read_b64_tr_b16 v[158:159], v8 offset:12800
  s_add_u32 m0, s76, 7168
  s_nop 0
  buffer_load_dwordx4 v31, s[32:35], 0 offen lds
  v_mfma_f32_16x16x32_bf16 v[204:207], v[116:119], v[92:95], v[204:207]
  s_set_gpr_idx_on s73, gpr_idx(SRC0)
  s_nop 0
  v_mov_b32 v9, v32
  s_set_gpr_idx_off
  s_add_u32 s73, s73, 1
  v_add_u32_dpp v24, v9, v14 row_newbcast:0 row_mask:0xf bank_mask:0x3
  v_mfma_f32_16x16x32_bf16 v[216:219], v[120:123], v[80:83], v[216:219]
  v_add_u32_dpp v25, v9, v15 row_newbcast:1 row_mask:0xf bank_mask:0x3
  v_add_u32_dpp v26, v9, v14 row_newbcast:2 row_mask:0xf bank_mask:0x3
  v_mfma_f32_16x16x32_bf16 v[216:219], v[124:127], v[84:87], v[216:219]
  s_xor_b32 s75, s75, 16384
  s_add_u32 m0, s75, 8192
  s_nop 0
  buffer_load_dwordx4 v13, s[44:47], s74 offen lds
  s_add_u32 s74, s74, 212992
  s_xor_b32 s75, s75, 16384
  v_add_u32_dpp v27, v9, v15 row_newbcast:3 row_mask:0xf bank_mask:0x3
  v_add_u32_dpp v24, v9, v14 row_newbcast:8 row_mask:0xf bank_mask:0xc
  v_mfma_f32_16x16x32_bf16 v[220:223], v[120:123], v[88:91], v[220:223]
  v_add_u32_dpp v25, v9, v15 row_newbcast:9 row_mask:0xf bank_mask:0xc
  v_add_u32_dpp v26, v9, v14 row_newbcast:10 row_mask:0xf bank_mask:0xc
  v_mfma_f32_16x16x32_bf16 v[220:223], v[124:127], v[92:95], v[220:223]
  v_add_u32_dpp v27, v9, v15 row_newbcast:11 row_mask:0xf bank_mask:0xc
  s_waitcnt vmcnt(9)
  s_barrier
  v_xor_b32 v1, 16384, v1
  v_xor_b32 v2, 16384, v2
  v_xor_b32 v7, 16384, v7
  v_xor_b32 v8, 16384, v8
  s_waitcnt lgkmcnt(8)
  v_mfma_f32_16x16x32_bf16 v[160:163], v[128:131], v[64:67], v[160:163]
  ds_read_b128 v[92:95], v12 offset:14336
  ds_read_b128 v[88:91], v11 offset:14336
  v_mfma_f32_16x16x32_bf16 v[160:163], v[132:135], v[68:71], v[160:163]
  ds_read_b128 v[84:87], v12 offset:12288
  s_add_u32 m0, s76, 8192
  s_nop 0
  buffer_load_dwordx4 v24, s[32:35], 0 offen lds
  v_mfma_f32_16x16x32_bf16 v[164:167], v[128:131], v[72:75], v[164:167]
  ds_read_b128 v[80:83], v11 offset:12288
  v_mfma_f32_16x16x32_bf16 v[164:167], v[132:135], v[76:79], v[164:167]
  ds_read_b64_tr_b16 v[96:97], v1 offset:0
  v_mfma_f32_16x16x32_bf16 v[176:179], v[136:139], v[64:67], v[176:179]
  ds_read_b64_tr_b16 v[98:99], v1 offset:512
  s_add_u32 m0, s76, 9216
  s_nop 0
  buffer_load_dwordx4 v25, s[32:35], 0 offen lds
  v_mfma_f32_16x16x32_bf16 v[176:179], v[140:143], v[68:71], v[176:179]
  ds_read_b64_tr_b16 v[100:101], v1 offset:4096
  v_mfma_f32_16x16x32_bf16 v[180:183], v[136:139], v[72:75], v[180:183]
  ds_read_b64_tr_b16 v[102:103], v1 offset:4608
  v_mfma_f32_16x16x32_bf16 v[180:183], v[140:143], v[76:79], v[180:183]
  ds_read_b64_tr_b16 v[104:105], v2 offset:0
  s_waitcnt lgkmcnt(14)
  v_mfma_f32_16x16x32_bf16 v[192:195], v[144:147], v[64:67], v[192:195]
  ds_read_b64_tr_b16 v[106:107], v2 offset:512
  s_add_u32 m0, s76, 10240
  s_nop 0
  buffer_load_dwordx4 v26, s[32:35], 0 offen lds
  s_waitcnt lgkmcnt(14)
  v_mfma_f32_16x16x32_bf16 v[192:195], v[148:151], v[68:71], v[192:195]
  ds_read_b64_tr_b16 v[108:109], v2 offset:4096
  v_mfma_f32_16x16x32_bf16 v[196:199], v[144:147], v[72:75], v[196:199]
  ds_read_b64_tr_b16 v[110:111], v2 offset:4608
  v_mfma_f32_16x16x32_bf16 v[196:199], v[148:151], v[76:79], v[196:199]
  v_add_u32_dpp v28, v9, v14 row_newbcast:4 row_mask:0xf bank_mask:0x3
  v_add_u32_dpp v29, v9, v15 row_newbcast:5 row_mask:0xf bank_mask:0x3
  s_waitcnt lgkmcnt(14)
  v_mfma_f32_16x16x32_bf16 v[208:211], v[152:155], v[64:67], v[208:211]
  s_add_u32 m0, s76, 11264
  s_nop 0
  buffer_load_dwordx4 v27, s[32:35], 0 offen lds
  v_add_u32_dpp v30, v9, v14 row_newbcast:6 row_mask:0xf bank_mask:0x3
  v_add_u32_dpp v31, v9, v15 row_newbcast:7 row_mask:0xf bank_mask:0x3
  s_waitcnt lgkmcnt(12)
  v_mfma_f32_16x16x32_bf16 v[208:211], v[156:159], v[68:71], v[208:211]
  v_add_u32_dpp v28, v9, v14 row_newbcast:12 row_mask:0xf bank_mask:0xc
  v_mfma_f32_16x16x32_bf16 v[212:215], v[152:155], v[72:75], v[212:215]
  v_add_u32_dpp v29, v9, v15 row_newbcast:13 row_mask:0xf bank_mask:0xc
  v_add_u32_dpp v30, v9, v14 row_newbcast:14 row_mask:0xf bank_mask:0xc
  v_mfma_f32_16x16x32_bf16 v[212:215], v[156:159], v[76:79], v[212:215]
  v_add_u32_dpp v31, v9, v15 row_newbcast:15 row_mask:0xf bank_mask:0xc
  s_waitcnt vmcnt(9)
  s_waitcnt lgkmcnt(8)
  v_mfma_f32_16x16x32_bf16 v[168:171], v[128:131], v[80:83], v[168:171]
  ds_read_b128 v[76:79], v12 offset:2048
  ds_read_b128 v[72:75], v11 offset:2048
  v_mfma_f32_16x16x32_bf16 v[168:171], v[132:135], v[84:87], v[168:171]
  ds_read_b128 v[68:71], v12 offset:0
  s_add_u32 m0, s76, 12288
  s_nop 0
  buffer_load_dwordx4 v28, s[32:35], 0 offen lds
  v_mfma_f32_16x16x32_bf16 v[172:175], v[128:131], v[88:91], v[172:175]
  ds_read_b128 v[64:67], v11 offset:0
  v_mfma_f32_16x16x32_bf16 v[172:175], v[132:135], v[92:95], v[172:175]
  ds_read_b64_tr_b16 v[112:113], v7 offset:0
  v_mfma_f32_16x16x32_bf16 v[184:187], v[136:139], v[80:83], v[184:187]
  ds_read_b64_tr_b16 v[114:115], v7 offset:512
  s_add_u32 m0, s76, 13312
  s_nop 0
  buffer_load_dwordx4 v29, s[32:35], 0 offen lds
  v_mfma_f32_16x16x32_bf16 v[184:187], v[140:143], v[84:87], v[184:187]
  ds_read_b64_tr_b16 v[116:117], v7 offset:4096
  v_mfma_f32_16x16x32_bf16 v[188:191], v[136:139], v[88:91], v[188:191]
  ds_read_b64_tr_b16 v[118:119], v7 offset:4608
  v_mfma_f32_16x16x32_bf16 v[188:191], v[140:143], v[92:95], v[188:191]
  ds_read_b64_tr_b16 v[120:121], v8 offset:0
  s_add_u32 m0, s76, 14336
  s_nop 0
  buffer_load_dwordx4 v30, s[32:35], 0 offen lds
  v_mfma_f32_16x16x32_bf16 v[200:203], v[144:147], v[80:83], v[200:203]
  ds_read_b64_tr_b16 v[122:123], v8 offset:512
  v_mfma_f32_16x16x32_bf16 v[200:203], v[148:151], v[84:87], v[200:203]
  ds_read_b64_tr_b16 v[124:125], v8 offset:4096
  v_mfma_f32_16x16x32_bf16 v[204:207], v[144:147], v[88:91], v[204:207]
  ds_read_b64_tr_b16 v[126:127], v8 offset:4608
  s_add_u32 m0, s76, 15360
  s_nop 0
  buffer_load_dwordx4 v31, s[32:35], 0 offen lds
  v_mfma_f32_16x16x32_bf16 v[204:207], v[148:151], v[92:95], v[204:207]
  s_set_gpr_idx_on s73, gpr_idx(SRC0)
  s_nop 0
  v_mov_b32 v9, v32
  s_set_gpr_idx_off
  s_add_u32 s73, s73, 1
  v_add_u32_dpp v24, v9, v14 row_newbcast:0 row_mask:0xf bank_mask:0x3
  v_mfma_f32_16x16x32_bf16 v[216:219], v[152:155], v[80:83], v[216:219]
  v_add_u32_dpp v25, v9, v15 row_newbcast:1 row_mask:0xf bank_mask:0x3
  v_add_u32_dpp v26, v9, v14 row_newbcast:2 row_mask:0xf bank_mask:0x3
  v_mfma_f32_16x16x32_bf16 v[216:219], v[156:159], v[84:87], v[216:219]
  s_add_u32 m0, s75, 0
  s_nop 0
  buffer_load_dwordx4 v13, s[44:47], s74 offen lds
  s_add_u32 s74, s74, 212992
  s_xor_b32 s75, s75, 16384
  v_add_u32_dpp v27, v9, v15 row_newbcast:3 row_mask:0xf bank_mask:0x3
  v_add_u32_dpp v24, v9, v14 row_newbcast:8 row_mask:0xf bank_mask:0xc
  v_mfma_f32_16x16x32_bf16 v[220:223], v[152:155], v[88:91], v[220:223]
  v_add_u32_dpp v25, v9, v15 row_newbcast:9 row_mask:0xf bank_mask:0xc
  v_add_u32_dpp v26, v9, v14 row_newbcast:10 row_mask:0xf bank_mask:0xc
  v_mfma_f32_16x16x32_bf16 v[220:223], v[156:159], v[92:95], v[220:223]
  v_add_u32_dpp v27, v9, v15 row_newbcast:11 row_mask:0xf bank_mask:0xc
  s_cmp_lt_u32 s73, 27
  s_cbranch_scc1 L_rem_loop
  s_waitcnt vmcnt(0)
  s_barrier
  s_waitcnt lgkmcnt(8)
  v_mfma_f32_16x16x32_bf16 v[160:163], v[96:99], v[64:67], v[160:163]
  ds_read_b128 v[92:95], v12 offset:6144
  ds_read_b128 v[88:91], v11 offset:6144
  v_mfma_f32_16x16x32_bf16 v[160:163], v[100:103], v[68:71], v[160:163]
  ds_read_b128 v[84:87], v12 offset:4096
  buffer_load_dwordx2 v[224:225], v248, s[48:51], 0 offen offset:3200
  v_mfma_f32_16x16x32_bf16 v[164:167], v[96:99], v[72:75], v[164:167]
  ds_read_b128 v[80:83], v11 offset:4096
  buffer_load_dwordx2 v[226:227], v248, s[48:51], 0 offen offset:3232
  v_mfma_f32_16x16x32_bf16 v[164:167], v[100:103], v[76:79], v[164:167]
  ds_read_b64_tr_b16 v[128:129], v1 offset:8192
  v_mfma_f32_16x16x32_bf16 v[176:179], v[104:107], v[64:67], v[176:179]
  ds_read_b64_tr_b16 v[130:131], v1 offset:8704
  buffer_load_dwordx2 v[228:229], v248, s[48:51], 0 offen offset:3264
  v_mfma_f32_16x16x32_bf16 v[176:179], v[108:111], v[68:71], v[176:179]
  ds_read_b64_tr_b16 v[132:133], v1 offset:12288
  v_mfma_f32_16x16x32_bf16 v[180:183], v[104:107], v[72:75], v[180:183]
  ds_read_b64_tr_b16 v[134:135], v1 offset:12800
  buffer_load_dwordx2 v[230:231], v248, s[48:51], 0 offen offset:3296
  v_mfma_f32_16x16x32_bf16 v[180:183], v[108:111], v[76:79], v[180:183]
  ds_read_b64_tr_b16 v[136:137], v2 offset:8192
  s_waitcnt lgkmcnt(14)
  v_mfma_f32_16x16x32_bf16 v[192:195], v[112:115], v[64:67], v[192:195]
  ds_read_b64_tr_b16 v[138:139], v2 offset:8704
  buffer_load_dwordx2 v[232:233], v248, s[52:55], 0 offen offset:3200
  s_waitcnt lgkmcnt(14)
  v_mfma_f32_16x16x32_bf16 v[192:195], v[116:119], v[68:71], v[192:195]
  ds_read_b64_tr_b16 v[140:141], v2 offset:12288
  v_mfma_f32_16x16x32_bf16 v[196:199], v[112:115], v[72:75], v[196:199]
  ds_read_b64_tr_b16 v[142:143], v2 offset:12800
  buffer_load_dwordx2 v[234:235], v248, s[52:55], 0 offen offset:3232
  v_mfma_f32_16x16x32_bf16 v[196:199], v[116:119], v[76:79], v[196:199]
  s_waitcnt lgkmcnt(14)
  v_mfma_f32_16x16x32_bf16 v[208:211], v[120:123], v[64:67], v[208:211]
  buffer_load_dwordx2 v[236:237], v248, s[52:55], 0 offen offset:3264
  s_waitcnt lgkmcnt(12)
  v_mfma_f32_16x16x32_bf16 v[208:211], v[124:127], v[68:71], v[208:211]
  v_mfma_f32_16x16x32_bf16 v[212:215], v[120:123], v[72:75], v[212:215]
  buffer_load_dwordx2 v[238:239], v248, s[52:55], 0 offen offset:3296
  v_mfma_f32_16x16x32_bf16 v[212:215], v[124:127], v[76:79], v[212:215]
  s_waitcnt lgkmcnt(8)
  v_mfma_f32_16x16x32_bf16 v[168:171], v[96:99], v[80:83], v[168:171]
  ds_read_b128 v[76:79], v12 offset:10240
  ds_read_b128 v[72:75], v11 offset:10240
  v_mfma_f32_16x16x32_bf16 v[168:171], v[100:103], v[84:87], v[168:171]
  ds_read_b128 v[68:71], v12 offset:8192
  v_mfma_f32_16x16x32_bf16 v[172:175], v[96:99], v[88:91], v[172:175]
  ds_read_b128 v[64:67], v11 offset:8192
  v_mfma_f32_16x16x32_bf16 v[172:175], v[100:103], v[92:95], v[172:175]
  ds_read_b64_tr_b16 v[144:145], v7 offset:8192
  v_mfma_f32_16x16x32_bf16 v[184:187], v[104:107], v[80:83], v[184:187]
  ds_read_b64_tr_b16 v[146:147], v7 offset:8704
  v_mfma_f32_16x16x32_bf16 v[184:187], v[108:111], v[84:87], v[184:187]
  ds_read_b64_tr_b16 v[148:149], v7 offset:12288
  v_mfma_f32_16x16x32_bf16 v[188:191], v[104:107], v[88:91], v[188:191]
  ds_read_b64_tr_b16 v[150:151], v7 offset:12800
  v_mfma_f32_16x16x32_bf16 v[188:191], v[108:111], v[92:95], v[188:191]
  ds_read_b64_tr_b16 v[152:153], v8 offset:8192
  v_mfma_f32_16x16x32_bf16 v[200:203], v[112:115], v[80:83], v[200:203]
  ds_read_b64_tr_b16 v[154:155], v8 offset:8704
  v_mfma_f32_16x16x32_bf16 v[200:203], v[116:119], v[84:87], v[200:203]
  ds_read_b64_tr_b16 v[156:157], v8 offset:12288
  v_mfma_f32_16x16x32_bf16 v[204:207], v[112:115], v[88:91], v[204:207]
  ds_read_b64_tr_b16 v[158:159], v8 offset:12800
  v_mfma_f32_16x16x32_bf16 v[204:207], v[116:119], v[92:95], v[204:207]
  v_mfma_f32_16x16x32_bf16 v[216:219], v[120:123], v[80:83], v[216:219]
  v_mfma_f32_16x16x32_bf16 v[216:219], v[124:127], v[84:87], v[216:219]
  v_mfma_f32_16x16x32_bf16 v[220:223], v[120:123], v[88:91], v[220:223]
  v_mfma_f32_16x16x32_bf16 v[220:223], v[124:127], v[92:95], v[220:223]
  s_waitcnt lgkmcnt(8)
  v_mfma_f32_16x16x32_bf16 v[160:163], v[128:131], v[64:67], v[160:163]
  ds_read_b128 v[92:95], v12 offset:14336
  v_mfma_f32_16x16x32_bf16 v[160:163], v[132:135], v[68:71], v[160:163]
  v_mfma_f32_16x16x32_bf16 v[164:167], v[128:131], v[72:75], v[164:167]
  ds_read_b128 v[88:91], v11 offset:14336
  v_mfma_f32_16x16x32_bf16 v[164:167], v[132:135], v[76:79], v[164:167]
  v_mfma_f32_16x16x32_bf16 v[176:179], v[136:139], v[64:67], v[176:179]
  v_mfma_f32_16x16x32_bf16 v[176:179], v[140:143], v[68:71], v[176:179]
  ds_read_b128 v[84:87], v12 offset:12288
  v_mfma_f32_16x16x32_bf16 v[180:183], v[136:139], v[72:75], v[180:183]
  v_mfma_f32_16x16x32_bf16 v[180:183], v[140:143], v[76:79], v[180:183]
  s_waitcnt lgkmcnt(9)
  v_mfma_f32_16x16x32_bf16 v[192:195], v[144:147], v[64:67], v[192:195]
  ds_read_b128 v[80:83], v11 offset:12288
  s_waitcnt lgkmcnt(8)
  v_mfma_f32_16x16x32_bf16 v[192:195], v[148:151], v[68:71], v[192:195]
  v_mfma_f32_16x16x32_bf16 v[196:199], v[144:147], v[72:75], v[196:199]
  v_mfma_f32_16x16x32_bf16 v[196:199], v[148:151], v[76:79], v[196:199]
  s_waitcnt lgkmcnt(6)
  v_mfma_f32_16x16x32_bf16 v[208:211], v[152:155], v[64:67], v[208:211]
  s_waitcnt lgkmcnt(4)
  v_mfma_f32_16x16x32_bf16 v[208:211], v[156:159], v[68:71], v[208:211]
  v_mfma_f32_16x16x32_bf16 v[212:215], v[152:155], v[72:75], v[212:215]
  v_mfma_f32_16x16x32_bf16 v[212:215], v[156:159], v[76:79], v[212:215]
  s_waitcnt lgkmcnt(0)
  v_mfma_f32_16x16x32_bf16 v[168:171], v[128:131], v[80:83], v[168:171]
  s_waitcnt vmcnt(7)
  v_lshlrev_b32 v112, 16, v224
  v_and_b32 v113, 0xffff0000, v224
  v_mfma_f32_16x16x32_bf16 v[168:171], v[132:135], v[84:87], v[168:171]
  s_waitcnt vmcnt(3)
  v_lshlrev_b32 v96, 16, v232
  v_and_b32 v97, 0xffff0000, v232
  v_mfma_f32_16x16x32_bf16 v[172:175], v[128:131], v[88:91], v[172:175]
  v_lshlrev_b32 v114, 16, v225
  v_and_b32 v115, 0xffff0000, v225
  v_mfma_f32_16x16x32_bf16 v[172:175], v[132:135], v[92:95], v[172:175]
  v_lshlrev_b32 v98, 16, v233
  v_and_b32 v99, 0xffff0000, v233
  v_mfma_f32_16x16x32_bf16 v[184:187], v[136:139], v[80:83], v[184:187]
  v_lshlrev_b32 v116, 16, v226
  v_and_b32 v117, 0xffff0000, v226
  v_mfma_f32_16x16x32_bf16 v[184:187], v[140:143], v[84:87], v[184:187]
  s_waitcnt vmcnt(2)
  v_lshlrev_b32 v100, 16, v234
  v_and_b32 v101, 0xffff0000, v234
  v_mfma_f32_16x16x32_bf16 v[188:191], v[136:139], v[88:91], v[188:191]
  v_lshlrev_b32 v118, 16, v227
  v_and_b32 v119, 0xffff0000, v227
  v_mfma_f32_16x16x32_bf16 v[188:191], v[140:143], v[92:95], v[188:191]
  v_lshlrev_b32 v102, 16, v235
  v_and_b32 v103, 0xffff0000, v235
  v_mfma_f32_16x16x32_bf16 v[200:203], v[144:147], v[80:83], v[200:203]
  v_lshlrev_b32 v120, 16, v228
  v_and_b32 v121, 0xffff0000, v228
  v_mfma_f32_16x16x32_bf16 v[200:203], v[148:151], v[84:87], v[200:203]
  s_waitcnt vmcnt(1)
  v_lshlrev_b32 v104, 16, v236
  v_and_b32 v105, 0xffff0000, v236
  v_mfma_f32_16x16x32_bf16 v[204:207], v[144:147], v[88:91], v[204:207]
  v_lshlrev_b32 v122, 16, v229
  v_and_b32 v123, 0xffff0000, v229
  v_mfma_f32_16x16x32_bf16 v[204:207], v[148:151], v[92:95], v[204:207]
  v_lshlrev_b32 v106, 16, v237
  v_and_b32 v107, 0xffff0000, v237
  v_mfma_f32_16x16x32_bf16 v[216:219], v[152:155], v[80:83], v[216:219]
  v_lshlrev_b32 v124, 16, v230
  v_and_b32 v125, 0xffff0000, v230
  v_mfma_f32_16x16x32_bf16 v[216:219], v[156:159], v[84:87], v[216:219]
  s_waitcnt vmcnt(0)
  v_lshlrev_b32 v108, 16, v238
  v_and_b32 v109, 0xffff0000, v238
  v_mfma_f32_16x16x32_bf16 v[220:223], v[152:155], v[88:91], v[220:223]
  v_lshlrev_b32 v126, 16, v231
  v_and_b32 v127, 0xffff0000, v231
  v_mfma_f32_16x16x32_bf16 v[220:223], v[156:159], v[92:95], v[220:223]
  v_lshlrev_b32 v110, 16, v239
  v_and_b32 v111, 0xffff0000, v239
  s_mov_b32 s60, s24
  s_and_b32 s61, s25, 0xffff
  s_mov_b32 s62, 268435456
  s_mov_b32 s63, 0x20000
  s_mov_b32 s64, s22
  s_and_b32 s65, s23, 0xffff
  s_mov_b32 s66, 256
  s_mov_b32 s67, 0x20000
  v_mov_b32 v4, 0
  s_mov_b64 exec, 1
  s_mov_b32 s81, 0x80000
  buffer_load_dword v255, v4, s[60:63], s81 offen
  buffer_load_dword v5, v4, s[64:67], 0 offen offset:128 sc1
  s_mov_b64 exec, -1
  s_mov_b32 s56, s20
  s_and_b32 s57, s21, 0xffff
  s_mov_b32 s58, 8192
  s_mov_b32 s59, 0x20000
  s_load_dword s80, s[18:19], 0
  buffer_load_dword v255, v4, s[56:59], 0 offen
  s_and_b32 s70, s2, 7
  s_lshl_b32 s68, s70, 14
  s_lshl_b32 s69, s3, 8
  s_add_u32 s68, s68, s69
  s_add_u32 s69, s68, 4096
  s_add_u32 s71, s68, 8192
  s_lshl_b32 s70, s70, 3
  s_add_u32 s70, s70, s3
  s_lshl_b32 s70, s70, 7
  v_lshlrev_b32 v3, 2, v0
  v_lshlrev_b32 v2, 1, v0
  s_waitcnt lgkmcnt(0)
  s_lshl_b32 s80, s80, 16
  v_rcp_f32 v96, v96
  v_rcp_f32 v97, v97
  v_rcp_f32 v98, v98
  v_rcp_f32 v99, v99
  v_rcp_f32 v100, v100
  v_rcp_f32 v101, v101
  v_rcp_f32 v102, v102
  v_rcp_f32 v103, v103
  v_rcp_f32 v104, v104
  v_rcp_f32 v105, v105
  v_rcp_f32 v106, v106
  v_rcp_f32 v107, v107
  v_rcp_f32 v108, v108
  v_rcp_f32 v109, v109
  v_rcp_f32 v110, v110
  v_rcp_f32 v111, v111
  v_med3_f32 v96, v96, -v244, v244
  v_med3_f32 v97, v97, -v244, v244
  v_med3_f32 v98, v98, -v244, v244
  v_med3_f32 v99, v99, -v244, v244
  v_med3_f32 v100, v100, -v244, v244
  v_med3_f32 v101, v101, -v244, v244
  v_med3_f32 v102, v102, -v244, v244
  v_med3_f32 v103, v103, -v244, v244
  v_med3_f32 v104, v104, -v244, v244
  v_med3_f32 v105, v105, -v244, v244
  v_med3_f32 v106, v106, -v244, v244
  v_med3_f32 v107, v107, -v244, v244
  v_med3_f32 v108, v108, -v244, v244
  v_med3_f32 v109, v109, -v244, v244
  v_med3_f32 v110, v110, -v244, v244
  v_med3_f32 v111, v111, -v244, v244
  v_pk_add_f32 v[160:161], v[160:161], v[112:113]
  v_pk_add_f32 v[162:163], v[162:163], v[114:115]
  v_pk_add_f32 v[164:165], v[164:165], v[112:113]
  v_pk_add_f32 v[166:167], v[166:167], v[114:115]
  v_pk_add_f32 v[168:169], v[168:169], v[112:113]
  v_pk_add_f32 v[170:171], v[170:171], v[114:115]
  v_pk_add_f32 v[172:173], v[172:173], v[112:113]
  v_pk_add_f32 v[174:175], v[174:175], v[114:115]
  v_pk_add_f32 v[176:177], v[176:177], v[116:117]
  v_pk_add_f32 v[178:179], v[178:179], v[118:119]
  v_pk_add_f32 v[180:181], v[180:181], v[116:117]
  v_pk_add_f32 v[182:183], v[182:183], v[118:119]
  v_pk_add_f32 v[184:185], v[184:185], v[116:117]
  v_pk_add_f32 v[186:187], v[186:187], v[118:119]
  v_pk_add_f32 v[188:189], v[188:189], v[116:117]
  v_pk_add_f32 v[190:191], v[190:191], v[118:119]
  v_pk_add_f32 v[192:193], v[192:193], v[120:121]
  v_pk_add_f32 v[194:195], v[194:195], v[122:123]
  v_pk_add_f32 v[196:197], v[196:197], v[120:121]
  v_pk_add_f32 v[198:199], v[198:199], v[122:123]
  v_pk_add_f32 v[200:201], v[200:201], v[120:121]
  v_pk_add_f32 v[202:203], v[202:203], v[122:123]
  v_pk_add_f32 v[204:205], v[204:205], v[120:121]
  v_pk_add_f32 v[206:207], v[206:207], v[122:123]
  v_pk_add_f32 v[208:209], v[208:209], v[124:125]
  v_pk_add_f32 v[210:211], v[210:211], v[126:127]
  v_pk_add_f32 v[212:213], v[212:213], v[124:125]
  v_pk_add_f32 v[214:215], v[214:215], v[126:127]
  v_pk_add_f32 v[216:217], v[216:217], v[124:125]
  v_pk_add_f32 v[218:219], v[218:219], v[126:127]
  v_pk_add_f32 v[220:221], v[220:221], v[124:125]
  v_pk_add_f32 v[222:223], v[222:223], v[126:127]
  v_pk_mul_f32 v[64:65], v[160:161], v[160:161]
  v_pk_mul_f32 v[68:69], v[164:165], v[164:165]
  v_pk_mul_f32 v[72:73], v[168:169], v[168:169]
  v_pk_mul_f32 v[76:77], v[172:173], v[172:173]
  v_pk_fma_f32 v[64:65], v[64:65], v[242:243], v[240:241]
  v_pk_fma_f32 v[68:69], v[68:69], v[242:243], v[240:241]
  v_pk_fma_f32 v[72:73], v[72:73], v[242:243], v[240:241]
  v_pk_fma_f32 v[76:77], v[76:77], v[242:243], v[240:241]
  v_pk_mul_f32 v[64:65], v[64:65], v[160:161]
  v_pk_mul_f32 v[68:69], v[68:69], v[164:165]
  v_pk_mul_f32 v[72:73], v[72:73], v[168:169]
  v_pk_mul_f32 v[76:77], v[76:77], v[172:173]
  v_exp_f32 v64, v64
  v_exp_f32 v65, v65
  v_exp_f32 v68, v68
  v_exp_f32 v69, v69
  v_exp_f32 v72, v72
  v_exp_f32 v73, v73
  v_exp_f32 v76, v76
  v_exp_f32 v77, v77
  v_pk_fma_f32 v[64:65], v[64:65], v[96:97], v[96:97]
  v_pk_fma_f32 v[68:69], v[68:69], v[96:97], v[96:97]
  v_pk_fma_f32 v[72:73], v[72:73], v[96:97], v[96:97]
  v_pk_fma_f32 v[76:77], v[76:77], v[96:97], v[96:97]
  v_rcp_f32 v64, v64
  v_rcp_f32 v65, v65
  v_rcp_f32 v68, v68
  v_rcp_f32 v69, v69
  v_rcp_f32 v72, v72
  v_rcp_f32 v73, v73
  v_rcp_f32 v76, v76
  v_rcp_f32 v77, v77
  v_pk_mul_f32 v[16:17], v[64:65], v[160:161]
  v_pk_mul_f32 v[18:19], v[68:69], v[164:165]
  v_pk_mul_f32 v[20:21], v[72:73], v[168:169]
  v_pk_mul_f32 v[22:23], v[76:77], v[172:173]
  v_pk_mul_f32 v[80:81], v[162:163], v[162:163]
  v_pk_mul_f32 v[84:85], v[166:167], v[166:167]
  v_pk_mul_f32 v[88:89], v[170:171], v[170:171]
  v_pk_mul_f32 v[92:93], v[174:175], v[174:175]
  v_pk_fma_f32 v[80:81], v[80:81], v[242:243], v[240:241]
  v_pk_fma_f32 v[84:85], v[84:85], v[242:243], v[240:241]
  v_pk_fma_f32 v[88:89], v[88:89], v[242:243], v[240:241]
  v_pk_fma_f32 v[92:93], v[92:93], v[242:243], v[240:241]
  v_pk_mul_f32 v[80:81], v[80:81], v[162:163]
  v_pk_mul_f32 v[84:85], v[84:85], v[166:167]
  v_pk_mul_f32 v[88:89], v[88:89], v[170:171]
  v_pk_mul_f32 v[92:93], v[92:93], v[174:175]
  v_exp_f32 v80, v80
  v_exp_f32 v81, v81
  v_exp_f32 v84, v84
  v_exp_f32 v85, v85
  v_exp_f32 v88, v88
  v_exp_f32 v89, v89
  v_exp_f32 v92, v92
  v_exp_f32 v93, v93
  v_pk_fma_f32 v[80:81], v[80:81], v[98:99], v[98:99]
  v_pk_fma_f32 v[84:85], v[84:85], v[98:99], v[98:99]
  v_pk_fma_f32 v[88:89], v[88:89], v[98:99], v[98:99]
  v_pk_fma_f32 v[92:93], v[92:93], v[98:99], v[98:99]
  v_rcp_f32 v80, v80
  v_rcp_f32 v81, v81
  v_rcp_f32 v84, v84
  v_rcp_f32 v85, v85
  v_rcp_f32 v88, v88
  v_rcp_f32 v89, v89
  v_rcp_f32 v92, v92
  v_rcp_f32 v93, v93
  v_pk_fma_f32 v[16:17], v[80:81], v[162:163], v[16:17]
  v_pk_fma_f32 v[18:19], v[84:85], v[166:167], v[18:19]
  v_pk_fma_f32 v[20:21], v[88:89], v[170:171], v[20:21]
  v_pk_fma_f32 v[22:23], v[92:93], v[174:175], v[22:23]
  v_pk_mul_f32 v[64:65], v[176:177], v[176:177]
  v_pk_mul_f32 v[68:69], v[180:181], v[180:181]
  v_pk_mul_f32 v[72:73], v[184:185], v[184:185]
  v_pk_mul_f32 v[76:77], v[188:189], v[188:189]
  v_pk_fma_f32 v[64:65], v[64:65], v[242:243], v[240:241]
  v_pk_fma_f32 v[68:69], v[68:69], v[242:243], v[240:241]
  v_pk_fma_f32 v[72:73], v[72:73], v[242:243], v[240:241]
  v_pk_fma_f32 v[76:77], v[76:77], v[242:243], v[240:241]
  v_pk_mul_f32 v[64:65], v[64:65], v[176:177]
  v_pk_mul_f32 v[68:69], v[68:69], v[180:181]
  v_pk_mul_f32 v[72:73], v[72:73], v[184:185]
  v_pk_mul_f32 v[76:77], v[76:77], v[188:189]
  v_exp_f32 v64, v64
  v_exp_f32 v65, v65
  v_exp_f32 v68, v68
  v_exp_f32 v69, v69
  v_exp_f32 v72, v72
  v_exp_f32 v73, v73
  v_exp_f32 v76, v76
  v_exp_f32 v77, v77
  v_pk_fma_f32 v[64:65], v[64:65], v[100:101], v[100:101]
  v_pk_fma_f32 v[68:69], v[68:69], v[100:101], v[100:101]
  v_pk_fma_f32 v[72:73], v[72:73], v[100:101], v[100:101]
  v_pk_fma_f32 v[76:77], v[76:77], v[100:101], v[100:101]
  v_rcp_f32 v64, v64
  v_rcp_f32 v65, v65
  v_rcp_f32 v68, v68
  v_rcp_f32 v69, v69
  v_rcp_f32 v72, v72
  v_rcp_f32 v73, v73
  v_rcp_f32 v76, v76
  v_rcp_f32 v77, v77
  v_pk_fma_f32 v[16:17], v[64:65], v[176:177], v[16:17]
  v_pk_fma_f32 v[18:19], v[68:69], v[180:181], v[18:19]
  v_pk_fma_f32 v[20:21], v[72:73], v[184:185], v[20:21]
  v_pk_fma_f32 v[22:23], v[76:77], v[188:189], v[22:23]
  v_pk_mul_f32 v[80:81], v[178:179], v[178:179]
  v_pk_mul_f32 v[84:85], v[182:183], v[182:183]
  v_pk_mul_f32 v[88:89], v[186:187], v[186:187]
  v_pk_mul_f32 v[92:93], v[190:191], v[190:191]
  v_pk_fma_f32 v[80:81], v[80:81], v[242:243], v[240:241]
  v_pk_fma_f32 v[84:85], v[84:85], v[242:243], v[240:241]
  v_pk_fma_f32 v[88:89], v[88:89], v[242:243], v[240:241]
  v_pk_fma_f32 v[92:93], v[92:93], v[242:243], v[240:241]
  v_pk_mul_f32 v[80:81], v[80:81], v[178:179]
  v_pk_mul_f32 v[84:85], v[84:85], v[182:183]
  v_pk_mul_f32 v[88:89], v[88:89], v[186:187]
  v_pk_mul_f32 v[92:93], v[92:93], v[190:191]
  v_exp_f32 v80, v80
  v_exp_f32 v81, v81
  v_exp_f32 v84, v84
  v_exp_f32 v85, v85
  v_exp_f32 v88, v88
  v_exp_f32 v89, v89
  v_exp_f32 v92, v92
  v_exp_f32 v93, v93
  v_pk_fma_f32 v[80:81], v[80:81], v[102:103], v[102:103]
  v_pk_fma_f32 v[84:85], v[84:85], v[102:103], v[102:103]
  v_pk_fma_f32 v[88:89], v[88:89], v[102:103], v[102:103]
  v_pk_fma_f32 v[92:93], v[92:93], v[102:103], v[102:103]
  v_rcp_f32 v80, v80
  v_rcp_f32 v81, v81
  v_rcp_f32 v84, v84
  v_rcp_f32 v85, v85
  v_rcp_f32 v88, v88
  v_rcp_f32 v89, v89
  v_rcp_f32 v92, v92
  v_rcp_f32 v93, v93
  v_pk_fma_f32 v[16:17], v[80:81], v[178:179], v[16:17]
  v_pk_fma_f32 v[18:19], v[84:85], v[182:183], v[18:19]
  v_pk_fma_f32 v[20:21], v[88:89], v[186:187], v[20:21]
  v_pk_fma_f32 v[22:23], v[92:93], v[190:191], v[22:23]
  v_pk_mul_f32 v[64:65], v[192:193], v[192:193]
  v_pk_mul_f32 v[68:69], v[196:197], v[196:197]
  v_pk_mul_f32 v[72:73], v[200:201], v[200:201]
  v_pk_mul_f32 v[76:77], v[204:205], v[204:205]
  v_pk_fma_f32 v[64:65], v[64:65], v[242:243], v[240:241]
  v_pk_fma_f32 v[68:69], v[68:69], v[242:243], v[240:241]
  v_pk_fma_f32 v[72:73], v[72:73], v[242:243], v[240:241]
  v_pk_fma_f32 v[76:77], v[76:77], v[242:243], v[240:241]
  v_pk_mul_f32 v[64:65], v[64:65], v[192:193]
  v_pk_mul_f32 v[68:69], v[68:69], v[196:197]
  v_pk_mul_f32 v[72:73], v[72:73], v[200:201]
  v_pk_mul_f32 v[76:77], v[76:77], v[204:205]
  v_exp_f32 v64, v64
  v_exp_f32 v65, v65
  v_exp_f32 v68, v68
  v_exp_f32 v69, v69
  v_exp_f32 v72, v72
  v_exp_f32 v73, v73
  v_exp_f32 v76, v76
  v_exp_f32 v77, v77
  v_pk_fma_f32 v[64:65], v[64:65], v[104:105], v[104:105]
  v_pk_fma_f32 v[68:69], v[68:69], v[104:105], v[104:105]
  v_pk_fma_f32 v[72:73], v[72:73], v[104:105], v[104:105]
  v_pk_fma_f32 v[76:77], v[76:77], v[104:105], v[104:105]
  v_rcp_f32 v64, v64
  v_rcp_f32 v65, v65
  v_rcp_f32 v68, v68
  v_rcp_f32 v69, v69
  v_rcp_f32 v72, v72
  v_rcp_f32 v73, v73
  v_rcp_f32 v76, v76
  v_rcp_f32 v77, v77
  v_pk_fma_f32 v[16:17], v[64:65], v[192:193], v[16:17]
  v_pk_fma_f32 v[18:19], v[68:69], v[196:197], v[18:19]
  v_pk_fma_f32 v[20:21], v[72:73], v[200:201], v[20:21]
  v_pk_fma_f32 v[22:23], v[76:77], v[204:205], v[22:23]
  v_pk_mul_f32 v[80:81], v[194:195], v[194:195]
  v_pk_mul_f32 v[84:85], v[198:199], v[198:199]
  v_pk_mul_f32 v[88:89], v[202:203], v[202:203]
  v_pk_mul_f32 v[92:93], v[206:207], v[206:207]
  v_pk_fma_f32 v[80:81], v[80:81], v[242:243], v[240:241]
  v_pk_fma_f32 v[84:85], v[84:85], v[242:243], v[240:241]
  v_pk_fma_f32 v[88:89], v[88:89], v[242:243], v[240:241]
  v_pk_fma_f32 v[92:93], v[92:93], v[242:243], v[240:241]
  v_pk_mul_f32 v[80:81], v[80:81], v[194:195]
  v_pk_mul_f32 v[84:85], v[84:85], v[198:199]
  v_pk_mul_f32 v[88:89], v[88:89], v[202:203]
  v_pk_mul_f32 v[92:93], v[92:93], v[206:207]
  v_exp_f32 v80, v80
  v_exp_f32 v81, v81
  v_exp_f32 v84, v84
  v_exp_f32 v85, v85
  v_exp_f32 v88, v88
  v_exp_f32 v89, v89
  v_exp_f32 v92, v92
  v_exp_f32 v93, v93
  v_pk_fma_f32 v[80:81], v[80:81], v[106:107], v[106:107]
  v_pk_fma_f32 v[84:85], v[84:85], v[106:107], v[106:107]
  v_pk_fma_f32 v[88:89], v[88:89], v[106:107], v[106:107]
  v_pk_fma_f32 v[92:93], v[92:93], v[106:107], v[106:107]
  v_rcp_f32 v80, v80
  v_rcp_f32 v81, v81
  v_rcp_f32 v84, v84
  v_rcp_f32 v85, v85
  v_rcp_f32 v88, v88
  v_rcp_f32 v89, v89
  v_rcp_f32 v92, v92
  v_rcp_f32 v93, v93
  v_pk_fma_f32 v[16:17], v[80:81], v[194:195], v[16:17]
  v_pk_fma_f32 v[18:19], v[84:85], v[198:199], v[18:19]
  v_pk_fma_f32 v[20:21], v[88:89], v[202:203], v[20:21]
  v_pk_fma_f32 v[22:23], v[92:93], v[206:207], v[22:23]
  v_pk_mul_f32 v[64:65], v[208:209], v[208:209]
  v_pk_mul_f32 v[68:69], v[212:213], v[212:213]
  v_pk_mul_f32 v[72:73], v[216:217], v[216:217]
  v_pk_mul_f32 v[76:77], v[220:221], v[220:221]
  v_pk_fma_f32 v[64:65], v[64:65], v[242:243], v[240:241]
  v_pk_fma_f32 v[68:69], v[68:69], v[242:243], v[240:241]
  v_pk_fma_f32 v[72:73], v[72:73], v[242:243], v[240:241]
  v_pk_fma_f32 v[76:77], v[76:77], v[242:243], v[240:241]
  v_pk_mul_f32 v[64:65], v[64:65], v[208:209]
  v_pk_mul_f32 v[68:69], v[68:69], v[212:213]
  v_pk_mul_f32 v[72:73], v[72:73], v[216:217]
  v_pk_mul_f32 v[76:77], v[76:77], v[220:221]
  v_exp_f32 v64, v64
  v_exp_f32 v65, v65
  v_exp_f32 v68, v68
  v_exp_f32 v69, v69
  v_exp_f32 v72, v72
  v_exp_f32 v73, v73
  v_exp_f32 v76, v76
  v_exp_f32 v77, v77
  v_pk_fma_f32 v[64:65], v[64:65], v[108:109], v[108:109]
  v_pk_fma_f32 v[68:69], v[68:69], v[108:109], v[108:109]
  v_pk_fma_f32 v[72:73], v[72:73], v[108:109], v[108:109]
  v_pk_fma_f32 v[76:77], v[76:77], v[108:109], v[108:109]
  v_rcp_f32 v64, v64
  v_rcp_f32 v65, v65
  v_rcp_f32 v68, v68
  v_rcp_f32 v69, v69
  v_rcp_f32 v72, v72
  v_rcp_f32 v73, v73
  v_rcp_f32 v76, v76
  v_rcp_f32 v77, v77
  v_pk_fma_f32 v[16:17], v[64:65], v[208:209], v[16:17]
  v_pk_fma_f32 v[18:19], v[68:69], v[212:213], v[18:19]
  v_pk_fma_f32 v[20:21], v[72:73], v[216:217], v[20:21]
  v_pk_fma_f32 v[22:23], v[76:77], v[220:221], v[22:23]
  v_pk_mul_f32 v[80:81], v[210:211], v[210:211]
  v_pk_mul_f32 v[84:85], v[214:215], v[214:215]
  v_pk_mul_f32 v[88:89], v[218:219], v[218:219]
  v_pk_mul_f32 v[92:93], v[222:223], v[222:223]
  v_pk_fma_f32 v[80:81], v[80:81], v[242:243], v[240:241]
  v_pk_fma_f32 v[84:85], v[84:85], v[242:243], v[240:241]
  v_pk_fma_f32 v[88:89], v[88:89], v[242:243], v[240:241]
  v_pk_fma_f32 v[92:93], v[92:93], v[242:243], v[240:241]
  v_pk_mul_f32 v[80:81], v[80:81], v[210:211]
  v_pk_mul_f32 v[84:85], v[84:85], v[214:215]
  v_pk_mul_f32 v[88:89], v[88:89], v[218:219]
  v_pk_mul_f32 v[92:93], v[92:93], v[222:223]
  v_exp_f32 v80, v80
  v_exp_f32 v81, v81
  v_exp_f32 v84, v84
  v_exp_f32 v85, v85
  v_exp_f32 v88, v88
  v_exp_f32 v89, v89
  v_exp_f32 v92, v92
  v_exp_f32 v93, v93
  v_pk_fma_f32 v[80:81], v[80:81], v[110:111], v[110:111]
  v_pk_fma_f32 v[84:85], v[84:85], v[110:111], v[110:111]
  v_pk_fma_f32 v[88:89], v[88:89], v[110:111], v[110:111]
  v_pk_fma_f32 v[92:93], v[92:93], v[110:111], v[110:111]
  v_rcp_f32 v80, v80
  v_rcp_f32 v81, v81
  v_rcp_f32 v84, v84
  v_rcp_f32 v85, v85
  v_rcp_f32 v88, v88
  v_rcp_f32 v89, v89
  v_rcp_f32 v92, v92
  v_rcp_f32 v93, v93
  v_pk_fma_f32 v[16:17], v[80:81], v[210:211], v[16:17]
  v_pk_fma_f32 v[18:19], v[84:85], v[214:215], v[18:19]
  v_pk_fma_f32 v[20:21], v[88:89], v[218:219], v[20:21]
  v_pk_fma_f32 v[22:23], v[92:93], v[222:223], v[22:23]
  v_add_f32 v16, v16, v17
  v_add_f32 v18, v18, v19
  v_add_f32 v20, v20, v21
  v_add_f32 v22, v22, v23
  s_nop 0
  v_permlane32_swap_b32 v16, v20
  v_permlane32_swap_b32 v18, v22
  v_add_f32 v16, v16, v20
  v_add_f32 v18, v18, v22
  s_nop 1
  v_permlane16_swap_b32 v16, v18
  v_add_f32 v16, v16, v18
  v_add_f32 v16, s80, v16
  s_waitcnt vmcnt(1)
  v_readfirstlane_b32 s81, v5
  s_nop 0
  s_cmp_ge_u32 s81, 56
  s_cbranch_scc1 L_rclr_ok
  v_mov_b32 v4, 0
  s_mov_b32 s78, 0x40000
L_rclr:
  s_sub_u32 s78, s78, 1
  s_cbranch_scc1 L_end
  buffer_load_dword v5, v4, s[64:67], 0 offen offset:128 sc1
  s_waitcnt vmcnt(0)
  v_readfirstlane_b32 s81, v5
  s_nop 0
  s_cmp_lt_u32 s81, 56
  s_cbranch_scc1 L_rclr
L_rclr_ok:
  s_mov_b32 s72, 0x40000
L_poll:
  s_sub_u32 s72, s72, 1
  s_cbranch_scc1 L_end
  buffer_load_dword v64, v3, s[60:63], s68 offen offset:0 sc1
  buffer_load_dword v65, v3, s[60:63], s68 offen offset:2048 sc1
  buffer_load_dword v66, v3, s[60:63], s69 offen offset:0 sc1
  buffer_load_dword v67, v3, s[60:63], s69 offen offset:2048 sc1
  buffer_load_dword v68, v3, s[60:63], s71 offen offset:0 sc1
  buffer_load_dword v69, v3, s[60:63], s71 offen offset:2048 sc1
  s_waitcnt vmcnt(3)
  v_max3_u32 v72, v64, v65, v66
  s_waitcnt vmcnt(0)
  v_max3_u32 v73, v67, v68, v69
  v_max_u32 v72, v72, v73
  v_cmp_eq_u32 vcc, -1, v72
  s_cbranch_vccnz L_poll
  v_add_f32 v64, v64, v65
  v_add_f32 v66, v66, v67
  v_add_f32 v68, v68, v69
  v_add_f32 v64, v64, v66
  v_add_f32 v68, v68, v16
  v_add_f32 v64, v64, v68
  v_cvt_pk_bf16_f32 v64, v64, v64
  buffer_store_short v64, v2, s[56:59], s70 offen
  s_endpgm
L_end:
  s_endpgm
.section .rodata,"a"
.p2align 6
.amdhsa_kernel standalone__deep_cross_xdeepfm__recsys_kernel
  .amdhsa_next_free_vgpr 256
  .amdhsa_next_free_sgpr 102
  .amdhsa_accum_offset 256
  .amdhsa_group_segment_fixed_size 0
  .amdhsa_kernarg_size 88
  .amdhsa_user_sgpr_count 2
  .amdhsa_user_sgpr_kernarg_segment_ptr 1
  .amdhsa_system_sgpr_workgroup_id_x 1
  .amdhsa_float_denorm_mode_32 3
.end_amdhsa_kernel
```

```asm
; @launch grid=(256,1,1) block=(512,1,1) lds=163840
.amdgcn_target "amdgcn-amd-amdhsa--gfx950"
.text
.globl standalone__deep_cross_xdeepfm__recsys_kernel
.p2align 8
.type standalone__deep_cross_xdeepfm__recsys_kernel,@function
standalone__deep_cross_xdeepfm__recsys_kernel:
  s_cmp_ge_u32 s2, 256
  s_cbranch_scc1 L_end
  s_load_dwordx16 s[4:19], s[0:1], 0
  s_load_dwordx4 s[20:23], s[0:1], 64
  s_load_dwordx2 s[24:25], s[0:1], 80
  v_lshrrev_b32 v1, 6, v0
  s_getpc_b64 s[92:93]
L_pc:
  s_and_b32 s68, s2, 0xf8
  v_add_u32 v2, s68, v1
  v_lshlrev_b32 v2, 7, v2
  v_and_b32 v3, 1, v0
  v_lshl_add_u32 v2, v3, 15, v2
  v_min_u32 v2, L_end-L_pc, v2
  v_mov_b32 v3, s93
  v_add_co_u32 v2, vcc, s92, v2
  s_nop 1
  v_addc_co_u32 v3, vcc, 0, v3, vcc
  global_load_dword v255, v[2:3], off
  v_and_b32 v0, 63, v0
  v_readfirstlane_b32 s3, v1
  s_and_b32 s68, s2, 7
  s_lshl_b32 s68, s68, 2
  s_lshr_b32 s26, s2, 6
  s_add_u32 s26, s26, s68
  s_bfe_u32 s27, s2, 0x30003
  s_and_b32 s80, s2, 0xf8
  s_add_u32 s80, s80, s3
  s_lshl_b32 s80, s80, 21
  s_cmp_ge_u32 s27, 5
  s_cbranch_scc1 L_cin
  s_mul_i32 s77, s27, 640
  s_mul_i32 s70, s3, 7
  v_min_u32 v132, 6, v0
  v_add_u32 v132, s70, v132
  v_min_u32 v132, 51, v132
  v_lshrrev_b32 v130, 1, v132
  v_mul_u32_u24 v130, 96, v130
  v_lshl_add_u32 v132, v132, 2, v130
  s_mul_i32 s78, s27, 26
  s_min_u32 s78, s78, 102
  s_lshl_b32 s71, s26, 7
  s_add_u32 s78, s78, s71
  s_mul_i32 s78, s78, 104
  s_and_b32 s70, s26, 3
  s_lshl_b32 s70, s70, 3
  s_add_u32 s70, s70, s3
  s_mul_i32 s70, s70, 3328
  s_add_u32 s81, s70, s77
  v_min_u32 v124, 15, v0
  v_lshrrev_b32 v130, 3, v124
  s_mov_b32 s70, 106496
  v_mul_u32_u24 v130, s70, v130
  v_and_b32 v124, 7, v124
  v_min_u32 v124, 4, v124
  v_lshl_add_u32 v124, v124, 7, v130
  s_waitcnt lgkmcnt(0)
  s_mov_b32 s28, s4
  s_and_b32 s29, s5, 0xffff
  s_mov_b32 s30, 425984
  s_mov_b32 s31, 0x20000
  buffer_load_dwordx3 v[120:122], v132, s[28:31], s78 offen
  s_mov_b32 s32, s6
  s_and_b32 s33, s7, 0xffff
  s_mov_b32 s34, 12800000
  s_mov_b32 s35, 0x20000
  v_mov_b32 v136, s80
  buffer_load_dword v255, v136, s[32:35], 0 offen
  v_lshlrev_b32 v37, 4, v0
  s_mov_b32 s48, s14
  s_and_b32 s49, s15, 0xffff
  s_mov_b32 s50, 3328
  s_mov_b32 s51, 0x20000
  s_mov_b32 s44, s12
  s_and_b32 s45, s13, 0xffff
  s_mov_b32 s46, 5537792
  s_mov_b32 s47, 0x20000
  buffer_load_dword v255, v124, s[44:47], s81 offen
  s_mov_b32 m0, 155648
  s_mov_b32 exec_hi, 0xff
  buffer_load_dwordx4 v37, s[48:51], s77 offen lds
  s_mov_b64 exec, -1
  s_lshr_b32 s68, s3, 2
  s_and_b32 s69, s3, 3
  s_xor_b32 s70, s3, 4
  s_lshl_b32 s70, s70, 4
  s_add_u32 s70, s70, s71
  v_lshrrev_b32 v128, 3, v0
  v_add_u32 v128, s70, v128
  v_mul_u32_u24 v13, 104, v128
  s_mov_b32 s70, 1639
  s_and_b32 s78, s69, 1
  s_lshl_b32 s78, s78, 2
  s_mov_b32 s81, 3328
  v_mov_b32 v128, v0
  v_mul_u32_u24 v129, s70, v128
  v_lshrrev_b32 v129, 16, v129
  v_mul_u32_u24 v132, 40, v129
  v_sub_u32 v132, v128, v132
  v_and_b32 v131, 2, v129
  v_or_b32 v131, s78, v131
  v_xor_b32 v132, v132, v131
  v_mul_u32_u24 v129, s81, v129
  v_lshl_add_u32 v29, v132, 4, v129
  v_add_u32 v128, 64, v128
  v_mul_u32_u24 v129, s70, v128
  v_lshrrev_b32 v129, 16, v129
  v_mul_u32_u24 v132, 40, v129
  v_sub_u32 v132, v128, v132
  v_and_b32 v131, 2, v129
  v_or_b32 v131, s78, v131
  v_xor_b32 v132, v132, v131
  v_mul_u32_u24 v129, s81, v129
  v_lshl_add_u32 v30, v132, 4, v129
  v_subrev_u32 v30, 1024, v30
  v_add_u32 v128, 64, v128
  v_mul_u32_u24 v129, s70, v128
  v_lshrrev_b32 v129, 16, v129
  v_mul_u32_u24 v132, 40, v129
  v_sub_u32 v132, v128, v132
  v_and_b32 v131, 2, v129
  v_or_b32 v131, s78, v131
  v_xor_b32 v132, v132, v131
  v_mul_u32_u24 v129, s81, v129
  v_lshl_add_u32 v31, v132, 4, v129
  v_subrev_u32 v31, 2048, v31
  v_add_u32 v128, 64, v128
  v_mul_u32_u24 v129, s70, v128
  v_lshrrev_b32 v129, 16, v129
  v_mul_u32_u24 v132, 40, v129
  v_sub_u32 v132, v128, v132
  v_and_b32 v131, 2, v129
  v_or_b32 v131, s78, v131
  v_xor_b32 v132, v132, v131
  v_mul_u32_u24 v129, s81, v129
  v_lshl_add_u32 v32, v132, 4, v129
  v_subrev_u32 v32, 3072, v32
  v_add_u32 v128, 64, v128
  v_mul_u32_u24 v129, s70, v128
  v_lshrrev_b32 v129, 16, v129
  v_mul_u32_u24 v132, 40, v129
  v_sub_u32 v132, v128, v132
  v_and_b32 v131, 2, v129
  v_or_b32 v131, s78, v131
  v_xor_b32 v132, v132, v131
  v_mul_u32_u24 v129, s81, v129
  v_lshl_add_u32 v33, v132, 4, v129
  s_mul_i32 s70, s3, 26624
  s_add_u32 s74, s70, s77
  s_mul_i32 s75, s3, 5120
  s_add_u32 s75, s75, 32768
  s_lshl_b32 s71, s68, 14
  s_lshl_b32 s76, s69, 11
  s_add_u32 s76, s76, s71
  s_xor_b32 s76, s76, 16384
  v_and_b32 v132, 7, v0
  v_lshrrev_b32 v130, 4, v0
  v_xor_b32 v132, v132, v130
  v_lshlrev_b32 v14, 4, v132
  v_xor_b32 v15, 64, v14
  v_and_b32 v132, 15, v0
  v_lshlrev_b32 v132, 7, v132
  v_bfe_u32 v131, v0, 1, 3
  v_xor_b32 v131, v131, v130
  v_lshl_add_u32 v132, v131, 4, v132
  v_add_u32 v11, s71, v132
  v_xor_b32 v12, 64, v11
  s_mov_b32 s52, s16
  s_and_b32 s53, s17, 0xffff
  s_mov_b32 s54, 3328
  s_mov_b32 s55, 0x20000
  s_mul_i32 s71, s69, 5
  v_bfe_u32 v131, v0, 2, 2
  v_lshl_add_u32 v132, v130, 3, v131
  v_mul_u32_u24 v132, 640, v132
  v_and_b32 v131, 3, v0
  v_lshl_add_u32 v132, v131, 3, v132
  v_add_u32 v132, 32768, v132
  v_bfe_u32 v131, v0, 3, 2
  v_xor_b32 v128, s71, v131
  v_lshl_add_u32 v1, v128, 5, v132
  v_add_u32 v6, 61440, v1
  s_add_u32 s71, s71, 1
  v_xor_b32 v128, s71, v131
  v_lshl_add_u32 v2, v128, 5, v132
  v_add_u32 v7, 61440, v2
  s_add_u32 s71, s71, 1
  v_xor_b32 v128, s71, v131
  v_lshl_add_u32 v3, v128, 5, v132
  v_add_u32 v8, 61440, v3
  s_add_u32 s71, s71, 1
  v_xor_b32 v128, s71, v131
  v_lshl_add_u32 v4, v128, 5, v132
  v_add_u32 v9, 61440, v4
  s_add_u32 s71, s71, 1
  v_xor_b32 v128, s71, v131
  v_lshl_add_u32 v5, v128, 5, v132
  v_add_u32 v10, 61440, v5
  s_add_u32 s71, s71, 1
  s_mul_i32 s71, s69, 160
  s_add_u32 s71, s71, 155648
  v_lshlrev_b32 v132, 3, v130
  v_add_u32 v35, s71, v132
  s_lshl_b32 s70, s69, 1
  s_add_u32 s70, s70, s68
  s_lshl_b32 s70, s70, 8
  s_add_u32 s70, s70, 156928
  v_lshlrev_b32 v36, 2, v0
  v_add_u32 v36, s70, v36
  s_waitcnt vmcnt(3)
  v_lshlrev_b32 v120, 7, v120
  buffer_load_dwordx2 v[112:113], v13, s[28:31], 0 offen offset:0
  buffer_load_dwordx2 v[116:117], v13, s[28:31], 0 offen offset:832
  s_barrier
  buffer_load_dword v255, v120, s[32:35], 0 offen
  v_lshlrev_b32 v122, 7, v122
  buffer_load_dword v255, v122, s[32:35], 0 offen
  s_add_u32 m0, s75, 0
  s_nop 0
  buffer_load_dwordx4 v29, s[44:47], s74 offen offset:0 lds
  buffer_load_dwordx4 v30, s[44:47], s74 offen offset:1024 lds
  buffer_load_dwordx4 v31, s[44:47], s74 offen offset:2048 lds
  buffer_load_dwordx4 v32, s[44:47], s74 offen offset:3072 lds
  s_add_u32 m0, m0, 4096
  s_nop 0
  buffer_load_dwordx4 v33, s[44:47], s74 offen offset:0 lds
  s_add_u32 s74, s74, 212992
  s_waitcnt vmcnt(9)
  ds_read_b64 v[220:221], v35 offset:0
  ds_read_b64 v[222:223], v35 offset:32
  ds_read_b64 v[224:225], v35 offset:64
  ds_read_b64 v[226:227], v35 offset:96
  ds_read_b64 v[228:229], v35 offset:128
  s_waitcnt lgkmcnt(4)
  v_lshlrev_b32 v140, 16, v220
  v_and_b32 v141, 0xffff0000, v220
  v_lshlrev_b32 v142, 16, v221
  v_and_b32 v143, 0xffff0000, v221
  s_waitcnt lgkmcnt(3)
  v_lshlrev_b32 v156, 16, v222
  v_and_b32 v157, 0xffff0000, v222
  v_lshlrev_b32 v158, 16, v223
  v_and_b32 v159, 0xffff0000, v223
  s_waitcnt lgkmcnt(2)
  v_lshlrev_b32 v172, 16, v224
  v_and_b32 v173, 0xffff0000, v224
  v_lshlrev_b32 v174, 16, v225
  v_and_b32 v175, 0xffff0000, v225
  s_waitcnt lgkmcnt(1)
  v_lshlrev_b32 v188, 16, v226
  v_and_b32 v189, 0xffff0000, v226
  v_lshlrev_b32 v190, 16, v227
  v_and_b32 v191, 0xffff0000, v227
  s_waitcnt lgkmcnt(0)
  v_lshlrev_b32 v204, 16, v228
  v_and_b32 v205, 0xffff0000, v228
  v_lshlrev_b32 v206, 16, v229
  v_and_b32 v207, 0xffff0000, v229
  v_mov_b64 v[144:145], v[140:141]
  v_mov_b64 v[146:147], v[142:143]
  v_mov_b64 v[148:149], v[140:141]
  v_mov_b64 v[150:151], v[142:143]
  v_mov_b64 v[152:153], v[140:141]
  v_mov_b64 v[154:155], v[142:143]
  v_mov_b64 v[160:161], v[156:157]
  v_mov_b64 v[162:163], v[158:159]
  v_mov_b64 v[164:165], v[156:157]
  v_mov_b64 v[166:167], v[158:159]
  v_mov_b64 v[168:169], v[156:157]
  v_mov_b64 v[170:171], v[158:159]
  v_mov_b64 v[176:177], v[172:173]
  v_mov_b64 v[178:179], v[174:175]
  v_mov_b64 v[180:181], v[172:173]
  v_mov_b64 v[182:183], v[174:175]
  v_mov_b64 v[184:185], v[172:173]
  v_mov_b64 v[186:187], v[174:175]
  v_mov_b64 v[192:193], v[188:189]
  v_mov_b64 v[194:195], v[190:191]
  v_mov_b64 v[196:197], v[188:189]
  v_mov_b64 v[198:199], v[190:191]
  v_mov_b64 v[200:201], v[188:189]
  v_mov_b64 v[202:203], v[190:191]
  v_mov_b64 v[208:209], v[204:205]
  v_mov_b64 v[210:211], v[206:207]
  v_mov_b64 v[212:213], v[204:205]
  v_mov_b64 v[214:215], v[206:207]
  v_mov_b64 v[216:217], v[204:205]
  v_mov_b64 v[218:219], v[206:207]
  s_waitcnt vmcnt(7)
  v_lshl_add_u32 v34, v116, 7, v15
  v_lshl_add_u32 v28, v112, 7, v14
  s_add_u32 m0, s76, 0
  s_nop 0
  buffer_load_dwordx4 v28, s[32:35], 0 offen lds
  s_add_u32 m0, m0, 1024
  s_nop 0
  buffer_load_dwordx4 v34, s[32:35], 0 offen lds
  s_barrier
  s_lshl_b32 s73, s68, 2
  s_add_u32 s73, s73, 4
  buffer_load_dwordx3 v[16:18], v13, s[28:31], s73 offen offset:0
  buffer_load_dwordx3 v[20:22], v13, s[28:31], s73 offen offset:832
  s_add_u32 s73, s73, 12
  s_mov_b32 s72, 0
  s_cmp_lg_u32 s68, 0
  s_cbranch_scc1 L_dnn_h1
L_dnn_h0:
  s_add_u32 m0, s75, 40960
  s_nop 0
  buffer_load_dwordx4 v29, s[44:47], s74 offen offset:0 lds
  buffer_load_dwordx4 v30, s[44:47], s74 offen offset:1024 lds
  buffer_load_dwordx4 v31, s[44:47], s74 offen offset:2048 lds
  buffer_load_dwordx4 v32, s[44:47], s74 offen offset:3072 lds
  s_add_u32 m0, m0, 4096
  s_nop 0
  buffer_load_dwordx4 v33, s[44:47], s74 offen offset:0 lds
  s_add_u32 s74, s74, 212992
  s_waitcnt vmcnt(9) lgkmcnt(0)
  s_barrier
  buffer_load_dwordx3 v[24:26], v13, s[28:31], s73 offen offset:0
  buffer_load_dwordx3 v[240:242], v13, s[28:31], s73 offen offset:832
  s_add_u32 s73, s73, 12
L_dnn_loop0:
  ds_read_b64_tr_b16 v[40:41], v1 offset:0
  s_add_u32 m0, s75, 81920
  s_nop 0
  buffer_load_dwordx4 v29, s[44:47], s74 offen offset:0 lds
  ds_read_b64_tr_b16 v[42:43], v1 offset:2560
  ds_read_b64_tr_b16 v[44:45], v1 offset:20480
  ds_read_b64_tr_b16 v[46:47], v1 offset:23040
  ds_read_b64_tr_b16 v[48:49], v2 offset:0
  buffer_load_dwordx4 v30, s[44:47], s74 offen offset:1024 lds
  ds_read_b64_tr_b16 v[50:51], v2 offset:2560
  ds_read_b64_tr_b16 v[52:53], v2 offset:20480
  ds_read_b64_tr_b16 v[54:55], v2 offset:23040
  ds_read_b64_tr_b16 v[56:57], v3 offset:0
  buffer_load_dwordx4 v31, s[44:47], s74 offen offset:2048 lds
  ds_read_b64_tr_b16 v[58:59], v3 offset:2560
  ds_read_b64_tr_b16 v[60:61], v3 offset:20480
  ds_read_b64_tr_b16 v[62:63], v3 offset:23040
  ds_read_b64_tr_b16 v[64:65], v4 offset:0
  buffer_load_dwordx4 v32, s[44:47], s74 offen offset:3072 lds
  ds_read_b64_tr_b16 v[66:67], v4 offset:2560
  ds_read_b64_tr_b16 v[68:69], v4 offset:20480
  ds_read_b64_tr_b16 v[70:71], v4 offset:23040
  ds_read_b128 v[80:83], v11 offset:0
  s_add_u32 m0, m0, 4096
  s_nop 0
  buffer_load_dwordx4 v33, s[44:47], s74 offen offset:0 lds
  s_add_u32 s74, s74, 212992
  ds_read_b128 v[84:87], v12 offset:0
  ds_read_b128 v[88:91], v11 offset:2048
  ds_read_b128 v[92:95], v12 offset:2048
  ds_read_b128 v[96:99], v11 offset:4096
  s_waitcnt vmcnt(12)
  v_lshl_add_u32 v34, v20, 7, v15
  v_lshl_add_u32 v28, v16, 7, v14
  s_add_u32 m0, s76, 8192
  s_nop 0
  buffer_load_dwordx4 v28, s[32:35], 0 offen lds
  ds_read_b128 v[100:103], v12 offset:4096
  ds_read_b128 v[104:107], v11 offset:6144
  ds_read_b128 v[108:111], v12 offset:6144
  ds_read_b64_tr_b16 v[72:73], v5 offset:0
  s_add_u32 m0, m0, 1024
  s_nop 0
  buffer_load_dwordx4 v34, s[32:35], 0 offen lds
  ds_read_b64_tr_b16 v[74:75], v5 offset:2560
  ds_read_b64_tr_b16 v[76:77], v5 offset:20480
  ds_read_b64_tr_b16 v[78:79], v5 offset:23040
  s_waitcnt vmcnt(9) lgkmcnt(0)
  s_barrier
  s_setprio 0
  v_mfma_f32_16x16x32_bf16 v[140:143], v[40:43], v[80:83], v[140:143]
  v_mfma_f32_16x16x32_bf16 v[140:143], v[44:47], v[84:87], v[140:143]
  v_mfma_f32_16x16x32_bf16 v[144:147], v[40:43], v[88:91], v[144:147]
  v_mfma_f32_16x16x32_bf16 v[144:147], v[44:47], v[92:95], v[144:147]
  v_mfma_f32_16x16x32_bf16 v[148:151], v[40:43], v[96:99], v[148:151]
  v_mfma_f32_16x16x32_bf16 v[148:151], v[44:47], v[100:103], v[148:151]
  v_mfma_f32_16x16x32_bf16 v[152:155], v[40:43], v[104:107], v[152:155]
  v_mfma_f32_16x16x32_bf16 v[152:155], v[44:47], v[108:111], v[152:155]
  v_mfma_f32_16x16x32_bf16 v[168:171], v[48:51], v[104:107], v[168:171]
  v_mfma_f32_16x16x32_bf16 v[168:171], v[52:55], v[108:111], v[168:171]
  v_mfma_f32_16x16x32_bf16 v[164:167], v[48:51], v[96:99], v[164:167]
  v_mfma_f32_16x16x32_bf16 v[164:167], v[52:55], v[100:103], v[164:167]
  v_mfma_f32_16x16x32_bf16 v[160:163], v[48:51], v[88:91], v[160:163]
  v_mfma_f32_16x16x32_bf16 v[160:163], v[52:55], v[92:95], v[160:163]
  v_mfma_f32_16x16x32_bf16 v[156:159], v[48:51], v[80:83], v[156:159]
  v_mfma_f32_16x16x32_bf16 v[156:159], v[52:55], v[84:87], v[156:159]
  v_mfma_f32_16x16x32_bf16 v[172:175], v[56:59], v[80:83], v[172:175]
  v_mfma_f32_16x16x32_bf16 v[172:175], v[60:63], v[84:87], v[172:175]
  v_mfma_f32_16x16x32_bf16 v[176:179], v[56:59], v[88:91], v[176:179]
  v_mfma_f32_16x16x32_bf16 v[176:179], v[60:63], v[92:95], v[176:179]
  v_mfma_f32_16x16x32_bf16 v[180:183], v[56:59], v[96:99], v[180:183]
  v_mfma_f32_16x16x32_bf16 v[180:183], v[60:63], v[100:103], v[180:183]
  v_mfma_f32_16x16x32_bf16 v[184:187], v[56:59], v[104:107], v[184:187]
  v_mfma_f32_16x16x32_bf16 v[184:187], v[60:63], v[108:111], v[184:187]
  v_mfma_f32_16x16x32_bf16 v[200:203], v[64:67], v[104:107], v[200:203]
  v_mfma_f32_16x16x32_bf16 v[200:203], v[68:71], v[108:111], v[200:203]
  v_mfma_f32_16x16x32_bf16 v[196:199], v[64:67], v[96:99], v[196:199]
  v_mfma_f32_16x16x32_bf16 v[196:199], v[68:71], v[100:103], v[196:199]
  v_mfma_f32_16x16x32_bf16 v[192:195], v[64:67], v[88:91], v[192:195]
  v_mfma_f32_16x16x32_bf16 v[192:195], v[68:71], v[92:95], v[192:195]
  v_mfma_f32_16x16x32_bf16 v[188:191], v[64:67], v[80:83], v[188:191]
  v_mfma_f32_16x16x32_bf16 v[188:191], v[68:71], v[84:87], v[188:191]
  v_mfma_f32_16x16x32_bf16 v[204:207], v[72:75], v[80:83], v[204:207]
  v_mfma_f32_16x16x32_bf16 v[204:207], v[76:79], v[84:87], v[204:207]
  v_mfma_f32_16x16x32_bf16 v[208:211], v[72:75], v[88:91], v[208:211]
  v_mfma_f32_16x16x32_bf16 v[208:211], v[76:79], v[92:95], v[208:211]
  v_mfma_f32_16x16x32_bf16 v[212:215], v[72:75], v[96:99], v[212:215]
  v_mfma_f32_16x16x32_bf16 v[212:215], v[76:79], v[100:103], v[212:215]
  v_mfma_f32_16x16x32_bf16 v[216:219], v[72:75], v[104:107], v[216:219]
  s_setprio 2
  s_waitcnt vmcnt(9)
  s_barrier
  v_mfma_f32_16x16x32_bf16 v[216:219], v[76:79], v[108:111], v[216:219]
  ds_read_b64_tr_b16 v[40:41], v1 offset:40960
  s_add_u32 m0, s75, 0
  s_nop 0
  buffer_load_dwordx4 v29, s[44:47], s74 offen offset:0 lds
  ds_read_b64_tr_b16 v[42:43], v1 offset:43520
  ds_read_b64_tr_b16 v[44:45], v6 offset:0
  ds_read_b64_tr_b16 v[46:47], v6 offset:2560
  ds_read_b64_tr_b16 v[48:49], v2 offset:40960
  buffer_load_dwordx4 v30, s[44:47], s74 offen offset:1024 lds
  ds_read_b64_tr_b16 v[50:51], v2 offset:43520
  ds_read_b64_tr_b16 v[52:53], v7 offset:0
  ds_read_b64_tr_b16 v[54:55], v7 offset:2560
  ds_read_b64_tr_b16 v[56:57], v3 offset:40960
  buffer_load_dwordx4 v31, s[44:47], s74 offen offset:2048 lds
  ds_read_b64_tr_b16 v[58:59], v3 offset:43520
  ds_read_b64_tr_b16 v[60:61], v8 offset:0
  ds_read_b64_tr_b16 v[62:63], v8 offset:2560
  ds_read_b64_tr_b16 v[64:65], v4 offset:40960
  buffer_load_dwordx4 v32, s[44:47], s74 offen offset:3072 lds
  ds_read_b64_tr_b16 v[66:67], v4 offset:43520
  ds_read_b64_tr_b16 v[68:69], v9 offset:0
  ds_read_b64_tr_b16 v[70:71], v9 offset:2560
  ds_read_b128 v[80:83], v11 offset:8192
  s_add_u32 m0, m0, 4096
  s_nop 0
  buffer_load_dwordx4 v33, s[44:47], s74 offen offset:0 lds
  s_add_u32 s74, s74, 212992
  ds_read_b128 v[84:87], v12 offset:8192
  ds_read_b128 v[88:91], v11 offset:10240
  ds_read_b128 v[92:95], v12 offset:10240
  ds_read_b128 v[96:99], v11 offset:12288
  v_lshl_add_u32 v34, v21, 7, v15
  v_lshl_add_u32 v28, v17, 7, v14
  s_add_u32 m0, s76, 0
  s_nop 0
  buffer_load_dwordx4 v28, s[32:35], 0 offen lds
  ds_read_b128 v[100:103], v12 offset:12288
  ds_read_b128 v[104:107], v11 offset:14336
  ds_read_b128 v[108:111], v12 offset:14336
  ds_read_b64_tr_b16 v[72:73], v5 offset:40960
  s_add_u32 m0, m0, 1024
  s_nop 0
  buffer_load_dwordx4 v34, s[32:35], 0 offen lds
  ds_read_b64_tr_b16 v[74:75], v5 offset:43520
  ds_read_b64_tr_b16 v[76:77], v10 offset:0
  ds_read_b64_tr_b16 v[78:79], v10 offset:2560
  s_waitcnt vmcnt(7) lgkmcnt(0)
  s_barrier
  s_setprio 0
  v_mfma_f32_16x16x32_bf16 v[140:143], v[40:43], v[80:83], v[140:143]
  v_mfma_f32_16x16x32_bf16 v[140:143], v[44:47], v[84:87], v[140:143]
  v_mfma_f32_16x16x32_bf16 v[144:147], v[40:43], v[88:91], v[144:147]
  v_mfma_f32_16x16x32_bf16 v[144:147], v[44:47], v[92:95], v[144:147]
  v_mfma_f32_16x16x32_bf16 v[148:151], v[40:43], v[96:99], v[148:151]
  v_mfma_f32_16x16x32_bf16 v[148:151], v[44:47], v[100:103], v[148:151]
  v_mfma_f32_16x16x32_bf16 v[152:155], v[40:43], v[104:107], v[152:155]
  v_mfma_f32_16x16x32_bf16 v[152:155], v[44:47], v[108:111], v[152:155]
  v_mfma_f32_16x16x32_bf16 v[168:171], v[48:51], v[104:107], v[168:171]
  v_mfma_f32_16x16x32_bf16 v[168:171], v[52:55], v[108:111], v[168:171]
  v_mfma_f32_16x16x32_bf16 v[164:167], v[48:51], v[96:99], v[164:167]
  v_mfma_f32_16x16x32_bf16 v[164:167], v[52:55], v[100:103], v[164:167]
  v_mfma_f32_16x16x32_bf16 v[160:163], v[48:51], v[88:91], v[160:163]
  v_mfma_f32_16x16x32_bf16 v[160:163], v[52:55], v[92:95], v[160:163]
  v_mfma_f32_16x16x32_bf16 v[156:159], v[48:51], v[80:83], v[156:159]
  v_mfma_f32_16x16x32_bf16 v[156:159], v[52:55], v[84:87], v[156:159]
  v_mfma_f32_16x16x32_bf16 v[172:175], v[56:59], v[80:83], v[172:175]
  v_mfma_f32_16x16x32_bf16 v[172:175], v[60:63], v[84:87], v[172:175]
  v_mfma_f32_16x16x32_bf16 v[176:179], v[56:59], v[88:91], v[176:179]
  v_mfma_f32_16x16x32_bf16 v[176:179], v[60:63], v[92:95], v[176:179]
  v_mfma_f32_16x16x32_bf16 v[180:183], v[56:59], v[96:99], v[180:183]
  v_mfma_f32_16x16x32_bf16 v[180:183], v[60:63], v[100:103], v[180:183]
  v_mfma_f32_16x16x32_bf16 v[184:187], v[56:59], v[104:107], v[184:187]
  v_mfma_f32_16x16x32_bf16 v[184:187], v[60:63], v[108:111], v[184:187]
  v_mfma_f32_16x16x32_bf16 v[200:203], v[64:67], v[104:107], v[200:203]
  v_mfma_f32_16x16x32_bf16 v[200:203], v[68:71], v[108:111], v[200:203]
  v_mfma_f32_16x16x32_bf16 v[196:199], v[64:67], v[96:99], v[196:199]
  v_mfma_f32_16x16x32_bf16 v[196:199], v[68:71], v[100:103], v[196:199]
  v_mfma_f32_16x16x32_bf16 v[192:195], v[64:67], v[88:91], v[192:195]
  v_mfma_f32_16x16x32_bf16 v[192:195], v[68:71], v[92:95], v[192:195]
  v_mfma_f32_16x16x32_bf16 v[188:191], v[64:67], v[80:83], v[188:191]
  v_mfma_f32_16x16x32_bf16 v[188:191], v[68:71], v[84:87], v[188:191]
  v_mfma_f32_16x16x32_bf16 v[204:207], v[72:75], v[80:83], v[204:207]
  v_mfma_f32_16x16x32_bf16 v[204:207], v[76:79], v[84:87], v[204:207]
  v_mfma_f32_16x16x32_bf16 v[208:211], v[72:75], v[88:91], v[208:211]
  v_mfma_f32_16x16x32_bf16 v[208:211], v[76:79], v[92:95], v[208:211]
  v_mfma_f32_16x16x32_bf16 v[212:215], v[72:75], v[96:99], v[212:215]
  v_mfma_f32_16x16x32_bf16 v[212:215], v[76:79], v[100:103], v[212:215]
  v_mfma_f32_16x16x32_bf16 v[216:219], v[72:75], v[104:107], v[216:219]
  s_setprio 2
  s_barrier
  v_mfma_f32_16x16x32_bf16 v[216:219], v[76:79], v[108:111], v[216:219]
  ds_read_b64_tr_b16 v[40:41], v6 offset:20480
  s_add_u32 m0, s75, 40960
  s_nop 0
  buffer_load_dwordx4 v29, s[44:47], s74 offen offset:0 lds
  ds_read_b64_tr_b16 v[42:43], v6 offset:23040
  ds_read_b64_tr_b16 v[44:45], v6 offset:40960
  ds_read_b64_tr_b16 v[46:47], v6 offset:43520
  ds_read_b64_tr_b16 v[48:49], v7 offset:20480
  buffer_load_dwordx4 v30, s[44:47], s74 offen offset:1024 lds
  ds_read_b64_tr_b16 v[50:51], v7 offset:23040
  ds_read_b64_tr_b16 v[52:53], v7 offset:40960
  ds_read_b64_tr_b16 v[54:55], v7 offset:43520
  ds_read_b64_tr_b16 v[56:57], v8 offset:20480
  buffer_load_dwordx4 v31, s[44:47], s74 offen offset:2048 lds
  ds_read_b64_tr_b16 v[58:59], v8 offset:23040
  ds_read_b64_tr_b16 v[60:61], v8 offset:40960
  ds_read_b64_tr_b16 v[62:63], v8 offset:43520
  ds_read_b64_tr_b16 v[64:65], v9 offset:20480
  buffer_load_dwordx4 v32, s[44:47], s74 offen offset:3072 lds
  ds_read_b64_tr_b16 v[66:67], v9 offset:23040
  ds_read_b64_tr_b16 v[68:69], v9 offset:40960
  ds_read_b64_tr_b16 v[70:71], v9 offset:43520
  ds_read_b128 v[80:83], v11 offset:0
  s_add_u32 m0, m0, 4096
  s_nop 0
  buffer_load_dwordx4 v33, s[44:47], s74 offen offset:0 lds
  s_add_u32 s74, s74, 212992
  ds_read_b128 v[84:87], v12 offset:0
  ds_read_b128 v[88:91], v11 offset:2048
  ds_read_b128 v[92:95], v12 offset:2048
  ds_read_b128 v[96:99], v11 offset:4096
  v_lshl_add_u32 v34, v22, 7, v15
  v_lshl_add_u32 v28, v18, 7, v14
  s_add_u32 m0, s76, 8192
  s_nop 0
  buffer_load_dwordx4 v28, s[32:35], 0 offen lds
  ds_read_b128 v[100:103], v12 offset:4096
  ds_read_b128 v[104:107], v11 offset:6144
  ds_read_b128 v[108:111], v12 offset:6144
  ds_read_b64_tr_b16 v[72:73], v10 offset:20480
  s_add_u32 m0, m0, 1024
  s_nop 0
  buffer_load_dwordx4 v34, s[32:35], 0 offen lds
  ds_read_b64_tr_b16 v[74:75], v10 offset:23040
  ds_read_b64_tr_b16 v[76:77], v10 offset:40960
  ds_read_b64_tr_b16 v[78:79], v10 offset:43520
  buffer_load_dwordx3 v[16:18], v13, s[28:31], s73 offen offset:0
  buffer_load_dwordx3 v[20:22], v13, s[28:31], s73 offen offset:832
  s_add_u32 s73, s73, 12
  s_waitcnt vmcnt(9) lgkmcnt(0)
  s_barrier
  s_setprio 0
  v_mfma_f32_16x16x32_bf16 v[140:143], v[40:43], v[80:83], v[140:143]
  v_mfma_f32_16x16x32_bf16 v[140:143], v[44:47], v[84:87], v[140:143]
  v_mfma_f32_16x16x32_bf16 v[144:147], v[40:43], v[88:91], v[144:147]
  v_mfma_f32_16x16x32_bf16 v[144:147], v[44:47], v[92:95], v[144:147]
  v_mfma_f32_16x16x32_bf16 v[148:151], v[40:43], v[96:99], v[148:151]
  v_mfma_f32_16x16x32_bf16 v[148:151], v[44:47], v[100:103], v[148:151]
  v_mfma_f32_16x16x32_bf16 v[152:155], v[40:43], v[104:107], v[152:155]
  v_mfma_f32_16x16x32_bf16 v[152:155], v[44:47], v[108:111], v[152:155]
  v_mfma_f32_16x16x32_bf16 v[168:171], v[48:51], v[104:107], v[168:171]
  v_mfma_f32_16x16x32_bf16 v[168:171], v[52:55], v[108:111], v[168:171]
  v_mfma_f32_16x16x32_bf16 v[164:167], v[48:51], v[96:99], v[164:167]
  v_mfma_f32_16x16x32_bf16 v[164:167], v[52:55], v[100:103], v[164:167]
  v_mfma_f32_16x16x32_bf16 v[160:163], v[48:51], v[88:91], v[160:163]
  v_mfma_f32_16x16x32_bf16 v[160:163], v[52:55], v[92:95], v[160:163]
  v_mfma_f32_16x16x32_bf16 v[156:159], v[48:51], v[80:83], v[156:159]
  v_mfma_f32_16x16x32_bf16 v[156:159], v[52:55], v[84:87], v[156:159]
  v_mfma_f32_16x16x32_bf16 v[172:175], v[56:59], v[80:83], v[172:175]
  v_mfma_f32_16x16x32_bf16 v[172:175], v[60:63], v[84:87], v[172:175]
  v_mfma_f32_16x16x32_bf16 v[176:179], v[56:59], v[88:91], v[176:179]
  v_mfma_f32_16x16x32_bf16 v[176:179], v[60:63], v[92:95], v[176:179]
  v_mfma_f32_16x16x32_bf16 v[180:183], v[56:59], v[96:99], v[180:183]
  v_mfma_f32_16x16x32_bf16 v[180:183], v[60:63], v[100:103], v[180:183]
  v_mfma_f32_16x16x32_bf16 v[184:187], v[56:59], v[104:107], v[184:187]
  v_mfma_f32_16x16x32_bf16 v[184:187], v[60:63], v[108:111], v[184:187]
  v_mfma_f32_16x16x32_bf16 v[200:203], v[64:67], v[104:107], v[200:203]
  v_mfma_f32_16x16x32_bf16 v[200:203], v[68:71], v[108:111], v[200:203]
  v_mfma_f32_16x16x32_bf16 v[196:199], v[64:67], v[96:99], v[196:199]
  v_mfma_f32_16x16x32_bf16 v[196:199], v[68:71], v[100:103], v[196:199]
  v_mfma_f32_16x16x32_bf16 v[192:195], v[64:67], v[88:91], v[192:195]
  v_mfma_f32_16x16x32_bf16 v[192:195], v[68:71], v[92:95], v[192:195]
  v_mfma_f32_16x16x32_bf16 v[188:191], v[64:67], v[80:83], v[188:191]
  v_mfma_f32_16x16x32_bf16 v[188:191], v[68:71], v[84:87], v[188:191]
  v_mfma_f32_16x16x32_bf16 v[204:207], v[72:75], v[80:83], v[204:207]
  v_mfma_f32_16x16x32_bf16 v[204:207], v[76:79], v[84:87], v[204:207]
  v_mfma_f32_16x16x32_bf16 v[208:211], v[72:75], v[88:91], v[208:211]
  v_mfma_f32_16x16x32_bf16 v[208:211], v[76:79], v[92:95], v[208:211]
  v_mfma_f32_16x16x32_bf16 v[212:215], v[72:75], v[96:99], v[212:215]
  v_mfma_f32_16x16x32_bf16 v[212:215], v[76:79], v[100:103], v[212:215]
  v_mfma_f32_16x16x32_bf16 v[216:219], v[72:75], v[104:107], v[216:219]
  s_setprio 2
  s_barrier
  v_mfma_f32_16x16x32_bf16 v[216:219], v[76:79], v[108:111], v[216:219]
  ds_read_b64_tr_b16 v[40:41], v1 offset:0
  s_add_u32 m0, s75, 81920
  s_nop 0
  buffer_load_dwordx4 v29, s[44:47], s74 offen offset:0 lds
  ds_read_b64_tr_b16 v[42:43], v1 offset:2560
  ds_read_b64_tr_b16 v[44:45], v1 offset:20480
  ds_read_b64_tr_b16 v[46:47], v1 offset:23040
  ds_read_b64_tr_b16 v[48:49], v2 offset:0
  buffer_load_dwordx4 v30, s[44:47], s74 offen offset:1024 lds
  ds_read_b64_tr_b16 v[50:51], v2 offset:2560
  ds_read_b64_tr_b16 v[52:53], v2 offset:20480
  ds_read_b64_tr_b16 v[54:55], v2 offset:23040
  ds_read_b64_tr_b16 v[56:57], v3 offset:0
  buffer_load_dwordx4 v31, s[44:47], s74 offen offset:2048 lds
  ds_read_b64_tr_b16 v[58:59], v3 offset:2560
  ds_read_b64_tr_b16 v[60:61], v3 offset:20480
  ds_read_b64_tr_b16 v[62:63], v3 offset:23040
  ds_read_b64_tr_b16 v[64:65], v4 offset:0
  buffer_load_dwordx4 v32, s[44:47], s74 offen offset:3072 lds
  ds_read_b64_tr_b16 v[66:67], v4 offset:2560
  ds_read_b64_tr_b16 v[68:69], v4 offset:20480
  ds_read_b64_tr_b16 v[70:71], v4 offset:23040
  ds_read_b128 v[80:83], v11 offset:8192
  s_add_u32 m0, m0, 4096
  s_nop 0
  buffer_load_dwordx4 v33, s[44:47], s74 offen offset:0 lds
  s_add_u32 s74, s74, 212992
  ds_read_b128 v[84:87], v12 offset:8192
  ds_read_b128 v[88:91], v11 offset:10240
  ds_read_b128 v[92:95], v12 offset:10240
  ds_read_b128 v[96:99], v11 offset:12288
  v_lshl_add_u32 v34, v240, 7, v15
  v_lshl_add_u32 v28, v24, 7, v14
  s_add_u32 m0, s76, 0
  s_nop 0
  buffer_load_dwordx4 v28, s[32:35], 0 offen lds
  ds_read_b128 v[100:103], v12 offset:12288
  ds_read_b128 v[104:107], v11 offset:14336
  ds_read_b128 v[108:111], v12 offset:14336
  ds_read_b64_tr_b16 v[72:73], v5 offset:0
  s_add_u32 m0, m0, 1024
  s_nop 0
  buffer_load_dwordx4 v34, s[32:35], 0 offen lds
  ds_read_b64_tr_b16 v[74:75], v5 offset:2560
  ds_read_b64_tr_b16 v[76:77], v5 offset:20480
  ds_read_b64_tr_b16 v[78:79], v5 offset:23040
  s_waitcnt vmcnt(9) lgkmcnt(0)
  s_barrier
  s_setprio 0
  v_mfma_f32_16x16x32_bf16 v[140:143], v[40:43], v[80:83], v[140:143]
  v_mfma_f32_16x16x32_bf16 v[140:143], v[44:47], v[84:87], v[140:143]
  v_mfma_f32_16x16x32_bf16 v[144:147], v[40:43], v[88:91], v[144:147]
  v_mfma_f32_16x16x32_bf16 v[144:147], v[44:47], v[92:95], v[144:147]
  v_mfma_f32_16x16x32_bf16 v[148:151], v[40:43], v[96:99], v[148:151]
  v_mfma_f32_16x16x32_bf16 v[148:151], v[44:47], v[100:103], v[148:151]
  v_mfma_f32_16x16x32_bf16 v[152:155], v[40:43], v[104:107], v[152:155]
  v_mfma_f32_16x16x32_bf16 v[152:155], v[44:47], v[108:111], v[152:155]
  v_mfma_f32_16x16x32_bf16 v[168:171], v[48:51], v[104:107], v[168:171]
  v_mfma_f32_16x16x32_bf16 v[168:171], v[52:55], v[108:111], v[168:171]
  v_mfma_f32_16x16x32_bf16 v[164:167], v[48:51], v[96:99], v[164:167]
  v_mfma_f32_16x16x32_bf16 v[164:167], v[52:55], v[100:103], v[164:167]
  v_mfma_f32_16x16x32_bf16 v[160:163], v[48:51], v[88:91], v[160:163]
  v_mfma_f32_16x16x32_bf16 v[160:163], v[52:55], v[92:95], v[160:163]
  v_mfma_f32_16x16x32_bf16 v[156:159], v[48:51], v[80:83], v[156:159]
  v_mfma_f32_16x16x32_bf16 v[156:159], v[52:55], v[84:87], v[156:159]
  v_mfma_f32_16x16x32_bf16 v[172:175], v[56:59], v[80:83], v[172:175]
  v_mfma_f32_16x16x32_bf16 v[172:175], v[60:63], v[84:87], v[172:175]
  v_mfma_f32_16x16x32_bf16 v[176:179], v[56:59], v[88:91], v[176:179]
  v_mfma_f32_16x16x32_bf16 v[176:179], v[60:63], v[92:95], v[176:179]
  v_mfma_f32_16x16x32_bf16 v[180:183], v[56:59], v[96:99], v[180:183]
  v_mfma_f32_16x16x32_bf16 v[180:183], v[60:63], v[100:103], v[180:183]
  v_mfma_f32_16x16x32_bf16 v[184:187], v[56:59], v[104:107], v[184:187]
  v_mfma_f32_16x16x32_bf16 v[184:187], v[60:63], v[108:111], v[184:187]
  v_mfma_f32_16x16x32_bf16 v[200:203], v[64:67], v[104:107], v[200:203]
  v_mfma_f32_16x16x32_bf16 v[200:203], v[68:71], v[108:111], v[200:203]
  v_mfma_f32_16x16x32_bf16 v[196:199], v[64:67], v[96:99], v[196:199]
  v_mfma_f32_16x16x32_bf16 v[196:199], v[68:71], v[100:103], v[196:199]
  v_mfma_f32_16x16x32_bf16 v[192:195], v[64:67], v[88:91], v[192:195]
  v_mfma_f32_16x16x32_bf16 v[192:195], v[68:71], v[92:95], v[192:195]
  v_mfma_f32_16x16x32_bf16 v[188:191], v[64:67], v[80:83], v[188:191]
  v_mfma_f32_16x16x32_bf16 v[188:191], v[68:71], v[84:87], v[188:191]
  v_mfma_f32_16x16x32_bf16 v[204:207], v[72:75], v[80:83], v[204:207]
  v_mfma_f32_16x16x32_bf16 v[204:207], v[76:79], v[84:87], v[204:207]
  v_mfma_f32_16x16x32_bf16 v[208:211], v[72:75], v[88:91], v[208:211]
  v_mfma_f32_16x16x32_bf16 v[208:211], v[76:79], v[92:95], v[208:211]
  v_mfma_f32_16x16x32_bf16 v[212:215], v[72:75], v[96:99], v[212:215]
  v_mfma_f32_16x16x32_bf16 v[212:215], v[76:79], v[100:103], v[212:215]
  v_mfma_f32_16x16x32_bf16 v[216:219], v[72:75], v[104:107], v[216:219]
  s_setprio 2
  s_barrier
  v_mfma_f32_16x16x32_bf16 v[216:219], v[76:79], v[108:111], v[216:219]
  ds_read_b64_tr_b16 v[40:41], v1 offset:40960
  s_add_u32 m0, s75, 0
  s_nop 0
  buffer_load_dwordx4 v29, s[44:47], s74 offen offset:0 lds
  ds_read_b64_tr_b16 v[42:43], v1 offset:43520
  ds_read_b64_tr_b16 v[44:45], v6 offset:0
  ds_read_b64_tr_b16 v[46:47], v6 offset:2560
  ds_read_b64_tr_b16 v[48:49], v2 offset:40960
  buffer_load_dwordx4 v30, s[44:47], s74 offen offset:1024 lds
  ds_read_b64_tr_b16 v[50:51], v2 offset:43520
  ds_read_b64_tr_b16 v[52:53], v7 offset:0
  ds_read_b64_tr_b16 v[54:55], v7 offset:2560
  ds_read_b64_tr_b16 v[56:57], v3 offset:40960
  buffer_load_dwordx4 v31, s[44:47], s74 offen offset:2048 lds
  ds_read_b64_tr_b16 v[58:59], v3 offset:43520
  ds_read_b64_tr_b16 v[60:61], v8 offset:0
  ds_read_b64_tr_b16 v[62:63], v8 offset:2560
  ds_read_b64_tr_b16 v[64:65], v4 offset:40960
  buffer_load_dwordx4 v32, s[44:47], s74 offen offset:3072 lds
  ds_read_b64_tr_b16 v[66:67], v4 offset:43520
  ds_read_b64_tr_b16 v[68:69], v9 offset:0
  ds_read_b64_tr_b16 v[70:71], v9 offset:2560
  ds_read_b128 v[80:83], v11 offset:0
  s_add_u32 m0, m0, 4096
  s_nop 0
  buffer_load_dwordx4 v33, s[44:47], s74 offen offset:0 lds
  s_add_u32 s74, s74, 212992
  ds_read_b128 v[84:87], v12 offset:0
  ds_read_b128 v[88:91], v11 offset:2048
  ds_read_b128 v[92:95], v12 offset:2048
  ds_read_b128 v[96:99], v11 offset:4096
  v_lshl_add_u32 v34, v241, 7, v15
  v_lshl_add_u32 v28, v25, 7, v14
  s_add_u32 m0, s76, 8192
  s_nop 0
  buffer_load_dwordx4 v28, s[32:35], 0 offen lds
  ds_read_b128 v[100:103], v12 offset:4096
  ds_read_b128 v[104:107], v11 offset:6144
  ds_read_b128 v[108:111], v12 offset:6144
  ds_read_b64_tr_b16 v[72:73], v5 offset:40960
  s_add_u32 m0, m0, 1024
  s_nop 0
  buffer_load_dwordx4 v34, s[32:35], 0 offen lds
  ds_read_b64_tr_b16 v[74:75], v5 offset:43520
  ds_read_b64_tr_b16 v[76:77], v10 offset:0
  ds_read_b64_tr_b16 v[78:79], v10 offset:2560
  s_waitcnt vmcnt(7) lgkmcnt(0)
  s_barrier
  s_setprio 0
  v_mfma_f32_16x16x32_bf16 v[140:143], v[40:43], v[80:83], v[140:143]
  v_mfma_f32_16x16x32_bf16 v[140:143], v[44:47], v[84:87], v[140:143]
  v_mfma_f32_16x16x32_bf16 v[144:147], v[40:43], v[88:91], v[144:147]
  v_mfma_f32_16x16x32_bf16 v[144:147], v[44:47], v[92:95], v[144:147]
  v_mfma_f32_16x16x32_bf16 v[148:151], v[40:43], v[96:99], v[148:151]
  v_mfma_f32_16x16x32_bf16 v[148:151], v[44:47], v[100:103], v[148:151]
  v_mfma_f32_16x16x32_bf16 v[152:155], v[40:43], v[104:107], v[152:155]
  v_mfma_f32_16x16x32_bf16 v[152:155], v[44:47], v[108:111], v[152:155]
  v_mfma_f32_16x16x32_bf16 v[168:171], v[48:51], v[104:107], v[168:171]
  v_mfma_f32_16x16x32_bf16 v[168:171], v[52:55], v[108:111], v[168:171]
  v_mfma_f32_16x16x32_bf16 v[164:167], v[48:51], v[96:99], v[164:167]
  v_mfma_f32_16x16x32_bf16 v[164:167], v[52:55], v[100:103], v[164:167]
  v_mfma_f32_16x16x32_bf16 v[160:163], v[48:51], v[88:91], v[160:163]
  v_mfma_f32_16x16x32_bf16 v[160:163], v[52:55], v[92:95], v[160:163]
  v_mfma_f32_16x16x32_bf16 v[156:159], v[48:51], v[80:83], v[156:159]
  v_mfma_f32_16x16x32_bf16 v[156:159], v[52:55], v[84:87], v[156:159]
  v_mfma_f32_16x16x32_bf16 v[172:175], v[56:59], v[80:83], v[172:175]
  v_mfma_f32_16x16x32_bf16 v[172:175], v[60:63], v[84:87], v[172:175]
  v_mfma_f32_16x16x32_bf16 v[176:179], v[56:59], v[88:91], v[176:179]
  v_mfma_f32_16x16x32_bf16 v[176:179], v[60:63], v[92:95], v[176:179]
  v_mfma_f32_16x16x32_bf16 v[180:183], v[56:59], v[96:99], v[180:183]
  v_mfma_f32_16x16x32_bf16 v[180:183], v[60:63], v[100:103], v[180:183]
  v_mfma_f32_16x16x32_bf16 v[184:187], v[56:59], v[104:107], v[184:187]
  v_mfma_f32_16x16x32_bf16 v[184:187], v[60:63], v[108:111], v[184:187]
  v_mfma_f32_16x16x32_bf16 v[200:203], v[64:67], v[104:107], v[200:203]
  v_mfma_f32_16x16x32_bf16 v[200:203], v[68:71], v[108:111], v[200:203]
  v_mfma_f32_16x16x32_bf16 v[196:199], v[64:67], v[96:99], v[196:199]
  v_mfma_f32_16x16x32_bf16 v[196:199], v[68:71], v[100:103], v[196:199]
  v_mfma_f32_16x16x32_bf16 v[192:195], v[64:67], v[88:91], v[192:195]
  v_mfma_f32_16x16x32_bf16 v[192:195], v[68:71], v[92:95], v[192:195]
  v_mfma_f32_16x16x32_bf16 v[188:191], v[64:67], v[80:83], v[188:191]
  v_mfma_f32_16x16x32_bf16 v[188:191], v[68:71], v[84:87], v[188:191]
  v_mfma_f32_16x16x32_bf16 v[204:207], v[72:75], v[80:83], v[204:207]
  v_mfma_f32_16x16x32_bf16 v[204:207], v[76:79], v[84:87], v[204:207]
  v_mfma_f32_16x16x32_bf16 v[208:211], v[72:75], v[88:91], v[208:211]
  v_mfma_f32_16x16x32_bf16 v[208:211], v[76:79], v[92:95], v[208:211]
  v_mfma_f32_16x16x32_bf16 v[212:215], v[72:75], v[96:99], v[212:215]
  v_mfma_f32_16x16x32_bf16 v[212:215], v[76:79], v[100:103], v[212:215]
  v_mfma_f32_16x16x32_bf16 v[216:219], v[72:75], v[104:107], v[216:219]
  s_setprio 2
  s_barrier
  v_mfma_f32_16x16x32_bf16 v[216:219], v[76:79], v[108:111], v[216:219]
  ds_read_b64_tr_b16 v[40:41], v6 offset:20480
  s_add_u32 m0, s75, 40960
  s_nop 0
  buffer_load_dwordx4 v29, s[44:47], s74 offen offset:0 lds
  ds_read_b64_tr_b16 v[42:43], v6 offset:23040
  ds_read_b64_tr_b16 v[44:45], v6 offset:40960
  ds_read_b64_tr_b16 v[46:47], v6 offset:43520
  ds_read_b64_tr_b16 v[48:49], v7 offset:20480
  buffer_load_dwordx4 v30, s[44:47], s74 offen offset:1024 lds
  ds_read_b64_tr_b16 v[50:51], v7 offset:23040
  ds_read_b64_tr_b16 v[52:53], v7 offset:40960
  ds_read_b64_tr_b16 v[54:55], v7 offset:43520
  ds_read_b64_tr_b16 v[56:57], v8 offset:20480
  buffer_load_dwordx4 v31, s[44:47], s74 offen offset:2048 lds
  ds_read_b64_tr_b16 v[58:59], v8 offset:23040
  ds_read_b64_tr_b16 v[60:61], v8 offset:40960
  ds_read_b64_tr_b16 v[62:63], v8 offset:43520
  ds_read_b64_tr_b16 v[64:65], v9 offset:20480
  buffer_load_dwordx4 v32, s[44:47], s74 offen offset:3072 lds
  ds_read_b64_tr_b16 v[66:67], v9 offset:23040
  ds_read_b64_tr_b16 v[68:69], v9 offset:40960
  ds_read_b64_tr_b16 v[70:71], v9 offset:43520
  ds_read_b128 v[80:83], v11 offset:8192
  s_add_u32 m0, m0, 4096
  s_nop 0
  buffer_load_dwordx4 v33, s[44:47], s74 offen offset:0 lds
  s_add_u32 s74, s74, 212992
  ds_read_b128 v[84:87], v12 offset:8192
  ds_read_b128 v[88:91], v11 offset:10240
  ds_read_b128 v[92:95], v12 offset:10240
  ds_read_b128 v[96:99], v11 offset:12288
  v_lshl_add_u32 v34, v242, 7, v15
  v_lshl_add_u32 v28, v26, 7, v14
  s_add_u32 m0, s76, 0
  s_nop 0
  buffer_load_dwordx4 v28, s[32:35], 0 offen lds
  ds_read_b128 v[100:103], v12 offset:12288
  ds_read_b128 v[104:107], v11 offset:14336
  ds_read_b128 v[108:111], v12 offset:14336
  ds_read_b64_tr_b16 v[72:73], v10 offset:20480
  s_add_u32 m0, m0, 1024
  s_nop 0
  buffer_load_dwordx4 v34, s[32:35], 0 offen lds
  ds_read_b64_tr_b16 v[74:75], v10 offset:23040
  ds_read_b64_tr_b16 v[76:77], v10 offset:40960
  ds_read_b64_tr_b16 v[78:79], v10 offset:43520
  buffer_load_dwordx3 v[24:26], v13, s[28:31], s73 offen offset:0
  buffer_load_dwordx3 v[240:242], v13, s[28:31], s73 offen offset:832
  s_add_u32 s73, s73, 12
  s_waitcnt vmcnt(9) lgkmcnt(0)
  s_barrier
  s_setprio 0
  v_mfma_f32_16x16x32_bf16 v[140:143], v[40:43], v[80:83], v[140:143]
  s_add_u32 s72, s72, 1
  v_mfma_f32_16x16x32_bf16 v[140:143], v[44:47], v[84:87], v[140:143]
  v_mfma_f32_16x16x32_bf16 v[144:147], v[40:43], v[88:91], v[144:147]
  v_mfma_f32_16x16x32_bf16 v[144:147], v[44:47], v[92:95], v[144:147]
  v_mfma_f32_16x16x32_bf16 v[148:151], v[40:43], v[96:99], v[148:151]
  v_mfma_f32_16x16x32_bf16 v[148:151], v[44:47], v[100:103], v[148:151]
  v_mfma_f32_16x16x32_bf16 v[152:155], v[40:43], v[104:107], v[152:155]
  v_mfma_f32_16x16x32_bf16 v[152:155], v[44:47], v[108:111], v[152:155]
  v_mfma_f32_16x16x32_bf16 v[168:171], v[48:51], v[104:107], v[168:171]
  v_mfma_f32_16x16x32_bf16 v[168:171], v[52:55], v[108:111], v[168:171]
  v_mfma_f32_16x16x32_bf16 v[164:167], v[48:51], v[96:99], v[164:167]
  v_mfma_f32_16x16x32_bf16 v[164:167], v[52:55], v[100:103], v[164:167]
  v_mfma_f32_16x16x32_bf16 v[160:163], v[48:51], v[88:91], v[160:163]
  v_mfma_f32_16x16x32_bf16 v[160:163], v[52:55], v[92:95], v[160:163]
  v_mfma_f32_16x16x32_bf16 v[156:159], v[48:51], v[80:83], v[156:159]
  v_mfma_f32_16x16x32_bf16 v[156:159], v[52:55], v[84:87], v[156:159]
  v_mfma_f32_16x16x32_bf16 v[172:175], v[56:59], v[80:83], v[172:175]
  v_mfma_f32_16x16x32_bf16 v[172:175], v[60:63], v[84:87], v[172:175]
  v_mfma_f32_16x16x32_bf16 v[176:179], v[56:59], v[88:91], v[176:179]
  v_mfma_f32_16x16x32_bf16 v[176:179], v[60:63], v[92:95], v[176:179]
  s_cmp_lt_u32 s72, 4
  v_mfma_f32_16x16x32_bf16 v[180:183], v[56:59], v[96:99], v[180:183]
  v_mfma_f32_16x16x32_bf16 v[180:183], v[60:63], v[100:103], v[180:183]
  v_mfma_f32_16x16x32_bf16 v[184:187], v[56:59], v[104:107], v[184:187]
  v_mfma_f32_16x16x32_bf16 v[184:187], v[60:63], v[108:111], v[184:187]
  v_mfma_f32_16x16x32_bf16 v[200:203], v[64:67], v[104:107], v[200:203]
  v_mfma_f32_16x16x32_bf16 v[200:203], v[68:71], v[108:111], v[200:203]
  v_mfma_f32_16x16x32_bf16 v[196:199], v[64:67], v[96:99], v[196:199]
  v_mfma_f32_16x16x32_bf16 v[196:199], v[68:71], v[100:103], v[196:199]
  v_mfma_f32_16x16x32_bf16 v[192:195], v[64:67], v[88:91], v[192:195]
  v_mfma_f32_16x16x32_bf16 v[192:195], v[68:71], v[92:95], v[192:195]
  v_mfma_f32_16x16x32_bf16 v[188:191], v[64:67], v[80:83], v[188:191]
  v_mfma_f32_16x16x32_bf16 v[188:191], v[68:71], v[84:87], v[188:191]
  v_mfma_f32_16x16x32_bf16 v[204:207], v[72:75], v[80:83], v[204:207]
  v_mfma_f32_16x16x32_bf16 v[204:207], v[76:79], v[84:87], v[204:207]
  v_mfma_f32_16x16x32_bf16 v[208:211], v[72:75], v[88:91], v[208:211]
  v_mfma_f32_16x16x32_bf16 v[208:211], v[76:79], v[92:95], v[208:211]
  v_mfma_f32_16x16x32_bf16 v[212:215], v[72:75], v[96:99], v[212:215]
  v_mfma_f32_16x16x32_bf16 v[212:215], v[76:79], v[100:103], v[212:215]
  v_mfma_f32_16x16x32_bf16 v[216:219], v[72:75], v[104:107], v[216:219]
  s_setprio 2
  s_barrier
  v_mfma_f32_16x16x32_bf16 v[216:219], v[76:79], v[108:111], v[216:219]
  s_cbranch_scc1 L_dnn_loop0
  ds_read_b64_tr_b16 v[40:41], v1 offset:0
  v_lshl_add_u32 v34, v20, 7, v15
  v_lshl_add_u32 v28, v16, 7, v14
  s_add_u32 m0, s76, 8192
  s_nop 0
  buffer_load_dwordx4 v28, s[32:35], 0 offen lds
  ds_read_b64_tr_b16 v[42:43], v1 offset:2560
  ds_read_b64_tr_b16 v[44:45], v1 offset:20480
  ds_read_b64_tr_b16 v[46:47], v1 offset:23040
  ds_read_b64_tr_b16 v[48:49], v2 offset:0
  ds_read_b64_tr_b16 v[50:51], v2 offset:2560
  ds_read_b64_tr_b16 v[52:53], v2 offset:20480
  ds_read_b64_tr_b16 v[54:55], v2 offset:23040
  ds_read_b64_tr_b16 v[56:57], v3 offset:0
  ds_read_b64_tr_b16 v[58:59], v3 offset:2560
  ds_read_b64_tr_b16 v[60:61], v3 offset:20480
  ds_read_b64_tr_b16 v[62:63], v3 offset:23040
  ds_read_b64_tr_b16 v[64:65], v4 offset:0
  ds_read_b64_tr_b16 v[66:67], v4 offset:2560
  ds_read_b64_tr_b16 v[68:69], v4 offset:20480
  ds_read_b64_tr_b16 v[70:71], v4 offset:23040
  ds_read_b128 v[80:83], v11 offset:0
  s_add_u32 m0, m0, 1024
  s_nop 0
  buffer_load_dwordx4 v34, s[32:35], 0 offen lds
  ds_read_b128 v[84:87], v12 offset:0
  ds_read_b128 v[88:91], v11 offset:2048
  ds_read_b128 v[92:95], v12 offset:2048
  ds_read_b128 v[96:99], v11 offset:4096
  ds_read_b128 v[100:103], v12 offset:4096
  ds_read_b128 v[104:107], v11 offset:6144
  ds_read_b128 v[108:111], v12 offset:6144
  ds_read_b64_tr_b16 v[72:73], v5 offset:0
  ds_read_b64_tr_b16 v[74:75], v5 offset:2560
  ds_read_b64_tr_b16 v[76:77], v5 offset:20480
  ds_read_b64_tr_b16 v[78:79], v5 offset:23040
  ds_read_b64 v[220:221], v35 offset:640
  ds_read_b64 v[222:223], v35 offset:672
  ds_read_b64 v[224:225], v35 offset:704
  ds_read_b64 v[226:227], v35 offset:736
  ds_read_b64 v[228:229], v35 offset:768
  s_mov_b32 s60, s24
  s_and_b32 s61, s25, 0xffff
  s_mov_b32 s62, 268435456
  s_mov_b32 s63, 0x20000
  s_mov_b32 s64, s22
  s_and_b32 s65, s23, 0xffff
  s_mov_b32 s66, 256
  s_mov_b32 s67, 0x20000
  v_lshlrev_b32 v28, 2, v0
  s_mov_b64 exec, 0xff
  s_mov_b32 s81, 0x80000
  buffer_load_dword v255, v28, s[60:63], s81 offen
  buffer_load_dword v37, v28, s[64:67], 0 offen offset:128 sc1
  s_mov_b64 exec, -1
  v_mov_b32 v28, 0
  s_waitcnt vmcnt(6) lgkmcnt(0)
  s_barrier
  s_setprio 0
  v_mfma_f32_16x16x32_bf16 v[140:143], v[40:43], v[80:83], v[140:143]
  v_mov_b32 v232, 0xc0135761
  v_mov_b32 v233, 0xc0135761
  v_mfma_f32_16x16x32_bf16 v[140:143], v[44:47], v[84:87], v[140:143]
  v_mov_b32 v234, 0xbdd2d3e8
  v_mfma_f32_16x16x32_bf16 v[144:147], v[40:43], v[88:91], v[144:147]
  v_mov_b32 v235, 0xbdd2d3e8
  v_mfma_f32_16x16x32_bf16 v[144:147], v[44:47], v[92:95], v[144:147]
  v_mov_b32 v236, 0x71800000
  v_mfma_f32_16x16x32_bf16 v[148:151], v[40:43], v[96:99], v[148:151]
  v_lshlrev_b32 v112, 16, v220
  v_mfma_f32_16x16x32_bf16 v[148:151], v[44:47], v[100:103], v[148:151]
  v_and_b32 v113, 0xffff0000, v220
  v_mfma_f32_16x16x32_bf16 v[152:155], v[40:43], v[104:107], v[152:155]
  v_lshlrev_b32 v114, 16, v221
  v_mfma_f32_16x16x32_bf16 v[152:155], v[44:47], v[108:111], v[152:155]
  v_and_b32 v115, 0xffff0000, v221
  v_mfma_f32_16x16x32_bf16 v[168:171], v[48:51], v[104:107], v[168:171]
  v_lshlrev_b32 v116, 16, v222
  v_mfma_f32_16x16x32_bf16 v[168:171], v[52:55], v[108:111], v[168:171]
  v_and_b32 v117, 0xffff0000, v222
  v_mfma_f32_16x16x32_bf16 v[164:167], v[48:51], v[96:99], v[164:167]
  v_lshlrev_b32 v118, 16, v223
  v_mfma_f32_16x16x32_bf16 v[164:167], v[52:55], v[100:103], v[164:167]
  v_and_b32 v119, 0xffff0000, v223
  v_mfma_f32_16x16x32_bf16 v[160:163], v[48:51], v[88:91], v[160:163]
  v_lshlrev_b32 v120, 16, v224
  v_mfma_f32_16x16x32_bf16 v[160:163], v[52:55], v[92:95], v[160:163]
  v_and_b32 v121, 0xffff0000, v224
  v_mfma_f32_16x16x32_bf16 v[156:159], v[48:51], v[80:83], v[156:159]
  v_lshlrev_b32 v122, 16, v225
  v_mfma_f32_16x16x32_bf16 v[156:159], v[52:55], v[84:87], v[156:159]
  v_and_b32 v123, 0xffff0000, v225
  v_mfma_f32_16x16x32_bf16 v[172:175], v[56:59], v[80:83], v[172:175]
  v_lshlrev_b32 v124, 16, v226
  v_mfma_f32_16x16x32_bf16 v[172:175], v[60:63], v[84:87], v[172:175]
  v_and_b32 v125, 0xffff0000, v226
  v_mfma_f32_16x16x32_bf16 v[176:179], v[56:59], v[88:91], v[176:179]
  v_lshlrev_b32 v126, 16, v227
  v_mfma_f32_16x16x32_bf16 v[176:179], v[60:63], v[92:95], v[176:179]
  v_and_b32 v127, 0xffff0000, v227
  v_mfma_f32_16x16x32_bf16 v[180:183], v[56:59], v[96:99], v[180:183]
  v_lshlrev_b32 v128, 16, v228
  v_mfma_f32_16x16x32_bf16 v[180:183], v[60:63], v[100:103], v[180:183]
  v_and_b32 v129, 0xffff0000, v228
  v_mfma_f32_16x16x32_bf16 v[184:187], v[56:59], v[104:107], v[184:187]
  v_lshlrev_b32 v130, 16, v229
  v_mfma_f32_16x16x32_bf16 v[184:187], v[60:63], v[108:111], v[184:187]
  v_and_b32 v131, 0xffff0000, v229
  v_mfma_f32_16x16x32_bf16 v[200:203], v[64:67], v[104:107], v[200:203]
  v_rcp_f32 v112, v112
  v_mfma_f32_16x16x32_bf16 v[200:203], v[68:71], v[108:111], v[200:203]
  v_rcp_f32 v113, v113
  v_mfma_f32_16x16x32_bf16 v[196:199], v[64:67], v[96:99], v[196:199]
  v_rcp_f32 v114, v114
  v_mfma_f32_16x16x32_bf16 v[196:199], v[68:71], v[100:103], v[196:199]
  v_rcp_f32 v115, v115
  v_mfma_f32_16x16x32_bf16 v[192:195], v[64:67], v[88:91], v[192:195]
  v_rcp_f32 v116, v116
  v_mfma_f32_16x16x32_bf16 v[192:195], v[68:71], v[92:95], v[192:195]
  v_rcp_f32 v117, v117
  v_mfma_f32_16x16x32_bf16 v[188:191], v[64:67], v[80:83], v[188:191]
  v_rcp_f32 v118, v118
  v_mfma_f32_16x16x32_bf16 v[188:191], v[68:71], v[84:87], v[188:191]
  v_rcp_f32 v119, v119
  v_mfma_f32_16x16x32_bf16 v[204:207], v[72:75], v[80:83], v[204:207]
  v_rcp_f32 v120, v120
  v_mfma_f32_16x16x32_bf16 v[204:207], v[76:79], v[84:87], v[204:207]
  v_rcp_f32 v121, v121
  v_mfma_f32_16x16x32_bf16 v[208:211], v[72:75], v[88:91], v[208:211]
  v_rcp_f32 v122, v122
  v_mfma_f32_16x16x32_bf16 v[208:211], v[76:79], v[92:95], v[208:211]
  v_rcp_f32 v123, v123
  v_mfma_f32_16x16x32_bf16 v[212:215], v[72:75], v[96:99], v[212:215]
  v_rcp_f32 v124, v124
  v_mfma_f32_16x16x32_bf16 v[212:215], v[76:79], v[100:103], v[212:215]
  v_rcp_f32 v125, v125
  v_mfma_f32_16x16x32_bf16 v[216:219], v[72:75], v[104:107], v[216:219]
  s_setprio 2
  s_barrier
  v_mfma_f32_16x16x32_bf16 v[216:219], v[76:79], v[108:111], v[216:219]
  ds_read_b64_tr_b16 v[40:41], v1 offset:40960
  ds_read_b64_tr_b16 v[42:43], v1 offset:43520
  ds_read_b64_tr_b16 v[44:45], v6 offset:0
  ds_read_b64_tr_b16 v[46:47], v6 offset:2560
  ds_read_b64_tr_b16 v[48:49], v2 offset:40960
  ds_read_b64_tr_b16 v[50:51], v2 offset:43520
  ds_read_b64_tr_b16 v[52:53], v7 offset:0
  ds_read_b64_tr_b16 v[54:55], v7 offset:2560
  ds_read_b64_tr_b16 v[56:57], v3 offset:40960
  ds_read_b64_tr_b16 v[58:59], v3 offset:43520
  ds_read_b64_tr_b16 v[60:61], v8 offset:0
  ds_read_b64_tr_b16 v[62:63], v8 offset:2560
  ds_read_b64_tr_b16 v[64:65], v4 offset:40960
  ds_read_b64_tr_b16 v[66:67], v4 offset:43520
  ds_read_b64_tr_b16 v[68:69], v9 offset:0
  ds_read_b64_tr_b16 v[70:71], v9 offset:2560
  ds_read_b128 v[80:83], v11 offset:8192
  ds_read_b128 v[84:87], v12 offset:8192
  ds_read_b128 v[88:91], v11 offset:10240
  ds_read_b128 v[92:95], v12 offset:10240
  ds_read_b128 v[96:99], v11 offset:12288
  ds_read_b128 v[100:103], v12 offset:12288
  ds_read_b128 v[104:107], v11 offset:14336
  ds_read_b128 v[108:111], v12 offset:14336
  ds_read_b64_tr_b16 v[72:73], v5 offset:40960
  ds_read_b64_tr_b16 v[74:75], v5 offset:43520
  ds_read_b64_tr_b16 v[76:77], v10 offset:0
  ds_read_b64_tr_b16 v[78:79], v10 offset:2560
  s_waitcnt vmcnt(2) lgkmcnt(0)
  s_barrier
  s_setprio 0
  v_mfma_f32_16x16x32_bf16 v[140:143], v[40:43], v[80:83], v[140:143]
  v_rcp_f32 v126, v126
  v_mfma_f32_16x16x32_bf16 v[140:143], v[44:47], v[84:87], v[140:143]
  v_rcp_f32 v127, v127
  v_mfma_f32_16x16x32_bf16 v[144:147], v[40:43], v[88:91], v[144:147]
  v_rcp_f32 v128, v128
  v_mfma_f32_16x16x32_bf16 v[144:147], v[44:47], v[92:95], v[144:147]
  v_mfma_f32_16x16x32_bf16 v[148:151], v[40:43], v[96:99], v[148:151]
  v_rcp_f32 v129, v129
  v_mfma_f32_16x16x32_bf16 v[148:151], v[44:47], v[100:103], v[148:151]
  v_rcp_f32 v130, v130
  v_mfma_f32_16x16x32_bf16 v[152:155], v[40:43], v[104:107], v[152:155]
  v_mfma_f32_16x16x32_bf16 v[152:155], v[44:47], v[108:111], v[152:155]
  v_rcp_f32 v131, v131
  v_mfma_f32_16x16x32_bf16 v[168:171], v[48:51], v[104:107], v[168:171]
  v_med3_f32 v112, v112, -v236, v236
  v_mfma_f32_16x16x32_bf16 v[168:171], v[52:55], v[108:111], v[168:171]
  v_mfma_f32_16x16x32_bf16 v[164:167], v[48:51], v[96:99], v[164:167]
  v_med3_f32 v113, v113, -v236, v236
  v_mfma_f32_16x16x32_bf16 v[164:167], v[52:55], v[100:103], v[164:167]
  v_med3_f32 v114, v114, -v236, v236
  v_mfma_f32_16x16x32_bf16 v[160:163], v[48:51], v[88:91], v[160:163]
  v_mfma_f32_16x16x32_bf16 v[160:163], v[52:55], v[92:95], v[160:163]
  v_med3_f32 v115, v115, -v236, v236
  v_mfma_f32_16x16x32_bf16 v[156:159], v[48:51], v[80:83], v[156:159]
  v_med3_f32 v116, v116, -v236, v236
  v_mfma_f32_16x16x32_bf16 v[156:159], v[52:55], v[84:87], v[156:159]
  v_mfma_f32_16x16x32_bf16 v[172:175], v[56:59], v[80:83], v[172:175]
  v_med3_f32 v117, v117, -v236, v236
  v_mfma_f32_16x16x32_bf16 v[172:175], v[60:63], v[84:87], v[172:175]
  v_med3_f32 v118, v118, -v236, v236
  v_mfma_f32_16x16x32_bf16 v[176:179], v[56:59], v[88:91], v[176:179]
  v_mfma_f32_16x16x32_bf16 v[176:179], v[60:63], v[92:95], v[176:179]
  v_med3_f32 v119, v119, -v236, v236
  v_mfma_f32_16x16x32_bf16 v[180:183], v[56:59], v[96:99], v[180:183]
  v_med3_f32 v120, v120, -v236, v236
  v_mfma_f32_16x16x32_bf16 v[180:183], v[60:63], v[100:103], v[180:183]
  v_med3_f32 v121, v121, -v236, v236
  v_mfma_f32_16x16x32_bf16 v[184:187], v[56:59], v[104:107], v[184:187]
  v_mfma_f32_16x16x32_bf16 v[184:187], v[60:63], v[108:111], v[184:187]
  v_med3_f32 v122, v122, -v236, v236
  v_mfma_f32_16x16x32_bf16 v[200:203], v[64:67], v[104:107], v[200:203]
  v_med3_f32 v123, v123, -v236, v236
  v_mfma_f32_16x16x32_bf16 v[200:203], v[68:71], v[108:111], v[200:203]
  v_mfma_f32_16x16x32_bf16 v[196:199], v[64:67], v[96:99], v[196:199]
  v_med3_f32 v124, v124, -v236, v236
  v_mfma_f32_16x16x32_bf16 v[196:199], v[68:71], v[100:103], v[196:199]
  v_med3_f32 v125, v125, -v236, v236
  v_mfma_f32_16x16x32_bf16 v[192:195], v[64:67], v[88:91], v[192:195]
  v_mfma_f32_16x16x32_bf16 v[192:195], v[68:71], v[92:95], v[192:195]
  v_med3_f32 v126, v126, -v236, v236
  v_mfma_f32_16x16x32_bf16 v[188:191], v[64:67], v[80:83], v[188:191]
  v_med3_f32 v127, v127, -v236, v236
  v_mfma_f32_16x16x32_bf16 v[188:191], v[68:71], v[84:87], v[188:191]
  v_mfma_f32_16x16x32_bf16 v[204:207], v[72:75], v[80:83], v[204:207]
  v_med3_f32 v128, v128, -v236, v236
  v_mfma_f32_16x16x32_bf16 v[204:207], v[76:79], v[84:87], v[204:207]
  v_med3_f32 v129, v129, -v236, v236
  v_mfma_f32_16x16x32_bf16 v[208:211], v[72:75], v[88:91], v[208:211]
  v_mfma_f32_16x16x32_bf16 v[208:211], v[76:79], v[92:95], v[208:211]
  v_med3_f32 v130, v130, -v236, v236
  v_mfma_f32_16x16x32_bf16 v[212:215], v[72:75], v[96:99], v[212:215]
  v_med3_f32 v131, v131, -v236, v236
  v_mfma_f32_16x16x32_bf16 v[212:215], v[76:79], v[100:103], v[212:215]
  v_mfma_f32_16x16x32_bf16 v[216:219], v[72:75], v[104:107], v[216:219]
  s_setprio 2
  s_barrier
  v_mfma_f32_16x16x32_bf16 v[216:219], v[76:79], v[108:111], v[216:219]
  s_setprio 0
  s_branch L_epi
L_dnn_h1:
  v_lshl_add_u32 v34, v117, 7, v15
  v_lshl_add_u32 v28, v113, 7, v14
  s_add_u32 m0, s76, 8192
  s_nop 0
  buffer_load_dwordx4 v28, s[32:35], 0 offen lds
  s_add_u32 m0, m0, 1024
  s_nop 0
  buffer_load_dwordx4 v34, s[32:35], 0 offen lds
  s_add_u32 m0, s75, 40960
  s_nop 0
  buffer_load_dwordx4 v29, s[44:47], s74 offen offset:0 lds
  buffer_load_dwordx4 v30, s[44:47], s74 offen offset:1024 lds
  buffer_load_dwordx4 v31, s[44:47], s74 offen offset:2048 lds
  buffer_load_dwordx4 v32, s[44:47], s74 offen offset:3072 lds
  s_add_u32 m0, m0, 4096
  s_nop 0
  buffer_load_dwordx4 v33, s[44:47], s74 offen offset:0 lds
  s_add_u32 s74, s74, 212992
  s_waitcnt vmcnt(9) lgkmcnt(0)
  s_barrier
  buffer_load_dwordx3 v[24:26], v13, s[28:31], s73 offen offset:0
  buffer_load_dwordx3 v[240:242], v13, s[28:31], s73 offen offset:832
  s_add_u32 s73, s73, 12
  s_barrier
L_dnn_loop1:
  ds_read_b64_tr_b16 v[40:41], v1 offset:0
  s_add_u32 m0, s75, 81920
  s_nop 0
  buffer_load_dwordx4 v29, s[44:47], s74 offen offset:0 lds
  ds_read_b64_tr_b16 v[42:43], v1 offset:2560
  ds_read_b64_tr_b16 v[44:45], v1 offset:20480
  ds_read_b64_tr_b16 v[46:47], v1 offset:23040
  ds_read_b64_tr_b16 v[48:49], v2 offset:0
  buffer_load_dwordx4 v30, s[44:47], s74 offen offset:1024 lds
  ds_read_b64_tr_b16 v[50:51], v2 offset:2560
  ds_read_b64_tr_b16 v[52:53], v2 offset:20480
  ds_read_b64_tr_b16 v[54:55], v2 offset:23040
  ds_read_b64_tr_b16 v[56:57], v3 offset:0
  buffer_load_dwordx4 v31, s[44:47], s74 offen offset:2048 lds
  ds_read_b64_tr_b16 v[58:59], v3 offset:2560
  ds_read_b64_tr_b16 v[60:61], v3 offset:20480
  ds_read_b64_tr_b16 v[62:63], v3 offset:23040
  ds_read_b64_tr_b16 v[64:65], v4 offset:0
  buffer_load_dwordx4 v32, s[44:47], s74 offen offset:3072 lds
  ds_read_b64_tr_b16 v[66:67], v4 offset:2560
  ds_read_b64_tr_b16 v[68:69], v4 offset:20480
  ds_read_b64_tr_b16 v[70:71], v4 offset:23040
  ds_read_b128 v[80:83], v11 offset:0
  s_add_u32 m0, m0, 4096
  s_nop 0
  buffer_load_dwordx4 v33, s[44:47], s74 offen offset:0 lds
  s_add_u32 s74, s74, 212992
  ds_read_b128 v[84:87], v12 offset:0
  ds_read_b128 v[88:91], v11 offset:2048
  ds_read_b128 v[92:95], v12 offset:2048
  ds_read_b128 v[96:99], v11 offset:4096
  s_waitcnt vmcnt(14)
  v_lshl_add_u32 v34, v20, 7, v15
  v_lshl_add_u32 v28, v16, 7, v14
  s_add_u32 m0, s76, 0
  s_nop 0
  buffer_load_dwordx4 v28, s[32:35], 0 offen lds
  ds_read_b128 v[100:103], v12 offset:4096
  ds_read_b128 v[104:107], v11 offset:6144
  ds_read_b128 v[108:111], v12 offset:6144
  ds_read_b64_tr_b16 v[72:73], v5 offset:0
  s_add_u32 m0, m0, 1024
  s_nop 0
  buffer_load_dwordx4 v34, s[32:35], 0 offen lds
  ds_read_b64_tr_b16 v[74:75], v5 offset:2560
  ds_read_b64_tr_b16 v[76:77], v5 offset:20480
  ds_read_b64_tr_b16 v[78:79], v5 offset:23040
  s_waitcnt vmcnt(9) lgkmcnt(0)
  s_waitcnt vmcnt(9)
  s_barrier
  s_setprio 0
  v_mfma_f32_16x16x32_bf16 v[140:143], v[40:43], v[80:83], v[140:143]
  v_mfma_f32_16x16x32_bf16 v[140:143], v[44:47], v[84:87], v[140:143]
  v_mfma_f32_16x16x32_bf16 v[144:147], v[40:43], v[88:91], v[144:147]
  v_mfma_f32_16x16x32_bf16 v[144:147], v[44:47], v[92:95], v[144:147]
  v_mfma_f32_16x16x32_bf16 v[148:151], v[40:43], v[96:99], v[148:151]
  v_mfma_f32_16x16x32_bf16 v[148:151], v[44:47], v[100:103], v[148:151]
  v_mfma_f32_16x16x32_bf16 v[152:155], v[40:43], v[104:107], v[152:155]
  v_mfma_f32_16x16x32_bf16 v[152:155], v[44:47], v[108:111], v[152:155]
  v_mfma_f32_16x16x32_bf16 v[168:171], v[48:51], v[104:107], v[168:171]
  v_mfma_f32_16x16x32_bf16 v[168:171], v[52:55], v[108:111], v[168:171]
  v_mfma_f32_16x16x32_bf16 v[164:167], v[48:51], v[96:99], v[164:167]
  v_mfma_f32_16x16x32_bf16 v[164:167], v[52:55], v[100:103], v[164:167]
  v_mfma_f32_16x16x32_bf16 v[160:163], v[48:51], v[88:91], v[160:163]
  v_mfma_f32_16x16x32_bf16 v[160:163], v[52:55], v[92:95], v[160:163]
  v_mfma_f32_16x16x32_bf16 v[156:159], v[48:51], v[80:83], v[156:159]
  v_mfma_f32_16x16x32_bf16 v[156:159], v[52:55], v[84:87], v[156:159]
  v_mfma_f32_16x16x32_bf16 v[172:175], v[56:59], v[80:83], v[172:175]
  v_mfma_f32_16x16x32_bf16 v[172:175], v[60:63], v[84:87], v[172:175]
  v_mfma_f32_16x16x32_bf16 v[176:179], v[56:59], v[88:91], v[176:179]
  v_mfma_f32_16x16x32_bf16 v[176:179], v[60:63], v[92:95], v[176:179]
  v_mfma_f32_16x16x32_bf16 v[180:183], v[56:59], v[96:99], v[180:183]
  v_mfma_f32_16x16x32_bf16 v[180:183], v[60:63], v[100:103], v[180:183]
  v_mfma_f32_16x16x32_bf16 v[184:187], v[56:59], v[104:107], v[184:187]
  v_mfma_f32_16x16x32_bf16 v[184:187], v[60:63], v[108:111], v[184:187]
  v_mfma_f32_16x16x32_bf16 v[200:203], v[64:67], v[104:107], v[200:203]
  v_mfma_f32_16x16x32_bf16 v[200:203], v[68:71], v[108:111], v[200:203]
  v_mfma_f32_16x16x32_bf16 v[196:199], v[64:67], v[96:99], v[196:199]
  v_mfma_f32_16x16x32_bf16 v[196:199], v[68:71], v[100:103], v[196:199]
  v_mfma_f32_16x16x32_bf16 v[192:195], v[64:67], v[88:91], v[192:195]
  v_mfma_f32_16x16x32_bf16 v[192:195], v[68:71], v[92:95], v[192:195]
  v_mfma_f32_16x16x32_bf16 v[188:191], v[64:67], v[80:83], v[188:191]
  v_mfma_f32_16x16x32_bf16 v[188:191], v[68:71], v[84:87], v[188:191]
  v_mfma_f32_16x16x32_bf16 v[204:207], v[72:75], v[80:83], v[204:207]
  v_mfma_f32_16x16x32_bf16 v[204:207], v[76:79], v[84:87], v[204:207]
  v_mfma_f32_16x16x32_bf16 v[208:211], v[72:75], v[88:91], v[208:211]
  v_mfma_f32_16x16x32_bf16 v[208:211], v[76:79], v[92:95], v[208:211]
  v_mfma_f32_16x16x32_bf16 v[212:215], v[72:75], v[96:99], v[212:215]
  v_mfma_f32_16x16x32_bf16 v[212:215], v[76:79], v[100:103], v[212:215]
  v_mfma_f32_16x16x32_bf16 v[216:219], v[72:75], v[104:107], v[216:219]
  s_setprio 2
  s_barrier
  v_mfma_f32_16x16x32_bf16 v[216:219], v[76:79], v[108:111], v[216:219]
  ds_read_b64_tr_b16 v[40:41], v1 offset:40960
  s_add_u32 m0, s75, 0
  s_nop 0
  buffer_load_dwordx4 v29, s[44:47], s74 offen offset:0 lds
  ds_read_b64_tr_b16 v[42:43], v1 offset:43520
  ds_read_b64_tr_b16 v[44:45], v6 offset:0
  ds_read_b64_tr_b16 v[46:47], v6 offset:2560
  ds_read_b64_tr_b16 v[48:49], v2 offset:40960
  buffer_load_dwordx4 v30, s[44:47], s74 offen offset:1024 lds
  ds_read_b64_tr_b16 v[50:51], v2 offset:43520
  ds_read_b64_tr_b16 v[52:53], v7 offset:0
  ds_read_b64_tr_b16 v[54:55], v7 offset:2560
  ds_read_b64_tr_b16 v[56:57], v3 offset:40960
  buffer_load_dwordx4 v31, s[44:47], s74 offen offset:2048 lds
  ds_read_b64_tr_b16 v[58:59], v3 offset:43520
  ds_read_b64_tr_b16 v[60:61], v8 offset:0
  ds_read_b64_tr_b16 v[62:63], v8 offset:2560
  ds_read_b64_tr_b16 v[64:65], v4 offset:40960
  buffer_load_dwordx4 v32, s[44:47], s74 offen offset:3072 lds
  ds_read_b64_tr_b16 v[66:67], v4 offset:43520
  ds_read_b64_tr_b16 v[68:69], v9 offset:0
  ds_read_b64_tr_b16 v[70:71], v9 offset:2560
  ds_read_b128 v[80:83], v11 offset:8192
  s_add_u32 m0, m0, 4096
  s_nop 0
  buffer_load_dwordx4 v33, s[44:47], s74 offen offset:0 lds
  s_add_u32 s74, s74, 212992
  ds_read_b128 v[84:87], v12 offset:8192
  ds_read_b128 v[88:91], v11 offset:10240
  ds_read_b128 v[92:95], v12 offset:10240
  ds_read_b128 v[96:99], v11 offset:12288
  v_lshl_add_u32 v34, v21, 7, v15
  v_lshl_add_u32 v28, v17, 7, v14
  s_add_u32 m0, s76, 8192
  s_nop 0
  buffer_load_dwordx4 v28, s[32:35], 0 offen lds
  ds_read_b128 v[100:103], v12 offset:12288
  ds_read_b128 v[104:107], v11 offset:14336
  ds_read_b128 v[108:111], v12 offset:14336
  ds_read_b64_tr_b16 v[72:73], v5 offset:40960
  s_add_u32 m0, m0, 1024
  s_nop 0
  buffer_load_dwordx4 v34, s[32:35], 0 offen lds
  ds_read_b64_tr_b16 v[74:75], v5 offset:43520
  ds_read_b64_tr_b16 v[76:77], v10 offset:0
  ds_read_b64_tr_b16 v[78:79], v10 offset:2560
  s_waitcnt vmcnt(7) lgkmcnt(0)
  s_barrier
  s_setprio 0
  v_mfma_f32_16x16x32_bf16 v[140:143], v[40:43], v[80:83], v[140:143]
  v_mfma_f32_16x16x32_bf16 v[140:143], v[44:47], v[84:87], v[140:143]
  v_mfma_f32_16x16x32_bf16 v[144:147], v[40:43], v[88:91], v[144:147]
  v_mfma_f32_16x16x32_bf16 v[144:147], v[44:47], v[92:95], v[144:147]
  v_mfma_f32_16x16x32_bf16 v[148:151], v[40:43], v[96:99], v[148:151]
  v_mfma_f32_16x16x32_bf16 v[148:151], v[44:47], v[100:103], v[148:151]
  v_mfma_f32_16x16x32_bf16 v[152:155], v[40:43], v[104:107], v[152:155]
  v_mfma_f32_16x16x32_bf16 v[152:155], v[44:47], v[108:111], v[152:155]
  v_mfma_f32_16x16x32_bf16 v[168:171], v[48:51], v[104:107], v[168:171]
  v_mfma_f32_16x16x32_bf16 v[168:171], v[52:55], v[108:111], v[168:171]
  v_mfma_f32_16x16x32_bf16 v[164:167], v[48:51], v[96:99], v[164:167]
  v_mfma_f32_16x16x32_bf16 v[164:167], v[52:55], v[100:103], v[164:167]
  v_mfma_f32_16x16x32_bf16 v[160:163], v[48:51], v[88:91], v[160:163]
  v_mfma_f32_16x16x32_bf16 v[160:163], v[52:55], v[92:95], v[160:163]
  v_mfma_f32_16x16x32_bf16 v[156:159], v[48:51], v[80:83], v[156:159]
  v_mfma_f32_16x16x32_bf16 v[156:159], v[52:55], v[84:87], v[156:159]
  v_mfma_f32_16x16x32_bf16 v[172:175], v[56:59], v[80:83], v[172:175]
  v_mfma_f32_16x16x32_bf16 v[172:175], v[60:63], v[84:87], v[172:175]
  v_mfma_f32_16x16x32_bf16 v[176:179], v[56:59], v[88:91], v[176:179]
  v_mfma_f32_16x16x32_bf16 v[176:179], v[60:63], v[92:95], v[176:179]
  v_mfma_f32_16x16x32_bf16 v[180:183], v[56:59], v[96:99], v[180:183]
  v_mfma_f32_16x16x32_bf16 v[180:183], v[60:63], v[100:103], v[180:183]
  v_mfma_f32_16x16x32_bf16 v[184:187], v[56:59], v[104:107], v[184:187]
  v_mfma_f32_16x16x32_bf16 v[184:187], v[60:63], v[108:111], v[184:187]
  v_mfma_f32_16x16x32_bf16 v[200:203], v[64:67], v[104:107], v[200:203]
  v_mfma_f32_16x16x32_bf16 v[200:203], v[68:71], v[108:111], v[200:203]
  v_mfma_f32_16x16x32_bf16 v[196:199], v[64:67], v[96:99], v[196:199]
  v_mfma_f32_16x16x32_bf16 v[196:199], v[68:71], v[100:103], v[196:199]
  v_mfma_f32_16x16x32_bf16 v[192:195], v[64:67], v[88:91], v[192:195]
  v_mfma_f32_16x16x32_bf16 v[192:195], v[68:71], v[92:95], v[192:195]
  v_mfma_f32_16x16x32_bf16 v[188:191], v[64:67], v[80:83], v[188:191]
  v_mfma_f32_16x16x32_bf16 v[188:191], v[68:71], v[84:87], v[188:191]
  v_mfma_f32_16x16x32_bf16 v[204:207], v[72:75], v[80:83], v[204:207]
  v_mfma_f32_16x16x32_bf16 v[204:207], v[76:79], v[84:87], v[204:207]
  v_mfma_f32_16x16x32_bf16 v[208:211], v[72:75], v[88:91], v[208:211]
  v_mfma_f32_16x16x32_bf16 v[208:211], v[76:79], v[92:95], v[208:211]
  v_mfma_f32_16x16x32_bf16 v[212:215], v[72:75], v[96:99], v[212:215]
  v_mfma_f32_16x16x32_bf16 v[212:215], v[76:79], v[100:103], v[212:215]
  v_mfma_f32_16x16x32_bf16 v[216:219], v[72:75], v[104:107], v[216:219]
  s_setprio 2
  s_barrier
  v_mfma_f32_16x16x32_bf16 v[216:219], v[76:79], v[108:111], v[216:219]
  ds_read_b64_tr_b16 v[40:41], v6 offset:20480
  s_add_u32 m0, s75, 40960
  s_nop 0
  buffer_load_dwordx4 v29, s[44:47], s74 offen offset:0 lds
  ds_read_b64_tr_b16 v[42:43], v6 offset:23040
  ds_read_b64_tr_b16 v[44:45], v6 offset:40960
  ds_read_b64_tr_b16 v[46:47], v6 offset:43520
  ds_read_b64_tr_b16 v[48:49], v7 offset:20480
  buffer_load_dwordx4 v30, s[44:47], s74 offen offset:1024 lds
  ds_read_b64_tr_b16 v[50:51], v7 offset:23040
  ds_read_b64_tr_b16 v[52:53], v7 offset:40960
  ds_read_b64_tr_b16 v[54:55], v7 offset:43520
  ds_read_b64_tr_b16 v[56:57], v8 offset:20480
  buffer_load_dwordx4 v31, s[44:47], s74 offen offset:2048 lds
  ds_read_b64_tr_b16 v[58:59], v8 offset:23040
  ds_read_b64_tr_b16 v[60:61], v8 offset:40960
  ds_read_b64_tr_b16 v[62:63], v8 offset:43520
  ds_read_b64_tr_b16 v[64:65], v9 offset:20480
  buffer_load_dwordx4 v32, s[44:47], s74 offen offset:3072 lds
  ds_read_b64_tr_b16 v[66:67], v9 offset:23040
  ds_read_b64_tr_b16 v[68:69], v9 offset:40960
  ds_read_b64_tr_b16 v[70:71], v9 offset:43520
  ds_read_b128 v[80:83], v11 offset:0
  s_add_u32 m0, m0, 4096
  s_nop 0
  buffer_load_dwordx4 v33, s[44:47], s74 offen offset:0 lds
  s_add_u32 s74, s74, 212992
  ds_read_b128 v[84:87], v12 offset:0
  ds_read_b128 v[88:91], v11 offset:2048
  ds_read_b128 v[92:95], v12 offset:2048
  ds_read_b128 v[96:99], v11 offset:4096
  v_lshl_add_u32 v34, v22, 7, v15
  v_lshl_add_u32 v28, v18, 7, v14
  s_add_u32 m0, s76, 0
  s_nop 0
  buffer_load_dwordx4 v28, s[32:35], 0 offen lds
  ds_read_b128 v[100:103], v12 offset:4096
  ds_read_b128 v[104:107], v11 offset:6144
  ds_read_b128 v[108:111], v12 offset:6144
  ds_read_b64_tr_b16 v[72:73], v10 offset:20480
  s_add_u32 m0, m0, 1024
  s_nop 0
  buffer_load_dwordx4 v34, s[32:35], 0 offen lds
  ds_read_b64_tr_b16 v[74:75], v10 offset:23040
  ds_read_b64_tr_b16 v[76:77], v10 offset:40960
  ds_read_b64_tr_b16 v[78:79], v10 offset:43520
  buffer_load_dwordx3 v[16:18], v13, s[28:31], s73 offen offset:0
  buffer_load_dwordx3 v[20:22], v13, s[28:31], s73 offen offset:832
  s_add_u32 s73, s73, 12
  s_waitcnt vmcnt(9) lgkmcnt(0)
  s_barrier
  s_setprio 0
  v_mfma_f32_16x16x32_bf16 v[140:143], v[40:43], v[80:83], v[140:143]
  v_mfma_f32_16x16x32_bf16 v[140:143], v[44:47], v[84:87], v[140:143]
  v_mfma_f32_16x16x32_bf16 v[144:147], v[40:43], v[88:91], v[144:147]
  v_mfma_f32_16x16x32_bf16 v[144:147], v[44:47], v[92:95], v[144:147]
  v_mfma_f32_16x16x32_bf16 v[148:151], v[40:43], v[96:99], v[148:151]
  v_mfma_f32_16x16x32_bf16 v[148:151], v[44:47], v[100:103], v[148:151]
  v_mfma_f32_16x16x32_bf16 v[152:155], v[40:43], v[104:107], v[152:155]
  v_mfma_f32_16x16x32_bf16 v[152:155], v[44:47], v[108:111], v[152:155]
  v_mfma_f32_16x16x32_bf16 v[168:171], v[48:51], v[104:107], v[168:171]
  v_mfma_f32_16x16x32_bf16 v[168:171], v[52:55], v[108:111], v[168:171]
  v_mfma_f32_16x16x32_bf16 v[164:167], v[48:51], v[96:99], v[164:167]
  v_mfma_f32_16x16x32_bf16 v[164:167], v[52:55], v[100:103], v[164:167]
  v_mfma_f32_16x16x32_bf16 v[160:163], v[48:51], v[88:91], v[160:163]
  v_mfma_f32_16x16x32_bf16 v[160:163], v[52:55], v[92:95], v[160:163]
  v_mfma_f32_16x16x32_bf16 v[156:159], v[48:51], v[80:83], v[156:159]
  v_mfma_f32_16x16x32_bf16 v[156:159], v[52:55], v[84:87], v[156:159]
  v_mfma_f32_16x16x32_bf16 v[172:175], v[56:59], v[80:83], v[172:175]
  v_mfma_f32_16x16x32_bf16 v[172:175], v[60:63], v[84:87], v[172:175]
  v_mfma_f32_16x16x32_bf16 v[176:179], v[56:59], v[88:91], v[176:179]
  v_mfma_f32_16x16x32_bf16 v[176:179], v[60:63], v[92:95], v[176:179]
  v_mfma_f32_16x16x32_bf16 v[180:183], v[56:59], v[96:99], v[180:183]
  v_mfma_f32_16x16x32_bf16 v[180:183], v[60:63], v[100:103], v[180:183]
  v_mfma_f32_16x16x32_bf16 v[184:187], v[56:59], v[104:107], v[184:187]
  v_mfma_f32_16x16x32_bf16 v[184:187], v[60:63], v[108:111], v[184:187]
  v_mfma_f32_16x16x32_bf16 v[200:203], v[64:67], v[104:107], v[200:203]
  v_mfma_f32_16x16x32_bf16 v[200:203], v[68:71], v[108:111], v[200:203]
  v_mfma_f32_16x16x32_bf16 v[196:199], v[64:67], v[96:99], v[196:199]
  v_mfma_f32_16x16x32_bf16 v[196:199], v[68:71], v[100:103], v[196:199]
  v_mfma_f32_16x16x32_bf16 v[192:195], v[64:67], v[88:91], v[192:195]
  v_mfma_f32_16x16x32_bf16 v[192:195], v[68:71], v[92:95], v[192:195]
  v_mfma_f32_16x16x32_bf16 v[188:191], v[64:67], v[80:83], v[188:191]
  v_mfma_f32_16x16x32_bf16 v[188:191], v[68:71], v[84:87], v[188:191]
  v_mfma_f32_16x16x32_bf16 v[204:207], v[72:75], v[80:83], v[204:207]
  v_mfma_f32_16x16x32_bf16 v[204:207], v[76:79], v[84:87], v[204:207]
  v_mfma_f32_16x16x32_bf16 v[208:211], v[72:75], v[88:91], v[208:211]
  v_mfma_f32_16x16x32_bf16 v[208:211], v[76:79], v[92:95], v[208:211]
  v_mfma_f32_16x16x32_bf16 v[212:215], v[72:75], v[96:99], v[212:215]
  v_mfma_f32_16x16x32_bf16 v[212:215], v[76:79], v[100:103], v[212:215]
  v_mfma_f32_16x16x32_bf16 v[216:219], v[72:75], v[104:107], v[216:219]
  s_setprio 2
  s_barrier
  v_mfma_f32_16x16x32_bf16 v[216:219], v[76:79], v[108:111], v[216:219]
  ds_read_b64_tr_b16 v[40:41], v1 offset:0
  s_add_u32 m0, s75, 81920
  s_nop 0
  buffer_load_dwordx4 v29, s[44:47], s74 offen offset:0 lds
  ds_read_b64_tr_b16 v[42:43], v1 offset:2560
  ds_read_b64_tr_b16 v[44:45], v1 offset:20480
  ds_read_b64_tr_b16 v[46:47], v1 offset:23040
  ds_read_b64_tr_b16 v[48:49], v2 offset:0
  buffer_load_dwordx4 v30, s[44:47], s74 offen offset:1024 lds
  ds_read_b64_tr_b16 v[50:51], v2 offset:2560
  ds_read_b64_tr_b16 v[52:53], v2 offset:20480
  ds_read_b64_tr_b16 v[54:55], v2 offset:23040
  ds_read_b64_tr_b16 v[56:57], v3 offset:0
  buffer_load_dwordx4 v31, s[44:47], s74 offen offset:2048 lds
  ds_read_b64_tr_b16 v[58:59], v3 offset:2560
  ds_read_b64_tr_b16 v[60:61], v3 offset:20480
  ds_read_b64_tr_b16 v[62:63], v3 offset:23040
  ds_read_b64_tr_b16 v[64:65], v4 offset:0
  buffer_load_dwordx4 v32, s[44:47], s74 offen offset:3072 lds
  ds_read_b64_tr_b16 v[66:67], v4 offset:2560
  ds_read_b64_tr_b16 v[68:69], v4 offset:20480
  ds_read_b64_tr_b16 v[70:71], v4 offset:23040
  ds_read_b128 v[80:83], v11 offset:8192
  s_add_u32 m0, m0, 4096
  s_nop 0
  buffer_load_dwordx4 v33, s[44:47], s74 offen offset:0 lds
  s_add_u32 s74, s74, 212992
  ds_read_b128 v[84:87], v12 offset:8192
  ds_read_b128 v[88:91], v11 offset:10240
  ds_read_b128 v[92:95], v12 offset:10240
  ds_read_b128 v[96:99], v11 offset:12288
  v_lshl_add_u32 v34, v240, 7, v15
  v_lshl_add_u32 v28, v24, 7, v14
  s_add_u32 m0, s76, 8192
  s_nop 0
  buffer_load_dwordx4 v28, s[32:35], 0 offen lds
  ds_read_b128 v[100:103], v12 offset:12288
  ds_read_b128 v[104:107], v11 offset:14336
  ds_read_b128 v[108:111], v12 offset:14336
  ds_read_b64_tr_b16 v[72:73], v5 offset:0
  s_add_u32 m0, m0, 1024
  s_nop 0
  buffer_load_dwordx4 v34, s[32:35], 0 offen lds
  ds_read_b64_tr_b16 v[74:75], v5 offset:2560
  ds_read_b64_tr_b16 v[76:77], v5 offset:20480
  ds_read_b64_tr_b16 v[78:79], v5 offset:23040
  s_waitcnt vmcnt(9) lgkmcnt(0)
  s_barrier
  s_setprio 0
  v_mfma_f32_16x16x32_bf16 v[140:143], v[40:43], v[80:83], v[140:143]
  v_mfma_f32_16x16x32_bf16 v[140:143], v[44:47], v[84:87], v[140:143]
  v_mfma_f32_16x16x32_bf16 v[144:147], v[40:43], v[88:91], v[144:147]
  v_mfma_f32_16x16x32_bf16 v[144:147], v[44:47], v[92:95], v[144:147]
  v_mfma_f32_16x16x32_bf16 v[148:151], v[40:43], v[96:99], v[148:151]
  v_mfma_f32_16x16x32_bf16 v[148:151], v[44:47], v[100:103], v[148:151]
  v_mfma_f32_16x16x32_bf16 v[152:155], v[40:43], v[104:107], v[152:155]
  v_mfma_f32_16x16x32_bf16 v[152:155], v[44:47], v[108:111], v[152:155]
  v_mfma_f32_16x16x32_bf16 v[168:171], v[48:51], v[104:107], v[168:171]
  v_mfma_f32_16x16x32_bf16 v[168:171], v[52:55], v[108:111], v[168:171]
  v_mfma_f32_16x16x32_bf16 v[164:167], v[48:51], v[96:99], v[164:167]
  v_mfma_f32_16x16x32_bf16 v[164:167], v[52:55], v[100:103], v[164:167]
  v_mfma_f32_16x16x32_bf16 v[160:163], v[48:51], v[88:91], v[160:163]
  v_mfma_f32_16x16x32_bf16 v[160:163], v[52:55], v[92:95], v[160:163]
  v_mfma_f32_16x16x32_bf16 v[156:159], v[48:51], v[80:83], v[156:159]
  v_mfma_f32_16x16x32_bf16 v[156:159], v[52:55], v[84:87], v[156:159]
  v_mfma_f32_16x16x32_bf16 v[172:175], v[56:59], v[80:83], v[172:175]
  v_mfma_f32_16x16x32_bf16 v[172:175], v[60:63], v[84:87], v[172:175]
  v_mfma_f32_16x16x32_bf16 v[176:179], v[56:59], v[88:91], v[176:179]
  v_mfma_f32_16x16x32_bf16 v[176:179], v[60:63], v[92:95], v[176:179]
  v_mfma_f32_16x16x32_bf16 v[180:183], v[56:59], v[96:99], v[180:183]
  v_mfma_f32_16x16x32_bf16 v[180:183], v[60:63], v[100:103], v[180:183]
  v_mfma_f32_16x16x32_bf16 v[184:187], v[56:59], v[104:107], v[184:187]
  v_mfma_f32_16x16x32_bf16 v[184:187], v[60:63], v[108:111], v[184:187]
  v_mfma_f32_16x16x32_bf16 v[200:203], v[64:67], v[104:107], v[200:203]
  v_mfma_f32_16x16x32_bf16 v[200:203], v[68:71], v[108:111], v[200:203]
  v_mfma_f32_16x16x32_bf16 v[196:199], v[64:67], v[96:99], v[196:199]
  v_mfma_f32_16x16x32_bf16 v[196:199], v[68:71], v[100:103], v[196:199]
  v_mfma_f32_16x16x32_bf16 v[192:195], v[64:67], v[88:91], v[192:195]
  v_mfma_f32_16x16x32_bf16 v[192:195], v[68:71], v[92:95], v[192:195]
  v_mfma_f32_16x16x32_bf16 v[188:191], v[64:67], v[80:83], v[188:191]
  v_mfma_f32_16x16x32_bf16 v[188:191], v[68:71], v[84:87], v[188:191]
  v_mfma_f32_16x16x32_bf16 v[204:207], v[72:75], v[80:83], v[204:207]
  v_mfma_f32_16x16x32_bf16 v[204:207], v[76:79], v[84:87], v[204:207]
  v_mfma_f32_16x16x32_bf16 v[208:211], v[72:75], v[88:91], v[208:211]
  v_mfma_f32_16x16x32_bf16 v[208:211], v[76:79], v[92:95], v[208:211]
  v_mfma_f32_16x16x32_bf16 v[212:215], v[72:75], v[96:99], v[212:215]
  v_mfma_f32_16x16x32_bf16 v[212:215], v[76:79], v[100:103], v[212:215]
  v_mfma_f32_16x16x32_bf16 v[216:219], v[72:75], v[104:107], v[216:219]
  s_setprio 2
  s_barrier
  v_mfma_f32_16x16x32_bf16 v[216:219], v[76:79], v[108:111], v[216:219]
  ds_read_b64_tr_b16 v[40:41], v1 offset:40960
  s_add_u32 m0, s75, 0
  s_nop 0
  buffer_load_dwordx4 v29, s[44:47], s74 offen offset:0 lds
  ds_read_b64_tr_b16 v[42:43], v1 offset:43520
  ds_read_b64_tr_b16 v[44:45], v6 offset:0
  ds_read_b64_tr_b16 v[46:47], v6 offset:2560
  ds_read_b64_tr_b16 v[48:49], v2 offset:40960
  buffer_load_dwordx4 v30, s[44:47], s74 offen offset:1024 lds
  ds_read_b64_tr_b16 v[50:51], v2 offset:43520
  ds_read_b64_tr_b16 v[52:53], v7 offset:0
  ds_read_b64_tr_b16 v[54:55], v7 offset:2560
  ds_read_b64_tr_b16 v[56:57], v3 offset:40960
  buffer_load_dwordx4 v31, s[44:47], s74 offen offset:2048 lds
  ds_read_b64_tr_b16 v[58:59], v3 offset:43520
  ds_read_b64_tr_b16 v[60:61], v8 offset:0
  ds_read_b64_tr_b16 v[62:63], v8 offset:2560
  ds_read_b64_tr_b16 v[64:65], v4 offset:40960
  buffer_load_dwordx4 v32, s[44:47], s74 offen offset:3072 lds
  ds_read_b64_tr_b16 v[66:67], v4 offset:43520
  ds_read_b64_tr_b16 v[68:69], v9 offset:0
  ds_read_b64_tr_b16 v[70:71], v9 offset:2560
  ds_read_b128 v[80:83], v11 offset:0
  s_add_u32 m0, m0, 4096
  s_nop 0
  buffer_load_dwordx4 v33, s[44:47], s74 offen offset:0 lds
  s_add_u32 s74, s74, 212992
  ds_read_b128 v[84:87], v12 offset:0
  ds_read_b128 v[88:91], v11 offset:2048
  ds_read_b128 v[92:95], v12 offset:2048
  ds_read_b128 v[96:99], v11 offset:4096
  v_lshl_add_u32 v34, v241, 7, v15
  v_lshl_add_u32 v28, v25, 7, v14
  s_add_u32 m0, s76, 0
  s_nop 0
  buffer_load_dwordx4 v28, s[32:35], 0 offen lds
  ds_read_b128 v[100:103], v12 offset:4096
  ds_read_b128 v[104:107], v11 offset:6144
  ds_read_b128 v[108:111], v12 offset:6144
  ds_read_b64_tr_b16 v[72:73], v5 offset:40960
  s_add_u32 m0, m0, 1024
  s_nop 0
  buffer_load_dwordx4 v34, s[32:35], 0 offen lds
  ds_read_b64_tr_b16 v[74:75], v5 offset:43520
  ds_read_b64_tr_b16 v[76:77], v10 offset:0
  ds_read_b64_tr_b16 v[78:79], v10 offset:2560
  s_mov_b32 m0, 156288
  s_mov_b32 exec_hi, 0xff
  buffer_load_dwordx4 v37, s[52:55], s77 offen lds
  s_mov_b64 exec, -1
  s_waitcnt vmcnt(8) lgkmcnt(0)
  s_barrier
  s_setprio 0
  v_mfma_f32_16x16x32_bf16 v[140:143], v[40:43], v[80:83], v[140:143]
  v_mfma_f32_16x16x32_bf16 v[140:143], v[44:47], v[84:87], v[140:143]
  v_mfma_f32_16x16x32_bf16 v[144:147], v[40:43], v[88:91], v[144:147]
  v_mfma_f32_16x16x32_bf16 v[144:147], v[44:47], v[92:95], v[144:147]
  v_mfma_f32_16x16x32_bf16 v[148:151], v[40:43], v[96:99], v[148:151]
  v_mfma_f32_16x16x32_bf16 v[148:151], v[44:47], v[100:103], v[148:151]
  v_mfma_f32_16x16x32_bf16 v[152:155], v[40:43], v[104:107], v[152:155]
  v_mfma_f32_16x16x32_bf16 v[152:155], v[44:47], v[108:111], v[152:155]
  v_mfma_f32_16x16x32_bf16 v[168:171], v[48:51], v[104:107], v[168:171]
  v_mfma_f32_16x16x32_bf16 v[168:171], v[52:55], v[108:111], v[168:171]
  v_mfma_f32_16x16x32_bf16 v[164:167], v[48:51], v[96:99], v[164:167]
  v_mfma_f32_16x16x32_bf16 v[164:167], v[52:55], v[100:103], v[164:167]
  v_mfma_f32_16x16x32_bf16 v[160:163], v[48:51], v[88:91], v[160:163]
  v_mfma_f32_16x16x32_bf16 v[160:163], v[52:55], v[92:95], v[160:163]
  v_mfma_f32_16x16x32_bf16 v[156:159], v[48:51], v[80:83], v[156:159]
  v_mfma_f32_16x16x32_bf16 v[156:159], v[52:55], v[84:87], v[156:159]
  v_mfma_f32_16x16x32_bf16 v[172:175], v[56:59], v[80:83], v[172:175]
  v_mfma_f32_16x16x32_bf16 v[172:175], v[60:63], v[84:87], v[172:175]
  v_mfma_f32_16x16x32_bf16 v[176:179], v[56:59], v[88:91], v[176:179]
  v_mfma_f32_16x16x32_bf16 v[176:179], v[60:63], v[92:95], v[176:179]
  v_mfma_f32_16x16x32_bf16 v[180:183], v[56:59], v[96:99], v[180:183]
  v_mfma_f32_16x16x32_bf16 v[180:183], v[60:63], v[100:103], v[180:183]
  v_mfma_f32_16x16x32_bf16 v[184:187], v[56:59], v[104:107], v[184:187]
  v_mfma_f32_16x16x32_bf16 v[184:187], v[60:63], v[108:111], v[184:187]
  v_mfma_f32_16x16x32_bf16 v[200:203], v[64:67], v[104:107], v[200:203]
  v_mfma_f32_16x16x32_bf16 v[200:203], v[68:71], v[108:111], v[200:203]
  v_mfma_f32_16x16x32_bf16 v[196:199], v[64:67], v[96:99], v[196:199]
  v_mfma_f32_16x16x32_bf16 v[196:199], v[68:71], v[100:103], v[196:199]
  v_mfma_f32_16x16x32_bf16 v[192:195], v[64:67], v[88:91], v[192:195]
  v_mfma_f32_16x16x32_bf16 v[192:195], v[68:71], v[92:95], v[192:195]
  v_mfma_f32_16x16x32_bf16 v[188:191], v[64:67], v[80:83], v[188:191]
  v_mfma_f32_16x16x32_bf16 v[188:191], v[68:71], v[84:87], v[188:191]
  v_mfma_f32_16x16x32_bf16 v[204:207], v[72:75], v[80:83], v[204:207]
  v_mfma_f32_16x16x32_bf16 v[204:207], v[76:79], v[84:87], v[204:207]
  v_mfma_f32_16x16x32_bf16 v[208:211], v[72:75], v[88:91], v[208:211]
  v_mfma_f32_16x16x32_bf16 v[208:211], v[76:79], v[92:95], v[208:211]
  v_mfma_f32_16x16x32_bf16 v[212:215], v[72:75], v[96:99], v[212:215]
  v_mfma_f32_16x16x32_bf16 v[212:215], v[76:79], v[100:103], v[212:215]
  v_mfma_f32_16x16x32_bf16 v[216:219], v[72:75], v[104:107], v[216:219]
  s_setprio 2
  s_barrier
  v_mfma_f32_16x16x32_bf16 v[216:219], v[76:79], v[108:111], v[216:219]
  ds_read_b64_tr_b16 v[40:41], v6 offset:20480
  s_add_u32 m0, s75, 40960
  s_nop 0
  buffer_load_dwordx4 v29, s[44:47], s74 offen offset:0 lds
  ds_read_b64_tr_b16 v[42:43], v6 offset:23040
  ds_read_b64_tr_b16 v[44:45], v6 offset:40960
  ds_read_b64_tr_b16 v[46:47], v6 offset:43520
  ds_read_b64_tr_b16 v[48:49], v7 offset:20480
  buffer_load_dwordx4 v30, s[44:47], s74 offen offset:1024 lds
  ds_read_b64_tr_b16 v[50:51], v7 offset:23040
  ds_read_b64_tr_b16 v[52:53], v7 offset:40960
  ds_read_b64_tr_b16 v[54:55], v7 offset:43520
  ds_read_b64_tr_b16 v[56:57], v8 offset:20480
  buffer_load_dwordx4 v31, s[44:47], s74 offen offset:2048 lds
  ds_read_b64_tr_b16 v[58:59], v8 offset:23040
  ds_read_b64_tr_b16 v[60:61], v8 offset:40960
  ds_read_b64_tr_b16 v[62:63], v8 offset:43520
  ds_read_b64_tr_b16 v[64:65], v9 offset:20480
  buffer_load_dwordx4 v32, s[44:47], s74 offen offset:3072 lds
  ds_read_b64_tr_b16 v[66:67], v9 offset:23040
  ds_read_b64_tr_b16 v[68:69], v9 offset:40960
  ds_read_b64_tr_b16 v[70:71], v9 offset:43520
  ds_read_b128 v[80:83], v11 offset:8192
  s_add_u32 m0, m0, 4096
  s_nop 0
  buffer_load_dwordx4 v33, s[44:47], s74 offen offset:0 lds
  s_add_u32 s74, s74, 212992
  ds_read_b128 v[84:87], v12 offset:8192
  ds_read_b128 v[88:91], v11 offset:10240
  ds_read_b128 v[92:95], v12 offset:10240
  ds_read_b128 v[96:99], v11 offset:12288
  v_lshl_add_u32 v34, v242, 7, v15
  v_lshl_add_u32 v28, v26, 7, v14
  s_add_u32 m0, s76, 8192
  s_nop 0
  buffer_load_dwordx4 v28, s[32:35], 0 offen lds
  ds_read_b128 v[100:103], v12 offset:12288
  ds_read_b128 v[104:107], v11 offset:14336
  ds_read_b128 v[108:111], v12 offset:14336
  ds_read_b64_tr_b16 v[72:73], v10 offset:20480
  s_add_u32 m0, m0, 1024
  s_nop 0
  buffer_load_dwordx4 v34, s[32:35], 0 offen lds
  ds_read_b64_tr_b16 v[74:75], v10 offset:23040
  ds_read_b64_tr_b16 v[76:77], v10 offset:40960
  ds_read_b64_tr_b16 v[78:79], v10 offset:43520
  buffer_load_dwordx3 v[24:26], v13, s[28:31], s73 offen offset:0
  buffer_load_dwordx3 v[240:242], v13, s[28:31], s73 offen offset:832
  s_add_u32 s73, s73, 12
  s_waitcnt vmcnt(10) lgkmcnt(0)
  s_barrier
  s_setprio 0
  v_mfma_f32_16x16x32_bf16 v[140:143], v[40:43], v[80:83], v[140:143]
  s_add_u32 s72, s72, 1
  v_mfma_f32_16x16x32_bf16 v[140:143], v[44:47], v[84:87], v[140:143]
  v_mfma_f32_16x16x32_bf16 v[144:147], v[40:43], v[88:91], v[144:147]
  v_mfma_f32_16x16x32_bf16 v[144:147], v[44:47], v[92:95], v[144:147]
  v_mfma_f32_16x16x32_bf16 v[148:151], v[40:43], v[96:99], v[148:151]
  v_mfma_f32_16x16x32_bf16 v[148:151], v[44:47], v[100:103], v[148:151]
  v_mfma_f32_16x16x32_bf16 v[152:155], v[40:43], v[104:107], v[152:155]
  v_mfma_f32_16x16x32_bf16 v[152:155], v[44:47], v[108:111], v[152:155]
  v_mfma_f32_16x16x32_bf16 v[168:171], v[48:51], v[104:107], v[168:171]
  v_mfma_f32_16x16x32_bf16 v[168:171], v[52:55], v[108:111], v[168:171]
  v_mfma_f32_16x16x32_bf16 v[164:167], v[48:51], v[96:99], v[164:167]
  v_mfma_f32_16x16x32_bf16 v[164:167], v[52:55], v[100:103], v[164:167]
  v_mfma_f32_16x16x32_bf16 v[160:163], v[48:51], v[88:91], v[160:163]
  v_mfma_f32_16x16x32_bf16 v[160:163], v[52:55], v[92:95], v[160:163]
  v_mfma_f32_16x16x32_bf16 v[156:159], v[48:51], v[80:83], v[156:159]
  v_mfma_f32_16x16x32_bf16 v[156:159], v[52:55], v[84:87], v[156:159]
  v_mfma_f32_16x16x32_bf16 v[172:175], v[56:59], v[80:83], v[172:175]
  v_mfma_f32_16x16x32_bf16 v[172:175], v[60:63], v[84:87], v[172:175]
  v_mfma_f32_16x16x32_bf16 v[176:179], v[56:59], v[88:91], v[176:179]
  v_mfma_f32_16x16x32_bf16 v[176:179], v[60:63], v[92:95], v[176:179]
  s_cmp_lt_u32 s72, 4
  v_mfma_f32_16x16x32_bf16 v[180:183], v[56:59], v[96:99], v[180:183]
  v_mfma_f32_16x16x32_bf16 v[180:183], v[60:63], v[100:103], v[180:183]
  v_mfma_f32_16x16x32_bf16 v[184:187], v[56:59], v[104:107], v[184:187]
  v_mfma_f32_16x16x32_bf16 v[184:187], v[60:63], v[108:111], v[184:187]
  v_mfma_f32_16x16x32_bf16 v[200:203], v[64:67], v[104:107], v[200:203]
  v_mfma_f32_16x16x32_bf16 v[200:203], v[68:71], v[108:111], v[200:203]
  v_mfma_f32_16x16x32_bf16 v[196:199], v[64:67], v[96:99], v[196:199]
  v_mfma_f32_16x16x32_bf16 v[196:199], v[68:71], v[100:103], v[196:199]
  v_mfma_f32_16x16x32_bf16 v[192:195], v[64:67], v[88:91], v[192:195]
  v_mfma_f32_16x16x32_bf16 v[192:195], v[68:71], v[92:95], v[192:195]
  v_mfma_f32_16x16x32_bf16 v[188:191], v[64:67], v[80:83], v[188:191]
  v_mfma_f32_16x16x32_bf16 v[188:191], v[68:71], v[84:87], v[188:191]
  v_mfma_f32_16x16x32_bf16 v[204:207], v[72:75], v[80:83], v[204:207]
  v_mfma_f32_16x16x32_bf16 v[204:207], v[76:79], v[84:87], v[204:207]
  v_mfma_f32_16x16x32_bf16 v[208:211], v[72:75], v[88:91], v[208:211]
  v_mfma_f32_16x16x32_bf16 v[208:211], v[76:79], v[92:95], v[208:211]
  v_mfma_f32_16x16x32_bf16 v[212:215], v[72:75], v[96:99], v[212:215]
  v_mfma_f32_16x16x32_bf16 v[212:215], v[76:79], v[100:103], v[212:215]
  v_mfma_f32_16x16x32_bf16 v[216:219], v[72:75], v[104:107], v[216:219]
  s_setprio 2
  s_barrier
  v_mfma_f32_16x16x32_bf16 v[216:219], v[76:79], v[108:111], v[216:219]
  s_cbranch_scc1 L_dnn_loop1
  ds_read_b64_tr_b16 v[40:41], v1 offset:0
  ds_read_b64_tr_b16 v[42:43], v1 offset:2560
  ds_read_b64_tr_b16 v[44:45], v1 offset:20480
  ds_read_b64_tr_b16 v[46:47], v1 offset:23040
  ds_read_b64_tr_b16 v[48:49], v2 offset:0
  ds_read_b64_tr_b16 v[50:51], v2 offset:2560
  ds_read_b64_tr_b16 v[52:53], v2 offset:20480
  ds_read_b64_tr_b16 v[54:55], v2 offset:23040
  ds_read_b64_tr_b16 v[56:57], v3 offset:0
  ds_read_b64_tr_b16 v[58:59], v3 offset:2560
  ds_read_b64_tr_b16 v[60:61], v3 offset:20480
  ds_read_b64_tr_b16 v[62:63], v3 offset:23040
  ds_read_b64_tr_b16 v[64:65], v4 offset:0
  ds_read_b64_tr_b16 v[66:67], v4 offset:2560
  ds_read_b64_tr_b16 v[68:69], v4 offset:20480
  ds_read_b64_tr_b16 v[70:71], v4 offset:23040
  ds_read_b128 v[80:83], v11 offset:0
  ds_read_b128 v[84:87], v12 offset:0
  ds_read_b128 v[88:91], v11 offset:2048
  ds_read_b128 v[92:95], v12 offset:2048
  ds_read_b128 v[96:99], v11 offset:4096
  ds_read_b128 v[100:103], v12 offset:4096
  ds_read_b128 v[104:107], v11 offset:6144
  ds_read_b128 v[108:111], v12 offset:6144
  ds_read_b64_tr_b16 v[72:73], v5 offset:0
  ds_read_b64_tr_b16 v[74:75], v5 offset:2560
  ds_read_b64_tr_b16 v[76:77], v5 offset:20480
  ds_read_b64_tr_b16 v[78:79], v5 offset:23040
  ds_read_b64 v[220:221], v35 offset:640
  ds_read_b64 v[222:223], v35 offset:672
  ds_read_b64 v[224:225], v35 offset:704
  ds_read_b64 v[226:227], v35 offset:736
  ds_read_b64 v[228:229], v35 offset:768
  s_waitcnt vmcnt(2) lgkmcnt(0)
  s_barrier
  s_setprio 0
  v_mfma_f32_16x16x32_bf16 v[140:143], v[40:43], v[80:83], v[140:143]
  v_mov_b32 v232, 0xc0135761
  v_mov_b32 v233, 0xc0135761
  v_mfma_f32_16x16x32_bf16 v[140:143], v[44:47], v[84:87], v[140:143]
  v_mov_b32 v234, 0xbdd2d3e8
  v_mfma_f32_16x16x32_bf16 v[144:147], v[40:43], v[88:91], v[144:147]
  v_mov_b32 v235, 0xbdd2d3e8
  v_mfma_f32_16x16x32_bf16 v[144:147], v[44:47], v[92:95], v[144:147]
  v_mov_b32 v236, 0x71800000
  v_mfma_f32_16x16x32_bf16 v[148:151], v[40:43], v[96:99], v[148:151]
  v_lshlrev_b32 v112, 16, v220
  v_mfma_f32_16x16x32_bf16 v[148:151], v[44:47], v[100:103], v[148:151]
  v_and_b32 v113, 0xffff0000, v220
  v_mfma_f32_16x16x32_bf16 v[152:155], v[40:43], v[104:107], v[152:155]
  v_lshlrev_b32 v114, 16, v221
  v_mfma_f32_16x16x32_bf16 v[152:155], v[44:47], v[108:111], v[152:155]
  v_and_b32 v115, 0xffff0000, v221
  v_mfma_f32_16x16x32_bf16 v[168:171], v[48:51], v[104:107], v[168:171]
  v_lshlrev_b32 v116, 16, v222
  v_mfma_f32_16x16x32_bf16 v[168:171], v[52:55], v[108:111], v[168:171]
  v_and_b32 v117, 0xffff0000, v222
  v_mfma_f32_16x16x32_bf16 v[164:167], v[48:51], v[96:99], v[164:167]
  v_lshlrev_b32 v118, 16, v223
  v_mfma_f32_16x16x32_bf16 v[164:167], v[52:55], v[100:103], v[164:167]
  v_and_b32 v119, 0xffff0000, v223
  v_mfma_f32_16x16x32_bf16 v[160:163], v[48:51], v[88:91], v[160:163]
  v_lshlrev_b32 v120, 16, v224
  v_mfma_f32_16x16x32_bf16 v[160:163], v[52:55], v[92:95], v[160:163]
  v_and_b32 v121, 0xffff0000, v224
  v_mfma_f32_16x16x32_bf16 v[156:159], v[48:51], v[80:83], v[156:159]
  v_lshlrev_b32 v122, 16, v225
  v_mfma_f32_16x16x32_bf16 v[156:159], v[52:55], v[84:87], v[156:159]
  v_and_b32 v123, 0xffff0000, v225
  v_mfma_f32_16x16x32_bf16 v[172:175], v[56:59], v[80:83], v[172:175]
  v_lshlrev_b32 v124, 16, v226
  v_mfma_f32_16x16x32_bf16 v[172:175], v[60:63], v[84:87], v[172:175]
  v_and_b32 v125, 0xffff0000, v226
  v_mfma_f32_16x16x32_bf16 v[176:179], v[56:59], v[88:91], v[176:179]
  v_lshlrev_b32 v126, 16, v227
  v_mfma_f32_16x16x32_bf16 v[176:179], v[60:63], v[92:95], v[176:179]
  v_and_b32 v127, 0xffff0000, v227
  v_mfma_f32_16x16x32_bf16 v[180:183], v[56:59], v[96:99], v[180:183]
  v_lshlrev_b32 v128, 16, v228
  v_mfma_f32_16x16x32_bf16 v[180:183], v[60:63], v[100:103], v[180:183]
  v_and_b32 v129, 0xffff0000, v228
  v_mfma_f32_16x16x32_bf16 v[184:187], v[56:59], v[104:107], v[184:187]
  v_lshlrev_b32 v130, 16, v229
  v_mfma_f32_16x16x32_bf16 v[184:187], v[60:63], v[108:111], v[184:187]
  v_and_b32 v131, 0xffff0000, v229
  v_mfma_f32_16x16x32_bf16 v[200:203], v[64:67], v[104:107], v[200:203]
  v_rcp_f32 v112, v112
  v_mfma_f32_16x16x32_bf16 v[200:203], v[68:71], v[108:111], v[200:203]
  v_rcp_f32 v113, v113
  v_mfma_f32_16x16x32_bf16 v[196:199], v[64:67], v[96:99], v[196:199]
  v_rcp_f32 v114, v114
  v_mfma_f32_16x16x32_bf16 v[196:199], v[68:71], v[100:103], v[196:199]
  v_rcp_f32 v115, v115
  v_mfma_f32_16x16x32_bf16 v[192:195], v[64:67], v[88:91], v[192:195]
  v_rcp_f32 v116, v116
  v_mfma_f32_16x16x32_bf16 v[192:195], v[68:71], v[92:95], v[192:195]
  v_rcp_f32 v117, v117
  v_mfma_f32_16x16x32_bf16 v[188:191], v[64:67], v[80:83], v[188:191]
  v_rcp_f32 v118, v118
  v_mfma_f32_16x16x32_bf16 v[188:191], v[68:71], v[84:87], v[188:191]
  v_rcp_f32 v119, v119
  v_mfma_f32_16x16x32_bf16 v[204:207], v[72:75], v[80:83], v[204:207]
  v_rcp_f32 v120, v120
  v_mfma_f32_16x16x32_bf16 v[204:207], v[76:79], v[84:87], v[204:207]
  v_rcp_f32 v121, v121
  v_mfma_f32_16x16x32_bf16 v[208:211], v[72:75], v[88:91], v[208:211]
  v_rcp_f32 v122, v122
  v_mfma_f32_16x16x32_bf16 v[208:211], v[76:79], v[92:95], v[208:211]
  v_rcp_f32 v123, v123
  v_mfma_f32_16x16x32_bf16 v[212:215], v[72:75], v[96:99], v[212:215]
  v_rcp_f32 v124, v124
  v_mfma_f32_16x16x32_bf16 v[212:215], v[76:79], v[100:103], v[212:215]
  v_rcp_f32 v125, v125
  v_mfma_f32_16x16x32_bf16 v[216:219], v[72:75], v[104:107], v[216:219]
  s_setprio 2
  s_barrier
  v_mfma_f32_16x16x32_bf16 v[216:219], v[76:79], v[108:111], v[216:219]
  ds_read_b64_tr_b16 v[40:41], v1 offset:40960
  ds_read_b64_tr_b16 v[42:43], v1 offset:43520
  ds_read_b64_tr_b16 v[44:45], v6 offset:0
  ds_read_b64_tr_b16 v[46:47], v6 offset:2560
  ds_read_b64_tr_b16 v[48:49], v2 offset:40960
  ds_read_b64_tr_b16 v[50:51], v2 offset:43520
  ds_read_b64_tr_b16 v[52:53], v7 offset:0
  ds_read_b64_tr_b16 v[54:55], v7 offset:2560
  ds_read_b64_tr_b16 v[56:57], v3 offset:40960
  ds_read_b64_tr_b16 v[58:59], v3 offset:43520
  ds_read_b64_tr_b16 v[60:61], v8 offset:0
  ds_read_b64_tr_b16 v[62:63], v8 offset:2560
  ds_read_b64_tr_b16 v[64:65], v4 offset:40960
  ds_read_b64_tr_b16 v[66:67], v4 offset:43520
  ds_read_b64_tr_b16 v[68:69], v9 offset:0
  ds_read_b64_tr_b16 v[70:71], v9 offset:2560
  ds_read_b128 v[80:83], v11 offset:8192
  ds_read_b128 v[84:87], v12 offset:8192
  ds_read_b128 v[88:91], v11 offset:10240
  ds_read_b128 v[92:95], v12 offset:10240
  ds_read_b128 v[96:99], v11 offset:12288
  ds_read_b128 v[100:103], v12 offset:12288
  ds_read_b128 v[104:107], v11 offset:14336
  ds_read_b128 v[108:111], v12 offset:14336
  ds_read_b64_tr_b16 v[72:73], v5 offset:40960
  ds_read_b64_tr_b16 v[74:75], v5 offset:43520
  ds_read_b64_tr_b16 v[76:77], v10 offset:0
  ds_read_b64_tr_b16 v[78:79], v10 offset:2560
  s_waitcnt lgkmcnt(0)
  s_barrier
  v_mfma_f32_16x16x32_bf16 v[140:143], v[40:43], v[80:83], v[140:143]
  v_rcp_f32 v126, v126
  v_mfma_f32_16x16x32_bf16 v[140:143], v[44:47], v[84:87], v[140:143]
  v_rcp_f32 v127, v127
  v_mfma_f32_16x16x32_bf16 v[144:147], v[40:43], v[88:91], v[144:147]
  v_rcp_f32 v128, v128
  v_mfma_f32_16x16x32_bf16 v[144:147], v[44:47], v[92:95], v[144:147]
  v_mfma_f32_16x16x32_bf16 v[148:151], v[40:43], v[96:99], v[148:151]
  v_rcp_f32 v129, v129
  v_mfma_f32_16x16x32_bf16 v[148:151], v[44:47], v[100:103], v[148:151]
  v_rcp_f32 v130, v130
  v_mfma_f32_16x16x32_bf16 v[152:155], v[40:43], v[104:107], v[152:155]
  v_mfma_f32_16x16x32_bf16 v[152:155], v[44:47], v[108:111], v[152:155]
  v_rcp_f32 v131, v131
  v_mfma_f32_16x16x32_bf16 v[168:171], v[48:51], v[104:107], v[168:171]
  v_med3_f32 v112, v112, -v236, v236
  v_mfma_f32_16x16x32_bf16 v[168:171], v[52:55], v[108:111], v[168:171]
  v_mfma_f32_16x16x32_bf16 v[164:167], v[48:51], v[96:99], v[164:167]
  v_med3_f32 v113, v113, -v236, v236
  v_mfma_f32_16x16x32_bf16 v[164:167], v[52:55], v[100:103], v[164:167]
  v_med3_f32 v114, v114, -v236, v236
  v_mfma_f32_16x16x32_bf16 v[160:163], v[48:51], v[88:91], v[160:163]
  v_mfma_f32_16x16x32_bf16 v[160:163], v[52:55], v[92:95], v[160:163]
  v_med3_f32 v115, v115, -v236, v236
  v_mfma_f32_16x16x32_bf16 v[156:159], v[48:51], v[80:83], v[156:159]
  v_med3_f32 v116, v116, -v236, v236
  v_mfma_f32_16x16x32_bf16 v[156:159], v[52:55], v[84:87], v[156:159]
  v_mfma_f32_16x16x32_bf16 v[172:175], v[56:59], v[80:83], v[172:175]
  v_med3_f32 v117, v117, -v236, v236
  v_mfma_f32_16x16x32_bf16 v[172:175], v[60:63], v[84:87], v[172:175]
  v_med3_f32 v118, v118, -v236, v236
  v_mfma_f32_16x16x32_bf16 v[176:179], v[56:59], v[88:91], v[176:179]
  v_mfma_f32_16x16x32_bf16 v[176:179], v[60:63], v[92:95], v[176:179]
  v_med3_f32 v119, v119, -v236, v236
  v_mfma_f32_16x16x32_bf16 v[180:183], v[56:59], v[96:99], v[180:183]
  v_med3_f32 v120, v120, -v236, v236
  v_mfma_f32_16x16x32_bf16 v[180:183], v[60:63], v[100:103], v[180:183]
  v_med3_f32 v121, v121, -v236, v236
  v_mfma_f32_16x16x32_bf16 v[184:187], v[56:59], v[104:107], v[184:187]
  v_mfma_f32_16x16x32_bf16 v[184:187], v[60:63], v[108:111], v[184:187]
  v_med3_f32 v122, v122, -v236, v236
  v_mfma_f32_16x16x32_bf16 v[200:203], v[64:67], v[104:107], v[200:203]
  v_med3_f32 v123, v123, -v236, v236
  v_mfma_f32_16x16x32_bf16 v[200:203], v[68:71], v[108:111], v[200:203]
  v_mfma_f32_16x16x32_bf16 v[196:199], v[64:67], v[96:99], v[196:199]
  v_med3_f32 v124, v124, -v236, v236
  v_mfma_f32_16x16x32_bf16 v[196:199], v[68:71], v[100:103], v[196:199]
  v_med3_f32 v125, v125, -v236, v236
  v_mfma_f32_16x16x32_bf16 v[192:195], v[64:67], v[88:91], v[192:195]
  v_mfma_f32_16x16x32_bf16 v[192:195], v[68:71], v[92:95], v[192:195]
  v_med3_f32 v126, v126, -v236, v236
  v_mfma_f32_16x16x32_bf16 v[188:191], v[64:67], v[80:83], v[188:191]
  v_med3_f32 v127, v127, -v236, v236
  v_mfma_f32_16x16x32_bf16 v[188:191], v[68:71], v[84:87], v[188:191]
  v_mfma_f32_16x16x32_bf16 v[204:207], v[72:75], v[80:83], v[204:207]
  v_med3_f32 v128, v128, -v236, v236
  v_mfma_f32_16x16x32_bf16 v[204:207], v[76:79], v[84:87], v[204:207]
  v_med3_f32 v129, v129, -v236, v236
  v_mfma_f32_16x16x32_bf16 v[208:211], v[72:75], v[88:91], v[208:211]
  v_mfma_f32_16x16x32_bf16 v[208:211], v[76:79], v[92:95], v[208:211]
  v_med3_f32 v130, v130, -v236, v236
  v_mfma_f32_16x16x32_bf16 v[212:215], v[72:75], v[96:99], v[212:215]
  v_med3_f32 v131, v131, -v236, v236
  v_mfma_f32_16x16x32_bf16 v[212:215], v[76:79], v[100:103], v[212:215]
  v_mfma_f32_16x16x32_bf16 v[216:219], v[72:75], v[104:107], v[216:219]
  v_mfma_f32_16x16x32_bf16 v[216:219], v[76:79], v[108:111], v[216:219]
  s_setprio 0
L_epi:
  s_lshl_b32 s69, s27, 11
  s_and_b32 s71, s26, 3
  s_lshl_b32 s71, s71, 9
  s_add_u32 s69, s69, s71
  s_lshr_b32 s68, s26, 2
  s_lshl_b32 s68, s68, 14
  s_add_u32 s69, s69, s68
  v_lshlrev_b32 v3, 3, v0
  v_add_u32 v2, 156928, v3
  v_pk_mul_f32 v[40:41], v[140:141], v[140:141]
  v_pk_mul_f32 v[44:45], v[144:145], v[144:145]
  v_pk_mul_f32 v[48:49], v[148:149], v[148:149]
  v_pk_mul_f32 v[52:53], v[152:153], v[152:153]
  v_pk_fma_f32 v[40:41], v[40:41], v[234:235], v[232:233]
  v_pk_fma_f32 v[44:45], v[44:45], v[234:235], v[232:233]
  v_pk_fma_f32 v[48:49], v[48:49], v[234:235], v[232:233]
  v_pk_fma_f32 v[52:53], v[52:53], v[234:235], v[232:233]
  v_pk_mul_f32 v[40:41], v[40:41], v[140:141]
  v_pk_mul_f32 v[44:45], v[44:45], v[144:145]
  v_pk_mul_f32 v[48:49], v[48:49], v[148:149]
  v_pk_mul_f32 v[52:53], v[52:53], v[152:153]
  v_exp_f32 v40, v40
  v_exp_f32 v41, v41
  v_exp_f32 v44, v44
  v_exp_f32 v45, v45
  v_exp_f32 v48, v48
  v_exp_f32 v49, v49
  v_exp_f32 v52, v52
  v_exp_f32 v53, v53
  v_pk_fma_f32 v[40:41], v[40:41], v[112:113], v[112:113]
  v_pk_fma_f32 v[44:45], v[44:45], v[112:113], v[112:113]
  v_pk_fma_f32 v[48:49], v[48:49], v[112:113], v[112:113]
  v_pk_fma_f32 v[52:53], v[52:53], v[112:113], v[112:113]
  v_rcp_f32 v40, v40
  v_rcp_f32 v41, v41
  v_rcp_f32 v44, v44
  v_rcp_f32 v45, v45
  v_rcp_f32 v48, v48
  v_rcp_f32 v49, v49
  v_rcp_f32 v52, v52
  v_rcp_f32 v53, v53
  v_pk_mul_f32 v[16:17], v[40:41], v[140:141]
  v_pk_mul_f32 v[18:19], v[44:45], v[144:145]
  v_pk_mul_f32 v[20:21], v[48:49], v[148:149]
  v_pk_mul_f32 v[22:23], v[52:53], v[152:153]
  v_pk_mul_f32 v[56:57], v[142:143], v[142:143]
  v_pk_mul_f32 v[60:61], v[146:147], v[146:147]
  v_pk_mul_f32 v[64:65], v[150:151], v[150:151]
  v_pk_mul_f32 v[68:69], v[154:155], v[154:155]
  v_pk_fma_f32 v[56:57], v[56:57], v[234:235], v[232:233]
  v_pk_fma_f32 v[60:61], v[60:61], v[234:235], v[232:233]
  v_pk_fma_f32 v[64:65], v[64:65], v[234:235], v[232:233]
  v_pk_fma_f32 v[68:69], v[68:69], v[234:235], v[232:233]
  v_pk_mul_f32 v[56:57], v[56:57], v[142:143]
  v_pk_mul_f32 v[60:61], v[60:61], v[146:147]
  v_pk_mul_f32 v[64:65], v[64:65], v[150:151]
  v_pk_mul_f32 v[68:69], v[68:69], v[154:155]
  v_exp_f32 v56, v56
  v_exp_f32 v57, v57
  v_exp_f32 v60, v60
  v_exp_f32 v61, v61
  v_exp_f32 v64, v64
  v_exp_f32 v65, v65
  v_exp_f32 v68, v68
  v_exp_f32 v69, v69
  v_pk_fma_f32 v[56:57], v[56:57], v[114:115], v[114:115]
  v_pk_fma_f32 v[60:61], v[60:61], v[114:115], v[114:115]
  v_pk_fma_f32 v[64:65], v[64:65], v[114:115], v[114:115]
  v_pk_fma_f32 v[68:69], v[68:69], v[114:115], v[114:115]
  v_rcp_f32 v56, v56
  v_rcp_f32 v57, v57
  v_rcp_f32 v60, v60
  v_rcp_f32 v61, v61
  v_rcp_f32 v64, v64
  v_rcp_f32 v65, v65
  v_rcp_f32 v68, v68
  v_rcp_f32 v69, v69
  v_pk_fma_f32 v[16:17], v[56:57], v[142:143], v[16:17]
  v_pk_fma_f32 v[18:19], v[60:61], v[146:147], v[18:19]
  v_pk_fma_f32 v[20:21], v[64:65], v[150:151], v[20:21]
  v_pk_fma_f32 v[22:23], v[68:69], v[154:155], v[22:23]
  v_pk_mul_f32 v[40:41], v[156:157], v[156:157]
  v_pk_mul_f32 v[44:45], v[160:161], v[160:161]
  v_pk_mul_f32 v[48:49], v[164:165], v[164:165]
  v_pk_mul_f32 v[52:53], v[168:169], v[168:169]
  v_pk_fma_f32 v[40:41], v[40:41], v[234:235], v[232:233]
  v_pk_fma_f32 v[44:45], v[44:45], v[234:235], v[232:233]
  v_pk_fma_f32 v[48:49], v[48:49], v[234:235], v[232:233]
  v_pk_fma_f32 v[52:53], v[52:53], v[234:235], v[232:233]
  v_pk_mul_f32 v[40:41], v[40:41], v[156:157]
  v_pk_mul_f32 v[44:45], v[44:45], v[160:161]
  v_pk_mul_f32 v[48:49], v[48:49], v[164:165]
  v_pk_mul_f32 v[52:53], v[52:53], v[168:169]
  v_exp_f32 v40, v40
  v_exp_f32 v41, v41
  v_exp_f32 v44, v44
  v_exp_f32 v45, v45
  v_exp_f32 v48, v48
  v_exp_f32 v49, v49
  v_exp_f32 v52, v52
  v_exp_f32 v53, v53
  v_pk_fma_f32 v[40:41], v[40:41], v[116:117], v[116:117]
  v_pk_fma_f32 v[44:45], v[44:45], v[116:117], v[116:117]
  v_pk_fma_f32 v[48:49], v[48:49], v[116:117], v[116:117]
  v_pk_fma_f32 v[52:53], v[52:53], v[116:117], v[116:117]
  v_rcp_f32 v40, v40
  v_rcp_f32 v41, v41
  v_rcp_f32 v44, v44
  v_rcp_f32 v45, v45
  v_rcp_f32 v48, v48
  v_rcp_f32 v49, v49
  v_rcp_f32 v52, v52
  v_rcp_f32 v53, v53
  v_pk_fma_f32 v[16:17], v[40:41], v[156:157], v[16:17]
  v_pk_fma_f32 v[18:19], v[44:45], v[160:161], v[18:19]
  v_pk_fma_f32 v[20:21], v[48:49], v[164:165], v[20:21]
  v_pk_fma_f32 v[22:23], v[52:53], v[168:169], v[22:23]
  v_pk_mul_f32 v[56:57], v[158:159], v[158:159]
  v_pk_mul_f32 v[60:61], v[162:163], v[162:163]
  v_pk_mul_f32 v[64:65], v[166:167], v[166:167]
  v_pk_mul_f32 v[68:69], v[170:171], v[170:171]
  v_pk_fma_f32 v[56:57], v[56:57], v[234:235], v[232:233]
  v_pk_fma_f32 v[60:61], v[60:61], v[234:235], v[232:233]
  v_pk_fma_f32 v[64:65], v[64:65], v[234:235], v[232:233]
  v_pk_fma_f32 v[68:69], v[68:69], v[234:235], v[232:233]
  v_pk_mul_f32 v[56:57], v[56:57], v[158:159]
  v_pk_mul_f32 v[60:61], v[60:61], v[162:163]
  v_pk_mul_f32 v[64:65], v[64:65], v[166:167]
  v_pk_mul_f32 v[68:69], v[68:69], v[170:171]
  v_exp_f32 v56, v56
  v_exp_f32 v57, v57
  v_exp_f32 v60, v60
  v_exp_f32 v61, v61
  v_exp_f32 v64, v64
  v_exp_f32 v65, v65
  v_exp_f32 v68, v68
  v_exp_f32 v69, v69
  v_pk_fma_f32 v[56:57], v[56:57], v[118:119], v[118:119]
  v_pk_fma_f32 v[60:61], v[60:61], v[118:119], v[118:119]
  v_pk_fma_f32 v[64:65], v[64:65], v[118:119], v[118:119]
  v_pk_fma_f32 v[68:69], v[68:69], v[118:119], v[118:119]
  v_rcp_f32 v56, v56
  v_rcp_f32 v57, v57
  v_rcp_f32 v60, v60
  v_rcp_f32 v61, v61
  v_rcp_f32 v64, v64
  v_rcp_f32 v65, v65
  v_rcp_f32 v68, v68
  v_rcp_f32 v69, v69
  v_pk_fma_f32 v[16:17], v[56:57], v[158:159], v[16:17]
  v_pk_fma_f32 v[18:19], v[60:61], v[162:163], v[18:19]
  v_pk_fma_f32 v[20:21], v[64:65], v[166:167], v[20:21]
  v_pk_fma_f32 v[22:23], v[68:69], v[170:171], v[22:23]
  v_pk_mul_f32 v[40:41], v[172:173], v[172:173]
  v_pk_mul_f32 v[44:45], v[176:177], v[176:177]
  v_pk_mul_f32 v[48:49], v[180:181], v[180:181]
  v_pk_mul_f32 v[52:53], v[184:185], v[184:185]
  v_pk_fma_f32 v[40:41], v[40:41], v[234:235], v[232:233]
  v_pk_fma_f32 v[44:45], v[44:45], v[234:235], v[232:233]
  v_pk_fma_f32 v[48:49], v[48:49], v[234:235], v[232:233]
  v_pk_fma_f32 v[52:53], v[52:53], v[234:235], v[232:233]
  v_pk_mul_f32 v[40:41], v[40:41], v[172:173]
  v_pk_mul_f32 v[44:45], v[44:45], v[176:177]
  v_pk_mul_f32 v[48:49], v[48:49], v[180:181]
  v_pk_mul_f32 v[52:53], v[52:53], v[184:185]
  v_exp_f32 v40, v40
  v_exp_f32 v41, v41
  v_exp_f32 v44, v44
  v_exp_f32 v45, v45
  v_exp_f32 v48, v48
  v_exp_f32 v49, v49
  v_exp_f32 v52, v52
  v_exp_f32 v53, v53
  v_pk_fma_f32 v[40:41], v[40:41], v[120:121], v[120:121]
  v_pk_fma_f32 v[44:45], v[44:45], v[120:121], v[120:121]
  v_pk_fma_f32 v[48:49], v[48:49], v[120:121], v[120:121]
  v_pk_fma_f32 v[52:53], v[52:53], v[120:121], v[120:121]
  v_rcp_f32 v40, v40
  v_rcp_f32 v41, v41
  v_rcp_f32 v44, v44
  v_rcp_f32 v45, v45
  v_rcp_f32 v48, v48
  v_rcp_f32 v49, v49
  v_rcp_f32 v52, v52
  v_rcp_f32 v53, v53
  v_pk_fma_f32 v[16:17], v[40:41], v[172:173], v[16:17]
  v_pk_fma_f32 v[18:19], v[44:45], v[176:177], v[18:19]
  v_pk_fma_f32 v[20:21], v[48:49], v[180:181], v[20:21]
  v_pk_fma_f32 v[22:23], v[52:53], v[184:185], v[22:23]
  v_pk_mul_f32 v[56:57], v[174:175], v[174:175]
  v_pk_mul_f32 v[60:61], v[178:179], v[178:179]
  v_pk_mul_f32 v[64:65], v[182:183], v[182:183]
  v_pk_mul_f32 v[68:69], v[186:187], v[186:187]
  v_pk_fma_f32 v[56:57], v[56:57], v[234:235], v[232:233]
  v_pk_fma_f32 v[60:61], v[60:61], v[234:235], v[232:233]
  v_pk_fma_f32 v[64:65], v[64:65], v[234:235], v[232:233]
  v_pk_fma_f32 v[68:69], v[68:69], v[234:235], v[232:233]
  v_pk_mul_f32 v[56:57], v[56:57], v[174:175]
  v_pk_mul_f32 v[60:61], v[60:61], v[178:179]
  v_pk_mul_f32 v[64:65], v[64:65], v[182:183]
  v_pk_mul_f32 v[68:69], v[68:69], v[186:187]
  v_exp_f32 v56, v56
  v_exp_f32 v57, v57
  v_exp_f32 v60, v60
  v_exp_f32 v61, v61
  v_exp_f32 v64, v64
  v_exp_f32 v65, v65
  v_exp_f32 v68, v68
  v_exp_f32 v69, v69
  v_pk_fma_f32 v[56:57], v[56:57], v[122:123], v[122:123]
  v_pk_fma_f32 v[60:61], v[60:61], v[122:123], v[122:123]
  v_pk_fma_f32 v[64:65], v[64:65], v[122:123], v[122:123]
  v_pk_fma_f32 v[68:69], v[68:69], v[122:123], v[122:123]
  v_rcp_f32 v56, v56
  v_rcp_f32 v57, v57
  v_rcp_f32 v60, v60
  v_rcp_f32 v61, v61
  v_rcp_f32 v64, v64
  v_rcp_f32 v65, v65
  v_rcp_f32 v68, v68
  v_rcp_f32 v69, v69
  v_pk_fma_f32 v[16:17], v[56:57], v[174:175], v[16:17]
  v_pk_fma_f32 v[18:19], v[60:61], v[178:179], v[18:19]
  v_pk_fma_f32 v[20:21], v[64:65], v[182:183], v[20:21]
  v_pk_fma_f32 v[22:23], v[68:69], v[186:187], v[22:23]
  v_pk_mul_f32 v[40:41], v[188:189], v[188:189]
  v_pk_mul_f32 v[44:45], v[192:193], v[192:193]
  v_pk_mul_f32 v[48:49], v[196:197], v[196:197]
  v_pk_mul_f32 v[52:53], v[200:201], v[200:201]
  v_pk_fma_f32 v[40:41], v[40:41], v[234:235], v[232:233]
  v_pk_fma_f32 v[44:45], v[44:45], v[234:235], v[232:233]
  v_pk_fma_f32 v[48:49], v[48:49], v[234:235], v[232:233]
  v_pk_fma_f32 v[52:53], v[52:53], v[234:235], v[232:233]
  v_pk_mul_f32 v[40:41], v[40:41], v[188:189]
  v_pk_mul_f32 v[44:45], v[44:45], v[192:193]
  v_pk_mul_f32 v[48:49], v[48:49], v[196:197]
  v_pk_mul_f32 v[52:53], v[52:53], v[200:201]
  v_exp_f32 v40, v40
  v_exp_f32 v41, v41
  v_exp_f32 v44, v44
  v_exp_f32 v45, v45
  v_exp_f32 v48, v48
  v_exp_f32 v49, v49
  v_exp_f32 v52, v52
  v_exp_f32 v53, v53
  v_pk_fma_f32 v[40:41], v[40:41], v[124:125], v[124:125]
  v_pk_fma_f32 v[44:45], v[44:45], v[124:125], v[124:125]
  v_pk_fma_f32 v[48:49], v[48:49], v[124:125], v[124:125]
  v_pk_fma_f32 v[52:53], v[52:53], v[124:125], v[124:125]
  v_rcp_f32 v40, v40
  v_rcp_f32 v41, v41
  v_rcp_f32 v44, v44
  v_rcp_f32 v45, v45
  v_rcp_f32 v48, v48
  v_rcp_f32 v49, v49
  v_rcp_f32 v52, v52
  v_rcp_f32 v53, v53
  v_pk_fma_f32 v[16:17], v[40:41], v[188:189], v[16:17]
  v_pk_fma_f32 v[18:19], v[44:45], v[192:193], v[18:19]
  v_pk_fma_f32 v[20:21], v[48:49], v[196:197], v[20:21]
  v_pk_fma_f32 v[22:23], v[52:53], v[200:201], v[22:23]
  v_pk_mul_f32 v[56:57], v[190:191], v[190:191]
  v_pk_mul_f32 v[60:61], v[194:195], v[194:195]
  v_pk_mul_f32 v[64:65], v[198:199], v[198:199]
  v_pk_mul_f32 v[68:69], v[202:203], v[202:203]
  v_pk_fma_f32 v[56:57], v[56:57], v[234:235], v[232:233]
  v_pk_fma_f32 v[60:61], v[60:61], v[234:235], v[232:233]
  v_pk_fma_f32 v[64:65], v[64:65], v[234:235], v[232:233]
  v_pk_fma_f32 v[68:69], v[68:69], v[234:235], v[232:233]
  v_pk_mul_f32 v[56:57], v[56:57], v[190:191]
  v_pk_mul_f32 v[60:61], v[60:61], v[194:195]
  v_pk_mul_f32 v[64:65], v[64:65], v[198:199]
  v_pk_mul_f32 v[68:69], v[68:69], v[202:203]
  v_exp_f32 v56, v56
  v_exp_f32 v57, v57
  v_exp_f32 v60, v60
  v_exp_f32 v61, v61
  v_exp_f32 v64, v64
  v_exp_f32 v65, v65
  v_exp_f32 v68, v68
  v_exp_f32 v69, v69
  v_pk_fma_f32 v[56:57], v[56:57], v[126:127], v[126:127]
  v_pk_fma_f32 v[60:61], v[60:61], v[126:127], v[126:127]
  v_pk_fma_f32 v[64:65], v[64:65], v[126:127], v[126:127]
  v_pk_fma_f32 v[68:69], v[68:69], v[126:127], v[126:127]
  v_rcp_f32 v56, v56
  v_rcp_f32 v57, v57
  v_rcp_f32 v60, v60
  v_rcp_f32 v61, v61
  v_rcp_f32 v64, v64
  v_rcp_f32 v65, v65
  v_rcp_f32 v68, v68
  v_rcp_f32 v69, v69
  v_pk_fma_f32 v[16:17], v[56:57], v[190:191], v[16:17]
  v_pk_fma_f32 v[18:19], v[60:61], v[194:195], v[18:19]
  v_pk_fma_f32 v[20:21], v[64:65], v[198:199], v[20:21]
  v_pk_fma_f32 v[22:23], v[68:69], v[202:203], v[22:23]
  v_pk_mul_f32 v[40:41], v[204:205], v[204:205]
  v_pk_mul_f32 v[44:45], v[208:209], v[208:209]
  v_pk_mul_f32 v[48:49], v[212:213], v[212:213]
  v_pk_mul_f32 v[52:53], v[216:217], v[216:217]
  v_pk_fma_f32 v[40:41], v[40:41], v[234:235], v[232:233]
  v_pk_fma_f32 v[44:45], v[44:45], v[234:235], v[232:233]
  v_pk_fma_f32 v[48:49], v[48:49], v[234:235], v[232:233]
  v_pk_fma_f32 v[52:53], v[52:53], v[234:235], v[232:233]
  v_pk_mul_f32 v[40:41], v[40:41], v[204:205]
  v_pk_mul_f32 v[44:45], v[44:45], v[208:209]
  v_pk_mul_f32 v[48:49], v[48:49], v[212:213]
  v_pk_mul_f32 v[52:53], v[52:53], v[216:217]
  v_exp_f32 v40, v40
  v_exp_f32 v41, v41
  v_exp_f32 v44, v44
  v_exp_f32 v45, v45
  v_exp_f32 v48, v48
  v_exp_f32 v49, v49
  v_exp_f32 v52, v52
  v_exp_f32 v53, v53
  v_pk_fma_f32 v[40:41], v[40:41], v[128:129], v[128:129]
  v_pk_fma_f32 v[44:45], v[44:45], v[128:129], v[128:129]
  v_pk_fma_f32 v[48:49], v[48:49], v[128:129], v[128:129]
  v_pk_fma_f32 v[52:53], v[52:53], v[128:129], v[128:129]
  v_rcp_f32 v40, v40
  v_rcp_f32 v41, v41
  v_rcp_f32 v44, v44
  v_rcp_f32 v45, v45
  v_rcp_f32 v48, v48
  v_rcp_f32 v49, v49
  v_rcp_f32 v52, v52
  v_rcp_f32 v53, v53
  v_pk_fma_f32 v[16:17], v[40:41], v[204:205], v[16:17]
  v_pk_fma_f32 v[18:19], v[44:45], v[208:209], v[18:19]
  v_pk_fma_f32 v[20:21], v[48:49], v[212:213], v[20:21]
  v_pk_fma_f32 v[22:23], v[52:53], v[216:217], v[22:23]
  v_pk_mul_f32 v[56:57], v[206:207], v[206:207]
  v_pk_mul_f32 v[60:61], v[210:211], v[210:211]
  v_pk_mul_f32 v[64:65], v[214:215], v[214:215]
  v_pk_mul_f32 v[68:69], v[218:219], v[218:219]
  v_pk_fma_f32 v[56:57], v[56:57], v[234:235], v[232:233]
  v_pk_fma_f32 v[60:61], v[60:61], v[234:235], v[232:233]
  v_pk_fma_f32 v[64:65], v[64:65], v[234:235], v[232:233]
  v_pk_fma_f32 v[68:69], v[68:69], v[234:235], v[232:233]
  v_pk_mul_f32 v[56:57], v[56:57], v[206:207]
  v_pk_mul_f32 v[60:61], v[60:61], v[210:211]
  v_pk_mul_f32 v[64:65], v[64:65], v[214:215]
  v_pk_mul_f32 v[68:69], v[68:69], v[218:219]
  v_exp_f32 v56, v56
  v_exp_f32 v57, v57
  v_exp_f32 v60, v60
  v_exp_f32 v61, v61
  v_exp_f32 v64, v64
  v_exp_f32 v65, v65
  v_exp_f32 v68, v68
  v_exp_f32 v69, v69
  v_pk_fma_f32 v[56:57], v[56:57], v[130:131], v[130:131]
  v_pk_fma_f32 v[60:61], v[60:61], v[130:131], v[130:131]
  v_pk_fma_f32 v[64:65], v[64:65], v[130:131], v[130:131]
  v_pk_fma_f32 v[68:69], v[68:69], v[130:131], v[130:131]
  v_rcp_f32 v56, v56
  v_rcp_f32 v57, v57
  v_rcp_f32 v60, v60
  v_rcp_f32 v61, v61
  v_rcp_f32 v64, v64
  v_rcp_f32 v65, v65
  v_rcp_f32 v68, v68
  v_rcp_f32 v69, v69
  v_pk_fma_f32 v[16:17], v[56:57], v[206:207], v[16:17]
  v_pk_fma_f32 v[18:19], v[60:61], v[210:211], v[18:19]
  v_pk_fma_f32 v[20:21], v[64:65], v[214:215], v[20:21]
  v_pk_fma_f32 v[22:23], v[68:69], v[218:219], v[22:23]
  v_add_f32 v16, v16, v17
  v_add_f32 v18, v18, v19
  v_add_f32 v20, v20, v21
  v_add_f32 v22, v22, v23
  s_nop 0
  v_permlane32_swap_b32 v16, v20
  v_permlane32_swap_b32 v18, v22
  v_add_f32 v16, v16, v20
  v_add_f32 v18, v18, v22
  s_nop 1
  v_permlane16_swap_b32 v16, v18
  v_add_f32 v16, v16, v18
  ds_write_b32 v36, v16
  s_waitcnt lgkmcnt(0)
  s_cmp_eq_u32 s3, 0
  s_cbranch_scc1 L_dpub
  s_barrier
  s_endpgm
L_dpub:
  s_mov_b32 s60, s24
  s_and_b32 s61, s25, 0xffff
  s_mov_b32 s62, 268435456
  s_mov_b32 s63, 0x20000
  s_mov_b32 s64, s22
  s_and_b32 s65, s23, 0xffff
  s_mov_b32 s66, 256
  s_mov_b32 s67, 0x20000
  s_waitcnt vmcnt(0)
  v_cmp_eq_u32 vcc, 0, v37
  s_nop 0
  s_and_b32 vcc_lo, vcc_lo, 0xff
  s_cbranch_scc0 L_dclr_ok
  s_mov_b32 s78, 0x40000
L_dclr:
  s_sub_u32 s78, s78, 1
  s_cbranch_scc1 L_dclr_ok
  v_lshlrev_b32 v37, 2, v0
  v_and_b32 v37, 31, v37
  buffer_load_dword v37, v37, s[64:67], 0 offen offset:128 sc1
  s_waitcnt vmcnt(0)
  v_cmp_eq_u32 vcc, 0, v37
  s_nop 0
  s_and_b32 vcc_lo, vcc_lo, 0xff
  s_cbranch_scc1 L_dclr
L_dclr_ok:
  s_barrier
  ds_read_b64 v[64:65], v2 offset:0
  ds_read_b64 v[66:67], v2 offset:512
  ds_read_b64 v[68:69], v2 offset:1024
  ds_read_b64 v[70:71], v2 offset:1536
  s_waitcnt lgkmcnt(2)
  v_pk_add_f32 v[64:65], v[64:65], v[66:67]
  s_waitcnt lgkmcnt(0)
  v_pk_add_f32 v[68:69], v[68:69], v[70:71]
  v_pk_add_f32 v[64:65], v[64:65], v[68:69]
  v_and_b32 v64, -2, v64
  v_and_b32 v65, -2, v65
  buffer_store_dwordx2 v[64:65], v3, s[60:63], s69 offen sc1
  s_endpgm
L_cin:
  s_and_b32 s68, s26, 3
  s_mul_i32 s68, s68, 3
  s_add_u32 s27, s68, s27
  s_sub_u32 s27, s27, 6
  s_cbranch_scc1 L_rem
  s_and_b32 s79, s3, 3
  s_lshr_b32 s84, s3, 2
  s_lshl_b32 s100, s27, 3
  s_add_u32 s100, s100, s3
  s_mul_i32 s68, s100, 1280
  v_min_u32 v40, 9, v0
  v_lshlrev_b32 v40, 7, v40
  v_lshlrev_b32 v48, 4, v0
  s_lshl_b32 s95, s79, 10
  s_cmp_eq_u32 s79, 2
  s_cselect_b64 s[82:83], 0x1fffff, -1
  s_cmp_eq_u32 s79, 3
  s_cselect_b32 s96, 0, 32768
  s_add_u32 s96, s96, s95
  s_mul_i32 s69, s27, 2979
  s_lshr_b32 s69, s69, 6
  s_mul_i32 s98, s27, 44
  s_and_b32 s70, s2, 7
  s_add_u32 s85, s98, s3
  s_lshl_b32 s85, s85, 2
  s_lshl_b32 s98, s70, 14
  s_add_u32 s85, s85, s98
  s_add_u32 s85, s85, 10240
  s_mul_i32 s98, s27, 44
  s_lshl_b32 s77, s70, 9
  s_add_u32 s94, s77, s98
  s_add_u32 s77, s77, s69
  s_add_u32 s94, s94, s3
  s_mul_i32 s94, s94, 104
  s_lshl_b32 s98, s27, 2
  s_add_u32 s98, s98, s3
  s_add_u32 s98, s98, s70
  s_and_b32 s98, s98, 7
  s_mul_i32 s98, s98, 16640
  s_add_u32 s98, s98, 12288
  s_sub_u32 s72, 6, s84
  s_lshl_b32 s99, s84, 1
  s_mov_b32 s26, -1
  v_lshrrev_b32 v43, 3, v0
  v_min_u32 v43, 6, v43
  v_lshlrev_b32 v17, 4, v43
  s_mul_i32 s70, s70, 88
  s_add_u32 s70, s100, s70
  s_mov_b32 s71, 704
  v_mov_b32 v44, s70
  v_mad_u32_u24 v19, v0, s71, v44
  s_mul_i32 s70, s100, 104
  s_sub_u32 s70, s70, 313
  v_min_u32 v44, 16, v0
  v_mul_u32_u24 v45, 26, v44
  v_add_u32 v45, s70, v45
  v_cmp_lt_u32 vcc, 12, v44
  s_nop 1
  v_cndmask_b32 v19, v19, v45, vcc
  v_lshlrev_b32 v19, 7, v19
  s_mov_b32 s101, 212992
  v_mov_b32 v2, 110464
  v_lshlrev_b32 v1, 20, v0
  v_add_u32 v1, 110464, v1
  v_and_b32 v44, 7, v0
  v_lshlrev_b32 v18, 4, v44
  v_and_b32 v44, 15, v0
  v_lshl_add_u32 v44, v44, 2, v2
  v_mov_b32 v3, 0
  ds_write_b32 v44, v3
  v_lshrrev_b32 v41, 5, v0
  v_and_b32 v42, 31, v0
  s_waitcnt lgkmcnt(0)
  v_mov_b32 v3, 1
  s_mov_b32 s32, s6
  s_and_b32 s33, s7, 0xffff
  s_mov_b32 s34, 12800000
  s_mov_b32 s35, 0x20000
  v_mov_b32 v45, s80
  buffer_load_dword v255, v45, s[32:35], 0 offen
  s_mov_b32 s36, s8
  s_and_b32 s37, s9, 0xffff
  s_mov_b32 s38, 105456
  s_mov_b32 s39, 0x20000
  buffer_load_dword v255, v40, s[36:39], s68 offen
  s_mov_b32 s44, s12
  s_and_b32 s45, s13, 0xffff
  s_mov_b32 s46, 5537792
  s_mov_b32 s47, 0x20000
  s_barrier
  s_mov_b64 exec, 131071
  buffer_load_dword v255, v19, s[44:47], s101 offen
  s_mov_b64 exec, -1
  s_add_u32 s101, s101, 1171456
  s_mov_b32 s28, s4
  s_and_b32 s29, s5, 0xffff
  s_mov_b32 s30, 425984
  s_mov_b32 s31, 0x20000
  s_cmp_lg_u32 s84, 0
  s_cbranch_scc1 L_g1a
  s_mov_b32 s40, s10
  s_and_b32 s41, s11, 0xffff
  s_mov_b32 s42, 156
  s_mov_b32 s43, 0x20000
  s_mov_b32 m0, 110272
  s_mov_b64 exec, 0x7ff
  buffer_load_dwordx4 v48, s[40:43], 0 offen lds
  s_mov_b64 exec, -1
  s_add_u32 m0, s95, 71552
  s_add_u32 s81, s95, 70304
  buffer_load_dwordx4 v48, s[36:39], s81 offen lds
  s_add_u32 m0, s95, 75648
  s_add_u32 s81, s95, 74400
  buffer_load_dwordx4 v48, s[36:39], s81 offen lds
  s_add_u32 m0, s95, 79744
  s_add_u32 s81, s95, 78496
  buffer_load_dwordx4 v48, s[36:39], s81 offen lds
  s_add_u32 m0, s95, 83840
  s_add_u32 s81, s95, 82592
  buffer_load_dwordx4 v48, s[36:39], s81 offen lds
  s_add_u32 m0, s95, 87936
  s_add_u32 s81, s95, 86688
  buffer_load_dwordx4 v48, s[36:39], s81 offen lds
  s_add_u32 m0, s95, 92032
  s_add_u32 s81, s95, 90784
  buffer_load_dwordx4 v48, s[36:39], s81 offen lds
  s_add_u32 m0, s95, 96128
  s_add_u32 s81, s95, 94880
  buffer_load_dwordx4 v48, s[36:39], s81 offen lds
  s_add_u32 m0, s95, 100224
  s_add_u32 s81, s95, 98976
  buffer_load_dwordx4 v48, s[36:39], s81 offen lds
  s_add_u32 m0, s96, 71552
  s_add_u32 s81, s96, 70304
  s_mov_b64 exec, s[82:83]
  buffer_load_dwordx4 v48, s[36:39], s81 offen lds
  s_mov_b64 exec, -1
  s_add_u32 m0, s95, 36288
  s_add_u32 s81, s95, 35152
  buffer_load_dwordx4 v48, s[36:39], s81 offen lds
  s_add_u32 m0, s95, 40384
  s_add_u32 s81, s95, 39248
  buffer_load_dwordx4 v48, s[36:39], s81 offen lds
  s_add_u32 m0, s95, 44480
  s_add_u32 s81, s95, 43344
  buffer_load_dwordx4 v48, s[36:39], s81 offen lds
  s_add_u32 m0, s95, 48576
  s_add_u32 s81, s95, 47440
  buffer_load_dwordx4 v48, s[36:39], s81 offen lds
  s_branch L_addrc
L_g1a:
  s_setprio 1
  v_bfe_u32 v43, v0, 2, 2
  v_lshl_add_u32 v43, v41, 3, v43
  v_bfe_u32 v44, v0, 4, 1
  v_lshlrev_b32 v44, 5, v44
  v_and_b32 v45, 3, v0
  v_lshl_add_u32 v44, v45, 3, v44
  v_lshl_add_u32 v240, v43, 6, v44
  v_add_u32 v240, 106816, v240
  s_lshl_b32 s68, s79, 6
  s_add_u32 s68, s68, 36288
  v_add_u32 v44, s68, v44
  v_mul_u32_u24 v45, 1352, v43
  v_add_u32 v241, v44, v45
  v_add_u32 v45, 16, v43
  v_min_u32 v45, 25, v45
  v_mul_u32_u24 v45, 1352, v45
  v_add_u32 v242, v44, v45
  v_add_u32 v45, 20, v43
  v_min_u32 v45, 25, v45
  v_mul_u32_u24 v45, 1352, v45
  v_add_u32 v243, v44, v45
  s_lshl_b32 s68, s79, 5
  v_add_u32 v246, s68, v42
  v_mul_u32_u24 v43, 52, v246
  v_lshl_add_u32 v43, v41, 3, v43
  v_add_u32 v244, 71552, v43
  v_lshlrev_b32 v43, 1, v246
  v_add_u32 v245, 108864, v43
  v_mov_b32 v216, 0
  v_mov_b32 v217, 0
  v_lshlrev_b32 v43, 3, v0
  v_add_u32 v44, 106816, v43
  s_lshl_b32 s68, s79, 9
  v_add_u32 v44, s68, v44
  ds_write_b64 v44, v[216:217]
  v_lshl_add_u32 v43, v41, 7, v246
  s_mov_b32 s69, 2521
  s_mov_b32 s70, 106816
  v_mul_u32_u24 v44, s69, v43
  v_lshrrev_b32 v44, 16, v44
  v_mad_u32_u24 v44, v44, 12, s70
  v_lshl_add_u32 v68, v43, 1, v44
  v_add_u32 v43, 256, v43
  v_mul_u32_u24 v44, s69, v43
  v_lshrrev_b32 v44, 16, v44
  v_mad_u32_u24 v44, v44, 12, s70
  v_lshl_add_u32 v69, v43, 1, v44
  v_add_u32 v43, 256, v43
  v_mul_u32_u24 v44, s69, v43
  v_lshrrev_b32 v44, 16, v44
  v_mad_u32_u24 v44, v44, 12, s70
  v_lshl_add_u32 v70, v43, 1, v44
  v_mov_b32 v44, 676
  v_cmp_gt_u32 s[92:93], v44, v43
  v_add_u32 v43, 0, v246
  v_mul_u32_u24 v44, s69, v43
  v_lshrrev_b32 v44, 16, v44
  v_lshl_add_u32 v44, v44, 2, v244
  v_add_u32 v72, 0, v44
  v_add_u32 v43, 128, v246
  v_mul_u32_u24 v44, s69, v43
  v_lshrrev_b32 v44, 16, v44
  v_lshl_add_u32 v44, v44, 2, v244
  v_add_u32 v73, 6656, v44
  v_add_u32 v43, 256, v246
  v_mul_u32_u24 v44, s69, v43
  v_lshrrev_b32 v44, 16, v44
  v_lshl_add_u32 v44, v44, 2, v244
  v_add_u32 v74, 13312, v44
  v_add_u32 v43, 384, v246
  v_mul_u32_u24 v44, s69, v43
  v_lshrrev_b32 v44, 16, v44
  v_lshl_add_u32 v44, v44, 2, v244
  v_add_u32 v75, 19968, v44
  v_add_u32 v43, 512, v246
  v_mul_u32_u24 v44, s69, v43
  v_lshrrev_b32 v44, 16, v44
  v_lshl_add_u32 v44, v44, 2, v244
  v_add_u32 v76, 26624, v44
  v_add_u32 v43, 640, v246
  v_mul_u32_u24 v44, s69, v43
  v_lshrrev_b32 v44, 16, v44
  v_lshl_add_u32 v44, v44, 2, v244
  v_add_u32 v77, 33280, v44
  v_lshlrev_b32 v78, 4, v41
  v_add_u32 v78, 110376, v78
  v_lshlrev_b32 v79, 1, v0
  v_add_u32 v79, 110272, v79
  v_lshlrev_b32 v80, 6, v0
  v_add_u32 v80, 106868, v80
L_addrc:
  s_and_b32 s70, s3, 1
  s_lshl_b32 s70, s70, 1
  v_add_u32 v46, s70, v41
  v_min_u32 v43, 25, v42
  s_mul_i32 s68, s84, 4
  s_add_u32 s68, s68, 1352
  s_mul_i32 s69, s84, 70528
  s_add_u32 s69, s69, 1024
  v_mul_u32_u24 v44, s68, v43
  v_add_u32 v44, s69, v44
  v_lshlrev_b32 v247, 2, v43
  v_add_u32 v247, 70528, v247
  v_mul_u32_u24 v65, 52, v43
  v_lshl_add_u32 v65, v46, 1, v65
  v_add_u32 v65, 108864, v65
  v_lshlrev_b32 v67, 1, v43
  v_add_u32 v67, 110272, v67
  v_mad_u32_u24 v60, v46, 52, v44
  v_lshl_add_u32 v61, v46, 1, v44
  v_lshl_add_u32 v49, v46, 1, v60
  v_lshlrev_b32 v43, 3, v46
  s_mov_b32 s68, 0x01000100
  v_bfe_i32 v45, s68, v43, 8
  v_lshl_add_u32 v50, v45, 1, v60
  v_mad_i32_i24 v51, v45, 52, v61
  s_mov_b32 s68, 0xff00ff00
  v_bfe_i32 v45, s68, v43, 8
  v_lshl_add_u32 v52, v45, 1, v60
  v_mad_i32_i24 v53, v45, 52, v61
  s_mov_b32 s68, 0xff020100
  v_bfe_i32 v45, s68, v43, 8
  v_lshl_add_u32 v54, v45, 1, v60
  v_mad_i32_i24 v55, v45, 52, v61
  s_mov_b32 s68, 0x0b0a0100
  v_bfe_i32 v45, s68, v43, 8
  v_lshl_add_u32 v56, v45, 1, v60
  v_mad_i32_i24 v57, v45, 52, v61
  s_mov_b32 s68, 0xf3f20100
  v_bfe_i32 v45, s68, v43, 8
  v_lshl_add_u32 v58, v45, 1, v60
  v_mad_i32_i24 v59, v45, 52, v61
  s_mov_b32 s68, 0x00023600
  v_bfe_u32 v45, s68, v43, 8
  v_add_u32 v60, v45, v44
  v_add_u32 v61, 52, v44
  v_mov_b32 v47, 1048576
  v_cmp_eq_u32 vcc, 3, v46
  s_nop 1
  v_cndmask_b32 v60, v60, v47, vcc
  v_cndmask_b32 v67, v47, v67, vcc
  v_cmp_eq_u32 vcc, 2, v46
  s_nop 1
  v_cndmask_b32 v61, v47, v61, vcc
  v_cmp_gt_u32 vcc, 2, v46
  s_nop 1
  v_cndmask_b32 v64, v47, v65, vcc
  s_lshr_b32 s69, s79, 1
  s_mul_i32 s69, s69, 6144
  s_mul_i32 s68, s84, 6144
  v_lshlrev_b32 v45, 8, v46
  v_lshl_add_u32 v43, v42, 4, v45
  v_add_u32 v63, 1024, v43
  v_add_u32 v66, 36288, v43
  v_bfe_u32 v43, v0, 2, 2
  v_lshl_add_u32 v45, v43, 4, v45
  v_and_b32 v43, 3, v0
  v_lshl_add_u32 v44, v43, 6, v45
  v_add_u32 v44, 12288, v44
  v_cmp_lt_u32 vcc, 15, v42
  s_nop 1
  v_cndmask_b32 v63, v63, v44, vcc
  v_add_u32 v44, 16, v44
  v_cndmask_b32 v66, v66, v44, vcc
  v_lshl_add_u32 v44, v43, 5, v45
  v_add_u32 v44, 24560, v44
  v_cmp_lt_u32 vcc, 19, v42
  s_nop 1
  v_cndmask_b32 v63, v63, v44, vcc
  v_add_u32 v63, s69, v63
  v_add_u32 v66, s68, v66
  v_cmp_lt_u32 vcc, 25, v42
  s_nop 1
  v_cndmask_b32 v63, v63, v47, vcc
  v_cndmask_b32 v66, v66, v47, vcc
  v_mov_b32 v62, 0
  s_mul_i32 s74, s3, 4224
  s_add_u32 s74, s74, 111040
  s_mov_b32 s75, -39488
  v_add_u32 v28, 1024, v48
  v_and_b32 v43, 11, v0
  v_cmp_eq_u32 vcc, 11, v43
  s_nop 1
  v_cndmask_b32 v31, v28, v47, vcc
  v_and_b32 v43, 3, v0
  v_cmp_eq_u32 vcc, 0, v43
  s_nop 1
  v_cndmask_b32 v30, v31, v47, vcc
  v_lshrrev_b32 v46, 4, v0
  v_bfe_u32 v43, v0, 1, 3
  v_lshlrev_b32 v45, 4, v43
  v_add_u32 v45, 24576, v45
  v_and_b32 v43, 10, v0
  v_cmp_eq_u32 vcc, 10, v43
  s_nop 1
  v_cndmask_b32 v45, v45, v47, vcc
  v_and_b32 v44, 1, v0
  v_lshl_add_u32 v29, v46, 9, v45
  v_lshl_add_u32 v29, v44, 2, v29
  v_add_u32 v29, 1024, v29
  v_lshl_add_u32 v22, v46, 8, v45
  v_lshl_add_u32 v22, v44, 20, v22
  v_and_b32 v47, 15, v0
  s_mov_b32 s68, 1056
  v_lshlrev_b32 v43, 1, v47
  v_add_u32 v43, s74, v43
  v_mad_u32_u24 v7, v46, s68, v43
  s_lshl_b32 s68, s3, 10
  s_add_u32 s68, s68, 144832
  v_add_u32 v10, s68, v48
  v_add_u32 v43, 256, v48
  v_and_b32 v43, 1023, v43
  v_add_u32 v11, s68, v43
  v_xor_b32 v43, 512, v48
  v_add_u32 v12, s68, v43
  v_lshlrev_b32 v13, 4, v41
  v_mov_b32 v32, 0
  v_mov_b32 v33, 0
  v_mov_b32 v34, 0
  v_mov_b32 v35, 0
  v_mov_b32 v36, 0
  v_mov_b32 v37, 0
  v_mov_b32 v38, 0
  v_mov_b32 v39, 0
  v_mov_b32 v216, 0
  v_mov_b32 v217, 0
  v_mov_b32 v218, 0
  v_mov_b32 v219, 0
  v_mov_b32 v220, 0
  v_mov_b32 v221, 0
  v_mov_b32 v222, 0
  v_mov_b32 v223, 0
  v_mov_b32 v224, 0
  v_mov_b32 v225, 0
  v_mov_b32 v226, 0
  v_mov_b32 v227, 0
  v_mov_b32 v228, 0
  v_mov_b32 v229, 0
  v_mov_b32 v230, 0
  v_mov_b32 v231, 0
  v_mov_b32 v232, 0
  v_mov_b32 v233, 0
  v_mov_b32 v234, 0
  v_mov_b32 v235, 0
  v_mov_b32 v236, 0
  v_mov_b32 v237, 0
  v_mov_b32 v238, 0
  v_mov_b32 v239, 0
  v_mul_u32_u24 v44, 1056, v46
  v_bfe_u32 v45, v0, 2, 2
  v_lshl_add_u32 v44, v45, 7, v44
  v_and_b32 v45, 3, v0
  v_lshl_add_u32 v9, v45, 3, v44
  v_add_u32 v8, s74, v9
  v_and_b32 v45, 1, v0
  s_mov_b32 s68, 0xaaaaaaaa
  v_mul_lo_u32 v16, s68, v45
  v_or_b32 v16, 0x44444444, v16
  v_lshlrev_b32 v15, 1, v0
  v_add_u32 v15, s74, v15
  v_mov_b32 v14, 0x3f80
  ds_write_b16 v15, v14 offset:4064
  v_add_u32 v15, s75, v15
  s_mul_i32 s71, s3, 6
  s_add_u32 s77, s77, s71
  s_mul_i32 s77, s77, 104
  s_add_u32 s73, s77, 80
  s_add_u32 s77, s77, 16
  s_mov_b32 s71, 10923
  v_min_u32 v43, 35, v0
  v_mul_u32_u24 v44, s71, v43
  v_lshrrev_b32 v44, 16, v44
  v_mul_u32_u24 v44, 80, v44
  v_lshl_add_u32 v20, v43, 2, v44
  s_cmp_eq_u32 s84, 0
  s_cbranch_scc1 L_g0pf
  s_waitcnt lgkmcnt(0)
  ds_add_u32 v1, v3 offset:0
  s_sub_u32 s94, s94, 416
  buffer_load_dwordx4 v[204:207], v17, s[28:31], s94 offen offset:0
  s_add_u32 s94, s94, 416
  buffer_load_dwordx4 v[24:27], v17, s[28:31], s94 offen offset:0
  s_add_u32 s94, s94, 832
  s_sub_u32 s68, s77, 2496
  buffer_load_dword v208, v20, s[28:31], s68 offen
  buffer_load_dword v209, v20, s[28:31], s77 offen
  s_add_u32 s77, s77, 24
  buffer_load_dword v21, v20, s[28:31], s77 offen
  s_cmp_eq_u32 s77, s73
  s_cselect_b32 s73, 0x7000000, s73
  s_cselect_b32 s77, 0x7000000, s77
  s_add_u32 s77, s77, 24
  s_min_u32 s77, s77, s73
L_csync1:
  ds_read_b32 v4, v2 offset:0
  s_waitcnt lgkmcnt(0)
  v_cmp_gt_u32 vcc, 8, v4
  s_cbranch_vccnz L_csync1
  ds_read_b64 v[132:133], v78 offset:0
  ds_read_b64 v[134:135], v78 offset:8
  ds_read_b64 v[136:137], v78 offset:32
  ds_read_b64 v[138:139], v78 offset:40
  ds_read_u16 v45, v79 offset:52
  ds_read_b64_tr_b16 v[84:85], v241 offset:35264
  ds_read_b64_tr_b16 v[86:87], v241 offset:40672
  ds_read_b64_tr_b16 v[88:89], v242 offset:35264
  ds_read_b64_tr_b16 v[90:91], v243 offset:35264
  ds_read_b64_tr_b16 v[92:93], v241 offset:35520
  ds_read_b64_tr_b16 v[94:95], v241 offset:40928
  ds_read_b64_tr_b16 v[96:97], v242 offset:35520
  ds_read_b64_tr_b16 v[98:99], v243 offset:35520
  ds_read_b64_tr_b16 v[100:101], v241 offset:35776
  ds_read_b64_tr_b16 v[102:103], v241 offset:41184
  ds_read_b64_tr_b16 v[104:105], v242 offset:35776
  ds_read_b64_tr_b16 v[106:107], v243 offset:35776
  ds_read_b64_tr_b16 v[108:109], v241 offset:36032
  ds_read_b64_tr_b16 v[110:111], v241 offset:41440
  ds_read_b64_tr_b16 v[112:113], v242 offset:36032
  ds_read_b64_tr_b16 v[114:115], v243 offset:36032
  s_waitcnt lgkmcnt(14)
  v_mfma_f32_32x32x16_bf16 v[140:155], v[132:135], v[84:87], 0
  s_waitcnt lgkmcnt(12)
  v_mfma_f32_32x32x16_bf16 v[140:155], v[136:139], v[88:91], v[140:155]
  ds_read_b64_tr_b16 v[116:117], v241 offset:36288
  ds_read_b64_tr_b16 v[118:119], v241 offset:41696
  ds_read_b64_tr_b16 v[120:121], v242 offset:36288
  ds_read_b64_tr_b16 v[122:123], v243 offset:36288
  s_waitcnt lgkmcnt(14)
  v_mfma_f32_32x32x16_bf16 v[156:171], v[132:135], v[92:95], 0
  s_waitcnt lgkmcnt(12)
  v_mfma_f32_32x32x16_bf16 v[156:171], v[136:139], v[96:99], v[156:171]
  ds_read_b64_tr_b16 v[124:125], v241 offset:36544
  ds_read_b64_tr_b16 v[126:127], v241 offset:41952
  ds_read_b64_tr_b16 v[128:129], v242 offset:36544
  ds_read_b64_tr_b16 v[130:131], v243 offset:36544
  s_waitcnt lgkmcnt(14)
  v_mfma_f32_32x32x16_bf16 v[172:187], v[132:135], v[100:103], 0
  s_waitcnt lgkmcnt(12)
  v_mfma_f32_32x32x16_bf16 v[172:187], v[136:139], v[104:107], v[172:187]
  v_cvt_pk_bf16_f32 v81, v140, 0
  s_waitcnt lgkmcnt(10)
  v_mfma_f32_32x32x16_bf16 v[188:203], v[132:135], v[108:111], 0
  s_waitcnt lgkmcnt(8)
  v_mfma_f32_32x32x16_bf16 v[188:203], v[136:139], v[112:115], v[188:203]
  s_mov_b32 exec_lo, 0
  v_cvt_pk_bf16_f32 v81, v156, 0
  s_mov_b32 exec_lo, -1
  ds_write_b16 v68, v81
  s_waitcnt lgkmcnt(7)
  v_mfma_f32_32x32x16_bf16 v[140:155], v[132:135], v[116:119], 0
  s_waitcnt lgkmcnt(5)
  v_mfma_f32_32x32x16_bf16 v[140:155], v[136:139], v[120:123], v[140:155]
  v_cvt_pk_bf16_f32 v82, v172, 0
  s_waitcnt lgkmcnt(3)
  v_mfma_f32_32x32x16_bf16 v[156:171], v[132:135], v[124:127], 0
  s_waitcnt lgkmcnt(1)
  v_mfma_f32_32x32x16_bf16 v[156:171], v[136:139], v[128:131], v[156:171]
  s_mov_b32 exec_lo, 0
  v_cvt_pk_bf16_f32 v82, v188, 0
  s_mov_b32 exec_lo, -1
  ds_write_b16 v69, v82
  s_nop 2
  v_cvt_pk_bf16_f32 v83, v140, 0
  s_mov_b32 exec_lo, 0
  s_nop 2
  v_cvt_pk_bf16_f32 v83, v156, 0
  s_mov_b64 exec, s[92:93]
  ds_write_b16 v70, v83
  s_mov_b64 exec, 0x3ffffff
  ds_write_b16 v80, v45
  s_mov_b64 exec, -1
  s_waitcnt lgkmcnt(0)
  ds_add_u32 v1, v3 offset:32
  v_cmp_gt_u32 s[92:93], 36, v246
  s_waitcnt vmcnt(2)
  v_lshlrev_b32 v208, 7, v208
  buffer_load_dword v255, v208, s[32:35], 0 offen
  s_waitcnt vmcnt(2)
  v_lshlrev_b32 v209, 7, v209
  buffer_load_dword v255, v209, s[32:35], 0 offen
L_csync2:
  ds_read_b32 v4, v2 offset:4
  s_waitcnt lgkmcnt(0)
  v_cmp_gt_u32 vcc, 4, v4
  s_cbranch_vccnz L_csync2
  ds_read_b64_tr_b16 v[84:85], v241 offset:0
  ds_read_b64_tr_b16 v[86:87], v241 offset:5408
  ds_read_b64_tr_b16 v[88:89], v242 offset:0
  ds_read_b64_tr_b16 v[90:91], v243 offset:0
  ds_read_b64_tr_b16 v[92:93], v241 offset:256
  ds_read_b64_tr_b16 v[94:95], v241 offset:5664
  ds_read_b64_tr_b16 v[96:97], v242 offset:256
  ds_read_b64_tr_b16 v[98:99], v243 offset:256
  ds_read_b64_tr_b16 v[100:101], v241 offset:512
  ds_read_b64_tr_b16 v[102:103], v241 offset:5920
  ds_read_b64_tr_b16 v[104:105], v242 offset:512
  ds_read_b64_tr_b16 v[106:107], v243 offset:512
  ds_read_b64_tr_b16 v[108:109], v241 offset:768
  ds_read_b64_tr_b16 v[110:111], v241 offset:6176
  ds_read_b64_tr_b16 v[112:113], v242 offset:768
  ds_read_b64_tr_b16 v[114:115], v243 offset:768
  ds_read_b64_tr_b16 v[116:117], v241 offset:1024
  ds_read_b64_tr_b16 v[118:119], v241 offset:6432
  ds_read_b64_tr_b16 v[120:121], v242 offset:1024
  ds_read_b64_tr_b16 v[122:123], v243 offset:1024
  ds_read_b64_tr_b16 v[124:125], v241 offset:1280
  ds_read_b64_tr_b16 v[126:127], v241 offset:6688
  ds_read_b64_tr_b16 v[128:129], v242 offset:1280
  ds_read_b64_tr_b16 v[130:131], v243 offset:1280
L_csync3:
  ds_read_b32 v4, v2 offset:32
  s_waitcnt lgkmcnt(0)
  v_cmp_gt_u32 vcc, 4, v4
  s_cbranch_vccnz L_csync3
  s_setprio 1
  ds_read_b64_tr_b16 v[132:133], v240 offset:0
  ds_read_b64_tr_b16 v[134:135], v240 offset:256
  ds_read_b64_tr_b16 v[136:137], v240 offset:1024
  ds_read_b64_tr_b16 v[138:139], v240 offset:1280
  s_waitcnt lgkmcnt(2)
  v_mfma_f32_32x32x16_bf16 v[140:155], v[132:135], v[84:87], 0
  s_waitcnt lgkmcnt(0)
  v_mfma_f32_32x32x16_bf16 v[140:155], v[136:139], v[88:91], v[140:155]
  v_mfma_f32_32x32x16_bf16 v[156:171], v[132:135], v[92:95], 0
  v_mfma_f32_32x32x16_bf16 v[156:171], v[136:139], v[96:99], v[156:171]
  v_mfma_f32_32x32x16_bf16 v[172:187], v[132:135], v[100:103], 0
  v_mfma_f32_32x32x16_bf16 v[172:187], v[136:139], v[104:107], v[172:187]
  s_nop 7
  v_cvt_pk_bf16_f32 v84, v140, v141
  v_cvt_pk_bf16_f32 v85, v142, v143
  v_cvt_pk_bf16_f32 v86, v144, v145
  v_cvt_pk_bf16_f32 v87, v146, v147
  v_cvt_pk_bf16_f32 v88, v148, v149
  v_cvt_pk_bf16_f32 v89, v150, v151
  v_cvt_pk_bf16_f32 v90, v152, v153
  v_cvt_pk_bf16_f32 v91, v154, v155
  ds_write2_b32 v72, v84, v85 offset0:0 offset1:1
  v_max3_f32 v62, v62, abs(v140), abs(v141)
  v_max3_f32 v62, v62, abs(v142), abs(v143)
  v_max3_f32 v62, v62, abs(v144), abs(v145)
  ds_write2_b32 v72, v86, v87 offset0:4 offset1:5
  v_max3_f32 v62, v62, abs(v146), abs(v147)
  v_max3_f32 v62, v62, abs(v148), abs(v149)
  ds_write2_b32 v72, v88, v89 offset0:8 offset1:9
  v_max3_f32 v62, v62, abs(v150), abs(v151)
  v_max3_f32 v62, v62, abs(v152), abs(v153)
  v_mfma_f32_32x32x16_bf16 v[188:203], v[132:135], v[108:111], 0
  v_mfma_f32_32x32x16_bf16 v[188:203], v[136:139], v[112:115], v[188:203]
  v_cvt_pk_bf16_f32 v92, v156, v157
  v_cvt_pk_bf16_f32 v93, v158, v159
  v_cvt_pk_bf16_f32 v94, v160, v161
  v_cvt_pk_bf16_f32 v95, v162, v163
  v_cvt_pk_bf16_f32 v96, v164, v165
  v_cvt_pk_bf16_f32 v97, v166, v167
  v_cvt_pk_bf16_f32 v98, v168, v169
  v_cvt_pk_bf16_f32 v99, v170, v171
  ds_write2_b32 v73, v92, v93 offset0:0 offset1:1
  v_max3_f32 v62, v62, abs(v156), abs(v157)
  v_max3_f32 v62, v62, abs(v158), abs(v159)
  v_max3_f32 v62, v62, abs(v160), abs(v161)
  ds_write2_b32 v73, v94, v95 offset0:4 offset1:5
  v_max3_f32 v62, v62, abs(v162), abs(v163)
  v_max3_f32 v62, v62, abs(v164), abs(v165)
  ds_write2_b32 v73, v96, v97 offset0:8 offset1:9
  v_max3_f32 v62, v62, abs(v166), abs(v167)
  v_max3_f32 v62, v62, abs(v168), abs(v169)
  v_mfma_f32_32x32x16_bf16 v[140:155], v[132:135], v[116:119], 0
  v_mfma_f32_32x32x16_bf16 v[140:155], v[136:139], v[120:123], v[140:155]
  v_cvt_pk_bf16_f32 v100, v172, v173
  v_cvt_pk_bf16_f32 v101, v174, v175
  v_cvt_pk_bf16_f32 v102, v176, v177
  v_cvt_pk_bf16_f32 v103, v178, v179
  v_cvt_pk_bf16_f32 v104, v180, v181
  v_cvt_pk_bf16_f32 v105, v182, v183
  v_cvt_pk_bf16_f32 v106, v184, v185
  v_cvt_pk_bf16_f32 v107, v186, v187
  ds_write2_b32 v74, v100, v101 offset0:0 offset1:1
  v_max3_f32 v62, v62, abs(v172), abs(v173)
  v_max3_f32 v62, v62, abs(v174), abs(v175)
  v_max3_f32 v62, v62, abs(v176), abs(v177)
  ds_write2_b32 v74, v102, v103 offset0:4 offset1:5
  v_max3_f32 v62, v62, abs(v178), abs(v179)
  v_max3_f32 v62, v62, abs(v180), abs(v181)
  ds_write2_b32 v74, v104, v105 offset0:8 offset1:9
  v_max3_f32 v62, v62, abs(v182), abs(v183)
  v_max3_f32 v62, v62, abs(v184), abs(v185)
  v_mfma_f32_32x32x16_bf16 v[156:171], v[132:135], v[124:127], 0
  v_mfma_f32_32x32x16_bf16 v[156:171], v[136:139], v[128:131], v[156:171]
  v_cvt_pk_bf16_f32 v108, v188, v189
  v_cvt_pk_bf16_f32 v109, v190, v191
  v_cvt_pk_bf16_f32 v110, v192, v193
  v_cvt_pk_bf16_f32 v111, v194, v195
  v_cvt_pk_bf16_f32 v112, v196, v197
  v_cvt_pk_bf16_f32 v113, v198, v199
  v_cvt_pk_bf16_f32 v114, v200, v201
  v_cvt_pk_bf16_f32 v115, v202, v203
  ds_write2_b32 v75, v108, v109 offset0:0 offset1:1
  v_max3_f32 v62, v62, abs(v188), abs(v189)
  v_max3_f32 v62, v62, abs(v190), abs(v191)
  v_max3_f32 v62, v62, abs(v192), abs(v193)
  ds_write2_b32 v75, v110, v111 offset0:4 offset1:5
  v_max3_f32 v62, v62, abs(v194), abs(v195)
  v_max3_f32 v62, v62, abs(v196), abs(v197)
  ds_write2_b32 v75, v112, v113 offset0:8 offset1:9
  v_max3_f32 v62, v62, abs(v198), abs(v199)
  v_max3_f32 v62, v62, abs(v200), abs(v201)
  v_cvt_pk_bf16_f32 v116, v140, v141
  v_cvt_pk_bf16_f32 v117, v142, v143
  v_cvt_pk_bf16_f32 v118, v144, v145
  v_cvt_pk_bf16_f32 v119, v146, v147
  v_cvt_pk_bf16_f32 v120, v148, v149
  v_cvt_pk_bf16_f32 v121, v150, v151
  v_cvt_pk_bf16_f32 v122, v152, v153
  v_cvt_pk_bf16_f32 v123, v154, v155
  ds_write2_b32 v76, v116, v117 offset0:0 offset1:1
  v_max3_f32 v62, v62, abs(v140), abs(v141)
  v_max3_f32 v62, v62, abs(v142), abs(v143)
  v_max3_f32 v62, v62, abs(v144), abs(v145)
  ds_write2_b32 v76, v118, v119 offset0:4 offset1:5
  v_max3_f32 v62, v62, abs(v146), abs(v147)
  v_max3_f32 v62, v62, abs(v148), abs(v149)
  ds_write2_b32 v76, v120, v121 offset0:8 offset1:9
  v_max3_f32 v62, v62, abs(v150), abs(v151)
  v_max3_f32 v62, v62, abs(v152), abs(v153)
  v_cvt_pk_bf16_f32 v124, v156, v157
  v_cvt_pk_bf16_f32 v125, v158, v159
  v_cvt_pk_bf16_f32 v126, v160, v161
  v_cvt_pk_bf16_f32 v127, v162, v163
  v_cvt_pk_bf16_f32 v128, v164, v165
  v_cvt_pk_bf16_f32 v129, v166, v167
  v_cvt_pk_bf16_f32 v130, v168, v169
  v_cvt_pk_bf16_f32 v131, v170, v171
  s_mov_b64 exec, s[92:93]
  ds_write2_b32 v77, v124, v125 offset0:0 offset1:1
  v_max3_f32 v62, v62, abs(v156), abs(v157)
  v_max3_f32 v62, v62, abs(v158), abs(v159)
  v_max3_f32 v62, v62, abs(v160), abs(v161)
  ds_write2_b32 v77, v126, v127 offset0:4 offset1:5
  v_max3_f32 v62, v62, abs(v162), abs(v163)
  v_max3_f32 v62, v62, abs(v164), abs(v165)
  ds_write2_b32 v77, v128, v129 offset0:8 offset1:9
  v_max3_f32 v62, v62, abs(v166), abs(v167)
  v_max3_f32 v62, v62, abs(v168), abs(v169)
  s_mov_b32 exec_hi, 0
  ds_write_b32 v77, v130 offset:48
  ds_write_b16 v245, v131 offset:1280
  s_mov_b32 exec_lo, -1
  ds_write_b32 v76, v122 offset:48
  ds_write_b16 v245, v123 offset:1024
  ds_write_b32 v75, v114 offset:48
  ds_write_b16 v245, v115 offset:768
  ds_write_b32 v74, v106 offset:48
  ds_write_b16 v245, v107 offset:512
  ds_write_b32 v73, v98 offset:48
  ds_write_b16 v245, v99 offset:256
  ds_write_b32 v72, v90 offset:48
  ds_write_b16 v245, v91 offset:0
  s_mov_b64 exec, -1
  v_max_u32_dpp v62, v62, v62 row_shr:1 row_mask:0xf bank_mask:0xf
  s_nop 1
  v_max_u32_dpp v62, v62, v62 row_shr:2 row_mask:0xf bank_mask:0xf
  s_nop 1
  v_max_u32_dpp v62, v62, v62 row_shr:4 row_mask:0xf bank_mask:0xf
  s_nop 1
  v_max_u32_dpp v62, v62, v62 row_shr:8 row_mask:0xf bank_mask:0xf
  s_nop 1
  v_max_u32_dpp v62, v62, v62 row_bcast:15 row_mask:0xa bank_mask:0xf
  s_nop 1
  v_max_u32_dpp v62, v62, v62 row_bcast:31 row_mask:0xc bank_mask:0xf
  s_nop 0
  v_readlane_b32 s68, v62, 63
  s_nop 1
  v_mov_b32 v62, s68
  ds_max_u32 v1, v62 offset:28
  ds_add_u32 v1, v3 offset:24
  s_setprio 0
  v_lshl_add_u32 v24, v24, 7, v18
  v_lshl_add_u32 v25, v25, 7, v18
  s_mov_b32 exec_hi, 0x0000ffff
  v_lshl_add_u32 v26, v26, 7, v18
  v_lshl_add_u32 v27, v27, 7, v18
  s_mov_b32 exec_lo, 0
  s_mov_b32 exec_hi, 0xffff0000
  v_mov_b32 v27, v25
  v_mov_b32 v26, v25
  s_mov_b32 exec_hi, 0x00ff0000
  v_mov_b32 v26, v24
  s_mov_b64 exec, -1
  s_add_u32 m0, s74, 0
  s_nop 0
  buffer_load_dwordx4 v24, s[32:35], 0 offen lds
  s_add_u32 m0, s74, 1056
  s_nop 0
  buffer_load_dwordx4 v25, s[32:35], 0 offen lds
  s_add_u32 m0, s74, 2112
  s_nop 0
  buffer_load_dwordx4 v26, s[32:35], 0 offen lds
  s_add_u32 m0, s74, 3168
  s_mov_b32 exec_hi, 0x00ffffff
  buffer_load_dwordx4 v27, s[32:35], 0 offen lds
  s_mov_b32 exec_hi, -1
  v_lshl_add_u32 v204, v204, 7, v18
  v_lshl_add_u32 v205, v205, 7, v18
  s_mov_b32 exec_hi, 0x0000ffff
  v_lshl_add_u32 v206, v206, 7, v18
  v_lshl_add_u32 v207, v207, 7, v18
  s_mov_b32 exec_lo, 0
  s_mov_b32 exec_hi, 0xffff0000
  v_mov_b32 v207, v205
  v_mov_b32 v206, v205
  s_mov_b32 exec_hi, 0x00ff0000
  v_mov_b32 v206, v204
  s_mov_b64 exec, -1
  s_add_u32 m0, s74, -16896
  s_nop 0
  buffer_load_dwordx4 v204, s[32:35], 0 offen lds
  s_add_u32 m0, s74, -15840
  s_nop 0
  buffer_load_dwordx4 v205, s[32:35], 0 offen lds
  s_add_u32 m0, s74, -14784
  s_nop 0
  buffer_load_dwordx4 v206, s[32:35], 0 offen lds
  s_add_u32 m0, s74, -13728
  s_mov_b32 exec_hi, 0x00ffffff
  buffer_load_dwordx4 v207, s[32:35], 0 offen lds
  s_mov_b32 exec_hi, -1
  buffer_load_dwordx4 v[24:27], v17, s[28:31], s94 offen offset:0
  s_add_u32 s94, s94, 832
  s_branch L_uph
L_g0pf:
  s_waitcnt vmcnt(4) lgkmcnt(0)
  ds_add_u32 v1, v3 offset:0
  s_add_u32 m0, s95, 52672
  s_add_u32 s81, s95, 51536
  buffer_load_dwordx4 v48, s[36:39], s81 offen lds
  s_add_u32 m0, s95, 56768
  s_add_u32 s81, s95, 55632
  buffer_load_dwordx4 v48, s[36:39], s81 offen lds
  s_add_u32 m0, s95, 60864
  s_add_u32 s81, s95, 59728
  buffer_load_dwordx4 v48, s[36:39], s81 offen lds
  s_add_u32 m0, s95, 64960
  s_add_u32 s81, s95, 63824
  buffer_load_dwordx4 v48, s[36:39], s81 offen lds
  s_add_u32 m0, s96, 36288
  s_add_u32 s81, s96, 35152
  s_mov_b64 exec, s[82:83]
  buffer_load_dwordx4 v48, s[36:39], s81 offen lds
  s_mov_b64 exec, -1
  s_add_u32 m0, s95, 1024
  s_add_u32 s81, s95, 0
  buffer_load_dwordx4 v48, s[36:39], s81 offen lds
  s_add_u32 m0, s95, 5120
  s_add_u32 s81, s95, 4096
  buffer_load_dwordx4 v48, s[36:39], s81 offen lds
  s_add_u32 m0, s95, 9216
  s_add_u32 s81, s95, 8192
  buffer_load_dwordx4 v48, s[36:39], s81 offen lds
  s_add_u32 m0, s95, 13312
  s_add_u32 s81, s95, 12288
  buffer_load_dwordx4 v48, s[36:39], s81 offen lds
  s_waitcnt vmcnt(4) lgkmcnt(0)
  ds_add_u32 v1, v3 offset:4
  s_add_u32 m0, s95, 17408
  s_add_u32 s81, s95, 16384
  buffer_load_dwordx4 v48, s[36:39], s81 offen lds
  s_add_u32 m0, s95, 21504
  s_add_u32 s81, s95, 20480
  buffer_load_dwordx4 v48, s[36:39], s81 offen lds
  s_add_u32 m0, s95, 25600
  s_add_u32 s81, s95, 24576
  buffer_load_dwordx4 v48, s[36:39], s81 offen lds
  s_add_u32 m0, s95, 29696
  s_add_u32 s81, s95, 28672
  buffer_load_dwordx4 v48, s[36:39], s81 offen lds
  s_add_u32 m0, s96, 1024
  s_add_u32 s81, s96, 0
  s_mov_b64 exec, s[82:83]
  buffer_load_dwordx4 v48, s[36:39], s81 offen lds
  s_mov_b64 exec, -1
  s_add_u32 s94, s94, 832
  s_add_u32 s77, s77, 24
  buffer_load_dwordx4 v[24:27], v17, s[28:31], s94 offen offset:0
  s_add_u32 s94, s94, 832
  buffer_load_dword v21, v20, s[28:31], s77 offen
  s_cmp_eq_u32 s77, s73
  s_cselect_b32 s73, 0x7000000, s73
  s_cselect_b32 s77, 0x7000000, s77
  s_add_u32 s77, s77, 24
  s_min_u32 s77, s77, s73
  s_waitcnt vmcnt(2) lgkmcnt(0)
  ds_add_u32 v1, v3 offset:8
  s_mov_b32 s97, 0
L_csync4:
  ds_read_b32 v4, v2 offset:8
  s_waitcnt lgkmcnt(0)
  v_cmp_gt_u32 vcc, 4, v4
  s_cbranch_vccnz L_csync4
  s_cmp_ge_u32 s79, 2
  s_cbranch_scc1 L_chunk2
L_chunk0:
  ds_read_u16_d16_hi v216, v49 offset:0
  ds_read_u16_d16_hi v218, v49 offset:648
  ds_read_u16_d16_hi v220, v49 offset:216
  ds_read_u16_d16_hi v222, v49 offset:864
  ds_read_u16_d16_hi v224, v49 offset:432
  ds_read_u16_d16_hi v226, v49 offset:1080
  ds_read_u16_d16_hi v228, v49 offset:8
  ds_read_u16_d16_hi v229, v49 offset:208
  ds_read_u16_d16_hi v230, v49 offset:656
  ds_read_u16_d16_hi v231, v49 offset:856
  s_waitcnt lgkmcnt(8)
  v_mov_b32 v85, v218
  v_mov_b32 v84, v216
  v_max3_f32 v62, v62, abs(v84), abs(v85)
  ds_read_u16_d16_hi v232, v49 offset:32
  ds_read_u16_d16_hi v233, v49 offset:832
  ds_read_u16_d16_hi v234, v49 offset:632
  ds_read_u16_d16_hi v235, v49 offset:232
  s_waitcnt lgkmcnt(10)
  v_mov_b32 v87, v222
  v_mov_b32 v86, v220
  v_max3_f32 v62, v62, abs(v86), abs(v87)
  ds_read_u16_d16_hi v236, v49 offset:16
  ds_read_u16_d16_hi v237, v49 offset:416
  ds_read_u16_d16_hi v238, v49 offset:664
  ds_read_u16_d16_hi v239, v49 offset:1064
  s_waitcnt lgkmcnt(12)
  v_mov_b32 v89, v226
  v_mov_b32 v88, v224
  v_max3_f32 v62, v62, abs(v88), abs(v89)
  ds_read_u16_d16_hi v216, v49 offset:40
  ds_read_u16_d16_hi v217, v49 offset:1040
  ds_read_u16_d16_hi v218, v49 offset:640
  ds_read_u16_d16_hi v219, v49 offset:440
  s_waitcnt lgkmcnt(12)
  v_add_f32 v91, v230, v231
  v_add_f32 v90, v228, v229
  v_max3_f32 v62, v62, abs(v90), abs(v91)
  ds_read_u16_d16_hi v220, v49 offset:224
  ds_read_u16_d16_hi v221, v49 offset:424
  ds_read_u16_d16_hi v222, v49 offset:872
  ds_read_u16_d16_hi v223, v49 offset:1072
  s_waitcnt lgkmcnt(12)
  v_add_f32 v93, v234, v235
  v_add_f32 v92, v232, v233
  v_max3_f32 v62, v62, abs(v92), abs(v93)
  ds_read_u16_d16_hi v224, v49 offset:248
  ds_read_u16_d16_hi v225, v49 offset:1048
  ds_read_u16_d16_hi v226, v49 offset:848
  ds_read_u16_d16_hi v227, v49 offset:448
  s_waitcnt lgkmcnt(12)
  v_add_f32 v95, v238, v239
  v_add_f32 v94, v236, v237
  v_max3_f32 v62, v62, abs(v94), abs(v95)
  ds_read_u16_d16_hi v228, v50 offset:48
  ds_read_u16_d16_hi v229, v51 offset:1248
  ds_read_u16_d16_hi v230, v50 offset:672
  ds_read_u16_d16_hi v231, v51 offset:1272
  s_waitcnt lgkmcnt(12)
  v_add_f32 v97, v218, v219
  v_add_f32 v96, v216, v217
  v_max3_f32 v62, v62, abs(v96), abs(v97)
  ds_read_u16_d16_hi v232, v50 offset:256
  ds_read_u16_d16_hi v233, v51 offset:1256
  ds_read_u16_d16_hi v234, v50 offset:880
  ds_read_u16_d16_hi v235, v51 offset:1280
  s_waitcnt lgkmcnt(12)
  v_add_f32 v99, v222, v223
  v_add_f32 v98, v220, v221
  v_max3_f32 v62, v62, abs(v98), abs(v99)
  ds_read_u16_d16_hi v236, v50 offset:464
  ds_read_u16_d16_hi v237, v51 offset:1264
  ds_read_u16_d16_hi v238, v50 offset:1088
  ds_read_u16_d16_hi v239, v51 offset:1288
  s_waitcnt lgkmcnt(12)
  v_add_f32 v101, v226, v227
  v_add_f32 v100, v224, v225
  v_max3_f32 v62, v62, abs(v100), abs(v101)
  s_waitcnt lgkmcnt(8)
  v_add_f32 v103, v230, v231
  v_add_f32 v102, v228, v229
  v_max3_f32 v62, v62, abs(v102), abs(v103)
  s_waitcnt lgkmcnt(4)
  v_add_f32 v105, v234, v235
  v_add_f32 v104, v232, v233
  v_max3_f32 v62, v62, abs(v104), abs(v105)
  s_waitcnt lgkmcnt(0)
  v_add_f32 v107, v238, v239
  v_add_f32 v106, v236, v237
  v_max3_f32 v62, v62, abs(v106), abs(v107)
  s_cmp_lg_u32 s97, 0
  s_cbranch_scc1 L_uconv0
L_chunk1:
  ds_read_u16_d16_hi v216, v49 offset:24
  ds_read_u16_d16_hi v217, v49 offset:624
  ds_read_u16_d16_hi v218, v49 offset:240
  ds_read_u16_d16_hi v219, v49 offset:840
  ds_read_u16_d16_hi v220, v49 offset:456
  ds_read_u16_d16_hi v221, v49 offset:1056
  ds_read_u16_d16_hi v222, v60 offset:1296
  ds_read_u16_d16_hi v223, v61 offset:1296
  ds_read_u16_d16_hi v224, v52 offset:50
  ds_read_u16_d16_hi v225, v53 offset:1300
  ds_read_u16_d16_hi v226, v52 offset:674
  ds_read_u16_d16_hi v227, v53 offset:1324
  ds_read_u16_d16_hi v228, v52 offset:258
  ds_read_u16_d16_hi v229, v53 offset:1308
  ds_read_u16_d16_hi v230, v52 offset:882
  ds_read_u16_d16_hi v231, v53 offset:1332
  s_waitcnt lgkmcnt(12)
  v_add_f32 v109, v218, v219
  v_add_f32 v108, v216, v217
  v_max3_f32 v62, v62, abs(v108), abs(v109)
  ds_read_u16_d16_hi v232, v52 offset:466
  ds_read_u16_d16_hi v233, v53 offset:1316
  ds_read_u16_d16_hi v234, v52 offset:1090
  ds_read_u16_d16_hi v235, v53 offset:1340
  s_waitcnt lgkmcnt(12)
  v_add_f32 v111, v222, v223
  v_add_f32 v110, v220, v221
  v_max3_f32 v62, v62, abs(v110), abs(v111)
  ds_read_u16_d16_hi v236, v54 offset:2
  ds_read_u16_d16_hi v237, v55 offset:52
  ds_read_u16_d16_hi v238, v54 offset:650
  ds_read_u16_d16_hi v239, v55 offset:700
  s_waitcnt lgkmcnt(12)
  v_add_f32 v113, v226, v227
  v_add_f32 v112, v224, v225
  v_max3_f32 v62, v62, abs(v112), abs(v113)
  ds_read_u16_d16_hi v216, v54 offset:26
  ds_read_u16_d16_hi v217, v55 offset:676
  ds_read_u16_d16_hi v218, v54 offset:626
  ds_read_u16_d16_hi v219, v55 offset:76
  s_waitcnt lgkmcnt(12)
  v_add_f32 v115, v230, v231
  v_add_f32 v114, v228, v229
  v_max3_f32 v62, v62, abs(v114), abs(v115)
  ds_read_u16_d16_hi v220, v54 offset:10
  ds_read_u16_d16_hi v221, v55 offset:260
  ds_read_u16_d16_hi v222, v54 offset:658
  ds_read_u16_d16_hi v223, v55 offset:908
  s_waitcnt lgkmcnt(12)
  v_add_f32 v117, v234, v235
  v_add_f32 v116, v232, v233
  v_max3_f32 v62, v62, abs(v116), abs(v117)
  ds_read_u16_d16_hi v224, v54 offset:34
  ds_read_u16_d16_hi v225, v55 offset:884
  ds_read_u16_d16_hi v226, v54 offset:634
  ds_read_u16_d16_hi v227, v55 offset:284
  s_waitcnt lgkmcnt(12)
  v_add_f32 v119, v238, v239
  v_add_f32 v118, v236, v237
  v_max3_f32 v62, v62, abs(v118), abs(v119)
  ds_read_u16_d16_hi v228, v54 offset:18
  ds_read_u16_d16_hi v229, v55 offset:468
  ds_read_u16_d16_hi v230, v54 offset:666
  ds_read_u16_d16_hi v231, v55 offset:1116
  s_waitcnt lgkmcnt(12)
  v_add_f32 v121, v218, v219
  v_add_f32 v120, v216, v217
  v_max3_f32 v62, v62, abs(v120), abs(v121)
  ds_read_u16_d16_hi v232, v54 offset:42
  ds_read_u16_d16_hi v233, v55 offset:1092
  ds_read_u16_d16_hi v234, v54 offset:642
  ds_read_u16_d16_hi v235, v55 offset:492
  s_waitcnt lgkmcnt(12)
  v_add_f32 v123, v222, v223
  v_add_f32 v122, v220, v221
  v_max3_f32 v62, v62, abs(v122), abs(v123)
  ds_read_u16_d16_hi v236, v54 offset:210
  ds_read_u16_d16_hi v237, v55 offset:60
  ds_read_u16_d16_hi v238, v54 offset:858
  ds_read_u16_d16_hi v239, v55 offset:708
  s_waitcnt lgkmcnt(12)
  v_add_f32 v125, v226, v227
  v_add_f32 v124, v224, v225
  v_max3_f32 v62, v62, abs(v124), abs(v125)
  s_waitcnt lgkmcnt(8)
  v_add_f32 v127, v230, v231
  v_add_f32 v126, v228, v229
  v_max3_f32 v62, v62, abs(v126), abs(v127)
  s_waitcnt lgkmcnt(4)
  v_add_f32 v129, v234, v235
  v_add_f32 v128, v232, v233
  v_max3_f32 v62, v62, abs(v128), abs(v129)
  s_waitcnt lgkmcnt(0)
  v_add_f32 v131, v238, v239
  v_add_f32 v130, v236, v237
  v_max3_f32 v62, v62, abs(v130), abs(v131)
  s_cmp_lg_u32 s97, 0
  s_cbranch_scc1 L_uconv1
  s_branch L_w1conv
L_chunk2:
  ds_read_u16_d16_hi v216, v54 offset:234
  ds_read_u16_d16_hi v217, v55 offset:684
  ds_read_u16_d16_hi v218, v54 offset:834
  ds_read_u16_d16_hi v219, v55 offset:84
  ds_read_u16_d16_hi v220, v54 offset:218
  ds_read_u16_d16_hi v221, v55 offset:268
  ds_read_u16_d16_hi v222, v54 offset:866
  ds_read_u16_d16_hi v223, v55 offset:916
  ds_read_u16_d16_hi v224, v54 offset:242
  ds_read_u16_d16_hi v225, v55 offset:892
  ds_read_u16_d16_hi v226, v54 offset:842
  ds_read_u16_d16_hi v227, v55 offset:292
  ds_read_u16_d16_hi v228, v54 offset:226
  ds_read_u16_d16_hi v229, v55 offset:476
  ds_read_u16_d16_hi v230, v54 offset:874
  ds_read_u16_d16_hi v231, v55 offset:1124
  s_waitcnt lgkmcnt(12)
  v_add_f32 v85, v218, v219
  v_add_f32 v84, v216, v217
  v_max3_f32 v62, v62, abs(v84), abs(v85)
  ds_read_u16_d16_hi v232, v54 offset:250
  ds_read_u16_d16_hi v233, v55 offset:1100
  ds_read_u16_d16_hi v234, v54 offset:850
  ds_read_u16_d16_hi v235, v55 offset:500
  s_waitcnt lgkmcnt(12)
  v_add_f32 v87, v222, v223
  v_add_f32 v86, v220, v221
  v_max3_f32 v62, v62, abs(v86), abs(v87)
  ds_read_u16_d16_hi v236, v54 offset:418
  ds_read_u16_d16_hi v237, v55 offset:68
  ds_read_u16_d16_hi v238, v54 offset:1066
  ds_read_u16_d16_hi v239, v55 offset:716
  s_waitcnt lgkmcnt(12)
  v_add_f32 v89, v226, v227
  v_add_f32 v88, v224, v225
  v_max3_f32 v62, v62, abs(v88), abs(v89)
  ds_read_u16_d16_hi v216, v54 offset:442
  ds_read_u16_d16_hi v217, v55 offset:692
  ds_read_u16_d16_hi v218, v54 offset:1042
  ds_read_u16_d16_hi v219, v55 offset:92
  s_waitcnt lgkmcnt(12)
  v_add_f32 v91, v230, v231
  v_add_f32 v90, v228, v229
  v_max3_f32 v62, v62, abs(v90), abs(v91)
  ds_read_u16_d16_hi v220, v54 offset:426
  ds_read_u16_d16_hi v221, v55 offset:276
  ds_read_u16_d16_hi v222, v54 offset:1074
  ds_read_u16_d16_hi v223, v55 offset:924
  s_waitcnt lgkmcnt(12)
  v_add_f32 v93, v234, v235
  v_add_f32 v92, v232, v233
  v_max3_f32 v62, v62, abs(v92), abs(v93)
  ds_read_u16_d16_hi v224, v54 offset:450
  ds_read_u16_d16_hi v225, v55 offset:900
  ds_read_u16_d16_hi v226, v54 offset:1050
  ds_read_u16_d16_hi v227, v55 offset:300
  s_waitcnt lgkmcnt(12)
  v_add_f32 v95, v238, v239
  v_add_f32 v94, v236, v237
  v_max3_f32 v62, v62, abs(v94), abs(v95)
  ds_read_u16_d16_hi v228, v54 offset:434
  ds_read_u16_d16_hi v229, v55 offset:484
  ds_read_u16_d16_hi v230, v54 offset:1082
  ds_read_u16_d16_hi v231, v55 offset:1132
  s_waitcnt lgkmcnt(12)
  v_add_f32 v97, v218, v219
  v_add_f32 v96, v216, v217
  v_max3_f32 v62, v62, abs(v96), abs(v97)
  ds_read_u16_d16_hi v232, v54 offset:458
  ds_read_u16_d16_hi v233, v55 offset:1108
  ds_read_u16_d16_hi v234, v54 offset:1058
  ds_read_u16_d16_hi v235, v55 offset:508
  s_waitcnt lgkmcnt(12)
  v_add_f32 v99, v222, v223
  v_add_f32 v98, v220, v221
  v_max3_f32 v62, v62, abs(v98), abs(v99)
  ds_read_u16_d16_hi v236, v56 offset:4
  ds_read_u16_d16_hi v237, v57 offset:104
  ds_read_u16_d16_hi v238, v58 offset:652
  ds_read_u16_d16_hi v239, v59 offset:752
  s_waitcnt lgkmcnt(12)
  v_add_f32 v101, v226, v227
  v_add_f32 v100, v224, v225
  v_max3_f32 v62, v62, abs(v100), abs(v101)
  s_waitcnt lgkmcnt(8)
  v_add_f32 v103, v230, v231
  v_add_f32 v102, v228, v229
  v_max3_f32 v62, v62, abs(v102), abs(v103)
  s_waitcnt lgkmcnt(4)
  v_add_f32 v105, v234, v235
  v_add_f32 v104, v232, v233
  v_max3_f32 v62, v62, abs(v104), abs(v105)
  s_waitcnt lgkmcnt(0)
  v_add_f32 v107, v238, v239
  v_add_f32 v106, v236, v237
  v_max3_f32 v62, v62, abs(v106), abs(v107)
  s_cmp_lg_u32 s97, 0
  s_cbranch_scc1 L_uconv0
L_chunk3:
  ds_read_u16_d16_hi v216, v56 offset:220
  ds_read_u16_d16_hi v217, v57 offset:320
  ds_read_u16_d16_hi v218, v58 offset:868
  ds_read_u16_d16_hi v219, v59 offset:968
  ds_read_u16_d16_hi v220, v56 offset:436
  ds_read_u16_d16_hi v221, v57 offset:536
  ds_read_u16_d16_hi v222, v58 offset:1084
  ds_read_u16_d16_hi v223, v59 offset:1184
  ds_read_u16_d16_hi v224, v56 offset:12
  ds_read_u16_d16_hi v225, v57 offset:312
  ds_read_u16_d16_hi v226, v58 offset:660
  ds_read_u16_d16_hi v227, v59 offset:960
  ds_read_u16_d16_hi v228, v58 offset:36
  ds_read_u16_d16_hi v229, v59 offset:936
  ds_read_u16_d16_hi v230, v56 offset:636
  ds_read_u16_d16_hi v231, v57 offset:336
  s_waitcnt lgkmcnt(12)
  v_add_f32 v109, v218, v219
  v_add_f32 v108, v216, v217
  v_max3_f32 v62, v62, abs(v108), abs(v109)
  ds_read_u16_d16_hi v232, v56 offset:20
  ds_read_u16_d16_hi v233, v57 offset:520
  ds_read_u16_d16_hi v234, v58 offset:668
  ds_read_u16_d16_hi v235, v59 offset:1168
  s_waitcnt lgkmcnt(12)
  v_add_f32 v111, v222, v223
  v_add_f32 v110, v220, v221
  v_max3_f32 v62, v62, abs(v110), abs(v111)
  ds_read_u16_d16_hi v236, v58 offset:44
  ds_read_u16_d16_hi v237, v59 offset:1144
  ds_read_u16_d16_hi v238, v56 offset:644
  ds_read_u16_d16_hi v239, v57 offset:544
  s_waitcnt lgkmcnt(12)
  v_add_f32 v113, v226, v227
  v_add_f32 v112, v224, v225
  v_max3_f32 v62, v62, abs(v112), abs(v113)
  ds_read_u16_d16_hi v216, v56 offset:228
  ds_read_u16_d16_hi v217, v57 offset:528
  ds_read_u16_d16_hi v218, v58 offset:876
  ds_read_u16_d16_hi v219, v59 offset:1176
  s_waitcnt lgkmcnt(12)
  v_add_f32 v115, v230, v231
  v_add_f32 v114, v228, v229
  v_max3_f32 v62, v62, abs(v114), abs(v115)
  ds_read_u16_d16_hi v220, v58 offset:252
  ds_read_u16_d16_hi v221, v59 offset:1152
  ds_read_u16_d16_hi v222, v56 offset:852
  ds_read_u16_d16_hi v223, v57 offset:552
  s_waitcnt lgkmcnt(12)
  v_add_f32 v117, v234, v235
  v_add_f32 v116, v232, v233
  v_max3_f32 v62, v62, abs(v116), abs(v117)
  ds_read_u16_d16_hi v224, v65 offset:0
  ds_read_u16_d16_hi v225, v65 offset:8
  ds_read_u16_d16_hi v226, v65 offset:16
  ds_read_u16_d16_hi v227, v65 offset:24
  ds_read_u16_d16_hi v228, v65 offset:32
  ds_read_u16_d16_hi v229, v65 offset:40
  ds_read_u16_d16_hi v230, v64 offset:48
  ds_read_u16_d16_hi v231, v67
  s_waitcnt lgkmcnt(14)
  v_add_f32 v119, v238, v239
  v_add_f32 v118, v236, v237
  v_max3_f32 v62, v62, abs(v118), abs(v119)
  s_waitcnt lgkmcnt(12)
  v_add_f32 v121, v218, v219
  v_add_f32 v120, v216, v217
  v_max3_f32 v62, v62, abs(v120), abs(v121)
  s_waitcnt lgkmcnt(8)
  v_add_f32 v123, v222, v223
  v_add_f32 v122, v220, v221
  v_max3_f32 v62, v62, abs(v122), abs(v123)
  s_cmp_lg_u32 s97, 0
  s_cbranch_scc1 L_uconv1
L_w1conv:
  v_max_u32_dpp v62, v62, v62 row_shr:1 row_mask:0xf bank_mask:0xf
  s_nop 1
  v_max_u32_dpp v62, v62, v62 row_shr:2 row_mask:0xf bank_mask:0xf
  s_nop 1
  v_max_u32_dpp v62, v62, v62 row_shr:4 row_mask:0xf bank_mask:0xf
  s_nop 1
  v_max_u32_dpp v62, v62, v62 row_shr:8 row_mask:0xf bank_mask:0xf
  s_nop 1
  v_max_u32_dpp v62, v62, v62 row_bcast:15 row_mask:0xa bank_mask:0xf
  s_nop 1
  v_max_u32_dpp v62, v62, v62 row_bcast:31 row_mask:0xc bank_mask:0xf
  s_nop 0
  v_readlane_b32 s68, v62, 63
  s_nop 1
  v_mov_b32 v62, s68
  ds_max_u32 v1, v62 offset:20
  ds_add_u32 v1, v3 offset:16
  v_add_u32 v49, v49, v247
  v_add_u32 v50, v50, v247
  v_add_u32 v51, v51, v247
  v_add_u32 v52, v52, v247
  v_add_u32 v53, v53, v247
  v_add_u32 v54, v54, v247
  v_add_u32 v55, v55, v247
  v_add_u32 v56, v56, v247
  v_add_u32 v57, v57, v247
  v_add_u32 v58, v58, v247
  v_add_u32 v59, v59, v247
  v_add_u32 v60, v60, v247
  v_add_u32 v61, v61, v247
L_csync5:
  ds_read_b64 v[40:41], v2 offset:16
  s_waitcnt lgkmcnt(0)
  v_cmp_gt_u32 vcc, 4, v40
  s_cbranch_vccnz L_csync5
  v_readfirstlane_b32 s70, v41
  s_nop 0
  s_lshr_b32 s70, s70, 23
  s_sub_i32 s70, 141, s70
  s_min_i32 s70, s70, 40
  s_add_i32 s51, s70, 127
  s_lshl_b32 s51, s51, 23
  v_fma_mixlo_f16 v132, v84, s51, 0
  v_fma_mixlo_f16 v133, v86, s51, 0
  v_fma_mixlo_f16 v134, v88, s51, 0
  v_fma_mixlo_f16 v135, v90, s51, 0
  v_fma_mixhi_f16 v132, v85, s51, 0
  v_fma_mixhi_f16 v133, v87, s51, 0
  v_fma_mixhi_f16 v134, v89, s51, 0
  v_fma_mixhi_f16 v135, v91, s51, 0
  v_fma_mixlo_f16 v136, v92, s51, 0
  v_fma_mixlo_f16 v137, v94, s51, 0
  v_fma_mixlo_f16 v138, v96, s51, 0
  v_fma_mixlo_f16 v139, v98, s51, 0
  v_fma_mixhi_f16 v136, v93, s51, 0
  v_fma_mixhi_f16 v137, v95, s51, 0
  v_fma_mixhi_f16 v138, v97, s51, 0
  v_fma_mixhi_f16 v139, v99, s51, 0
  ds_write_b128 v63, v[132:135] offset:0
  v_fma_mixlo_f16 v140, v100, s51, 0
  v_fma_mixlo_f16 v141, v102, s51, 0
  v_fma_mixlo_f16 v142, v104, s51, 0
  v_fma_mixlo_f16 v143, v106, s51, 0
  v_fma_mixhi_f16 v140, v101, s51, 0
  v_fma_mixhi_f16 v141, v103, s51, 0
  v_fma_mixhi_f16 v142, v105, s51, 0
  v_fma_mixhi_f16 v143, v107, s51, 0
  ds_write_b128 v63, v[136:139] offset:1024
  v_fma_mixlo_f16 v144, v108, s51, 0
  v_fma_mixlo_f16 v145, v110, s51, 0
  v_fma_mixlo_f16 v146, v112, s51, 0
  v_fma_mixlo_f16 v147, v114, s51, 0
  v_fma_mixhi_f16 v144, v109, s51, 0
  v_fma_mixhi_f16 v145, v111, s51, 0
  v_fma_mixhi_f16 v146, v113, s51, 0
  v_fma_mixhi_f16 v147, v115, s51, 0
  ds_write_b128 v63, v[140:143] offset:2048
  v_fma_mixlo_f16 v148, v116, s51, 0
  v_fma_mixlo_f16 v149, v118, s51, 0
  v_fma_mixlo_f16 v150, v120, s51, 0
  v_fma_mixlo_f16 v151, v122, s51, 0
  v_fma_mixhi_f16 v148, v117, s51, 0
  v_fma_mixhi_f16 v149, v119, s51, 0
  v_fma_mixhi_f16 v150, v121, s51, 0
  v_fma_mixhi_f16 v151, v123, s51, 0
  ds_write_b128 v63, v[144:147] offset:3072
  ds_write_b128 v63, v[148:151] offset:4096
  s_cmp_ge_u32 s79, 2
  s_cbranch_scc1 L_w1x
  v_fma_mixlo_f16 v152, v124, s51, 0
  v_fma_mixlo_f16 v153, v126, s51, 0
  v_fma_mixlo_f16 v154, v128, s51, 0
  v_fma_mixlo_f16 v155, v130, s51, 0
  v_fma_mixhi_f16 v152, v125, s51, 0
  v_fma_mixhi_f16 v153, v127, s51, 0
  v_fma_mixhi_f16 v154, v129, s51, 0
  v_fma_mixhi_f16 v155, v131, s51, 0
  ds_write_b128 v63, v[152:155] offset:5120
L_w1x:
L_uph:
L_csync6:
  ds_read_b64 v[40:41], v2 offset:24
  s_waitcnt lgkmcnt(0)
  v_cmp_gt_u32 vcc, 4, v40
  s_cbranch_vccnz L_csync6
  v_readfirstlane_b32 s71, v41
  s_nop 0
  s_lshr_b32 s71, s71, 23
  s_sub_i32 s71, 140, s71
  s_min_i32 s71, s71, 40
  s_add_i32 s51, s71, 127
  s_lshl_b32 s51, s51, 23
  s_mov_b32 s97, 1
  s_lshr_b32 s69, s3, 1
  s_cmp_eq_u32 s69, 0
  s_cbranch_scc1 L_chunk0
  s_cmp_eq_u32 s69, 1
  s_cbranch_scc1 L_chunk1
  s_cmp_eq_u32 s69, 2
  s_cbranch_scc1 L_chunk2
  s_branch L_chunk3
L_uconv0:
  v_fma_mixlo_f16 v132, v84, s51, 0
  v_fma_mixlo_f16 v133, v86, s51, 0
  v_fma_mixlo_f16 v134, v88, s51, 0
  v_fma_mixlo_f16 v135, v90, s51, 0
  v_fma_mixhi_f16 v132, v85, s51, 0
  v_fma_mixhi_f16 v133, v87, s51, 0
  v_fma_mixhi_f16 v134, v89, s51, 0
  v_fma_mixhi_f16 v135, v91, s51, 0
L_csync7:
  ds_read_b64 v[40:41], v2 offset:16
  s_waitcnt lgkmcnt(0)
  v_cmp_gt_u32 vcc, 4, v40
  s_cbranch_vccnz L_csync7
  v_readfirstlane_b32 s70, v41
  s_nop 0
  s_lshr_b32 s70, s70, 23
  s_sub_i32 s70, 141, s70
  s_min_i32 s70, s70, 40
  ds_write_b128 v66, v[132:135] offset:0
  v_fma_mixlo_f16 v136, v92, s51, 0
  v_fma_mixlo_f16 v137, v94, s51, 0
  v_fma_mixlo_f16 v138, v96, s51, 0
  v_fma_mixlo_f16 v139, v98, s51, 0
  v_fma_mixhi_f16 v136, v93, s51, 0
  v_fma_mixhi_f16 v137, v95, s51, 0
  v_fma_mixhi_f16 v138, v97, s51, 0
  v_fma_mixhi_f16 v139, v99, s51, 0
  ds_write_b128 v66, v[136:139] offset:1024
  v_fma_mixlo_f16 v140, v100, s51, 0
  v_fma_mixlo_f16 v141, v102, s51, 0
  v_fma_mixlo_f16 v142, v104, s51, 0
  v_fma_mixlo_f16 v143, v106, s51, 0
  v_fma_mixhi_f16 v140, v101, s51, 0
  v_fma_mixhi_f16 v141, v103, s51, 0
  v_fma_mixhi_f16 v142, v105, s51, 0
  v_fma_mixhi_f16 v143, v107, s51, 0
  ds_write_b128 v66, v[140:143] offset:2048
  s_branch L_built
L_uconv1:
  v_fma_mixlo_f16 v144, v108, s51, 0
  v_fma_mixlo_f16 v145, v110, s51, 0
  v_fma_mixlo_f16 v146, v112, s51, 0
  v_fma_mixlo_f16 v147, v114, s51, 0
  v_fma_mixhi_f16 v144, v109, s51, 0
  v_fma_mixhi_f16 v145, v111, s51, 0
  v_fma_mixhi_f16 v146, v113, s51, 0
  v_fma_mixhi_f16 v147, v115, s51, 0
L_csync8:
  ds_read_b64 v[40:41], v2 offset:16
  s_waitcnt lgkmcnt(0)
  v_cmp_gt_u32 vcc, 4, v40
  s_cbranch_vccnz L_csync8
  v_readfirstlane_b32 s70, v41
  s_nop 0
  s_lshr_b32 s70, s70, 23
  s_sub_i32 s70, 141, s70
  s_min_i32 s70, s70, 40
  ds_write_b128 v66, v[144:147] offset:3072
  v_fma_mixlo_f16 v148, v116, s51, 0
  v_fma_mixlo_f16 v149, v118, s51, 0
  v_fma_mixlo_f16 v150, v120, s51, 0
  v_fma_mixlo_f16 v151, v122, s51, 0
  v_fma_mixhi_f16 v148, v117, s51, 0
  v_fma_mixhi_f16 v149, v119, s51, 0
  v_fma_mixhi_f16 v150, v121, s51, 0
  v_fma_mixhi_f16 v151, v123, s51, 0
  ds_write_b128 v66, v[148:151] offset:4096
  s_cmp_lg_u32 s84, 0
  s_cbranch_scc1 L_ulin
  v_fma_mixlo_f16 v152, v124, s51, 0
  v_fma_mixlo_f16 v153, v126, s51, 0
  v_fma_mixlo_f16 v154, v128, s51, 0
  v_fma_mixlo_f16 v155, v130, s51, 0
  v_fma_mixhi_f16 v152, v125, s51, 0
  v_fma_mixhi_f16 v153, v127, s51, 0
  v_fma_mixhi_f16 v154, v129, s51, 0
  v_fma_mixhi_f16 v155, v131, s51, 0
  ds_write_b128 v66, v[152:155] offset:5120
  s_branch L_built
L_ulin:
  v_mul_f32 v224, s51, v224
  v_mul_f32 v225, s51, v225
  v_mul_f32 v226, s51, v226
  v_mul_f32 v227, s51, v227
  v_mul_f32 v228, s51, v228
  v_mul_f32 v229, s51, v229
  v_mul_f32 v230, s51, v230
  v_mul_f32 v231, s51, v231
  v_cvt_pk_bf16_f32 v152, v224, v225
  v_cvt_pk_bf16_f32 v153, v226, v227
  v_cvt_pk_bf16_f32 v154, v228, v229
  v_cvt_pk_bf16_f32 v155, v230, v231
  ds_write_b128 v66, v[152:155] offset:5120
L_built:
  s_waitcnt vmcnt(1)
  v_mov_b32 v4, s84
  ds_add_u32 v1, v4 offset:36
  s_mov_b32 s60, s24
  s_and_b32 s61, s25, 0xffff
  s_mov_b32 s62, 268435456
  s_mov_b32 s63, 0x20000
  s_mov_b32 s64, s22
  s_and_b32 s65, s23, 0xffff
  s_mov_b32 s66, 256
  s_mov_b32 s67, 0x20000
  v_lshlrev_b32 v251, 2, v0
  s_mov_b64 exec, 0xff
  s_mov_b32 s81, 0x80000
  buffer_load_dword v255, v251, s[60:63], s81 offen
  buffer_load_dword v250, v251, s[64:67], 0 offen offset:128 sc1
  s_mov_b64 exec, -1
  v_mov_b32 v251, 0
  s_add_i32 s48, s70, s71
L_csync9:
  ds_read_b32 v4, v2 offset:36
  s_waitcnt lgkmcnt(0)
  v_cmp_gt_u32 vcc, 4, v4
  s_cbranch_vccnz L_csync9
  ds_read_u16_d16_hi v32, v7 offset:0
  ds_read_u16_d16_hi v33, v7 offset:128
  ds_read_u16_d16_hi v34, v7 offset:256
  ds_read_u16_d16_hi v35, v7 offset:384
  ds_read_u16_d16_hi v36, v7 offset:512
  ds_read_u16_d16_hi v37, v7 offset:640
  ds_read_u16_d16_hi v38, v7 offset:768
  ds_read_u16_d16_hi v39, v7 offset:896
  s_waitcnt lgkmcnt(0)
  v_cvt_pk_f16_f32 v43, v38, v39
  v_cvt_pk_f16_f32 v40, v32, v35
  v_cvt_pk_f16_f32 v41, v33, v36
  v_cvt_pk_f16_f32 v42, v34, v37
  ds_write_b128 v10, v[40:43]
  ds_read_b64_tr_b16 v[52:53], v8 offset:0
  ds_read_b64_tr_b16 v[54:55], v8 offset:512
  v_pk_mul_f16 v56, v40, v40 op_sel:[0,0] op_sel_hi:[1,1]
  v_pk_mul_f16 v57, v41, v41 op_sel:[0,0] op_sel_hi:[1,1]
  v_pk_mul_f16 v58, v42, v42 op_sel:[0,0] op_sel_hi:[1,1]
  v_pk_mul_f16 v59, v40, v41 op_sel:[0,0] op_sel_hi:[1,1]
  ds_read_b128 v[44:47], v11
  ds_read_b128 v[48:51], v12
  v_pk_mul_f16 v60, v40, v41 op_sel:[0,1] op_sel_hi:[1,0]
  v_pk_mul_f16 v61, v40, v42 op_sel:[0,0] op_sel_hi:[1,1]
  s_waitcnt vmcnt(2)
  v_lshlrev_b32 v21, 7, v21
  buffer_load_dword v255, v21, s[32:35], 0 offen
  buffer_load_dword v21, v20, s[28:31], s77 offen
  s_cmp_eq_u32 s77, s73
  s_cselect_b32 s73, 0x7000000, s73
  s_cselect_b32 s77, 0x7000000, s77
  s_add_u32 s77, s77, 24
  s_min_u32 s77, s77, s73
  s_mov_b64 exec, 131071
  buffer_load_dword v255, v19, s[44:47], s101 offen
  s_mov_b64 exec, -1
  s_add_u32 s101, s101, 1171456
  s_waitcnt lgkmcnt(0)
  s_barrier
  s_setprio 1
  ds_read_b128 v[216:219], v22
  ds_read_b128 v[240:243], v28 offset:46528
  ds_read_b128 v[128:131], v28 offset:35264
  ds_read_b128 v[84:87], v28 offset:0
  ds_read_b128 v[244:247], v30 offset:22528
  ds_read_b128 v[172:175], v31 offset:11264
  ds_read_b128 v[176:179], v31 offset:12288
  ds_read_b128 v[180:183], v31 offset:13312
  ds_read2_b32 v[220:221], v29 offset0:0 offset1:2
  ds_read2_b32 v[222:223], v29 offset0:64 offset1:66
  v_add_u32 v29, 2048, v29
  ds_read_b128 v[88:91], v28 offset:1024
  s_cmp_lg_u32 s84, 0
  s_cbranch_scc1 L_prf
  s_setprio 2
L_prf:
  s_waitcnt lgkmcnt(10)
  v_mfma_f32_16x16x32_f16 v[80:83], v[216:219], v[56:59], 0
  ds_read_b128 v[92:95], v28 offset:2048
  s_waitcnt lgkmcnt(10)
  v_mfma_f32_16x16x32_bf16 v[72:75], v[240:243], v[52:55], 0
  ds_read_b128 v[132:135], v28 offset:36288
  v_pk_mul_f16 v62, v40, v42 op_sel:[0,1] op_sel_hi:[1,0]
  v_pk_mul_f16 v63, v41, v42 op_sel:[0,0] op_sel_hi:[1,1]
  s_waitcnt lgkmcnt(10)
  v_mfma_f32_16x16x32_f16 v[72:75], v[128:131], v[56:59], v[72:75]
  ds_read_b128 v[136:139], v28 offset:37312
  s_waitcnt lgkmcnt(10)
  v_mfma_f32_16x16x32_f16 v[68:71], v[84:87], v[56:59], 0
  ds_read_b128 v[140:143], v28 offset:38336
  v_pk_mul_f16 v64, v41, v42 op_sel:[0,1] op_sel_hi:[1,0]
  s_waitcnt lgkmcnt(10)
  v_mfma_f32_16x16x32_bf16 v[76:79], v[244:247], v[52:55], 0
  ds_read_b128 v[144:147], v28 offset:39360
  v_pk_mul_f16 v65, v40, v43 op_sel:[0,0] op_sel_hi:[1,0]
  v_pk_mul_f16 v66, v41, v43 op_sel:[0,0] op_sel_hi:[1,0]
  s_waitcnt lgkmcnt(10)
  v_mfma_f32_16x16x32_f16 v[76:79], v[172:175], v[56:59], v[76:79]
  ds_read2_b32 v[224:225], v29 offset0:0 offset1:2
  ds_read2_b32 v[226:227], v29 offset0:64 offset1:66
  v_add_u32 v29, 2048, v29
  v_pk_mul_f16 v67, v42, v43 op_sel:[0,0] op_sel_hi:[1,0]
  s_waitcnt lgkmcnt(11)
  v_mfma_f32_16x16x32_f16 v[76:79], v[176:179], v[60:63], v[76:79]
  ds_read_b128 v[96:99], v28 offset:3072
  v_mul_f16_sdwa v52, v40, v40 dst_sel:WORD_0 dst_unused:UNUSED_PAD src0_sel:WORD_0 src1_sel:WORD_1
  v_mul_f16_sdwa v53, v42, v42 dst_sel:WORD_0 dst_unused:UNUSED_PAD src0_sel:WORD_0 src1_sel:WORD_1
  s_waitcnt lgkmcnt(11)
  v_mfma_f32_16x16x32_f16 v[76:79], v[180:183], v[64:67], v[76:79]
  ds_read_b128 v[100:103], v28 offset:4096
  v_alignbit_b32 v48, v48, v48, v13
  s_waitcnt lgkmcnt(10)
  v_smfmac_f32_16x16x64_f16 v[80:83], v[220:223], v[60:67], v16
  ds_read_b128 v[184:187], v31 offset:14336
  v_mul_f16_sdwa v52, v41, v41 dst_sel:WORD_1 dst_unused:UNUSED_PRESERVE src0_sel:WORD_0 src1_sel:WORD_1
  v_mul_f16_sdwa v53, v43, v43 dst_sel:WORD_1 dst_unused:UNUSED_PRESERVE src0_sel:WORD_0 src1_sel:WORD_1
  s_waitcnt lgkmcnt(10)
  v_mfma_f32_16x16x32_f16 v[68:71], v[88:91], v[60:63], v[68:71]
  ds_read_b128 v[188:191], v31 offset:15360
  v_pk_mul_f16 v54, v40, v47 op_sel:[0,0] op_sel_hi:[1,0]
  s_waitcnt lgkmcnt(10)
  v_mfma_f32_16x16x32_f16 v[68:71], v[92:95], v[64:67], v[68:71]
  ds_read_b128 v[192:195], v31 offset:16384
  v_pk_mul_f16 v55, v41, v47 op_sel:[0,0] op_sel_hi:[1,0]
  v_pk_mul_f16 v56, v42, v47 op_sel:[0,0] op_sel_hi:[1,0]
  s_waitcnt lgkmcnt(10)
  v_mfma_f32_16x16x32_f16 v[72:75], v[132:135], v[60:63], v[72:75]
  ds_read_b128 v[196:199], v31 offset:17408
  v_pk_mul_f16 v57, v40, v44 op_sel:[0,0] op_sel_hi:[1,1]
  v_pk_mul_f16 v58, v40, v44 op_sel:[0,1] op_sel_hi:[1,0]
  s_waitcnt lgkmcnt(10)
  v_mfma_f32_16x16x32_f16 v[72:75], v[136:139], v[64:67], v[72:75]
  ds_read2_b32 v[228:229], v29 offset0:0 offset1:2
  ds_read2_b32 v[230:231], v29 offset0:64 offset1:66
  v_add_u32 v29, 2048, v29
  v_pk_mul_f16 v59, v40, v45 op_sel:[0,0] op_sel_hi:[1,1]
  s_waitcnt lgkmcnt(11)
  v_mfma_f32_16x16x32_f16 v[72:75], v[140:143], v[52:55], v[72:75]
  ds_read_b128 v[104:107], v28 offset:5120
  v_pk_mul_f16 v60, v40, v45 op_sel:[0,1] op_sel_hi:[1,0]
  v_pk_mul_f16 v61, v40, v46 op_sel:[0,0] op_sel_hi:[1,1]
  s_waitcnt lgkmcnt(11)
  v_mfma_f32_16x16x32_f16 v[72:75], v[144:147], v[56:59], v[72:75]
  ds_read_b128 v[108:111], v28 offset:6144
  v_pk_mul_f16 v62, v40, v46 op_sel:[0,1] op_sel_hi:[1,0]
  s_waitcnt lgkmcnt(10)
  v_smfmac_f32_16x16x64_f16 v[80:83], v[224:227], v[52:59], v16
  ds_read_b128 v[148:151], v28 offset:40384
  v_pk_mul_f16 v63, v41, v44 op_sel:[0,0] op_sel_hi:[1,1]
  v_pk_mul_f16 v64, v41, v44 op_sel:[0,1] op_sel_hi:[1,0]
  s_waitcnt lgkmcnt(10)
  v_mfma_f32_16x16x32_f16 v[68:71], v[96:99], v[52:55], v[68:71]
  ds_read_b128 v[152:155], v28 offset:41408
  v_pk_mul_f16 v65, v41, v45 op_sel:[0,0] op_sel_hi:[1,1]
  s_waitcnt lgkmcnt(10)
  v_mfma_f32_16x16x32_f16 v[68:71], v[100:103], v[56:59], v[68:71]
  ds_read_b128 v[156:159], v28 offset:42432
  v_pk_mul_f16 v66, v41, v45 op_sel:[0,1] op_sel_hi:[1,0]
  v_pk_mul_f16 v67, v41, v46 op_sel:[0,0] op_sel_hi:[1,1]
  ds_write_b16 v15, v14 offset:4064
  s_waitcnt vmcnt(3)
  v_cmp_eq_u32 vcc, 0, v250
  s_nop 0
  s_and_b32 vcc_lo, vcc_lo, 0xff
  s_cbranch_scc0 L_cclr_ok
  s_mov_b32 s78, 0x40000
L_cclr:
  s_sub_u32 s78, s78, 1
  s_cbranch_scc1 L_cclr_ok
  v_lshlrev_b32 v250, 2, v0
  v_and_b32 v250, 31, v250
  buffer_load_dword v250, v250, s[64:67], 0 offen offset:128 sc1
  s_waitcnt vmcnt(0)
  v_cmp_eq_u32 vcc, 0, v250
  s_nop 0
  s_and_b32 vcc_lo, vcc_lo, 0xff
  s_cbranch_scc1 L_cclr
L_cclr_ok:
  v_lshl_add_u32 v24, v24, 7, v18
  v_lshl_add_u32 v25, v25, 7, v18
  s_mov_b32 exec_hi, 0x0000ffff
  v_lshl_add_u32 v26, v26, 7, v18
  v_lshl_add_u32 v27, v27, 7, v18
  s_mov_b32 exec_lo, 0
  s_mov_b32 exec_hi, 0xffff0000
  v_mov_b32 v27, v25
  v_mov_b32 v26, v25
  s_mov_b32 exec_hi, 0x00ff0000
  v_mov_b32 v26, v24
  s_mov_b64 exec, -1
  s_add_u32 m0, s74, -39488
  s_nop 0
  buffer_load_dwordx4 v24, s[32:35], 0 offen lds
  s_add_u32 m0, s74, -38432
  s_nop 0
  buffer_load_dwordx4 v25, s[32:35], 0 offen lds
  s_add_u32 m0, s74, -37376
  s_nop 0
  buffer_load_dwordx4 v26, s[32:35], 0 offen lds
  s_add_u32 m0, s74, -36320
  s_mov_b32 exec_hi, 0x00ffffff
  buffer_load_dwordx4 v27, s[32:35], 0 offen lds
  s_mov_b32 exec_hi, -1
  s_mov_b64 exec, 131071
  buffer_load_dword v255, v19, s[44:47], s101 offen
  s_mov_b64 exec, -1
  s_add_u32 s101, s101, 1171456
  s_sub_i32 s48, 0, s48
  s_mov_b32 s49, s48
  s_mov_b32 s97, 1
  s_mov_b32 s50, 1
  s_cmp_lg_u32 s3, 7
  s_cbranch_scc1 L_nw0
  s_mov_b32 s52, s16
  s_and_b32 s53, s17, 0xffff
  s_mov_b32 s54, 3328
  s_mov_b32 s55, 0x20000
  v_lshlrev_b32 v22, 7, v0
  buffer_load_dword v255, v22, s[52:55], 0 offen
L_nw0:
  s_waitcnt lgkmcnt(11)
  v_mfma_f32_16x16x32_f16 v[76:79], v[184:187], v[52:55], v[76:79]
  ds_read_b128 v[160:163], v28 offset:43456
  v_alignbit_b32 v49, v49, v49, v13
  v_alignbit_b32 v50, v50, v50, v13
  s_waitcnt lgkmcnt(11)
  v_mfma_f32_16x16x32_f16 v[76:79], v[188:191], v[56:59], v[76:79]
  ds_read2_b32 v[232:233], v29 offset0:0 offset1:2
  ds_read2_b32 v[234:235], v29 offset0:64 offset1:66
  v_add_u32 v29, 2048, v29
  v_pk_mul_f16 v52, v41, v46 op_sel:[0,1] op_sel_hi:[1,0]
  v_pk_mul_f16 v53, v42, v44 op_sel:[0,0] op_sel_hi:[1,1]
  s_waitcnt lgkmcnt(12)
  v_mfma_f32_16x16x32_f16 v[76:79], v[192:195], v[60:63], v[76:79]
  ds_read_b128 v[112:115], v28 offset:7168
  v_pk_mul_f16 v54, v42, v44 op_sel:[0,1] op_sel_hi:[1,0]
  v_pk_mul_f16 v55, v42, v45 op_sel:[0,0] op_sel_hi:[1,1]
  s_waitcnt lgkmcnt(12)
  v_mfma_f32_16x16x32_f16 v[76:79], v[196:199], v[64:67], v[76:79]
  ds_read_b128 v[116:119], v28 offset:8192
  v_pk_mul_f16 v56, v42, v45 op_sel:[0,1] op_sel_hi:[1,0]
  v_pk_mul_f16 v57, v42, v46 op_sel:[0,0] op_sel_hi:[1,1]
  s_waitcnt lgkmcnt(11)
  v_smfmac_f32_16x16x64_f16 v[80:83], v[228:231], v[60:67], v16
  ds_read_b128 v[200:203], v31 offset:18432
  v_pk_mul_f16 v58, v42, v46 op_sel:[0,1] op_sel_hi:[1,0]
  v_pk_mul_f16 v59, v40, v48 op_sel:[0,0] op_sel_hi:[1,1]
  s_waitcnt lgkmcnt(11)
  v_mfma_f32_16x16x32_f16 v[68:71], v[104:107], v[60:63], v[68:71]
  ds_read_b128 v[204:207], v31 offset:19456
  ds_read_u16_d16_hi v32, v7 offset:32
  ds_read_u16_d16_hi v33, v7 offset:160
  s_waitcnt lgkmcnt(13)
  v_mfma_f32_16x16x32_f16 v[68:71], v[108:111], v[64:67], v[68:71]
  ds_read_b128 v[164:167], v28 offset:44480
  ds_read_u16_d16_hi v34, v7 offset:288
  ds_read_u16_d16_hi v35, v7 offset:416
  s_waitcnt lgkmcnt(14)
  v_mfma_f32_16x16x32_f16 v[72:75], v[148:151], v[60:63], v[72:75]
  ds_read_b128 v[168:171], v28 offset:45504
  ds_read_u16_d16_hi v36, v7 offset:544
  ds_read_u16_d16_hi v37, v7 offset:672
  v_mfma_f32_16x16x32_f16 v[72:75], v[152:155], v[64:67], v[72:75]
  ds_read2_b32 v[236:237], v29 offset0:0 offset1:2
  ds_read2_b32 v[238:239], v29 offset0:64 offset1:66
  v_add_u32 v29, 2048, v29
  ds_read_u16_d16_hi v38, v7 offset:800
  ds_read_u16_d16_hi v39, v7 offset:928
  s_waitcnt lgkmcnt(14)
  v_mfma_f32_16x16x32_f16 v[72:75], v[156:159], v[52:55], v[72:75]
  ds_read_b128 v[120:123], v28 offset:9216
  v_pk_mul_f16 v60, v41, v49 op_sel:[0,0] op_sel_hi:[1,1]
  v_pk_mul_f16 v61, v42, v50 op_sel:[0,0] op_sel_hi:[1,1]
  v_mfma_f32_16x16x32_f16 v[72:75], v[160:163], v[56:59], v[72:75]
  ds_read_b128 v[124:127], v28 offset:10240
  v_pk_mul_f16 v62, v40, v49 op_sel:[0,0] op_sel_hi:[1,1]
  v_pk_mul_f16 v63, v40, v49 op_sel:[0,1] op_sel_hi:[1,0]
  v_smfmac_f32_16x16x64_f16 v[80:83], v[232:235], v[52:59], v16
  ds_read_b128 v[208:211], v31 offset:20480
  v_pk_mul_f16 v64, v40, v50 op_sel:[0,0] op_sel_hi:[1,1]
  v_pk_mul_f16 v65, v40, v50 op_sel:[0,1] op_sel_hi:[1,0]
  v_mfma_f32_16x16x32_f16 v[68:71], v[112:115], v[52:55], v[68:71]
  ds_read_b128 v[212:215], v31 offset:21504
  v_pk_mul_f16 v66, v41, v50 op_sel:[0,0] op_sel_hi:[1,1]
  v_pk_mul_f16 v67, v41, v50 op_sel:[0,1] op_sel_hi:[1,0]
  v_mfma_f32_16x16x32_f16 v[68:71], v[116:119], v[56:59], v[68:71]
  s_waitcnt lgkmcnt(4)
  v_cvt_pk_f16_f32 v43, v38, v39
  v_cvt_pk_f16_f32 v40, v32, v35
  v_mfma_f32_16x16x32_f16 v[76:79], v[200:203], v[52:55], v[76:79]
  ds_read_b64_tr_b16 v[52:53], v8 offset:32
  ds_read_b64_tr_b16 v[54:55], v8 offset:544
  v_mfma_f32_16x16x32_f16 v[76:79], v[204:207], v[56:59], v[76:79]
  v_cvt_pk_f16_f32 v41, v33, v36
  v_cvt_pk_f16_f32 v42, v34, v37
  v_mfma_f32_16x16x32_f16 v[72:75], v[164:167], v[60:63], v[72:75]
  ds_write_b128 v10, v[40:43]
  v_mfma_f32_16x16x32_f16 v[72:75], v[168:171], v[64:67], v[72:75]
  v_pk_mul_f16 v56, v40, v40 op_sel:[0,0] op_sel_hi:[1,1]
  v_pk_mul_f16 v57, v41, v41 op_sel:[0,0] op_sel_hi:[1,1]
  v_smfmac_f32_16x16x64_f16 v[80:83], v[236:239], v[60:67], v16
  v_pk_mul_f16 v58, v42, v42 op_sel:[0,0] op_sel_hi:[1,1]
  v_pk_mul_f16 v59, v40, v41 op_sel:[0,0] op_sel_hi:[1,1]
  s_waitcnt lgkmcnt(6)
  v_mfma_f32_16x16x32_f16 v[68:71], v[120:123], v[60:63], v[68:71]
  ds_read_b128 v[44:47], v11
  ds_read_b128 v[48:51], v12
  s_waitcnt lgkmcnt(7)
  v_mfma_f32_16x16x32_f16 v[68:71], v[124:127], v[64:67], v[68:71]
  v_or3_b32 v15, v56, v57, v58
  s_waitcnt lgkmcnt(6)
  v_mfma_f32_16x16x32_f16 v[76:79], v[208:211], v[60:63], v[76:79]
  v_add_f32 v22, v80, v81
  v_add_f32 v23, v82, v83
  s_waitcnt lgkmcnt(5)
  v_mfma_f32_16x16x32_f16 v[76:79], v[212:215], v[64:67], v[76:79]
  v_pk_mul_f16 v60, v40, v41 op_sel:[0,1] op_sel_hi:[1,0]
  v_pk_mul_f16 v61, v40, v42 op_sel:[0,0] op_sel_hi:[1,1]
  ds_add_u32 v1, v3 offset:12
  s_branch L_grp1
L_prime:
  v_mov_b32 v68, 0
  v_mov_b32 v69, 0
  v_mov_b32 v70, 0
  v_mov_b32 v71, 0
  v_mov_b32 v72, 0
  v_mov_b32 v73, 0
  v_mov_b32 v74, 0
  v_mov_b32 v75, 0
  v_mov_b32 v76, 0
  v_mov_b32 v77, 0
  v_mov_b32 v78, 0
  v_mov_b32 v79, 0
  v_mov_b32 v80, 0
  v_mov_b32 v81, 0
  v_mov_b32 v82, 0
  v_mov_b32 v83, 0
  v_mov_b32 v22, 0
  v_mov_b32 v23, 0
  ds_read_u16_d16_hi v32, v7 offset:0
  ds_read_u16_d16_hi v33, v7 offset:128
  ds_read_u16_d16_hi v34, v7 offset:256
  ds_read_u16_d16_hi v35, v7 offset:384
  ds_read_u16_d16_hi v36, v7 offset:512
  ds_read_u16_d16_hi v37, v7 offset:640
  ds_read_u16_d16_hi v38, v7 offset:768
  ds_read_u16_d16_hi v39, v7 offset:896
  s_waitcnt lgkmcnt(0)
  v_cvt_pk_f16_f32 v43, v38, v39
  v_cvt_pk_f16_f32 v40, v32, v35
  v_cvt_pk_f16_f32 v41, v33, v36
  v_cvt_pk_f16_f32 v42, v34, v37
  ds_write_b128 v10, v[40:43]
  ds_read_b64_tr_b16 v[52:53], v8 offset:0
  ds_read_b64_tr_b16 v[54:55], v8 offset:512
  v_pk_mul_f16 v56, v40, v40 op_sel:[0,0] op_sel_hi:[1,1]
  v_pk_mul_f16 v57, v41, v41 op_sel:[0,0] op_sel_hi:[1,1]
  v_pk_mul_f16 v58, v42, v42 op_sel:[0,0] op_sel_hi:[1,1]
  v_pk_mul_f16 v59, v40, v41 op_sel:[0,0] op_sel_hi:[1,1]
  ds_read_b128 v[44:47], v11
  ds_read_b128 v[48:51], v12
  v_pk_mul_f16 v60, v40, v41 op_sel:[0,1] op_sel_hi:[1,0]
  v_pk_mul_f16 v61, v40, v42 op_sel:[0,0] op_sel_hi:[1,1]
L_cin_loop:
  s_cmp_lg_u32 s84, 0
  s_cbranch_scc1 L_pr0
  s_setprio 2
L_pr0:
  v_mfma_f32_16x16x32_f16 v[80:83], v[216:219], v[56:59], 0
  v_fmac_f32 v14, v68, v72
  v_fmac_f32 v14, v69, v73
  v_fmac_f32 v14, v70, v74
  v_fmac_f32 v14, v71, v75
  s_waitcnt lgkmcnt(2)
  v_mfma_f32_16x16x32_bf16 v[72:75], v[240:243], v[52:55], 0
  v_pk_mul_f16 v62, v40, v42 op_sel:[0,1] op_sel_hi:[1,0]
  v_pk_mul_f16 v63, v41, v42 op_sel:[0,0] op_sel_hi:[1,1]
  v_mfma_f32_16x16x32_f16 v[72:75], v[128:131], v[56:59], v[72:75]
  v_fmac_f32 v14, v76, v77
  v_fmac_f32 v14, v22, v78
  v_mfma_f32_16x16x32_f16 v[68:71], v[84:87], v[56:59], 0
  v_fmac_f32 v14, v23, v79
  v_pk_mul_f16 v64, v41, v42 op_sel:[0,1] op_sel_hi:[1,0]
  v_mfma_f32_16x16x32_bf16 v[76:79], v[244:247], v[52:55], 0
  v_pk_mul_f16 v65, v40, v43 op_sel:[0,0] op_sel_hi:[1,0]
  v_pk_mul_f16 v66, v41, v43 op_sel:[0,0] op_sel_hi:[1,0]
  v_mfma_f32_16x16x32_f16 v[76:79], v[172:175], v[56:59], v[76:79]
  v_pk_mul_f16 v67, v42, v43 op_sel:[0,0] op_sel_hi:[1,0]
  v_add_f32_dpp v14, v14, v14 row_shr:1 row_mask:0xf bank_mask:0xf
  v_mfma_f32_16x16x32_f16 v[76:79], v[176:179], v[60:63], v[76:79]
  v_mul_f16_sdwa v52, v40, v40 dst_sel:WORD_0 dst_unused:UNUSED_PAD src0_sel:WORD_0 src1_sel:WORD_1
  v_mul_f16_sdwa v53, v42, v42 dst_sel:WORD_0 dst_unused:UNUSED_PAD src0_sel:WORD_0 src1_sel:WORD_1
  v_mfma_f32_16x16x32_f16 v[76:79], v[180:183], v[64:67], v[76:79]
  v_add_f32_dpp v14, v14, v14 row_shr:2 row_mask:0xf bank_mask:0xf
  s_waitcnt lgkmcnt(0)
  v_alignbit_b32 v48, v48, v48, v13
  v_smfmac_f32_16x16x64_f16 v[80:83], v[220:223], v[60:67], v16
  v_mul_f16_sdwa v52, v41, v41 dst_sel:WORD_1 dst_unused:UNUSED_PRESERVE src0_sel:WORD_0 src1_sel:WORD_1
  v_mul_f16_sdwa v53, v43, v43 dst_sel:WORD_1 dst_unused:UNUSED_PRESERVE src0_sel:WORD_0 src1_sel:WORD_1
  v_mfma_f32_16x16x32_f16 v[68:71], v[88:91], v[60:63], v[68:71]
  v_add_f32_dpp v14, v14, v14 row_shr:4 row_mask:0xf bank_mask:0xf
  v_pk_mul_f16 v54, v40, v47 op_sel:[0,0] op_sel_hi:[1,0]
  v_mfma_f32_16x16x32_f16 v[68:71], v[92:95], v[64:67], v[68:71]
  v_pk_mul_f16 v55, v41, v47 op_sel:[0,0] op_sel_hi:[1,0]
  v_pk_mul_f16 v56, v42, v47 op_sel:[0,0] op_sel_hi:[1,0]
  v_mfma_f32_16x16x32_f16 v[72:75], v[132:135], v[60:63], v[72:75]
  v_pk_mul_f16 v57, v40, v44 op_sel:[0,0] op_sel_hi:[1,1]
  v_pk_mul_f16 v58, v40, v44 op_sel:[0,1] op_sel_hi:[1,0]
  v_mfma_f32_16x16x32_f16 v[72:75], v[136:139], v[64:67], v[72:75]
  v_pk_mul_f16 v59, v40, v45 op_sel:[0,0] op_sel_hi:[1,1]
  v_add_f32_dpp v14, v14, v14 row_shr:8 row_mask:0xf bank_mask:0xf
  v_mfma_f32_16x16x32_f16 v[72:75], v[140:143], v[52:55], v[72:75]
  v_pk_mul_f16 v60, v40, v45 op_sel:[0,1] op_sel_hi:[1,0]
  v_pk_mul_f16 v61, v40, v46 op_sel:[0,0] op_sel_hi:[1,1]
  v_mfma_f32_16x16x32_f16 v[72:75], v[144:147], v[56:59], v[72:75]
  v_add_f32_dpp v14, v14, v14 row_bcast:15 row_mask:0xa bank_mask:0xf
  v_pk_mul_f16 v62, v40, v46 op_sel:[0,1] op_sel_hi:[1,0]
  v_smfmac_f32_16x16x64_f16 v[80:83], v[224:227], v[52:59], v16
  v_pk_mul_f16 v63, v41, v44 op_sel:[0,0] op_sel_hi:[1,1]
  v_pk_mul_f16 v64, v41, v44 op_sel:[0,1] op_sel_hi:[1,0]
  v_mfma_f32_16x16x32_f16 v[68:71], v[96:99], v[52:55], v[68:71]
  v_add_f32_dpp v14, v14, v14 row_bcast:31 row_mask:0xc bank_mask:0xf
  v_pk_mul_f16 v65, v41, v45 op_sel:[0,0] op_sel_hi:[1,1]
  v_mfma_f32_16x16x32_f16 v[68:71], v[100:103], v[56:59], v[68:71]
  v_pk_mul_f16 v66, v41, v45 op_sel:[0,1] op_sel_hi:[1,0]
  v_pk_mul_f16 v67, v41, v46 op_sel:[0,0] op_sel_hi:[1,1]
  s_waitcnt vmcnt(0)
  s_cmp_le_u32 s72, 3
  s_cbranch_scc1 L_blk
  v_lshlrev_b32 v21, 7, v21
  buffer_load_dword v255, v21, s[32:35], 0 offen
  buffer_load_dword v21, v20, s[28:31], s77 offen
  s_cmp_eq_u32 s77, s73
  s_cselect_b32 s73, 0x7000000, s73
  s_cselect_b32 s77, 0x7000000, s77
  s_add_u32 s77, s77, 24
  s_min_u32 s77, s77, s73
  s_mov_b64 exec, 131071
  buffer_load_dword v255, v19, s[44:47], s101 offen
  s_mov_b64 exec, -1
  s_add_u32 s101, s101, 1171456
L_blk:
  s_cmp_eq_u32 s50, 0
  s_cbranch_scc1 L_blkend
  v_readlane_b32 s81, v14, 63
  v_ldexp_f32 v14, v14, s49
  v_and_b32 v14, -2, v14
  s_cmp_eq_u32 s50, 2
  s_cbranch_scc1 L_good
  s_cmp_eq_u64 s[90:91], 0
  s_cbranch_scc1 L_slow
  s_bfe_u32 s81, s81, 0x80017
  s_cmp_eq_u32 s81, 255
  s_cbranch_scc1 L_slow
L_good:
  s_mov_b32 exec_lo, 0
  s_mov_b32 exec_hi, 0x80000000
  buffer_store_dword v14, v251, s[60:63], s85 offen sc1
  s_mov_b64 exec, -1
  s_add_u32 s85, s85, 32
  s_sub_u32 s72, s72, 1
  s_cmp_eq_u32 s72, 0
  s_cbranch_scc1 L_cin_done
  s_cmp_eq_u32 s72, 1
  s_cbranch_scc1 L_lastnext
  v_lshl_add_u32 v24, v24, 7, v18
  v_lshl_add_u32 v25, v25, 7, v18
  s_mov_b32 exec_hi, 0x0000ffff
  v_lshl_add_u32 v26, v26, 7, v18
  v_lshl_add_u32 v27, v27, 7, v18
  s_mov_b32 exec_lo, 0
  s_mov_b32 exec_hi, 0xffff0000
  v_mov_b32 v27, v25
  v_mov_b32 v26, v25
  s_mov_b32 exec_hi, 0x00ff0000
  v_mov_b32 v26, v24
  s_mov_b64 exec, -1
  s_add_u32 m0, s74, 0
  s_nop 0
  buffer_load_dwordx4 v24, s[32:35], 0 offen lds
  s_add_u32 m0, s74, 1056
  s_nop 0
  buffer_load_dwordx4 v25, s[32:35], 0 offen lds
  s_add_u32 m0, s74, 2112
  s_nop 0
  buffer_load_dwordx4 v26, s[32:35], 0 offen lds
  s_add_u32 m0, s74, 3168
  s_mov_b32 exec_hi, 0x00ffffff
  buffer_load_dwordx4 v27, s[32:35], 0 offen lds
  s_mov_b32 exec_hi, -1
  s_add_u32 s94, s94, 832
  s_cmp_lg_u32 s72, s99
  s_cbranch_scc1 L_nodma
  v_mov_b32 v250, 1
  s_mov_b64 exec, 1
  buffer_atomic_add v250, v251, s[60:63], s98 offen sc0
  s_mov_b64 exec, -1
  s_mov_b32 s99, 8
  s_branch L_nodma
L_lastnext:
  s_cmp_lt_i32 s26, 0
  s_cselect_b32 s85, s85, s26
L_nodma:
  s_add_u32 s74, s74, s75
  s_sub_u32 s75, 0, s75
  s_mov_b32 s49, s48
  s_mov_b32 s97, 1
L_blkend:
  s_mov_b32 s50, s97
  v_mfma_f32_16x16x32_f16 v[76:79], v[184:187], v[52:55], v[76:79]
  v_alignbit_b32 v49, v49, v49, v13
  v_alignbit_b32 v50, v50, v50, v13
  v_mfma_f32_16x16x32_f16 v[76:79], v[188:191], v[56:59], v[76:79]
  v_pk_mul_f16 v52, v41, v46 op_sel:[0,1] op_sel_hi:[1,0]
  v_pk_mul_f16 v53, v42, v44 op_sel:[0,0] op_sel_hi:[1,1]
  v_mfma_f32_16x16x32_f16 v[76:79], v[192:195], v[60:63], v[76:79]
  v_pk_mul_f16 v54, v42, v44 op_sel:[0,1] op_sel_hi:[1,0]
  v_pk_mul_f16 v55, v42, v45 op_sel:[0,0] op_sel_hi:[1,1]
  v_mfma_f32_16x16x32_f16 v[76:79], v[196:199], v[64:67], v[76:79]
  v_pk_mul_f16 v56, v42, v45 op_sel:[0,1] op_sel_hi:[1,0]
  v_pk_mul_f16 v57, v42, v46 op_sel:[0,0] op_sel_hi:[1,1]
  v_smfmac_f32_16x16x64_f16 v[80:83], v[228:231], v[60:67], v16
  v_pk_mul_f16 v58, v42, v46 op_sel:[0,1] op_sel_hi:[1,0]
  v_pk_mul_f16 v59, v40, v48 op_sel:[0,0] op_sel_hi:[1,1]
  v_mfma_f32_16x16x32_f16 v[68:71], v[104:107], v[60:63], v[68:71]
  ds_read_u16_d16_hi v32, v7 offset:32
  ds_read_u16_d16_hi v33, v7 offset:160
  v_mfma_f32_16x16x32_f16 v[68:71], v[108:111], v[64:67], v[68:71]
  ds_read_u16_d16_hi v34, v7 offset:288
  ds_read_u16_d16_hi v35, v7 offset:416
  v_mfma_f32_16x16x32_f16 v[72:75], v[148:151], v[60:63], v[72:75]
  ds_read_u16_d16_hi v36, v7 offset:544
  ds_read_u16_d16_hi v37, v7 offset:672
  v_mfma_f32_16x16x32_f16 v[72:75], v[152:155], v[64:67], v[72:75]
  ds_read_u16_d16_hi v38, v7 offset:800
  ds_read_u16_d16_hi v39, v7 offset:928
  v_mfma_f32_16x16x32_f16 v[72:75], v[156:159], v[52:55], v[72:75]
  v_pk_mul_f16 v60, v41, v49 op_sel:[0,0] op_sel_hi:[1,1]
  v_pk_mul_f16 v61, v42, v50 op_sel:[0,0] op_sel_hi:[1,1]
  v_mfma_f32_16x16x32_f16 v[72:75], v[160:163], v[56:59], v[72:75]
  v_pk_mul_f16 v62, v40, v49 op_sel:[0,0] op_sel_hi:[1,1]
  v_pk_mul_f16 v63, v40, v49 op_sel:[0,1] op_sel_hi:[1,0]
  v_smfmac_f32_16x16x64_f16 v[80:83], v[232:235], v[52:59], v16
  v_pk_mul_f16 v64, v40, v50 op_sel:[0,0] op_sel_hi:[1,1]
  v_pk_mul_f16 v65, v40, v50 op_sel:[0,1] op_sel_hi:[1,0]
  v_mfma_f32_16x16x32_f16 v[68:71], v[112:115], v[52:55], v[68:71]
  v_pk_mul_f16 v66, v41, v50 op_sel:[0,0] op_sel_hi:[1,1]
  v_pk_mul_f16 v67, v41, v50 op_sel:[0,1] op_sel_hi:[1,0]
  v_mfma_f32_16x16x32_f16 v[68:71], v[116:119], v[56:59], v[68:71]
  s_waitcnt lgkmcnt(0)
  v_cvt_pk_f16_f32 v43, v38, v39
  v_cvt_pk_f16_f32 v40, v32, v35
  v_mfma_f32_16x16x32_f16 v[76:79], v[200:203], v[52:55], v[76:79]
  ds_read_b64_tr_b16 v[52:53], v8 offset:32
  ds_read_b64_tr_b16 v[54:55], v8 offset:544
  v_mfma_f32_16x16x32_f16 v[76:79], v[204:207], v[56:59], v[76:79]
  v_cvt_pk_f16_f32 v41, v33, v36
  v_cvt_pk_f16_f32 v42, v34, v37
  v_mfma_f32_16x16x32_f16 v[72:75], v[164:167], v[60:63], v[72:75]
  ds_write_b128 v10, v[40:43]
  v_mfma_f32_16x16x32_f16 v[72:75], v[168:171], v[64:67], v[72:75]
  v_pk_mul_f16 v56, v40, v40 op_sel:[0,0] op_sel_hi:[1,1]
  v_pk_mul_f16 v57, v41, v41 op_sel:[0,0] op_sel_hi:[1,1]
  v_smfmac_f32_16x16x64_f16 v[80:83], v[236:239], v[60:67], v16
  v_pk_mul_f16 v58, v42, v42 op_sel:[0,0] op_sel_hi:[1,1]
  v_pk_mul_f16 v59, v40, v41 op_sel:[0,0] op_sel_hi:[1,1]
  v_mfma_f32_16x16x32_f16 v[68:71], v[120:123], v[60:63], v[68:71]
  ds_read_b128 v[44:47], v11
  ds_read_b128 v[48:51], v12
  v_mfma_f32_16x16x32_f16 v[68:71], v[124:127], v[64:67], v[68:71]
  v_or3_b32 v15, v56, v57, v58
  v_mfma_f32_16x16x32_f16 v[76:79], v[208:211], v[60:63], v[76:79]
  v_add_f32 v22, v80, v81
  v_add_f32 v23, v82, v83
  v_mfma_f32_16x16x32_f16 v[76:79], v[212:215], v[64:67], v[76:79]
  v_pk_mul_f16 v60, v40, v41 op_sel:[0,1] op_sel_hi:[1,0]
  v_pk_mul_f16 v61, v40, v42 op_sel:[0,0] op_sel_hi:[1,1]
L_grp1:
  v_mfma_f32_16x16x32_f16 v[80:83], v[216:219], v[56:59], 0
  v_mul_f32 v14, v68, v72
  v_fmac_f32 v14, v69, v73
  v_fmac_f32 v14, v70, v74
  v_fmac_f32 v14, v71, v75
  s_waitcnt lgkmcnt(3)
  v_mfma_f32_16x16x32_bf16 v[72:75], v[240:243], v[52:55], 0
  v_pk_mul_f16 v62, v40, v42 op_sel:[0,1] op_sel_hi:[1,0]
  v_pk_mul_f16 v63, v41, v42 op_sel:[0,0] op_sel_hi:[1,1]
  v_mfma_f32_16x16x32_f16 v[72:75], v[128:131], v[56:59], v[72:75]
  v_fmac_f32 v14, v76, v77
  v_fmac_f32 v14, v22, v78
  v_mfma_f32_16x16x32_f16 v[68:71], v[84:87], v[56:59], 0
  v_fmac_f32 v14, v23, v79
  v_pk_mul_f16 v64, v41, v42 op_sel:[0,1] op_sel_hi:[1,0]
  v_mfma_f32_16x16x32_bf16 v[76:79], v[244:247], v[52:55], 0
  v_pk_mul_f16 v65, v40, v43 op_sel:[0,0] op_sel_hi:[1,0]
  v_pk_mul_f16 v66, v41, v43 op_sel:[0,0] op_sel_hi:[1,0]
  v_mfma_f32_16x16x32_f16 v[76:79], v[172:175], v[56:59], v[76:79]
  v_pk_mul_f16 v67, v42, v43 op_sel:[0,0] op_sel_hi:[1,0]
  s_waitcnt lgkmcnt(0)
  v_alignbit_b32 v48, v48, v48, v13
  v_mfma_f32_16x16x32_f16 v[76:79], v[176:179], v[60:63], v[76:79]
  v_mul_f16_sdwa v52, v40, v40 dst_sel:WORD_0 dst_unused:UNUSED_PAD src0_sel:WORD_0 src1_sel:WORD_1
  v_mul_f16_sdwa v53, v42, v42 dst_sel:WORD_0 dst_unused:UNUSED_PAD src0_sel:WORD_0 src1_sel:WORD_1
  v_mfma_f32_16x16x32_f16 v[76:79], v[180:183], v[64:67], v[76:79]
  v_mul_f16_sdwa v52, v41, v41 dst_sel:WORD_1 dst_unused:UNUSED_PRESERVE src0_sel:WORD_0 src1_sel:WORD_1
  v_mul_f16_sdwa v53, v43, v43 dst_sel:WORD_1 dst_unused:UNUSED_PRESERVE src0_sel:WORD_0 src1_sel:WORD_1
  v_smfmac_f32_16x16x64_f16 v[80:83], v[220:223], v[60:67], v16
  v_pk_mul_f16 v54, v40, v47 op_sel:[0,0] op_sel_hi:[1,0]
  v_pk_mul_f16 v55, v41, v47 op_sel:[0,0] op_sel_hi:[1,0]
  v_mfma_f32_16x16x32_f16 v[68:71], v[88:91], v[60:63], v[68:71]
  v_pk_mul_f16 v56, v42, v47 op_sel:[0,0] op_sel_hi:[1,0]
  v_pk_mul_f16 v57, v40, v44 op_sel:[0,0] op_sel_hi:[1,1]
  v_mfma_f32_16x16x32_f16 v[68:71], v[92:95], v[64:67], v[68:71]
  v_pk_mul_f16 v58, v40, v44 op_sel:[0,1] op_sel_hi:[1,0]
  v_pk_mul_f16 v59, v40, v45 op_sel:[0,0] op_sel_hi:[1,1]
  v_mfma_f32_16x16x32_f16 v[72:75], v[132:135], v[60:63], v[72:75]
  v_pk_mul_f16 v60, v40, v45 op_sel:[0,1] op_sel_hi:[1,0]
  v_pk_mul_f16 v61, v40, v46 op_sel:[0,0] op_sel_hi:[1,1]
  v_mfma_f32_16x16x32_f16 v[72:75], v[136:139], v[64:67], v[72:75]
  v_pk_mul_f16 v62, v40, v46 op_sel:[0,1] op_sel_hi:[1,0]
  v_pk_mul_f16 v63, v41, v44 op_sel:[0,0] op_sel_hi:[1,1]
  v_mfma_f32_16x16x32_f16 v[72:75], v[140:143], v[52:55], v[72:75]
  v_pk_mul_f16 v64, v41, v44 op_sel:[0,1] op_sel_hi:[1,0]
  v_pk_mul_f16 v65, v41, v45 op_sel:[0,0] op_sel_hi:[1,1]
  v_mfma_f32_16x16x32_f16 v[72:75], v[144:147], v[56:59], v[72:75]
  v_pk_mul_f16 v66, v41, v45 op_sel:[0,1] op_sel_hi:[1,0]
  v_pk_mul_f16 v67, v41, v46 op_sel:[0,0] op_sel_hi:[1,1]
  v_smfmac_f32_16x16x64_f16 v[80:83], v[224:227], v[52:59], v16
  v_alignbit_b32 v49, v49, v49, v13
  v_alignbit_b32 v50, v50, v50, v13
  v_mfma_f32_16x16x32_f16 v[68:71], v[96:99], v[52:55], v[68:71]
  ds_read_u16_d16_hi v32, v7 offset:64
  ds_read_u16_d16_hi v33, v7 offset:192
  v_mfma_f32_16x16x32_f16 v[68:71], v[100:103], v[56:59], v[68:71]
  ds_read_u16_d16_hi v34, v7 offset:320
  ds_read_u16_d16_hi v35, v7 offset:448
  v_mfma_f32_16x16x32_f16 v[76:79], v[184:187], v[52:55], v[76:79]
  v_pk_mul_f16 v52, v41, v46 op_sel:[0,1] op_sel_hi:[1,0]
  v_pk_mul_f16 v53, v42, v44 op_sel:[0,0] op_sel_hi:[1,1]
  v_mfma_f32_16x16x32_f16 v[76:79], v[188:191], v[56:59], v[76:79]
  v_pk_mul_f16 v54, v42, v44 op_sel:[0,1] op_sel_hi:[1,0]
  v_pk_mul_f16 v55, v42, v45 op_sel:[0,0] op_sel_hi:[1,1]
  v_mfma_f32_16x16x32_f16 v[76:79], v[192:195], v[60:63], v[76:79]
  v_pk_mul_f16 v56, v42, v45 op_sel:[0,1] op_sel_hi:[1,0]
  v_pk_mul_f16 v57, v42, v46 op_sel:[0,0] op_sel_hi:[1,1]
  v_mfma_f32_16x16x32_f16 v[76:79], v[196:199], v[64:67], v[76:79]
  v_pk_mul_f16 v58, v42, v46 op_sel:[0,1] op_sel_hi:[1,0]
  v_pk_mul_f16 v59, v40, v48 op_sel:[0,0] op_sel_hi:[1,1]
  v_smfmac_f32_16x16x64_f16 v[80:83], v[228:231], v[60:67], v16
  ds_read_u16_d16_hi v36, v7 offset:576
  ds_read_u16_d16_hi v37, v7 offset:704
  v_mfma_f32_16x16x32_f16 v[68:71], v[104:107], v[60:63], v[68:71]
  ds_read_u16_d16_hi v38, v7 offset:832
  ds_read_u16_d16_hi v39, v7 offset:960
  v_mfma_f32_16x16x32_f16 v[68:71], v[108:111], v[64:67], v[68:71]
  v_and_b32 v15, 0x60006000, v15
  v_cmp_ne_u32 s[90:91], 0, v15
  v_mfma_f32_16x16x32_f16 v[72:75], v[148:151], v[60:63], v[72:75]
  v_pk_mul_f16 v60, v41, v49 op_sel:[0,0] op_sel_hi:[1,1]
  v_pk_mul_f16 v61, v42, v50 op_sel:[0,0] op_sel_hi:[1,1]
  v_mfma_f32_16x16x32_f16 v[72:75], v[152:155], v[64:67], v[72:75]
  v_pk_mul_f16 v62, v40, v49 op_sel:[0,0] op_sel_hi:[1,1]
  v_pk_mul_f16 v63, v40, v49 op_sel:[0,1] op_sel_hi:[1,0]
  v_mfma_f32_16x16x32_f16 v[72:75], v[156:159], v[52:55], v[72:75]
  v_pk_mul_f16 v64, v40, v50 op_sel:[0,0] op_sel_hi:[1,1]
  v_pk_mul_f16 v65, v40, v50 op_sel:[0,1] op_sel_hi:[1,0]
  v_mfma_f32_16x16x32_f16 v[72:75], v[160:163], v[56:59], v[72:75]
  v_pk_mul_f16 v66, v41, v50 op_sel:[0,0] op_sel_hi:[1,1]
  v_pk_mul_f16 v67, v41, v50 op_sel:[0,1] op_sel_hi:[1,0]
  v_smfmac_f32_16x16x64_f16 v[80:83], v[232:235], v[52:59], v16
  s_waitcnt lgkmcnt(0)
  v_cvt_pk_f16_f32 v43, v38, v39
  v_cvt_pk_f16_f32 v40, v32, v35
  v_mfma_f32_16x16x32_f16 v[68:71], v[112:115], v[52:55], v[68:71]
  v_cvt_pk_f16_f32 v41, v33, v36
  v_cvt_pk_f16_f32 v42, v34, v37
  v_mfma_f32_16x16x32_f16 v[68:71], v[116:119], v[56:59], v[68:71]
  ds_write_b128 v10, v[40:43]
  v_mfma_f32_16x16x32_f16 v[76:79], v[200:203], v[52:55], v[76:79]
  ds_read_b64_tr_b16 v[52:53], v8 offset:64
  ds_read_b64_tr_b16 v[54:55], v8 offset:576
  v_mfma_f32_16x16x32_f16 v[76:79], v[204:207], v[56:59], v[76:79]
  v_pk_mul_f16 v56, v40, v40 op_sel:[0,0] op_sel_hi:[1,1]
  v_pk_mul_f16 v57, v41, v41 op_sel:[0,0] op_sel_hi:[1,1]
  v_mfma_f32_16x16x32_f16 v[72:75], v[164:167], v[60:63], v[72:75]
  v_pk_mul_f16 v58, v42, v42 op_sel:[0,0] op_sel_hi:[1,1]
  v_pk_mul_f16 v59, v40, v41 op_sel:[0,0] op_sel_hi:[1,1]
  v_mfma_f32_16x16x32_f16 v[72:75], v[168:171], v[64:67], v[72:75]
  ds_read_b128 v[44:47], v11
  ds_read_b128 v[48:51], v12
  v_smfmac_f32_16x16x64_f16 v[80:83], v[236:239], v[60:67], v16
  v_mfma_f32_16x16x32_f16 v[68:71], v[120:123], v[60:63], v[68:71]
  v_mfma_f32_16x16x32_f16 v[68:71], v[124:127], v[64:67], v[68:71]
  v_mfma_f32_16x16x32_f16 v[76:79], v[208:211], v[60:63], v[76:79]
  s_nop 4
  v_add_f32 v22, v80, v81
  v_add_f32 v23, v82, v83
  v_mfma_f32_16x16x32_f16 v[76:79], v[212:215], v[64:67], v[76:79]
  v_pk_mul_f16 v60, v40, v41 op_sel:[0,1] op_sel_hi:[1,0]
  v_pk_mul_f16 v61, v40, v42 op_sel:[0,0] op_sel_hi:[1,1]
  v_mfma_f32_16x16x32_f16 v[80:83], v[216:219], v[56:59], 0
  v_fmac_f32 v14, v68, v72
  v_fmac_f32 v14, v69, v73
  v_fmac_f32 v14, v70, v74
  v_fmac_f32 v14, v71, v75
  s_waitcnt lgkmcnt(2)
  v_mfma_f32_16x16x32_bf16 v[72:75], v[240:243], v[52:55], 0
  v_pk_mul_f16 v62, v40, v42 op_sel:[0,1] op_sel_hi:[1,0]
  v_pk_mul_f16 v63, v41, v42 op_sel:[0,0] op_sel_hi:[1,1]
  v_mfma_f32_16x16x32_f16 v[72:75], v[128:131], v[56:59], v[72:75]
  v_fmac_f32 v14, v76, v77
  v_fmac_f32 v14, v22, v78
  v_mfma_f32_16x16x32_f16 v[68:71], v[84:87], v[56:59], 0
  v_fmac_f32 v14, v23, v79
  v_pk_mul_f16 v64, v41, v42 op_sel:[0,1] op_sel_hi:[1,0]
  v_mfma_f32_16x16x32_bf16 v[76:79], v[244:247], v[52:55], 0
  v_pk_mul_f16 v65, v40, v43 op_sel:[0,0] op_sel_hi:[1,0]
  v_pk_mul_f16 v66, v41, v43 op_sel:[0,0] op_sel_hi:[1,0]
  v_mfma_f32_16x16x32_f16 v[76:79], v[172:175], v[56:59], v[76:79]
  v_pk_mul_f16 v67, v42, v43 op_sel:[0,0] op_sel_hi:[1,0]
  s_waitcnt lgkmcnt(0)
  v_alignbit_b32 v48, v48, v48, v13
  v_mfma_f32_16x16x32_f16 v[76:79], v[176:179], v[60:63], v[76:79]
  v_mul_f16_sdwa v52, v40, v40 dst_sel:WORD_0 dst_unused:UNUSED_PAD src0_sel:WORD_0 src1_sel:WORD_1
  v_mul_f16_sdwa v53, v42, v42 dst_sel:WORD_0 dst_unused:UNUSED_PAD src0_sel:WORD_0 src1_sel:WORD_1
  v_mfma_f32_16x16x32_f16 v[76:79], v[180:183], v[64:67], v[76:79]
  v_mul_f16_sdwa v52, v41, v41 dst_sel:WORD_1 dst_unused:UNUSED_PRESERVE src0_sel:WORD_0 src1_sel:WORD_1
  v_mul_f16_sdwa v53, v43, v43 dst_sel:WORD_1 dst_unused:UNUSED_PRESERVE src0_sel:WORD_0 src1_sel:WORD_1
  v_smfmac_f32_16x16x64_f16 v[80:83], v[220:223], v[60:67], v16
  v_pk_mul_f16 v54, v40, v47 op_sel:[0,0] op_sel_hi:[1,0]
  v_pk_mul_f16 v55, v41, v47 op_sel:[0,0] op_sel_hi:[1,0]
  v_mfma_f32_16x16x32_f16 v[68:71], v[88:91], v[60:63], v[68:71]
  v_pk_mul_f16 v56, v42, v47 op_sel:[0,0] op_sel_hi:[1,0]
  v_pk_mul_f16 v57, v40, v44 op_sel:[0,0] op_sel_hi:[1,1]
  v_mfma_f32_16x16x32_f16 v[68:71], v[92:95], v[64:67], v[68:71]
  v_pk_mul_f16 v58, v40, v44 op_sel:[0,1] op_sel_hi:[1,0]
  v_pk_mul_f16 v59, v40, v45 op_sel:[0,0] op_sel_hi:[1,1]
  v_mfma_f32_16x16x32_f16 v[72:75], v[132:135], v[60:63], v[72:75]
  v_pk_mul_f16 v60, v40, v45 op_sel:[0,1] op_sel_hi:[1,0]
  v_pk_mul_f16 v61, v40, v46 op_sel:[0,0] op_sel_hi:[1,1]
  v_mfma_f32_16x16x32_f16 v[72:75], v[136:139], v[64:67], v[72:75]
  v_pk_mul_f16 v62, v40, v46 op_sel:[0,1] op_sel_hi:[1,0]
  v_pk_mul_f16 v63, v41, v44 op_sel:[0,0] op_sel_hi:[1,1]
  v_mfma_f32_16x16x32_f16 v[72:75], v[140:143], v[52:55], v[72:75]
  v_pk_mul_f16 v64, v41, v44 op_sel:[0,1] op_sel_hi:[1,0]
  v_pk_mul_f16 v65, v41, v45 op_sel:[0,0] op_sel_hi:[1,1]
  v_mfma_f32_16x16x32_f16 v[72:75], v[144:147], v[56:59], v[72:75]
  v_pk_mul_f16 v66, v41, v45 op_sel:[0,1] op_sel_hi:[1,0]
  v_pk_mul_f16 v67, v41, v46 op_sel:[0,0] op_sel_hi:[1,1]
  v_smfmac_f32_16x16x64_f16 v[80:83], v[224:227], v[52:59], v16
  v_alignbit_b32 v49, v49, v49, v13
  v_alignbit_b32 v50, v50, v50, v13
  v_mfma_f32_16x16x32_f16 v[68:71], v[96:99], v[52:55], v[68:71]
  ds_read_u16_d16_hi v32, v7 offset:96
  ds_read_u16_d16_hi v33, v7 offset:224
  v_mfma_f32_16x16x32_f16 v[68:71], v[100:103], v[56:59], v[68:71]
  ds_read_u16_d16_hi v34, v7 offset:352
  ds_read_u16_d16_hi v35, v7 offset:480
  s_cmp_lg_u32 s99, 8
  s_cbranch_scc1 L_hk
  s_waitcnt vmcnt(0)
  v_readfirstlane_b32 s81, v250
  s_mov_b32 s99, 0
  s_add_u32 s81, s81, 485
  s_cmp_ge_u32 s81, 512
  s_cbranch_scc1 L_hk
  s_add_u32 s72, s72, 1
  s_lshr_b32 s94, s98, 14
  s_lshl_b32 s26, s94, 12
  s_add_u32 s26, s26, s81
  s_lshl_b32 s26, s26, 2
  s_add_u32 s26, s26, 10240
  s_lshl_b32 s94, s94, 9
  s_add_u32 s94, s94, s81
  s_mul_i32 s94, s94, 104
L_hk:
  buffer_load_dwordx4 v[24:27], v17, s[28:31], s94 offen offset:0
  v_mfma_f32_16x16x32_f16 v[76:79], v[184:187], v[52:55], v[76:79]
  v_pk_mul_f16 v52, v41, v46 op_sel:[0,1] op_sel_hi:[1,0]
  v_pk_mul_f16 v53, v42, v44 op_sel:[0,0] op_sel_hi:[1,1]
  v_mfma_f32_16x16x32_f16 v[76:79], v[188:191], v[56:59], v[76:79]
  v_pk_mul_f16 v54, v42, v44 op_sel:[0,1] op_sel_hi:[1,0]
  v_pk_mul_f16 v55, v42, v45 op_sel:[0,0] op_sel_hi:[1,1]
  v_mfma_f32_16x16x32_f16 v[76:79], v[192:195], v[60:63], v[76:79]
  v_pk_mul_f16 v56, v42, v45 op_sel:[0,1] op_sel_hi:[1,0]
  v_pk_mul_f16 v57, v42, v46 op_sel:[0,0] op_sel_hi:[1,1]
  v_mfma_f32_16x16x32_f16 v[76:79], v[196:199], v[64:67], v[76:79]
  v_pk_mul_f16 v58, v42, v46 op_sel:[0,1] op_sel_hi:[1,0]
  v_pk_mul_f16 v59, v40, v48 op_sel:[0,0] op_sel_hi:[1,1]
  v_smfmac_f32_16x16x64_f16 v[80:83], v[228:231], v[60:67], v16
  ds_read_u16_d16_hi v36, v7 offset:608
  ds_read_u16_d16_hi v37, v7 offset:736
  v_mfma_f32_16x16x32_f16 v[68:71], v[104:107], v[60:63], v[68:71]
  ds_read_u16_d16_hi v38, v7 offset:864
  ds_read_u16_d16_hi v39, v7 offset:992
  v_mfma_f32_16x16x32_f16 v[68:71], v[108:111], v[64:67], v[68:71]
  v_mfma_f32_16x16x32_f16 v[72:75], v[148:151], v[60:63], v[72:75]
  v_pk_mul_f16 v60, v41, v49 op_sel:[0,0] op_sel_hi:[1,1]
  v_pk_mul_f16 v61, v42, v50 op_sel:[0,0] op_sel_hi:[1,1]
  v_mfma_f32_16x16x32_f16 v[72:75], v[152:155], v[64:67], v[72:75]
  v_pk_mul_f16 v62, v40, v49 op_sel:[0,0] op_sel_hi:[1,1]
  v_pk_mul_f16 v63, v40, v49 op_sel:[0,1] op_sel_hi:[1,0]
  v_mfma_f32_16x16x32_f16 v[72:75], v[156:159], v[52:55], v[72:75]
  v_pk_mul_f16 v64, v40, v50 op_sel:[0,0] op_sel_hi:[1,1]
  v_pk_mul_f16 v65, v40, v50 op_sel:[0,1] op_sel_hi:[1,0]
  v_mfma_f32_16x16x32_f16 v[72:75], v[160:163], v[56:59], v[72:75]
  v_pk_mul_f16 v66, v41, v50 op_sel:[0,0] op_sel_hi:[1,1]
  v_pk_mul_f16 v67, v41, v50 op_sel:[0,1] op_sel_hi:[1,0]
  v_smfmac_f32_16x16x64_f16 v[80:83], v[232:235], v[52:59], v16
  s_waitcnt lgkmcnt(0)
  v_cvt_pk_f16_f32 v43, v38, v39
  v_cvt_pk_f16_f32 v40, v32, v35
  v_mfma_f32_16x16x32_f16 v[68:71], v[112:115], v[52:55], v[68:71]
  v_cvt_pk_f16_f32 v41, v33, v36
  v_cvt_pk_f16_f32 v42, v34, v37
  v_mfma_f32_16x16x32_f16 v[68:71], v[116:119], v[56:59], v[68:71]
  ds_write_b128 v10, v[40:43]
  v_mfma_f32_16x16x32_f16 v[76:79], v[200:203], v[52:55], v[76:79]
  ds_read_b64_tr_b16 v[52:53], v8 offset:96
  ds_read_b64_tr_b16 v[54:55], v8 offset:608
  v_mfma_f32_16x16x32_f16 v[76:79], v[204:207], v[56:59], v[76:79]
  v_pk_mul_f16 v56, v40, v40 op_sel:[0,0] op_sel_hi:[1,1]
  v_pk_mul_f16 v57, v41, v41 op_sel:[0,0] op_sel_hi:[1,1]
  v_mfma_f32_16x16x32_f16 v[72:75], v[164:167], v[60:63], v[72:75]
  v_pk_mul_f16 v58, v42, v42 op_sel:[0,0] op_sel_hi:[1,1]
  v_pk_mul_f16 v59, v40, v41 op_sel:[0,0] op_sel_hi:[1,1]
  v_mfma_f32_16x16x32_f16 v[72:75], v[168:171], v[64:67], v[72:75]
  ds_read_b128 v[44:47], v11
  ds_read_b128 v[48:51], v12
  v_smfmac_f32_16x16x64_f16 v[80:83], v[236:239], v[60:67], v16
  v_mfma_f32_16x16x32_f16 v[68:71], v[120:123], v[60:63], v[68:71]
  v_mfma_f32_16x16x32_f16 v[68:71], v[124:127], v[64:67], v[68:71]
  v_mfma_f32_16x16x32_f16 v[76:79], v[208:211], v[60:63], v[76:79]
  s_nop 4
  v_add_f32 v22, v80, v81
  v_add_f32 v23, v82, v83
  v_mfma_f32_16x16x32_f16 v[76:79], v[212:215], v[64:67], v[76:79]
  v_pk_mul_f16 v60, v40, v41 op_sel:[0,1] op_sel_hi:[1,0]
  v_pk_mul_f16 v61, v40, v42 op_sel:[0,0] op_sel_hi:[1,1]
  s_cmp_lg_u32 s84, 0
  s_cbranch_scc1 L_pr123
  s_setprio 0
L_pr123:
  v_mfma_f32_16x16x32_f16 v[80:83], v[216:219], v[56:59], 0
  v_fmac_f32 v14, v68, v72
  v_fmac_f32 v14, v69, v73
  v_fmac_f32 v14, v70, v74
  v_fmac_f32 v14, v71, v75
  s_waitcnt lgkmcnt(2)
  v_mfma_f32_16x16x32_bf16 v[72:75], v[240:243], v[52:55], 0
  v_pk_mul_f16 v62, v40, v42 op_sel:[0,1] op_sel_hi:[1,0]
  v_pk_mul_f16 v63, v41, v42 op_sel:[0,0] op_sel_hi:[1,1]
  v_mfma_f32_16x16x32_f16 v[72:75], v[128:131], v[56:59], v[72:75]
  v_fmac_f32 v14, v76, v77
  v_fmac_f32 v14, v22, v78
  v_mfma_f32_16x16x32_f16 v[68:71], v[84:87], v[56:59], 0
  v_fmac_f32 v14, v23, v79
  v_pk_mul_f16 v64, v41, v42 op_sel:[0,1] op_sel_hi:[1,0]
  v_mfma_f32_16x16x32_bf16 v[76:79], v[244:247], v[52:55], 0
  v_pk_mul_f16 v65, v40, v43 op_sel:[0,0] op_sel_hi:[1,0]
  v_pk_mul_f16 v66, v41, v43 op_sel:[0,0] op_sel_hi:[1,0]
  v_mfma_f32_16x16x32_f16 v[76:79], v[172:175], v[56:59], v[76:79]
  v_pk_mul_f16 v67, v42, v43 op_sel:[0,0] op_sel_hi:[1,0]
  s_waitcnt lgkmcnt(0)
  v_alignbit_b32 v48, v48, v48, v13
  v_mfma_f32_16x16x32_f16 v[76:79], v[176:179], v[60:63], v[76:79]
  v_mul_f16_sdwa v52, v40, v40 dst_sel:WORD_0 dst_unused:UNUSED_PAD src0_sel:WORD_0 src1_sel:WORD_1
  v_mul_f16_sdwa v53, v42, v42 dst_sel:WORD_0 dst_unused:UNUSED_PAD src0_sel:WORD_0 src1_sel:WORD_1
  v_mfma_f32_16x16x32_f16 v[76:79], v[180:183], v[64:67], v[76:79]
  v_mul_f16_sdwa v52, v41, v41 dst_sel:WORD_1 dst_unused:UNUSED_PRESERVE src0_sel:WORD_0 src1_sel:WORD_1
  v_mul_f16_sdwa v53, v43, v43 dst_sel:WORD_1 dst_unused:UNUSED_PRESERVE src0_sel:WORD_0 src1_sel:WORD_1
  v_smfmac_f32_16x16x64_f16 v[80:83], v[220:223], v[60:67], v16
  v_pk_mul_f16 v54, v40, v47 op_sel:[0,0] op_sel_hi:[1,0]
  v_pk_mul_f16 v55, v41, v47 op_sel:[0,0] op_sel_hi:[1,0]
  v_mfma_f32_16x16x32_f16 v[68:71], v[88:91], v[60:63], v[68:71]
  v_pk_mul_f16 v56, v42, v47 op_sel:[0,0] op_sel_hi:[1,0]
  v_pk_mul_f16 v57, v40, v44 op_sel:[0,0] op_sel_hi:[1,1]
  v_mfma_f32_16x16x32_f16 v[68:71], v[92:95], v[64:67], v[68:71]
  v_add_u32 v7, s75, v7
  s_waitcnt vmcnt(1)
  v_pk_mul_f16 v58, v40, v44 op_sel:[0,1] op_sel_hi:[1,0]
  v_mfma_f32_16x16x32_f16 v[72:75], v[132:135], v[60:63], v[72:75]
  v_pk_mul_f16 v59, v40, v45 op_sel:[0,0] op_sel_hi:[1,1]
  v_pk_mul_f16 v60, v40, v45 op_sel:[0,1] op_sel_hi:[1,0]
  v_mfma_f32_16x16x32_f16 v[72:75], v[136:139], v[64:67], v[72:75]
  v_pk_mul_f16 v61, v40, v46 op_sel:[0,0] op_sel_hi:[1,1]
  v_pk_mul_f16 v62, v40, v46 op_sel:[0,1] op_sel_hi:[1,0]
  v_mfma_f32_16x16x32_f16 v[72:75], v[140:143], v[52:55], v[72:75]
  v_pk_mul_f16 v63, v41, v44 op_sel:[0,0] op_sel_hi:[1,1]
  v_pk_mul_f16 v64, v41, v44 op_sel:[0,1] op_sel_hi:[1,0]
  v_mfma_f32_16x16x32_f16 v[72:75], v[144:147], v[56:59], v[72:75]
  v_pk_mul_f16 v65, v41, v45 op_sel:[0,0] op_sel_hi:[1,1]
  v_pk_mul_f16 v66, v41, v45 op_sel:[0,1] op_sel_hi:[1,0]
  v_smfmac_f32_16x16x64_f16 v[80:83], v[224:227], v[52:59], v16
  v_pk_mul_f16 v67, v41, v46 op_sel:[0,0] op_sel_hi:[1,1]
  v_alignbit_b32 v49, v49, v49, v13
  v_mfma_f32_16x16x32_f16 v[68:71], v[96:99], v[52:55], v[68:71]
  v_alignbit_b32 v50, v50, v50, v13
  ds_read_u16_d16_hi v32, v7 offset:0
  v_mfma_f32_16x16x32_f16 v[68:71], v[100:103], v[56:59], v[68:71]
  ds_read_u16_d16_hi v33, v7 offset:128
  ds_read_u16_d16_hi v34, v7 offset:256
  v_mfma_f32_16x16x32_f16 v[76:79], v[184:187], v[52:55], v[76:79]
  v_pk_mul_f16 v52, v41, v46 op_sel:[0,1] op_sel_hi:[1,0]
  v_pk_mul_f16 v53, v42, v44 op_sel:[0,0] op_sel_hi:[1,1]
  v_mfma_f32_16x16x32_f16 v[76:79], v[188:191], v[56:59], v[76:79]
  v_pk_mul_f16 v54, v42, v44 op_sel:[0,1] op_sel_hi:[1,0]
  v_pk_mul_f16 v55, v42, v45 op_sel:[0,0] op_sel_hi:[1,1]
  v_mfma_f32_16x16x32_f16 v[76:79], v[192:195], v[60:63], v[76:79]
  v_pk_mul_f16 v56, v42, v45 op_sel:[0,1] op_sel_hi:[1,0]
  v_pk_mul_f16 v57, v42, v46 op_sel:[0,0] op_sel_hi:[1,1]
  v_mfma_f32_16x16x32_f16 v[76:79], v[196:199], v[64:67], v[76:79]
  v_pk_mul_f16 v58, v42, v46 op_sel:[0,1] op_sel_hi:[1,0]
  v_pk_mul_f16 v59, v40, v48 op_sel:[0,0] op_sel_hi:[1,1]
  v_smfmac_f32_16x16x64_f16 v[80:83], v[228:231], v[60:67], v16
  ds_read_u16_d16_hi v35, v7 offset:384
  ds_read_u16_d16_hi v36, v7 offset:512
  v_mfma_f32_16x16x32_f16 v[68:71], v[104:107], v[60:63], v[68:71]
  ds_read_u16_d16_hi v37, v7 offset:640
  ds_read_u16_d16_hi v38, v7 offset:768
  v_mfma_f32_16x16x32_f16 v[68:71], v[108:111], v[64:67], v[68:71]
  ds_read_u16_d16_hi v39, v7 offset:896
  s_add_u32 s81, s74, s75
  v_add_u32 v8, s81, v9
  v_mfma_f32_16x16x32_f16 v[72:75], v[148:151], v[60:63], v[72:75]
  v_pk_mul_f16 v60, v41, v49 op_sel:[0,0] op_sel_hi:[1,1]
  v_pk_mul_f16 v61, v42, v50 op_sel:[0,0] op_sel_hi:[1,1]
  v_mfma_f32_16x16x32_f16 v[72:75], v[152:155], v[64:67], v[72:75]
  v_pk_mul_f16 v62, v40, v49 op_sel:[0,0] op_sel_hi:[1,1]
  v_pk_mul_f16 v63, v40, v49 op_sel:[0,1] op_sel_hi:[1,0]
  v_mfma_f32_16x16x32_f16 v[72:75], v[156:159], v[52:55], v[72:75]
  v_pk_mul_f16 v64, v40, v50 op_sel:[0,0] op_sel_hi:[1,1]
  v_pk_mul_f16 v65, v40, v50 op_sel:[0,1] op_sel_hi:[1,0]
  v_mfma_f32_16x16x32_f16 v[72:75], v[160:163], v[56:59], v[72:75]
  v_pk_mul_f16 v66, v41, v50 op_sel:[0,0] op_sel_hi:[1,1]
  v_pk_mul_f16 v67, v41, v50 op_sel:[0,1] op_sel_hi:[1,0]
  v_smfmac_f32_16x16x64_f16 v[80:83], v[232:235], v[52:59], v16
  s_waitcnt lgkmcnt(0)
  v_cvt_pk_f16_f32 v43, v38, v39
  v_cvt_pk_f16_f32 v40, v32, v35
  v_mfma_f32_16x16x32_f16 v[68:71], v[112:115], v[52:55], v[68:71]
  v_cvt_pk_f16_f32 v41, v33, v36
  v_cvt_pk_f16_f32 v42, v34, v37
  v_mfma_f32_16x16x32_f16 v[68:71], v[116:119], v[56:59], v[68:71]
  ds_write_b128 v10, v[40:43]
  v_mfma_f32_16x16x32_f16 v[76:79], v[200:203], v[52:55], v[76:79]
  ds_read_b64_tr_b16 v[52:53], v8 offset:0
  ds_read_b64_tr_b16 v[54:55], v8 offset:512
  v_mfma_f32_16x16x32_f16 v[76:79], v[204:207], v[56:59], v[76:79]
  v_pk_mul_f16 v56, v40, v40 op_sel:[0,0] op_sel_hi:[1,1]
  v_pk_mul_f16 v57, v41, v41 op_sel:[0,0] op_sel_hi:[1,1]
  v_mfma_f32_16x16x32_f16 v[72:75], v[164:167], v[60:63], v[72:75]
  v_pk_mul_f16 v58, v42, v42 op_sel:[0,0] op_sel_hi:[1,1]
  v_pk_mul_f16 v59, v40, v41 op_sel:[0,0] op_sel_hi:[1,1]
  v_mfma_f32_16x16x32_f16 v[72:75], v[168:171], v[64:67], v[72:75]
  ds_read_b128 v[44:47], v11
  ds_read_b128 v[48:51], v12
  v_smfmac_f32_16x16x64_f16 v[80:83], v[236:239], v[60:67], v16
  v_mfma_f32_16x16x32_f16 v[68:71], v[120:123], v[60:63], v[68:71]
  v_mfma_f32_16x16x32_f16 v[68:71], v[124:127], v[64:67], v[68:71]
  v_mfma_f32_16x16x32_f16 v[76:79], v[208:211], v[60:63], v[76:79]
  s_nop 4
  v_add_f32 v22, v80, v81
  v_add_f32 v23, v82, v83
  v_mfma_f32_16x16x32_f16 v[76:79], v[212:215], v[64:67], v[76:79]
  v_pk_mul_f16 v60, v40, v41 op_sel:[0,1] op_sel_hi:[1,0]
  v_pk_mul_f16 v61, v40, v42 op_sel:[0,0] op_sel_hi:[1,1]
  s_cmp_lg_u32 s72, 1
  s_cbranch_scc1 L_cin_loop
  v_fmac_f32 v14, v68, v72
  v_fmac_f32 v14, v69, v73
  v_fmac_f32 v14, v70, v74
  v_fmac_f32 v14, v71, v75
  v_fmac_f32 v14, v76, v77
  v_fmac_f32 v14, v22, v78
  v_fmac_f32 v14, v23, v79
  s_nop 1
  v_add_f32_dpp v14, v14, v14 row_shr:1 row_mask:0xf bank_mask:0xf
  s_nop 1
  v_add_f32_dpp v14, v14, v14 row_shr:2 row_mask:0xf bank_mask:0xf
  s_nop 1
  v_add_f32_dpp v14, v14, v14 row_shr:4 row_mask:0xf bank_mask:0xf
  s_nop 1
  v_add_f32_dpp v14, v14, v14 row_shr:8 row_mask:0xf bank_mask:0xf
  s_nop 1
  v_add_f32_dpp v14, v14, v14 row_bcast:15 row_mask:0xa bank_mask:0xf
  s_nop 1
  v_add_f32_dpp v14, v14, v14 row_bcast:31 row_mask:0xc bank_mask:0xf
  s_branch L_blk
L_slow:
  v_lshlrev_b32 v22, 1, v0
  v_add_u32 v23, s74, v22
  s_mul_i32 s81, s3, 4224
  s_add_u32 s81, s81, 1024
  v_add_u32 v22, s81, v22
  v_add_u32 v8, s81, v9
  v_subrev_u32 v7, s75, v7
L_csync10:
  ds_read_b32 v4, v2 offset:12
  s_waitcnt lgkmcnt(0)
  v_cmp_gt_u32 vcc, 8, v4
  s_cbranch_vccnz L_csync10
  ds_read_u16 v52, v23 offset:0
  ds_read_u16 v53, v23 offset:128
  ds_read_u16 v54, v23 offset:256
  ds_read_u16 v55, v23 offset:384
  ds_read_u16 v56, v23 offset:512
  ds_read_u16 v57, v23 offset:640
  ds_read_u16 v58, v23 offset:768
  ds_read_u16 v59, v23 offset:896
  ds_read_u16 v60, v23 offset:1056
  ds_read_u16 v61, v23 offset:1184
  ds_read_u16 v62, v23 offset:1312
  ds_read_u16 v63, v23 offset:1440
  ds_read_u16 v64, v23 offset:1568
  ds_read_u16 v65, v23 offset:1696
  ds_read_u16 v66, v23 offset:1824
  ds_read_u16 v67, v23 offset:1952
  ds_read_u16 v68, v23 offset:2112
  ds_read_u16 v69, v23 offset:2240
  ds_read_u16 v70, v23 offset:2368
  ds_read_u16 v71, v23 offset:2496
  ds_read_u16 v72, v23 offset:2624
  ds_read_u16 v73, v23 offset:2752
  ds_read_u16 v74, v23 offset:2880
  ds_read_u16 v75, v23 offset:3008
  ds_read_u16 v76, v23 offset:3168
  ds_read_u16 v77, v23 offset:3296
  ds_read_u16 v78, v23 offset:3424
  ds_read_u16 v79, v23 offset:3552
  ds_read_u16 v80, v23 offset:3680
  ds_read_u16 v81, v23 offset:3808
  ds_read_u16 v82, v23 offset:3936
  s_waitcnt lgkmcnt(14)
  v_lshlrev_b32 v52, 16, v52
  v_lshlrev_b32 v53, 16, v53
  v_lshlrev_b32 v54, 16, v54
  v_lshlrev_b32 v55, 16, v55
  v_lshlrev_b32 v56, 16, v56
  v_lshlrev_b32 v57, 16, v57
  v_lshlrev_b32 v58, 16, v58
  v_lshlrev_b32 v59, 16, v59
  v_lshlrev_b32 v60, 16, v60
  v_lshlrev_b32 v61, 16, v61
  v_lshlrev_b32 v62, 16, v62
  v_lshlrev_b32 v63, 16, v63
  v_lshlrev_b32 v64, 16, v64
  v_lshlrev_b32 v65, 16, v65
  v_lshlrev_b32 v66, 16, v66
  v_lshlrev_b32 v67, 16, v67
  v_lshlrev_b32 v68, 16, v68
  s_waitcnt lgkmcnt(13)
  v_lshlrev_b32 v69, 16, v69
  s_waitcnt lgkmcnt(12)
  v_lshlrev_b32 v70, 16, v70
  s_waitcnt lgkmcnt(11)
  v_lshlrev_b32 v71, 16, v71
  s_waitcnt lgkmcnt(10)
  v_lshlrev_b32 v72, 16, v72
  s_waitcnt lgkmcnt(9)
  v_lshlrev_b32 v73, 16, v73
  s_waitcnt lgkmcnt(8)
  v_lshlrev_b32 v74, 16, v74
  s_waitcnt lgkmcnt(7)
  v_lshlrev_b32 v75, 16, v75
  s_waitcnt lgkmcnt(6)
  v_lshlrev_b32 v76, 16, v76
  s_waitcnt lgkmcnt(5)
  v_lshlrev_b32 v77, 16, v77
  s_waitcnt lgkmcnt(4)
  v_lshlrev_b32 v78, 16, v78
  s_waitcnt lgkmcnt(3)
  v_lshlrev_b32 v79, 16, v79
  s_waitcnt lgkmcnt(2)
  v_lshlrev_b32 v80, 16, v80
  s_waitcnt lgkmcnt(1)
  v_lshlrev_b32 v81, 16, v81
  s_waitcnt lgkmcnt(0)
  v_lshlrev_b32 v82, 16, v82
  v_max3_f32 v14, abs(v52), abs(v53), abs(v54)
  v_max3_f32 v14, v14, abs(v55), abs(v56)
  v_max3_f32 v14, v14, abs(v57), abs(v58)
  v_max3_f32 v14, v14, abs(v59), abs(v60)
  v_max3_f32 v14, v14, abs(v61), abs(v62)
  v_max3_f32 v14, v14, abs(v63), abs(v64)
  v_max3_f32 v14, v14, abs(v65), abs(v66)
  v_max3_f32 v14, v14, abs(v67), abs(v68)
  v_max3_f32 v14, v14, abs(v69), abs(v70)
  v_max3_f32 v14, v14, abs(v71), abs(v72)
  v_max3_f32 v14, v14, abs(v73), abs(v74)
  v_max3_f32 v14, v14, abs(v75), abs(v76)
  v_max3_f32 v14, v14, abs(v77), abs(v78)
  v_max3_f32 v14, v14, abs(v79), abs(v80)
  v_max3_f32 v14, v14, abs(v81), abs(v82)
  s_nop 1
  v_max_u32_dpp v14, v14, v14 row_shr:1 row_mask:0xf bank_mask:0xf
  s_nop 1
  v_max_u32_dpp v14, v14, v14 row_shr:2 row_mask:0xf bank_mask:0xf
  s_nop 1
  v_max_u32_dpp v14, v14, v14 row_shr:4 row_mask:0xf bank_mask:0xf
  s_nop 1
  v_max_u32_dpp v14, v14, v14 row_shr:8 row_mask:0xf bank_mask:0xf
  s_nop 1
  v_max_u32_dpp v14, v14, v14 row_bcast:15 row_mask:0xa bank_mask:0xf
  s_nop 1
  v_max_u32_dpp v14, v14, v14 row_bcast:31 row_mask:0xc bank_mask:0xf
  s_nop 0
  v_readlane_b32 s81, v14, 63
  s_nop 0
  s_lshr_b32 s81, s81, 23
  s_sub_i32 s81, 134, s81
  s_min_i32 s81, s81, 16
  s_lshl_b32 s49, s81, 2
  s_sub_i32 s49, s48, s49
  s_add_i32 s81, s81, 127
  s_lshl_b32 s81, s81, 23
  v_mov_b32 v83, s81
  v_mul_f32 v52, s81, v52
  v_mul_f32 v53, s81, v53
  v_mul_f32 v54, s81, v54
  v_mul_f32 v55, s81, v55
  v_mul_f32 v56, s81, v56
  v_mul_f32 v57, s81, v57
  v_mul_f32 v58, s81, v58
  v_mul_f32 v59, s81, v59
  v_mul_f32 v60, s81, v60
  v_mul_f32 v61, s81, v61
  v_mul_f32 v62, s81, v62
  v_mul_f32 v63, s81, v63
  v_mul_f32 v64, s81, v64
  v_mul_f32 v65, s81, v65
  v_mul_f32 v66, s81, v66
  v_mul_f32 v67, s81, v67
  v_mul_f32 v68, s81, v68
  v_mul_f32 v69, s81, v69
  v_mul_f32 v70, s81, v70
  v_mul_f32 v71, s81, v71
  v_mul_f32 v72, s81, v72
  v_mul_f32 v73, s81, v73
  v_mul_f32 v74, s81, v74
  v_mul_f32 v75, s81, v75
  v_mul_f32 v76, s81, v76
  v_mul_f32 v77, s81, v77
  v_mul_f32 v78, s81, v78
  v_mul_f32 v79, s81, v79
  v_mul_f32 v80, s81, v80
  v_mul_f32 v81, s81, v81
  v_mul_f32 v82, s81, v82
  ds_write_b16_d16_hi v23, v52 offset:0
  ds_write_b16_d16_hi v23, v53 offset:128
  ds_write_b16_d16_hi v23, v54 offset:256
  ds_write_b16_d16_hi v23, v55 offset:384
  ds_write_b16_d16_hi v23, v56 offset:512
  ds_write_b16_d16_hi v23, v57 offset:640
  ds_write_b16_d16_hi v23, v58 offset:768
  ds_write_b16_d16_hi v23, v59 offset:896
  ds_write_b16_d16_hi v23, v60 offset:1056
  ds_write_b16_d16_hi v23, v61 offset:1184
  ds_write_b16_d16_hi v23, v62 offset:1312
  ds_write_b16_d16_hi v23, v63 offset:1440
  ds_write_b16_d16_hi v23, v64 offset:1568
  ds_write_b16_d16_hi v23, v65 offset:1696
  ds_write_b16_d16_hi v23, v66 offset:1824
  ds_write_b16_d16_hi v23, v67 offset:1952
  ds_write_b16_d16_hi v23, v68 offset:2112
  ds_write_b16_d16_hi v23, v69 offset:2240
  ds_write_b16_d16_hi v23, v70 offset:2368
  ds_write_b16_d16_hi v23, v71 offset:2496
  ds_write_b16_d16_hi v23, v72 offset:2624
  ds_write_b16_d16_hi v23, v73 offset:2752
  ds_write_b16_d16_hi v23, v74 offset:2880
  ds_write_b16_d16_hi v23, v75 offset:3008
  ds_write_b16_d16_hi v23, v76 offset:3168
  ds_write_b16_d16_hi v23, v77 offset:3296
  ds_write_b16_d16_hi v23, v78 offset:3424
  ds_write_b16_d16_hi v23, v79 offset:3552
  ds_write_b16_d16_hi v23, v80 offset:3680
  ds_write_b16_d16_hi v23, v81 offset:3808
  ds_write_b16_d16_hi v23, v82 offset:3936
  v_mul_f32 v52, s81, v52
  v_mul_f32 v53, s81, v53
  v_mul_f32 v54, s81, v54
  v_mul_f32 v55, s81, v55
  v_mul_f32 v56, s81, v56
  v_mul_f32 v57, s81, v57
  v_mul_f32 v58, s81, v58
  v_mul_f32 v59, s81, v59
  v_mul_f32 v60, s81, v60
  v_mul_f32 v61, s81, v61
  v_mul_f32 v62, s81, v62
  v_mul_f32 v63, s81, v63
  v_mul_f32 v64, s81, v64
  v_mul_f32 v65, s81, v65
  v_mul_f32 v66, s81, v66
  v_mul_f32 v67, s81, v67
  v_mul_f32 v68, s81, v68
  v_mul_f32 v69, s81, v69
  v_mul_f32 v70, s81, v70
  v_mul_f32 v71, s81, v71
  v_mul_f32 v72, s81, v72
  v_mul_f32 v73, s81, v73
  v_mul_f32 v74, s81, v74
  v_mul_f32 v75, s81, v75
  v_mul_f32 v76, s81, v76
  v_mul_f32 v77, s81, v77
  v_mul_f32 v78, s81, v78
  v_mul_f32 v79, s81, v79
  v_mul_f32 v80, s81, v80
  v_mul_f32 v81, s81, v81
  v_mul_f32 v82, s81, v82
  v_mul_f32 v83, s81, v83
  ds_write_b16_d16_hi v22, v52 offset:0
  ds_write_b16_d16_hi v22, v53 offset:128
  ds_write_b16_d16_hi v22, v54 offset:256
  ds_write_b16_d16_hi v22, v55 offset:384
  ds_write_b16_d16_hi v22, v56 offset:512
  ds_write_b16_d16_hi v22, v57 offset:640
  ds_write_b16_d16_hi v22, v58 offset:768
  ds_write_b16_d16_hi v22, v59 offset:896
  ds_write_b16_d16_hi v22, v60 offset:1056
  ds_write_b16_d16_hi v22, v61 offset:1184
  ds_write_b16_d16_hi v22, v62 offset:1312
  ds_write_b16_d16_hi v22, v63 offset:1440
  ds_write_b16_d16_hi v22, v64 offset:1568
  ds_write_b16_d16_hi v22, v65 offset:1696
  ds_write_b16_d16_hi v22, v66 offset:1824
  ds_write_b16_d16_hi v22, v67 offset:1952
  ds_write_b16_d16_hi v22, v68 offset:2112
  ds_write_b16_d16_hi v22, v69 offset:2240
  ds_write_b16_d16_hi v22, v70 offset:2368
  ds_write_b16_d16_hi v22, v71 offset:2496
  ds_write_b16_d16_hi v22, v72 offset:2624
  ds_write_b16_d16_hi v22, v73 offset:2752
  ds_write_b16_d16_hi v22, v74 offset:2880
  ds_write_b16_d16_hi v22, v75 offset:3008
  ds_write_b16_d16_hi v22, v76 offset:3168
  ds_write_b16_d16_hi v22, v77 offset:3296
  ds_write_b16_d16_hi v22, v78 offset:3424
  ds_write_b16_d16_hi v22, v79 offset:3552
  ds_write_b16_d16_hi v22, v80 offset:3680
  ds_write_b16_d16_hi v22, v81 offset:3808
  ds_write_b16_d16_hi v22, v82 offset:3936
  ds_write_b16_d16_hi v22, v83 offset:4064
  s_mov_b32 s50, 0
  s_mov_b32 s97, 2
  s_waitcnt lgkmcnt(0)
  s_branch L_prime
L_cin_done:
  s_endpgm
L_rem:
  s_lshr_b32 s84, s3, 2
  s_and_b32 s68, s2, 7
  s_lshl_b32 s68, s68, 3
  s_add_u32 s68, s68, s3
  s_mul_i32 s68, s68, 6656
  s_lshl_b32 s76, s3, 14
  v_lshlrev_b32 v248, 4, v0
  v_lshrrev_b32 v246, 4, v0
  v_lshrrev_b32 v247, 3, v0
  v_mul_u32_u24 v13, 3328, v247
  v_and_b32 v247, 2, v247
  s_and_b32 s69, s3, 1
  s_lshl_b32 s69, s69, 2
  v_or_b32 v247, s69, v247
  v_and_b32 v9, 7, v0
  v_xor_b32 v247, v247, v9
  v_lshl_add_u32 v13, v247, 4, v13
  s_mul_i32 s74, s3, 26624
  s_add_u32 s74, s74, 3200
  s_lshl_b32 s75, s3, 10
  s_add_u32 s75, s75, 131072
  s_waitcnt lgkmcnt(0)
  s_mov_b32 s28, s4
  s_and_b32 s29, s5, 0xffff
  s_mov_b32 s30, 425984
  s_mov_b32 s31, 0x20000
  s_add_u32 m0, s76, 8192
  s_nop 0
  buffer_load_dwordx4 v248, s[28:31], s68 offen lds
  s_add_u32 s68, s68, 1024
  s_add_u32 m0, s76, 9216
  s_nop 0
  buffer_load_dwordx4 v248, s[28:31], s68 offen lds
  s_add_u32 s68, s68, 1024
  s_add_u32 m0, s76, 10240
  s_nop 0
  buffer_load_dwordx4 v248, s[28:31], s68 offen lds
  s_add_u32 s68, s68, 1024
  s_add_u32 m0, s76, 11264
  s_nop 0
  buffer_load_dwordx4 v248, s[28:31], s68 offen lds
  s_add_u32 s68, s68, 1024
  s_add_u32 m0, s76, 12288
  s_nop 0
  buffer_load_dwordx4 v248, s[28:31], s68 offen lds
  s_add_u32 s68, s68, 1024
  s_add_u32 m0, s76, 13312
  s_nop 0
  buffer_load_dwordx4 v248, s[28:31], s68 offen lds
  s_add_u32 s68, s68, 1024
  s_add_u32 m0, s76, 14336
  s_nop 0
  buffer_load_dwordx4 v248, s[28:31], s68 offen lds
  s_add_u32 s68, s68, 1024
  s_mov_b32 s44, s12
  s_and_b32 s45, s13, 0xffff
  s_mov_b32 s46, 5537792
  s_mov_b32 s47, 0x20000
  s_add_u32 m0, s75, 0
  s_nop 0
  buffer_load_dwordx4 v13, s[44:47], s74 offen lds
  s_add_u32 s74, s74, 212992
  s_mov_b32 s60, s24
  s_and_b32 s61, s25, 0xffff
  s_mov_b32 s62, 268435456
  s_mov_b32 s63, 0x20000
  s_mov_b32 s64, s22
  s_and_b32 s65, s23, 0xffff
  s_mov_b32 s66, 256
  s_mov_b32 s67, 0x20000
  v_mov_b32 v64, -1
  v_mov_b32 v65, -1
  v_mov_b32 v66, -1
  v_mov_b32 v67, -1
  s_and_b32 s70, s2, 7
  s_lshl_b32 s68, s70, 3
  s_add_u32 s68, s68, s3
  s_lshl_b32 s68, s68, 11
  s_lshl_b32 s70, s70, 2
  buffer_store_dwordx4 v[64:67], v248, s[60:63], s68 offen sc1
  buffer_store_dwordx4 v[64:67], v248, s[60:63], s68 offen offset:1024 sc1
  s_mov_b32 s48, s14
  s_and_b32 s49, s15, 0xffff
  s_mov_b32 s50, 3328
  s_mov_b32 s51, 0x20000
  s_mov_b32 s52, s16
  s_and_b32 s53, s17, 0xffff
  s_mov_b32 s54, 3328
  s_mov_b32 s55, 0x20000
  s_mov_b32 s32, s6
  s_and_b32 s33, s7, 0xffff
  s_mov_b32 s34, 12800000
  s_mov_b32 s35, 0x20000
  v_xor_b32 v248, v9, v246
  v_lshlrev_b32 v14, 4, v248
  v_xor_b32 v15, 64, v14
  v_bfe_u32 v247, v0, 2, 2
  v_lshl_add_u32 v248, v246, 3, v247
  v_lshlrev_b32 v248, 7, v248
  v_and_b32 v247, 3, v0
  v_lshl_add_u32 v248, v247, 3, v248
  v_add_u32 v248, 131072, v248
  v_bfe_u32 v247, v0, 3, 2
  v_lshl_add_u32 v1, v247, 5, v248
  v_xor_b32 v2, 32, v1
  v_xor_b32 v7, 64, v1
  v_xor_b32 v8, 96, v1
  v_and_b32 v248, 15, v0
  v_lshlrev_b32 v248, 7, v248
  v_bfe_u32 v247, v0, 1, 3
  v_xor_b32 v247, v247, v246
  v_lshl_add_u32 v248, v247, 4, v248
  v_add_u32 v11, s76, v248
  v_xor_b32 v12, 64, v11
  v_lshrrev_b32 v247, 3, v0
  v_lshl_add_u32 v248, v9, 3, v247
  v_mul_u32_u24 v248, 104, v248
  v_add_u32 v248, s76, v248
  v_mov_b32 v240, 0xc0135761
  v_mov_b32 v241, 0xc0135761
  v_mov_b32 v242, 0xbdd2d3e8
  v_mov_b32 v243, 0xbdd2d3e8
  v_mov_b32 v244, 0x71800000
  v_mov_b32 v160, 0
  v_mov_b32 v161, 0
  v_mov_b32 v162, 0
  v_mov_b32 v163, 0
  v_mov_b32 v164, 0
  v_mov_b32 v165, 0
  v_mov_b32 v166, 0
  v_mov_b32 v167, 0
  v_mov_b32 v168, 0
  v_mov_b32 v169, 0
  v_mov_b32 v170, 0
  v_mov_b32 v171, 0
  v_mov_b32 v172, 0
  v_mov_b32 v173, 0
  v_mov_b32 v174, 0
  v_mov_b32 v175, 0
  v_mov_b32 v176, 0
  v_mov_b32 v177, 0
  v_mov_b32 v178, 0
  v_mov_b32 v179, 0
  v_mov_b32 v180, 0
  v_mov_b32 v181, 0
  v_mov_b32 v182, 0
  v_mov_b32 v183, 0
  v_mov_b32 v184, 0
  v_mov_b32 v185, 0
  v_mov_b32 v186, 0
  v_mov_b32 v187, 0
  v_mov_b32 v188, 0
  v_mov_b32 v189, 0
  v_mov_b32 v190, 0
  v_mov_b32 v191, 0
  v_mov_b32 v192, 0
  v_mov_b32 v193, 0
  v_mov_b32 v194, 0
  v_mov_b32 v195, 0
  v_mov_b32 v196, 0
  v_mov_b32 v197, 0
  v_mov_b32 v198, 0
  v_mov_b32 v199, 0
  v_mov_b32 v200, 0
  v_mov_b32 v201, 0
  v_mov_b32 v202, 0
  v_mov_b32 v203, 0
  v_mov_b32 v204, 0
  v_mov_b32 v205, 0
  v_mov_b32 v206, 0
  v_mov_b32 v207, 0
  v_mov_b32 v208, 0
  v_mov_b32 v209, 0
  v_mov_b32 v210, 0
  v_mov_b32 v211, 0
  v_mov_b32 v212, 0
  v_mov_b32 v213, 0
  v_mov_b32 v214, 0
  v_mov_b32 v215, 0
  v_mov_b32 v216, 0
  v_mov_b32 v217, 0
  v_mov_b32 v218, 0
  v_mov_b32 v219, 0
  v_mov_b32 v220, 0
  v_mov_b32 v221, 0
  v_mov_b32 v222, 0
  v_mov_b32 v223, 0
  s_waitcnt vmcnt(0)
  ds_read_b64 v[32:33], v248 offset:8192
  ds_read_b64 v[34:35], v248 offset:8200
  ds_read_b64 v[36:37], v248 offset:8208
  ds_read_b64 v[38:39], v248 offset:8216
  ds_read_b64 v[40:41], v248 offset:8224
  ds_read_b64 v[42:43], v248 offset:8232
  ds_read_b64 v[44:45], v248 offset:8240
  ds_read_b64 v[46:47], v248 offset:8248
  ds_read_b64 v[48:49], v248 offset:8256
  ds_read_b64 v[50:51], v248 offset:8264
  ds_read_b64 v[52:53], v248 offset:8272
  ds_read_b64 v[54:55], v248 offset:8280
  ds_read_b64 v[56:57], v248 offset:8288
  v_mov_b32 v24, 0
  v_mov_b32 v25, 0
  v_mov_b32 v26, 0
  v_mov_b32 v27, 0
  v_mov_b32 v28, 0
  v_mov_b32 v29, 0
  v_mov_b32 v30, 0
  v_mov_b32 v31, 0
  v_mov_b32 v58, 0x7f000000
  v_mov_b32 v59, 0x7f000000
  s_waitcnt lgkmcnt(12)
  v_lshlrev_b32 v32, 7, v32
  s_nop 1
  v_add_u32_dpp v24, v32, v14 row_newbcast:0 row_mask:0xf bank_mask:0x3
  v_add_u32_dpp v25, v32, v15 row_newbcast:1 row_mask:0xf bank_mask:0x3
  v_add_u32_dpp v26, v32, v14 row_newbcast:2 row_mask:0xf bank_mask:0x3
  v_add_u32_dpp v27, v32, v15 row_newbcast:3 row_mask:0xf bank_mask:0x3
  v_add_u32_dpp v24, v32, v14 row_newbcast:8 row_mask:0xf bank_mask:0xc
  v_add_u32_dpp v25, v32, v15 row_newbcast:9 row_mask:0xf bank_mask:0xc
  v_add_u32_dpp v26, v32, v14 row_newbcast:10 row_mask:0xf bank_mask:0xc
  v_add_u32_dpp v27, v32, v15 row_newbcast:11 row_mask:0xf bank_mask:0xc
  s_add_u32 m0, s76, 0
  s_nop 0
  buffer_load_dwordx4 v24, s[32:35], 0 offen lds
  s_add_u32 m0, s76, 1024
  s_nop 0
  buffer_load_dwordx4 v25, s[32:35], 0 offen lds
  s_add_u32 m0, s76, 2048
  s_nop 0
  buffer_load_dwordx4 v26, s[32:35], 0 offen lds
  s_add_u32 m0, s76, 3072
  s_nop 0
  buffer_load_dwordx4 v27, s[32:35], 0 offen lds
  v_add_u32_dpp v28, v32, v14 row_newbcast:4 row_mask:0xf bank_mask:0x3
  v_add_u32_dpp v29, v32, v15 row_newbcast:5 row_mask:0xf bank_mask:0x3
  v_add_u32_dpp v30, v32, v14 row_newbcast:6 row_mask:0xf bank_mask:0x3
  v_add_u32_dpp v31, v32, v15 row_newbcast:7 row_mask:0xf bank_mask:0x3
  v_add_u32_dpp v28, v32, v14 row_newbcast:12 row_mask:0xf bank_mask:0xc
  v_add_u32_dpp v29, v32, v15 row_newbcast:13 row_mask:0xf bank_mask:0xc
  v_add_u32_dpp v30, v32, v14 row_newbcast:14 row_mask:0xf bank_mask:0xc
  v_add_u32_dpp v31, v32, v15 row_newbcast:15 row_mask:0xf bank_mask:0xc
  s_add_u32 m0, s76, 4096
  s_nop 0
  buffer_load_dwordx4 v28, s[32:35], 0 offen lds
  s_add_u32 m0, s76, 5120
  s_nop 0
  buffer_load_dwordx4 v29, s[32:35], 0 offen lds
  s_add_u32 m0, s76, 6144
  s_nop 0
  buffer_load_dwordx4 v30, s[32:35], 0 offen lds
  s_add_u32 m0, s76, 7168
  s_nop 0
  buffer_load_dwordx4 v31, s[32:35], 0 offen lds
  s_add_u32 m0, s75, 8192
  s_nop 0
  buffer_load_dwordx4 v13, s[44:47], s74 offen lds
  s_add_u32 s74, s74, 212992
  s_waitcnt lgkmcnt(0)
  v_lshlrev_b32 v57, 7, v57
  v_lshlrev_b32 v56, 7, v56
  v_lshlrev_b32 v55, 7, v55
  v_lshlrev_b32 v54, 7, v54
  v_lshlrev_b32 v53, 7, v53
  v_lshlrev_b32 v52, 7, v52
  v_lshlrev_b32 v51, 7, v51
  v_lshlrev_b32 v50, 7, v50
  v_lshlrev_b32 v49, 7, v49
  v_lshlrev_b32 v48, 7, v48
  v_lshlrev_b32 v47, 7, v47
  v_lshlrev_b32 v46, 7, v46
  v_lshlrev_b32 v45, 7, v45
  v_lshlrev_b32 v44, 7, v44
  v_lshlrev_b32 v43, 7, v43
  v_lshlrev_b32 v42, 7, v42
  v_lshlrev_b32 v41, 7, v41
  v_lshlrev_b32 v40, 7, v40
  v_lshlrev_b32 v39, 7, v39
  v_lshlrev_b32 v38, 7, v38
  v_lshlrev_b32 v37, 7, v37
  v_lshlrev_b32 v36, 7, v36
  v_lshlrev_b32 v35, 7, v35
  v_lshlrev_b32 v34, 7, v34
  v_lshlrev_b32 v33, 7, v33
  s_nop 1
  v_add_u32_dpp v24, v33, v14 row_newbcast:0 row_mask:0xf bank_mask:0x3
  v_add_u32_dpp v25, v33, v15 row_newbcast:1 row_mask:0xf bank_mask:0x3
  v_add_u32_dpp v26, v33, v14 row_newbcast:2 row_mask:0xf bank_mask:0x3
  v_add_u32_dpp v27, v33, v15 row_newbcast:3 row_mask:0xf bank_mask:0x3
  v_add_u32_dpp v24, v33, v14 row_newbcast:8 row_mask:0xf bank_mask:0xc
  v_add_u32_dpp v25, v33, v15 row_newbcast:9 row_mask:0xf bank_mask:0xc
  v_add_u32_dpp v26, v33, v14 row_newbcast:10 row_mask:0xf bank_mask:0xc
  v_add_u32_dpp v27, v33, v15 row_newbcast:11 row_mask:0xf bank_mask:0xc
  s_add_u32 m0, s76, 8192
  s_nop 0
  buffer_load_dwordx4 v24, s[32:35], 0 offen lds
  s_add_u32 m0, s76, 9216
  s_nop 0
  buffer_load_dwordx4 v25, s[32:35], 0 offen lds
  s_add_u32 m0, s76, 10240
  s_nop 0
  buffer_load_dwordx4 v26, s[32:35], 0 offen lds
  s_add_u32 m0, s76, 11264
  s_nop 0
  buffer_load_dwordx4 v27, s[32:35], 0 offen lds
  v_add_u32_dpp v28, v33, v14 row_newbcast:4 row_mask:0xf bank_mask:0x3
  v_add_u32_dpp v29, v33, v15 row_newbcast:5 row_mask:0xf bank_mask:0x3
  v_add_u32_dpp v30, v33, v14 row_newbcast:6 row_mask:0xf bank_mask:0x3
  v_add_u32_dpp v31, v33, v15 row_newbcast:7 row_mask:0xf bank_mask:0x3
  v_add_u32_dpp v28, v33, v14 row_newbcast:12 row_mask:0xf bank_mask:0xc
  v_add_u32_dpp v29, v33, v15 row_newbcast:13 row_mask:0xf bank_mask:0xc
  v_add_u32_dpp v30, v33, v14 row_newbcast:14 row_mask:0xf bank_mask:0xc
  v_add_u32_dpp v31, v33, v15 row_newbcast:15 row_mask:0xf bank_mask:0xc
  s_add_u32 m0, s76, 12288
  s_nop 0
  buffer_load_dwordx4 v28, s[32:35], 0 offen lds
  s_add_u32 m0, s76, 13312
  s_nop 0
  buffer_load_dwordx4 v29, s[32:35], 0 offen lds
  s_add_u32 m0, s76, 14336
  s_nop 0
  buffer_load_dwordx4 v30, s[32:35], 0 offen lds
  s_add_u32 m0, s76, 15360
  s_nop 0
  buffer_load_dwordx4 v31, s[32:35], 0 offen lds
  s_add_u32 m0, s75, 16384
  s_nop 0
  buffer_load_dwordx4 v13, s[44:47], s74 offen lds
  s_add_u32 s74, s74, 212992
  v_lshlrev_b32 v248, 3, v246
  s_mov_b32 s73, 3
  v_mov_b32 v9, v34
  s_nop 1
  v_add_u32_dpp v24, v9, v14 row_newbcast:0 row_mask:0xf bank_mask:0x3
  v_add_u32_dpp v25, v9, v15 row_newbcast:1 row_mask:0xf bank_mask:0x3
  v_add_u32_dpp v26, v9, v14 row_newbcast:2 row_mask:0xf bank_mask:0x3
  v_add_u32_dpp v27, v9, v15 row_newbcast:3 row_mask:0xf bank_mask:0x3
  v_add_u32_dpp v24, v9, v14 row_newbcast:8 row_mask:0xf bank_mask:0xc
  v_add_u32_dpp v25, v9, v15 row_newbcast:9 row_mask:0xf bank_mask:0xc
  v_add_u32_dpp v26, v9, v14 row_newbcast:10 row_mask:0xf bank_mask:0xc
  v_add_u32_dpp v27, v9, v15 row_newbcast:11 row_mask:0xf bank_mask:0xc
  s_waitcnt vmcnt(14)
  s_barrier
  ds_read_b128 v[76:79], v12 offset:2048
  ds_read_b128 v[72:75], v11 offset:2048
  ds_read_b128 v[68:71], v12 offset:0
  ds_read_b128 v[64:67], v11 offset:0
  ds_read_b64_tr_b16 v[96:97], v1 offset:0
  ds_read_b64_tr_b16 v[98:99], v1 offset:512
  ds_read_b64_tr_b16 v[100:101], v1 offset:4096
  ds_read_b64_tr_b16 v[102:103], v1 offset:4608
  ds_read_b64_tr_b16 v[104:105], v2 offset:0
  ds_read_b64_tr_b16 v[106:107], v2 offset:512
  ds_read_b64_tr_b16 v[108:109], v2 offset:4096
  ds_read_b64_tr_b16 v[110:111], v2 offset:4608
  ds_read_b64_tr_b16 v[112:113], v7 offset:0
  ds_read_b64_tr_b16 v[114:115], v7 offset:512
  ds_read_b64_tr_b16 v[116:117], v7 offset:4096
  ds_read_b64_tr_b16 v[118:119], v7 offset:4608
  ds_read_b64_tr_b16 v[120:121], v8 offset:0
  ds_read_b64_tr_b16 v[122:123], v8 offset:512
  ds_read_b64_tr_b16 v[124:125], v8 offset:4096
  ds_read_b64_tr_b16 v[126:127], v8 offset:4608
  s_cmp_lg_u32 s3, 7
  s_cbranch_scc1 L_rem_loop
  s_mov_b64 exec, 1
  buffer_store_dword v240, v14, s[64:67], s70 offen offset:128 sc1
  s_mov_b64 exec, -1
L_rem_loop:
  s_waitcnt vmcnt(9)
  s_barrier
  s_waitcnt lgkmcnt(8)
  v_mfma_f32_16x16x32_bf16 v[160:163], v[96:99], v[64:67], v[160:163]
  ds_read_b128 v[92:95], v12 offset:6144
  ds_read_b128 v[88:91], v11 offset:6144
  s_waitcnt lgkmcnt(14)
  v_mfma_f32_16x16x32_bf16 v[160:163], v[100:103], v[68:71], v[160:163]
  ds_read_b128 v[84:87], v12 offset:4096
  s_add_u32 m0, s76, 0
  s_nop 0
  buffer_load_dwordx4 v24, s[32:35], 0 offen lds
  v_mfma_f32_16x16x32_bf16 v[164:167], v[96:99], v[72:75], v[164:167]
  ds_read_b128 v[80:83], v11 offset:4096
  v_mfma_f32_16x16x32_bf16 v[164:167], v[100:103], v[76:79], v[164:167]
  ds_read_b64_tr_b16 v[128:129], v1 offset:8192
  s_waitcnt lgkmcnt(14)
  v_mfma_f32_16x16x32_bf16 v[176:179], v[104:107], v[64:67], v[176:179]
  ds_read_b64_tr_b16 v[130:131], v1 offset:8704
  s_add_u32 m0, s76, 1024
  s_nop 0
  buffer_load_dwordx4 v25, s[32:35], 0 offen lds
  s_waitcnt lgkmcnt(14)
  v_mfma_f32_16x16x32_bf16 v[176:179], v[108:111], v[68:71], v[176:179]
  ds_read_b64_tr_b16 v[132:133], v1 offset:12288
  v_mfma_f32_16x16x32_bf16 v[180:183], v[104:107], v[72:75], v[180:183]
  ds_read_b64_tr_b16 v[134:135], v1 offset:12800
  v_mfma_f32_16x16x32_bf16 v[180:183], v[108:111], v[76:79], v[180:183]
  ds_read_b64_tr_b16 v[136:137], v2 offset:8192
  s_waitcnt lgkmcnt(14)
  v_mfma_f32_16x16x32_bf16 v[192:195], v[112:115], v[64:67], v[192:195]
  ds_read_b64_tr_b16 v[138:139], v2 offset:8704
  s_add_u32 m0, s76, 2048
  s_nop 0
  buffer_load_dwordx4 v26, s[32:35], 0 offen lds
  s_waitcnt lgkmcnt(14)
  v_mfma_f32_16x16x32_bf16 v[192:195], v[116:119], v[68:71], v[192:195]
  ds_read_b64_tr_b16 v[140:141], v2 offset:12288
  v_mfma_f32_16x16x32_bf16 v[196:199], v[112:115], v[72:75], v[196:199]
  ds_read_b64_tr_b16 v[142:143], v2 offset:12800
  v_mfma_f32_16x16x32_bf16 v[196:199], v[116:119], v[76:79], v[196:199]
  v_add_u32_dpp v28, v9, v14 row_newbcast:4 row_mask:0xf bank_mask:0x3
  v_add_u32_dpp v29, v9, v15 row_newbcast:5 row_mask:0xf bank_mask:0x3
  s_waitcnt lgkmcnt(14)
  v_mfma_f32_16x16x32_bf16 v[208:211], v[120:123], v[64:67], v[208:211]
  s_add_u32 m0, s76, 3072
  s_nop 0
  buffer_load_dwordx4 v27, s[32:35], 0 offen lds
  v_add_u32_dpp v30, v9, v14 row_newbcast:6 row_mask:0xf bank_mask:0x3
  v_add_u32_dpp v31, v9, v15 row_newbcast:7 row_mask:0xf bank_mask:0x3
  s_waitcnt lgkmcnt(12)
  v_mfma_f32_16x16x32_bf16 v[208:211], v[124:127], v[68:71], v[208:211]
  v_add_u32_dpp v28, v9, v14 row_newbcast:12 row_mask:0xf bank_mask:0xc
  v_mfma_f32_16x16x32_bf16 v[212:215], v[120:123], v[72:75], v[212:215]
  v_add_u32_dpp v29, v9, v15 row_newbcast:13 row_mask:0xf bank_mask:0xc
  v_add_u32_dpp v30, v9, v14 row_newbcast:14 row_mask:0xf bank_mask:0xc
  v_mfma_f32_16x16x32_bf16 v[212:215], v[124:127], v[76:79], v[212:215]
  v_add_u32_dpp v31, v9, v15 row_newbcast:15 row_mask:0xf bank_mask:0xc
  s_waitcnt vmcnt(9)
  s_waitcnt lgkmcnt(8)
  v_mfma_f32_16x16x32_bf16 v[168:171], v[96:99], v[80:83], v[168:171]
  ds_read_b128 v[76:79], v12 offset:10240
  ds_read_b128 v[72:75], v11 offset:10240
  v_mfma_f32_16x16x32_bf16 v[168:171], v[100:103], v[84:87], v[168:171]
  ds_read_b128 v[68:71], v12 offset:8192
  s_add_u32 m0, s76, 4096
  s_nop 0
  buffer_load_dwordx4 v28, s[32:35], 0 offen lds
  v_mfma_f32_16x16x32_bf16 v[172:175], v[96:99], v[88:91], v[172:175]
  ds_read_b128 v[64:67], v11 offset:8192
  v_mfma_f32_16x16x32_bf16 v[172:175], v[100:103], v[92:95], v[172:175]
  ds_read_b64_tr_b16 v[144:145], v7 offset:8192
  v_mfma_f32_16x16x32_bf16 v[184:187], v[104:107], v[80:83], v[184:187]
  ds_read_b64_tr_b16 v[146:147], v7 offset:8704
  s_add_u32 m0, s76, 5120
  s_nop 0
  buffer_load_dwordx4 v29, s[32:35], 0 offen lds
  v_mfma_f32_16x16x32_bf16 v[184:187], v[108:111], v[84:87], v[184:187]
  ds_read_b64_tr_b16 v[148:149], v7 offset:12288
  v_mfma_f32_16x16x32_bf16 v[188:191], v[104:107], v[88:91], v[188:191]
  ds_read_b64_tr_b16 v[150:151], v7 offset:12800
  v_mfma_f32_16x16x32_bf16 v[188:191], v[108:111], v[92:95], v[188:191]
  ds_read_b64_tr_b16 v[152:153], v8 offset:8192
  s_add_u32 m0, s76, 6144
  s_nop 0
  buffer_load_dwordx4 v30, s[32:35], 0 offen lds
  v_mfma_f32_16x16x32_bf16 v[200:203], v[112:115], v[80:83], v[200:203]
  ds_read_b64_tr_b16 v[154:155], v8 offset:8704
  v_mfma_f32_16x16x32_bf16 v[200:203], v[116:119], v[84:87], v[200:203]
  ds_read_b64_tr_b16 v[156:157], v8 offset:12288
  v_mfma_f32_16x16x32_bf16 v[204:207], v[112:115], v[88:91], v[204:207]
  ds_read_b64_tr_b16 v[158:159], v8 offset:12800
  s_add_u32 m0, s76, 7168
  s_nop 0
  buffer_load_dwordx4 v31, s[32:35], 0 offen lds
  v_mfma_f32_16x16x32_bf16 v[204:207], v[116:119], v[92:95], v[204:207]
  s_set_gpr_idx_on s73, gpr_idx(SRC0)
  s_nop 0
  v_mov_b32 v9, v32
  s_set_gpr_idx_off
  s_add_u32 s73, s73, 1
  v_add_u32_dpp v24, v9, v14 row_newbcast:0 row_mask:0xf bank_mask:0x3
  v_mfma_f32_16x16x32_bf16 v[216:219], v[120:123], v[80:83], v[216:219]
  v_add_u32_dpp v25, v9, v15 row_newbcast:1 row_mask:0xf bank_mask:0x3
  v_add_u32_dpp v26, v9, v14 row_newbcast:2 row_mask:0xf bank_mask:0x3
  v_mfma_f32_16x16x32_bf16 v[216:219], v[124:127], v[84:87], v[216:219]
  s_xor_b32 s75, s75, 16384
  s_add_u32 m0, s75, 8192
  s_nop 0
  buffer_load_dwordx4 v13, s[44:47], s74 offen lds
  s_add_u32 s74, s74, 212992
  s_xor_b32 s75, s75, 16384
  v_add_u32_dpp v27, v9, v15 row_newbcast:3 row_mask:0xf bank_mask:0x3
  v_add_u32_dpp v24, v9, v14 row_newbcast:8 row_mask:0xf bank_mask:0xc
  v_mfma_f32_16x16x32_bf16 v[220:223], v[120:123], v[88:91], v[220:223]
  v_add_u32_dpp v25, v9, v15 row_newbcast:9 row_mask:0xf bank_mask:0xc
  v_add_u32_dpp v26, v9, v14 row_newbcast:10 row_mask:0xf bank_mask:0xc
  v_mfma_f32_16x16x32_bf16 v[220:223], v[124:127], v[92:95], v[220:223]
  v_add_u32_dpp v27, v9, v15 row_newbcast:11 row_mask:0xf bank_mask:0xc
  s_waitcnt vmcnt(9)
  s_barrier
  v_xor_b32 v1, 16384, v1
  v_xor_b32 v2, 16384, v2
  v_xor_b32 v7, 16384, v7
  v_xor_b32 v8, 16384, v8
  s_waitcnt lgkmcnt(8)
  v_mfma_f32_16x16x32_bf16 v[160:163], v[128:131], v[64:67], v[160:163]
  ds_read_b128 v[92:95], v12 offset:14336
  ds_read_b128 v[88:91], v11 offset:14336
  v_mfma_f32_16x16x32_bf16 v[160:163], v[132:135], v[68:71], v[160:163]
  ds_read_b128 v[84:87], v12 offset:12288
  s_add_u32 m0, s76, 8192
  s_nop 0
  buffer_load_dwordx4 v24, s[32:35], 0 offen lds
  v_mfma_f32_16x16x32_bf16 v[164:167], v[128:131], v[72:75], v[164:167]
  ds_read_b128 v[80:83], v11 offset:12288
  v_mfma_f32_16x16x32_bf16 v[164:167], v[132:135], v[76:79], v[164:167]
  ds_read_b64_tr_b16 v[96:97], v1 offset:0
  v_mfma_f32_16x16x32_bf16 v[176:179], v[136:139], v[64:67], v[176:179]
  ds_read_b64_tr_b16 v[98:99], v1 offset:512
  s_add_u32 m0, s76, 9216
  s_nop 0
  buffer_load_dwordx4 v25, s[32:35], 0 offen lds
  v_mfma_f32_16x16x32_bf16 v[176:179], v[140:143], v[68:71], v[176:179]
  ds_read_b64_tr_b16 v[100:101], v1 offset:4096
  v_mfma_f32_16x16x32_bf16 v[180:183], v[136:139], v[72:75], v[180:183]
  ds_read_b64_tr_b16 v[102:103], v1 offset:4608
  v_mfma_f32_16x16x32_bf16 v[180:183], v[140:143], v[76:79], v[180:183]
  ds_read_b64_tr_b16 v[104:105], v2 offset:0
  s_waitcnt lgkmcnt(14)
  v_mfma_f32_16x16x32_bf16 v[192:195], v[144:147], v[64:67], v[192:195]
  ds_read_b64_tr_b16 v[106:107], v2 offset:512
  s_add_u32 m0, s76, 10240
  s_nop 0
  buffer_load_dwordx4 v26, s[32:35], 0 offen lds
  s_waitcnt lgkmcnt(14)
  v_mfma_f32_16x16x32_bf16 v[192:195], v[148:151], v[68:71], v[192:195]
  ds_read_b64_tr_b16 v[108:109], v2 offset:4096
  v_mfma_f32_16x16x32_bf16 v[196:199], v[144:147], v[72:75], v[196:199]
  ds_read_b64_tr_b16 v[110:111], v2 offset:4608
  v_mfma_f32_16x16x32_bf16 v[196:199], v[148:151], v[76:79], v[196:199]
  v_add_u32_dpp v28, v9, v14 row_newbcast:4 row_mask:0xf bank_mask:0x3
  v_add_u32_dpp v29, v9, v15 row_newbcast:5 row_mask:0xf bank_mask:0x3
  s_waitcnt lgkmcnt(14)
  v_mfma_f32_16x16x32_bf16 v[208:211], v[152:155], v[64:67], v[208:211]
  s_add_u32 m0, s76, 11264
  s_nop 0
  buffer_load_dwordx4 v27, s[32:35], 0 offen lds
  v_add_u32_dpp v30, v9, v14 row_newbcast:6 row_mask:0xf bank_mask:0x3
  v_add_u32_dpp v31, v9, v15 row_newbcast:7 row_mask:0xf bank_mask:0x3
  s_waitcnt lgkmcnt(12)
  v_mfma_f32_16x16x32_bf16 v[208:211], v[156:159], v[68:71], v[208:211]
  v_add_u32_dpp v28, v9, v14 row_newbcast:12 row_mask:0xf bank_mask:0xc
  v_mfma_f32_16x16x32_bf16 v[212:215], v[152:155], v[72:75], v[212:215]
  v_add_u32_dpp v29, v9, v15 row_newbcast:13 row_mask:0xf bank_mask:0xc
  v_add_u32_dpp v30, v9, v14 row_newbcast:14 row_mask:0xf bank_mask:0xc
  v_mfma_f32_16x16x32_bf16 v[212:215], v[156:159], v[76:79], v[212:215]
  v_add_u32_dpp v31, v9, v15 row_newbcast:15 row_mask:0xf bank_mask:0xc
  s_waitcnt vmcnt(9)
  s_waitcnt lgkmcnt(8)
  v_mfma_f32_16x16x32_bf16 v[168:171], v[128:131], v[80:83], v[168:171]
  ds_read_b128 v[76:79], v12 offset:2048
  ds_read_b128 v[72:75], v11 offset:2048
  v_mfma_f32_16x16x32_bf16 v[168:171], v[132:135], v[84:87], v[168:171]
  ds_read_b128 v[68:71], v12 offset:0
  s_add_u32 m0, s76, 12288
  s_nop 0
  buffer_load_dwordx4 v28, s[32:35], 0 offen lds
  v_mfma_f32_16x16x32_bf16 v[172:175], v[128:131], v[88:91], v[172:175]
  ds_read_b128 v[64:67], v11 offset:0
  v_mfma_f32_16x16x32_bf16 v[172:175], v[132:135], v[92:95], v[172:175]
  ds_read_b64_tr_b16 v[112:113], v7 offset:0
  v_mfma_f32_16x16x32_bf16 v[184:187], v[136:139], v[80:83], v[184:187]
  ds_read_b64_tr_b16 v[114:115], v7 offset:512
  s_add_u32 m0, s76, 13312
  s_nop 0
  buffer_load_dwordx4 v29, s[32:35], 0 offen lds
  v_mfma_f32_16x16x32_bf16 v[184:187], v[140:143], v[84:87], v[184:187]
  ds_read_b64_tr_b16 v[116:117], v7 offset:4096
  v_mfma_f32_16x16x32_bf16 v[188:191], v[136:139], v[88:91], v[188:191]
  ds_read_b64_tr_b16 v[118:119], v7 offset:4608
  v_mfma_f32_16x16x32_bf16 v[188:191], v[140:143], v[92:95], v[188:191]
  ds_read_b64_tr_b16 v[120:121], v8 offset:0
  s_add_u32 m0, s76, 14336
  s_nop 0
  buffer_load_dwordx4 v30, s[32:35], 0 offen lds
  v_mfma_f32_16x16x32_bf16 v[200:203], v[144:147], v[80:83], v[200:203]
  ds_read_b64_tr_b16 v[122:123], v8 offset:512
  v_mfma_f32_16x16x32_bf16 v[200:203], v[148:151], v[84:87], v[200:203]
  ds_read_b64_tr_b16 v[124:125], v8 offset:4096
  v_mfma_f32_16x16x32_bf16 v[204:207], v[144:147], v[88:91], v[204:207]
  ds_read_b64_tr_b16 v[126:127], v8 offset:4608
  s_add_u32 m0, s76, 15360
  s_nop 0
  buffer_load_dwordx4 v31, s[32:35], 0 offen lds
  v_mfma_f32_16x16x32_bf16 v[204:207], v[148:151], v[92:95], v[204:207]
  s_set_gpr_idx_on s73, gpr_idx(SRC0)
  s_nop 0
  v_mov_b32 v9, v32
  s_set_gpr_idx_off
  s_add_u32 s73, s73, 1
  v_add_u32_dpp v24, v9, v14 row_newbcast:0 row_mask:0xf bank_mask:0x3
  v_mfma_f32_16x16x32_bf16 v[216:219], v[152:155], v[80:83], v[216:219]
  v_add_u32_dpp v25, v9, v15 row_newbcast:1 row_mask:0xf bank_mask:0x3
  v_add_u32_dpp v26, v9, v14 row_newbcast:2 row_mask:0xf bank_mask:0x3
  v_mfma_f32_16x16x32_bf16 v[216:219], v[156:159], v[84:87], v[216:219]
  s_add_u32 m0, s75, 0
  s_nop 0
  buffer_load_dwordx4 v13, s[44:47], s74 offen lds
  s_add_u32 s74, s74, 212992
  s_xor_b32 s75, s75, 16384
  v_add_u32_dpp v27, v9, v15 row_newbcast:3 row_mask:0xf bank_mask:0x3
  v_add_u32_dpp v24, v9, v14 row_newbcast:8 row_mask:0xf bank_mask:0xc
  v_mfma_f32_16x16x32_bf16 v[220:223], v[152:155], v[88:91], v[220:223]
  v_add_u32_dpp v25, v9, v15 row_newbcast:9 row_mask:0xf bank_mask:0xc
  v_add_u32_dpp v26, v9, v14 row_newbcast:10 row_mask:0xf bank_mask:0xc
  v_mfma_f32_16x16x32_bf16 v[220:223], v[156:159], v[92:95], v[220:223]
  v_add_u32_dpp v27, v9, v15 row_newbcast:11 row_mask:0xf bank_mask:0xc
  s_cmp_lt_u32 s73, 27
  s_cbranch_scc1 L_rem_loop
  s_waitcnt vmcnt(0)
  s_barrier
  s_waitcnt lgkmcnt(8)
  v_mfma_f32_16x16x32_bf16 v[160:163], v[96:99], v[64:67], v[160:163]
  ds_read_b128 v[92:95], v12 offset:6144
  ds_read_b128 v[88:91], v11 offset:6144
  v_mfma_f32_16x16x32_bf16 v[160:163], v[100:103], v[68:71], v[160:163]
  ds_read_b128 v[84:87], v12 offset:4096
  buffer_load_dwordx2 v[224:225], v248, s[48:51], 0 offen offset:3200
  v_mfma_f32_16x16x32_bf16 v[164:167], v[96:99], v[72:75], v[164:167]
  ds_read_b128 v[80:83], v11 offset:4096
  buffer_load_dwordx2 v[226:227], v248, s[48:51], 0 offen offset:3232
  v_mfma_f32_16x16x32_bf16 v[164:167], v[100:103], v[76:79], v[164:167]
  ds_read_b64_tr_b16 v[128:129], v1 offset:8192
  v_mfma_f32_16x16x32_bf16 v[176:179], v[104:107], v[64:67], v[176:179]
  ds_read_b64_tr_b16 v[130:131], v1 offset:8704
  buffer_load_dwordx2 v[228:229], v248, s[48:51], 0 offen offset:3264
  v_mfma_f32_16x16x32_bf16 v[176:179], v[108:111], v[68:71], v[176:179]
  ds_read_b64_tr_b16 v[132:133], v1 offset:12288
  v_mfma_f32_16x16x32_bf16 v[180:183], v[104:107], v[72:75], v[180:183]
  ds_read_b64_tr_b16 v[134:135], v1 offset:12800
  buffer_load_dwordx2 v[230:231], v248, s[48:51], 0 offen offset:3296
  v_mfma_f32_16x16x32_bf16 v[180:183], v[108:111], v[76:79], v[180:183]
  ds_read_b64_tr_b16 v[136:137], v2 offset:8192
  s_waitcnt lgkmcnt(14)
  v_mfma_f32_16x16x32_bf16 v[192:195], v[112:115], v[64:67], v[192:195]
  ds_read_b64_tr_b16 v[138:139], v2 offset:8704
  buffer_load_dwordx2 v[232:233], v248, s[52:55], 0 offen offset:3200
  s_waitcnt lgkmcnt(14)
  v_mfma_f32_16x16x32_bf16 v[192:195], v[116:119], v[68:71], v[192:195]
  ds_read_b64_tr_b16 v[140:141], v2 offset:12288
  v_mfma_f32_16x16x32_bf16 v[196:199], v[112:115], v[72:75], v[196:199]
  ds_read_b64_tr_b16 v[142:143], v2 offset:12800
  buffer_load_dwordx2 v[234:235], v248, s[52:55], 0 offen offset:3232
  v_mfma_f32_16x16x32_bf16 v[196:199], v[116:119], v[76:79], v[196:199]
  s_waitcnt lgkmcnt(14)
  v_mfma_f32_16x16x32_bf16 v[208:211], v[120:123], v[64:67], v[208:211]
  buffer_load_dwordx2 v[236:237], v248, s[52:55], 0 offen offset:3264
  s_waitcnt lgkmcnt(12)
  v_mfma_f32_16x16x32_bf16 v[208:211], v[124:127], v[68:71], v[208:211]
  v_mfma_f32_16x16x32_bf16 v[212:215], v[120:123], v[72:75], v[212:215]
  buffer_load_dwordx2 v[238:239], v248, s[52:55], 0 offen offset:3296
  v_mfma_f32_16x16x32_bf16 v[212:215], v[124:127], v[76:79], v[212:215]
  s_waitcnt lgkmcnt(8)
  v_mfma_f32_16x16x32_bf16 v[168:171], v[96:99], v[80:83], v[168:171]
  ds_read_b128 v[76:79], v12 offset:10240
  ds_read_b128 v[72:75], v11 offset:10240
  v_mfma_f32_16x16x32_bf16 v[168:171], v[100:103], v[84:87], v[168:171]
  ds_read_b128 v[68:71], v12 offset:8192
  v_mfma_f32_16x16x32_bf16 v[172:175], v[96:99], v[88:91], v[172:175]
  ds_read_b128 v[64:67], v11 offset:8192
  v_mfma_f32_16x16x32_bf16 v[172:175], v[100:103], v[92:95], v[172:175]
  ds_read_b64_tr_b16 v[144:145], v7 offset:8192
  v_mfma_f32_16x16x32_bf16 v[184:187], v[104:107], v[80:83], v[184:187]
  ds_read_b64_tr_b16 v[146:147], v7 offset:8704
  v_mfma_f32_16x16x32_bf16 v[184:187], v[108:111], v[84:87], v[184:187]
  ds_read_b64_tr_b16 v[148:149], v7 offset:12288
  v_mfma_f32_16x16x32_bf16 v[188:191], v[104:107], v[88:91], v[188:191]
  ds_read_b64_tr_b16 v[150:151], v7 offset:12800
  v_mfma_f32_16x16x32_bf16 v[188:191], v[108:111], v[92:95], v[188:191]
  ds_read_b64_tr_b16 v[152:153], v8 offset:8192
  v_mfma_f32_16x16x32_bf16 v[200:203], v[112:115], v[80:83], v[200:203]
  ds_read_b64_tr_b16 v[154:155], v8 offset:8704
  v_mfma_f32_16x16x32_bf16 v[200:203], v[116:119], v[84:87], v[200:203]
  ds_read_b64_tr_b16 v[156:157], v8 offset:12288
  v_mfma_f32_16x16x32_bf16 v[204:207], v[112:115], v[88:91], v[204:207]
  ds_read_b64_tr_b16 v[158:159], v8 offset:12800
  v_mfma_f32_16x16x32_bf16 v[204:207], v[116:119], v[92:95], v[204:207]
  v_mfma_f32_16x16x32_bf16 v[216:219], v[120:123], v[80:83], v[216:219]
  v_mfma_f32_16x16x32_bf16 v[216:219], v[124:127], v[84:87], v[216:219]
  v_mfma_f32_16x16x32_bf16 v[220:223], v[120:123], v[88:91], v[220:223]
  v_mfma_f32_16x16x32_bf16 v[220:223], v[124:127], v[92:95], v[220:223]
  s_waitcnt lgkmcnt(8)
  v_mfma_f32_16x16x32_bf16 v[160:163], v[128:131], v[64:67], v[160:163]
  ds_read_b128 v[92:95], v12 offset:14336
  v_mfma_f32_16x16x32_bf16 v[160:163], v[132:135], v[68:71], v[160:163]
  v_mfma_f32_16x16x32_bf16 v[164:167], v[128:131], v[72:75], v[164:167]
  ds_read_b128 v[88:91], v11 offset:14336
  v_mfma_f32_16x16x32_bf16 v[164:167], v[132:135], v[76:79], v[164:167]
  v_mfma_f32_16x16x32_bf16 v[176:179], v[136:139], v[64:67], v[176:179]
  v_mfma_f32_16x16x32_bf16 v[176:179], v[140:143], v[68:71], v[176:179]
  ds_read_b128 v[84:87], v12 offset:12288
  v_mfma_f32_16x16x32_bf16 v[180:183], v[136:139], v[72:75], v[180:183]
  v_mfma_f32_16x16x32_bf16 v[180:183], v[140:143], v[76:79], v[180:183]
  s_waitcnt lgkmcnt(9)
  v_mfma_f32_16x16x32_bf16 v[192:195], v[144:147], v[64:67], v[192:195]
  ds_read_b128 v[80:83], v11 offset:12288
  s_waitcnt lgkmcnt(8)
  v_mfma_f32_16x16x32_bf16 v[192:195], v[148:151], v[68:71], v[192:195]
  v_mfma_f32_16x16x32_bf16 v[196:199], v[144:147], v[72:75], v[196:199]
  v_mfma_f32_16x16x32_bf16 v[196:199], v[148:151], v[76:79], v[196:199]
  s_waitcnt lgkmcnt(6)
  v_mfma_f32_16x16x32_bf16 v[208:211], v[152:155], v[64:67], v[208:211]
  s_waitcnt lgkmcnt(4)
  v_mfma_f32_16x16x32_bf16 v[208:211], v[156:159], v[68:71], v[208:211]
  v_mfma_f32_16x16x32_bf16 v[212:215], v[152:155], v[72:75], v[212:215]
  v_mfma_f32_16x16x32_bf16 v[212:215], v[156:159], v[76:79], v[212:215]
  s_waitcnt lgkmcnt(0)
  v_mfma_f32_16x16x32_bf16 v[168:171], v[128:131], v[80:83], v[168:171]
  s_waitcnt vmcnt(7)
  v_lshlrev_b32 v112, 16, v224
  v_and_b32 v113, 0xffff0000, v224
  v_mfma_f32_16x16x32_bf16 v[168:171], v[132:135], v[84:87], v[168:171]
  s_waitcnt vmcnt(3)
  v_lshlrev_b32 v96, 16, v232
  v_and_b32 v97, 0xffff0000, v232
  v_mfma_f32_16x16x32_bf16 v[172:175], v[128:131], v[88:91], v[172:175]
  v_lshlrev_b32 v114, 16, v225
  v_and_b32 v115, 0xffff0000, v225
  v_mfma_f32_16x16x32_bf16 v[172:175], v[132:135], v[92:95], v[172:175]
  v_lshlrev_b32 v98, 16, v233
  v_and_b32 v99, 0xffff0000, v233
  v_mfma_f32_16x16x32_bf16 v[184:187], v[136:139], v[80:83], v[184:187]
  v_lshlrev_b32 v116, 16, v226
  v_and_b32 v117, 0xffff0000, v226
  v_mfma_f32_16x16x32_bf16 v[184:187], v[140:143], v[84:87], v[184:187]
  s_waitcnt vmcnt(2)
  v_lshlrev_b32 v100, 16, v234
  v_and_b32 v101, 0xffff0000, v234
  v_mfma_f32_16x16x32_bf16 v[188:191], v[136:139], v[88:91], v[188:191]
  v_lshlrev_b32 v118, 16, v227
  v_and_b32 v119, 0xffff0000, v227
  v_mfma_f32_16x16x32_bf16 v[188:191], v[140:143], v[92:95], v[188:191]
  v_lshlrev_b32 v102, 16, v235
  v_and_b32 v103, 0xffff0000, v235
  v_mfma_f32_16x16x32_bf16 v[200:203], v[144:147], v[80:83], v[200:203]
  v_lshlrev_b32 v120, 16, v228
  v_and_b32 v121, 0xffff0000, v228
  v_mfma_f32_16x16x32_bf16 v[200:203], v[148:151], v[84:87], v[200:203]
  s_waitcnt vmcnt(1)
  v_lshlrev_b32 v104, 16, v236
  v_and_b32 v105, 0xffff0000, v236
  v_mfma_f32_16x16x32_bf16 v[204:207], v[144:147], v[88:91], v[204:207]
  v_lshlrev_b32 v122, 16, v229
  v_and_b32 v123, 0xffff0000, v229
  v_mfma_f32_16x16x32_bf16 v[204:207], v[148:151], v[92:95], v[204:207]
  v_lshlrev_b32 v106, 16, v237
  v_and_b32 v107, 0xffff0000, v237
  v_mfma_f32_16x16x32_bf16 v[216:219], v[152:155], v[80:83], v[216:219]
  v_lshlrev_b32 v124, 16, v230
  v_and_b32 v125, 0xffff0000, v230
  v_mfma_f32_16x16x32_bf16 v[216:219], v[156:159], v[84:87], v[216:219]
  s_waitcnt vmcnt(0)
  v_lshlrev_b32 v108, 16, v238
  v_and_b32 v109, 0xffff0000, v238
  v_mfma_f32_16x16x32_bf16 v[220:223], v[152:155], v[88:91], v[220:223]
  v_lshlrev_b32 v126, 16, v231
  v_and_b32 v127, 0xffff0000, v231
  v_mfma_f32_16x16x32_bf16 v[220:223], v[156:159], v[92:95], v[220:223]
  v_lshlrev_b32 v110, 16, v239
  v_and_b32 v111, 0xffff0000, v239
  s_mov_b32 s60, s24
  s_and_b32 s61, s25, 0xffff
  s_mov_b32 s62, 268435456
  s_mov_b32 s63, 0x20000
  s_mov_b32 s64, s22
  s_and_b32 s65, s23, 0xffff
  s_mov_b32 s66, 256
  s_mov_b32 s67, 0x20000
  v_lshlrev_b32 v4, 2, v0
  s_mov_b64 exec, 0xff
  s_mov_b32 s81, 0x80000
  buffer_load_dword v255, v4, s[60:63], s81 offen
  buffer_load_dword v5, v4, s[64:67], 0 offen offset:128 sc1
  s_mov_b64 exec, -1
  v_mov_b32 v4, 0
  s_mov_b32 s56, s20
  s_and_b32 s57, s21, 0xffff
  s_mov_b32 s58, 8192
  s_mov_b32 s59, 0x20000
  s_load_dword s80, s[18:19], 0
  buffer_load_dword v255, v4, s[56:59], 0 offen
  s_and_b32 s70, s2, 7
  s_lshl_b32 s68, s70, 14
  s_lshl_b32 s69, s3, 8
  s_add_u32 s68, s68, s69
  s_add_u32 s69, s68, 4096
  s_add_u32 s71, s68, 8192
  s_lshl_b32 s70, s70, 3
  s_add_u32 s70, s70, s3
  s_lshl_b32 s70, s70, 7
  v_lshlrev_b32 v3, 2, v0
  v_lshlrev_b32 v2, 1, v0
  s_waitcnt lgkmcnt(0)
  s_lshl_b32 s80, s80, 16
  v_rcp_f32 v96, v96
  v_rcp_f32 v97, v97
  v_rcp_f32 v98, v98
  v_rcp_f32 v99, v99
  v_rcp_f32 v100, v100
  v_rcp_f32 v101, v101
  v_rcp_f32 v102, v102
  v_rcp_f32 v103, v103
  v_rcp_f32 v104, v104
  v_rcp_f32 v105, v105
  v_rcp_f32 v106, v106
  v_rcp_f32 v107, v107
  v_rcp_f32 v108, v108
  v_rcp_f32 v109, v109
  v_rcp_f32 v110, v110
  v_rcp_f32 v111, v111
  v_med3_f32 v96, v96, -v244, v244
  v_med3_f32 v97, v97, -v244, v244
  v_med3_f32 v98, v98, -v244, v244
  v_med3_f32 v99, v99, -v244, v244
  v_med3_f32 v100, v100, -v244, v244
  v_med3_f32 v101, v101, -v244, v244
  v_med3_f32 v102, v102, -v244, v244
  v_med3_f32 v103, v103, -v244, v244
  v_med3_f32 v104, v104, -v244, v244
  v_med3_f32 v105, v105, -v244, v244
  v_med3_f32 v106, v106, -v244, v244
  v_med3_f32 v107, v107, -v244, v244
  v_med3_f32 v108, v108, -v244, v244
  v_med3_f32 v109, v109, -v244, v244
  v_med3_f32 v110, v110, -v244, v244
  v_med3_f32 v111, v111, -v244, v244
  v_pk_add_f32 v[160:161], v[160:161], v[112:113]
  v_pk_add_f32 v[162:163], v[162:163], v[114:115]
  v_pk_add_f32 v[164:165], v[164:165], v[112:113]
  v_pk_add_f32 v[166:167], v[166:167], v[114:115]
  v_pk_add_f32 v[168:169], v[168:169], v[112:113]
  v_pk_add_f32 v[170:171], v[170:171], v[114:115]
  v_pk_add_f32 v[172:173], v[172:173], v[112:113]
  v_pk_add_f32 v[174:175], v[174:175], v[114:115]
  v_pk_add_f32 v[176:177], v[176:177], v[116:117]
  v_pk_add_f32 v[178:179], v[178:179], v[118:119]
  v_pk_add_f32 v[180:181], v[180:181], v[116:117]
  v_pk_add_f32 v[182:183], v[182:183], v[118:119]
  v_pk_add_f32 v[184:185], v[184:185], v[116:117]
  v_pk_add_f32 v[186:187], v[186:187], v[118:119]
  v_pk_add_f32 v[188:189], v[188:189], v[116:117]
  v_pk_add_f32 v[190:191], v[190:191], v[118:119]
  v_pk_add_f32 v[192:193], v[192:193], v[120:121]
  v_pk_add_f32 v[194:195], v[194:195], v[122:123]
  v_pk_add_f32 v[196:197], v[196:197], v[120:121]
  v_pk_add_f32 v[198:199], v[198:199], v[122:123]
  v_pk_add_f32 v[200:201], v[200:201], v[120:121]
  v_pk_add_f32 v[202:203], v[202:203], v[122:123]
  v_pk_add_f32 v[204:205], v[204:205], v[120:121]
  v_pk_add_f32 v[206:207], v[206:207], v[122:123]
  v_pk_add_f32 v[208:209], v[208:209], v[124:125]
  v_pk_add_f32 v[210:211], v[210:211], v[126:127]
  v_pk_add_f32 v[212:213], v[212:213], v[124:125]
  v_pk_add_f32 v[214:215], v[214:215], v[126:127]
  v_pk_add_f32 v[216:217], v[216:217], v[124:125]
  v_pk_add_f32 v[218:219], v[218:219], v[126:127]
  v_pk_add_f32 v[220:221], v[220:221], v[124:125]
  v_pk_add_f32 v[222:223], v[222:223], v[126:127]
  v_pk_mul_f32 v[64:65], v[160:161], v[160:161]
  v_pk_mul_f32 v[68:69], v[164:165], v[164:165]
  v_pk_mul_f32 v[72:73], v[168:169], v[168:169]
  v_pk_mul_f32 v[76:77], v[172:173], v[172:173]
  v_pk_fma_f32 v[64:65], v[64:65], v[242:243], v[240:241]
  v_pk_fma_f32 v[68:69], v[68:69], v[242:243], v[240:241]
  v_pk_fma_f32 v[72:73], v[72:73], v[242:243], v[240:241]
  v_pk_fma_f32 v[76:77], v[76:77], v[242:243], v[240:241]
  v_pk_mul_f32 v[64:65], v[64:65], v[160:161]
  v_pk_mul_f32 v[68:69], v[68:69], v[164:165]
  v_pk_mul_f32 v[72:73], v[72:73], v[168:169]
  v_pk_mul_f32 v[76:77], v[76:77], v[172:173]
  v_exp_f32 v64, v64
  v_exp_f32 v65, v65
  v_exp_f32 v68, v68
  v_exp_f32 v69, v69
  v_exp_f32 v72, v72
  v_exp_f32 v73, v73
  v_exp_f32 v76, v76
  v_exp_f32 v77, v77
  v_pk_fma_f32 v[64:65], v[64:65], v[96:97], v[96:97]
  v_pk_fma_f32 v[68:69], v[68:69], v[96:97], v[96:97]
  v_pk_fma_f32 v[72:73], v[72:73], v[96:97], v[96:97]
  v_pk_fma_f32 v[76:77], v[76:77], v[96:97], v[96:97]
  v_rcp_f32 v64, v64
  v_rcp_f32 v65, v65
  v_rcp_f32 v68, v68
  v_rcp_f32 v69, v69
  v_rcp_f32 v72, v72
  v_rcp_f32 v73, v73
  v_rcp_f32 v76, v76
  v_rcp_f32 v77, v77
  v_pk_mul_f32 v[16:17], v[64:65], v[160:161]
  v_pk_mul_f32 v[18:19], v[68:69], v[164:165]
  v_pk_mul_f32 v[20:21], v[72:73], v[168:169]
  v_pk_mul_f32 v[22:23], v[76:77], v[172:173]
  v_pk_mul_f32 v[80:81], v[162:163], v[162:163]
  v_pk_mul_f32 v[84:85], v[166:167], v[166:167]
  v_pk_mul_f32 v[88:89], v[170:171], v[170:171]
  v_pk_mul_f32 v[92:93], v[174:175], v[174:175]
  v_pk_fma_f32 v[80:81], v[80:81], v[242:243], v[240:241]
  v_pk_fma_f32 v[84:85], v[84:85], v[242:243], v[240:241]
  v_pk_fma_f32 v[88:89], v[88:89], v[242:243], v[240:241]
  v_pk_fma_f32 v[92:93], v[92:93], v[242:243], v[240:241]
  v_pk_mul_f32 v[80:81], v[80:81], v[162:163]
  v_pk_mul_f32 v[84:85], v[84:85], v[166:167]
  v_pk_mul_f32 v[88:89], v[88:89], v[170:171]
  v_pk_mul_f32 v[92:93], v[92:93], v[174:175]
  v_exp_f32 v80, v80
  v_exp_f32 v81, v81
  v_exp_f32 v84, v84
  v_exp_f32 v85, v85
  v_exp_f32 v88, v88
  v_exp_f32 v89, v89
  v_exp_f32 v92, v92
  v_exp_f32 v93, v93
  v_pk_fma_f32 v[80:81], v[80:81], v[98:99], v[98:99]
  v_pk_fma_f32 v[84:85], v[84:85], v[98:99], v[98:99]
  v_pk_fma_f32 v[88:89], v[88:89], v[98:99], v[98:99]
  v_pk_fma_f32 v[92:93], v[92:93], v[98:99], v[98:99]
  v_rcp_f32 v80, v80
  v_rcp_f32 v81, v81
  v_rcp_f32 v84, v84
  v_rcp_f32 v85, v85
  v_rcp_f32 v88, v88
  v_rcp_f32 v89, v89
  v_rcp_f32 v92, v92
  v_rcp_f32 v93, v93
  v_pk_fma_f32 v[16:17], v[80:81], v[162:163], v[16:17]
  v_pk_fma_f32 v[18:19], v[84:85], v[166:167], v[18:19]
  v_pk_fma_f32 v[20:21], v[88:89], v[170:171], v[20:21]
  v_pk_fma_f32 v[22:23], v[92:93], v[174:175], v[22:23]
  v_pk_mul_f32 v[64:65], v[176:177], v[176:177]
  v_pk_mul_f32 v[68:69], v[180:181], v[180:181]
  v_pk_mul_f32 v[72:73], v[184:185], v[184:185]
  v_pk_mul_f32 v[76:77], v[188:189], v[188:189]
  v_pk_fma_f32 v[64:65], v[64:65], v[242:243], v[240:241]
  v_pk_fma_f32 v[68:69], v[68:69], v[242:243], v[240:241]
  v_pk_fma_f32 v[72:73], v[72:73], v[242:243], v[240:241]
  v_pk_fma_f32 v[76:77], v[76:77], v[242:243], v[240:241]
  v_pk_mul_f32 v[64:65], v[64:65], v[176:177]
  v_pk_mul_f32 v[68:69], v[68:69], v[180:181]
  v_pk_mul_f32 v[72:73], v[72:73], v[184:185]
  v_pk_mul_f32 v[76:77], v[76:77], v[188:189]
  v_exp_f32 v64, v64
  v_exp_f32 v65, v65
  v_exp_f32 v68, v68
  v_exp_f32 v69, v69
  v_exp_f32 v72, v72
  v_exp_f32 v73, v73
  v_exp_f32 v76, v76
  v_exp_f32 v77, v77
  v_pk_fma_f32 v[64:65], v[64:65], v[100:101], v[100:101]
  v_pk_fma_f32 v[68:69], v[68:69], v[100:101], v[100:101]
  v_pk_fma_f32 v[72:73], v[72:73], v[100:101], v[100:101]
  v_pk_fma_f32 v[76:77], v[76:77], v[100:101], v[100:101]
  v_rcp_f32 v64, v64
  v_rcp_f32 v65, v65
  v_rcp_f32 v68, v68
  v_rcp_f32 v69, v69
  v_rcp_f32 v72, v72
  v_rcp_f32 v73, v73
  v_rcp_f32 v76, v76
  v_rcp_f32 v77, v77
  v_pk_fma_f32 v[16:17], v[64:65], v[176:177], v[16:17]
  v_pk_fma_f32 v[18:19], v[68:69], v[180:181], v[18:19]
  v_pk_fma_f32 v[20:21], v[72:73], v[184:185], v[20:21]
  v_pk_fma_f32 v[22:23], v[76:77], v[188:189], v[22:23]
  v_pk_mul_f32 v[80:81], v[178:179], v[178:179]
  v_pk_mul_f32 v[84:85], v[182:183], v[182:183]
  v_pk_mul_f32 v[88:89], v[186:187], v[186:187]
  v_pk_mul_f32 v[92:93], v[190:191], v[190:191]
  v_pk_fma_f32 v[80:81], v[80:81], v[242:243], v[240:241]
  v_pk_fma_f32 v[84:85], v[84:85], v[242:243], v[240:241]
  v_pk_fma_f32 v[88:89], v[88:89], v[242:243], v[240:241]
  v_pk_fma_f32 v[92:93], v[92:93], v[242:243], v[240:241]
  v_pk_mul_f32 v[80:81], v[80:81], v[178:179]
  v_pk_mul_f32 v[84:85], v[84:85], v[182:183]
  v_pk_mul_f32 v[88:89], v[88:89], v[186:187]
  v_pk_mul_f32 v[92:93], v[92:93], v[190:191]
  v_exp_f32 v80, v80
  v_exp_f32 v81, v81
  v_exp_f32 v84, v84
  v_exp_f32 v85, v85
  v_exp_f32 v88, v88
  v_exp_f32 v89, v89
  v_exp_f32 v92, v92
  v_exp_f32 v93, v93
  v_pk_fma_f32 v[80:81], v[80:81], v[102:103], v[102:103]
  v_pk_fma_f32 v[84:85], v[84:85], v[102:103], v[102:103]
  v_pk_fma_f32 v[88:89], v[88:89], v[102:103], v[102:103]
  v_pk_fma_f32 v[92:93], v[92:93], v[102:103], v[102:103]
  v_rcp_f32 v80, v80
  v_rcp_f32 v81, v81
  v_rcp_f32 v84, v84
  v_rcp_f32 v85, v85
  v_rcp_f32 v88, v88
  v_rcp_f32 v89, v89
  v_rcp_f32 v92, v92
  v_rcp_f32 v93, v93
  v_pk_fma_f32 v[16:17], v[80:81], v[178:179], v[16:17]
  v_pk_fma_f32 v[18:19], v[84:85], v[182:183], v[18:19]
  v_pk_fma_f32 v[20:21], v[88:89], v[186:187], v[20:21]
  v_pk_fma_f32 v[22:23], v[92:93], v[190:191], v[22:23]
  v_pk_mul_f32 v[64:65], v[192:193], v[192:193]
  v_pk_mul_f32 v[68:69], v[196:197], v[196:197]
  v_pk_mul_f32 v[72:73], v[200:201], v[200:201]
  v_pk_mul_f32 v[76:77], v[204:205], v[204:205]
  v_pk_fma_f32 v[64:65], v[64:65], v[242:243], v[240:241]
  v_pk_fma_f32 v[68:69], v[68:69], v[242:243], v[240:241]
  v_pk_fma_f32 v[72:73], v[72:73], v[242:243], v[240:241]
  v_pk_fma_f32 v[76:77], v[76:77], v[242:243], v[240:241]
  v_pk_mul_f32 v[64:65], v[64:65], v[192:193]
  v_pk_mul_f32 v[68:69], v[68:69], v[196:197]
  v_pk_mul_f32 v[72:73], v[72:73], v[200:201]
  v_pk_mul_f32 v[76:77], v[76:77], v[204:205]
  v_exp_f32 v64, v64
  v_exp_f32 v65, v65
  v_exp_f32 v68, v68
  v_exp_f32 v69, v69
  v_exp_f32 v72, v72
  v_exp_f32 v73, v73
  v_exp_f32 v76, v76
  v_exp_f32 v77, v77
  v_pk_fma_f32 v[64:65], v[64:65], v[104:105], v[104:105]
  v_pk_fma_f32 v[68:69], v[68:69], v[104:105], v[104:105]
  v_pk_fma_f32 v[72:73], v[72:73], v[104:105], v[104:105]
  v_pk_fma_f32 v[76:77], v[76:77], v[104:105], v[104:105]
  v_rcp_f32 v64, v64
  v_rcp_f32 v65, v65
  v_rcp_f32 v68, v68
  v_rcp_f32 v69, v69
  v_rcp_f32 v72, v72
  v_rcp_f32 v73, v73
  v_rcp_f32 v76, v76
  v_rcp_f32 v77, v77
  v_pk_fma_f32 v[16:17], v[64:65], v[192:193], v[16:17]
  v_pk_fma_f32 v[18:19], v[68:69], v[196:197], v[18:19]
  v_pk_fma_f32 v[20:21], v[72:73], v[200:201], v[20:21]
  v_pk_fma_f32 v[22:23], v[76:77], v[204:205], v[22:23]
  v_pk_mul_f32 v[80:81], v[194:195], v[194:195]
  v_pk_mul_f32 v[84:85], v[198:199], v[198:199]
  v_pk_mul_f32 v[88:89], v[202:203], v[202:203]
  v_pk_mul_f32 v[92:93], v[206:207], v[206:207]
  v_pk_fma_f32 v[80:81], v[80:81], v[242:243], v[240:241]
  v_pk_fma_f32 v[84:85], v[84:85], v[242:243], v[240:241]
  v_pk_fma_f32 v[88:89], v[88:89], v[242:243], v[240:241]
  v_pk_fma_f32 v[92:93], v[92:93], v[242:243], v[240:241]
  v_pk_mul_f32 v[80:81], v[80:81], v[194:195]
  v_pk_mul_f32 v[84:85], v[84:85], v[198:199]
  v_pk_mul_f32 v[88:89], v[88:89], v[202:203]
  v_pk_mul_f32 v[92:93], v[92:93], v[206:207]
  v_exp_f32 v80, v80
  v_exp_f32 v81, v81
  v_exp_f32 v84, v84
  v_exp_f32 v85, v85
  v_exp_f32 v88, v88
  v_exp_f32 v89, v89
  v_exp_f32 v92, v92
  v_exp_f32 v93, v93
  v_pk_fma_f32 v[80:81], v[80:81], v[106:107], v[106:107]
  v_pk_fma_f32 v[84:85], v[84:85], v[106:107], v[106:107]
  v_pk_fma_f32 v[88:89], v[88:89], v[106:107], v[106:107]
  v_pk_fma_f32 v[92:93], v[92:93], v[106:107], v[106:107]
  v_rcp_f32 v80, v80
  v_rcp_f32 v81, v81
  v_rcp_f32 v84, v84
  v_rcp_f32 v85, v85
  v_rcp_f32 v88, v88
  v_rcp_f32 v89, v89
  v_rcp_f32 v92, v92
  v_rcp_f32 v93, v93
  v_pk_fma_f32 v[16:17], v[80:81], v[194:195], v[16:17]
  v_pk_fma_f32 v[18:19], v[84:85], v[198:199], v[18:19]
  v_pk_fma_f32 v[20:21], v[88:89], v[202:203], v[20:21]
  v_pk_fma_f32 v[22:23], v[92:93], v[206:207], v[22:23]
  v_pk_mul_f32 v[64:65], v[208:209], v[208:209]
  v_pk_mul_f32 v[68:69], v[212:213], v[212:213]
  v_pk_mul_f32 v[72:73], v[216:217], v[216:217]
  v_pk_mul_f32 v[76:77], v[220:221], v[220:221]
  v_pk_fma_f32 v[64:65], v[64:65], v[242:243], v[240:241]
  v_pk_fma_f32 v[68:69], v[68:69], v[242:243], v[240:241]
  v_pk_fma_f32 v[72:73], v[72:73], v[242:243], v[240:241]
  v_pk_fma_f32 v[76:77], v[76:77], v[242:243], v[240:241]
  v_pk_mul_f32 v[64:65], v[64:65], v[208:209]
  v_pk_mul_f32 v[68:69], v[68:69], v[212:213]
  v_pk_mul_f32 v[72:73], v[72:73], v[216:217]
  v_pk_mul_f32 v[76:77], v[76:77], v[220:221]
  v_exp_f32 v64, v64
  v_exp_f32 v65, v65
  v_exp_f32 v68, v68
  v_exp_f32 v69, v69
  v_exp_f32 v72, v72
  v_exp_f32 v73, v73
  v_exp_f32 v76, v76
  v_exp_f32 v77, v77
  v_pk_fma_f32 v[64:65], v[64:65], v[108:109], v[108:109]
  v_pk_fma_f32 v[68:69], v[68:69], v[108:109], v[108:109]
  v_pk_fma_f32 v[72:73], v[72:73], v[108:109], v[108:109]
  v_pk_fma_f32 v[76:77], v[76:77], v[108:109], v[108:109]
  v_rcp_f32 v64, v64
  v_rcp_f32 v65, v65
  v_rcp_f32 v68, v68
  v_rcp_f32 v69, v69
  v_rcp_f32 v72, v72
  v_rcp_f32 v73, v73
  v_rcp_f32 v76, v76
  v_rcp_f32 v77, v77
  v_pk_fma_f32 v[16:17], v[64:65], v[208:209], v[16:17]
  v_pk_fma_f32 v[18:19], v[68:69], v[212:213], v[18:19]
  v_pk_fma_f32 v[20:21], v[72:73], v[216:217], v[20:21]
  v_pk_fma_f32 v[22:23], v[76:77], v[220:221], v[22:23]
  v_pk_mul_f32 v[80:81], v[210:211], v[210:211]
  v_pk_mul_f32 v[84:85], v[214:215], v[214:215]
  v_pk_mul_f32 v[88:89], v[218:219], v[218:219]
  v_pk_mul_f32 v[92:93], v[222:223], v[222:223]
  v_pk_fma_f32 v[80:81], v[80:81], v[242:243], v[240:241]
  v_pk_fma_f32 v[84:85], v[84:85], v[242:243], v[240:241]
  v_pk_fma_f32 v[88:89], v[88:89], v[242:243], v[240:241]
  v_pk_fma_f32 v[92:93], v[92:93], v[242:243], v[240:241]
  v_pk_mul_f32 v[80:81], v[80:81], v[210:211]
  v_pk_mul_f32 v[84:85], v[84:85], v[214:215]
  v_pk_mul_f32 v[88:89], v[88:89], v[218:219]
  v_pk_mul_f32 v[92:93], v[92:93], v[222:223]
  v_exp_f32 v80, v80
  v_exp_f32 v81, v81
  v_exp_f32 v84, v84
  v_exp_f32 v85, v85
  v_exp_f32 v88, v88
  v_exp_f32 v89, v89
  v_exp_f32 v92, v92
  v_exp_f32 v93, v93
  v_pk_fma_f32 v[80:81], v[80:81], v[110:111], v[110:111]
  v_pk_fma_f32 v[84:85], v[84:85], v[110:111], v[110:111]
  v_pk_fma_f32 v[88:89], v[88:89], v[110:111], v[110:111]
  v_pk_fma_f32 v[92:93], v[92:93], v[110:111], v[110:111]
  v_rcp_f32 v80, v80
  v_rcp_f32 v81, v81
  v_rcp_f32 v84, v84
  v_rcp_f32 v85, v85
  v_rcp_f32 v88, v88
  v_rcp_f32 v89, v89
  v_rcp_f32 v92, v92
  v_rcp_f32 v93, v93
  v_pk_fma_f32 v[16:17], v[80:81], v[210:211], v[16:17]
  v_pk_fma_f32 v[18:19], v[84:85], v[214:215], v[18:19]
  v_pk_fma_f32 v[20:21], v[88:89], v[218:219], v[20:21]
  v_pk_fma_f32 v[22:23], v[92:93], v[222:223], v[22:23]
  v_add_f32 v16, v16, v17
  v_add_f32 v18, v18, v19
  v_add_f32 v20, v20, v21
  v_add_f32 v22, v22, v23
  s_nop 0
  v_permlane32_swap_b32 v16, v20
  v_permlane32_swap_b32 v18, v22
  v_add_f32 v16, v16, v20
  v_add_f32 v18, v18, v22
  s_nop 1
  v_permlane16_swap_b32 v16, v18
  v_add_f32 v16, v16, v18
  v_add_f32 v16, s80, v16
  s_waitcnt vmcnt(1)
  v_cmp_eq_u32 vcc, 0, v5
  s_nop 0
  s_and_b32 vcc_lo, vcc_lo, 0xff
  s_cbranch_scc0 L_rclr_ok
  s_mov_b32 s78, 0x40000
L_rclr:
  s_sub_u32 s78, s78, 1
  s_cbranch_scc1 L_rclr_ok
  v_lshlrev_b32 v5, 2, v0
  v_and_b32 v5, 31, v5
  buffer_load_dword v5, v5, s[64:67], 0 offen offset:128 sc1
  s_waitcnt vmcnt(0)
  v_cmp_eq_u32 vcc, 0, v5
  s_nop 0
  s_and_b32 vcc_lo, vcc_lo, 0xff
  s_cbranch_scc1 L_rclr
L_rclr_ok:
  s_mov_b32 s72, 0x40000
L_poll:
  s_sub_u32 s72, s72, 1
  s_cbranch_scc1 L_pollx
  buffer_load_dword v64, v3, s[60:63], s68 offen offset:0 sc1
  buffer_load_dword v65, v3, s[60:63], s68 offen offset:2048 sc1
  buffer_load_dword v66, v3, s[60:63], s69 offen offset:0 sc1
  buffer_load_dword v67, v3, s[60:63], s69 offen offset:2048 sc1
  buffer_load_dword v68, v3, s[60:63], s71 offen offset:0 sc1
  buffer_load_dword v69, v3, s[60:63], s71 offen offset:2048 sc1
  s_waitcnt vmcnt(3)
  v_max3_u32 v72, v64, v65, v66
  s_waitcnt vmcnt(0)
  v_max3_u32 v73, v67, v68, v69
  v_max_u32 v72, v72, v73
  v_cmp_eq_u32 vcc, -1, v72
  s_cbranch_vccnz L_poll
L_pollx:
  v_add_f32 v64, v64, v65
  v_add_f32 v66, v66, v67
  v_add_f32 v68, v68, v69
  v_add_f32 v64, v64, v66
  v_add_f32 v68, v68, v16
  v_add_f32 v64, v64, v68
  v_cvt_pk_bf16_f32 v64, v64, v64
  buffer_store_short v64, v2, s[56:59], s70 offen
  s_endpgm
L_end:
  s_endpgm
.section .rodata,"a"
.p2align 6
.amdhsa_kernel standalone__deep_cross_xdeepfm__recsys_kernel
  .amdhsa_next_free_vgpr 256
  .amdhsa_next_free_sgpr 102
  .amdhsa_accum_offset 256
  .amdhsa_group_segment_fixed_size 0
  .amdhsa_kernarg_size 88
  .amdhsa_user_sgpr_count 2
  .amdhsa_user_sgpr_kernarg_segment_ptr 1
  .amdhsa_system_sgpr_workgroup_id_x 1
  .amdhsa_float_denorm_mode_32 3
.end_amdhsa_kernel
```

```asm
; @launch grid=(256,1,1) block=(512,1,1) lds=163840
.amdgcn_target "amdgcn-amd-amdhsa--gfx950"
.text
.globl standalone__deep_cross_xdeepfm__recsys_kernel
.p2align 8
.type standalone__deep_cross_xdeepfm__recsys_kernel,@function
standalone__deep_cross_xdeepfm__recsys_kernel:
  s_cmp_ge_u32 s2, 256
  s_cbranch_scc1 L_end
  s_load_dwordx16 s[4:19], s[0:1], 0
  s_load_dwordx4 s[20:23], s[0:1], 64
  s_load_dwordx2 s[24:25], s[0:1], 80
  v_lshrrev_b32 v1, 6, v0
  s_getpc_b64 s[92:93]
L_pc:
  s_and_b32 s68, s2, 0xf8
  v_add_u32 v2, s68, v1
  v_lshlrev_b32 v2, 7, v2
  v_and_b32 v3, 1, v0
  v_lshl_add_u32 v2, v3, 15, v2
  v_min_u32 v2, L_end-L_pc, v2
  v_mov_b32 v3, s93
  v_add_co_u32 v2, vcc, s92, v2
  s_nop 1
  v_addc_co_u32 v3, vcc, 0, v3, vcc
  global_load_dword v255, v[2:3], off
  v_and_b32 v0, 63, v0
  v_readfirstlane_b32 s3, v1
  s_and_b32 s68, s2, 7
  s_lshl_b32 s68, s68, 2
  s_lshr_b32 s26, s2, 6
  s_add_u32 s26, s26, s68
  s_bfe_u32 s27, s2, 0x30003
  s_and_b32 s80, s2, 0xf8
  s_add_u32 s80, s80, s3
  s_lshl_b32 s80, s80, 21
  s_cmp_ge_u32 s27, 5
  s_cbranch_scc1 L_cin
  s_mul_i32 s77, s27, 640
  s_mul_i32 s70, s3, 7
  v_min_u32 v132, 6, v0
  v_add_u32 v132, s70, v132
  v_min_u32 v132, 51, v132
  v_lshrrev_b32 v130, 1, v132
  v_mul_u32_u24 v130, 96, v130
  v_lshl_add_u32 v132, v132, 2, v130
  s_mul_i32 s78, s27, 26
  s_min_u32 s78, s78, 102
  s_lshl_b32 s71, s26, 7
  s_add_u32 s78, s78, s71
  s_mul_i32 s78, s78, 104
  s_and_b32 s70, s26, 3
  s_lshl_b32 s70, s70, 3
  s_add_u32 s70, s70, s3
  s_mul_i32 s70, s70, 3328
  s_add_u32 s81, s70, s77
  v_min_u32 v124, 15, v0
  v_lshrrev_b32 v130, 3, v124
  s_mov_b32 s70, 106496
  v_mul_u32_u24 v130, s70, v130
  v_and_b32 v124, 7, v124
  v_min_u32 v124, 4, v124
  v_lshl_add_u32 v124, v124, 7, v130
  s_xor_b32 s70, s3, 4
  s_lshl_b32 s70, s70, 4
  s_add_u32 s70, s70, s71
  v_lshrrev_b32 v128, 3, v0
  v_add_u32 v128, s70, v128
  v_mul_u32_u24 v13, 104, v128
  s_waitcnt lgkmcnt(0)
  s_mov_b32 s28, s4
  s_and_b32 s29, s5, 0xffff
  s_mov_b32 s30, 425984
  s_mov_b32 s31, 0x20000
  buffer_load_dwordx3 v[120:122], v132, s[28:31], s78 offen
  buffer_load_dwordx2 v[112:113], v13, s[28:31], 0 offen offset:0
  buffer_load_dwordx2 v[116:117], v13, s[28:31], 0 offen offset:832
  s_mov_b32 s32, s6
  s_and_b32 s33, s7, 0xffff
  s_mov_b32 s34, 12800000
  s_mov_b32 s35, 0x20000
  v_mov_b32 v136, s80
  buffer_load_dword v255, v136, s[32:35], 0 offen
  v_lshlrev_b32 v37, 4, v0
  s_mov_b32 s48, s14
  s_and_b32 s49, s15, 0xffff
  s_mov_b32 s50, 3328
  s_mov_b32 s51, 0x20000
  s_mov_b32 s44, s12
  s_and_b32 s45, s13, 0xffff
  s_mov_b32 s46, 5537792
  s_mov_b32 s47, 0x20000
  buffer_load_dword v255, v124, s[44:47], s81 offen
  s_mov_b32 m0, 155648
  s_mov_b32 exec_hi, 0xff
  buffer_load_dwordx4 v37, s[48:51], s77 offen lds
  s_mov_b64 exec, -1
  s_lshr_b32 s68, s3, 2
  s_and_b32 s69, s3, 3
  s_mov_b32 s70, 1639
  s_and_b32 s78, s69, 1
  s_lshl_b32 s78, s78, 2
  s_mov_b32 s81, 3328
  v_mov_b32 v128, v0
  v_mul_u32_u24 v129, s70, v128
  v_lshrrev_b32 v129, 16, v129
  v_mul_u32_u24 v132, 40, v129
  v_sub_u32 v132, v128, v132
  v_and_b32 v131, 2, v129
  v_or_b32 v131, s78, v131
  v_xor_b32 v132, v132, v131
  v_mul_u32_u24 v129, s81, v129
  v_lshl_add_u32 v29, v132, 4, v129
  v_add_u32 v128, 64, v128
  v_mul_u32_u24 v129, s70, v128
  v_lshrrev_b32 v129, 16, v129
  v_mul_u32_u24 v132, 40, v129
  v_sub_u32 v132, v128, v132
  v_and_b32 v131, 2, v129
  v_or_b32 v131, s78, v131
  v_xor_b32 v132, v132, v131
  v_mul_u32_u24 v129, s81, v129
  v_lshl_add_u32 v30, v132, 4, v129
  v_subrev_u32 v30, 1024, v30
  v_add_u32 v128, 64, v128
  v_mul_u32_u24 v129, s70, v128
  v_lshrrev_b32 v129, 16, v129
  v_mul_u32_u24 v132, 40, v129
  v_sub_u32 v132, v128, v132
  v_and_b32 v131, 2, v129
  v_or_b32 v131, s78, v131
  v_xor_b32 v132, v132, v131
  v_mul_u32_u24 v129, s81, v129
  v_lshl_add_u32 v31, v132, 4, v129
  v_subrev_u32 v31, 2048, v31
  v_add_u32 v128, 64, v128
  v_mul_u32_u24 v129, s70, v128
  v_lshrrev_b32 v129, 16, v129
  v_mul_u32_u24 v132, 40, v129
  v_sub_u32 v132, v128, v132
  v_and_b32 v131, 2, v129
  v_or_b32 v131, s78, v131
  v_xor_b32 v132, v132, v131
  v_mul_u32_u24 v129, s81, v129
  v_lshl_add_u32 v32, v132, 4, v129
  v_subrev_u32 v32, 3072, v32
  v_add_u32 v128, 64, v128
  v_mul_u32_u24 v129, s70, v128
  v_lshrrev_b32 v129, 16, v129
  v_mul_u32_u24 v132, 40, v129
  v_sub_u32 v132, v128, v132
  v_and_b32 v131, 2, v129
  v_or_b32 v131, s78, v131
  v_xor_b32 v132, v132, v131
  v_mul_u32_u24 v129, s81, v129
  v_lshl_add_u32 v33, v132, 4, v129
  s_mul_i32 s70, s3, 26624
  s_add_u32 s74, s70, s77
  s_mul_i32 s75, s3, 5120
  s_add_u32 s75, s75, 32768
  s_lshl_b32 s71, s68, 14
  s_lshl_b32 s76, s69, 11
  s_add_u32 s76, s76, s71
  s_xor_b32 s76, s76, 16384
  v_and_b32 v132, 7, v0
  v_lshrrev_b32 v130, 4, v0
  v_xor_b32 v132, v132, v130
  v_lshlrev_b32 v14, 4, v132
  v_xor_b32 v15, 64, v14
  v_and_b32 v132, 15, v0
  v_lshlrev_b32 v132, 7, v132
  v_bfe_u32 v131, v0, 1, 3
  v_xor_b32 v131, v131, v130
  v_lshl_add_u32 v132, v131, 4, v132
  v_add_u32 v11, s71, v132
  v_xor_b32 v12, 64, v11
  s_mov_b32 s52, s16
  s_and_b32 s53, s17, 0xffff
  s_mov_b32 s54, 3328
  s_mov_b32 s55, 0x20000
  s_mul_i32 s71, s69, 5
  v_bfe_u32 v131, v0, 2, 2
  v_lshl_add_u32 v132, v130, 3, v131
  v_mul_u32_u24 v132, 640, v132
  v_and_b32 v131, 3, v0
  v_lshl_add_u32 v132, v131, 3, v132
  v_add_u32 v132, 32768, v132
  v_bfe_u32 v131, v0, 3, 2
  v_xor_b32 v128, s71, v131
  v_lshl_add_u32 v1, v128, 5, v132
  v_add_u32 v6, 61440, v1
  s_add_u32 s71, s71, 1
  v_xor_b32 v128, s71, v131
  v_lshl_add_u32 v2, v128, 5, v132
  v_add_u32 v7, 61440, v2
  s_add_u32 s71, s71, 1
  v_xor_b32 v128, s71, v131
  v_lshl_add_u32 v3, v128, 5, v132
  v_add_u32 v8, 61440, v3
  s_add_u32 s71, s71, 1
  v_xor_b32 v128, s71, v131
  v_lshl_add_u32 v4, v128, 5, v132
  v_add_u32 v9, 61440, v4
  s_add_u32 s71, s71, 1
  v_xor_b32 v128, s71, v131
  v_lshl_add_u32 v5, v128, 5, v132
  v_add_u32 v10, 61440, v5
  s_add_u32 s71, s71, 1
  s_mul_i32 s71, s69, 160
  s_add_u32 s71, s71, 155648
  v_lshlrev_b32 v132, 3, v130
  v_add_u32 v35, s71, v132
  s_lshl_b32 s70, s69, 1
  s_add_u32 s70, s70, s68
  s_lshl_b32 s70, s70, 8
  s_add_u32 s70, s70, 156928
  v_lshlrev_b32 v36, 2, v0
  v_add_u32 v36, s70, v36
  s_add_u32 m0, s75, 0
  s_nop 0
  buffer_load_dwordx4 v29, s[44:47], s74 offen offset:0 lds
  buffer_load_dwordx4 v30, s[44:47], s74 offen offset:1024 lds
  buffer_load_dwordx4 v31, s[44:47], s74 offen offset:2048 lds
  buffer_load_dwordx4 v32, s[44:47], s74 offen offset:3072 lds
  s_add_u32 m0, m0, 4096
  s_nop 0
  buffer_load_dwordx4 v33, s[44:47], s74 offen offset:0 lds
  s_add_u32 s74, s74, 212992
  s_waitcnt vmcnt(10)
  v_lshlrev_b32 v120, 7, v120
  s_barrier
  buffer_load_dword v255, v120, s[32:35], 0 offen
  s_waitcnt vmcnt(9)
  v_lshl_add_u32 v34, v116, 7, v15
  v_lshl_add_u32 v28, v112, 7, v14
  s_add_u32 m0, s76, 0
  s_nop 0
  buffer_load_dwordx4 v28, s[32:35], 0 offen lds
  s_add_u32 m0, m0, 1024
  s_nop 0
  buffer_load_dwordx4 v34, s[32:35], 0 offen lds
  v_lshlrev_b32 v122, 7, v122
  buffer_load_dword v255, v122, s[32:35], 0 offen
  s_barrier
  s_waitcnt vmcnt(9)
  ds_read_b64 v[220:221], v35 offset:0
  ds_read_b64 v[222:223], v35 offset:32
  ds_read_b64 v[224:225], v35 offset:64
  ds_read_b64 v[226:227], v35 offset:96
  ds_read_b64 v[228:229], v35 offset:128
  s_waitcnt lgkmcnt(4)
  v_lshlrev_b32 v140, 16, v220
  v_and_b32 v141, 0xffff0000, v220
  v_lshlrev_b32 v142, 16, v221
  v_and_b32 v143, 0xffff0000, v221
  s_waitcnt lgkmcnt(3)
  v_lshlrev_b32 v156, 16, v222
  v_and_b32 v157, 0xffff0000, v222
  v_lshlrev_b32 v158, 16, v223
  v_and_b32 v159, 0xffff0000, v223
  s_waitcnt lgkmcnt(2)
  v_lshlrev_b32 v172, 16, v224
  v_and_b32 v173, 0xffff0000, v224
  v_lshlrev_b32 v174, 16, v225
  v_and_b32 v175, 0xffff0000, v225
  s_waitcnt lgkmcnt(1)
  v_lshlrev_b32 v188, 16, v226
  v_and_b32 v189, 0xffff0000, v226
  v_lshlrev_b32 v190, 16, v227
  v_and_b32 v191, 0xffff0000, v227
  s_waitcnt lgkmcnt(0)
  v_lshlrev_b32 v204, 16, v228
  v_and_b32 v205, 0xffff0000, v228
  v_lshlrev_b32 v206, 16, v229
  v_and_b32 v207, 0xffff0000, v229
  v_mov_b64 v[144:145], v[140:141]
  v_mov_b64 v[146:147], v[142:143]
  v_mov_b64 v[148:149], v[140:141]
  v_mov_b64 v[150:151], v[142:143]
  v_mov_b64 v[152:153], v[140:141]
  v_mov_b64 v[154:155], v[142:143]
  v_mov_b64 v[160:161], v[156:157]
  v_mov_b64 v[162:163], v[158:159]
  v_mov_b64 v[164:165], v[156:157]
  v_mov_b64 v[166:167], v[158:159]
  v_mov_b64 v[168:169], v[156:157]
  v_mov_b64 v[170:171], v[158:159]
  v_mov_b64 v[176:177], v[172:173]
  v_mov_b64 v[178:179], v[174:175]
  v_mov_b64 v[180:181], v[172:173]
  v_mov_b64 v[182:183], v[174:175]
  v_mov_b64 v[184:185], v[172:173]
  v_mov_b64 v[186:187], v[174:175]
  v_mov_b64 v[192:193], v[188:189]
  v_mov_b64 v[194:195], v[190:191]
  v_mov_b64 v[196:197], v[188:189]
  v_mov_b64 v[198:199], v[190:191]
  v_mov_b64 v[200:201], v[188:189]
  v_mov_b64 v[202:203], v[190:191]
  v_mov_b64 v[208:209], v[204:205]
  v_mov_b64 v[210:211], v[206:207]
  v_mov_b64 v[212:213], v[204:205]
  v_mov_b64 v[214:215], v[206:207]
  v_mov_b64 v[216:217], v[204:205]
  v_mov_b64 v[218:219], v[206:207]
  s_lshl_b32 s73, s68, 2
  s_add_u32 s73, s73, 4
  buffer_load_dwordx3 v[16:18], v13, s[28:31], s73 offen offset:0
  buffer_load_dwordx3 v[20:22], v13, s[28:31], s73 offen offset:832
  s_add_u32 s73, s73, 12
  s_mov_b32 s72, 0
  s_cmp_lg_u32 s68, 0
  s_cbranch_scc1 L_dnn_h1
L_dnn_h0:
  s_add_u32 m0, s75, 40960
  s_nop 0
  buffer_load_dwordx4 v29, s[44:47], s74 offen offset:0 lds
  buffer_load_dwordx4 v30, s[44:47], s74 offen offset:1024 lds
  buffer_load_dwordx4 v31, s[44:47], s74 offen offset:2048 lds
  buffer_load_dwordx4 v32, s[44:47], s74 offen offset:3072 lds
  s_add_u32 m0, m0, 4096
  s_nop 0
  buffer_load_dwordx4 v33, s[44:47], s74 offen offset:0 lds
  s_add_u32 s74, s74, 212992
  s_waitcnt vmcnt(11) lgkmcnt(0)
  s_barrier
  buffer_load_dwordx3 v[24:26], v13, s[28:31], s73 offen offset:0
  buffer_load_dwordx3 v[240:242], v13, s[28:31], s73 offen offset:832
  s_add_u32 s73, s73, 12
L_dnn_loop0:
  ds_read_b64_tr_b16 v[40:41], v1 offset:0
  s_add_u32 m0, s75, 81920
  s_nop 0
  buffer_load_dwordx4 v29, s[44:47], s74 offen offset:0 lds
  ds_read_b64_tr_b16 v[42:43], v1 offset:2560
  ds_read_b64_tr_b16 v[44:45], v1 offset:20480
  ds_read_b64_tr_b16 v[46:47], v1 offset:23040
  ds_read_b64_tr_b16 v[48:49], v2 offset:0
  buffer_load_dwordx4 v30, s[44:47], s74 offen offset:1024 lds
  ds_read_b64_tr_b16 v[50:51], v2 offset:2560
  ds_read_b64_tr_b16 v[52:53], v2 offset:20480
  ds_read_b64_tr_b16 v[54:55], v2 offset:23040
  ds_read_b64_tr_b16 v[56:57], v3 offset:0
  buffer_load_dwordx4 v31, s[44:47], s74 offen offset:2048 lds
  ds_read_b64_tr_b16 v[58:59], v3 offset:2560
  ds_read_b64_tr_b16 v[60:61], v3 offset:20480
  ds_read_b64_tr_b16 v[62:63], v3 offset:23040
  ds_read_b64_tr_b16 v[64:65], v4 offset:0
  buffer_load_dwordx4 v32, s[44:47], s74 offen offset:3072 lds
  ds_read_b64_tr_b16 v[66:67], v4 offset:2560
  ds_read_b64_tr_b16 v[68:69], v4 offset:20480
  ds_read_b64_tr_b16 v[70:71], v4 offset:23040
  ds_read_b128 v[80:83], v11 offset:0
  s_add_u32 m0, m0, 4096
  s_nop 0
  buffer_load_dwordx4 v33, s[44:47], s74 offen offset:0 lds
  s_add_u32 s74, s74, 212992
  ds_read_b128 v[84:87], v12 offset:0
  ds_read_b128 v[88:91], v11 offset:2048
  ds_read_b128 v[92:95], v12 offset:2048
  ds_read_b128 v[96:99], v11 offset:4096
  s_waitcnt vmcnt(12)
  v_lshl_add_u32 v34, v20, 7, v15
  v_lshl_add_u32 v28, v16, 7, v14
  s_add_u32 m0, s76, 8192
  s_nop 0
  buffer_load_dwordx4 v28, s[32:35], 0 offen lds
  ds_read_b128 v[100:103], v12 offset:4096
  ds_read_b128 v[104:107], v11 offset:6144
  ds_read_b128 v[108:111], v12 offset:6144
  ds_read_b64_tr_b16 v[72:73], v5 offset:0
  s_add_u32 m0, m0, 1024
  s_nop 0
  buffer_load_dwordx4 v34, s[32:35], 0 offen lds
  ds_read_b64_tr_b16 v[74:75], v5 offset:2560
  ds_read_b64_tr_b16 v[76:77], v5 offset:20480
  ds_read_b64_tr_b16 v[78:79], v5 offset:23040
  s_waitcnt vmcnt(9) lgkmcnt(0)
  s_barrier
  s_setprio 0
  v_mfma_f32_16x16x32_bf16 v[140:143], v[40:43], v[80:83], v[140:143]
  v_mfma_f32_16x16x32_bf16 v[140:143], v[44:47], v[84:87], v[140:143]
  v_mfma_f32_16x16x32_bf16 v[144:147], v[40:43], v[88:91], v[144:147]
  v_mfma_f32_16x16x32_bf16 v[144:147], v[44:47], v[92:95], v[144:147]
  v_mfma_f32_16x16x32_bf16 v[148:151], v[40:43], v[96:99], v[148:151]
  v_mfma_f32_16x16x32_bf16 v[148:151], v[44:47], v[100:103], v[148:151]
  v_mfma_f32_16x16x32_bf16 v[152:155], v[40:43], v[104:107], v[152:155]
  v_mfma_f32_16x16x32_bf16 v[152:155], v[44:47], v[108:111], v[152:155]
  v_mfma_f32_16x16x32_bf16 v[168:171], v[48:51], v[104:107], v[168:171]
  v_mfma_f32_16x16x32_bf16 v[168:171], v[52:55], v[108:111], v[168:171]
  v_mfma_f32_16x16x32_bf16 v[164:167], v[48:51], v[96:99], v[164:167]
  v_mfma_f32_16x16x32_bf16 v[164:167], v[52:55], v[100:103], v[164:167]
  v_mfma_f32_16x16x32_bf16 v[160:163], v[48:51], v[88:91], v[160:163]
  v_mfma_f32_16x16x32_bf16 v[160:163], v[52:55], v[92:95], v[160:163]
  v_mfma_f32_16x16x32_bf16 v[156:159], v[48:51], v[80:83], v[156:159]
  v_mfma_f32_16x16x32_bf16 v[156:159], v[52:55], v[84:87], v[156:159]
  v_mfma_f32_16x16x32_bf16 v[172:175], v[56:59], v[80:83], v[172:175]
  v_mfma_f32_16x16x32_bf16 v[172:175], v[60:63], v[84:87], v[172:175]
  v_mfma_f32_16x16x32_bf16 v[176:179], v[56:59], v[88:91], v[176:179]
  v_mfma_f32_16x16x32_bf16 v[176:179], v[60:63], v[92:95], v[176:179]
  v_mfma_f32_16x16x32_bf16 v[180:183], v[56:59], v[96:99], v[180:183]
  v_mfma_f32_16x16x32_bf16 v[180:183], v[60:63], v[100:103], v[180:183]
  v_mfma_f32_16x16x32_bf16 v[184:187], v[56:59], v[104:107], v[184:187]
  v_mfma_f32_16x16x32_bf16 v[184:187], v[60:63], v[108:111], v[184:187]
  v_mfma_f32_16x16x32_bf16 v[200:203], v[64:67], v[104:107], v[200:203]
  v_mfma_f32_16x16x32_bf16 v[200:203], v[68:71], v[108:111], v[200:203]
  v_mfma_f32_16x16x32_bf16 v[196:199], v[64:67], v[96:99], v[196:199]
  v_mfma_f32_16x16x32_bf16 v[196:199], v[68:71], v[100:103], v[196:199]
  v_mfma_f32_16x16x32_bf16 v[192:195], v[64:67], v[88:91], v[192:195]
  v_mfma_f32_16x16x32_bf16 v[192:195], v[68:71], v[92:95], v[192:195]
  v_mfma_f32_16x16x32_bf16 v[188:191], v[64:67], v[80:83], v[188:191]
  v_mfma_f32_16x16x32_bf16 v[188:191], v[68:71], v[84:87], v[188:191]
  v_mfma_f32_16x16x32_bf16 v[204:207], v[72:75], v[80:83], v[204:207]
  v_mfma_f32_16x16x32_bf16 v[204:207], v[76:79], v[84:87], v[204:207]
  v_mfma_f32_16x16x32_bf16 v[208:211], v[72:75], v[88:91], v[208:211]
  v_mfma_f32_16x16x32_bf16 v[208:211], v[76:79], v[92:95], v[208:211]
  v_mfma_f32_16x16x32_bf16 v[212:215], v[72:75], v[96:99], v[212:215]
  v_mfma_f32_16x16x32_bf16 v[212:215], v[76:79], v[100:103], v[212:215]
  v_mfma_f32_16x16x32_bf16 v[216:219], v[72:75], v[104:107], v[216:219]
  s_setprio 2
  s_waitcnt vmcnt(9)
  s_barrier
  v_mfma_f32_16x16x32_bf16 v[216:219], v[76:79], v[108:111], v[216:219]
  ds_read_b64_tr_b16 v[40:41], v1 offset:40960
  s_add_u32 m0, s75, 0
  s_nop 0
  buffer_load_dwordx4 v29, s[44:47], s74 offen offset:0 lds
  ds_read_b64_tr_b16 v[42:43], v1 offset:43520
  ds_read_b64_tr_b16 v[44:45], v6 offset:0
  ds_read_b64_tr_b16 v[46:47], v6 offset:2560
  ds_read_b64_tr_b16 v[48:49], v2 offset:40960
  buffer_load_dwordx4 v30, s[44:47], s74 offen offset:1024 lds
  ds_read_b64_tr_b16 v[50:51], v2 offset:43520
  ds_read_b64_tr_b16 v[52:53], v7 offset:0
  ds_read_b64_tr_b16 v[54:55], v7 offset:2560
  ds_read_b64_tr_b16 v[56:57], v3 offset:40960
  buffer_load_dwordx4 v31, s[44:47], s74 offen offset:2048 lds
  ds_read_b64_tr_b16 v[58:59], v3 offset:43520
  ds_read_b64_tr_b16 v[60:61], v8 offset:0
  ds_read_b64_tr_b16 v[62:63], v8 offset:2560
  ds_read_b64_tr_b16 v[64:65], v4 offset:40960
  buffer_load_dwordx4 v32, s[44:47], s74 offen offset:3072 lds
  ds_read_b64_tr_b16 v[66:67], v4 offset:43520
  ds_read_b64_tr_b16 v[68:69], v9 offset:0
  ds_read_b64_tr_b16 v[70:71], v9 offset:2560
  ds_read_b128 v[80:83], v11 offset:8192
  s_add_u32 m0, m0, 4096
  s_nop 0
  buffer_load_dwordx4 v33, s[44:47], s74 offen offset:0 lds
  s_add_u32 s74, s74, 212992
  ds_read_b128 v[84:87], v12 offset:8192
  ds_read_b128 v[88:91], v11 offset:10240
  ds_read_b128 v[92:95], v12 offset:10240
  ds_read_b128 v[96:99], v11 offset:12288
  v_lshl_add_u32 v34, v21, 7, v15
  v_lshl_add_u32 v28, v17, 7, v14
  s_add_u32 m0, s76, 0
  s_nop 0
  buffer_load_dwordx4 v28, s[32:35], 0 offen lds
  ds_read_b128 v[100:103], v12 offset:12288
  ds_read_b128 v[104:107], v11 offset:14336
  ds_read_b128 v[108:111], v12 offset:14336
  ds_read_b64_tr_b16 v[72:73], v5 offset:40960
  s_add_u32 m0, m0, 1024
  s_nop 0
  buffer_load_dwordx4 v34, s[32:35], 0 offen lds
  ds_read_b64_tr_b16 v[74:75], v5 offset:43520
  ds_read_b64_tr_b16 v[76:77], v10 offset:0
  ds_read_b64_tr_b16 v[78:79], v10 offset:2560
  s_waitcnt vmcnt(7) lgkmcnt(0)
  s_barrier
  s_setprio 0
  v_mfma_f32_16x16x32_bf16 v[140:143], v[40:43], v[80:83], v[140:143]
  v_mfma_f32_16x16x32_bf16 v[140:143], v[44:47], v[84:87], v[140:143]
  v_mfma_f32_16x16x32_bf16 v[144:147], v[40:43], v[88:91], v[144:147]
  v_mfma_f32_16x16x32_bf16 v[144:147], v[44:47], v[92:95], v[144:147]
  v_mfma_f32_16x16x32_bf16 v[148:151], v[40:43], v[96:99], v[148:151]
  v_mfma_f32_16x16x32_bf16 v[148:151], v[44:47], v[100:103], v[148:151]
  v_mfma_f32_16x16x32_bf16 v[152:155], v[40:43], v[104:107], v[152:155]
  v_mfma_f32_16x16x32_bf16 v[152:155], v[44:47], v[108:111], v[152:155]
  v_mfma_f32_16x16x32_bf16 v[168:171], v[48:51], v[104:107], v[168:171]
  v_mfma_f32_16x16x32_bf16 v[168:171], v[52:55], v[108:111], v[168:171]
  v_mfma_f32_16x16x32_bf16 v[164:167], v[48:51], v[96:99], v[164:167]
  v_mfma_f32_16x16x32_bf16 v[164:167], v[52:55], v[100:103], v[164:167]
  v_mfma_f32_16x16x32_bf16 v[160:163], v[48:51], v[88:91], v[160:163]
  v_mfma_f32_16x16x32_bf16 v[160:163], v[52:55], v[92:95], v[160:163]
  v_mfma_f32_16x16x32_bf16 v[156:159], v[48:51], v[80:83], v[156:159]
  v_mfma_f32_16x16x32_bf16 v[156:159], v[52:55], v[84:87], v[156:159]
  v_mfma_f32_16x16x32_bf16 v[172:175], v[56:59], v[80:83], v[172:175]
  v_mfma_f32_16x16x32_bf16 v[172:175], v[60:63], v[84:87], v[172:175]
  v_mfma_f32_16x16x32_bf16 v[176:179], v[56:59], v[88:91], v[176:179]
  v_mfma_f32_16x16x32_bf16 v[176:179], v[60:63], v[92:95], v[176:179]
  v_mfma_f32_16x16x32_bf16 v[180:183], v[56:59], v[96:99], v[180:183]
  v_mfma_f32_16x16x32_bf16 v[180:183], v[60:63], v[100:103], v[180:183]
  v_mfma_f32_16x16x32_bf16 v[184:187], v[56:59], v[104:107], v[184:187]
  v_mfma_f32_16x16x32_bf16 v[184:187], v[60:63], v[108:111], v[184:187]
  v_mfma_f32_16x16x32_bf16 v[200:203], v[64:67], v[104:107], v[200:203]
  v_mfma_f32_16x16x32_bf16 v[200:203], v[68:71], v[108:111], v[200:203]
  v_mfma_f32_16x16x32_bf16 v[196:199], v[64:67], v[96:99], v[196:199]
  v_mfma_f32_16x16x32_bf16 v[196:199], v[68:71], v[100:103], v[196:199]
  v_mfma_f32_16x16x32_bf16 v[192:195], v[64:67], v[88:91], v[192:195]
  v_mfma_f32_16x16x32_bf16 v[192:195], v[68:71], v[92:95], v[192:195]
  v_mfma_f32_16x16x32_bf16 v[188:191], v[64:67], v[80:83], v[188:191]
  v_mfma_f32_16x16x32_bf16 v[188:191], v[68:71], v[84:87], v[188:191]
  v_mfma_f32_16x16x32_bf16 v[204:207], v[72:75], v[80:83], v[204:207]
  v_mfma_f32_16x16x32_bf16 v[204:207], v[76:79], v[84:87], v[204:207]
  v_mfma_f32_16x16x32_bf16 v[208:211], v[72:75], v[88:91], v[208:211]
  v_mfma_f32_16x16x32_bf16 v[208:211], v[76:79], v[92:95], v[208:211]
  v_mfma_f32_16x16x32_bf16 v[212:215], v[72:75], v[96:99], v[212:215]
  v_mfma_f32_16x16x32_bf16 v[212:215], v[76:79], v[100:103], v[212:215]
  v_mfma_f32_16x16x32_bf16 v[216:219], v[72:75], v[104:107], v[216:219]
  s_setprio 2
  s_barrier
  v_mfma_f32_16x16x32_bf16 v[216:219], v[76:79], v[108:111], v[216:219]
  ds_read_b64_tr_b16 v[40:41], v6 offset:20480
  s_add_u32 m0, s75, 40960
  s_nop 0
  buffer_load_dwordx4 v29, s[44:47], s74 offen offset:0 lds
  ds_read_b64_tr_b16 v[42:43], v6 offset:23040
  ds_read_b64_tr_b16 v[44:45], v6 offset:40960
  ds_read_b64_tr_b16 v[46:47], v6 offset:43520
  ds_read_b64_tr_b16 v[48:49], v7 offset:20480
  buffer_load_dwordx4 v30, s[44:47], s74 offen offset:1024 lds
  ds_read_b64_tr_b16 v[50:51], v7 offset:23040
  ds_read_b64_tr_b16 v[52:53], v7 offset:40960
  ds_read_b64_tr_b16 v[54:55], v7 offset:43520
  ds_read_b64_tr_b16 v[56:57], v8 offset:20480
  buffer_load_dwordx4 v31, s[44:47], s74 offen offset:2048 lds
  ds_read_b64_tr_b16 v[58:59], v8 offset:23040
  ds_read_b64_tr_b16 v[60:61], v8 offset:40960
  ds_read_b64_tr_b16 v[62:63], v8 offset:43520
  ds_read_b64_tr_b16 v[64:65], v9 offset:20480
  buffer_load_dwordx4 v32, s[44:47], s74 offen offset:3072 lds
  ds_read_b64_tr_b16 v[66:67], v9 offset:23040
  ds_read_b64_tr_b16 v[68:69], v9 offset:40960
  ds_read_b64_tr_b16 v[70:71], v9 offset:43520
  ds_read_b128 v[80:83], v11 offset:0
  s_add_u32 m0, m0, 4096
  s_nop 0
  buffer_load_dwordx4 v33, s[44:47], s74 offen offset:0 lds
  s_add_u32 s74, s74, 212992
  ds_read_b128 v[84:87], v12 offset:0
  ds_read_b128 v[88:91], v11 offset:2048
  ds_read_b128 v[92:95], v12 offset:2048
  ds_read_b128 v[96:99], v11 offset:4096
  v_lshl_add_u32 v34, v22, 7, v15
  v_lshl_add_u32 v28, v18, 7, v14
  s_add_u32 m0, s76, 8192
  s_nop 0
  buffer_load_dwordx4 v28, s[32:35], 0 offen lds
  ds_read_b128 v[100:103], v12 offset:4096
  ds_read_b128 v[104:107], v11 offset:6144
  ds_read_b128 v[108:111], v12 offset:6144
  ds_read_b64_tr_b16 v[72:73], v10 offset:20480
  s_add_u32 m0, m0, 1024
  s_nop 0
  buffer_load_dwordx4 v34, s[32:35], 0 offen lds
  ds_read_b64_tr_b16 v[74:75], v10 offset:23040
  ds_read_b64_tr_b16 v[76:77], v10 offset:40960
  ds_read_b64_tr_b16 v[78:79], v10 offset:43520
  buffer_load_dwordx3 v[16:18], v13, s[28:31], s73 offen offset:0
  buffer_load_dwordx3 v[20:22], v13, s[28:31], s73 offen offset:832
  s_add_u32 s73, s73, 12
  s_waitcnt vmcnt(9) lgkmcnt(0)
  s_barrier
  s_setprio 0
  v_mfma_f32_16x16x32_bf16 v[140:143], v[40:43], v[80:83], v[140:143]
  v_mfma_f32_16x16x32_bf16 v[140:143], v[44:47], v[84:87], v[140:143]
  v_mfma_f32_16x16x32_bf16 v[144:147], v[40:43], v[88:91], v[144:147]
  v_mfma_f32_16x16x32_bf16 v[144:147], v[44:47], v[92:95], v[144:147]
  v_mfma_f32_16x16x32_bf16 v[148:151], v[40:43], v[96:99], v[148:151]
  v_mfma_f32_16x16x32_bf16 v[148:151], v[44:47], v[100:103], v[148:151]
  v_mfma_f32_16x16x32_bf16 v[152:155], v[40:43], v[104:107], v[152:155]
  v_mfma_f32_16x16x32_bf16 v[152:155], v[44:47], v[108:111], v[152:155]
  v_mfma_f32_16x16x32_bf16 v[168:171], v[48:51], v[104:107], v[168:171]
  v_mfma_f32_16x16x32_bf16 v[168:171], v[52:55], v[108:111], v[168:171]
  v_mfma_f32_16x16x32_bf16 v[164:167], v[48:51], v[96:99], v[164:167]
  v_mfma_f32_16x16x32_bf16 v[164:167], v[52:55], v[100:103], v[164:167]
  v_mfma_f32_16x16x32_bf16 v[160:163], v[48:51], v[88:91], v[160:163]
  v_mfma_f32_16x16x32_bf16 v[160:163], v[52:55], v[92:95], v[160:163]
  v_mfma_f32_16x16x32_bf16 v[156:159], v[48:51], v[80:83], v[156:159]
  v_mfma_f32_16x16x32_bf16 v[156:159], v[52:55], v[84:87], v[156:159]
  v_mfma_f32_16x16x32_bf16 v[172:175], v[56:59], v[80:83], v[172:175]
  v_mfma_f32_16x16x32_bf16 v[172:175], v[60:63], v[84:87], v[172:175]
  v_mfma_f32_16x16x32_bf16 v[176:179], v[56:59], v[88:91], v[176:179]
  v_mfma_f32_16x16x32_bf16 v[176:179], v[60:63], v[92:95], v[176:179]
  v_mfma_f32_16x16x32_bf16 v[180:183], v[56:59], v[96:99], v[180:183]
  v_mfma_f32_16x16x32_bf16 v[180:183], v[60:63], v[100:103], v[180:183]
  v_mfma_f32_16x16x32_bf16 v[184:187], v[56:59], v[104:107], v[184:187]
  v_mfma_f32_16x16x32_bf16 v[184:187], v[60:63], v[108:111], v[184:187]
  v_mfma_f32_16x16x32_bf16 v[200:203], v[64:67], v[104:107], v[200:203]
  v_mfma_f32_16x16x32_bf16 v[200:203], v[68:71], v[108:111], v[200:203]
  v_mfma_f32_16x16x32_bf16 v[196:199], v[64:67], v[96:99], v[196:199]
  v_mfma_f32_16x16x32_bf16 v[196:199], v[68:71], v[100:103], v[196:199]
  v_mfma_f32_16x16x32_bf16 v[192:195], v[64:67], v[88:91], v[192:195]
  v_mfma_f32_16x16x32_bf16 v[192:195], v[68:71], v[92:95], v[192:195]
  v_mfma_f32_16x16x32_bf16 v[188:191], v[64:67], v[80:83], v[188:191]
  v_mfma_f32_16x16x32_bf16 v[188:191], v[68:71], v[84:87], v[188:191]
  v_mfma_f32_16x16x32_bf16 v[204:207], v[72:75], v[80:83], v[204:207]
  v_mfma_f32_16x16x32_bf16 v[204:207], v[76:79], v[84:87], v[204:207]
  v_mfma_f32_16x16x32_bf16 v[208:211], v[72:75], v[88:91], v[208:211]
  v_mfma_f32_16x16x32_bf16 v[208:211], v[76:79], v[92:95], v[208:211]
  v_mfma_f32_16x16x32_bf16 v[212:215], v[72:75], v[96:99], v[212:215]
  v_mfma_f32_16x16x32_bf16 v[212:215], v[76:79], v[100:103], v[212:215]
  v_mfma_f32_16x16x32_bf16 v[216:219], v[72:75], v[104:107], v[216:219]
  s_setprio 2
  s_barrier
  v_mfma_f32_16x16x32_bf16 v[216:219], v[76:79], v[108:111], v[216:219]
  ds_read_b64_tr_b16 v[40:41], v1 offset:0
  s_add_u32 m0, s75, 81920
  s_nop 0
  buffer_load_dwordx4 v29, s[44:47], s74 offen offset:0 lds
  ds_read_b64_tr_b16 v[42:43], v1 offset:2560
  ds_read_b64_tr_b16 v[44:45], v1 offset:20480
  ds_read_b64_tr_b16 v[46:47], v1 offset:23040
  ds_read_b64_tr_b16 v[48:49], v2 offset:0
  buffer_load_dwordx4 v30, s[44:47], s74 offen offset:1024 lds
  ds_read_b64_tr_b16 v[50:51], v2 offset:2560
  ds_read_b64_tr_b16 v[52:53], v2 offset:20480
  ds_read_b64_tr_b16 v[54:55], v2 offset:23040
  ds_read_b64_tr_b16 v[56:57], v3 offset:0
  buffer_load_dwordx4 v31, s[44:47], s74 offen offset:2048 lds
  ds_read_b64_tr_b16 v[58:59], v3 offset:2560
  ds_read_b64_tr_b16 v[60:61], v3 offset:20480
  ds_read_b64_tr_b16 v[62:63], v3 offset:23040
  ds_read_b64_tr_b16 v[64:65], v4 offset:0
  buffer_load_dwordx4 v32, s[44:47], s74 offen offset:3072 lds
  ds_read_b64_tr_b16 v[66:67], v4 offset:2560
  ds_read_b64_tr_b16 v[68:69], v4 offset:20480
  ds_read_b64_tr_b16 v[70:71], v4 offset:23040
  ds_read_b128 v[80:83], v11 offset:8192
  s_add_u32 m0, m0, 4096
  s_nop 0
  buffer_load_dwordx4 v33, s[44:47], s74 offen offset:0 lds
  s_add_u32 s74, s74, 212992
  ds_read_b128 v[84:87], v12 offset:8192
  ds_read_b128 v[88:91], v11 offset:10240
  ds_read_b128 v[92:95], v12 offset:10240
  ds_read_b128 v[96:99], v11 offset:12288
  v_lshl_add_u32 v34, v240, 7, v15
  v_lshl_add_u32 v28, v24, 7, v14
  s_add_u32 m0, s76, 0
  s_nop 0
  buffer_load_dwordx4 v28, s[32:35], 0 offen lds
  ds_read_b128 v[100:103], v12 offset:12288
  ds_read_b128 v[104:107], v11 offset:14336
  ds_read_b128 v[108:111], v12 offset:14336
  ds_read_b64_tr_b16 v[72:73], v5 offset:0
  s_add_u32 m0, m0, 1024
  s_nop 0
  buffer_load_dwordx4 v34, s[32:35], 0 offen lds
  ds_read_b64_tr_b16 v[74:75], v5 offset:2560
  ds_read_b64_tr_b16 v[76:77], v5 offset:20480
  ds_read_b64_tr_b16 v[78:79], v5 offset:23040
  s_waitcnt vmcnt(9) lgkmcnt(0)
  s_barrier
  s_setprio 0
  v_mfma_f32_16x16x32_bf16 v[140:143], v[40:43], v[80:83], v[140:143]
  v_mfma_f32_16x16x32_bf16 v[140:143], v[44:47], v[84:87], v[140:143]
  v_mfma_f32_16x16x32_bf16 v[144:147], v[40:43], v[88:91], v[144:147]
  v_mfma_f32_16x16x32_bf16 v[144:147], v[44:47], v[92:95], v[144:147]
  v_mfma_f32_16x16x32_bf16 v[148:151], v[40:43], v[96:99], v[148:151]
  v_mfma_f32_16x16x32_bf16 v[148:151], v[44:47], v[100:103], v[148:151]
  v_mfma_f32_16x16x32_bf16 v[152:155], v[40:43], v[104:107], v[152:155]
  v_mfma_f32_16x16x32_bf16 v[152:155], v[44:47], v[108:111], v[152:155]
  v_mfma_f32_16x16x32_bf16 v[168:171], v[48:51], v[104:107], v[168:171]
  v_mfma_f32_16x16x32_bf16 v[168:171], v[52:55], v[108:111], v[168:171]
  v_mfma_f32_16x16x32_bf16 v[164:167], v[48:51], v[96:99], v[164:167]
  v_mfma_f32_16x16x32_bf16 v[164:167], v[52:55], v[100:103], v[164:167]
  v_mfma_f32_16x16x32_bf16 v[160:163], v[48:51], v[88:91], v[160:163]
  v_mfma_f32_16x16x32_bf16 v[160:163], v[52:55], v[92:95], v[160:163]
  v_mfma_f32_16x16x32_bf16 v[156:159], v[48:51], v[80:83], v[156:159]
  v_mfma_f32_16x16x32_bf16 v[156:159], v[52:55], v[84:87], v[156:159]
  v_mfma_f32_16x16x32_bf16 v[172:175], v[56:59], v[80:83], v[172:175]
  v_mfma_f32_16x16x32_bf16 v[172:175], v[60:63], v[84:87], v[172:175]
  v_mfma_f32_16x16x32_bf16 v[176:179], v[56:59], v[88:91], v[176:179]
  v_mfma_f32_16x16x32_bf16 v[176:179], v[60:63], v[92:95], v[176:179]
  v_mfma_f32_16x16x32_bf16 v[180:183], v[56:59], v[96:99], v[180:183]
  v_mfma_f32_16x16x32_bf16 v[180:183], v[60:63], v[100:103], v[180:183]
  v_mfma_f32_16x16x32_bf16 v[184:187], v[56:59], v[104:107], v[184:187]
  v_mfma_f32_16x16x32_bf16 v[184:187], v[60:63], v[108:111], v[184:187]
  v_mfma_f32_16x16x32_bf16 v[200:203], v[64:67], v[104:107], v[200:203]
  v_mfma_f32_16x16x32_bf16 v[200:203], v[68:71], v[108:111], v[200:203]
  v_mfma_f32_16x16x32_bf16 v[196:199], v[64:67], v[96:99], v[196:199]
  v_mfma_f32_16x16x32_bf16 v[196:199], v[68:71], v[100:103], v[196:199]
  v_mfma_f32_16x16x32_bf16 v[192:195], v[64:67], v[88:91], v[192:195]
  v_mfma_f32_16x16x32_bf16 v[192:195], v[68:71], v[92:95], v[192:195]
  v_mfma_f32_16x16x32_bf16 v[188:191], v[64:67], v[80:83], v[188:191]
  v_mfma_f32_16x16x32_bf16 v[188:191], v[68:71], v[84:87], v[188:191]
  v_mfma_f32_16x16x32_bf16 v[204:207], v[72:75], v[80:83], v[204:207]
  v_mfma_f32_16x16x32_bf16 v[204:207], v[76:79], v[84:87], v[204:207]
  v_mfma_f32_16x16x32_bf16 v[208:211], v[72:75], v[88:91], v[208:211]
  v_mfma_f32_16x16x32_bf16 v[208:211], v[76:79], v[92:95], v[208:211]
  v_mfma_f32_16x16x32_bf16 v[212:215], v[72:75], v[96:99], v[212:215]
  v_mfma_f32_16x16x32_bf16 v[212:215], v[76:79], v[100:103], v[212:215]
  v_mfma_f32_16x16x32_bf16 v[216:219], v[72:75], v[104:107], v[216:219]
  s_setprio 2
  s_barrier
  v_mfma_f32_16x16x32_bf16 v[216:219], v[76:79], v[108:111], v[216:219]
  ds_read_b64_tr_b16 v[40:41], v1 offset:40960
  s_add_u32 m0, s75, 0
  s_nop 0
  buffer_load_dwordx4 v29, s[44:47], s74 offen offset:0 lds
  ds_read_b64_tr_b16 v[42:43], v1 offset:43520
  ds_read_b64_tr_b16 v[44:45], v6 offset:0
  ds_read_b64_tr_b16 v[46:47], v6 offset:2560
  ds_read_b64_tr_b16 v[48:49], v2 offset:40960
  buffer_load_dwordx4 v30, s[44:47], s74 offen offset:1024 lds
  ds_read_b64_tr_b16 v[50:51], v2 offset:43520
  ds_read_b64_tr_b16 v[52:53], v7 offset:0
  ds_read_b64_tr_b16 v[54:55], v7 offset:2560
  ds_read_b64_tr_b16 v[56:57], v3 offset:40960
  buffer_load_dwordx4 v31, s[44:47], s74 offen offset:2048 lds
  ds_read_b64_tr_b16 v[58:59], v3 offset:43520
  ds_read_b64_tr_b16 v[60:61], v8 offset:0
  ds_read_b64_tr_b16 v[62:63], v8 offset:2560
  ds_read_b64_tr_b16 v[64:65], v4 offset:40960
  buffer_load_dwordx4 v32, s[44:47], s74 offen offset:3072 lds
  ds_read_b64_tr_b16 v[66:67], v4 offset:43520
  ds_read_b64_tr_b16 v[68:69], v9 offset:0
  ds_read_b64_tr_b16 v[70:71], v9 offset:2560
  ds_read_b128 v[80:83], v11 offset:0
  s_add_u32 m0, m0, 4096
  s_nop 0
  buffer_load_dwordx4 v33, s[44:47], s74 offen offset:0 lds
  s_add_u32 s74, s74, 212992
  ds_read_b128 v[84:87], v12 offset:0
  ds_read_b128 v[88:91], v11 offset:2048
  ds_read_b128 v[92:95], v12 offset:2048
  ds_read_b128 v[96:99], v11 offset:4096
  v_lshl_add_u32 v34, v241, 7, v15
  v_lshl_add_u32 v28, v25, 7, v14
  s_add_u32 m0, s76, 8192
  s_nop 0
  buffer_load_dwordx4 v28, s[32:35], 0 offen lds
  ds_read_b128 v[100:103], v12 offset:4096
  ds_read_b128 v[104:107], v11 offset:6144
  ds_read_b128 v[108:111], v12 offset:6144
  ds_read_b64_tr_b16 v[72:73], v5 offset:40960
  s_add_u32 m0, m0, 1024
  s_nop 0
  buffer_load_dwordx4 v34, s[32:35], 0 offen lds
  ds_read_b64_tr_b16 v[74:75], v5 offset:43520
  ds_read_b64_tr_b16 v[76:77], v10 offset:0
  ds_read_b64_tr_b16 v[78:79], v10 offset:2560
  s_waitcnt vmcnt(7) lgkmcnt(0)
  s_barrier
  s_setprio 0
  v_mfma_f32_16x16x32_bf16 v[140:143], v[40:43], v[80:83], v[140:143]
  v_mfma_f32_16x16x32_bf16 v[140:143], v[44:47], v[84:87], v[140:143]
  v_mfma_f32_16x16x32_bf16 v[144:147], v[40:43], v[88:91], v[144:147]
  v_mfma_f32_16x16x32_bf16 v[144:147], v[44:47], v[92:95], v[144:147]
  v_mfma_f32_16x16x32_bf16 v[148:151], v[40:43], v[96:99], v[148:151]
  v_mfma_f32_16x16x32_bf16 v[148:151], v[44:47], v[100:103], v[148:151]
  v_mfma_f32_16x16x32_bf16 v[152:155], v[40:43], v[104:107], v[152:155]
  v_mfma_f32_16x16x32_bf16 v[152:155], v[44:47], v[108:111], v[152:155]
  v_mfma_f32_16x16x32_bf16 v[168:171], v[48:51], v[104:107], v[168:171]
  v_mfma_f32_16x16x32_bf16 v[168:171], v[52:55], v[108:111], v[168:171]
  v_mfma_f32_16x16x32_bf16 v[164:167], v[48:51], v[96:99], v[164:167]
  v_mfma_f32_16x16x32_bf16 v[164:167], v[52:55], v[100:103], v[164:167]
  v_mfma_f32_16x16x32_bf16 v[160:163], v[48:51], v[88:91], v[160:163]
  v_mfma_f32_16x16x32_bf16 v[160:163], v[52:55], v[92:95], v[160:163]
  v_mfma_f32_16x16x32_bf16 v[156:159], v[48:51], v[80:83], v[156:159]
  v_mfma_f32_16x16x32_bf16 v[156:159], v[52:55], v[84:87], v[156:159]
  v_mfma_f32_16x16x32_bf16 v[172:175], v[56:59], v[80:83], v[172:175]
  v_mfma_f32_16x16x32_bf16 v[172:175], v[60:63], v[84:87], v[172:175]
  v_mfma_f32_16x16x32_bf16 v[176:179], v[56:59], v[88:91], v[176:179]
  v_mfma_f32_16x16x32_bf16 v[176:179], v[60:63], v[92:95], v[176:179]
  v_mfma_f32_16x16x32_bf16 v[180:183], v[56:59], v[96:99], v[180:183]
  v_mfma_f32_16x16x32_bf16 v[180:183], v[60:63], v[100:103], v[180:183]
  v_mfma_f32_16x16x32_bf16 v[184:187], v[56:59], v[104:107], v[184:187]
  v_mfma_f32_16x16x32_bf16 v[184:187], v[60:63], v[108:111], v[184:187]
  v_mfma_f32_16x16x32_bf16 v[200:203], v[64:67], v[104:107], v[200:203]
  v_mfma_f32_16x16x32_bf16 v[200:203], v[68:71], v[108:111], v[200:203]
  v_mfma_f32_16x16x32_bf16 v[196:199], v[64:67], v[96:99], v[196:199]
  v_mfma_f32_16x16x32_bf16 v[196:199], v[68:71], v[100:103], v[196:199]
  v_mfma_f32_16x16x32_bf16 v[192:195], v[64:67], v[88:91], v[192:195]
  v_mfma_f32_16x16x32_bf16 v[192:195], v[68:71], v[92:95], v[192:195]
  v_mfma_f32_16x16x32_bf16 v[188:191], v[64:67], v[80:83], v[188:191]
  v_mfma_f32_16x16x32_bf16 v[188:191], v[68:71], v[84:87], v[188:191]
  v_mfma_f32_16x16x32_bf16 v[204:207], v[72:75], v[80:83], v[204:207]
  v_mfma_f32_16x16x32_bf16 v[204:207], v[76:79], v[84:87], v[204:207]
  v_mfma_f32_16x16x32_bf16 v[208:211], v[72:75], v[88:91], v[208:211]
  v_mfma_f32_16x16x32_bf16 v[208:211], v[76:79], v[92:95], v[208:211]
  v_mfma_f32_16x16x32_bf16 v[212:215], v[72:75], v[96:99], v[212:215]
  v_mfma_f32_16x16x32_bf16 v[212:215], v[76:79], v[100:103], v[212:215]
  v_mfma_f32_16x16x32_bf16 v[216:219], v[72:75], v[104:107], v[216:219]
  s_setprio 2
  s_barrier
  v_mfma_f32_16x16x32_bf16 v[216:219], v[76:79], v[108:111], v[216:219]
  ds_read_b64_tr_b16 v[40:41], v6 offset:20480
  s_add_u32 m0, s75, 40960
  s_nop 0
  buffer_load_dwordx4 v29, s[44:47], s74 offen offset:0 lds
  ds_read_b64_tr_b16 v[42:43], v6 offset:23040
  ds_read_b64_tr_b16 v[44:45], v6 offset:40960
  ds_read_b64_tr_b16 v[46:47], v6 offset:43520
  ds_read_b64_tr_b16 v[48:49], v7 offset:20480
  buffer_load_dwordx4 v30, s[44:47], s74 offen offset:1024 lds
  ds_read_b64_tr_b16 v[50:51], v7 offset:23040
  ds_read_b64_tr_b16 v[52:53], v7 offset:40960
  ds_read_b64_tr_b16 v[54:55], v7 offset:43520
  ds_read_b64_tr_b16 v[56:57], v8 offset:20480
  buffer_load_dwordx4 v31, s[44:47], s74 offen offset:2048 lds
  ds_read_b64_tr_b16 v[58:59], v8 offset:23040
  ds_read_b64_tr_b16 v[60:61], v8 offset:40960
  ds_read_b64_tr_b16 v[62:63], v8 offset:43520
  ds_read_b64_tr_b16 v[64:65], v9 offset:20480
  buffer_load_dwordx4 v32, s[44:47], s74 offen offset:3072 lds
  ds_read_b64_tr_b16 v[66:67], v9 offset:23040
  ds_read_b64_tr_b16 v[68:69], v9 offset:40960
  ds_read_b64_tr_b16 v[70:71], v9 offset:43520
  ds_read_b128 v[80:83], v11 offset:8192
  s_add_u32 m0, m0, 4096
  s_nop 0
  buffer_load_dwordx4 v33, s[44:47], s74 offen offset:0 lds
  s_add_u32 s74, s74, 212992
  ds_read_b128 v[84:87], v12 offset:8192
  ds_read_b128 v[88:91], v11 offset:10240
  ds_read_b128 v[92:95], v12 offset:10240
  ds_read_b128 v[96:99], v11 offset:12288
  v_lshl_add_u32 v34, v242, 7, v15
  v_lshl_add_u32 v28, v26, 7, v14
  s_add_u32 m0, s76, 0
  s_nop 0
  buffer_load_dwordx4 v28, s[32:35], 0 offen lds
  ds_read_b128 v[100:103], v12 offset:12288
  ds_read_b128 v[104:107], v11 offset:14336
  ds_read_b128 v[108:111], v12 offset:14336
  ds_read_b64_tr_b16 v[72:73], v10 offset:20480
  s_add_u32 m0, m0, 1024
  s_nop 0
  buffer_load_dwordx4 v34, s[32:35], 0 offen lds
  ds_read_b64_tr_b16 v[74:75], v10 offset:23040
  ds_read_b64_tr_b16 v[76:77], v10 offset:40960
  ds_read_b64_tr_b16 v[78:79], v10 offset:43520
  buffer_load_dwordx3 v[24:26], v13, s[28:31], s73 offen offset:0
  buffer_load_dwordx3 v[240:242], v13, s[28:31], s73 offen offset:832
  s_add_u32 s73, s73, 12
  s_waitcnt vmcnt(9) lgkmcnt(0)
  s_barrier
  s_setprio 0
  v_mfma_f32_16x16x32_bf16 v[140:143], v[40:43], v[80:83], v[140:143]
  s_add_u32 s72, s72, 1
  v_mfma_f32_16x16x32_bf16 v[140:143], v[44:47], v[84:87], v[140:143]
  v_mfma_f32_16x16x32_bf16 v[144:147], v[40:43], v[88:91], v[144:147]
  v_mfma_f32_16x16x32_bf16 v[144:147], v[44:47], v[92:95], v[144:147]
  v_mfma_f32_16x16x32_bf16 v[148:151], v[40:43], v[96:99], v[148:151]
  v_mfma_f32_16x16x32_bf16 v[148:151], v[44:47], v[100:103], v[148:151]
  v_mfma_f32_16x16x32_bf16 v[152:155], v[40:43], v[104:107], v[152:155]
  v_mfma_f32_16x16x32_bf16 v[152:155], v[44:47], v[108:111], v[152:155]
  v_mfma_f32_16x16x32_bf16 v[168:171], v[48:51], v[104:107], v[168:171]
  v_mfma_f32_16x16x32_bf16 v[168:171], v[52:55], v[108:111], v[168:171]
  v_mfma_f32_16x16x32_bf16 v[164:167], v[48:51], v[96:99], v[164:167]
  v_mfma_f32_16x16x32_bf16 v[164:167], v[52:55], v[100:103], v[164:167]
  v_mfma_f32_16x16x32_bf16 v[160:163], v[48:51], v[88:91], v[160:163]
  v_mfma_f32_16x16x32_bf16 v[160:163], v[52:55], v[92:95], v[160:163]
  v_mfma_f32_16x16x32_bf16 v[156:159], v[48:51], v[80:83], v[156:159]
  v_mfma_f32_16x16x32_bf16 v[156:159], v[52:55], v[84:87], v[156:159]
  v_mfma_f32_16x16x32_bf16 v[172:175], v[56:59], v[80:83], v[172:175]
  v_mfma_f32_16x16x32_bf16 v[172:175], v[60:63], v[84:87], v[172:175]
  v_mfma_f32_16x16x32_bf16 v[176:179], v[56:59], v[88:91], v[176:179]
  v_mfma_f32_16x16x32_bf16 v[176:179], v[60:63], v[92:95], v[176:179]
  s_cmp_lt_u32 s72, 4
  v_mfma_f32_16x16x32_bf16 v[180:183], v[56:59], v[96:99], v[180:183]
  v_mfma_f32_16x16x32_bf16 v[180:183], v[60:63], v[100:103], v[180:183]
  v_mfma_f32_16x16x32_bf16 v[184:187], v[56:59], v[104:107], v[184:187]
  v_mfma_f32_16x16x32_bf16 v[184:187], v[60:63], v[108:111], v[184:187]
  v_mfma_f32_16x16x32_bf16 v[200:203], v[64:67], v[104:107], v[200:203]
  v_mfma_f32_16x16x32_bf16 v[200:203], v[68:71], v[108:111], v[200:203]
  v_mfma_f32_16x16x32_bf16 v[196:199], v[64:67], v[96:99], v[196:199]
  v_mfma_f32_16x16x32_bf16 v[196:199], v[68:71], v[100:103], v[196:199]
  v_mfma_f32_16x16x32_bf16 v[192:195], v[64:67], v[88:91], v[192:195]
  v_mfma_f32_16x16x32_bf16 v[192:195], v[68:71], v[92:95], v[192:195]
  v_mfma_f32_16x16x32_bf16 v[188:191], v[64:67], v[80:83], v[188:191]
  v_mfma_f32_16x16x32_bf16 v[188:191], v[68:71], v[84:87], v[188:191]
  v_mfma_f32_16x16x32_bf16 v[204:207], v[72:75], v[80:83], v[204:207]
  v_mfma_f32_16x16x32_bf16 v[204:207], v[76:79], v[84:87], v[204:207]
  v_mfma_f32_16x16x32_bf16 v[208:211], v[72:75], v[88:91], v[208:211]
  v_mfma_f32_16x16x32_bf16 v[208:211], v[76:79], v[92:95], v[208:211]
  v_mfma_f32_16x16x32_bf16 v[212:215], v[72:75], v[96:99], v[212:215]
  v_mfma_f32_16x16x32_bf16 v[212:215], v[76:79], v[100:103], v[212:215]
  v_mfma_f32_16x16x32_bf16 v[216:219], v[72:75], v[104:107], v[216:219]
  s_setprio 2
  s_barrier
  v_mfma_f32_16x16x32_bf16 v[216:219], v[76:79], v[108:111], v[216:219]
  s_cbranch_scc1 L_dnn_loop0
  ds_read_b64_tr_b16 v[40:41], v1 offset:0
  v_lshl_add_u32 v34, v20, 7, v15
  v_lshl_add_u32 v28, v16, 7, v14
  s_add_u32 m0, s76, 8192
  s_nop 0
  buffer_load_dwordx4 v28, s[32:35], 0 offen lds
  ds_read_b64_tr_b16 v[42:43], v1 offset:2560
  ds_read_b64_tr_b16 v[44:45], v1 offset:20480
  ds_read_b64_tr_b16 v[46:47], v1 offset:23040
  ds_read_b64_tr_b16 v[48:49], v2 offset:0
  ds_read_b64_tr_b16 v[50:51], v2 offset:2560
  ds_read_b64_tr_b16 v[52:53], v2 offset:20480
  ds_read_b64_tr_b16 v[54:55], v2 offset:23040
  ds_read_b64_tr_b16 v[56:57], v3 offset:0
  ds_read_b64_tr_b16 v[58:59], v3 offset:2560
  ds_read_b64_tr_b16 v[60:61], v3 offset:20480
  ds_read_b64_tr_b16 v[62:63], v3 offset:23040
  ds_read_b64_tr_b16 v[64:65], v4 offset:0
  ds_read_b64_tr_b16 v[66:67], v4 offset:2560
  ds_read_b64_tr_b16 v[68:69], v4 offset:20480
  ds_read_b64_tr_b16 v[70:71], v4 offset:23040
  ds_read_b128 v[80:83], v11 offset:0
  s_add_u32 m0, m0, 1024
  s_nop 0
  buffer_load_dwordx4 v34, s[32:35], 0 offen lds
  ds_read_b128 v[84:87], v12 offset:0
  ds_read_b128 v[88:91], v11 offset:2048
  ds_read_b128 v[92:95], v12 offset:2048
  ds_read_b128 v[96:99], v11 offset:4096
  ds_read_b128 v[100:103], v12 offset:4096
  ds_read_b128 v[104:107], v11 offset:6144
  ds_read_b128 v[108:111], v12 offset:6144
  ds_read_b64_tr_b16 v[72:73], v5 offset:0
  ds_read_b64_tr_b16 v[74:75], v5 offset:2560
  ds_read_b64_tr_b16 v[76:77], v5 offset:20480
  ds_read_b64_tr_b16 v[78:79], v5 offset:23040
  ds_read_b64 v[220:221], v35 offset:640
  ds_read_b64 v[222:223], v35 offset:672
  ds_read_b64 v[224:225], v35 offset:704
  ds_read_b64 v[226:227], v35 offset:736
  ds_read_b64 v[228:229], v35 offset:768
  s_mov_b32 s60, s24
  s_and_b32 s61, s25, 0xffff
  s_mov_b32 s62, 268435456
  s_mov_b32 s63, 0x20000
  s_mov_b32 s64, s22
  s_and_b32 s65, s23, 0xffff
  s_mov_b32 s66, 256
  s_mov_b32 s67, 0x20000
  v_lshlrev_b32 v28, 2, v0
  s_mov_b64 exec, 0xff
  s_mov_b32 s81, 0x80000
  buffer_load_dword v255, v28, s[60:63], s81 offen
  buffer_load_dword v37, v28, s[64:67], 0 offen offset:128 sc1
  s_mov_b64 exec, -1
  v_mov_b32 v28, 0
  s_waitcnt vmcnt(6) lgkmcnt(0)
  s_barrier
  s_setprio 0
  v_mfma_f32_16x16x32_bf16 v[140:143], v[40:43], v[80:83], v[140:143]
  v_mov_b32 v232, 0xc0135761
  v_mov_b32 v233, 0xc0135761
  v_mfma_f32_16x16x32_bf16 v[140:143], v[44:47], v[84:87], v[140:143]
  v_mov_b32 v234, 0xbdd2d3e8
  v_mfma_f32_16x16x32_bf16 v[144:147], v[40:43], v[88:91], v[144:147]
  v_mov_b32 v235, 0xbdd2d3e8
  v_mfma_f32_16x16x32_bf16 v[144:147], v[44:47], v[92:95], v[144:147]
  v_mov_b32 v236, 0x71800000
  v_mfma_f32_16x16x32_bf16 v[148:151], v[40:43], v[96:99], v[148:151]
  v_lshlrev_b32 v112, 16, v220
  v_mfma_f32_16x16x32_bf16 v[148:151], v[44:47], v[100:103], v[148:151]
  v_and_b32 v113, 0xffff0000, v220
  v_mfma_f32_16x16x32_bf16 v[152:155], v[40:43], v[104:107], v[152:155]
  v_lshlrev_b32 v114, 16, v221
  v_mfma_f32_16x16x32_bf16 v[152:155], v[44:47], v[108:111], v[152:155]
  v_and_b32 v115, 0xffff0000, v221
  v_mfma_f32_16x16x32_bf16 v[168:171], v[48:51], v[104:107], v[168:171]
  v_lshlrev_b32 v116, 16, v222
  v_mfma_f32_16x16x32_bf16 v[168:171], v[52:55], v[108:111], v[168:171]
  v_and_b32 v117, 0xffff0000, v222
  v_mfma_f32_16x16x32_bf16 v[164:167], v[48:51], v[96:99], v[164:167]
  v_lshlrev_b32 v118, 16, v223
  v_mfma_f32_16x16x32_bf16 v[164:167], v[52:55], v[100:103], v[164:167]
  v_and_b32 v119, 0xffff0000, v223
  v_mfma_f32_16x16x32_bf16 v[160:163], v[48:51], v[88:91], v[160:163]
  v_lshlrev_b32 v120, 16, v224
  v_mfma_f32_16x16x32_bf16 v[160:163], v[52:55], v[92:95], v[160:163]
  v_and_b32 v121, 0xffff0000, v224
  v_mfma_f32_16x16x32_bf16 v[156:159], v[48:51], v[80:83], v[156:159]
  v_lshlrev_b32 v122, 16, v225
  v_mfma_f32_16x16x32_bf16 v[156:159], v[52:55], v[84:87], v[156:159]
  v_and_b32 v123, 0xffff0000, v225
  v_mfma_f32_16x16x32_bf16 v[172:175], v[56:59], v[80:83], v[172:175]
  v_lshlrev_b32 v124, 16, v226
  v_mfma_f32_16x16x32_bf16 v[172:175], v[60:63], v[84:87], v[172:175]
  v_and_b32 v125, 0xffff0000, v226
  v_mfma_f32_16x16x32_bf16 v[176:179], v[56:59], v[88:91], v[176:179]
  v_lshlrev_b32 v126, 16, v227
  v_mfma_f32_16x16x32_bf16 v[176:179], v[60:63], v[92:95], v[176:179]
  v_and_b32 v127, 0xffff0000, v227
  v_mfma_f32_16x16x32_bf16 v[180:183], v[56:59], v[96:99], v[180:183]
  v_lshlrev_b32 v128, 16, v228
  v_mfma_f32_16x16x32_bf16 v[180:183], v[60:63], v[100:103], v[180:183]
  v_and_b32 v129, 0xffff0000, v228
  v_mfma_f32_16x16x32_bf16 v[184:187], v[56:59], v[104:107], v[184:187]
  v_lshlrev_b32 v130, 16, v229
  v_mfma_f32_16x16x32_bf16 v[184:187], v[60:63], v[108:111], v[184:187]
  v_and_b32 v131, 0xffff0000, v229
  v_mfma_f32_16x16x32_bf16 v[200:203], v[64:67], v[104:107], v[200:203]
  v_rcp_f32 v112, v112
  v_mfma_f32_16x16x32_bf16 v[200:203], v[68:71], v[108:111], v[200:203]
  v_rcp_f32 v113, v113
  v_mfma_f32_16x16x32_bf16 v[196:199], v[64:67], v[96:99], v[196:199]
  v_rcp_f32 v114, v114
  v_mfma_f32_16x16x32_bf16 v[196:199], v[68:71], v[100:103], v[196:199]
  v_rcp_f32 v115, v115
  v_mfma_f32_16x16x32_bf16 v[192:195], v[64:67], v[88:91], v[192:195]
  v_rcp_f32 v116, v116
  v_mfma_f32_16x16x32_bf16 v[192:195], v[68:71], v[92:95], v[192:195]
  v_rcp_f32 v117, v117
  v_mfma_f32_16x16x32_bf16 v[188:191], v[64:67], v[80:83], v[188:191]
  v_rcp_f32 v118, v118
  v_mfma_f32_16x16x32_bf16 v[188:191], v[68:71], v[84:87], v[188:191]
  v_rcp_f32 v119, v119
  v_mfma_f32_16x16x32_bf16 v[204:207], v[72:75], v[80:83], v[204:207]
  v_rcp_f32 v120, v120
  v_mfma_f32_16x16x32_bf16 v[204:207], v[76:79], v[84:87], v[204:207]
  v_rcp_f32 v121, v121
  v_mfma_f32_16x16x32_bf16 v[208:211], v[72:75], v[88:91], v[208:211]
  v_rcp_f32 v122, v122
  v_mfma_f32_16x16x32_bf16 v[208:211], v[76:79], v[92:95], v[208:211]
  v_rcp_f32 v123, v123
  v_mfma_f32_16x16x32_bf16 v[212:215], v[72:75], v[96:99], v[212:215]
  v_rcp_f32 v124, v124
  v_mfma_f32_16x16x32_bf16 v[212:215], v[76:79], v[100:103], v[212:215]
  v_rcp_f32 v125, v125
  v_mfma_f32_16x16x32_bf16 v[216:219], v[72:75], v[104:107], v[216:219]
  s_setprio 2
  s_barrier
  v_mfma_f32_16x16x32_bf16 v[216:219], v[76:79], v[108:111], v[216:219]
  ds_read_b64_tr_b16 v[40:41], v1 offset:40960
  ds_read_b64_tr_b16 v[42:43], v1 offset:43520
  ds_read_b64_tr_b16 v[44:45], v6 offset:0
  ds_read_b64_tr_b16 v[46:47], v6 offset:2560
  ds_read_b64_tr_b16 v[48:49], v2 offset:40960
  ds_read_b64_tr_b16 v[50:51], v2 offset:43520
  ds_read_b64_tr_b16 v[52:53], v7 offset:0
  ds_read_b64_tr_b16 v[54:55], v7 offset:2560
  ds_read_b64_tr_b16 v[56:57], v3 offset:40960
  ds_read_b64_tr_b16 v[58:59], v3 offset:43520
  ds_read_b64_tr_b16 v[60:61], v8 offset:0
  ds_read_b64_tr_b16 v[62:63], v8 offset:2560
  ds_read_b64_tr_b16 v[64:65], v4 offset:40960
  ds_read_b64_tr_b16 v[66:67], v4 offset:43520
  ds_read_b64_tr_b16 v[68:69], v9 offset:0
  ds_read_b64_tr_b16 v[70:71], v9 offset:2560
  ds_read_b128 v[80:83], v11 offset:8192
  ds_read_b128 v[84:87], v12 offset:8192
  ds_read_b128 v[88:91], v11 offset:10240
  ds_read_b128 v[92:95], v12 offset:10240
  ds_read_b128 v[96:99], v11 offset:12288
  ds_read_b128 v[100:103], v12 offset:12288
  ds_read_b128 v[104:107], v11 offset:14336
  ds_read_b128 v[108:111], v12 offset:14336
  ds_read_b64_tr_b16 v[72:73], v5 offset:40960
  ds_read_b64_tr_b16 v[74:75], v5 offset:43520
  ds_read_b64_tr_b16 v[76:77], v10 offset:0
  ds_read_b64_tr_b16 v[78:79], v10 offset:2560
  s_waitcnt vmcnt(2) lgkmcnt(0)
  s_barrier
  s_setprio 0
  v_mfma_f32_16x16x32_bf16 v[140:143], v[40:43], v[80:83], v[140:143]
  v_rcp_f32 v126, v126
  v_mfma_f32_16x16x32_bf16 v[140:143], v[44:47], v[84:87], v[140:143]
  v_rcp_f32 v127, v127
  v_mfma_f32_16x16x32_bf16 v[144:147], v[40:43], v[88:91], v[144:147]
  v_rcp_f32 v128, v128
  v_mfma_f32_16x16x32_bf16 v[144:147], v[44:47], v[92:95], v[144:147]
  v_mfma_f32_16x16x32_bf16 v[148:151], v[40:43], v[96:99], v[148:151]
  v_rcp_f32 v129, v129
  v_mfma_f32_16x16x32_bf16 v[148:151], v[44:47], v[100:103], v[148:151]
  v_rcp_f32 v130, v130
  v_mfma_f32_16x16x32_bf16 v[152:155], v[40:43], v[104:107], v[152:155]
  v_mfma_f32_16x16x32_bf16 v[152:155], v[44:47], v[108:111], v[152:155]
  v_rcp_f32 v131, v131
  v_mfma_f32_16x16x32_bf16 v[168:171], v[48:51], v[104:107], v[168:171]
  v_med3_f32 v112, v112, -v236, v236
  v_mfma_f32_16x16x32_bf16 v[168:171], v[52:55], v[108:111], v[168:171]
  v_mfma_f32_16x16x32_bf16 v[164:167], v[48:51], v[96:99], v[164:167]
  v_med3_f32 v113, v113, -v236, v236
  v_mfma_f32_16x16x32_bf16 v[164:167], v[52:55], v[100:103], v[164:167]
  v_med3_f32 v114, v114, -v236, v236
  v_mfma_f32_16x16x32_bf16 v[160:163], v[48:51], v[88:91], v[160:163]
  v_mfma_f32_16x16x32_bf16 v[160:163], v[52:55], v[92:95], v[160:163]
  v_med3_f32 v115, v115, -v236, v236
  v_mfma_f32_16x16x32_bf16 v[156:159], v[48:51], v[80:83], v[156:159]
  v_med3_f32 v116, v116, -v236, v236
  v_mfma_f32_16x16x32_bf16 v[156:159], v[52:55], v[84:87], v[156:159]
  v_mfma_f32_16x16x32_bf16 v[172:175], v[56:59], v[80:83], v[172:175]
  v_med3_f32 v117, v117, -v236, v236
  v_mfma_f32_16x16x32_bf16 v[172:175], v[60:63], v[84:87], v[172:175]
  v_med3_f32 v118, v118, -v236, v236
  v_mfma_f32_16x16x32_bf16 v[176:179], v[56:59], v[88:91], v[176:179]
  v_mfma_f32_16x16x32_bf16 v[176:179], v[60:63], v[92:95], v[176:179]
  v_med3_f32 v119, v119, -v236, v236
  v_mfma_f32_16x16x32_bf16 v[180:183], v[56:59], v[96:99], v[180:183]
  v_med3_f32 v120, v120, -v236, v236
  v_mfma_f32_16x16x32_bf16 v[180:183], v[60:63], v[100:103], v[180:183]
  v_med3_f32 v121, v121, -v236, v236
  v_mfma_f32_16x16x32_bf16 v[184:187], v[56:59], v[104:107], v[184:187]
  v_mfma_f32_16x16x32_bf16 v[184:187], v[60:63], v[108:111], v[184:187]
  v_med3_f32 v122, v122, -v236, v236
  v_mfma_f32_16x16x32_bf16 v[200:203], v[64:67], v[104:107], v[200:203]
  v_med3_f32 v123, v123, -v236, v236
  v_mfma_f32_16x16x32_bf16 v[200:203], v[68:71], v[108:111], v[200:203]
  v_mfma_f32_16x16x32_bf16 v[196:199], v[64:67], v[96:99], v[196:199]
  v_med3_f32 v124, v124, -v236, v236
  v_mfma_f32_16x16x32_bf16 v[196:199], v[68:71], v[100:103], v[196:199]
  v_med3_f32 v125, v125, -v236, v236
  v_mfma_f32_16x16x32_bf16 v[192:195], v[64:67], v[88:91], v[192:195]
  v_mfma_f32_16x16x32_bf16 v[192:195], v[68:71], v[92:95], v[192:195]
  v_med3_f32 v126, v126, -v236, v236
  v_mfma_f32_16x16x32_bf16 v[188:191], v[64:67], v[80:83], v[188:191]
  v_med3_f32 v127, v127, -v236, v236
  v_mfma_f32_16x16x32_bf16 v[188:191], v[68:71], v[84:87], v[188:191]
  v_mfma_f32_16x16x32_bf16 v[204:207], v[72:75], v[80:83], v[204:207]
  v_med3_f32 v128, v128, -v236, v236
  v_mfma_f32_16x16x32_bf16 v[204:207], v[76:79], v[84:87], v[204:207]
  v_med3_f32 v129, v129, -v236, v236
  v_mfma_f32_16x16x32_bf16 v[208:211], v[72:75], v[88:91], v[208:211]
  v_mfma_f32_16x16x32_bf16 v[208:211], v[76:79], v[92:95], v[208:211]
  v_med3_f32 v130, v130, -v236, v236
  v_mfma_f32_16x16x32_bf16 v[212:215], v[72:75], v[96:99], v[212:215]
  v_med3_f32 v131, v131, -v236, v236
  v_mfma_f32_16x16x32_bf16 v[212:215], v[76:79], v[100:103], v[212:215]
  v_mfma_f32_16x16x32_bf16 v[216:219], v[72:75], v[104:107], v[216:219]
  s_setprio 2
  s_barrier
  v_mfma_f32_16x16x32_bf16 v[216:219], v[76:79], v[108:111], v[216:219]
  s_setprio 0
  s_branch L_epi
L_dnn_h1:
  v_lshl_add_u32 v34, v117, 7, v15
  v_lshl_add_u32 v28, v113, 7, v14
  s_add_u32 m0, s76, 8192
  s_nop 0
  buffer_load_dwordx4 v28, s[32:35], 0 offen lds
  s_add_u32 m0, m0, 1024
  s_nop 0
  buffer_load_dwordx4 v34, s[32:35], 0 offen lds
  s_add_u32 m0, s75, 40960
  s_nop 0
  buffer_load_dwordx4 v29, s[44:47], s74 offen offset:0 lds
  buffer_load_dwordx4 v30, s[44:47], s74 offen offset:1024 lds
  buffer_load_dwordx4 v31, s[44:47], s74 offen offset:2048 lds
  buffer_load_dwordx4 v32, s[44:47], s74 offen offset:3072 lds
  s_add_u32 m0, m0, 4096
  s_nop 0
  buffer_load_dwordx4 v33, s[44:47], s74 offen offset:0 lds
  s_add_u32 s74, s74, 212992
  s_waitcnt vmcnt(13)
  s_waitcnt vmcnt(10) lgkmcnt(0)
  s_barrier
  buffer_load_dwordx3 v[24:26], v13, s[28:31], s73 offen offset:0
  buffer_load_dwordx3 v[240:242], v13, s[28:31], s73 offen offset:832
  s_add_u32 s73, s73, 12
  s_barrier
L_dnn_loop1:
  ds_read_b64_tr_b16 v[40:41], v1 offset:0
  s_add_u32 m0, s75, 81920
  s_nop 0
  buffer_load_dwordx4 v29, s[44:47], s74 offen offset:0 lds
  ds_read_b64_tr_b16 v[42:43], v1 offset:2560
  ds_read_b64_tr_b16 v[44:45], v1 offset:20480
  ds_read_b64_tr_b16 v[46:47], v1 offset:23040
  ds_read_b64_tr_b16 v[48:49], v2 offset:0
  buffer_load_dwordx4 v30, s[44:47], s74 offen offset:1024 lds
  ds_read_b64_tr_b16 v[50:51], v2 offset:2560
  ds_read_b64_tr_b16 v[52:53], v2 offset:20480
  ds_read_b64_tr_b16 v[54:55], v2 offset:23040
  ds_read_b64_tr_b16 v[56:57], v3 offset:0
  buffer_load_dwordx4 v31, s[44:47], s74 offen offset:2048 lds
  ds_read_b64_tr_b16 v[58:59], v3 offset:2560
  ds_read_b64_tr_b16 v[60:61], v3 offset:20480
  ds_read_b64_tr_b16 v[62:63], v3 offset:23040
  ds_read_b64_tr_b16 v[64:65], v4 offset:0
  buffer_load_dwordx4 v32, s[44:47], s74 offen offset:3072 lds
  ds_read_b64_tr_b16 v[66:67], v4 offset:2560
  ds_read_b64_tr_b16 v[68:69], v4 offset:20480
  ds_read_b64_tr_b16 v[70:71], v4 offset:23040
  ds_read_b128 v[80:83], v11 offset:0
  s_add_u32 m0, m0, 4096
  s_nop 0
  buffer_load_dwordx4 v33, s[44:47], s74 offen offset:0 lds
  s_add_u32 s74, s74, 212992
  ds_read_b128 v[84:87], v12 offset:0
  ds_read_b128 v[88:91], v11 offset:2048
  ds_read_b128 v[92:95], v12 offset:2048
  ds_read_b128 v[96:99], v11 offset:4096
  s_waitcnt vmcnt(14)
  v_lshl_add_u32 v34, v20, 7, v15
  v_lshl_add_u32 v28, v16, 7, v14
  s_add_u32 m0, s76, 0
  s_nop 0
  buffer_load_dwordx4 v28, s[32:35], 0 offen lds
  ds_read_b128 v[100:103], v12 offset:4096
  ds_read_b128 v[104:107], v11 offset:6144
  ds_read_b128 v[108:111], v12 offset:6144
  ds_read_b64_tr_b16 v[72:73], v5 offset:0
  s_add_u32 m0, m0, 1024
  s_nop 0
  buffer_load_dwordx4 v34, s[32:35], 0 offen lds
  ds_read_b64_tr_b16 v[74:75], v5 offset:2560
  ds_read_b64_tr_b16 v[76:77], v5 offset:20480
  ds_read_b64_tr_b16 v[78:79], v5 offset:23040
  s_waitcnt vmcnt(9) lgkmcnt(0)
  s_waitcnt vmcnt(9)
  s_barrier
  s_setprio 0
  v_mfma_f32_16x16x32_bf16 v[140:143], v[40:43], v[80:83], v[140:143]
  v_mfma_f32_16x16x32_bf16 v[140:143], v[44:47], v[84:87], v[140:143]
  v_mfma_f32_16x16x32_bf16 v[144:147], v[40:43], v[88:91], v[144:147]
  v_mfma_f32_16x16x32_bf16 v[144:147], v[44:47], v[92:95], v[144:147]
  v_mfma_f32_16x16x32_bf16 v[148:151], v[40:43], v[96:99], v[148:151]
  v_mfma_f32_16x16x32_bf16 v[148:151], v[44:47], v[100:103], v[148:151]
  v_mfma_f32_16x16x32_bf16 v[152:155], v[40:43], v[104:107], v[152:155]
  v_mfma_f32_16x16x32_bf16 v[152:155], v[44:47], v[108:111], v[152:155]
  v_mfma_f32_16x16x32_bf16 v[168:171], v[48:51], v[104:107], v[168:171]
  v_mfma_f32_16x16x32_bf16 v[168:171], v[52:55], v[108:111], v[168:171]
  v_mfma_f32_16x16x32_bf16 v[164:167], v[48:51], v[96:99], v[164:167]
  v_mfma_f32_16x16x32_bf16 v[164:167], v[52:55], v[100:103], v[164:167]
  v_mfma_f32_16x16x32_bf16 v[160:163], v[48:51], v[88:91], v[160:163]
  v_mfma_f32_16x16x32_bf16 v[160:163], v[52:55], v[92:95], v[160:163]
  v_mfma_f32_16x16x32_bf16 v[156:159], v[48:51], v[80:83], v[156:159]
  v_mfma_f32_16x16x32_bf16 v[156:159], v[52:55], v[84:87], v[156:159]
  v_mfma_f32_16x16x32_bf16 v[172:175], v[56:59], v[80:83], v[172:175]
  v_mfma_f32_16x16x32_bf16 v[172:175], v[60:63], v[84:87], v[172:175]
  v_mfma_f32_16x16x32_bf16 v[176:179], v[56:59], v[88:91], v[176:179]
  v_mfma_f32_16x16x32_bf16 v[176:179], v[60:63], v[92:95], v[176:179]
  v_mfma_f32_16x16x32_bf16 v[180:183], v[56:59], v[96:99], v[180:183]
  v_mfma_f32_16x16x32_bf16 v[180:183], v[60:63], v[100:103], v[180:183]
  v_mfma_f32_16x16x32_bf16 v[184:187], v[56:59], v[104:107], v[184:187]
  v_mfma_f32_16x16x32_bf16 v[184:187], v[60:63], v[108:111], v[184:187]
  v_mfma_f32_16x16x32_bf16 v[200:203], v[64:67], v[104:107], v[200:203]
  v_mfma_f32_16x16x32_bf16 v[200:203], v[68:71], v[108:111], v[200:203]
  v_mfma_f32_16x16x32_bf16 v[196:199], v[64:67], v[96:99], v[196:199]
  v_mfma_f32_16x16x32_bf16 v[196:199], v[68:71], v[100:103], v[196:199]
  v_mfma_f32_16x16x32_bf16 v[192:195], v[64:67], v[88:91], v[192:195]
  v_mfma_f32_16x16x32_bf16 v[192:195], v[68:71], v[92:95], v[192:195]
  v_mfma_f32_16x16x32_bf16 v[188:191], v[64:67], v[80:83], v[188:191]
  v_mfma_f32_16x16x32_bf16 v[188:191], v[68:71], v[84:87], v[188:191]
  v_mfma_f32_16x16x32_bf16 v[204:207], v[72:75], v[80:83], v[204:207]
  v_mfma_f32_16x16x32_bf16 v[204:207], v[76:79], v[84:87], v[204:207]
  v_mfma_f32_16x16x32_bf16 v[208:211], v[72:75], v[88:91], v[208:211]
  v_mfma_f32_16x16x32_bf16 v[208:211], v[76:79], v[92:95], v[208:211]
  v_mfma_f32_16x16x32_bf16 v[212:215], v[72:75], v[96:99], v[212:215]
  v_mfma_f32_16x16x32_bf16 v[212:215], v[76:79], v[100:103], v[212:215]
  v_mfma_f32_16x16x32_bf16 v[216:219], v[72:75], v[104:107], v[216:219]
  s_setprio 2
  s_barrier
  v_mfma_f32_16x16x32_bf16 v[216:219], v[76:79], v[108:111], v[216:219]
  ds_read_b64_tr_b16 v[40:41], v1 offset:40960
  s_add_u32 m0, s75, 0
  s_nop 0
  buffer_load_dwordx4 v29, s[44:47], s74 offen offset:0 lds
  ds_read_b64_tr_b16 v[42:43], v1 offset:43520
  ds_read_b64_tr_b16 v[44:45], v6 offset:0
  ds_read_b64_tr_b16 v[46:47], v6 offset:2560
  ds_read_b64_tr_b16 v[48:49], v2 offset:40960
  buffer_load_dwordx4 v30, s[44:47], s74 offen offset:1024 lds
  ds_read_b64_tr_b16 v[50:51], v2 offset:43520
  ds_read_b64_tr_b16 v[52:53], v7 offset:0
  ds_read_b64_tr_b16 v[54:55], v7 offset:2560
  ds_read_b64_tr_b16 v[56:57], v3 offset:40960
  buffer_load_dwordx4 v31, s[44:47], s74 offen offset:2048 lds
  ds_read_b64_tr_b16 v[58:59], v3 offset:43520
  ds_read_b64_tr_b16 v[60:61], v8 offset:0
  ds_read_b64_tr_b16 v[62:63], v8 offset:2560
  ds_read_b64_tr_b16 v[64:65], v4 offset:40960
  buffer_load_dwordx4 v32, s[44:47], s74 offen offset:3072 lds
  ds_read_b64_tr_b16 v[66:67], v4 offset:43520
  ds_read_b64_tr_b16 v[68:69], v9 offset:0
  ds_read_b64_tr_b16 v[70:71], v9 offset:2560
  ds_read_b128 v[80:83], v11 offset:8192
  s_add_u32 m0, m0, 4096
  s_nop 0
  buffer_load_dwordx4 v33, s[44:47], s74 offen offset:0 lds
  s_add_u32 s74, s74, 212992
  ds_read_b128 v[84:87], v12 offset:8192
  ds_read_b128 v[88:91], v11 offset:10240
  ds_read_b128 v[92:95], v12 offset:10240
  ds_read_b128 v[96:99], v11 offset:12288
  v_lshl_add_u32 v34, v21, 7, v15
  v_lshl_add_u32 v28, v17, 7, v14
  s_add_u32 m0, s76, 8192
  s_nop 0
  buffer_load_dwordx4 v28, s[32:35], 0 offen lds
  ds_read_b128 v[100:103], v12 offset:12288
  ds_read_b128 v[104:107], v11 offset:14336
  ds_read_b128 v[108:111], v12 offset:14336
  ds_read_b64_tr_b16 v[72:73], v5 offset:40960
  s_add_u32 m0, m0, 1024
  s_nop 0
  buffer_load_dwordx4 v34, s[32:35], 0 offen lds
  ds_read_b64_tr_b16 v[74:75], v5 offset:43520
  ds_read_b64_tr_b16 v[76:77], v10 offset:0
  ds_read_b64_tr_b16 v[78:79], v10 offset:2560
  s_waitcnt vmcnt(7) lgkmcnt(0)
  s_barrier
  s_setprio 0
  v_mfma_f32_16x16x32_bf16 v[140:143], v[40:43], v[80:83], v[140:143]
  v_mfma_f32_16x16x32_bf16 v[140:143], v[44:47], v[84:87], v[140:143]
  v_mfma_f32_16x16x32_bf16 v[144:147], v[40:43], v[88:91], v[144:147]
  v_mfma_f32_16x16x32_bf16 v[144:147], v[44:47], v[92:95], v[144:147]
  v_mfma_f32_16x16x32_bf16 v[148:151], v[40:43], v[96:99], v[148:151]
  v_mfma_f32_16x16x32_bf16 v[148:151], v[44:47], v[100:103], v[148:151]
  v_mfma_f32_16x16x32_bf16 v[152:155], v[40:43], v[104:107], v[152:155]
  v_mfma_f32_16x16x32_bf16 v[152:155], v[44:47], v[108:111], v[152:155]
  v_mfma_f32_16x16x32_bf16 v[168:171], v[48:51], v[104:107], v[168:171]
  v_mfma_f32_16x16x32_bf16 v[168:171], v[52:55], v[108:111], v[168:171]
  v_mfma_f32_16x16x32_bf16 v[164:167], v[48:51], v[96:99], v[164:167]
  v_mfma_f32_16x16x32_bf16 v[164:167], v[52:55], v[100:103], v[164:167]
  v_mfma_f32_16x16x32_bf16 v[160:163], v[48:51], v[88:91], v[160:163]
  v_mfma_f32_16x16x32_bf16 v[160:163], v[52:55], v[92:95], v[160:163]
  v_mfma_f32_16x16x32_bf16 v[156:159], v[48:51], v[80:83], v[156:159]
  v_mfma_f32_16x16x32_bf16 v[156:159], v[52:55], v[84:87], v[156:159]
  v_mfma_f32_16x16x32_bf16 v[172:175], v[56:59], v[80:83], v[172:175]
  v_mfma_f32_16x16x32_bf16 v[172:175], v[60:63], v[84:87], v[172:175]
  v_mfma_f32_16x16x32_bf16 v[176:179], v[56:59], v[88:91], v[176:179]
  v_mfma_f32_16x16x32_bf16 v[176:179], v[60:63], v[92:95], v[176:179]
  v_mfma_f32_16x16x32_bf16 v[180:183], v[56:59], v[96:99], v[180:183]
  v_mfma_f32_16x16x32_bf16 v[180:183], v[60:63], v[100:103], v[180:183]
  v_mfma_f32_16x16x32_bf16 v[184:187], v[56:59], v[104:107], v[184:187]
  v_mfma_f32_16x16x32_bf16 v[184:187], v[60:63], v[108:111], v[184:187]
  v_mfma_f32_16x16x32_bf16 v[200:203], v[64:67], v[104:107], v[200:203]
  v_mfma_f32_16x16x32_bf16 v[200:203], v[68:71], v[108:111], v[200:203]
  v_mfma_f32_16x16x32_bf16 v[196:199], v[64:67], v[96:99], v[196:199]
  v_mfma_f32_16x16x32_bf16 v[196:199], v[68:71], v[100:103], v[196:199]
  v_mfma_f32_16x16x32_bf16 v[192:195], v[64:67], v[88:91], v[192:195]
  v_mfma_f32_16x16x32_bf16 v[192:195], v[68:71], v[92:95], v[192:195]
  v_mfma_f32_16x16x32_bf16 v[188:191], v[64:67], v[80:83], v[188:191]
  v_mfma_f32_16x16x32_bf16 v[188:191], v[68:71], v[84:87], v[188:191]
  v_mfma_f32_16x16x32_bf16 v[204:207], v[72:75], v[80:83], v[204:207]
  v_mfma_f32_16x16x32_bf16 v[204:207], v[76:79], v[84:87], v[204:207]
  v_mfma_f32_16x16x32_bf16 v[208:211], v[72:75], v[88:91], v[208:211]
  v_mfma_f32_16x16x32_bf16 v[208:211], v[76:79], v[92:95], v[208:211]
  v_mfma_f32_16x16x32_bf16 v[212:215], v[72:75], v[96:99], v[212:215]
  v_mfma_f32_16x16x32_bf16 v[212:215], v[76:79], v[100:103], v[212:215]
  v_mfma_f32_16x16x32_bf16 v[216:219], v[72:75], v[104:107], v[216:219]
  s_setprio 2
  s_barrier
  v_mfma_f32_16x16x32_bf16 v[216:219], v[76:79], v[108:111], v[216:219]
  ds_read_b64_tr_b16 v[40:41], v6 offset:20480
  s_add_u32 m0, s75, 40960
  s_nop 0
  buffer_load_dwordx4 v29, s[44:47], s74 offen offset:0 lds
  ds_read_b64_tr_b16 v[42:43], v6 offset:23040
  ds_read_b64_tr_b16 v[44:45], v6 offset:40960
  ds_read_b64_tr_b16 v[46:47], v6 offset:43520
  ds_read_b64_tr_b16 v[48:49], v7 offset:20480
  buffer_load_dwordx4 v30, s[44:47], s74 offen offset:1024 lds
  ds_read_b64_tr_b16 v[50:51], v7 offset:23040
  ds_read_b64_tr_b16 v[52:53], v7 offset:40960
  ds_read_b64_tr_b16 v[54:55], v7 offset:43520
  ds_read_b64_tr_b16 v[56:57], v8 offset:20480
  buffer_load_dwordx4 v31, s[44:47], s74 offen offset:2048 lds
  ds_read_b64_tr_b16 v[58:59], v8 offset:23040
  ds_read_b64_tr_b16 v[60:61], v8 offset:40960
  ds_read_b64_tr_b16 v[62:63], v8 offset:43520
  ds_read_b64_tr_b16 v[64:65], v9 offset:20480
  buffer_load_dwordx4 v32, s[44:47], s74 offen offset:3072 lds
  ds_read_b64_tr_b16 v[66:67], v9 offset:23040
  ds_read_b64_tr_b16 v[68:69], v9 offset:40960
  ds_read_b64_tr_b16 v[70:71], v9 offset:43520
  ds_read_b128 v[80:83], v11 offset:0
  s_add_u32 m0, m0, 4096
  s_nop 0
  buffer_load_dwordx4 v33, s[44:47], s74 offen offset:0 lds
  s_add_u32 s74, s74, 212992
  ds_read_b128 v[84:87], v12 offset:0
  ds_read_b128 v[88:91], v11 offset:2048
  ds_read_b128 v[92:95], v12 offset:2048
  ds_read_b128 v[96:99], v11 offset:4096
  v_lshl_add_u32 v34, v22, 7, v15
  v_lshl_add_u32 v28, v18, 7, v14
  s_add_u32 m0, s76, 0
  s_nop 0
  buffer_load_dwordx4 v28, s[32:35], 0 offen lds
  ds_read_b128 v[100:103], v12 offset:4096
  ds_read_b128 v[104:107], v11 offset:6144
  ds_read_b128 v[108:111], v12 offset:6144
  ds_read_b64_tr_b16 v[72:73], v10 offset:20480
  s_add_u32 m0, m0, 1024
  s_nop 0
  buffer_load_dwordx4 v34, s[32:35], 0 offen lds
  ds_read_b64_tr_b16 v[74:75], v10 offset:23040
  ds_read_b64_tr_b16 v[76:77], v10 offset:40960
  ds_read_b64_tr_b16 v[78:79], v10 offset:43520
  buffer_load_dwordx3 v[16:18], v13, s[28:31], s73 offen offset:0
  buffer_load_dwordx3 v[20:22], v13, s[28:31], s73 offen offset:832
  s_add_u32 s73, s73, 12
  s_waitcnt vmcnt(9) lgkmcnt(0)
  s_barrier
  s_setprio 0
  v_mfma_f32_16x16x32_bf16 v[140:143], v[40:43], v[80:83], v[140:143]
  v_mfma_f32_16x16x32_bf16 v[140:143], v[44:47], v[84:87], v[140:143]
  v_mfma_f32_16x16x32_bf16 v[144:147], v[40:43], v[88:91], v[144:147]
  v_mfma_f32_16x16x32_bf16 v[144:147], v[44:47], v[92:95], v[144:147]
  v_mfma_f32_16x16x32_bf16 v[148:151], v[40:43], v[96:99], v[148:151]
  v_mfma_f32_16x16x32_bf16 v[148:151], v[44:47], v[100:103], v[148:151]
  v_mfma_f32_16x16x32_bf16 v[152:155], v[40:43], v[104:107], v[152:155]
  v_mfma_f32_16x16x32_bf16 v[152:155], v[44:47], v[108:111], v[152:155]
  v_mfma_f32_16x16x32_bf16 v[168:171], v[48:51], v[104:107], v[168:171]
  v_mfma_f32_16x16x32_bf16 v[168:171], v[52:55], v[108:111], v[168:171]
  v_mfma_f32_16x16x32_bf16 v[164:167], v[48:51], v[96:99], v[164:167]
  v_mfma_f32_16x16x32_bf16 v[164:167], v[52:55], v[100:103], v[164:167]
  v_mfma_f32_16x16x32_bf16 v[160:163], v[48:51], v[88:91], v[160:163]
  v_mfma_f32_16x16x32_bf16 v[160:163], v[52:55], v[92:95], v[160:163]
  v_mfma_f32_16x16x32_bf16 v[156:159], v[48:51], v[80:83], v[156:159]
  v_mfma_f32_16x16x32_bf16 v[156:159], v[52:55], v[84:87], v[156:159]
  v_mfma_f32_16x16x32_bf16 v[172:175], v[56:59], v[80:83], v[172:175]
  v_mfma_f32_16x16x32_bf16 v[172:175], v[60:63], v[84:87], v[172:175]
  v_mfma_f32_16x16x32_bf16 v[176:179], v[56:59], v[88:91], v[176:179]
  v_mfma_f32_16x16x32_bf16 v[176:179], v[60:63], v[92:95], v[176:179]
  v_mfma_f32_16x16x32_bf16 v[180:183], v[56:59], v[96:99], v[180:183]
  v_mfma_f32_16x16x32_bf16 v[180:183], v[60:63], v[100:103], v[180:183]
  v_mfma_f32_16x16x32_bf16 v[184:187], v[56:59], v[104:107], v[184:187]
  v_mfma_f32_16x16x32_bf16 v[184:187], v[60:63], v[108:111], v[184:187]
  v_mfma_f32_16x16x32_bf16 v[200:203], v[64:67], v[104:107], v[200:203]
  v_mfma_f32_16x16x32_bf16 v[200:203], v[68:71], v[108:111], v[200:203]
  v_mfma_f32_16x16x32_bf16 v[196:199], v[64:67], v[96:99], v[196:199]
  v_mfma_f32_16x16x32_bf16 v[196:199], v[68:71], v[100:103], v[196:199]
  v_mfma_f32_16x16x32_bf16 v[192:195], v[64:67], v[88:91], v[192:195]
  v_mfma_f32_16x16x32_bf16 v[192:195], v[68:71], v[92:95], v[192:195]
  v_mfma_f32_16x16x32_bf16 v[188:191], v[64:67], v[80:83], v[188:191]
  v_mfma_f32_16x16x32_bf16 v[188:191], v[68:71], v[84:87], v[188:191]
  v_mfma_f32_16x16x32_bf16 v[204:207], v[72:75], v[80:83], v[204:207]
  v_mfma_f32_16x16x32_bf16 v[204:207], v[76:79], v[84:87], v[204:207]
  v_mfma_f32_16x16x32_bf16 v[208:211], v[72:75], v[88:91], v[208:211]
  v_mfma_f32_16x16x32_bf16 v[208:211], v[76:79], v[92:95], v[208:211]
  v_mfma_f32_16x16x32_bf16 v[212:215], v[72:75], v[96:99], v[212:215]
  v_mfma_f32_16x16x32_bf16 v[212:215], v[76:79], v[100:103], v[212:215]
  v_mfma_f32_16x16x32_bf16 v[216:219], v[72:75], v[104:107], v[216:219]
  s_setprio 2
  s_barrier
  v_mfma_f32_16x16x32_bf16 v[216:219], v[76:79], v[108:111], v[216:219]
  ds_read_b64_tr_b16 v[40:41], v1 offset:0
  s_add_u32 m0, s75, 81920
  s_nop 0
  buffer_load_dwordx4 v29, s[44:47], s74 offen offset:0 lds
  ds_read_b64_tr_b16 v[42:43], v1 offset:2560
  ds_read_b64_tr_b16 v[44:45], v1 offset:20480
  ds_read_b64_tr_b16 v[46:47], v1 offset:23040
  ds_read_b64_tr_b16 v[48:49], v2 offset:0
  buffer_load_dwordx4 v30, s[44:47], s74 offen offset:1024 lds
  ds_read_b64_tr_b16 v[50:51], v2 offset:2560
  ds_read_b64_tr_b16 v[52:53], v2 offset:20480
  ds_read_b64_tr_b16 v[54:55], v2 offset:23040
  ds_read_b64_tr_b16 v[56:57], v3 offset:0
  buffer_load_dwordx4 v31, s[44:47], s74 offen offset:2048 lds
  ds_read_b64_tr_b16 v[58:59], v3 offset:2560
  ds_read_b64_tr_b16 v[60:61], v3 offset:20480
  ds_read_b64_tr_b16 v[62:63], v3 offset:23040
  ds_read_b64_tr_b16 v[64:65], v4 offset:0
  buffer_load_dwordx4 v32, s[44:47], s74 offen offset:3072 lds
  ds_read_b64_tr_b16 v[66:67], v4 offset:2560
  ds_read_b64_tr_b16 v[68:69], v4 offset:20480
  ds_read_b64_tr_b16 v[70:71], v4 offset:23040
  ds_read_b128 v[80:83], v11 offset:8192
  s_add_u32 m0, m0, 4096
  s_nop 0
  buffer_load_dwordx4 v33, s[44:47], s74 offen offset:0 lds
  s_add_u32 s74, s74, 212992
  ds_read_b128 v[84:87], v12 offset:8192
  ds_read_b128 v[88:91], v11 offset:10240
  ds_read_b128 v[92:95], v12 offset:10240
  ds_read_b128 v[96:99], v11 offset:12288
  v_lshl_add_u32 v34, v240, 7, v15
  v_lshl_add_u32 v28, v24, 7, v14
  s_add_u32 m0, s76, 8192
  s_nop 0
  buffer_load_dwordx4 v28, s[32:35], 0 offen lds
  ds_read_b128 v[100:103], v12 offset:12288
  ds_read_b128 v[104:107], v11 offset:14336
  ds_read_b128 v[108:111], v12 offset:14336
  ds_read_b64_tr_b16 v[72:73], v5 offset:0
  s_add_u32 m0, m0, 1024
  s_nop 0
  buffer_load_dwordx4 v34, s[32:35], 0 offen lds
  ds_read_b64_tr_b16 v[74:75], v5 offset:2560
  ds_read_b64_tr_b16 v[76:77], v5 offset:20480
  ds_read_b64_tr_b16 v[78:79], v5 offset:23040
  s_waitcnt vmcnt(9) lgkmcnt(0)
  s_barrier
  s_setprio 0
  v_mfma_f32_16x16x32_bf16 v[140:143], v[40:43], v[80:83], v[140:143]
  v_mfma_f32_16x16x32_bf16 v[140:143], v[44:47], v[84:87], v[140:143]
  v_mfma_f32_16x16x32_bf16 v[144:147], v[40:43], v[88:91], v[144:147]
  v_mfma_f32_16x16x32_bf16 v[144:147], v[44:47], v[92:95], v[144:147]
  v_mfma_f32_16x16x32_bf16 v[148:151], v[40:43], v[96:99], v[148:151]
  v_mfma_f32_16x16x32_bf16 v[148:151], v[44:47], v[100:103], v[148:151]
  v_mfma_f32_16x16x32_bf16 v[152:155], v[40:43], v[104:107], v[152:155]
  v_mfma_f32_16x16x32_bf16 v[152:155], v[44:47], v[108:111], v[152:155]
  v_mfma_f32_16x16x32_bf16 v[168:171], v[48:51], v[104:107], v[168:171]
  v_mfma_f32_16x16x32_bf16 v[168:171], v[52:55], v[108:111], v[168:171]
  v_mfma_f32_16x16x32_bf16 v[164:167], v[48:51], v[96:99], v[164:167]
  v_mfma_f32_16x16x32_bf16 v[164:167], v[52:55], v[100:103], v[164:167]
  v_mfma_f32_16x16x32_bf16 v[160:163], v[48:51], v[88:91], v[160:163]
  v_mfma_f32_16x16x32_bf16 v[160:163], v[52:55], v[92:95], v[160:163]
  v_mfma_f32_16x16x32_bf16 v[156:159], v[48:51], v[80:83], v[156:159]
  v_mfma_f32_16x16x32_bf16 v[156:159], v[52:55], v[84:87], v[156:159]
  v_mfma_f32_16x16x32_bf16 v[172:175], v[56:59], v[80:83], v[172:175]
  v_mfma_f32_16x16x32_bf16 v[172:175], v[60:63], v[84:87], v[172:175]
  v_mfma_f32_16x16x32_bf16 v[176:179], v[56:59], v[88:91], v[176:179]
  v_mfma_f32_16x16x32_bf16 v[176:179], v[60:63], v[92:95], v[176:179]
  v_mfma_f32_16x16x32_bf16 v[180:183], v[56:59], v[96:99], v[180:183]
  v_mfma_f32_16x16x32_bf16 v[180:183], v[60:63], v[100:103], v[180:183]
  v_mfma_f32_16x16x32_bf16 v[184:187], v[56:59], v[104:107], v[184:187]
  v_mfma_f32_16x16x32_bf16 v[184:187], v[60:63], v[108:111], v[184:187]
  v_mfma_f32_16x16x32_bf16 v[200:203], v[64:67], v[104:107], v[200:203]
  v_mfma_f32_16x16x32_bf16 v[200:203], v[68:71], v[108:111], v[200:203]
  v_mfma_f32_16x16x32_bf16 v[196:199], v[64:67], v[96:99], v[196:199]
  v_mfma_f32_16x16x32_bf16 v[196:199], v[68:71], v[100:103], v[196:199]
  v_mfma_f32_16x16x32_bf16 v[192:195], v[64:67], v[88:91], v[192:195]
  v_mfma_f32_16x16x32_bf16 v[192:195], v[68:71], v[92:95], v[192:195]
  v_mfma_f32_16x16x32_bf16 v[188:191], v[64:67], v[80:83], v[188:191]
  v_mfma_f32_16x16x32_bf16 v[188:191], v[68:71], v[84:87], v[188:191]
  v_mfma_f32_16x16x32_bf16 v[204:207], v[72:75], v[80:83], v[204:207]
  v_mfma_f32_16x16x32_bf16 v[204:207], v[76:79], v[84:87], v[204:207]
  v_mfma_f32_16x16x32_bf16 v[208:211], v[72:75], v[88:91], v[208:211]
  v_mfma_f32_16x16x32_bf16 v[208:211], v[76:79], v[92:95], v[208:211]
  v_mfma_f32_16x16x32_bf16 v[212:215], v[72:75], v[96:99], v[212:215]
  v_mfma_f32_16x16x32_bf16 v[212:215], v[76:79], v[100:103], v[212:215]
  v_mfma_f32_16x16x32_bf16 v[216:219], v[72:75], v[104:107], v[216:219]
  s_setprio 2
  s_barrier
  v_mfma_f32_16x16x32_bf16 v[216:219], v[76:79], v[108:111], v[216:219]
  ds_read_b64_tr_b16 v[40:41], v1 offset:40960
  s_add_u32 m0, s75, 0
  s_nop 0
  buffer_load_dwordx4 v29, s[44:47], s74 offen offset:0 lds
  ds_read_b64_tr_b16 v[42:43], v1 offset:43520
  ds_read_b64_tr_b16 v[44:45], v6 offset:0
  ds_read_b64_tr_b16 v[46:47], v6 offset:2560
  ds_read_b64_tr_b16 v[48:49], v2 offset:40960
  buffer_load_dwordx4 v30, s[44:47], s74 offen offset:1024 lds
  ds_read_b64_tr_b16 v[50:51], v2 offset:43520
  ds_read_b64_tr_b16 v[52:53], v7 offset:0
  ds_read_b64_tr_b16 v[54:55], v7 offset:2560
  ds_read_b64_tr_b16 v[56:57], v3 offset:40960
  buffer_load_dwordx4 v31, s[44:47], s74 offen offset:2048 lds
  ds_read_b64_tr_b16 v[58:59], v3 offset:43520
  ds_read_b64_tr_b16 v[60:61], v8 offset:0
  ds_read_b64_tr_b16 v[62:63], v8 offset:2560
  ds_read_b64_tr_b16 v[64:65], v4 offset:40960
  buffer_load_dwordx4 v32, s[44:47], s74 offen offset:3072 lds
  ds_read_b64_tr_b16 v[66:67], v4 offset:43520
  ds_read_b64_tr_b16 v[68:69], v9 offset:0
  ds_read_b64_tr_b16 v[70:71], v9 offset:2560
  ds_read_b128 v[80:83], v11 offset:0
  s_add_u32 m0, m0, 4096
  s_nop 0
  buffer_load_dwordx4 v33, s[44:47], s74 offen offset:0 lds
  s_add_u32 s74, s74, 212992
  ds_read_b128 v[84:87], v12 offset:0
  ds_read_b128 v[88:91], v11 offset:2048
  ds_read_b128 v[92:95], v12 offset:2048
  ds_read_b128 v[96:99], v11 offset:4096
  v_lshl_add_u32 v34, v241, 7, v15
  v_lshl_add_u32 v28, v25, 7, v14
  s_add_u32 m0, s76, 0
  s_nop 0
  buffer_load_dwordx4 v28, s[32:35], 0 offen lds
  ds_read_b128 v[100:103], v12 offset:4096
  ds_read_b128 v[104:107], v11 offset:6144
  ds_read_b128 v[108:111], v12 offset:6144
  ds_read_b64_tr_b16 v[72:73], v5 offset:40960
  s_add_u32 m0, m0, 1024
  s_nop 0
  buffer_load_dwordx4 v34, s[32:35], 0 offen lds
  ds_read_b64_tr_b16 v[74:75], v5 offset:43520
  ds_read_b64_tr_b16 v[76:77], v10 offset:0
  ds_read_b64_tr_b16 v[78:79], v10 offset:2560
  s_mov_b32 m0, 156288
  s_mov_b32 exec_hi, 0xff
  buffer_load_dwordx4 v37, s[52:55], s77 offen lds
  s_mov_b64 exec, -1
  s_waitcnt vmcnt(8) lgkmcnt(0)
  s_barrier
  s_setprio 0
  v_mfma_f32_16x16x32_bf16 v[140:143], v[40:43], v[80:83], v[140:143]
  v_mfma_f32_16x16x32_bf16 v[140:143], v[44:47], v[84:87], v[140:143]
  v_mfma_f32_16x16x32_bf16 v[144:147], v[40:43], v[88:91], v[144:147]
  v_mfma_f32_16x16x32_bf16 v[144:147], v[44:47], v[92:95], v[144:147]
  v_mfma_f32_16x16x32_bf16 v[148:151], v[40:43], v[96:99], v[148:151]
  v_mfma_f32_16x16x32_bf16 v[148:151], v[44:47], v[100:103], v[148:151]
  v_mfma_f32_16x16x32_bf16 v[152:155], v[40:43], v[104:107], v[152:155]
  v_mfma_f32_16x16x32_bf16 v[152:155], v[44:47], v[108:111], v[152:155]
  v_mfma_f32_16x16x32_bf16 v[168:171], v[48:51], v[104:107], v[168:171]
  v_mfma_f32_16x16x32_bf16 v[168:171], v[52:55], v[108:111], v[168:171]
  v_mfma_f32_16x16x32_bf16 v[164:167], v[48:51], v[96:99], v[164:167]
  v_mfma_f32_16x16x32_bf16 v[164:167], v[52:55], v[100:103], v[164:167]
  v_mfma_f32_16x16x32_bf16 v[160:163], v[48:51], v[88:91], v[160:163]
  v_mfma_f32_16x16x32_bf16 v[160:163], v[52:55], v[92:95], v[160:163]
  v_mfma_f32_16x16x32_bf16 v[156:159], v[48:51], v[80:83], v[156:159]
  v_mfma_f32_16x16x32_bf16 v[156:159], v[52:55], v[84:87], v[156:159]
  v_mfma_f32_16x16x32_bf16 v[172:175], v[56:59], v[80:83], v[172:175]
  v_mfma_f32_16x16x32_bf16 v[172:175], v[60:63], v[84:87], v[172:175]
  v_mfma_f32_16x16x32_bf16 v[176:179], v[56:59], v[88:91], v[176:179]
  v_mfma_f32_16x16x32_bf16 v[176:179], v[60:63], v[92:95], v[176:179]
  v_mfma_f32_16x16x32_bf16 v[180:183], v[56:59], v[96:99], v[180:183]
  v_mfma_f32_16x16x32_bf16 v[180:183], v[60:63], v[100:103], v[180:183]
  v_mfma_f32_16x16x32_bf16 v[184:187], v[56:59], v[104:107], v[184:187]
  v_mfma_f32_16x16x32_bf16 v[184:187], v[60:63], v[108:111], v[184:187]
  v_mfma_f32_16x16x32_bf16 v[200:203], v[64:67], v[104:107], v[200:203]
  v_mfma_f32_16x16x32_bf16 v[200:203], v[68:71], v[108:111], v[200:203]
  v_mfma_f32_16x16x32_bf16 v[196:199], v[64:67], v[96:99], v[196:199]
  v_mfma_f32_16x16x32_bf16 v[196:199], v[68:71], v[100:103], v[196:199]
  v_mfma_f32_16x16x32_bf16 v[192:195], v[64:67], v[88:91], v[192:195]
  v_mfma_f32_16x16x32_bf16 v[192:195], v[68:71], v[92:95], v[192:195]
  v_mfma_f32_16x16x32_bf16 v[188:191], v[64:67], v[80:83], v[188:191]
  v_mfma_f32_16x16x32_bf16 v[188:191], v[68:71], v[84:87], v[188:191]
  v_mfma_f32_16x16x32_bf16 v[204:207], v[72:75], v[80:83], v[204:207]
  v_mfma_f32_16x16x32_bf16 v[204:207], v[76:79], v[84:87], v[204:207]
  v_mfma_f32_16x16x32_bf16 v[208:211], v[72:75], v[88:91], v[208:211]
  v_mfma_f32_16x16x32_bf16 v[208:211], v[76:79], v[92:95], v[208:211]
  v_mfma_f32_16x16x32_bf16 v[212:215], v[72:75], v[96:99], v[212:215]
  v_mfma_f32_16x16x32_bf16 v[212:215], v[76:79], v[100:103], v[212:215]
  v_mfma_f32_16x16x32_bf16 v[216:219], v[72:75], v[104:107], v[216:219]
  s_setprio 2
  s_barrier
  v_mfma_f32_16x16x32_bf16 v[216:219], v[76:79], v[108:111], v[216:219]
  ds_read_b64_tr_b16 v[40:41], v6 offset:20480
  s_add_u32 m0, s75, 40960
  s_nop 0
  buffer_load_dwordx4 v29, s[44:47], s74 offen offset:0 lds
  ds_read_b64_tr_b16 v[42:43], v6 offset:23040
  ds_read_b64_tr_b16 v[44:45], v6 offset:40960
  ds_read_b64_tr_b16 v[46:47], v6 offset:43520
  ds_read_b64_tr_b16 v[48:49], v7 offset:20480
  buffer_load_dwordx4 v30, s[44:47], s74 offen offset:1024 lds
  ds_read_b64_tr_b16 v[50:51], v7 offset:23040
  ds_read_b64_tr_b16 v[52:53], v7 offset:40960
  ds_read_b64_tr_b16 v[54:55], v7 offset:43520
  ds_read_b64_tr_b16 v[56:57], v8 offset:20480
  buffer_load_dwordx4 v31, s[44:47], s74 offen offset:2048 lds
  ds_read_b64_tr_b16 v[58:59], v8 offset:23040
  ds_read_b64_tr_b16 v[60:61], v8 offset:40960
  ds_read_b64_tr_b16 v[62:63], v8 offset:43520
  ds_read_b64_tr_b16 v[64:65], v9 offset:20480
  buffer_load_dwordx4 v32, s[44:47], s74 offen offset:3072 lds
  ds_read_b64_tr_b16 v[66:67], v9 offset:23040
  ds_read_b64_tr_b16 v[68:69], v9 offset:40960
  ds_read_b64_tr_b16 v[70:71], v9 offset:43520
  ds_read_b128 v[80:83], v11 offset:8192
  s_add_u32 m0, m0, 4096
  s_nop 0
  buffer_load_dwordx4 v33, s[44:47], s74 offen offset:0 lds
  s_add_u32 s74, s74, 212992
  ds_read_b128 v[84:87], v12 offset:8192
  ds_read_b128 v[88:91], v11 offset:10240
  ds_read_b128 v[92:95], v12 offset:10240
  ds_read_b128 v[96:99], v11 offset:12288
  v_lshl_add_u32 v34, v242, 7, v15
  v_lshl_add_u32 v28, v26, 7, v14
  s_add_u32 m0, s76, 8192
  s_nop 0
  buffer_load_dwordx4 v28, s[32:35], 0 offen lds
  ds_read_b128 v[100:103], v12 offset:12288
  ds_read_b128 v[104:107], v11 offset:14336
  ds_read_b128 v[108:111], v12 offset:14336
  ds_read_b64_tr_b16 v[72:73], v10 offset:20480
  s_add_u32 m0, m0, 1024
  s_nop 0
  buffer_load_dwordx4 v34, s[32:35], 0 offen lds
  ds_read_b64_tr_b16 v[74:75], v10 offset:23040
  ds_read_b64_tr_b16 v[76:77], v10 offset:40960
  ds_read_b64_tr_b16 v[78:79], v10 offset:43520
  buffer_load_dwordx3 v[24:26], v13, s[28:31], s73 offen offset:0
  buffer_load_dwordx3 v[240:242], v13, s[28:31], s73 offen offset:832
  s_add_u32 s73, s73, 12
  s_waitcnt vmcnt(10) lgkmcnt(0)
  s_barrier
  s_setprio 0
  v_mfma_f32_16x16x32_bf16 v[140:143], v[40:43], v[80:83], v[140:143]
  s_add_u32 s72, s72, 1
  v_mfma_f32_16x16x32_bf16 v[140:143], v[44:47], v[84:87], v[140:143]
  v_mfma_f32_16x16x32_bf16 v[144:147], v[40:43], v[88:91], v[144:147]
  v_mfma_f32_16x16x32_bf16 v[144:147], v[44:47], v[92:95], v[144:147]
  v_mfma_f32_16x16x32_bf16 v[148:151], v[40:43], v[96:99], v[148:151]
  v_mfma_f32_16x16x32_bf16 v[148:151], v[44:47], v[100:103], v[148:151]
  v_mfma_f32_16x16x32_bf16 v[152:155], v[40:43], v[104:107], v[152:155]
  v_mfma_f32_16x16x32_bf16 v[152:155], v[44:47], v[108:111], v[152:155]
  v_mfma_f32_16x16x32_bf16 v[168:171], v[48:51], v[104:107], v[168:171]
  v_mfma_f32_16x16x32_bf16 v[168:171], v[52:55], v[108:111], v[168:171]
  v_mfma_f32_16x16x32_bf16 v[164:167], v[48:51], v[96:99], v[164:167]
  v_mfma_f32_16x16x32_bf16 v[164:167], v[52:55], v[100:103], v[164:167]
  v_mfma_f32_16x16x32_bf16 v[160:163], v[48:51], v[88:91], v[160:163]
  v_mfma_f32_16x16x32_bf16 v[160:163], v[52:55], v[92:95], v[160:163]
  v_mfma_f32_16x16x32_bf16 v[156:159], v[48:51], v[80:83], v[156:159]
  v_mfma_f32_16x16x32_bf16 v[156:159], v[52:55], v[84:87], v[156:159]
  v_mfma_f32_16x16x32_bf16 v[172:175], v[56:59], v[80:83], v[172:175]
  v_mfma_f32_16x16x32_bf16 v[172:175], v[60:63], v[84:87], v[172:175]
  v_mfma_f32_16x16x32_bf16 v[176:179], v[56:59], v[88:91], v[176:179]
  v_mfma_f32_16x16x32_bf16 v[176:179], v[60:63], v[92:95], v[176:179]
  s_cmp_lt_u32 s72, 4
  v_mfma_f32_16x16x32_bf16 v[180:183], v[56:59], v[96:99], v[180:183]
  v_mfma_f32_16x16x32_bf16 v[180:183], v[60:63], v[100:103], v[180:183]
  v_mfma_f32_16x16x32_bf16 v[184:187], v[56:59], v[104:107], v[184:187]
  v_mfma_f32_16x16x32_bf16 v[184:187], v[60:63], v[108:111], v[184:187]
  v_mfma_f32_16x16x32_bf16 v[200:203], v[64:67], v[104:107], v[200:203]
  v_mfma_f32_16x16x32_bf16 v[200:203], v[68:71], v[108:111], v[200:203]
  v_mfma_f32_16x16x32_bf16 v[196:199], v[64:67], v[96:99], v[196:199]
  v_mfma_f32_16x16x32_bf16 v[196:199], v[68:71], v[100:103], v[196:199]
  v_mfma_f32_16x16x32_bf16 v[192:195], v[64:67], v[88:91], v[192:195]
  v_mfma_f32_16x16x32_bf16 v[192:195], v[68:71], v[92:95], v[192:195]
  v_mfma_f32_16x16x32_bf16 v[188:191], v[64:67], v[80:83], v[188:191]
  v_mfma_f32_16x16x32_bf16 v[188:191], v[68:71], v[84:87], v[188:191]
  v_mfma_f32_16x16x32_bf16 v[204:207], v[72:75], v[80:83], v[204:207]
  v_mfma_f32_16x16x32_bf16 v[204:207], v[76:79], v[84:87], v[204:207]
  v_mfma_f32_16x16x32_bf16 v[208:211], v[72:75], v[88:91], v[208:211]
  v_mfma_f32_16x16x32_bf16 v[208:211], v[76:79], v[92:95], v[208:211]
  v_mfma_f32_16x16x32_bf16 v[212:215], v[72:75], v[96:99], v[212:215]
  v_mfma_f32_16x16x32_bf16 v[212:215], v[76:79], v[100:103], v[212:215]
  v_mfma_f32_16x16x32_bf16 v[216:219], v[72:75], v[104:107], v[216:219]
  s_setprio 2
  s_barrier
  v_mfma_f32_16x16x32_bf16 v[216:219], v[76:79], v[108:111], v[216:219]
  s_cbranch_scc1 L_dnn_loop1
  ds_read_b64_tr_b16 v[40:41], v1 offset:0
  ds_read_b64_tr_b16 v[42:43], v1 offset:2560
  ds_read_b64_tr_b16 v[44:45], v1 offset:20480
  ds_read_b64_tr_b16 v[46:47], v1 offset:23040
  ds_read_b64_tr_b16 v[48:49], v2 offset:0
  ds_read_b64_tr_b16 v[50:51], v2 offset:2560
  ds_read_b64_tr_b16 v[52:53], v2 offset:20480
  ds_read_b64_tr_b16 v[54:55], v2 offset:23040
  ds_read_b64_tr_b16 v[56:57], v3 offset:0
  ds_read_b64_tr_b16 v[58:59], v3 offset:2560
  ds_read_b64_tr_b16 v[60:61], v3 offset:20480
  ds_read_b64_tr_b16 v[62:63], v3 offset:23040
  ds_read_b64_tr_b16 v[64:65], v4 offset:0
  ds_read_b64_tr_b16 v[66:67], v4 offset:2560
  ds_read_b64_tr_b16 v[68:69], v4 offset:20480
  ds_read_b64_tr_b16 v[70:71], v4 offset:23040
  ds_read_b128 v[80:83], v11 offset:0
  ds_read_b128 v[84:87], v12 offset:0
  ds_read_b128 v[88:91], v11 offset:2048
  ds_read_b128 v[92:95], v12 offset:2048
  ds_read_b128 v[96:99], v11 offset:4096
  ds_read_b128 v[100:103], v12 offset:4096
  ds_read_b128 v[104:107], v11 offset:6144
  ds_read_b128 v[108:111], v12 offset:6144
  ds_read_b64_tr_b16 v[72:73], v5 offset:0
  ds_read_b64_tr_b16 v[74:75], v5 offset:2560
  ds_read_b64_tr_b16 v[76:77], v5 offset:20480
  ds_read_b64_tr_b16 v[78:79], v5 offset:23040
  ds_read_b64 v[220:221], v35 offset:640
  ds_read_b64 v[222:223], v35 offset:672
  ds_read_b64 v[224:225], v35 offset:704
  ds_read_b64 v[226:227], v35 offset:736
  ds_read_b64 v[228:229], v35 offset:768
  s_waitcnt vmcnt(2) lgkmcnt(0)
  s_barrier
  s_setprio 0
  v_mfma_f32_16x16x32_bf16 v[140:143], v[40:43], v[80:83], v[140:143]
  v_mov_b32 v232, 0xc0135761
  v_mov_b32 v233, 0xc0135761
  v_mfma_f32_16x16x32_bf16 v[140:143], v[44:47], v[84:87], v[140:143]
  v_mov_b32 v234, 0xbdd2d3e8
  v_mfma_f32_16x16x32_bf16 v[144:147], v[40:43], v[88:91], v[144:147]
  v_mov_b32 v235, 0xbdd2d3e8
  v_mfma_f32_16x16x32_bf16 v[144:147], v[44:47], v[92:95], v[144:147]
  v_mov_b32 v236, 0x71800000
  v_mfma_f32_16x16x32_bf16 v[148:151], v[40:43], v[96:99], v[148:151]
  v_lshlrev_b32 v112, 16, v220
  v_mfma_f32_16x16x32_bf16 v[148:151], v[44:47], v[100:103], v[148:151]
  v_and_b32 v113, 0xffff0000, v220
  v_mfma_f32_16x16x32_bf16 v[152:155], v[40:43], v[104:107], v[152:155]
  v_lshlrev_b32 v114, 16, v221
  v_mfma_f32_16x16x32_bf16 v[152:155], v[44:47], v[108:111], v[152:155]
  v_and_b32 v115, 0xffff0000, v221
  v_mfma_f32_16x16x32_bf16 v[168:171], v[48:51], v[104:107], v[168:171]
  v_lshlrev_b32 v116, 16, v222
  v_mfma_f32_16x16x32_bf16 v[168:171], v[52:55], v[108:111], v[168:171]
  v_and_b32 v117, 0xffff0000, v222
  v_mfma_f32_16x16x32_bf16 v[164:167], v[48:51], v[96:99], v[164:167]
  v_lshlrev_b32 v118, 16, v223
  v_mfma_f32_16x16x32_bf16 v[164:167], v[52:55], v[100:103], v[164:167]
  v_and_b32 v119, 0xffff0000, v223
  v_mfma_f32_16x16x32_bf16 v[160:163], v[48:51], v[88:91], v[160:163]
  v_lshlrev_b32 v120, 16, v224
  v_mfma_f32_16x16x32_bf16 v[160:163], v[52:55], v[92:95], v[160:163]
  v_and_b32 v121, 0xffff0000, v224
  v_mfma_f32_16x16x32_bf16 v[156:159], v[48:51], v[80:83], v[156:159]
  v_lshlrev_b32 v122, 16, v225
  v_mfma_f32_16x16x32_bf16 v[156:159], v[52:55], v[84:87], v[156:159]
  v_and_b32 v123, 0xffff0000, v225
  v_mfma_f32_16x16x32_bf16 v[172:175], v[56:59], v[80:83], v[172:175]
  v_lshlrev_b32 v124, 16, v226
  v_mfma_f32_16x16x32_bf16 v[172:175], v[60:63], v[84:87], v[172:175]
  v_and_b32 v125, 0xffff0000, v226
  v_mfma_f32_16x16x32_bf16 v[176:179], v[56:59], v[88:91], v[176:179]
  v_lshlrev_b32 v126, 16, v227
  v_mfma_f32_16x16x32_bf16 v[176:179], v[60:63], v[92:95], v[176:179]
  v_and_b32 v127, 0xffff0000, v227
  v_mfma_f32_16x16x32_bf16 v[180:183], v[56:59], v[96:99], v[180:183]
  v_lshlrev_b32 v128, 16, v228
  v_mfma_f32_16x16x32_bf16 v[180:183], v[60:63], v[100:103], v[180:183]
  v_and_b32 v129, 0xffff0000, v228
  v_mfma_f32_16x16x32_bf16 v[184:187], v[56:59], v[104:107], v[184:187]
  v_lshlrev_b32 v130, 16, v229
  v_mfma_f32_16x16x32_bf16 v[184:187], v[60:63], v[108:111], v[184:187]
  v_and_b32 v131, 0xffff0000, v229
  v_mfma_f32_16x16x32_bf16 v[200:203], v[64:67], v[104:107], v[200:203]
  v_rcp_f32 v112, v112
  v_mfma_f32_16x16x32_bf16 v[200:203], v[68:71], v[108:111], v[200:203]
  v_rcp_f32 v113, v113
  v_mfma_f32_16x16x32_bf16 v[196:199], v[64:67], v[96:99], v[196:199]
  v_rcp_f32 v114, v114
  v_mfma_f32_16x16x32_bf16 v[196:199], v[68:71], v[100:103], v[196:199]
  v_rcp_f32 v115, v115
  v_mfma_f32_16x16x32_bf16 v[192:195], v[64:67], v[88:91], v[192:195]
  v_rcp_f32 v116, v116
  v_mfma_f32_16x16x32_bf16 v[192:195], v[68:71], v[92:95], v[192:195]
  v_rcp_f32 v117, v117
  v_mfma_f32_16x16x32_bf16 v[188:191], v[64:67], v[80:83], v[188:191]
  v_rcp_f32 v118, v118
  v_mfma_f32_16x16x32_bf16 v[188:191], v[68:71], v[84:87], v[188:191]
  v_rcp_f32 v119, v119
  v_mfma_f32_16x16x32_bf16 v[204:207], v[72:75], v[80:83], v[204:207]
  v_rcp_f32 v120, v120
  v_mfma_f32_16x16x32_bf16 v[204:207], v[76:79], v[84:87], v[204:207]
  v_rcp_f32 v121, v121
  v_mfma_f32_16x16x32_bf16 v[208:211], v[72:75], v[88:91], v[208:211]
  v_rcp_f32 v122, v122
  v_mfma_f32_16x16x32_bf16 v[208:211], v[76:79], v[92:95], v[208:211]
  v_rcp_f32 v123, v123
  v_mfma_f32_16x16x32_bf16 v[212:215], v[72:75], v[96:99], v[212:215]
  v_rcp_f32 v124, v124
  v_mfma_f32_16x16x32_bf16 v[212:215], v[76:79], v[100:103], v[212:215]
  v_rcp_f32 v125, v125
  v_mfma_f32_16x16x32_bf16 v[216:219], v[72:75], v[104:107], v[216:219]
  s_setprio 2
  s_barrier
  v_mfma_f32_16x16x32_bf16 v[216:219], v[76:79], v[108:111], v[216:219]
  ds_read_b64_tr_b16 v[40:41], v1 offset:40960
  ds_read_b64_tr_b16 v[42:43], v1 offset:43520
  ds_read_b64_tr_b16 v[44:45], v6 offset:0
  ds_read_b64_tr_b16 v[46:47], v6 offset:2560
  ds_read_b64_tr_b16 v[48:49], v2 offset:40960
  ds_read_b64_tr_b16 v[50:51], v2 offset:43520
  ds_read_b64_tr_b16 v[52:53], v7 offset:0
  ds_read_b64_tr_b16 v[54:55], v7 offset:2560
  ds_read_b64_tr_b16 v[56:57], v3 offset:40960
  ds_read_b64_tr_b16 v[58:59], v3 offset:43520
  ds_read_b64_tr_b16 v[60:61], v8 offset:0
  ds_read_b64_tr_b16 v[62:63], v8 offset:2560
  ds_read_b64_tr_b16 v[64:65], v4 offset:40960
  ds_read_b64_tr_b16 v[66:67], v4 offset:43520
  ds_read_b64_tr_b16 v[68:69], v9 offset:0
  ds_read_b64_tr_b16 v[70:71], v9 offset:2560
  ds_read_b128 v[80:83], v11 offset:8192
  ds_read_b128 v[84:87], v12 offset:8192
  ds_read_b128 v[88:91], v11 offset:10240
  ds_read_b128 v[92:95], v12 offset:10240
  ds_read_b128 v[96:99], v11 offset:12288
  ds_read_b128 v[100:103], v12 offset:12288
  ds_read_b128 v[104:107], v11 offset:14336
  ds_read_b128 v[108:111], v12 offset:14336
  ds_read_b64_tr_b16 v[72:73], v5 offset:40960
  ds_read_b64_tr_b16 v[74:75], v5 offset:43520
  ds_read_b64_tr_b16 v[76:77], v10 offset:0
  ds_read_b64_tr_b16 v[78:79], v10 offset:2560
  s_waitcnt lgkmcnt(0)
  s_barrier
  v_mfma_f32_16x16x32_bf16 v[140:143], v[40:43], v[80:83], v[140:143]
  v_rcp_f32 v126, v126
  v_mfma_f32_16x16x32_bf16 v[140:143], v[44:47], v[84:87], v[140:143]
  v_rcp_f32 v127, v127
  v_mfma_f32_16x16x32_bf16 v[144:147], v[40:43], v[88:91], v[144:147]
  v_rcp_f32 v128, v128
  v_mfma_f32_16x16x32_bf16 v[144:147], v[44:47], v[92:95], v[144:147]
  v_mfma_f32_16x16x32_bf16 v[148:151], v[40:43], v[96:99], v[148:151]
  v_rcp_f32 v129, v129
  v_mfma_f32_16x16x32_bf16 v[148:151], v[44:47], v[100:103], v[148:151]
  v_rcp_f32 v130, v130
  v_mfma_f32_16x16x32_bf16 v[152:155], v[40:43], v[104:107], v[152:155]
  v_mfma_f32_16x16x32_bf16 v[152:155], v[44:47], v[108:111], v[152:155]
  v_rcp_f32 v131, v131
  v_mfma_f32_16x16x32_bf16 v[168:171], v[48:51], v[104:107], v[168:171]
  v_med3_f32 v112, v112, -v236, v236
  v_mfma_f32_16x16x32_bf16 v[168:171], v[52:55], v[108:111], v[168:171]
  v_mfma_f32_16x16x32_bf16 v[164:167], v[48:51], v[96:99], v[164:167]
  v_med3_f32 v113, v113, -v236, v236
  v_mfma_f32_16x16x32_bf16 v[164:167], v[52:55], v[100:103], v[164:167]
  v_med3_f32 v114, v114, -v236, v236
  v_mfma_f32_16x16x32_bf16 v[160:163], v[48:51], v[88:91], v[160:163]
  v_mfma_f32_16x16x32_bf16 v[160:163], v[52:55], v[92:95], v[160:163]
  v_med3_f32 v115, v115, -v236, v236
  v_mfma_f32_16x16x32_bf16 v[156:159], v[48:51], v[80:83], v[156:159]
  v_med3_f32 v116, v116, -v236, v236
  v_mfma_f32_16x16x32_bf16 v[156:159], v[52:55], v[84:87], v[156:159]
  v_mfma_f32_16x16x32_bf16 v[172:175], v[56:59], v[80:83], v[172:175]
  v_med3_f32 v117, v117, -v236, v236
  v_mfma_f32_16x16x32_bf16 v[172:175], v[60:63], v[84:87], v[172:175]
  v_med3_f32 v118, v118, -v236, v236
  v_mfma_f32_16x16x32_bf16 v[176:179], v[56:59], v[88:91], v[176:179]
  v_mfma_f32_16x16x32_bf16 v[176:179], v[60:63], v[92:95], v[176:179]
  v_med3_f32 v119, v119, -v236, v236
  v_mfma_f32_16x16x32_bf16 v[180:183], v[56:59], v[96:99], v[180:183]
  v_med3_f32 v120, v120, -v236, v236
  v_mfma_f32_16x16x32_bf16 v[180:183], v[60:63], v[100:103], v[180:183]
  v_med3_f32 v121, v121, -v236, v236
  v_mfma_f32_16x16x32_bf16 v[184:187], v[56:59], v[104:107], v[184:187]
  v_mfma_f32_16x16x32_bf16 v[184:187], v[60:63], v[108:111], v[184:187]
  v_med3_f32 v122, v122, -v236, v236
  v_mfma_f32_16x16x32_bf16 v[200:203], v[64:67], v[104:107], v[200:203]
  v_med3_f32 v123, v123, -v236, v236
  v_mfma_f32_16x16x32_bf16 v[200:203], v[68:71], v[108:111], v[200:203]
  v_mfma_f32_16x16x32_bf16 v[196:199], v[64:67], v[96:99], v[196:199]
  v_med3_f32 v124, v124, -v236, v236
  v_mfma_f32_16x16x32_bf16 v[196:199], v[68:71], v[100:103], v[196:199]
  v_med3_f32 v125, v125, -v236, v236
  v_mfma_f32_16x16x32_bf16 v[192:195], v[64:67], v[88:91], v[192:195]
  v_mfma_f32_16x16x32_bf16 v[192:195], v[68:71], v[92:95], v[192:195]
  v_med3_f32 v126, v126, -v236, v236
  v_mfma_f32_16x16x32_bf16 v[188:191], v[64:67], v[80:83], v[188:191]
  v_med3_f32 v127, v127, -v236, v236
  v_mfma_f32_16x16x32_bf16 v[188:191], v[68:71], v[84:87], v[188:191]
  v_mfma_f32_16x16x32_bf16 v[204:207], v[72:75], v[80:83], v[204:207]
  v_med3_f32 v128, v128, -v236, v236
  v_mfma_f32_16x16x32_bf16 v[204:207], v[76:79], v[84:87], v[204:207]
  v_med3_f32 v129, v129, -v236, v236
  v_mfma_f32_16x16x32_bf16 v[208:211], v[72:75], v[88:91], v[208:211]
  v_mfma_f32_16x16x32_bf16 v[208:211], v[76:79], v[92:95], v[208:211]
  v_med3_f32 v130, v130, -v236, v236
  v_mfma_f32_16x16x32_bf16 v[212:215], v[72:75], v[96:99], v[212:215]
  v_med3_f32 v131, v131, -v236, v236
  v_mfma_f32_16x16x32_bf16 v[212:215], v[76:79], v[100:103], v[212:215]
  v_mfma_f32_16x16x32_bf16 v[216:219], v[72:75], v[104:107], v[216:219]
  v_mfma_f32_16x16x32_bf16 v[216:219], v[76:79], v[108:111], v[216:219]
  s_setprio 0
  s_nop 0
L_epi:
  s_lshl_b32 s69, s27, 11
  s_and_b32 s71, s26, 3
  s_lshl_b32 s71, s71, 9
  s_add_u32 s69, s69, s71
  s_lshr_b32 s68, s26, 2
  s_lshl_b32 s68, s68, 14
  s_add_u32 s69, s69, s68
  v_lshlrev_b32 v3, 3, v0
  v_add_u32 v2, 156928, v3
  v_pk_mul_f32 v[40:41], v[140:141], v[140:141]
  v_pk_mul_f32 v[44:45], v[144:145], v[144:145]
  v_pk_mul_f32 v[48:49], v[148:149], v[148:149]
  v_pk_mul_f32 v[52:53], v[152:153], v[152:153]
  v_pk_fma_f32 v[40:41], v[40:41], v[234:235], v[232:233]
  v_pk_fma_f32 v[44:45], v[44:45], v[234:235], v[232:233]
  v_pk_fma_f32 v[48:49], v[48:49], v[234:235], v[232:233]
  v_pk_fma_f32 v[52:53], v[52:53], v[234:235], v[232:233]
  v_pk_mul_f32 v[40:41], v[40:41], v[140:141]
  v_pk_mul_f32 v[44:45], v[44:45], v[144:145]
  v_pk_mul_f32 v[48:49], v[48:49], v[148:149]
  v_pk_mul_f32 v[52:53], v[52:53], v[152:153]
  v_exp_f32 v40, v40
  v_exp_f32 v41, v41
  v_exp_f32 v44, v44
  v_exp_f32 v45, v45
  v_exp_f32 v48, v48
  v_exp_f32 v49, v49
  v_exp_f32 v52, v52
  v_exp_f32 v53, v53
  v_pk_fma_f32 v[40:41], v[40:41], v[112:113], v[112:113]
  v_pk_fma_f32 v[44:45], v[44:45], v[112:113], v[112:113]
  v_pk_fma_f32 v[48:49], v[48:49], v[112:113], v[112:113]
  v_pk_fma_f32 v[52:53], v[52:53], v[112:113], v[112:113]
  v_rcp_f32 v40, v40
  v_rcp_f32 v41, v41
  v_rcp_f32 v44, v44
  v_rcp_f32 v45, v45
  v_rcp_f32 v48, v48
  v_rcp_f32 v49, v49
  v_rcp_f32 v52, v52
  v_rcp_f32 v53, v53
  v_pk_mul_f32 v[16:17], v[40:41], v[140:141]
  v_pk_mul_f32 v[18:19], v[44:45], v[144:145]
  v_pk_mul_f32 v[20:21], v[48:49], v[148:149]
  v_pk_mul_f32 v[22:23], v[52:53], v[152:153]
  v_pk_mul_f32 v[56:57], v[142:143], v[142:143]
  v_pk_mul_f32 v[60:61], v[146:147], v[146:147]
  v_pk_mul_f32 v[64:65], v[150:151], v[150:151]
  v_pk_mul_f32 v[68:69], v[154:155], v[154:155]
  v_pk_fma_f32 v[56:57], v[56:57], v[234:235], v[232:233]
  v_pk_fma_f32 v[60:61], v[60:61], v[234:235], v[232:233]
  v_pk_fma_f32 v[64:65], v[64:65], v[234:235], v[232:233]
  v_pk_fma_f32 v[68:69], v[68:69], v[234:235], v[232:233]
  v_pk_mul_f32 v[56:57], v[56:57], v[142:143]
  v_pk_mul_f32 v[60:61], v[60:61], v[146:147]
  v_pk_mul_f32 v[64:65], v[64:65], v[150:151]
  v_pk_mul_f32 v[68:69], v[68:69], v[154:155]
  v_exp_f32 v56, v56
  v_exp_f32 v57, v57
  v_exp_f32 v60, v60
  v_exp_f32 v61, v61
  v_exp_f32 v64, v64
  v_exp_f32 v65, v65
  v_exp_f32 v68, v68
  v_exp_f32 v69, v69
  v_pk_fma_f32 v[56:57], v[56:57], v[114:115], v[114:115]
  v_pk_fma_f32 v[60:61], v[60:61], v[114:115], v[114:115]
  v_pk_fma_f32 v[64:65], v[64:65], v[114:115], v[114:115]
  v_pk_fma_f32 v[68:69], v[68:69], v[114:115], v[114:115]
  v_rcp_f32 v56, v56
  v_rcp_f32 v57, v57
  v_rcp_f32 v60, v60
  v_rcp_f32 v61, v61
  v_rcp_f32 v64, v64
  v_rcp_f32 v65, v65
  v_rcp_f32 v68, v68
  v_rcp_f32 v69, v69
  v_pk_fma_f32 v[16:17], v[56:57], v[142:143], v[16:17]
  v_pk_fma_f32 v[18:19], v[60:61], v[146:147], v[18:19]
  v_pk_fma_f32 v[20:21], v[64:65], v[150:151], v[20:21]
  v_pk_fma_f32 v[22:23], v[68:69], v[154:155], v[22:23]
  v_pk_mul_f32 v[40:41], v[156:157], v[156:157]
  v_pk_mul_f32 v[44:45], v[160:161], v[160:161]
  v_pk_mul_f32 v[48:49], v[164:165], v[164:165]
  v_pk_mul_f32 v[52:53], v[168:169], v[168:169]
  v_pk_fma_f32 v[40:41], v[40:41], v[234:235], v[232:233]
  v_pk_fma_f32 v[44:45], v[44:45], v[234:235], v[232:233]
  v_pk_fma_f32 v[48:49], v[48:49], v[234:235], v[232:233]
  v_pk_fma_f32 v[52:53], v[52:53], v[234:235], v[232:233]
  v_pk_mul_f32 v[40:41], v[40:41], v[156:157]
  v_pk_mul_f32 v[44:45], v[44:45], v[160:161]
  v_pk_mul_f32 v[48:49], v[48:49], v[164:165]
  v_pk_mul_f32 v[52:53], v[52:53], v[168:169]
  v_exp_f32 v40, v40
  v_exp_f32 v41, v41
  v_exp_f32 v44, v44
  v_exp_f32 v45, v45
  v_exp_f32 v48, v48
  v_exp_f32 v49, v49
  v_exp_f32 v52, v52
  v_exp_f32 v53, v53
  v_pk_fma_f32 v[40:41], v[40:41], v[116:117], v[116:117]
  v_pk_fma_f32 v[44:45], v[44:45], v[116:117], v[116:117]
  v_pk_fma_f32 v[48:49], v[48:49], v[116:117], v[116:117]
  v_pk_fma_f32 v[52:53], v[52:53], v[116:117], v[116:117]
  v_rcp_f32 v40, v40
  v_rcp_f32 v41, v41
  v_rcp_f32 v44, v44
  v_rcp_f32 v45, v45
  v_rcp_f32 v48, v48
  v_rcp_f32 v49, v49
  v_rcp_f32 v52, v52
  v_rcp_f32 v53, v53
  v_pk_fma_f32 v[16:17], v[40:41], v[156:157], v[16:17]
  v_pk_fma_f32 v[18:19], v[44:45], v[160:161], v[18:19]
  v_pk_fma_f32 v[20:21], v[48:49], v[164:165], v[20:21]
  v_pk_fma_f32 v[22:23], v[52:53], v[168:169], v[22:23]
  v_pk_mul_f32 v[56:57], v[158:159], v[158:159]
  v_pk_mul_f32 v[60:61], v[162:163], v[162:163]
  v_pk_mul_f32 v[64:65], v[166:167], v[166:167]
  v_pk_mul_f32 v[68:69], v[170:171], v[170:171]
  v_pk_fma_f32 v[56:57], v[56:57], v[234:235], v[232:233]
  v_pk_fma_f32 v[60:61], v[60:61], v[234:235], v[232:233]
  v_pk_fma_f32 v[64:65], v[64:65], v[234:235], v[232:233]
  v_pk_fma_f32 v[68:69], v[68:69], v[234:235], v[232:233]
  v_pk_mul_f32 v[56:57], v[56:57], v[158:159]
  v_pk_mul_f32 v[60:61], v[60:61], v[162:163]
  v_pk_mul_f32 v[64:65], v[64:65], v[166:167]
  v_pk_mul_f32 v[68:69], v[68:69], v[170:171]
  v_exp_f32 v56, v56
  v_exp_f32 v57, v57
  v_exp_f32 v60, v60
  v_exp_f32 v61, v61
  v_exp_f32 v64, v64
  v_exp_f32 v65, v65
  v_exp_f32 v68, v68
  v_exp_f32 v69, v69
  v_pk_fma_f32 v[56:57], v[56:57], v[118:119], v[118:119]
  v_pk_fma_f32 v[60:61], v[60:61], v[118:119], v[118:119]
  v_pk_fma_f32 v[64:65], v[64:65], v[118:119], v[118:119]
  v_pk_fma_f32 v[68:69], v[68:69], v[118:119], v[118:119]
  v_rcp_f32 v56, v56
  v_rcp_f32 v57, v57
  v_rcp_f32 v60, v60
  v_rcp_f32 v61, v61
  v_rcp_f32 v64, v64
  v_rcp_f32 v65, v65
  v_rcp_f32 v68, v68
  v_rcp_f32 v69, v69
  v_pk_fma_f32 v[16:17], v[56:57], v[158:159], v[16:17]
  v_pk_fma_f32 v[18:19], v[60:61], v[162:163], v[18:19]
  v_pk_fma_f32 v[20:21], v[64:65], v[166:167], v[20:21]
  v_pk_fma_f32 v[22:23], v[68:69], v[170:171], v[22:23]
  v_pk_mul_f32 v[40:41], v[172:173], v[172:173]
  v_pk_mul_f32 v[44:45], v[176:177], v[176:177]
  v_pk_mul_f32 v[48:49], v[180:181], v[180:181]
  v_pk_mul_f32 v[52:53], v[184:185], v[184:185]
  v_pk_fma_f32 v[40:41], v[40:41], v[234:235], v[232:233]
  v_pk_fma_f32 v[44:45], v[44:45], v[234:235], v[232:233]
  v_pk_fma_f32 v[48:49], v[48:49], v[234:235], v[232:233]
  v_pk_fma_f32 v[52:53], v[52:53], v[234:235], v[232:233]
  v_pk_mul_f32 v[40:41], v[40:41], v[172:173]
  v_pk_mul_f32 v[44:45], v[44:45], v[176:177]
  v_pk_mul_f32 v[48:49], v[48:49], v[180:181]
  v_pk_mul_f32 v[52:53], v[52:53], v[184:185]
  v_exp_f32 v40, v40
  v_exp_f32 v41, v41
  v_exp_f32 v44, v44
  v_exp_f32 v45, v45
  v_exp_f32 v48, v48
  v_exp_f32 v49, v49
  v_exp_f32 v52, v52
  v_exp_f32 v53, v53
  v_pk_fma_f32 v[40:41], v[40:41], v[120:121], v[120:121]
  v_pk_fma_f32 v[44:45], v[44:45], v[120:121], v[120:121]
  v_pk_fma_f32 v[48:49], v[48:49], v[120:121], v[120:121]
  v_pk_fma_f32 v[52:53], v[52:53], v[120:121], v[120:121]
  v_rcp_f32 v40, v40
  v_rcp_f32 v41, v41
  v_rcp_f32 v44, v44
  v_rcp_f32 v45, v45
  v_rcp_f32 v48, v48
  v_rcp_f32 v49, v49
  v_rcp_f32 v52, v52
  v_rcp_f32 v53, v53
  v_pk_fma_f32 v[16:17], v[40:41], v[172:173], v[16:17]
  v_pk_fma_f32 v[18:19], v[44:45], v[176:177], v[18:19]
  v_pk_fma_f32 v[20:21], v[48:49], v[180:181], v[20:21]
  v_pk_fma_f32 v[22:23], v[52:53], v[184:185], v[22:23]
  v_pk_mul_f32 v[56:57], v[174:175], v[174:175]
  v_pk_mul_f32 v[60:61], v[178:179], v[178:179]
  v_pk_mul_f32 v[64:65], v[182:183], v[182:183]
  v_pk_mul_f32 v[68:69], v[186:187], v[186:187]
  v_pk_fma_f32 v[56:57], v[56:57], v[234:235], v[232:233]
  v_pk_fma_f32 v[60:61], v[60:61], v[234:235], v[232:233]
  v_pk_fma_f32 v[64:65], v[64:65], v[234:235], v[232:233]
  v_pk_fma_f32 v[68:69], v[68:69], v[234:235], v[232:233]
  v_pk_mul_f32 v[56:57], v[56:57], v[174:175]
  v_pk_mul_f32 v[60:61], v[60:61], v[178:179]
  v_pk_mul_f32 v[64:65], v[64:65], v[182:183]
  v_pk_mul_f32 v[68:69], v[68:69], v[186:187]
  v_exp_f32 v56, v56
  v_exp_f32 v57, v57
  v_exp_f32 v60, v60
  v_exp_f32 v61, v61
  v_exp_f32 v64, v64
  v_exp_f32 v65, v65
  v_exp_f32 v68, v68
  v_exp_f32 v69, v69
  v_pk_fma_f32 v[56:57], v[56:57], v[122:123], v[122:123]
  v_pk_fma_f32 v[60:61], v[60:61], v[122:123], v[122:123]
  v_pk_fma_f32 v[64:65], v[64:65], v[122:123], v[122:123]
  v_pk_fma_f32 v[68:69], v[68:69], v[122:123], v[122:123]
  v_rcp_f32 v56, v56
  v_rcp_f32 v57, v57
  v_rcp_f32 v60, v60
  v_rcp_f32 v61, v61
  v_rcp_f32 v64, v64
  v_rcp_f32 v65, v65
  v_rcp_f32 v68, v68
  v_rcp_f32 v69, v69
  v_pk_fma_f32 v[16:17], v[56:57], v[174:175], v[16:17]
  v_pk_fma_f32 v[18:19], v[60:61], v[178:179], v[18:19]
  v_pk_fma_f32 v[20:21], v[64:65], v[182:183], v[20:21]
  v_pk_fma_f32 v[22:23], v[68:69], v[186:187], v[22:23]
  v_pk_mul_f32 v[40:41], v[188:189], v[188:189]
  v_pk_mul_f32 v[44:45], v[192:193], v[192:193]
  v_pk_mul_f32 v[48:49], v[196:197], v[196:197]
  v_pk_mul_f32 v[52:53], v[200:201], v[200:201]
  v_pk_fma_f32 v[40:41], v[40:41], v[234:235], v[232:233]
  v_pk_fma_f32 v[44:45], v[44:45], v[234:235], v[232:233]
  v_pk_fma_f32 v[48:49], v[48:49], v[234:235], v[232:233]
  v_pk_fma_f32 v[52:53], v[52:53], v[234:235], v[232:233]
  v_pk_mul_f32 v[40:41], v[40:41], v[188:189]
  v_pk_mul_f32 v[44:45], v[44:45], v[192:193]
  v_pk_mul_f32 v[48:49], v[48:49], v[196:197]
  v_pk_mul_f32 v[52:53], v[52:53], v[200:201]
  v_exp_f32 v40, v40
  v_exp_f32 v41, v41
  v_exp_f32 v44, v44
  v_exp_f32 v45, v45
  v_exp_f32 v48, v48
  v_exp_f32 v49, v49
  v_exp_f32 v52, v52
  v_exp_f32 v53, v53
  v_pk_fma_f32 v[40:41], v[40:41], v[124:125], v[124:125]
  v_pk_fma_f32 v[44:45], v[44:45], v[124:125], v[124:125]
  v_pk_fma_f32 v[48:49], v[48:49], v[124:125], v[124:125]
  v_pk_fma_f32 v[52:53], v[52:53], v[124:125], v[124:125]
  v_rcp_f32 v40, v40
  v_rcp_f32 v41, v41
  v_rcp_f32 v44, v44
  v_rcp_f32 v45, v45
  v_rcp_f32 v48, v48
  v_rcp_f32 v49, v49
  v_rcp_f32 v52, v52
  v_rcp_f32 v53, v53
  v_pk_fma_f32 v[16:17], v[40:41], v[188:189], v[16:17]
  v_pk_fma_f32 v[18:19], v[44:45], v[192:193], v[18:19]
  v_pk_fma_f32 v[20:21], v[48:49], v[196:197], v[20:21]
  v_pk_fma_f32 v[22:23], v[52:53], v[200:201], v[22:23]
  v_pk_mul_f32 v[56:57], v[190:191], v[190:191]
  v_pk_mul_f32 v[60:61], v[194:195], v[194:195]
  v_pk_mul_f32 v[64:65], v[198:199], v[198:199]
  v_pk_mul_f32 v[68:69], v[202:203], v[202:203]
  v_pk_fma_f32 v[56:57], v[56:57], v[234:235], v[232:233]
  v_pk_fma_f32 v[60:61], v[60:61], v[234:235], v[232:233]
  v_pk_fma_f32 v[64:65], v[64:65], v[234:235], v[232:233]
  v_pk_fma_f32 v[68:69], v[68:69], v[234:235], v[232:233]
  v_pk_mul_f32 v[56:57], v[56:57], v[190:191]
  v_pk_mul_f32 v[60:61], v[60:61], v[194:195]
  v_pk_mul_f32 v[64:65], v[64:65], v[198:199]
  v_pk_mul_f32 v[68:69], v[68:69], v[202:203]
  v_exp_f32 v56, v56
  v_exp_f32 v57, v57
  v_exp_f32 v60, v60
  v_exp_f32 v61, v61
  v_exp_f32 v64, v64
  v_exp_f32 v65, v65
  v_exp_f32 v68, v68
  v_exp_f32 v69, v69
  v_pk_fma_f32 v[56:57], v[56:57], v[126:127], v[126:127]
  v_pk_fma_f32 v[60:61], v[60:61], v[126:127], v[126:127]
  v_pk_fma_f32 v[64:65], v[64:65], v[126:127], v[126:127]
  v_pk_fma_f32 v[68:69], v[68:69], v[126:127], v[126:127]
  v_rcp_f32 v56, v56
  v_rcp_f32 v57, v57
  v_rcp_f32 v60, v60
  v_rcp_f32 v61, v61
  v_rcp_f32 v64, v64
  v_rcp_f32 v65, v65
  v_rcp_f32 v68, v68
  v_rcp_f32 v69, v69
  v_pk_fma_f32 v[16:17], v[56:57], v[190:191], v[16:17]
  v_pk_fma_f32 v[18:19], v[60:61], v[194:195], v[18:19]
  v_pk_fma_f32 v[20:21], v[64:65], v[198:199], v[20:21]
  v_pk_fma_f32 v[22:23], v[68:69], v[202:203], v[22:23]
  v_pk_mul_f32 v[40:41], v[204:205], v[204:205]
  v_pk_mul_f32 v[44:45], v[208:209], v[208:209]
  v_pk_mul_f32 v[48:49], v[212:213], v[212:213]
  v_pk_mul_f32 v[52:53], v[216:217], v[216:217]
  v_pk_fma_f32 v[40:41], v[40:41], v[234:235], v[232:233]
  v_pk_fma_f32 v[44:45], v[44:45], v[234:235], v[232:233]
  v_pk_fma_f32 v[48:49], v[48:49], v[234:235], v[232:233]
  v_pk_fma_f32 v[52:53], v[52:53], v[234:235], v[232:233]
  v_pk_mul_f32 v[40:41], v[40:41], v[204:205]
  v_pk_mul_f32 v[44:45], v[44:45], v[208:209]
  v_pk_mul_f32 v[48:49], v[48:49], v[212:213]
  v_pk_mul_f32 v[52:53], v[52:53], v[216:217]
  v_exp_f32 v40, v40
  v_exp_f32 v41, v41
  v_exp_f32 v44, v44
  v_exp_f32 v45, v45
  v_exp_f32 v48, v48
  v_exp_f32 v49, v49
  v_exp_f32 v52, v52
  v_exp_f32 v53, v53
  v_pk_fma_f32 v[40:41], v[40:41], v[128:129], v[128:129]
  v_pk_fma_f32 v[44:45], v[44:45], v[128:129], v[128:129]
  v_pk_fma_f32 v[48:49], v[48:49], v[128:129], v[128:129]
  v_pk_fma_f32 v[52:53], v[52:53], v[128:129], v[128:129]
  v_rcp_f32 v40, v40
  v_rcp_f32 v41, v41
  v_rcp_f32 v44, v44
  v_rcp_f32 v45, v45
  v_rcp_f32 v48, v48
  v_rcp_f32 v49, v49
  v_rcp_f32 v52, v52
  v_rcp_f32 v53, v53
  v_pk_fma_f32 v[16:17], v[40:41], v[204:205], v[16:17]
  v_pk_fma_f32 v[18:19], v[44:45], v[208:209], v[18:19]
  v_pk_fma_f32 v[20:21], v[48:49], v[212:213], v[20:21]
  v_pk_fma_f32 v[22:23], v[52:53], v[216:217], v[22:23]
  v_pk_mul_f32 v[56:57], v[206:207], v[206:207]
  v_pk_mul_f32 v[60:61], v[210:211], v[210:211]
  v_pk_mul_f32 v[64:65], v[214:215], v[214:215]
  v_pk_mul_f32 v[68:69], v[218:219], v[218:219]
  v_pk_fma_f32 v[56:57], v[56:57], v[234:235], v[232:233]
  v_pk_fma_f32 v[60:61], v[60:61], v[234:235], v[232:233]
  v_pk_fma_f32 v[64:65], v[64:65], v[234:235], v[232:233]
  v_pk_fma_f32 v[68:69], v[68:69], v[234:235], v[232:233]
  v_pk_mul_f32 v[56:57], v[56:57], v[206:207]
  v_pk_mul_f32 v[60:61], v[60:61], v[210:211]
  v_pk_mul_f32 v[64:65], v[64:65], v[214:215]
  v_pk_mul_f32 v[68:69], v[68:69], v[218:219]
  v_exp_f32 v56, v56
  v_exp_f32 v57, v57
  v_exp_f32 v60, v60
  v_exp_f32 v61, v61
  v_exp_f32 v64, v64
  v_exp_f32 v65, v65
  v_exp_f32 v68, v68
  v_exp_f32 v69, v69
  v_pk_fma_f32 v[56:57], v[56:57], v[130:131], v[130:131]
  v_pk_fma_f32 v[60:61], v[60:61], v[130:131], v[130:131]
  v_pk_fma_f32 v[64:65], v[64:65], v[130:131], v[130:131]
  v_pk_fma_f32 v[68:69], v[68:69], v[130:131], v[130:131]
  v_rcp_f32 v56, v56
  v_rcp_f32 v57, v57
  v_rcp_f32 v60, v60
  v_rcp_f32 v61, v61
  v_rcp_f32 v64, v64
  v_rcp_f32 v65, v65
  v_rcp_f32 v68, v68
  v_rcp_f32 v69, v69
  v_pk_fma_f32 v[16:17], v[56:57], v[206:207], v[16:17]
  v_pk_fma_f32 v[18:19], v[60:61], v[210:211], v[18:19]
  v_pk_fma_f32 v[20:21], v[64:65], v[214:215], v[20:21]
  v_pk_fma_f32 v[22:23], v[68:69], v[218:219], v[22:23]
  v_add_f32 v16, v16, v17
  v_add_f32 v18, v18, v19
  v_add_f32 v20, v20, v21
  v_add_f32 v22, v22, v23
  s_nop 0
  v_permlane32_swap_b32 v16, v20
  v_permlane32_swap_b32 v18, v22
  v_add_f32 v16, v16, v20
  v_add_f32 v18, v18, v22
  s_nop 1
  v_permlane16_swap_b32 v16, v18
  v_add_f32 v16, v16, v18
  ds_write_b32 v36, v16
  s_waitcnt lgkmcnt(0)
  s_cmp_eq_u32 s3, 0
  s_cbranch_scc1 L_dpub
  s_barrier
  s_endpgm
L_dpub:
  s_mov_b32 s60, s24
  s_and_b32 s61, s25, 0xffff
  s_mov_b32 s62, 268435456
  s_mov_b32 s63, 0x20000
  s_mov_b32 s64, s22
  s_and_b32 s65, s23, 0xffff
  s_mov_b32 s66, 256
  s_mov_b32 s67, 0x20000
  s_waitcnt vmcnt(0)
  v_cmp_eq_u32 vcc, 0, v37
  s_nop 0
  s_and_b32 vcc_lo, vcc_lo, 0xff
  s_cbranch_scc0 L_dclr_ok
  s_mov_b32 s78, 0x40000
L_dclr:
  s_sub_u32 s78, s78, 1
  s_cbranch_scc1 L_dclr_ok
  v_lshlrev_b32 v37, 2, v0
  v_and_b32 v37, 31, v37
  buffer_load_dword v37, v37, s[64:67], 0 offen offset:128 sc1
  s_waitcnt vmcnt(0)
  v_cmp_eq_u32 vcc, 0, v37
  s_nop 0
  s_and_b32 vcc_lo, vcc_lo, 0xff
  s_cbranch_scc1 L_dclr
L_dclr_ok:
  s_barrier
  ds_read_b64 v[64:65], v2 offset:0
  ds_read_b64 v[66:67], v2 offset:512
  ds_read_b64 v[68:69], v2 offset:1024
  ds_read_b64 v[70:71], v2 offset:1536
  s_waitcnt lgkmcnt(2)
  v_pk_add_f32 v[64:65], v[64:65], v[66:67]
  s_waitcnt lgkmcnt(0)
  v_pk_add_f32 v[68:69], v[68:69], v[70:71]
  v_pk_add_f32 v[64:65], v[64:65], v[68:69]
  v_and_b32 v64, -2, v64
  v_and_b32 v65, -2, v65
  buffer_store_dwordx2 v[64:65], v3, s[60:63], s69 offen sc1
  s_endpgm
L_cin:
  s_and_b32 s68, s26, 3
  s_mul_i32 s68, s68, 3
  s_add_u32 s27, s68, s27
  s_sub_u32 s27, s27, 6
  s_cbranch_scc1 L_rem
  s_and_b32 s79, s3, 3
  s_lshr_b32 s84, s3, 2
  s_lshl_b32 s100, s27, 3
  s_add_u32 s100, s100, s3
  s_mul_i32 s68, s100, 1280
  v_min_u32 v40, 9, v0
  v_lshlrev_b32 v40, 7, v40
  v_lshlrev_b32 v48, 4, v0
  s_lshl_b32 s95, s79, 10
  s_cmp_eq_u32 s79, 2
  s_cselect_b64 s[82:83], 0x1fffff, -1
  s_cmp_eq_u32 s79, 3
  s_cselect_b32 s96, 0, 32768
  s_add_u32 s96, s96, s95
  s_mul_i32 s69, s27, 2979
  s_lshr_b32 s69, s69, 6
  s_mul_i32 s98, s27, 44
  s_and_b32 s70, s2, 7
  s_add_u32 s85, s98, s3
  s_lshl_b32 s85, s85, 2
  s_lshl_b32 s98, s70, 14
  s_add_u32 s85, s85, s98
  s_add_u32 s85, s85, 10240
  s_mul_i32 s98, s27, 44
  s_lshl_b32 s77, s70, 9
  s_add_u32 s94, s77, s98
  s_add_u32 s77, s77, s69
  s_add_u32 s94, s94, s3
  s_mul_i32 s94, s94, 104
  s_lshl_b32 s98, s27, 2
  s_add_u32 s98, s98, s3
  s_add_u32 s98, s98, s70
  s_and_b32 s98, s98, 7
  s_mul_i32 s98, s98, 16640
  s_add_u32 s98, s98, 12288
  s_sub_u32 s72, 6, s84
  s_lshl_b32 s99, s84, 1
  s_mov_b32 s26, -1
  v_lshrrev_b32 v43, 3, v0
  v_min_u32 v43, 6, v43
  v_lshlrev_b32 v17, 4, v43
  s_mul_i32 s70, s70, 88
  s_add_u32 s70, s100, s70
  s_mov_b32 s71, 704
  v_mov_b32 v44, s70
  v_mad_u32_u24 v19, v0, s71, v44
  s_mul_i32 s70, s100, 104
  s_sub_u32 s70, s70, 313
  v_min_u32 v44, 16, v0
  v_mul_u32_u24 v45, 26, v44
  v_add_u32 v45, s70, v45
  v_cmp_lt_u32 vcc, 12, v44
  s_nop 1
  v_cndmask_b32 v19, v19, v45, vcc
  v_lshlrev_b32 v19, 7, v19
  s_mov_b32 s101, 212992
  v_mov_b32 v2, 110464
  v_lshlrev_b32 v1, 20, v0
  v_add_u32 v1, 110464, v1
  v_and_b32 v44, 7, v0
  v_lshlrev_b32 v18, 4, v44
  v_and_b32 v44, 15, v0
  v_lshl_add_u32 v44, v44, 2, v2
  v_mov_b32 v3, 0
  ds_write_b32 v44, v3
  v_lshrrev_b32 v41, 5, v0
  v_and_b32 v42, 31, v0
  s_waitcnt lgkmcnt(0)
  v_mov_b32 v3, 1
  s_mov_b32 s32, s6
  s_and_b32 s33, s7, 0xffff
  s_mov_b32 s34, 12800000
  s_mov_b32 s35, 0x20000
  v_mov_b32 v45, s80
  buffer_load_dword v255, v45, s[32:35], 0 offen
  s_mov_b32 s36, s8
  s_and_b32 s37, s9, 0xffff
  s_mov_b32 s38, 105456
  s_mov_b32 s39, 0x20000
  buffer_load_dword v255, v40, s[36:39], s68 offen
  s_mov_b32 s44, s12
  s_and_b32 s45, s13, 0xffff
  s_mov_b32 s46, 5537792
  s_mov_b32 s47, 0x20000
  s_barrier
  s_mov_b64 exec, 131071
  buffer_load_dword v255, v19, s[44:47], s101 offen
  s_mov_b64 exec, -1
  s_add_u32 s101, s101, 1171456
  s_mov_b32 s28, s4
  s_and_b32 s29, s5, 0xffff
  s_mov_b32 s30, 425984
  s_mov_b32 s31, 0x20000
  s_cmp_lg_u32 s84, 0
  s_cbranch_scc1 L_g1a
  s_mov_b32 s40, s10
  s_and_b32 s41, s11, 0xffff
  s_mov_b32 s42, 156
  s_mov_b32 s43, 0x20000
  s_mov_b32 m0, 110272
  s_mov_b64 exec, 0x7ff
  buffer_load_dwordx4 v48, s[40:43], 0 offen lds
  s_mov_b64 exec, -1
  s_add_u32 m0, s95, 71552
  s_add_u32 s81, s95, 70304
  buffer_load_dwordx4 v48, s[36:39], s81 offen lds
  s_add_u32 m0, s95, 75648
  s_add_u32 s81, s95, 74400
  buffer_load_dwordx4 v48, s[36:39], s81 offen lds
  s_add_u32 m0, s95, 79744
  s_add_u32 s81, s95, 78496
  buffer_load_dwordx4 v48, s[36:39], s81 offen lds
  s_add_u32 m0, s95, 83840
  s_add_u32 s81, s95, 82592
  buffer_load_dwordx4 v48, s[36:39], s81 offen lds
  s_add_u32 m0, s95, 87936
  s_add_u32 s81, s95, 86688
  buffer_load_dwordx4 v48, s[36:39], s81 offen lds
  s_add_u32 m0, s95, 92032
  s_add_u32 s81, s95, 90784
  buffer_load_dwordx4 v48, s[36:39], s81 offen lds
  s_add_u32 m0, s95, 96128
  s_add_u32 s81, s95, 94880
  buffer_load_dwordx4 v48, s[36:39], s81 offen lds
  s_add_u32 m0, s95, 100224
  s_add_u32 s81, s95, 98976
  buffer_load_dwordx4 v48, s[36:39], s81 offen lds
  s_add_u32 m0, s96, 71552
  s_add_u32 s81, s96, 70304
  s_mov_b64 exec, s[82:83]
  buffer_load_dwordx4 v48, s[36:39], s81 offen lds
  s_mov_b64 exec, -1
  s_add_u32 m0, s95, 36288
  s_add_u32 s81, s95, 35152
  buffer_load_dwordx4 v48, s[36:39], s81 offen lds
  s_add_u32 m0, s95, 40384
  s_add_u32 s81, s95, 39248
  buffer_load_dwordx4 v48, s[36:39], s81 offen lds
  s_add_u32 m0, s95, 44480
  s_add_u32 s81, s95, 43344
  buffer_load_dwordx4 v48, s[36:39], s81 offen lds
  s_add_u32 m0, s95, 48576
  s_add_u32 s81, s95, 47440
  buffer_load_dwordx4 v48, s[36:39], s81 offen lds
  s_branch L_addrc
L_g1a:
  s_setprio 1
  v_bfe_u32 v43, v0, 2, 2
  v_lshl_add_u32 v43, v41, 3, v43
  v_bfe_u32 v44, v0, 4, 1
  v_lshlrev_b32 v44, 5, v44
  v_and_b32 v45, 3, v0
  v_lshl_add_u32 v44, v45, 3, v44
  v_lshl_add_u32 v240, v43, 6, v44
  v_add_u32 v240, 106816, v240
  s_lshl_b32 s68, s79, 6
  s_add_u32 s68, s68, 36288
  v_add_u32 v44, s68, v44
  v_mul_u32_u24 v45, 1352, v43
  v_add_u32 v241, v44, v45
  v_add_u32 v45, 16, v43
  v_min_u32 v45, 25, v45
  v_mul_u32_u24 v45, 1352, v45
  v_add_u32 v242, v44, v45
  v_add_u32 v45, 20, v43
  v_min_u32 v45, 25, v45
  v_mul_u32_u24 v45, 1352, v45
  v_add_u32 v243, v44, v45
  s_lshl_b32 s68, s79, 5
  v_add_u32 v246, s68, v42
  v_mul_u32_u24 v43, 52, v246
  v_lshl_add_u32 v43, v41, 3, v43
  v_add_u32 v244, 71552, v43
  v_lshlrev_b32 v43, 1, v246
  v_add_u32 v245, 108864, v43
  v_mov_b32 v216, 0
  v_mov_b32 v217, 0
  v_lshlrev_b32 v43, 3, v0
  v_add_u32 v44, 106816, v43
  s_lshl_b32 s68, s79, 9
  v_add_u32 v44, s68, v44
  ds_write_b64 v44, v[216:217]
  v_lshl_add_u32 v43, v41, 7, v246
  s_mov_b32 s69, 2521
  s_mov_b32 s70, 106816
  v_mul_u32_u24 v44, s69, v43
  v_lshrrev_b32 v44, 16, v44
  v_mad_u32_u24 v44, v44, 12, s70
  v_lshl_add_u32 v68, v43, 1, v44
  v_add_u32 v43, 256, v43
  v_mul_u32_u24 v44, s69, v43
  v_lshrrev_b32 v44, 16, v44
  v_mad_u32_u24 v44, v44, 12, s70
  v_lshl_add_u32 v69, v43, 1, v44
  v_add_u32 v43, 256, v43
  v_mul_u32_u24 v44, s69, v43
  v_lshrrev_b32 v44, 16, v44
  v_mad_u32_u24 v44, v44, 12, s70
  v_lshl_add_u32 v70, v43, 1, v44
  v_mov_b32 v44, 676
  v_cmp_gt_u32 s[92:93], v44, v43
  v_add_u32 v43, 0, v246
  v_mul_u32_u24 v44, s69, v43
  v_lshrrev_b32 v44, 16, v44
  v_lshl_add_u32 v44, v44, 2, v244
  v_add_u32 v72, 0, v44
  v_add_u32 v43, 128, v246
  v_mul_u32_u24 v44, s69, v43
  v_lshrrev_b32 v44, 16, v44
  v_lshl_add_u32 v44, v44, 2, v244
  v_add_u32 v73, 6656, v44
  v_add_u32 v43, 256, v246
  v_mul_u32_u24 v44, s69, v43
  v_lshrrev_b32 v44, 16, v44
  v_lshl_add_u32 v44, v44, 2, v244
  v_add_u32 v74, 13312, v44
  v_add_u32 v43, 384, v246
  v_mul_u32_u24 v44, s69, v43
  v_lshrrev_b32 v44, 16, v44
  v_lshl_add_u32 v44, v44, 2, v244
  v_add_u32 v75, 19968, v44
  v_add_u32 v43, 512, v246
  v_mul_u32_u24 v44, s69, v43
  v_lshrrev_b32 v44, 16, v44
  v_lshl_add_u32 v44, v44, 2, v244
  v_add_u32 v76, 26624, v44
  v_add_u32 v43, 640, v246
  v_mul_u32_u24 v44, s69, v43
  v_lshrrev_b32 v44, 16, v44
  v_lshl_add_u32 v44, v44, 2, v244
  v_add_u32 v77, 33280, v44
  v_lshlrev_b32 v78, 4, v41
  v_add_u32 v78, 110376, v78
  v_lshlrev_b32 v79, 1, v0
  v_add_u32 v79, 110272, v79
  v_lshlrev_b32 v80, 6, v0
  v_add_u32 v80, 106868, v80
L_addrc:
  s_and_b32 s70, s3, 1
  s_lshl_b32 s70, s70, 1
  v_add_u32 v46, s70, v41
  v_min_u32 v43, 25, v42
  s_mul_i32 s68, s84, 4
  s_add_u32 s68, s68, 1352
  s_mul_i32 s69, s84, 70528
  s_add_u32 s69, s69, 1024
  v_mul_u32_u24 v44, s68, v43
  v_add_u32 v44, s69, v44
  v_lshlrev_b32 v247, 2, v43
  v_add_u32 v247, 70528, v247
  v_mul_u32_u24 v65, 52, v43
  v_lshl_add_u32 v65, v46, 1, v65
  v_add_u32 v65, 108864, v65
  v_lshlrev_b32 v67, 1, v43
  v_add_u32 v67, 110272, v67
  v_mad_u32_u24 v60, v46, 52, v44
  v_lshl_add_u32 v61, v46, 1, v44
  v_lshl_add_u32 v49, v46, 1, v60
  v_lshlrev_b32 v43, 3, v46
  s_mov_b32 s68, 0x01000100
  v_bfe_i32 v45, s68, v43, 8
  v_lshl_add_u32 v50, v45, 1, v60
  v_mad_i32_i24 v51, v45, 52, v61
  s_mov_b32 s68, 0xff00ff00
  v_bfe_i32 v45, s68, v43, 8
  v_lshl_add_u32 v52, v45, 1, v60
  v_mad_i32_i24 v53, v45, 52, v61
  s_mov_b32 s68, 0xff020100
  v_bfe_i32 v45, s68, v43, 8
  v_lshl_add_u32 v54, v45, 1, v60
  v_mad_i32_i24 v55, v45, 52, v61
  s_mov_b32 s68, 0x0b0a0100
  v_bfe_i32 v45, s68, v43, 8
  v_lshl_add_u32 v56, v45, 1, v60
  v_mad_i32_i24 v57, v45, 52, v61
  s_mov_b32 s68, 0xf3f20100
  v_bfe_i32 v45, s68, v43, 8
  v_lshl_add_u32 v58, v45, 1, v60
  v_mad_i32_i24 v59, v45, 52, v61
  s_mov_b32 s68, 0x00023600
  v_bfe_u32 v45, s68, v43, 8
  v_add_u32 v60, v45, v44
  v_add_u32 v61, 52, v44
  v_mov_b32 v47, 1048576
  v_cmp_eq_u32 vcc, 3, v46
  s_nop 1
  v_cndmask_b32 v60, v60, v47, vcc
  v_cndmask_b32 v67, v47, v67, vcc
  v_cmp_eq_u32 vcc, 2, v46
  s_nop 1
  v_cndmask_b32 v61, v47, v61, vcc
  v_cmp_gt_u32 vcc, 2, v46
  s_nop 1
  v_cndmask_b32 v64, v47, v65, vcc
  s_lshr_b32 s69, s79, 1
  s_mul_i32 s69, s69, 6144
  s_mul_i32 s68, s84, 6144
  v_lshlrev_b32 v45, 8, v46
  v_lshl_add_u32 v43, v42, 4, v45
  v_add_u32 v63, 1024, v43
  v_add_u32 v66, 36288, v43
  v_bfe_u32 v43, v0, 2, 2
  v_lshl_add_u32 v45, v43, 4, v45
  v_and_b32 v43, 3, v0
  v_lshl_add_u32 v44, v43, 6, v45
  v_add_u32 v44, 12288, v44
  v_cmp_lt_u32 vcc, 15, v42
  s_nop 1
  v_cndmask_b32 v63, v63, v44, vcc
  v_add_u32 v44, 16, v44
  v_cndmask_b32 v66, v66, v44, vcc
  v_lshl_add_u32 v44, v43, 5, v45
  v_add_u32 v44, 24560, v44
  v_cmp_lt_u32 vcc, 19, v42
  s_nop 1
  v_cndmask_b32 v63, v63, v44, vcc
  v_add_u32 v63, s69, v63
  v_add_u32 v66, s68, v66
  v_cmp_lt_u32 vcc, 25, v42
  s_nop 1
  v_cndmask_b32 v63, v63, v47, vcc
  v_cndmask_b32 v66, v66, v47, vcc
  v_mov_b32 v62, 0
  s_mul_i32 s74, s3, 4224
  s_add_u32 s74, s74, 111040
  s_mov_b32 s75, -39488
  v_add_u32 v28, 1024, v48
  v_and_b32 v43, 11, v0
  v_cmp_eq_u32 vcc, 11, v43
  s_nop 1
  v_cndmask_b32 v31, v28, v47, vcc
  v_and_b32 v43, 3, v0
  v_cmp_eq_u32 vcc, 0, v43
  s_nop 1
  v_cndmask_b32 v30, v31, v47, vcc
  v_lshrrev_b32 v46, 4, v0
  v_bfe_u32 v43, v0, 1, 3
  v_lshlrev_b32 v45, 4, v43
  v_add_u32 v45, 24576, v45
  v_and_b32 v43, 10, v0
  v_cmp_eq_u32 vcc, 10, v43
  s_nop 1
  v_cndmask_b32 v45, v45, v47, vcc
  v_and_b32 v44, 1, v0
  v_lshl_add_u32 v29, v46, 9, v45
  v_lshl_add_u32 v29, v44, 2, v29
  v_add_u32 v29, 1024, v29
  v_lshl_add_u32 v22, v46, 8, v45
  v_lshl_add_u32 v22, v44, 20, v22
  v_and_b32 v47, 15, v0
  s_mov_b32 s68, 1056
  v_lshlrev_b32 v43, 1, v47
  v_add_u32 v43, s74, v43
  v_mad_u32_u24 v7, v46, s68, v43
  s_lshl_b32 s68, s3, 10
  s_add_u32 s68, s68, 144832
  v_add_u32 v10, s68, v48
  v_add_u32 v43, 256, v48
  v_and_b32 v43, 1023, v43
  v_add_u32 v11, s68, v43
  v_xor_b32 v43, 512, v48
  v_add_u32 v12, s68, v43
  v_lshlrev_b32 v13, 4, v41
  v_mov_b32 v32, 0
  v_mov_b32 v33, 0
  v_mov_b32 v34, 0
  v_mov_b32 v35, 0
  v_mov_b32 v36, 0
  v_mov_b32 v37, 0
  v_mov_b32 v38, 0
  v_mov_b32 v39, 0
  v_mov_b32 v216, 0
  v_mov_b32 v217, 0
  v_mov_b32 v218, 0
  v_mov_b32 v219, 0
  v_mov_b32 v220, 0
  v_mov_b32 v221, 0
  v_mov_b32 v222, 0
  v_mov_b32 v223, 0
  v_mov_b32 v224, 0
  v_mov_b32 v225, 0
  v_mov_b32 v226, 0
  v_mov_b32 v227, 0
  v_mov_b32 v228, 0
  v_mov_b32 v229, 0
  v_mov_b32 v230, 0
  v_mov_b32 v231, 0
  v_mov_b32 v232, 0
  v_mov_b32 v233, 0
  v_mov_b32 v234, 0
  v_mov_b32 v235, 0
  v_mov_b32 v236, 0
  v_mov_b32 v237, 0
  v_mov_b32 v238, 0
  v_mov_b32 v239, 0
  v_mul_u32_u24 v44, 1056, v46
  v_bfe_u32 v45, v0, 2, 2
  v_lshl_add_u32 v44, v45, 7, v44
  v_and_b32 v45, 3, v0
  v_lshl_add_u32 v9, v45, 3, v44
  v_add_u32 v8, s74, v9
  v_and_b32 v45, 1, v0
  s_mov_b32 s68, 0xaaaaaaaa
  v_mul_lo_u32 v16, s68, v45
  v_or_b32 v16, 0x44444444, v16
  v_lshlrev_b32 v15, 1, v0
  v_add_u32 v15, s74, v15
  v_mov_b32 v14, 0x3f80
  ds_write_b16 v15, v14 offset:4064
  v_add_u32 v15, s75, v15
  s_mul_i32 s71, s3, 6
  s_add_u32 s77, s77, s71
  s_mul_i32 s77, s77, 104
  s_add_u32 s73, s77, 80
  s_add_u32 s77, s77, 16
  s_mov_b32 s71, 10923
  v_min_u32 v43, 35, v0
  v_mul_u32_u24 v44, s71, v43
  v_lshrrev_b32 v44, 16, v44
  v_mul_u32_u24 v44, 80, v44
  v_lshl_add_u32 v20, v43, 2, v44
  s_cmp_eq_u32 s84, 0
  s_cbranch_scc1 L_g0pf
  s_waitcnt lgkmcnt(0)
  ds_add_u32 v1, v3 offset:0
  s_sub_u32 s94, s94, 416
  buffer_load_dwordx4 v[204:207], v17, s[28:31], s94 offen offset:0
  s_add_u32 s94, s94, 416
  buffer_load_dwordx4 v[24:27], v17, s[28:31], s94 offen offset:0
  s_add_u32 s94, s94, 832
  s_sub_u32 s68, s77, 2496
  buffer_load_dword v208, v20, s[28:31], s68 offen
  buffer_load_dword v209, v20, s[28:31], s77 offen
  s_add_u32 s77, s77, 24
L_csync1:
  ds_read_b32 v4, v2 offset:0
  s_waitcnt lgkmcnt(0)
  v_cmp_gt_u32 vcc, 8, v4
  s_cbranch_vccnz L_csync1
  ds_read_b64 v[132:133], v78 offset:0
  ds_read_b64 v[134:135], v78 offset:8
  ds_read_b64 v[136:137], v78 offset:32
  ds_read_b64 v[138:139], v78 offset:40
  ds_read_u16 v45, v79 offset:52
  ds_read_b64_tr_b16 v[84:85], v241 offset:35264
  ds_read_b64_tr_b16 v[86:87], v241 offset:40672
  ds_read_b64_tr_b16 v[88:89], v242 offset:35264
  ds_read_b64_tr_b16 v[90:91], v243 offset:35264
  ds_read_b64_tr_b16 v[92:93], v241 offset:35520
  ds_read_b64_tr_b16 v[94:95], v241 offset:40928
  ds_read_b64_tr_b16 v[96:97], v242 offset:35520
  ds_read_b64_tr_b16 v[98:99], v243 offset:35520
  ds_read_b64_tr_b16 v[100:101], v241 offset:35776
  ds_read_b64_tr_b16 v[102:103], v241 offset:41184
  ds_read_b64_tr_b16 v[104:105], v242 offset:35776
  ds_read_b64_tr_b16 v[106:107], v243 offset:35776
  ds_read_b64_tr_b16 v[108:109], v241 offset:36032
  ds_read_b64_tr_b16 v[110:111], v241 offset:41440
  ds_read_b64_tr_b16 v[112:113], v242 offset:36032
  ds_read_b64_tr_b16 v[114:115], v243 offset:36032
  s_waitcnt lgkmcnt(14)
  v_mfma_f32_32x32x16_bf16 v[140:155], v[132:135], v[84:87], 0
  s_waitcnt lgkmcnt(12)
  v_mfma_f32_32x32x16_bf16 v[140:155], v[136:139], v[88:91], v[140:155]
  ds_read_b64_tr_b16 v[116:117], v241 offset:36288
  ds_read_b64_tr_b16 v[118:119], v241 offset:41696
  ds_read_b64_tr_b16 v[120:121], v242 offset:36288
  ds_read_b64_tr_b16 v[122:123], v243 offset:36288
  s_waitcnt lgkmcnt(14)
  v_mfma_f32_32x32x16_bf16 v[156:171], v[132:135], v[92:95], 0
  s_waitcnt lgkmcnt(12)
  v_mfma_f32_32x32x16_bf16 v[156:171], v[136:139], v[96:99], v[156:171]
  ds_read_b64_tr_b16 v[124:125], v241 offset:36544
  ds_read_b64_tr_b16 v[126:127], v241 offset:41952
  ds_read_b64_tr_b16 v[128:129], v242 offset:36544
  ds_read_b64_tr_b16 v[130:131], v243 offset:36544
  s_waitcnt lgkmcnt(14)
  v_mfma_f32_32x32x16_bf16 v[172:187], v[132:135], v[100:103], 0
  s_waitcnt lgkmcnt(12)
  v_mfma_f32_32x32x16_bf16 v[172:187], v[136:139], v[104:107], v[172:187]
  v_cvt_pk_bf16_f32 v81, v140, 0
  s_waitcnt lgkmcnt(10)
  v_mfma_f32_32x32x16_bf16 v[188:203], v[132:135], v[108:111], 0
  s_waitcnt lgkmcnt(8)
  v_mfma_f32_32x32x16_bf16 v[188:203], v[136:139], v[112:115], v[188:203]
  s_mov_b32 exec_lo, 0
  v_cvt_pk_bf16_f32 v81, v156, 0
  s_mov_b32 exec_lo, -1
  ds_write_b16 v68, v81
  s_waitcnt lgkmcnt(7)
  v_mfma_f32_32x32x16_bf16 v[140:155], v[132:135], v[116:119], 0
  s_waitcnt lgkmcnt(5)
  v_mfma_f32_32x32x16_bf16 v[140:155], v[136:139], v[120:123], v[140:155]
  v_cvt_pk_bf16_f32 v82, v172, 0
  s_waitcnt lgkmcnt(3)
  v_mfma_f32_32x32x16_bf16 v[156:171], v[132:135], v[124:127], 0
  s_waitcnt lgkmcnt(1)
  v_mfma_f32_32x32x16_bf16 v[156:171], v[136:139], v[128:131], v[156:171]
  s_mov_b32 exec_lo, 0
  v_cvt_pk_bf16_f32 v82, v188, 0
  s_mov_b32 exec_lo, -1
  ds_write_b16 v69, v82
  s_nop 2
  v_cvt_pk_bf16_f32 v83, v140, 0
  s_mov_b32 exec_lo, 0
  s_nop 2
  v_cvt_pk_bf16_f32 v83, v156, 0
  s_mov_b64 exec, s[92:93]
  ds_write_b16 v70, v83
  s_mov_b64 exec, 0x3ffffff
  ds_write_b16 v80, v45
  s_mov_b64 exec, -1
  s_waitcnt lgkmcnt(0)
  ds_add_u32 v1, v3 offset:32
  v_cmp_gt_u32 s[92:93], 36, v246
  s_waitcnt vmcnt(1)
  v_lshlrev_b32 v208, 7, v208
  buffer_load_dword v255, v208, s[32:35], 0 offen
  s_waitcnt vmcnt(1)
  v_lshlrev_b32 v209, 7, v209
  buffer_load_dword v255, v209, s[32:35], 0 offen
L_csync2:
  ds_read_b32 v4, v2 offset:4
  s_waitcnt lgkmcnt(0)
  v_cmp_gt_u32 vcc, 4, v4
  s_cbranch_vccnz L_csync2
  ds_read_b64_tr_b16 v[84:85], v241 offset:0
  ds_read_b64_tr_b16 v[86:87], v241 offset:5408
  ds_read_b64_tr_b16 v[88:89], v242 offset:0
  ds_read_b64_tr_b16 v[90:91], v243 offset:0
  ds_read_b64_tr_b16 v[92:93], v241 offset:256
  ds_read_b64_tr_b16 v[94:95], v241 offset:5664
  ds_read_b64_tr_b16 v[96:97], v242 offset:256
  ds_read_b64_tr_b16 v[98:99], v243 offset:256
  ds_read_b64_tr_b16 v[100:101], v241 offset:512
  ds_read_b64_tr_b16 v[102:103], v241 offset:5920
  ds_read_b64_tr_b16 v[104:105], v242 offset:512
  ds_read_b64_tr_b16 v[106:107], v243 offset:512
  ds_read_b64_tr_b16 v[108:109], v241 offset:768
  ds_read_b64_tr_b16 v[110:111], v241 offset:6176
  ds_read_b64_tr_b16 v[112:113], v242 offset:768
  ds_read_b64_tr_b16 v[114:115], v243 offset:768
  ds_read_b64_tr_b16 v[116:117], v241 offset:1024
  ds_read_b64_tr_b16 v[118:119], v241 offset:6432
  ds_read_b64_tr_b16 v[120:121], v242 offset:1024
  ds_read_b64_tr_b16 v[122:123], v243 offset:1024
  ds_read_b64_tr_b16 v[124:125], v241 offset:1280
  ds_read_b64_tr_b16 v[126:127], v241 offset:6688
  ds_read_b64_tr_b16 v[128:129], v242 offset:1280
  ds_read_b64_tr_b16 v[130:131], v243 offset:1280
L_csync3:
  ds_read_b32 v4, v2 offset:32
  s_waitcnt lgkmcnt(0)
  v_cmp_gt_u32 vcc, 4, v4
  s_cbranch_vccnz L_csync3
  s_setprio 1
  ds_read_b64_tr_b16 v[132:133], v240 offset:0
  ds_read_b64_tr_b16 v[134:135], v240 offset:256
  ds_read_b64_tr_b16 v[136:137], v240 offset:1024
  ds_read_b64_tr_b16 v[138:139], v240 offset:1280
  s_waitcnt lgkmcnt(2)
  v_mfma_f32_32x32x16_bf16 v[140:155], v[132:135], v[84:87], 0
  s_waitcnt lgkmcnt(0)
  v_mfma_f32_32x32x16_bf16 v[140:155], v[136:139], v[88:91], v[140:155]
  v_mfma_f32_32x32x16_bf16 v[156:171], v[132:135], v[92:95], 0
  v_mfma_f32_32x32x16_bf16 v[156:171], v[136:139], v[96:99], v[156:171]
  v_mfma_f32_32x32x16_bf16 v[172:187], v[132:135], v[100:103], 0
  v_mfma_f32_32x32x16_bf16 v[172:187], v[136:139], v[104:107], v[172:187]
  s_nop 7
  v_cvt_pk_bf16_f32 v84, v140, v141
  v_cvt_pk_bf16_f32 v85, v142, v143
  v_cvt_pk_bf16_f32 v86, v144, v145
  v_cvt_pk_bf16_f32 v87, v146, v147
  v_cvt_pk_bf16_f32 v88, v148, v149
  v_cvt_pk_bf16_f32 v89, v150, v151
  v_cvt_pk_bf16_f32 v90, v152, v153
  v_cvt_pk_bf16_f32 v91, v154, v155
  ds_write2_b32 v72, v84, v85 offset0:0 offset1:1
  v_max3_f32 v62, v62, abs(v140), abs(v141)
  v_max3_f32 v62, v62, abs(v142), abs(v143)
  v_max3_f32 v62, v62, abs(v144), abs(v145)
  ds_write2_b32 v72, v86, v87 offset0:4 offset1:5
  v_max3_f32 v62, v62, abs(v146), abs(v147)
  v_max3_f32 v62, v62, abs(v148), abs(v149)
  ds_write2_b32 v72, v88, v89 offset0:8 offset1:9
  v_max3_f32 v62, v62, abs(v150), abs(v151)
  v_max3_f32 v62, v62, abs(v152), abs(v153)
  v_mfma_f32_32x32x16_bf16 v[188:203], v[132:135], v[108:111], 0
  v_mfma_f32_32x32x16_bf16 v[188:203], v[136:139], v[112:115], v[188:203]
  v_cvt_pk_bf16_f32 v92, v156, v157
  v_cvt_pk_bf16_f32 v93, v158, v159
  v_cvt_pk_bf16_f32 v94, v160, v161
  v_cvt_pk_bf16_f32 v95, v162, v163
  v_cvt_pk_bf16_f32 v96, v164, v165
  v_cvt_pk_bf16_f32 v97, v166, v167
  v_cvt_pk_bf16_f32 v98, v168, v169
  v_cvt_pk_bf16_f32 v99, v170, v171
  ds_write2_b32 v73, v92, v93 offset0:0 offset1:1
  v_max3_f32 v62, v62, abs(v156), abs(v157)
  v_max3_f32 v62, v62, abs(v158), abs(v159)
  v_max3_f32 v62, v62, abs(v160), abs(v161)
  ds_write2_b32 v73, v94, v95 offset0:4 offset1:5
  v_max3_f32 v62, v62, abs(v162), abs(v163)
  v_max3_f32 v62, v62, abs(v164), abs(v165)
  ds_write2_b32 v73, v96, v97 offset0:8 offset1:9
  v_max3_f32 v62, v62, abs(v166), abs(v167)
  v_max3_f32 v62, v62, abs(v168), abs(v169)
  v_mfma_f32_32x32x16_bf16 v[140:155], v[132:135], v[116:119], 0
  v_mfma_f32_32x32x16_bf16 v[140:155], v[136:139], v[120:123], v[140:155]
  v_cvt_pk_bf16_f32 v100, v172, v173
  v_cvt_pk_bf16_f32 v101, v174, v175
  v_cvt_pk_bf16_f32 v102, v176, v177
  v_cvt_pk_bf16_f32 v103, v178, v179
  v_cvt_pk_bf16_f32 v104, v180, v181
  v_cvt_pk_bf16_f32 v105, v182, v183
  v_cvt_pk_bf16_f32 v106, v184, v185
  v_cvt_pk_bf16_f32 v107, v186, v187
  ds_write2_b32 v74, v100, v101 offset0:0 offset1:1
  v_max3_f32 v62, v62, abs(v172), abs(v173)
  v_max3_f32 v62, v62, abs(v174), abs(v175)
  v_max3_f32 v62, v62, abs(v176), abs(v177)
  ds_write2_b32 v74, v102, v103 offset0:4 offset1:5
  v_max3_f32 v62, v62, abs(v178), abs(v179)
  v_max3_f32 v62, v62, abs(v180), abs(v181)
  ds_write2_b32 v74, v104, v105 offset0:8 offset1:9
  v_max3_f32 v62, v62, abs(v182), abs(v183)
  v_max3_f32 v62, v62, abs(v184), abs(v185)
  v_mfma_f32_32x32x16_bf16 v[156:171], v[132:135], v[124:127], 0
  v_mfma_f32_32x32x16_bf16 v[156:171], v[136:139], v[128:131], v[156:171]
  v_cvt_pk_bf16_f32 v108, v188, v189
  v_cvt_pk_bf16_f32 v109, v190, v191
  v_cvt_pk_bf16_f32 v110, v192, v193
  v_cvt_pk_bf16_f32 v111, v194, v195
  v_cvt_pk_bf16_f32 v112, v196, v197
  v_cvt_pk_bf16_f32 v113, v198, v199
  v_cvt_pk_bf16_f32 v114, v200, v201
  v_cvt_pk_bf16_f32 v115, v202, v203
  ds_write2_b32 v75, v108, v109 offset0:0 offset1:1
  v_max3_f32 v62, v62, abs(v188), abs(v189)
  v_max3_f32 v62, v62, abs(v190), abs(v191)
  v_max3_f32 v62, v62, abs(v192), abs(v193)
  ds_write2_b32 v75, v110, v111 offset0:4 offset1:5
  v_max3_f32 v62, v62, abs(v194), abs(v195)
  v_max3_f32 v62, v62, abs(v196), abs(v197)
  ds_write2_b32 v75, v112, v113 offset0:8 offset1:9
  v_max3_f32 v62, v62, abs(v198), abs(v199)
  v_max3_f32 v62, v62, abs(v200), abs(v201)
  v_cvt_pk_bf16_f32 v116, v140, v141
  v_cvt_pk_bf16_f32 v117, v142, v143
  v_cvt_pk_bf16_f32 v118, v144, v145
  v_cvt_pk_bf16_f32 v119, v146, v147
  v_cvt_pk_bf16_f32 v120, v148, v149
  v_cvt_pk_bf16_f32 v121, v150, v151
  v_cvt_pk_bf16_f32 v122, v152, v153
  v_cvt_pk_bf16_f32 v123, v154, v155
  ds_write2_b32 v76, v116, v117 offset0:0 offset1:1
  v_max3_f32 v62, v62, abs(v140), abs(v141)
  v_max3_f32 v62, v62, abs(v142), abs(v143)
  v_max3_f32 v62, v62, abs(v144), abs(v145)
  ds_write2_b32 v76, v118, v119 offset0:4 offset1:5
  v_max3_f32 v62, v62, abs(v146), abs(v147)
  v_max3_f32 v62, v62, abs(v148), abs(v149)
  ds_write2_b32 v76, v120, v121 offset0:8 offset1:9
  v_max3_f32 v62, v62, abs(v150), abs(v151)
  v_max3_f32 v62, v62, abs(v152), abs(v153)
  v_cvt_pk_bf16_f32 v124, v156, v157
  v_cvt_pk_bf16_f32 v125, v158, v159
  v_cvt_pk_bf16_f32 v126, v160, v161
  v_cvt_pk_bf16_f32 v127, v162, v163
  v_cvt_pk_bf16_f32 v128, v164, v165
  v_cvt_pk_bf16_f32 v129, v166, v167
  v_cvt_pk_bf16_f32 v130, v168, v169
  v_cvt_pk_bf16_f32 v131, v170, v171
  s_mov_b64 exec, s[92:93]
  ds_write2_b32 v77, v124, v125 offset0:0 offset1:1
  v_max3_f32 v62, v62, abs(v156), abs(v157)
  v_max3_f32 v62, v62, abs(v158), abs(v159)
  v_max3_f32 v62, v62, abs(v160), abs(v161)
  ds_write2_b32 v77, v126, v127 offset0:4 offset1:5
  v_max3_f32 v62, v62, abs(v162), abs(v163)
  v_max3_f32 v62, v62, abs(v164), abs(v165)
  ds_write2_b32 v77, v128, v129 offset0:8 offset1:9
  v_max3_f32 v62, v62, abs(v166), abs(v167)
  v_max3_f32 v62, v62, abs(v168), abs(v169)
  s_mov_b32 exec_hi, 0
  ds_write_b32 v77, v130 offset:48
  ds_write_b16 v245, v131 offset:1280
  s_mov_b32 exec_lo, -1
  ds_write_b32 v76, v122 offset:48
  ds_write_b16 v245, v123 offset:1024
  ds_write_b32 v75, v114 offset:48
  ds_write_b16 v245, v115 offset:768
  ds_write_b32 v74, v106 offset:48
  ds_write_b16 v245, v107 offset:512
  ds_write_b32 v73, v98 offset:48
  ds_write_b16 v245, v99 offset:256
  ds_write_b32 v72, v90 offset:48
  ds_write_b16 v245, v91 offset:0
  s_mov_b64 exec, -1
  v_max_u32_dpp v62, v62, v62 row_shr:1 row_mask:0xf bank_mask:0xf
  s_nop 1
  v_max_u32_dpp v62, v62, v62 row_shr:2 row_mask:0xf bank_mask:0xf
  s_nop 1
  v_max_u32_dpp v62, v62, v62 row_shr:4 row_mask:0xf bank_mask:0xf
  s_nop 1
  v_max_u32_dpp v62, v62, v62 row_shr:8 row_mask:0xf bank_mask:0xf
  s_nop 1
  v_max_u32_dpp v62, v62, v62 row_bcast:15 row_mask:0xa bank_mask:0xf
  s_nop 1
  v_max_u32_dpp v62, v62, v62 row_bcast:31 row_mask:0xc bank_mask:0xf
  s_nop 0
  v_readlane_b32 s68, v62, 63
  s_nop 1
  v_mov_b32 v62, s68
  ds_max_u32 v1, v62 offset:28
  ds_add_u32 v1, v3 offset:24
  s_setprio 0
  v_lshl_add_u32 v24, v24, 7, v18
  v_lshl_add_u32 v25, v25, 7, v18
  s_mov_b32 exec_hi, 0x0000ffff
  v_lshl_add_u32 v26, v26, 7, v18
  v_lshl_add_u32 v27, v27, 7, v18
  s_mov_b32 exec_lo, 0
  s_mov_b32 exec_hi, 0xffff0000
  v_mov_b32 v27, v25
  v_mov_b32 v26, v25
  s_mov_b32 exec_hi, 0x00ff0000
  v_mov_b32 v26, v24
  s_mov_b64 exec, -1
  s_add_u32 m0, s74, 0
  s_nop 0
  buffer_load_dwordx4 v24, s[32:35], 0 offen lds
  s_add_u32 m0, s74, 1056
  s_nop 0
  buffer_load_dwordx4 v25, s[32:35], 0 offen lds
  s_add_u32 m0, s74, 2112
  s_nop 0
  buffer_load_dwordx4 v26, s[32:35], 0 offen lds
  s_add_u32 m0, s74, 3168
  s_mov_b32 exec_hi, 0x00ffffff
  buffer_load_dwordx4 v27, s[32:35], 0 offen lds
  s_mov_b32 exec_hi, -1
  v_lshl_add_u32 v204, v204, 7, v18
  v_lshl_add_u32 v205, v205, 7, v18
  s_mov_b32 exec_hi, 0x0000ffff
  v_lshl_add_u32 v206, v206, 7, v18
  v_lshl_add_u32 v207, v207, 7, v18
  s_mov_b32 exec_lo, 0
  s_mov_b32 exec_hi, 0xffff0000
  v_mov_b32 v207, v205
  v_mov_b32 v206, v205
  s_mov_b32 exec_hi, 0x00ff0000
  v_mov_b32 v206, v204
  s_mov_b64 exec, -1
  s_add_u32 m0, s74, -16896
  s_nop 0
  buffer_load_dwordx4 v204, s[32:35], 0 offen lds
  s_add_u32 m0, s74, -15840
  s_nop 0
  buffer_load_dwordx4 v205, s[32:35], 0 offen lds
  s_add_u32 m0, s74, -14784
  s_nop 0
  buffer_load_dwordx4 v206, s[32:35], 0 offen lds
  s_add_u32 m0, s74, -13728
  s_mov_b32 exec_hi, 0x00ffffff
  buffer_load_dwordx4 v207, s[32:35], 0 offen lds
  s_mov_b32 exec_hi, -1
  buffer_load_dwordx4 v[24:27], v17, s[28:31], s94 offen offset:0
  s_add_u32 s94, s94, 832
  s_branch L_uph
L_g0pf:
  s_waitcnt vmcnt(4) lgkmcnt(0)
  ds_add_u32 v1, v3 offset:0
  s_add_u32 m0, s95, 52672
  s_add_u32 s81, s95, 51536
  buffer_load_dwordx4 v48, s[36:39], s81 offen lds
  s_add_u32 m0, s95, 56768
  s_add_u32 s81, s95, 55632
  buffer_load_dwordx4 v48, s[36:39], s81 offen lds
  s_add_u32 m0, s95, 60864
  s_add_u32 s81, s95, 59728
  buffer_load_dwordx4 v48, s[36:39], s81 offen lds
  s_add_u32 m0, s95, 64960
  s_add_u32 s81, s95, 63824
  buffer_load_dwordx4 v48, s[36:39], s81 offen lds
  s_add_u32 m0, s96, 36288
  s_add_u32 s81, s96, 35152
  s_mov_b64 exec, s[82:83]
  buffer_load_dwordx4 v48, s[36:39], s81 offen lds
  s_mov_b64 exec, -1
  s_add_u32 m0, s95, 1024
  s_add_u32 s81, s95, 0
  buffer_load_dwordx4 v48, s[36:39], s81 offen lds
  s_add_u32 m0, s95, 5120
  s_add_u32 s81, s95, 4096
  buffer_load_dwordx4 v48, s[36:39], s81 offen lds
  s_add_u32 m0, s95, 9216
  s_add_u32 s81, s95, 8192
  buffer_load_dwordx4 v48, s[36:39], s81 offen lds
  s_add_u32 m0, s95, 13312
  s_add_u32 s81, s95, 12288
  buffer_load_dwordx4 v48, s[36:39], s81 offen lds
  s_waitcnt vmcnt(4) lgkmcnt(0)
  ds_add_u32 v1, v3 offset:4
  s_add_u32 m0, s95, 17408
  s_add_u32 s81, s95, 16384
  buffer_load_dwordx4 v48, s[36:39], s81 offen lds
  s_add_u32 m0, s95, 21504
  s_add_u32 s81, s95, 20480
  buffer_load_dwordx4 v48, s[36:39], s81 offen lds
  s_add_u32 m0, s95, 25600
  s_add_u32 s81, s95, 24576
  buffer_load_dwordx4 v48, s[36:39], s81 offen lds
  s_add_u32 m0, s95, 29696
  s_add_u32 s81, s95, 28672
  buffer_load_dwordx4 v48, s[36:39], s81 offen lds
  s_add_u32 m0, s96, 1024
  s_add_u32 s81, s96, 0
  s_mov_b64 exec, s[82:83]
  buffer_load_dwordx4 v48, s[36:39], s81 offen lds
  s_mov_b64 exec, -1
  s_add_u32 s94, s94, 832
  s_add_u32 s77, s77, 24
  buffer_load_dwordx4 v[24:27], v17, s[28:31], s94 offen offset:0
  s_add_u32 s94, s94, 832
  s_waitcnt vmcnt(1) lgkmcnt(0)
  ds_add_u32 v1, v3 offset:8
  s_mov_b32 s97, 0
L_csync4:
  ds_read_b32 v4, v2 offset:8
  s_waitcnt lgkmcnt(0)
  v_cmp_gt_u32 vcc, 4, v4
  s_cbranch_vccnz L_csync4
  s_cmp_ge_u32 s79, 2
  s_cbranch_scc1 L_chunk2
L_chunk0:
  ds_read_u16_d16_hi v216, v49 offset:0
  ds_read_u16_d16_hi v218, v49 offset:648
  ds_read_u16_d16_hi v220, v49 offset:216
  ds_read_u16_d16_hi v222, v49 offset:864
  ds_read_u16_d16_hi v224, v49 offset:432
  ds_read_u16_d16_hi v226, v49 offset:1080
  ds_read_u16_d16_hi v228, v49 offset:8
  ds_read_u16_d16_hi v229, v49 offset:208
  ds_read_u16_d16_hi v230, v49 offset:656
  ds_read_u16_d16_hi v231, v49 offset:856
  s_waitcnt lgkmcnt(8)
  v_mov_b32 v85, v218
  v_mov_b32 v84, v216
  v_max3_f32 v62, v62, abs(v84), abs(v85)
  ds_read_u16_d16_hi v232, v49 offset:32
  ds_read_u16_d16_hi v233, v49 offset:832
  ds_read_u16_d16_hi v234, v49 offset:632
  ds_read_u16_d16_hi v235, v49 offset:232
  s_waitcnt lgkmcnt(10)
  v_mov_b32 v87, v222
  v_mov_b32 v86, v220
  v_max3_f32 v62, v62, abs(v86), abs(v87)
  ds_read_u16_d16_hi v236, v49 offset:16
  ds_read_u16_d16_hi v237, v49 offset:416
  ds_read_u16_d16_hi v238, v49 offset:664
  ds_read_u16_d16_hi v239, v49 offset:1064
  s_waitcnt lgkmcnt(12)
  v_mov_b32 v89, v226
  v_mov_b32 v88, v224
  v_max3_f32 v62, v62, abs(v88), abs(v89)
  ds_read_u16_d16_hi v216, v49 offset:40
  ds_read_u16_d16_hi v217, v49 offset:1040
  ds_read_u16_d16_hi v218, v49 offset:640
  ds_read_u16_d16_hi v219, v49 offset:440
  s_waitcnt lgkmcnt(12)
  v_add_f32 v91, v230, v231
  v_add_f32 v90, v228, v229
  v_max3_f32 v62, v62, abs(v90), abs(v91)
  ds_read_u16_d16_hi v220, v49 offset:224
  ds_read_u16_d16_hi v221, v49 offset:424
  ds_read_u16_d16_hi v222, v49 offset:872
  ds_read_u16_d16_hi v223, v49 offset:1072
  s_waitcnt lgkmcnt(12)
  v_add_f32 v93, v234, v235
  v_add_f32 v92, v232, v233
  v_max3_f32 v62, v62, abs(v92), abs(v93)
  ds_read_u16_d16_hi v224, v49 offset:248
  ds_read_u16_d16_hi v225, v49 offset:1048
  ds_read_u16_d16_hi v226, v49 offset:848
  ds_read_u16_d16_hi v227, v49 offset:448
  s_waitcnt lgkmcnt(12)
  v_add_f32 v95, v238, v239
  v_add_f32 v94, v236, v237
  v_max3_f32 v62, v62, abs(v94), abs(v95)
  ds_read_u16_d16_hi v228, v50 offset:48
  ds_read_u16_d16_hi v229, v51 offset:1248
  ds_read_u16_d16_hi v230, v50 offset:672
  ds_read_u16_d16_hi v231, v51 offset:1272
  s_waitcnt lgkmcnt(12)
  v_add_f32 v97, v218, v219
  v_add_f32 v96, v216, v217
  v_max3_f32 v62, v62, abs(v96), abs(v97)
  ds_read_u16_d16_hi v232, v50 offset:256
  ds_read_u16_d16_hi v233, v51 offset:1256
  ds_read_u16_d16_hi v234, v50 offset:880
  ds_read_u16_d16_hi v235, v51 offset:1280
  s_waitcnt lgkmcnt(12)
  v_add_f32 v99, v222, v223
  v_add_f32 v98, v220, v221
  v_max3_f32 v62, v62, abs(v98), abs(v99)
  ds_read_u16_d16_hi v236, v50 offset:464
  ds_read_u16_d16_hi v237, v51 offset:1264
  ds_read_u16_d16_hi v238, v50 offset:1088
  ds_read_u16_d16_hi v239, v51 offset:1288
  s_waitcnt lgkmcnt(12)
  v_add_f32 v101, v226, v227
  v_add_f32 v100, v224, v225
  v_max3_f32 v62, v62, abs(v100), abs(v101)
  s_waitcnt lgkmcnt(8)
  v_add_f32 v103, v230, v231
  v_add_f32 v102, v228, v229
  v_max3_f32 v62, v62, abs(v102), abs(v103)
  s_waitcnt lgkmcnt(4)
  v_add_f32 v105, v234, v235
  v_add_f32 v104, v232, v233
  v_max3_f32 v62, v62, abs(v104), abs(v105)
  s_waitcnt lgkmcnt(0)
  v_add_f32 v107, v238, v239
  v_add_f32 v106, v236, v237
  v_max3_f32 v62, v62, abs(v106), abs(v107)
  s_cmp_lg_u32 s97, 0
  s_cbranch_scc1 L_uconv0
L_chunk1:
  ds_read_u16_d16_hi v216, v49 offset:24
  ds_read_u16_d16_hi v217, v49 offset:624
  ds_read_u16_d16_hi v218, v49 offset:240
  ds_read_u16_d16_hi v219, v49 offset:840
  ds_read_u16_d16_hi v220, v49 offset:456
  ds_read_u16_d16_hi v221, v49 offset:1056
  ds_read_u16_d16_hi v222, v60 offset:1296
  ds_read_u16_d16_hi v223, v61 offset:1296
  ds_read_u16_d16_hi v224, v52 offset:50
  ds_read_u16_d16_hi v225, v53 offset:1300
  ds_read_u16_d16_hi v226, v52 offset:674
  ds_read_u16_d16_hi v227, v53 offset:1324
  ds_read_u16_d16_hi v228, v52 offset:258
  ds_read_u16_d16_hi v229, v53 offset:1308
  ds_read_u16_d16_hi v230, v52 offset:882
  ds_read_u16_d16_hi v231, v53 offset:1332
  s_waitcnt lgkmcnt(12)
  v_add_f32 v109, v218, v219
  v_add_f32 v108, v216, v217
  v_max3_f32 v62, v62, abs(v108), abs(v109)
  ds_read_u16_d16_hi v232, v52 offset:466
  ds_read_u16_d16_hi v233, v53 offset:1316
  ds_read_u16_d16_hi v234, v52 offset:1090
  ds_read_u16_d16_hi v235, v53 offset:1340
  s_waitcnt lgkmcnt(12)
  v_add_f32 v111, v222, v223
  v_add_f32 v110, v220, v221
  v_max3_f32 v62, v62, abs(v110), abs(v111)
  ds_read_u16_d16_hi v236, v54 offset:2
  ds_read_u16_d16_hi v237, v55 offset:52
  ds_read_u16_d16_hi v238, v54 offset:650
  ds_read_u16_d16_hi v239, v55 offset:700
  s_waitcnt lgkmcnt(12)
  v_add_f32 v113, v226, v227
  v_add_f32 v112, v224, v225
  v_max3_f32 v62, v62, abs(v112), abs(v113)
  ds_read_u16_d16_hi v216, v54 offset:26
  ds_read_u16_d16_hi v217, v55 offset:676
  ds_read_u16_d16_hi v218, v54 offset:626
  ds_read_u16_d16_hi v219, v55 offset:76
  s_waitcnt lgkmcnt(12)
  v_add_f32 v115, v230, v231
  v_add_f32 v114, v228, v229
  v_max3_f32 v62, v62, abs(v114), abs(v115)
  ds_read_u16_d16_hi v220, v54 offset:10
  ds_read_u16_d16_hi v221, v55 offset:260
  ds_read_u16_d16_hi v222, v54 offset:658
  ds_read_u16_d16_hi v223, v55 offset:908
  s_waitcnt lgkmcnt(12)
  v_add_f32 v117, v234, v235
  v_add_f32 v116, v232, v233
  v_max3_f32 v62, v62, abs(v116), abs(v117)
  ds_read_u16_d16_hi v224, v54 offset:34
  ds_read_u16_d16_hi v225, v55 offset:884
  ds_read_u16_d16_hi v226, v54 offset:634
  ds_read_u16_d16_hi v227, v55 offset:284
  s_waitcnt lgkmcnt(12)
  v_add_f32 v119, v238, v239
  v_add_f32 v118, v236, v237
  v_max3_f32 v62, v62, abs(v118), abs(v119)
  ds_read_u16_d16_hi v228, v54 offset:18
  ds_read_u16_d16_hi v229, v55 offset:468
  ds_read_u16_d16_hi v230, v54 offset:666
  ds_read_u16_d16_hi v231, v55 offset:1116
  s_waitcnt lgkmcnt(12)
  v_add_f32 v121, v218, v219
  v_add_f32 v120, v216, v217
  v_max3_f32 v62, v62, abs(v120), abs(v121)
  ds_read_u16_d16_hi v232, v54 offset:42
  ds_read_u16_d16_hi v233, v55 offset:1092
  ds_read_u16_d16_hi v234, v54 offset:642
  ds_read_u16_d16_hi v235, v55 offset:492
  s_waitcnt lgkmcnt(12)
  v_add_f32 v123, v222, v223
  v_add_f32 v122, v220, v221
  v_max3_f32 v62, v62, abs(v122), abs(v123)
  ds_read_u16_d16_hi v236, v54 offset:210
  ds_read_u16_d16_hi v237, v55 offset:60
  ds_read_u16_d16_hi v238, v54 offset:858
  ds_read_u16_d16_hi v239, v55 offset:708
  s_waitcnt lgkmcnt(12)
  v_add_f32 v125, v226, v227
  v_add_f32 v124, v224, v225
  v_max3_f32 v62, v62, abs(v124), abs(v125)
  s_waitcnt lgkmcnt(8)
  v_add_f32 v127, v230, v231
  v_add_f32 v126, v228, v229
  v_max3_f32 v62, v62, abs(v126), abs(v127)
  s_waitcnt lgkmcnt(4)
  v_add_f32 v129, v234, v235
  v_add_f32 v128, v232, v233
  v_max3_f32 v62, v62, abs(v128), abs(v129)
  s_waitcnt lgkmcnt(0)
  v_add_f32 v131, v238, v239
  v_add_f32 v130, v236, v237
  v_max3_f32 v62, v62, abs(v130), abs(v131)
  s_cmp_lg_u32 s97, 0
  s_cbranch_scc1 L_uconv1
  s_branch L_w1conv
L_chunk2:
  ds_read_u16_d16_hi v216, v54 offset:234
  ds_read_u16_d16_hi v217, v55 offset:684
  ds_read_u16_d16_hi v218, v54 offset:834
  ds_read_u16_d16_hi v219, v55 offset:84
  ds_read_u16_d16_hi v220, v54 offset:218
  ds_read_u16_d16_hi v221, v55 offset:268
  ds_read_u16_d16_hi v222, v54 offset:866
  ds_read_u16_d16_hi v223, v55 offset:916
  ds_read_u16_d16_hi v224, v54 offset:242
  ds_read_u16_d16_hi v225, v55 offset:892
  ds_read_u16_d16_hi v226, v54 offset:842
  ds_read_u16_d16_hi v227, v55 offset:292
  ds_read_u16_d16_hi v228, v54 offset:226
  ds_read_u16_d16_hi v229, v55 offset:476
  ds_read_u16_d16_hi v230, v54 offset:874
  ds_read_u16_d16_hi v231, v55 offset:1124
  s_waitcnt lgkmcnt(12)
  v_add_f32 v85, v218, v219
  v_add_f32 v84, v216, v217
  v_max3_f32 v62, v62, abs(v84), abs(v85)
  ds_read_u16_d16_hi v232, v54 offset:250
  ds_read_u16_d16_hi v233, v55 offset:1100
  ds_read_u16_d16_hi v234, v54 offset:850
  ds_read_u16_d16_hi v235, v55 offset:500
  s_waitcnt lgkmcnt(12)
  v_add_f32 v87, v222, v223
  v_add_f32 v86, v220, v221
  v_max3_f32 v62, v62, abs(v86), abs(v87)
  ds_read_u16_d16_hi v236, v54 offset:418
  ds_read_u16_d16_hi v237, v55 offset:68
  ds_read_u16_d16_hi v238, v54 offset:1066
  ds_read_u16_d16_hi v239, v55 offset:716
  s_waitcnt lgkmcnt(12)
  v_add_f32 v89, v226, v227
  v_add_f32 v88, v224, v225
  v_max3_f32 v62, v62, abs(v88), abs(v89)
  ds_read_u16_d16_hi v216, v54 offset:442
  ds_read_u16_d16_hi v217, v55 offset:692
  ds_read_u16_d16_hi v218, v54 offset:1042
  ds_read_u16_d16_hi v219, v55 offset:92
  s_waitcnt lgkmcnt(12)
  v_add_f32 v91, v230, v231
  v_add_f32 v90, v228, v229
  v_max3_f32 v62, v62, abs(v90), abs(v91)
  ds_read_u16_d16_hi v220, v54 offset:426
  ds_read_u16_d16_hi v221, v55 offset:276
  ds_read_u16_d16_hi v222, v54 offset:1074
  ds_read_u16_d16_hi v223, v55 offset:924
  s_waitcnt lgkmcnt(12)
  v_add_f32 v93, v234, v235
  v_add_f32 v92, v232, v233
  v_max3_f32 v62, v62, abs(v92), abs(v93)
  ds_read_u16_d16_hi v224, v54 offset:450
  ds_read_u16_d16_hi v225, v55 offset:900
  ds_read_u16_d16_hi v226, v54 offset:1050
  ds_read_u16_d16_hi v227, v55 offset:300
  s_waitcnt lgkmcnt(12)
  v_add_f32 v95, v238, v239
  v_add_f32 v94, v236, v237
  v_max3_f32 v62, v62, abs(v94), abs(v95)
  ds_read_u16_d16_hi v228, v54 offset:434
  ds_read_u16_d16_hi v229, v55 offset:484
  ds_read_u16_d16_hi v230, v54 offset:1082
  ds_read_u16_d16_hi v231, v55 offset:1132
  s_waitcnt lgkmcnt(12)
  v_add_f32 v97, v218, v219
  v_add_f32 v96, v216, v217
  v_max3_f32 v62, v62, abs(v96), abs(v97)
  ds_read_u16_d16_hi v232, v54 offset:458
  ds_read_u16_d16_hi v233, v55 offset:1108
  ds_read_u16_d16_hi v234, v54 offset:1058
  ds_read_u16_d16_hi v235, v55 offset:508
  s_waitcnt lgkmcnt(12)
  v_add_f32 v99, v222, v223
  v_add_f32 v98, v220, v221
  v_max3_f32 v62, v62, abs(v98), abs(v99)
  ds_read_u16_d16_hi v236, v56 offset:4
  ds_read_u16_d16_hi v237, v57 offset:104
  ds_read_u16_d16_hi v238, v58 offset:652
  ds_read_u16_d16_hi v239, v59 offset:752
  s_waitcnt lgkmcnt(12)
  v_add_f32 v101, v226, v227
  v_add_f32 v100, v224, v225
  v_max3_f32 v62, v62, abs(v100), abs(v101)
  s_waitcnt lgkmcnt(8)
  v_add_f32 v103, v230, v231
  v_add_f32 v102, v228, v229
  v_max3_f32 v62, v62, abs(v102), abs(v103)
  s_waitcnt lgkmcnt(4)
  v_add_f32 v105, v234, v235
  v_add_f32 v104, v232, v233
  v_max3_f32 v62, v62, abs(v104), abs(v105)
  s_waitcnt lgkmcnt(0)
  v_add_f32 v107, v238, v239
  v_add_f32 v106, v236, v237
  v_max3_f32 v62, v62, abs(v106), abs(v107)
  s_cmp_lg_u32 s97, 0
  s_cbranch_scc1 L_uconv0
L_chunk3:
  ds_read_u16_d16_hi v216, v56 offset:220
  ds_read_u16_d16_hi v217, v57 offset:320
  ds_read_u16_d16_hi v218, v58 offset:868
  ds_read_u16_d16_hi v219, v59 offset:968
  ds_read_u16_d16_hi v220, v56 offset:436
  ds_read_u16_d16_hi v221, v57 offset:536
  ds_read_u16_d16_hi v222, v58 offset:1084
  ds_read_u16_d16_hi v223, v59 offset:1184
  ds_read_u16_d16_hi v224, v56 offset:12
  ds_read_u16_d16_hi v225, v57 offset:312
  ds_read_u16_d16_hi v226, v58 offset:660
  ds_read_u16_d16_hi v227, v59 offset:960
  ds_read_u16_d16_hi v228, v58 offset:36
  ds_read_u16_d16_hi v229, v59 offset:936
  ds_read_u16_d16_hi v230, v56 offset:636
  ds_read_u16_d16_hi v231, v57 offset:336
  s_waitcnt lgkmcnt(12)
  v_add_f32 v109, v218, v219
  v_add_f32 v108, v216, v217
  v_max3_f32 v62, v62, abs(v108), abs(v109)
  ds_read_u16_d16_hi v232, v56 offset:20
  ds_read_u16_d16_hi v233, v57 offset:520
  ds_read_u16_d16_hi v234, v58 offset:668
  ds_read_u16_d16_hi v235, v59 offset:1168
  s_waitcnt lgkmcnt(12)
  v_add_f32 v111, v222, v223
  v_add_f32 v110, v220, v221
  v_max3_f32 v62, v62, abs(v110), abs(v111)
  ds_read_u16_d16_hi v236, v58 offset:44
  ds_read_u16_d16_hi v237, v59 offset:1144
  ds_read_u16_d16_hi v238, v56 offset:644
  ds_read_u16_d16_hi v239, v57 offset:544
  s_waitcnt lgkmcnt(12)
  v_add_f32 v113, v226, v227
  v_add_f32 v112, v224, v225
  v_max3_f32 v62, v62, abs(v112), abs(v113)
  ds_read_u16_d16_hi v216, v56 offset:228
  ds_read_u16_d16_hi v217, v57 offset:528
  ds_read_u16_d16_hi v218, v58 offset:876
  ds_read_u16_d16_hi v219, v59 offset:1176
  s_waitcnt lgkmcnt(12)
  v_add_f32 v115, v230, v231
  v_add_f32 v114, v228, v229
  v_max3_f32 v62, v62, abs(v114), abs(v115)
  ds_read_u16_d16_hi v220, v58 offset:252
  ds_read_u16_d16_hi v221, v59 offset:1152
  ds_read_u16_d16_hi v222, v56 offset:852
  ds_read_u16_d16_hi v223, v57 offset:552
  s_waitcnt lgkmcnt(12)
  v_add_f32 v117, v234, v235
  v_add_f32 v116, v232, v233
  v_max3_f32 v62, v62, abs(v116), abs(v117)
  ds_read_u16_d16_hi v224, v65 offset:0
  ds_read_u16_d16_hi v225, v65 offset:8
  ds_read_u16_d16_hi v226, v65 offset:16
  ds_read_u16_d16_hi v227, v65 offset:24
  ds_read_u16_d16_hi v228, v65 offset:32
  ds_read_u16_d16_hi v229, v65 offset:40
  ds_read_u16_d16_hi v230, v64 offset:48
  ds_read_u16_d16_hi v231, v67
  s_waitcnt lgkmcnt(14)
  v_add_f32 v119, v238, v239
  v_add_f32 v118, v236, v237
  v_max3_f32 v62, v62, abs(v118), abs(v119)
  s_waitcnt lgkmcnt(12)
  v_add_f32 v121, v218, v219
  v_add_f32 v120, v216, v217
  v_max3_f32 v62, v62, abs(v120), abs(v121)
  s_waitcnt lgkmcnt(8)
  v_add_f32 v123, v222, v223
  v_add_f32 v122, v220, v221
  v_max3_f32 v62, v62, abs(v122), abs(v123)
  s_cmp_lg_u32 s97, 0
  s_cbranch_scc1 L_uconv1
L_w1conv:
  v_max_u32_dpp v62, v62, v62 row_shr:1 row_mask:0xf bank_mask:0xf
  s_nop 1
  v_max_u32_dpp v62, v62, v62 row_shr:2 row_mask:0xf bank_mask:0xf
  s_nop 1
  v_max_u32_dpp v62, v62, v62 row_shr:4 row_mask:0xf bank_mask:0xf
  s_nop 1
  v_max_u32_dpp v62, v62, v62 row_shr:8 row_mask:0xf bank_mask:0xf
  s_nop 1
  v_max_u32_dpp v62, v62, v62 row_bcast:15 row_mask:0xa bank_mask:0xf
  s_nop 1
  v_max_u32_dpp v62, v62, v62 row_bcast:31 row_mask:0xc bank_mask:0xf
  s_nop 0
  v_readlane_b32 s68, v62, 63
  s_nop 1
  v_mov_b32 v62, s68
  ds_max_u32 v1, v62 offset:20
  ds_add_u32 v1, v3 offset:16
  v_add_u32 v49, v49, v247
  v_add_u32 v50, v50, v247
  v_add_u32 v51, v51, v247
  v_add_u32 v52, v52, v247
  v_add_u32 v53, v53, v247
  v_add_u32 v54, v54, v247
  v_add_u32 v55, v55, v247
  v_add_u32 v56, v56, v247
  v_add_u32 v57, v57, v247
  v_add_u32 v58, v58, v247
  v_add_u32 v59, v59, v247
  v_add_u32 v60, v60, v247
  v_add_u32 v61, v61, v247
L_csync5:
  ds_read_b64 v[40:41], v2 offset:16
  s_waitcnt lgkmcnt(0)
  v_cmp_gt_u32 vcc, 4, v40
  s_cbranch_vccnz L_csync5
  v_readfirstlane_b32 s70, v41
  s_nop 0
  s_lshr_b32 s70, s70, 23
  s_sub_i32 s70, 141, s70
  s_min_i32 s70, s70, 40
  s_add_i32 s51, s70, 127
  s_lshl_b32 s51, s51, 23
  v_fma_mixlo_f16 v132, v84, s51, 0
  v_fma_mixlo_f16 v133, v86, s51, 0
  v_fma_mixlo_f16 v134, v88, s51, 0
  v_fma_mixlo_f16 v135, v90, s51, 0
  v_fma_mixhi_f16 v132, v85, s51, 0
  v_fma_mixhi_f16 v133, v87, s51, 0
  v_fma_mixhi_f16 v134, v89, s51, 0
  v_fma_mixhi_f16 v135, v91, s51, 0
  v_fma_mixlo_f16 v136, v92, s51, 0
  v_fma_mixlo_f16 v137, v94, s51, 0
  v_fma_mixlo_f16 v138, v96, s51, 0
  v_fma_mixlo_f16 v139, v98, s51, 0
  v_fma_mixhi_f16 v136, v93, s51, 0
  v_fma_mixhi_f16 v137, v95, s51, 0
  v_fma_mixhi_f16 v138, v97, s51, 0
  v_fma_mixhi_f16 v139, v99, s51, 0
  ds_write_b128 v63, v[132:135] offset:0
  v_fma_mixlo_f16 v140, v100, s51, 0
  v_fma_mixlo_f16 v141, v102, s51, 0
  v_fma_mixlo_f16 v142, v104, s51, 0
  v_fma_mixlo_f16 v143, v106, s51, 0
  v_fma_mixhi_f16 v140, v101, s51, 0
  v_fma_mixhi_f16 v141, v103, s51, 0
  v_fma_mixhi_f16 v142, v105, s51, 0
  v_fma_mixhi_f16 v143, v107, s51, 0
  ds_write_b128 v63, v[136:139] offset:1024
  v_fma_mixlo_f16 v144, v108, s51, 0
  v_fma_mixlo_f16 v145, v110, s51, 0
  v_fma_mixlo_f16 v146, v112, s51, 0
  v_fma_mixlo_f16 v147, v114, s51, 0
  v_fma_mixhi_f16 v144, v109, s51, 0
  v_fma_mixhi_f16 v145, v111, s51, 0
  v_fma_mixhi_f16 v146, v113, s51, 0
  v_fma_mixhi_f16 v147, v115, s51, 0
  ds_write_b128 v63, v[140:143] offset:2048
  v_fma_mixlo_f16 v148, v116, s51, 0
  v_fma_mixlo_f16 v149, v118, s51, 0
  v_fma_mixlo_f16 v150, v120, s51, 0
  v_fma_mixlo_f16 v151, v122, s51, 0
  v_fma_mixhi_f16 v148, v117, s51, 0
  v_fma_mixhi_f16 v149, v119, s51, 0
  v_fma_mixhi_f16 v150, v121, s51, 0
  v_fma_mixhi_f16 v151, v123, s51, 0
  ds_write_b128 v63, v[144:147] offset:3072
  ds_write_b128 v63, v[148:151] offset:4096
  s_cmp_ge_u32 s79, 2
  s_cbranch_scc1 L_w1x
  v_fma_mixlo_f16 v152, v124, s51, 0
  v_fma_mixlo_f16 v153, v126, s51, 0
  v_fma_mixlo_f16 v154, v128, s51, 0
  v_fma_mixlo_f16 v155, v130, s51, 0
  v_fma_mixhi_f16 v152, v125, s51, 0
  v_fma_mixhi_f16 v153, v127, s51, 0
  v_fma_mixhi_f16 v154, v129, s51, 0
  v_fma_mixhi_f16 v155, v131, s51, 0
  ds_write_b128 v63, v[152:155] offset:5120
L_w1x:
L_uph:
L_csync6:
  ds_read_b64 v[40:41], v2 offset:24
  s_waitcnt lgkmcnt(0)
  v_cmp_gt_u32 vcc, 4, v40
  s_cbranch_vccnz L_csync6
  v_readfirstlane_b32 s71, v41
  s_nop 0
  s_lshr_b32 s71, s71, 23
  s_sub_i32 s71, 140, s71
  s_min_i32 s71, s71, 40
  s_add_i32 s51, s71, 127
  s_lshl_b32 s51, s51, 23
  s_mov_b32 s97, 1
  s_lshr_b32 s69, s3, 1
  s_cmp_eq_u32 s69, 0
  s_cbranch_scc1 L_chunk0
  s_cmp_eq_u32 s69, 1
  s_cbranch_scc1 L_chunk1
  s_cmp_eq_u32 s69, 2
  s_cbranch_scc1 L_chunk2
  s_branch L_chunk3
L_uconv0:
  v_fma_mixlo_f16 v132, v84, s51, 0
  v_fma_mixlo_f16 v133, v86, s51, 0
  v_fma_mixlo_f16 v134, v88, s51, 0
  v_fma_mixlo_f16 v135, v90, s51, 0
  v_fma_mixhi_f16 v132, v85, s51, 0
  v_fma_mixhi_f16 v133, v87, s51, 0
  v_fma_mixhi_f16 v134, v89, s51, 0
  v_fma_mixhi_f16 v135, v91, s51, 0
L_csync7:
  ds_read_b64 v[40:41], v2 offset:16
  s_waitcnt lgkmcnt(0)
  v_cmp_gt_u32 vcc, 4, v40
  s_cbranch_vccnz L_csync7
  v_readfirstlane_b32 s70, v41
  s_nop 0
  s_lshr_b32 s70, s70, 23
  s_sub_i32 s70, 141, s70
  s_min_i32 s70, s70, 40
  ds_write_b128 v66, v[132:135] offset:0
  v_fma_mixlo_f16 v136, v92, s51, 0
  v_fma_mixlo_f16 v137, v94, s51, 0
  v_fma_mixlo_f16 v138, v96, s51, 0
  v_fma_mixlo_f16 v139, v98, s51, 0
  v_fma_mixhi_f16 v136, v93, s51, 0
  v_fma_mixhi_f16 v137, v95, s51, 0
  v_fma_mixhi_f16 v138, v97, s51, 0
  v_fma_mixhi_f16 v139, v99, s51, 0
  ds_write_b128 v66, v[136:139] offset:1024
  v_fma_mixlo_f16 v140, v100, s51, 0
  v_fma_mixlo_f16 v141, v102, s51, 0
  v_fma_mixlo_f16 v142, v104, s51, 0
  v_fma_mixlo_f16 v143, v106, s51, 0
  v_fma_mixhi_f16 v140, v101, s51, 0
  v_fma_mixhi_f16 v141, v103, s51, 0
  v_fma_mixhi_f16 v142, v105, s51, 0
  v_fma_mixhi_f16 v143, v107, s51, 0
  ds_write_b128 v66, v[140:143] offset:2048
  s_branch L_built
L_uconv1:
  v_fma_mixlo_f16 v144, v108, s51, 0
  v_fma_mixlo_f16 v145, v110, s51, 0
  v_fma_mixlo_f16 v146, v112, s51, 0
  v_fma_mixlo_f16 v147, v114, s51, 0
  v_fma_mixhi_f16 v144, v109, s51, 0
  v_fma_mixhi_f16 v145, v111, s51, 0
  v_fma_mixhi_f16 v146, v113, s51, 0
  v_fma_mixhi_f16 v147, v115, s51, 0
L_csync8:
  ds_read_b64 v[40:41], v2 offset:16
  s_waitcnt lgkmcnt(0)
  v_cmp_gt_u32 vcc, 4, v40
  s_cbranch_vccnz L_csync8
  v_readfirstlane_b32 s70, v41
  s_nop 0
  s_lshr_b32 s70, s70, 23
  s_sub_i32 s70, 141, s70
  s_min_i32 s70, s70, 40
  ds_write_b128 v66, v[144:147] offset:3072
  v_fma_mixlo_f16 v148, v116, s51, 0
  v_fma_mixlo_f16 v149, v118, s51, 0
  v_fma_mixlo_f16 v150, v120, s51, 0
  v_fma_mixlo_f16 v151, v122, s51, 0
  v_fma_mixhi_f16 v148, v117, s51, 0
  v_fma_mixhi_f16 v149, v119, s51, 0
  v_fma_mixhi_f16 v150, v121, s51, 0
  v_fma_mixhi_f16 v151, v123, s51, 0
  ds_write_b128 v66, v[148:151] offset:4096
  s_cmp_lg_u32 s84, 0
  s_cbranch_scc1 L_ulin
  v_fma_mixlo_f16 v152, v124, s51, 0
  v_fma_mixlo_f16 v153, v126, s51, 0
  v_fma_mixlo_f16 v154, v128, s51, 0
  v_fma_mixlo_f16 v155, v130, s51, 0
  v_fma_mixhi_f16 v152, v125, s51, 0
  v_fma_mixhi_f16 v153, v127, s51, 0
  v_fma_mixhi_f16 v154, v129, s51, 0
  v_fma_mixhi_f16 v155, v131, s51, 0
  ds_write_b128 v66, v[152:155] offset:5120
  s_branch L_built
L_ulin:
  v_mul_f32 v224, s51, v224
  v_mul_f32 v225, s51, v225
  v_mul_f32 v226, s51, v226
  v_mul_f32 v227, s51, v227
  v_mul_f32 v228, s51, v228
  v_mul_f32 v229, s51, v229
  v_mul_f32 v230, s51, v230
  v_mul_f32 v231, s51, v231
  v_cvt_pk_bf16_f32 v152, v224, v225
  v_cvt_pk_bf16_f32 v153, v226, v227
  v_cvt_pk_bf16_f32 v154, v228, v229
  v_cvt_pk_bf16_f32 v155, v230, v231
  ds_write_b128 v66, v[152:155] offset:5120
L_built:
  s_waitcnt vmcnt(1)
  v_mov_b32 v4, s84
  ds_add_u32 v1, v4 offset:36
  s_mov_b32 s60, s24
  s_and_b32 s61, s25, 0xffff
  s_mov_b32 s62, 268435456
  s_mov_b32 s63, 0x20000
  s_mov_b32 s64, s22
  s_and_b32 s65, s23, 0xffff
  s_mov_b32 s66, 256
  s_mov_b32 s67, 0x20000
  v_lshlrev_b32 v251, 2, v0
  s_mov_b64 exec, 0xff
  s_mov_b32 s81, 0x80000
  buffer_load_dword v255, v251, s[60:63], s81 offen
  buffer_load_dword v250, v251, s[64:67], 0 offen offset:128 sc1
  s_mov_b64 exec, -1
  v_mov_b32 v251, 0
  s_add_i32 s48, s70, s71
L_csync9:
  ds_read_b32 v4, v2 offset:36
  s_waitcnt lgkmcnt(0)
  v_cmp_gt_u32 vcc, 4, v4
  s_cbranch_vccnz L_csync9
  ds_read_u16_d16_hi v32, v7 offset:0
  ds_read_u16_d16_hi v33, v7 offset:128
  ds_read_u16_d16_hi v34, v7 offset:256
  ds_read_u16_d16_hi v35, v7 offset:384
  ds_read_u16_d16_hi v36, v7 offset:512
  ds_read_u16_d16_hi v37, v7 offset:640
  ds_read_u16_d16_hi v38, v7 offset:768
  ds_read_u16_d16_hi v39, v7 offset:896
  s_waitcnt lgkmcnt(0)
  v_cvt_pk_f16_f32 v43, v38, v39
  v_cvt_pk_f16_f32 v40, v32, v35
  v_cvt_pk_f16_f32 v41, v33, v36
  v_cvt_pk_f16_f32 v42, v34, v37
  ds_write_b128 v10, v[40:43]
  ds_read_b64_tr_b16 v[52:53], v8 offset:0
  ds_read_b64_tr_b16 v[54:55], v8 offset:512
  v_pk_mul_f16 v56, v40, v40 op_sel:[0,0] op_sel_hi:[1,1]
  v_pk_mul_f16 v57, v41, v41 op_sel:[0,0] op_sel_hi:[1,1]
  v_pk_mul_f16 v58, v42, v42 op_sel:[0,0] op_sel_hi:[1,1]
  v_pk_mul_f16 v59, v40, v41 op_sel:[0,0] op_sel_hi:[1,1]
  ds_read_b128 v[44:47], v11
  ds_read_b128 v[48:51], v12
  v_pk_mul_f16 v60, v40, v41 op_sel:[0,1] op_sel_hi:[1,0]
  v_pk_mul_f16 v61, v40, v42 op_sel:[0,0] op_sel_hi:[1,1]
  s_mov_b64 exec, 131071
  buffer_load_dword v255, v19, s[44:47], s101 offen
  s_mov_b64 exec, -1
  s_add_u32 s101, s101, 1171456
  s_waitcnt lgkmcnt(0)
  s_barrier
  s_setprio 1
  ds_read_b128 v[216:219], v22
  ds_read_b128 v[240:243], v28 offset:46528
  ds_read_b128 v[128:131], v28 offset:35264
  ds_read_b128 v[84:87], v28 offset:0
  ds_read_b128 v[244:247], v30 offset:22528
  ds_read_b128 v[172:175], v31 offset:11264
  ds_read_b128 v[176:179], v31 offset:12288
  ds_read_b128 v[180:183], v31 offset:13312
  ds_read2_b32 v[220:221], v29 offset0:0 offset1:2
  ds_read2_b32 v[222:223], v29 offset0:64 offset1:66
  v_add_u32 v29, 2048, v29
  ds_read_b128 v[88:91], v28 offset:1024
  s_cmp_lg_u32 s84, 0
  s_cbranch_scc1 L_prf
  s_setprio 2
L_prf:
  s_waitcnt lgkmcnt(10)
  v_mfma_f32_16x16x32_f16 v[80:83], v[216:219], v[56:59], 0
  ds_read_b128 v[92:95], v28 offset:2048
  s_waitcnt lgkmcnt(10)
  v_mfma_f32_16x16x32_bf16 v[72:75], v[240:243], v[52:55], 0
  ds_read_b128 v[132:135], v28 offset:36288
  v_pk_mul_f16 v62, v40, v42 op_sel:[0,1] op_sel_hi:[1,0]
  v_pk_mul_f16 v63, v41, v42 op_sel:[0,0] op_sel_hi:[1,1]
  s_waitcnt lgkmcnt(10)
  v_mfma_f32_16x16x32_f16 v[72:75], v[128:131], v[56:59], v[72:75]
  ds_read_b128 v[136:139], v28 offset:37312
  s_waitcnt lgkmcnt(10)
  v_mfma_f32_16x16x32_f16 v[68:71], v[84:87], v[56:59], 0
  ds_read_b128 v[140:143], v28 offset:38336
  v_pk_mul_f16 v64, v41, v42 op_sel:[0,1] op_sel_hi:[1,0]
  s_waitcnt lgkmcnt(10)
  v_mfma_f32_16x16x32_bf16 v[76:79], v[244:247], v[52:55], 0
  ds_read_b128 v[144:147], v28 offset:39360
  v_pk_mul_f16 v65, v40, v43 op_sel:[0,0] op_sel_hi:[1,0]
  v_pk_mul_f16 v66, v41, v43 op_sel:[0,0] op_sel_hi:[1,0]
  s_waitcnt lgkmcnt(10)
  v_mfma_f32_16x16x32_f16 v[76:79], v[172:175], v[56:59], v[76:79]
  ds_read2_b32 v[224:225], v29 offset0:0 offset1:2
  ds_read2_b32 v[226:227], v29 offset0:64 offset1:66
  v_add_u32 v29, 2048, v29
  v_pk_mul_f16 v67, v42, v43 op_sel:[0,0] op_sel_hi:[1,0]
  s_waitcnt lgkmcnt(11)
  v_mfma_f32_16x16x32_f16 v[76:79], v[176:179], v[60:63], v[76:79]
  ds_read_b128 v[96:99], v28 offset:3072
  v_mul_f16_sdwa v52, v40, v40 dst_sel:WORD_0 dst_unused:UNUSED_PAD src0_sel:WORD_0 src1_sel:WORD_1
  v_mul_f16_sdwa v53, v42, v42 dst_sel:WORD_0 dst_unused:UNUSED_PAD src0_sel:WORD_0 src1_sel:WORD_1
  s_waitcnt lgkmcnt(11)
  v_mfma_f32_16x16x32_f16 v[76:79], v[180:183], v[64:67], v[76:79]
  ds_read_b128 v[100:103], v28 offset:4096
  v_alignbit_b32 v48, v48, v48, v13
  s_waitcnt lgkmcnt(10)
  v_smfmac_f32_16x16x64_f16 v[80:83], v[220:223], v[60:67], v16
  ds_read_b128 v[184:187], v31 offset:14336
  v_mul_f16_sdwa v52, v41, v41 dst_sel:WORD_1 dst_unused:UNUSED_PRESERVE src0_sel:WORD_0 src1_sel:WORD_1
  v_mul_f16_sdwa v53, v43, v43 dst_sel:WORD_1 dst_unused:UNUSED_PRESERVE src0_sel:WORD_0 src1_sel:WORD_1
  s_waitcnt lgkmcnt(10)
  v_mfma_f32_16x16x32_f16 v[68:71], v[88:91], v[60:63], v[68:71]
  ds_read_b128 v[188:191], v31 offset:15360
  v_pk_mul_f16 v54, v40, v47 op_sel:[0,0] op_sel_hi:[1,0]
  s_waitcnt lgkmcnt(10)
  v_mfma_f32_16x16x32_f16 v[68:71], v[92:95], v[64:67], v[68:71]
  ds_read_b128 v[192:195], v31 offset:16384
  v_pk_mul_f16 v55, v41, v47 op_sel:[0,0] op_sel_hi:[1,0]
  v_pk_mul_f16 v56, v42, v47 op_sel:[0,0] op_sel_hi:[1,0]
  s_waitcnt lgkmcnt(10)
  v_mfma_f32_16x16x32_f16 v[72:75], v[132:135], v[60:63], v[72:75]
  ds_read_b128 v[196:199], v31 offset:17408
  v_pk_mul_f16 v57, v40, v44 op_sel:[0,0] op_sel_hi:[1,1]
  v_pk_mul_f16 v58, v40, v44 op_sel:[0,1] op_sel_hi:[1,0]
  s_waitcnt lgkmcnt(10)
  v_mfma_f32_16x16x32_f16 v[72:75], v[136:139], v[64:67], v[72:75]
  ds_read2_b32 v[228:229], v29 offset0:0 offset1:2
  ds_read2_b32 v[230:231], v29 offset0:64 offset1:66
  v_add_u32 v29, 2048, v29
  v_pk_mul_f16 v59, v40, v45 op_sel:[0,0] op_sel_hi:[1,1]
  s_waitcnt lgkmcnt(11)
  v_mfma_f32_16x16x32_f16 v[72:75], v[140:143], v[52:55], v[72:75]
  ds_read_b128 v[104:107], v28 offset:5120
  v_pk_mul_f16 v60, v40, v45 op_sel:[0,1] op_sel_hi:[1,0]
  v_pk_mul_f16 v61, v40, v46 op_sel:[0,0] op_sel_hi:[1,1]
  s_waitcnt lgkmcnt(11)
  v_mfma_f32_16x16x32_f16 v[72:75], v[144:147], v[56:59], v[72:75]
  ds_read_b128 v[108:111], v28 offset:6144
  v_pk_mul_f16 v62, v40, v46 op_sel:[0,1] op_sel_hi:[1,0]
  s_waitcnt lgkmcnt(10)
  v_smfmac_f32_16x16x64_f16 v[80:83], v[224:227], v[52:59], v16
  ds_read_b128 v[148:151], v28 offset:40384
  v_pk_mul_f16 v63, v41, v44 op_sel:[0,0] op_sel_hi:[1,1]
  v_pk_mul_f16 v64, v41, v44 op_sel:[0,1] op_sel_hi:[1,0]
  s_waitcnt lgkmcnt(10)
  v_mfma_f32_16x16x32_f16 v[68:71], v[96:99], v[52:55], v[68:71]
  ds_read_b128 v[152:155], v28 offset:41408
  v_pk_mul_f16 v65, v41, v45 op_sel:[0,0] op_sel_hi:[1,1]
  s_waitcnt lgkmcnt(10)
  v_mfma_f32_16x16x32_f16 v[68:71], v[100:103], v[56:59], v[68:71]
  ds_read_b128 v[156:159], v28 offset:42432
  v_pk_mul_f16 v66, v41, v45 op_sel:[0,1] op_sel_hi:[1,0]
  v_pk_mul_f16 v67, v41, v46 op_sel:[0,0] op_sel_hi:[1,1]
  ds_write_b16 v15, v14 offset:4064
  s_waitcnt vmcnt(1)
  v_cmp_eq_u32 vcc, 0, v250
  s_nop 0
  s_and_b32 vcc_lo, vcc_lo, 0xff
  s_cbranch_scc0 L_cclr_ok
  s_mov_b32 s78, 0x40000
L_cclr:
  s_sub_u32 s78, s78, 1
  s_cbranch_scc1 L_cclr_ok
  v_lshlrev_b32 v250, 2, v0
  v_and_b32 v250, 31, v250
  buffer_load_dword v250, v250, s[64:67], 0 offen offset:128 sc1
  s_waitcnt vmcnt(0)
  v_cmp_eq_u32 vcc, 0, v250
  s_nop 0
  s_and_b32 vcc_lo, vcc_lo, 0xff
  s_cbranch_scc1 L_cclr
L_cclr_ok:
  v_lshl_add_u32 v24, v24, 7, v18
  v_lshl_add_u32 v25, v25, 7, v18
  s_mov_b32 exec_hi, 0x0000ffff
  v_lshl_add_u32 v26, v26, 7, v18
  v_lshl_add_u32 v27, v27, 7, v18
  s_mov_b32 exec_lo, 0
  s_mov_b32 exec_hi, 0xffff0000
  v_mov_b32 v27, v25
  v_mov_b32 v26, v25
  s_mov_b32 exec_hi, 0x00ff0000
  v_mov_b32 v26, v24
  s_mov_b64 exec, -1
  s_add_u32 m0, s74, -39488
  s_nop 0
  buffer_load_dwordx4 v24, s[32:35], 0 offen lds
  s_add_u32 m0, s74, -38432
  s_nop 0
  buffer_load_dwordx4 v25, s[32:35], 0 offen lds
  s_add_u32 m0, s74, -37376
  s_nop 0
  buffer_load_dwordx4 v26, s[32:35], 0 offen lds
  s_add_u32 m0, s74, -36320
  s_mov_b32 exec_hi, 0x00ffffff
  buffer_load_dwordx4 v27, s[32:35], 0 offen lds
  s_mov_b32 exec_hi, -1
  s_mov_b64 exec, 131071
  buffer_load_dword v255, v19, s[44:47], s101 offen
  s_mov_b64 exec, -1
  s_add_u32 s101, s101, 1171456
  s_sub_i32 s48, 0, s48
  s_mov_b32 s49, s48
  s_mov_b32 s97, 1
  s_mov_b32 s50, 1
  s_cmp_lg_u32 s3, 7
  s_cbranch_scc1 L_nw0
  s_mov_b32 s52, s16
  s_and_b32 s53, s17, 0xffff
  s_mov_b32 s54, 3328
  s_mov_b32 s55, 0x20000
  v_lshlrev_b32 v22, 7, v0
  buffer_load_dword v255, v22, s[52:55], 0 offen
L_nw0:
  s_waitcnt lgkmcnt(11)
  v_mfma_f32_16x16x32_f16 v[76:79], v[184:187], v[52:55], v[76:79]
  ds_read_b128 v[160:163], v28 offset:43456
  v_alignbit_b32 v49, v49, v49, v13
  v_alignbit_b32 v50, v50, v50, v13
  s_waitcnt lgkmcnt(11)
  v_mfma_f32_16x16x32_f16 v[76:79], v[188:191], v[56:59], v[76:79]
  ds_read2_b32 v[232:233], v29 offset0:0 offset1:2
  ds_read2_b32 v[234:235], v29 offset0:64 offset1:66
  v_add_u32 v29, 2048, v29
  v_pk_mul_f16 v52, v41, v46 op_sel:[0,1] op_sel_hi:[1,0]
  v_pk_mul_f16 v53, v42, v44 op_sel:[0,0] op_sel_hi:[1,1]
  s_waitcnt lgkmcnt(12)
  v_mfma_f32_16x16x32_f16 v[76:79], v[192:195], v[60:63], v[76:79]
  ds_read_b128 v[112:115], v28 offset:7168
  v_pk_mul_f16 v54, v42, v44 op_sel:[0,1] op_sel_hi:[1,0]
  v_pk_mul_f16 v55, v42, v45 op_sel:[0,0] op_sel_hi:[1,1]
  s_waitcnt lgkmcnt(12)
  v_mfma_f32_16x16x32_f16 v[76:79], v[196:199], v[64:67], v[76:79]
  ds_read_b128 v[116:119], v28 offset:8192
  v_pk_mul_f16 v56, v42, v45 op_sel:[0,1] op_sel_hi:[1,0]
  v_pk_mul_f16 v57, v42, v46 op_sel:[0,0] op_sel_hi:[1,1]
  s_waitcnt lgkmcnt(11)
  v_smfmac_f32_16x16x64_f16 v[80:83], v[228:231], v[60:67], v16
  ds_read_b128 v[200:203], v31 offset:18432
  v_pk_mul_f16 v58, v42, v46 op_sel:[0,1] op_sel_hi:[1,0]
  v_pk_mul_f16 v59, v40, v48 op_sel:[0,0] op_sel_hi:[1,1]
  s_waitcnt lgkmcnt(11)
  v_mfma_f32_16x16x32_f16 v[68:71], v[104:107], v[60:63], v[68:71]
  ds_read_b128 v[204:207], v31 offset:19456
  ds_read_u16_d16_hi v32, v7 offset:32
  ds_read_u16_d16_hi v33, v7 offset:160
  s_waitcnt lgkmcnt(13)
  v_mfma_f32_16x16x32_f16 v[68:71], v[108:111], v[64:67], v[68:71]
  ds_read_b128 v[164:167], v28 offset:44480
  ds_read_u16_d16_hi v34, v7 offset:288
  ds_read_u16_d16_hi v35, v7 offset:416
  s_waitcnt lgkmcnt(14)
  v_mfma_f32_16x16x32_f16 v[72:75], v[148:151], v[60:63], v[72:75]
  ds_read_b128 v[168:171], v28 offset:45504
  ds_read_u16_d16_hi v36, v7 offset:544
  ds_read_u16_d16_hi v37, v7 offset:672
  v_mfma_f32_16x16x32_f16 v[72:75], v[152:155], v[64:67], v[72:75]
  ds_read2_b32 v[236:237], v29 offset0:0 offset1:2
  ds_read2_b32 v[238:239], v29 offset0:64 offset1:66
  v_add_u32 v29, 2048, v29
  ds_read_u16_d16_hi v38, v7 offset:800
  ds_read_u16_d16_hi v39, v7 offset:928
  s_waitcnt lgkmcnt(14)
  v_mfma_f32_16x16x32_f16 v[72:75], v[156:159], v[52:55], v[72:75]
  ds_read_b128 v[120:123], v28 offset:9216
  v_pk_mul_f16 v60, v41, v49 op_sel:[0,0] op_sel_hi:[1,1]
  v_pk_mul_f16 v61, v42, v50 op_sel:[0,0] op_sel_hi:[1,1]
  v_mfma_f32_16x16x32_f16 v[72:75], v[160:163], v[56:59], v[72:75]
  ds_read_b128 v[124:127], v28 offset:10240
  v_pk_mul_f16 v62, v40, v49 op_sel:[0,0] op_sel_hi:[1,1]
  v_pk_mul_f16 v63, v40, v49 op_sel:[0,1] op_sel_hi:[1,0]
  v_smfmac_f32_16x16x64_f16 v[80:83], v[232:235], v[52:59], v16
  ds_read_b128 v[208:211], v31 offset:20480
  v_pk_mul_f16 v64, v40, v50 op_sel:[0,0] op_sel_hi:[1,1]
  v_pk_mul_f16 v65, v40, v50 op_sel:[0,1] op_sel_hi:[1,0]
  v_mfma_f32_16x16x32_f16 v[68:71], v[112:115], v[52:55], v[68:71]
  ds_read_b128 v[212:215], v31 offset:21504
  v_pk_mul_f16 v66, v41, v50 op_sel:[0,0] op_sel_hi:[1,1]
  v_pk_mul_f16 v67, v41, v50 op_sel:[0,1] op_sel_hi:[1,0]
  v_mfma_f32_16x16x32_f16 v[68:71], v[116:119], v[56:59], v[68:71]
  s_waitcnt lgkmcnt(4)
  v_cvt_pk_f16_f32 v43, v38, v39
  v_cvt_pk_f16_f32 v40, v32, v35
  v_mfma_f32_16x16x32_f16 v[76:79], v[200:203], v[52:55], v[76:79]
  ds_read_b64_tr_b16 v[52:53], v8 offset:32
  ds_read_b64_tr_b16 v[54:55], v8 offset:544
  v_mfma_f32_16x16x32_f16 v[76:79], v[204:207], v[56:59], v[76:79]
  v_cvt_pk_f16_f32 v41, v33, v36
  v_cvt_pk_f16_f32 v42, v34, v37
  v_mfma_f32_16x16x32_f16 v[72:75], v[164:167], v[60:63], v[72:75]
  ds_write_b128 v10, v[40:43]
  v_mfma_f32_16x16x32_f16 v[72:75], v[168:171], v[64:67], v[72:75]
  v_pk_mul_f16 v56, v40, v40 op_sel:[0,0] op_sel_hi:[1,1]
  v_pk_mul_f16 v57, v41, v41 op_sel:[0,0] op_sel_hi:[1,1]
  v_smfmac_f32_16x16x64_f16 v[80:83], v[236:239], v[60:67], v16
  v_pk_mul_f16 v58, v42, v42 op_sel:[0,0] op_sel_hi:[1,1]
  v_pk_mul_f16 v59, v40, v41 op_sel:[0,0] op_sel_hi:[1,1]
  s_waitcnt lgkmcnt(6)
  v_mfma_f32_16x16x32_f16 v[68:71], v[120:123], v[60:63], v[68:71]
  ds_read_b128 v[44:47], v11
  ds_read_b128 v[48:51], v12
  s_waitcnt lgkmcnt(7)
  v_mfma_f32_16x16x32_f16 v[68:71], v[124:127], v[64:67], v[68:71]
  v_or3_b32 v15, v56, v57, v58
  s_waitcnt lgkmcnt(6)
  v_mfma_f32_16x16x32_f16 v[76:79], v[208:211], v[60:63], v[76:79]
  v_add_f32 v22, v80, v81
  v_add_f32 v23, v82, v83
  s_waitcnt lgkmcnt(5)
  v_mfma_f32_16x16x32_f16 v[76:79], v[212:215], v[64:67], v[76:79]
  v_pk_mul_f16 v60, v40, v41 op_sel:[0,1] op_sel_hi:[1,0]
  v_pk_mul_f16 v61, v40, v42 op_sel:[0,0] op_sel_hi:[1,1]
  ds_add_u32 v1, v3 offset:12
  s_branch L_grp1
L_prime:
  v_mov_b32 v68, 0
  v_mov_b32 v69, 0
  v_mov_b32 v70, 0
  v_mov_b32 v71, 0
  v_mov_b32 v72, 0
  v_mov_b32 v73, 0
  v_mov_b32 v74, 0
  v_mov_b32 v75, 0
  v_mov_b32 v76, 0
  v_mov_b32 v77, 0
  v_mov_b32 v78, 0
  v_mov_b32 v79, 0
  v_mov_b32 v80, 0
  v_mov_b32 v81, 0
  v_mov_b32 v82, 0
  v_mov_b32 v83, 0
  v_mov_b32 v22, 0
  v_mov_b32 v23, 0
  ds_read_u16_d16_hi v32, v7 offset:0
  ds_read_u16_d16_hi v33, v7 offset:128
  ds_read_u16_d16_hi v34, v7 offset:256
  ds_read_u16_d16_hi v35, v7 offset:384
  ds_read_u16_d16_hi v36, v7 offset:512
  ds_read_u16_d16_hi v37, v7 offset:640
  ds_read_u16_d16_hi v38, v7 offset:768
  ds_read_u16_d16_hi v39, v7 offset:896
  s_waitcnt lgkmcnt(0)
  v_cvt_pk_f16_f32 v43, v38, v39
  v_cvt_pk_f16_f32 v40, v32, v35
  v_cvt_pk_f16_f32 v41, v33, v36
  v_cvt_pk_f16_f32 v42, v34, v37
  ds_write_b128 v10, v[40:43]
  ds_read_b64_tr_b16 v[52:53], v8 offset:0
  ds_read_b64_tr_b16 v[54:55], v8 offset:512
  v_pk_mul_f16 v56, v40, v40 op_sel:[0,0] op_sel_hi:[1,1]
  v_pk_mul_f16 v57, v41, v41 op_sel:[0,0] op_sel_hi:[1,1]
  v_pk_mul_f16 v58, v42, v42 op_sel:[0,0] op_sel_hi:[1,1]
  v_pk_mul_f16 v59, v40, v41 op_sel:[0,0] op_sel_hi:[1,1]
  ds_read_b128 v[44:47], v11
  ds_read_b128 v[48:51], v12
  v_pk_mul_f16 v60, v40, v41 op_sel:[0,1] op_sel_hi:[1,0]
  v_pk_mul_f16 v61, v40, v42 op_sel:[0,0] op_sel_hi:[1,1]
L_cin_loop:
  s_cmp_lg_u32 s84, 0
  s_cbranch_scc1 L_pr0
  s_setprio 2
L_pr0:
  v_mfma_f32_16x16x32_f16 v[80:83], v[216:219], v[56:59], 0
  v_fmac_f32 v14, v68, v72
  v_fmac_f32 v14, v69, v73
  v_fmac_f32 v14, v70, v74
  v_fmac_f32 v14, v71, v75
  s_waitcnt lgkmcnt(2)
  v_mfma_f32_16x16x32_bf16 v[72:75], v[240:243], v[52:55], 0
  v_pk_mul_f16 v62, v40, v42 op_sel:[0,1] op_sel_hi:[1,0]
  v_pk_mul_f16 v63, v41, v42 op_sel:[0,0] op_sel_hi:[1,1]
  v_mfma_f32_16x16x32_f16 v[72:75], v[128:131], v[56:59], v[72:75]
  v_fmac_f32 v14, v76, v77
  v_fmac_f32 v14, v22, v78
  v_mfma_f32_16x16x32_f16 v[68:71], v[84:87], v[56:59], 0
  v_fmac_f32 v14, v23, v79
  v_pk_mul_f16 v64, v41, v42 op_sel:[0,1] op_sel_hi:[1,0]
  v_mfma_f32_16x16x32_bf16 v[76:79], v[244:247], v[52:55], 0
  v_pk_mul_f16 v65, v40, v43 op_sel:[0,0] op_sel_hi:[1,0]
  v_pk_mul_f16 v66, v41, v43 op_sel:[0,0] op_sel_hi:[1,0]
  v_mfma_f32_16x16x32_f16 v[76:79], v[172:175], v[56:59], v[76:79]
  v_pk_mul_f16 v67, v42, v43 op_sel:[0,0] op_sel_hi:[1,0]
  v_add_f32_dpp v14, v14, v14 row_shr:1 row_mask:0xf bank_mask:0xf
  v_mfma_f32_16x16x32_f16 v[76:79], v[176:179], v[60:63], v[76:79]
  v_mul_f16_sdwa v52, v40, v40 dst_sel:WORD_0 dst_unused:UNUSED_PAD src0_sel:WORD_0 src1_sel:WORD_1
  v_mul_f16_sdwa v53, v42, v42 dst_sel:WORD_0 dst_unused:UNUSED_PAD src0_sel:WORD_0 src1_sel:WORD_1
  v_mfma_f32_16x16x32_f16 v[76:79], v[180:183], v[64:67], v[76:79]
  v_add_f32_dpp v14, v14, v14 row_shr:2 row_mask:0xf bank_mask:0xf
  s_waitcnt lgkmcnt(0)
  v_alignbit_b32 v48, v48, v48, v13
  v_smfmac_f32_16x16x64_f16 v[80:83], v[220:223], v[60:67], v16
  v_mul_f16_sdwa v52, v41, v41 dst_sel:WORD_1 dst_unused:UNUSED_PRESERVE src0_sel:WORD_0 src1_sel:WORD_1
  v_mul_f16_sdwa v53, v43, v43 dst_sel:WORD_1 dst_unused:UNUSED_PRESERVE src0_sel:WORD_0 src1_sel:WORD_1
  v_mfma_f32_16x16x32_f16 v[68:71], v[88:91], v[60:63], v[68:71]
  v_add_f32_dpp v14, v14, v14 row_shr:4 row_mask:0xf bank_mask:0xf
  v_pk_mul_f16 v54, v40, v47 op_sel:[0,0] op_sel_hi:[1,0]
  v_mfma_f32_16x16x32_f16 v[68:71], v[92:95], v[64:67], v[68:71]
  v_pk_mul_f16 v55, v41, v47 op_sel:[0,0] op_sel_hi:[1,0]
  v_pk_mul_f16 v56, v42, v47 op_sel:[0,0] op_sel_hi:[1,0]
  v_mfma_f32_16x16x32_f16 v[72:75], v[132:135], v[60:63], v[72:75]
  v_pk_mul_f16 v57, v40, v44 op_sel:[0,0] op_sel_hi:[1,1]
  v_pk_mul_f16 v58, v40, v44 op_sel:[0,1] op_sel_hi:[1,0]
  v_mfma_f32_16x16x32_f16 v[72:75], v[136:139], v[64:67], v[72:75]
  v_pk_mul_f16 v59, v40, v45 op_sel:[0,0] op_sel_hi:[1,1]
  v_add_f32_dpp v14, v14, v14 row_shr:8 row_mask:0xf bank_mask:0xf
  v_mfma_f32_16x16x32_f16 v[72:75], v[140:143], v[52:55], v[72:75]
  v_pk_mul_f16 v60, v40, v45 op_sel:[0,1] op_sel_hi:[1,0]
  v_pk_mul_f16 v61, v40, v46 op_sel:[0,0] op_sel_hi:[1,1]
  v_mfma_f32_16x16x32_f16 v[72:75], v[144:147], v[56:59], v[72:75]
  v_add_f32_dpp v14, v14, v14 row_bcast:15 row_mask:0xa bank_mask:0xf
  v_pk_mul_f16 v62, v40, v46 op_sel:[0,1] op_sel_hi:[1,0]
  v_smfmac_f32_16x16x64_f16 v[80:83], v[224:227], v[52:59], v16
  v_pk_mul_f16 v63, v41, v44 op_sel:[0,0] op_sel_hi:[1,1]
  v_pk_mul_f16 v64, v41, v44 op_sel:[0,1] op_sel_hi:[1,0]
  v_mfma_f32_16x16x32_f16 v[68:71], v[96:99], v[52:55], v[68:71]
  v_add_f32_dpp v14, v14, v14 row_bcast:31 row_mask:0xc bank_mask:0xf
  v_pk_mul_f16 v65, v41, v45 op_sel:[0,0] op_sel_hi:[1,1]
  v_mfma_f32_16x16x32_f16 v[68:71], v[100:103], v[56:59], v[68:71]
  v_pk_mul_f16 v66, v41, v45 op_sel:[0,1] op_sel_hi:[1,0]
  v_pk_mul_f16 v67, v41, v46 op_sel:[0,0] op_sel_hi:[1,1]
  s_waitcnt vmcnt(0)
  s_cmp_le_u32 s72, 3
  s_cbranch_scc1 L_blk
  s_mov_b64 exec, 131071
  buffer_load_dword v255, v19, s[44:47], s101 offen
  s_mov_b64 exec, -1
  s_add_u32 s101, s101, 1171456
L_blk:
  s_cmp_eq_u32 s50, 0
  s_cbranch_scc1 L_blkend
  v_readlane_b32 s81, v14, 63
  v_ldexp_f32 v14, v14, s49
  v_and_b32 v14, -2, v14
  s_cmp_eq_u32 s50, 2
  s_cbranch_scc1 L_good
  s_cmp_eq_u64 s[90:91], 0
  s_cbranch_scc1 L_slow
  s_bfe_u32 s81, s81, 0x80017
  s_cmp_eq_u32 s81, 255
  s_cbranch_scc1 L_slow
L_good:
  s_mov_b32 exec_lo, 0
  s_mov_b32 exec_hi, 0x80000000
  buffer_store_dword v14, v251, s[60:63], s85 offen sc1
  s_mov_b64 exec, -1
  s_add_u32 s85, s85, 32
  s_sub_u32 s72, s72, 1
  s_cmp_eq_u32 s72, 0
  s_cbranch_scc1 L_cin_done
  s_cmp_eq_u32 s72, 1
  s_cbranch_scc1 L_lastnext
  v_lshl_add_u32 v24, v24, 7, v18
  v_lshl_add_u32 v25, v25, 7, v18
  s_mov_b32 exec_hi, 0x0000ffff
  v_lshl_add_u32 v26, v26, 7, v18
  v_lshl_add_u32 v27, v27, 7, v18
  s_mov_b32 exec_lo, 0
  s_mov_b32 exec_hi, 0xffff0000
  v_mov_b32 v27, v25
  v_mov_b32 v26, v25
  s_mov_b32 exec_hi, 0x00ff0000
  v_mov_b32 v26, v24
  s_mov_b64 exec, -1
  s_add_u32 m0, s74, 0
  s_nop 0
  buffer_load_dwordx4 v24, s[32:35], 0 offen lds
  s_add_u32 m0, s74, 1056
  s_nop 0
  buffer_load_dwordx4 v25, s[32:35], 0 offen lds
  s_add_u32 m0, s74, 2112
  s_nop 0
  buffer_load_dwordx4 v26, s[32:35], 0 offen lds
  s_add_u32 m0, s74, 3168
  s_mov_b32 exec_hi, 0x00ffffff
  buffer_load_dwordx4 v27, s[32:35], 0 offen lds
  s_mov_b32 exec_hi, -1
  s_add_u32 s94, s94, 832
  s_cmp_lg_u32 s72, s99
  s_cbranch_scc1 L_nodma
  v_mov_b32 v250, 1
  s_mov_b64 exec, 1
  buffer_atomic_add v250, v251, s[60:63], s98 offen sc0
  s_mov_b64 exec, -1
  s_mov_b32 s99, 8
  s_branch L_nodma
L_lastnext:
  s_cmp_lt_i32 s26, 0
  s_cselect_b32 s85, s85, s26
L_nodma:
  s_add_u32 s74, s74, s75
  s_sub_u32 s75, 0, s75
  s_mov_b32 s49, s48
  s_mov_b32 s97, 1
L_blkend:
  s_mov_b32 s50, s97
  v_mfma_f32_16x16x32_f16 v[76:79], v[184:187], v[52:55], v[76:79]
  v_alignbit_b32 v49, v49, v49, v13
  v_alignbit_b32 v50, v50, v50, v13
  v_mfma_f32_16x16x32_f16 v[76:79], v[188:191], v[56:59], v[76:79]
  v_pk_mul_f16 v52, v41, v46 op_sel:[0,1] op_sel_hi:[1,0]
  v_pk_mul_f16 v53, v42, v44 op_sel:[0,0] op_sel_hi:[1,1]
  v_mfma_f32_16x16x32_f16 v[76:79], v[192:195], v[60:63], v[76:79]
  v_pk_mul_f16 v54, v42, v44 op_sel:[0,1] op_sel_hi:[1,0]
  v_pk_mul_f16 v55, v42, v45 op_sel:[0,0] op_sel_hi:[1,1]
  v_mfma_f32_16x16x32_f16 v[76:79], v[196:199], v[64:67], v[76:79]
  v_pk_mul_f16 v56, v42, v45 op_sel:[0,1] op_sel_hi:[1,0]
  v_pk_mul_f16 v57, v42, v46 op_sel:[0,0] op_sel_hi:[1,1]
  v_smfmac_f32_16x16x64_f16 v[80:83], v[228:231], v[60:67], v16
  v_pk_mul_f16 v58, v42, v46 op_sel:[0,1] op_sel_hi:[1,0]
  v_pk_mul_f16 v59, v40, v48 op_sel:[0,0] op_sel_hi:[1,1]
  v_mfma_f32_16x16x32_f16 v[68:71], v[104:107], v[60:63], v[68:71]
  ds_read_u16_d16_hi v32, v7 offset:32
  ds_read_u16_d16_hi v33, v7 offset:160
  v_mfma_f32_16x16x32_f16 v[68:71], v[108:111], v[64:67], v[68:71]
  ds_read_u16_d16_hi v34, v7 offset:288
  ds_read_u16_d16_hi v35, v7 offset:416
  v_mfma_f32_16x16x32_f16 v[72:75], v[148:151], v[60:63], v[72:75]
  ds_read_u16_d16_hi v36, v7 offset:544
  ds_read_u16_d16_hi v37, v7 offset:672
  v_mfma_f32_16x16x32_f16 v[72:75], v[152:155], v[64:67], v[72:75]
  ds_read_u16_d16_hi v38, v7 offset:800
  ds_read_u16_d16_hi v39, v7 offset:928
  v_mfma_f32_16x16x32_f16 v[72:75], v[156:159], v[52:55], v[72:75]
  v_pk_mul_f16 v60, v41, v49 op_sel:[0,0] op_sel_hi:[1,1]
  v_pk_mul_f16 v61, v42, v50 op_sel:[0,0] op_sel_hi:[1,1]
  v_mfma_f32_16x16x32_f16 v[72:75], v[160:163], v[56:59], v[72:75]
  v_pk_mul_f16 v62, v40, v49 op_sel:[0,0] op_sel_hi:[1,1]
  v_pk_mul_f16 v63, v40, v49 op_sel:[0,1] op_sel_hi:[1,0]
  v_smfmac_f32_16x16x64_f16 v[80:83], v[232:235], v[52:59], v16
  v_pk_mul_f16 v64, v40, v50 op_sel:[0,0] op_sel_hi:[1,1]
  v_pk_mul_f16 v65, v40, v50 op_sel:[0,1] op_sel_hi:[1,0]
  v_mfma_f32_16x16x32_f16 v[68:71], v[112:115], v[52:55], v[68:71]
  v_pk_mul_f16 v66, v41, v50 op_sel:[0,0] op_sel_hi:[1,1]
  v_pk_mul_f16 v67, v41, v50 op_sel:[0,1] op_sel_hi:[1,0]
  v_mfma_f32_16x16x32_f16 v[68:71], v[116:119], v[56:59], v[68:71]
  s_waitcnt lgkmcnt(0)
  v_cvt_pk_f16_f32 v43, v38, v39
  v_cvt_pk_f16_f32 v40, v32, v35
  v_mfma_f32_16x16x32_f16 v[76:79], v[200:203], v[52:55], v[76:79]
  ds_read_b64_tr_b16 v[52:53], v8 offset:32
  ds_read_b64_tr_b16 v[54:55], v8 offset:544
  v_mfma_f32_16x16x32_f16 v[76:79], v[204:207], v[56:59], v[76:79]
  v_cvt_pk_f16_f32 v41, v33, v36
  v_cvt_pk_f16_f32 v42, v34, v37
  v_mfma_f32_16x16x32_f16 v[72:75], v[164:167], v[60:63], v[72:75]
  ds_write_b128 v10, v[40:43]
  v_mfma_f32_16x16x32_f16 v[72:75], v[168:171], v[64:67], v[72:75]
  v_pk_mul_f16 v56, v40, v40 op_sel:[0,0] op_sel_hi:[1,1]
  v_pk_mul_f16 v57, v41, v41 op_sel:[0,0] op_sel_hi:[1,1]
  v_smfmac_f32_16x16x64_f16 v[80:83], v[236:239], v[60:67], v16
  v_pk_mul_f16 v58, v42, v42 op_sel:[0,0] op_sel_hi:[1,1]
  v_pk_mul_f16 v59, v40, v41 op_sel:[0,0] op_sel_hi:[1,1]
  v_mfma_f32_16x16x32_f16 v[68:71], v[120:123], v[60:63], v[68:71]
  ds_read_b128 v[44:47], v11
  ds_read_b128 v[48:51], v12
  v_mfma_f32_16x16x32_f16 v[68:71], v[124:127], v[64:67], v[68:71]
  v_or3_b32 v15, v56, v57, v58
  v_mfma_f32_16x16x32_f16 v[76:79], v[208:211], v[60:63], v[76:79]
  v_add_f32 v22, v80, v81
  v_add_f32 v23, v82, v83
  v_mfma_f32_16x16x32_f16 v[76:79], v[212:215], v[64:67], v[76:79]
  v_pk_mul_f16 v60, v40, v41 op_sel:[0,1] op_sel_hi:[1,0]
  v_pk_mul_f16 v61, v40, v42 op_sel:[0,0] op_sel_hi:[1,1]
L_grp1:
  v_mfma_f32_16x16x32_f16 v[80:83], v[216:219], v[56:59], 0
  v_mul_f32 v14, v68, v72
  v_fmac_f32 v14, v69, v73
  v_fmac_f32 v14, v70, v74
  v_fmac_f32 v14, v71, v75
  s_waitcnt lgkmcnt(3)
  v_mfma_f32_16x16x32_bf16 v[72:75], v[240:243], v[52:55], 0
  v_pk_mul_f16 v62, v40, v42 op_sel:[0,1] op_sel_hi:[1,0]
  v_pk_mul_f16 v63, v41, v42 op_sel:[0,0] op_sel_hi:[1,1]
  v_mfma_f32_16x16x32_f16 v[72:75], v[128:131], v[56:59], v[72:75]
  v_fmac_f32 v14, v76, v77
  v_fmac_f32 v14, v22, v78
  v_mfma_f32_16x16x32_f16 v[68:71], v[84:87], v[56:59], 0
  v_fmac_f32 v14, v23, v79
  v_pk_mul_f16 v64, v41, v42 op_sel:[0,1] op_sel_hi:[1,0]
  v_mfma_f32_16x16x32_bf16 v[76:79], v[244:247], v[52:55], 0
  v_pk_mul_f16 v65, v40, v43 op_sel:[0,0] op_sel_hi:[1,0]
  v_pk_mul_f16 v66, v41, v43 op_sel:[0,0] op_sel_hi:[1,0]
  v_mfma_f32_16x16x32_f16 v[76:79], v[172:175], v[56:59], v[76:79]
  v_pk_mul_f16 v67, v42, v43 op_sel:[0,0] op_sel_hi:[1,0]
  s_waitcnt lgkmcnt(0)
  v_alignbit_b32 v48, v48, v48, v13
  v_mfma_f32_16x16x32_f16 v[76:79], v[176:179], v[60:63], v[76:79]
  v_mul_f16_sdwa v52, v40, v40 dst_sel:WORD_0 dst_unused:UNUSED_PAD src0_sel:WORD_0 src1_sel:WORD_1
  v_mul_f16_sdwa v53, v42, v42 dst_sel:WORD_0 dst_unused:UNUSED_PAD src0_sel:WORD_0 src1_sel:WORD_1
  v_mfma_f32_16x16x32_f16 v[76:79], v[180:183], v[64:67], v[76:79]
  v_mul_f16_sdwa v52, v41, v41 dst_sel:WORD_1 dst_unused:UNUSED_PRESERVE src0_sel:WORD_0 src1_sel:WORD_1
  v_mul_f16_sdwa v53, v43, v43 dst_sel:WORD_1 dst_unused:UNUSED_PRESERVE src0_sel:WORD_0 src1_sel:WORD_1
  v_smfmac_f32_16x16x64_f16 v[80:83], v[220:223], v[60:67], v16
  v_pk_mul_f16 v54, v40, v47 op_sel:[0,0] op_sel_hi:[1,0]
  v_pk_mul_f16 v55, v41, v47 op_sel:[0,0] op_sel_hi:[1,0]
  v_mfma_f32_16x16x32_f16 v[68:71], v[88:91], v[60:63], v[68:71]
  v_pk_mul_f16 v56, v42, v47 op_sel:[0,0] op_sel_hi:[1,0]
  v_pk_mul_f16 v57, v40, v44 op_sel:[0,0] op_sel_hi:[1,1]
  v_mfma_f32_16x16x32_f16 v[68:71], v[92:95], v[64:67], v[68:71]
  v_pk_mul_f16 v58, v40, v44 op_sel:[0,1] op_sel_hi:[1,0]
  v_pk_mul_f16 v59, v40, v45 op_sel:[0,0] op_sel_hi:[1,1]
  v_mfma_f32_16x16x32_f16 v[72:75], v[132:135], v[60:63], v[72:75]
  v_pk_mul_f16 v60, v40, v45 op_sel:[0,1] op_sel_hi:[1,0]
  v_pk_mul_f16 v61, v40, v46 op_sel:[0,0] op_sel_hi:[1,1]
  v_mfma_f32_16x16x32_f16 v[72:75], v[136:139], v[64:67], v[72:75]
  v_pk_mul_f16 v62, v40, v46 op_sel:[0,1] op_sel_hi:[1,0]
  v_pk_mul_f16 v63, v41, v44 op_sel:[0,0] op_sel_hi:[1,1]
  v_mfma_f32_16x16x32_f16 v[72:75], v[140:143], v[52:55], v[72:75]
  v_pk_mul_f16 v64, v41, v44 op_sel:[0,1] op_sel_hi:[1,0]
  v_pk_mul_f16 v65, v41, v45 op_sel:[0,0] op_sel_hi:[1,1]
  v_mfma_f32_16x16x32_f16 v[72:75], v[144:147], v[56:59], v[72:75]
  v_pk_mul_f16 v66, v41, v45 op_sel:[0,1] op_sel_hi:[1,0]
  v_pk_mul_f16 v67, v41, v46 op_sel:[0,0] op_sel_hi:[1,1]
  v_smfmac_f32_16x16x64_f16 v[80:83], v[224:227], v[52:59], v16
  v_alignbit_b32 v49, v49, v49, v13
  v_alignbit_b32 v50, v50, v50, v13
  v_mfma_f32_16x16x32_f16 v[68:71], v[96:99], v[52:55], v[68:71]
  ds_read_u16_d16_hi v32, v7 offset:64
  ds_read_u16_d16_hi v33, v7 offset:192
  v_mfma_f32_16x16x32_f16 v[68:71], v[100:103], v[56:59], v[68:71]
  ds_read_u16_d16_hi v34, v7 offset:320
  ds_read_u16_d16_hi v35, v7 offset:448
  v_mfma_f32_16x16x32_f16 v[76:79], v[184:187], v[52:55], v[76:79]
  v_pk_mul_f16 v52, v41, v46 op_sel:[0,1] op_sel_hi:[1,0]
  v_pk_mul_f16 v53, v42, v44 op_sel:[0,0] op_sel_hi:[1,1]
  v_mfma_f32_16x16x32_f16 v[76:79], v[188:191], v[56:59], v[76:79]
  v_pk_mul_f16 v54, v42, v44 op_sel:[0,1] op_sel_hi:[1,0]
  v_pk_mul_f16 v55, v42, v45 op_sel:[0,0] op_sel_hi:[1,1]
  v_mfma_f32_16x16x32_f16 v[76:79], v[192:195], v[60:63], v[76:79]
  v_pk_mul_f16 v56, v42, v45 op_sel:[0,1] op_sel_hi:[1,0]
  v_pk_mul_f16 v57, v42, v46 op_sel:[0,0] op_sel_hi:[1,1]
  v_mfma_f32_16x16x32_f16 v[76:79], v[196:199], v[64:67], v[76:79]
  v_pk_mul_f16 v58, v42, v46 op_sel:[0,1] op_sel_hi:[1,0]
  v_pk_mul_f16 v59, v40, v48 op_sel:[0,0] op_sel_hi:[1,1]
  v_smfmac_f32_16x16x64_f16 v[80:83], v[228:231], v[60:67], v16
  ds_read_u16_d16_hi v36, v7 offset:576
  ds_read_u16_d16_hi v37, v7 offset:704
  v_mfma_f32_16x16x32_f16 v[68:71], v[104:107], v[60:63], v[68:71]
  ds_read_u16_d16_hi v38, v7 offset:832
  ds_read_u16_d16_hi v39, v7 offset:960
  v_mfma_f32_16x16x32_f16 v[68:71], v[108:111], v[64:67], v[68:71]
  v_and_b32 v15, 0x60006000, v15
  v_cmp_ne_u32 s[90:91], 0, v15
  v_mfma_f32_16x16x32_f16 v[72:75], v[148:151], v[60:63], v[72:75]
  v_pk_mul_f16 v60, v41, v49 op_sel:[0,0] op_sel_hi:[1,1]
  v_pk_mul_f16 v61, v42, v50 op_sel:[0,0] op_sel_hi:[1,1]
  v_mfma_f32_16x16x32_f16 v[72:75], v[152:155], v[64:67], v[72:75]
  v_pk_mul_f16 v62, v40, v49 op_sel:[0,0] op_sel_hi:[1,1]
  v_pk_mul_f16 v63, v40, v49 op_sel:[0,1] op_sel_hi:[1,0]
  v_mfma_f32_16x16x32_f16 v[72:75], v[156:159], v[52:55], v[72:75]
  v_pk_mul_f16 v64, v40, v50 op_sel:[0,0] op_sel_hi:[1,1]
  v_pk_mul_f16 v65, v40, v50 op_sel:[0,1] op_sel_hi:[1,0]
  v_mfma_f32_16x16x32_f16 v[72:75], v[160:163], v[56:59], v[72:75]
  v_pk_mul_f16 v66, v41, v50 op_sel:[0,0] op_sel_hi:[1,1]
  v_pk_mul_f16 v67, v41, v50 op_sel:[0,1] op_sel_hi:[1,0]
  v_smfmac_f32_16x16x64_f16 v[80:83], v[232:235], v[52:59], v16
  s_waitcnt lgkmcnt(0)
  v_cvt_pk_f16_f32 v43, v38, v39
  v_cvt_pk_f16_f32 v40, v32, v35
  v_mfma_f32_16x16x32_f16 v[68:71], v[112:115], v[52:55], v[68:71]
  v_cvt_pk_f16_f32 v41, v33, v36
  v_cvt_pk_f16_f32 v42, v34, v37
  v_mfma_f32_16x16x32_f16 v[68:71], v[116:119], v[56:59], v[68:71]
  ds_write_b128 v10, v[40:43]
  v_mfma_f32_16x16x32_f16 v[76:79], v[200:203], v[52:55], v[76:79]
  ds_read_b64_tr_b16 v[52:53], v8 offset:64
  ds_read_b64_tr_b16 v[54:55], v8 offset:576
  v_mfma_f32_16x16x32_f16 v[76:79], v[204:207], v[56:59], v[76:79]
  v_pk_mul_f16 v56, v40, v40 op_sel:[0,0] op_sel_hi:[1,1]
  v_pk_mul_f16 v57, v41, v41 op_sel:[0,0] op_sel_hi:[1,1]
  v_mfma_f32_16x16x32_f16 v[72:75], v[164:167], v[60:63], v[72:75]
  v_pk_mul_f16 v58, v42, v42 op_sel:[0,0] op_sel_hi:[1,1]
  v_pk_mul_f16 v59, v40, v41 op_sel:[0,0] op_sel_hi:[1,1]
  v_mfma_f32_16x16x32_f16 v[72:75], v[168:171], v[64:67], v[72:75]
  ds_read_b128 v[44:47], v11
  ds_read_b128 v[48:51], v12
  v_smfmac_f32_16x16x64_f16 v[80:83], v[236:239], v[60:67], v16
  v_mfma_f32_16x16x32_f16 v[68:71], v[120:123], v[60:63], v[68:71]
  v_mfma_f32_16x16x32_f16 v[68:71], v[124:127], v[64:67], v[68:71]
  v_mfma_f32_16x16x32_f16 v[76:79], v[208:211], v[60:63], v[76:79]
  s_nop 4
  v_add_f32 v22, v80, v81
  v_add_f32 v23, v82, v83
  v_mfma_f32_16x16x32_f16 v[76:79], v[212:215], v[64:67], v[76:79]
  v_pk_mul_f16 v60, v40, v41 op_sel:[0,1] op_sel_hi:[1,0]
  v_pk_mul_f16 v61, v40, v42 op_sel:[0,0] op_sel_hi:[1,1]
  v_mfma_f32_16x16x32_f16 v[80:83], v[216:219], v[56:59], 0
  v_fmac_f32 v14, v68, v72
  v_fmac_f32 v14, v69, v73
  v_fmac_f32 v14, v70, v74
  v_fmac_f32 v14, v71, v75
  s_waitcnt lgkmcnt(2)
  v_mfma_f32_16x16x32_bf16 v[72:75], v[240:243], v[52:55], 0
  v_pk_mul_f16 v62, v40, v42 op_sel:[0,1] op_sel_hi:[1,0]
  v_pk_mul_f16 v63, v41, v42 op_sel:[0,0] op_sel_hi:[1,1]
  v_mfma_f32_16x16x32_f16 v[72:75], v[128:131], v[56:59], v[72:75]
  v_fmac_f32 v14, v76, v77
  v_fmac_f32 v14, v22, v78
  v_mfma_f32_16x16x32_f16 v[68:71], v[84:87], v[56:59], 0
  v_fmac_f32 v14, v23, v79
  v_pk_mul_f16 v64, v41, v42 op_sel:[0,1] op_sel_hi:[1,0]
  v_mfma_f32_16x16x32_bf16 v[76:79], v[244:247], v[52:55], 0
  v_pk_mul_f16 v65, v40, v43 op_sel:[0,0] op_sel_hi:[1,0]
  v_pk_mul_f16 v66, v41, v43 op_sel:[0,0] op_sel_hi:[1,0]
  v_mfma_f32_16x16x32_f16 v[76:79], v[172:175], v[56:59], v[76:79]
  v_pk_mul_f16 v67, v42, v43 op_sel:[0,0] op_sel_hi:[1,0]
  s_waitcnt lgkmcnt(0)
  v_alignbit_b32 v48, v48, v48, v13
  v_mfma_f32_16x16x32_f16 v[76:79], v[176:179], v[60:63], v[76:79]
  v_mul_f16_sdwa v52, v40, v40 dst_sel:WORD_0 dst_unused:UNUSED_PAD src0_sel:WORD_0 src1_sel:WORD_1
  v_mul_f16_sdwa v53, v42, v42 dst_sel:WORD_0 dst_unused:UNUSED_PAD src0_sel:WORD_0 src1_sel:WORD_1
  v_mfma_f32_16x16x32_f16 v[76:79], v[180:183], v[64:67], v[76:79]
  v_mul_f16_sdwa v52, v41, v41 dst_sel:WORD_1 dst_unused:UNUSED_PRESERVE src0_sel:WORD_0 src1_sel:WORD_1
  v_mul_f16_sdwa v53, v43, v43 dst_sel:WORD_1 dst_unused:UNUSED_PRESERVE src0_sel:WORD_0 src1_sel:WORD_1
  v_smfmac_f32_16x16x64_f16 v[80:83], v[220:223], v[60:67], v16
  v_pk_mul_f16 v54, v40, v47 op_sel:[0,0] op_sel_hi:[1,0]
  v_pk_mul_f16 v55, v41, v47 op_sel:[0,0] op_sel_hi:[1,0]
  v_mfma_f32_16x16x32_f16 v[68:71], v[88:91], v[60:63], v[68:71]
  v_pk_mul_f16 v56, v42, v47 op_sel:[0,0] op_sel_hi:[1,0]
  v_pk_mul_f16 v57, v40, v44 op_sel:[0,0] op_sel_hi:[1,1]
  v_mfma_f32_16x16x32_f16 v[68:71], v[92:95], v[64:67], v[68:71]
  v_pk_mul_f16 v58, v40, v44 op_sel:[0,1] op_sel_hi:[1,0]
  v_pk_mul_f16 v59, v40, v45 op_sel:[0,0] op_sel_hi:[1,1]
  v_mfma_f32_16x16x32_f16 v[72:75], v[132:135], v[60:63], v[72:75]
  v_pk_mul_f16 v60, v40, v45 op_sel:[0,1] op_sel_hi:[1,0]
  v_pk_mul_f16 v61, v40, v46 op_sel:[0,0] op_sel_hi:[1,1]
  v_mfma_f32_16x16x32_f16 v[72:75], v[136:139], v[64:67], v[72:75]
  v_pk_mul_f16 v62, v40, v46 op_sel:[0,1] op_sel_hi:[1,0]
  v_pk_mul_f16 v63, v41, v44 op_sel:[0,0] op_sel_hi:[1,1]
  v_mfma_f32_16x16x32_f16 v[72:75], v[140:143], v[52:55], v[72:75]
  v_pk_mul_f16 v64, v41, v44 op_sel:[0,1] op_sel_hi:[1,0]
  v_pk_mul_f16 v65, v41, v45 op_sel:[0,0] op_sel_hi:[1,1]
  v_mfma_f32_16x16x32_f16 v[72:75], v[144:147], v[56:59], v[72:75]
  v_pk_mul_f16 v66, v41, v45 op_sel:[0,1] op_sel_hi:[1,0]
  v_pk_mul_f16 v67, v41, v46 op_sel:[0,0] op_sel_hi:[1,1]
  v_smfmac_f32_16x16x64_f16 v[80:83], v[224:227], v[52:59], v16
  v_alignbit_b32 v49, v49, v49, v13
  v_alignbit_b32 v50, v50, v50, v13
  v_mfma_f32_16x16x32_f16 v[68:71], v[96:99], v[52:55], v[68:71]
  ds_read_u16_d16_hi v32, v7 offset:96
  ds_read_u16_d16_hi v33, v7 offset:224
  v_mfma_f32_16x16x32_f16 v[68:71], v[100:103], v[56:59], v[68:71]
  ds_read_u16_d16_hi v34, v7 offset:352
  ds_read_u16_d16_hi v35, v7 offset:480
  s_cmp_lg_u32 s99, 8
  s_cbranch_scc1 L_hk
  s_waitcnt vmcnt(0)
  v_readfirstlane_b32 s81, v250
  s_mov_b32 s99, 0
  s_add_u32 s81, s81, 485
  s_cmp_ge_u32 s81, 512
  s_cbranch_scc1 L_hk
  s_add_u32 s72, s72, 1
  s_lshr_b32 s94, s98, 14
  s_lshl_b32 s26, s94, 12
  s_add_u32 s26, s26, s81
  s_lshl_b32 s26, s26, 2
  s_add_u32 s26, s26, 10240
  s_lshl_b32 s94, s94, 9
  s_add_u32 s94, s94, s81
  s_mul_i32 s94, s94, 104
L_hk:
  buffer_load_dwordx4 v[24:27], v17, s[28:31], s94 offen offset:0
  v_mfma_f32_16x16x32_f16 v[76:79], v[184:187], v[52:55], v[76:79]
  v_pk_mul_f16 v52, v41, v46 op_sel:[0,1] op_sel_hi:[1,0]
  v_pk_mul_f16 v53, v42, v44 op_sel:[0,0] op_sel_hi:[1,1]
  v_mfma_f32_16x16x32_f16 v[76:79], v[188:191], v[56:59], v[76:79]
  v_pk_mul_f16 v54, v42, v44 op_sel:[0,1] op_sel_hi:[1,0]
  v_pk_mul_f16 v55, v42, v45 op_sel:[0,0] op_sel_hi:[1,1]
  v_mfma_f32_16x16x32_f16 v[76:79], v[192:195], v[60:63], v[76:79]
  v_pk_mul_f16 v56, v42, v45 op_sel:[0,1] op_sel_hi:[1,0]
  v_pk_mul_f16 v57, v42, v46 op_sel:[0,0] op_sel_hi:[1,1]
  v_mfma_f32_16x16x32_f16 v[76:79], v[196:199], v[64:67], v[76:79]
  v_pk_mul_f16 v58, v42, v46 op_sel:[0,1] op_sel_hi:[1,0]
  v_pk_mul_f16 v59, v40, v48 op_sel:[0,0] op_sel_hi:[1,1]
  v_smfmac_f32_16x16x64_f16 v[80:83], v[228:231], v[60:67], v16
  ds_read_u16_d16_hi v36, v7 offset:608
  ds_read_u16_d16_hi v37, v7 offset:736
  v_mfma_f32_16x16x32_f16 v[68:71], v[104:107], v[60:63], v[68:71]
  ds_read_u16_d16_hi v38, v7 offset:864
  ds_read_u16_d16_hi v39, v7 offset:992
  v_mfma_f32_16x16x32_f16 v[68:71], v[108:111], v[64:67], v[68:71]
  v_mfma_f32_16x16x32_f16 v[72:75], v[148:151], v[60:63], v[72:75]
  v_pk_mul_f16 v60, v41, v49 op_sel:[0,0] op_sel_hi:[1,1]
  v_pk_mul_f16 v61, v42, v50 op_sel:[0,0] op_sel_hi:[1,1]
  v_mfma_f32_16x16x32_f16 v[72:75], v[152:155], v[64:67], v[72:75]
  v_pk_mul_f16 v62, v40, v49 op_sel:[0,0] op_sel_hi:[1,1]
  v_pk_mul_f16 v63, v40, v49 op_sel:[0,1] op_sel_hi:[1,0]
  v_mfma_f32_16x16x32_f16 v[72:75], v[156:159], v[52:55], v[72:75]
  v_pk_mul_f16 v64, v40, v50 op_sel:[0,0] op_sel_hi:[1,1]
  v_pk_mul_f16 v65, v40, v50 op_sel:[0,1] op_sel_hi:[1,0]
  s_cmp_lg_u32 s84, 0
  s_cbranch_scc1 L_pr110
  s_setprio 0
L_pr110:
  v_mfma_f32_16x16x32_f16 v[72:75], v[160:163], v[56:59], v[72:75]
  v_pk_mul_f16 v66, v41, v50 op_sel:[0,0] op_sel_hi:[1,1]
  v_pk_mul_f16 v67, v41, v50 op_sel:[0,1] op_sel_hi:[1,0]
  v_smfmac_f32_16x16x64_f16 v[80:83], v[232:235], v[52:59], v16
  s_waitcnt lgkmcnt(0)
  v_cvt_pk_f16_f32 v43, v38, v39
  v_cvt_pk_f16_f32 v40, v32, v35
  v_mfma_f32_16x16x32_f16 v[68:71], v[112:115], v[52:55], v[68:71]
  v_cvt_pk_f16_f32 v41, v33, v36
  v_cvt_pk_f16_f32 v42, v34, v37
  v_mfma_f32_16x16x32_f16 v[68:71], v[116:119], v[56:59], v[68:71]
  ds_write_b128 v10, v[40:43]
  v_mfma_f32_16x16x32_f16 v[76:79], v[200:203], v[52:55], v[76:79]
  ds_read_b64_tr_b16 v[52:53], v8 offset:96
  ds_read_b64_tr_b16 v[54:55], v8 offset:608
  v_mfma_f32_16x16x32_f16 v[76:79], v[204:207], v[56:59], v[76:79]
  v_pk_mul_f16 v56, v40, v40 op_sel:[0,0] op_sel_hi:[1,1]
  v_pk_mul_f16 v57, v41, v41 op_sel:[0,0] op_sel_hi:[1,1]
  v_mfma_f32_16x16x32_f16 v[72:75], v[164:167], v[60:63], v[72:75]
  v_pk_mul_f16 v58, v42, v42 op_sel:[0,0] op_sel_hi:[1,1]
  v_pk_mul_f16 v59, v40, v41 op_sel:[0,0] op_sel_hi:[1,1]
  v_mfma_f32_16x16x32_f16 v[72:75], v[168:171], v[64:67], v[72:75]
  ds_read_b128 v[44:47], v11
  ds_read_b128 v[48:51], v12
  v_smfmac_f32_16x16x64_f16 v[80:83], v[236:239], v[60:67], v16
  v_mfma_f32_16x16x32_f16 v[68:71], v[120:123], v[60:63], v[68:71]
  v_mfma_f32_16x16x32_f16 v[68:71], v[124:127], v[64:67], v[68:71]
  v_mfma_f32_16x16x32_f16 v[76:79], v[208:211], v[60:63], v[76:79]
  s_nop 4
  v_add_f32 v22, v80, v81
  v_add_f32 v23, v82, v83
  v_mfma_f32_16x16x32_f16 v[76:79], v[212:215], v[64:67], v[76:79]
  v_pk_mul_f16 v60, v40, v41 op_sel:[0,1] op_sel_hi:[1,0]
  v_pk_mul_f16 v61, v40, v42 op_sel:[0,0] op_sel_hi:[1,1]
  v_mfma_f32_16x16x32_f16 v[80:83], v[216:219], v[56:59], 0
  v_fmac_f32 v14, v68, v72
  v_fmac_f32 v14, v69, v73
  v_fmac_f32 v14, v70, v74
  v_fmac_f32 v14, v71, v75
  s_waitcnt lgkmcnt(2)
  v_mfma_f32_16x16x32_bf16 v[72:75], v[240:243], v[52:55], 0
  v_pk_mul_f16 v62, v40, v42 op_sel:[0,1] op_sel_hi:[1,0]
  v_pk_mul_f16 v63, v41, v42 op_sel:[0,0] op_sel_hi:[1,1]
  v_mfma_f32_16x16x32_f16 v[72:75], v[128:131], v[56:59], v[72:75]
  v_fmac_f32 v14, v76, v77
  v_fmac_f32 v14, v22, v78
  v_mfma_f32_16x16x32_f16 v[68:71], v[84:87], v[56:59], 0
  v_fmac_f32 v14, v23, v79
  v_pk_mul_f16 v64, v41, v42 op_sel:[0,1] op_sel_hi:[1,0]
  v_mfma_f32_16x16x32_bf16 v[76:79], v[244:247], v[52:55], 0
  v_pk_mul_f16 v65, v40, v43 op_sel:[0,0] op_sel_hi:[1,0]
  v_pk_mul_f16 v66, v41, v43 op_sel:[0,0] op_sel_hi:[1,0]
  v_mfma_f32_16x16x32_f16 v[76:79], v[172:175], v[56:59], v[76:79]
  v_pk_mul_f16 v67, v42, v43 op_sel:[0,0] op_sel_hi:[1,0]
  s_waitcnt lgkmcnt(0)
  v_alignbit_b32 v48, v48, v48, v13
  v_mfma_f32_16x16x32_f16 v[76:79], v[176:179], v[60:63], v[76:79]
  v_mul_f16_sdwa v52, v40, v40 dst_sel:WORD_0 dst_unused:UNUSED_PAD src0_sel:WORD_0 src1_sel:WORD_1
  v_mul_f16_sdwa v53, v42, v42 dst_sel:WORD_0 dst_unused:UNUSED_PAD src0_sel:WORD_0 src1_sel:WORD_1
  v_mfma_f32_16x16x32_f16 v[76:79], v[180:183], v[64:67], v[76:79]
  v_mul_f16_sdwa v52, v41, v41 dst_sel:WORD_1 dst_unused:UNUSED_PRESERVE src0_sel:WORD_0 src1_sel:WORD_1
  v_mul_f16_sdwa v53, v43, v43 dst_sel:WORD_1 dst_unused:UNUSED_PRESERVE src0_sel:WORD_0 src1_sel:WORD_1
  v_smfmac_f32_16x16x64_f16 v[80:83], v[220:223], v[60:67], v16
  v_pk_mul_f16 v54, v40, v47 op_sel:[0,0] op_sel_hi:[1,0]
  v_pk_mul_f16 v55, v41, v47 op_sel:[0,0] op_sel_hi:[1,0]
  v_mfma_f32_16x16x32_f16 v[68:71], v[88:91], v[60:63], v[68:71]
  v_pk_mul_f16 v56, v42, v47 op_sel:[0,0] op_sel_hi:[1,0]
  v_pk_mul_f16 v57, v40, v44 op_sel:[0,0] op_sel_hi:[1,1]
  v_mfma_f32_16x16x32_f16 v[68:71], v[92:95], v[64:67], v[68:71]
  v_add_u32 v7, s75, v7
  s_waitcnt vmcnt(1)
  v_pk_mul_f16 v58, v40, v44 op_sel:[0,1] op_sel_hi:[1,0]
  v_mfma_f32_16x16x32_f16 v[72:75], v[132:135], v[60:63], v[72:75]
  v_pk_mul_f16 v59, v40, v45 op_sel:[0,0] op_sel_hi:[1,1]
  v_pk_mul_f16 v60, v40, v45 op_sel:[0,1] op_sel_hi:[1,0]
  v_mfma_f32_16x16x32_f16 v[72:75], v[136:139], v[64:67], v[72:75]
  v_pk_mul_f16 v61, v40, v46 op_sel:[0,0] op_sel_hi:[1,1]
  v_pk_mul_f16 v62, v40, v46 op_sel:[0,1] op_sel_hi:[1,0]
  v_mfma_f32_16x16x32_f16 v[72:75], v[140:143], v[52:55], v[72:75]
  v_pk_mul_f16 v63, v41, v44 op_sel:[0,0] op_sel_hi:[1,1]
  v_pk_mul_f16 v64, v41, v44 op_sel:[0,1] op_sel_hi:[1,0]
  v_mfma_f32_16x16x32_f16 v[72:75], v[144:147], v[56:59], v[72:75]
  v_pk_mul_f16 v65, v41, v45 op_sel:[0,0] op_sel_hi:[1,1]
  v_pk_mul_f16 v66, v41, v45 op_sel:[0,1] op_sel_hi:[1,0]
  v_smfmac_f32_16x16x64_f16 v[80:83], v[224:227], v[52:59], v16
  v_pk_mul_f16 v67, v41, v46 op_sel:[0,0] op_sel_hi:[1,1]
  v_alignbit_b32 v49, v49, v49, v13
  v_mfma_f32_16x16x32_f16 v[68:71], v[96:99], v[52:55], v[68:71]
  v_alignbit_b32 v50, v50, v50, v13
  ds_read_u16_d16_hi v32, v7 offset:0
  v_mfma_f32_16x16x32_f16 v[68:71], v[100:103], v[56:59], v[68:71]
  ds_read_u16_d16_hi v33, v7 offset:128
  ds_read_u16_d16_hi v34, v7 offset:256
  v_mfma_f32_16x16x32_f16 v[76:79], v[184:187], v[52:55], v[76:79]
  v_pk_mul_f16 v52, v41, v46 op_sel:[0,1] op_sel_hi:[1,0]
  v_pk_mul_f16 v53, v42, v44 op_sel:[0,0] op_sel_hi:[1,1]
  v_mfma_f32_16x16x32_f16 v[76:79], v[188:191], v[56:59], v[76:79]
  v_pk_mul_f16 v54, v42, v44 op_sel:[0,1] op_sel_hi:[1,0]
  v_pk_mul_f16 v55, v42, v45 op_sel:[0,0] op_sel_hi:[1,1]
  v_mfma_f32_16x16x32_f16 v[76:79], v[192:195], v[60:63], v[76:79]
  v_pk_mul_f16 v56, v42, v45 op_sel:[0,1] op_sel_hi:[1,0]
  v_pk_mul_f16 v57, v42, v46 op_sel:[0,0] op_sel_hi:[1,1]
  v_mfma_f32_16x16x32_f16 v[76:79], v[196:199], v[64:67], v[76:79]
  v_pk_mul_f16 v58, v42, v46 op_sel:[0,1] op_sel_hi:[1,0]
  v_pk_mul_f16 v59, v40, v48 op_sel:[0,0] op_sel_hi:[1,1]
  v_smfmac_f32_16x16x64_f16 v[80:83], v[228:231], v[60:67], v16
  ds_read_u16_d16_hi v35, v7 offset:384
  ds_read_u16_d16_hi v36, v7 offset:512
  v_mfma_f32_16x16x32_f16 v[68:71], v[104:107], v[60:63], v[68:71]
  ds_read_u16_d16_hi v37, v7 offset:640
  ds_read_u16_d16_hi v38, v7 offset:768
  v_mfma_f32_16x16x32_f16 v[68:71], v[108:111], v[64:67], v[68:71]
  ds_read_u16_d16_hi v39, v7 offset:896
  s_add_u32 s81, s74, s75
  v_add_u32 v8, s81, v9
  v_mfma_f32_16x16x32_f16 v[72:75], v[148:151], v[60:63], v[72:75]
  v_pk_mul_f16 v60, v41, v49 op_sel:[0,0] op_sel_hi:[1,1]
  v_pk_mul_f16 v61, v42, v50 op_sel:[0,0] op_sel_hi:[1,1]
  v_mfma_f32_16x16x32_f16 v[72:75], v[152:155], v[64:67], v[72:75]
  v_pk_mul_f16 v62, v40, v49 op_sel:[0,0] op_sel_hi:[1,1]
  v_pk_mul_f16 v63, v40, v49 op_sel:[0,1] op_sel_hi:[1,0]
  v_mfma_f32_16x16x32_f16 v[72:75], v[156:159], v[52:55], v[72:75]
  v_pk_mul_f16 v64, v40, v50 op_sel:[0,0] op_sel_hi:[1,1]
  v_pk_mul_f16 v65, v40, v50 op_sel:[0,1] op_sel_hi:[1,0]
  v_mfma_f32_16x16x32_f16 v[72:75], v[160:163], v[56:59], v[72:75]
  v_pk_mul_f16 v66, v41, v50 op_sel:[0,0] op_sel_hi:[1,1]
  v_pk_mul_f16 v67, v41, v50 op_sel:[0,1] op_sel_hi:[1,0]
  v_smfmac_f32_16x16x64_f16 v[80:83], v[232:235], v[52:59], v16
  s_waitcnt lgkmcnt(0)
  v_cvt_pk_f16_f32 v43, v38, v39
  v_cvt_pk_f16_f32 v40, v32, v35
  v_mfma_f32_16x16x32_f16 v[68:71], v[112:115], v[52:55], v[68:71]
  v_cvt_pk_f16_f32 v41, v33, v36
  v_cvt_pk_f16_f32 v42, v34, v37
  v_mfma_f32_16x16x32_f16 v[68:71], v[116:119], v[56:59], v[68:71]
  ds_write_b128 v10, v[40:43]
  v_mfma_f32_16x16x32_f16 v[76:79], v[200:203], v[52:55], v[76:79]
  ds_read_b64_tr_b16 v[52:53], v8 offset:0
  ds_read_b64_tr_b16 v[54:55], v8 offset:512
  v_mfma_f32_16x16x32_f16 v[76:79], v[204:207], v[56:59], v[76:79]
  v_pk_mul_f16 v56, v40, v40 op_sel:[0,0] op_sel_hi:[1,1]
  v_pk_mul_f16 v57, v41, v41 op_sel:[0,0] op_sel_hi:[1,1]
  v_mfma_f32_16x16x32_f16 v[72:75], v[164:167], v[60:63], v[72:75]
  v_pk_mul_f16 v58, v42, v42 op_sel:[0,0] op_sel_hi:[1,1]
  v_pk_mul_f16 v59, v40, v41 op_sel:[0,0] op_sel_hi:[1,1]
  v_mfma_f32_16x16x32_f16 v[72:75], v[168:171], v[64:67], v[72:75]
  ds_read_b128 v[44:47], v11
  ds_read_b128 v[48:51], v12
  v_smfmac_f32_16x16x64_f16 v[80:83], v[236:239], v[60:67], v16
  v_mfma_f32_16x16x32_f16 v[68:71], v[120:123], v[60:63], v[68:71]
  v_mfma_f32_16x16x32_f16 v[68:71], v[124:127], v[64:67], v[68:71]
  v_mfma_f32_16x16x32_f16 v[76:79], v[208:211], v[60:63], v[76:79]
  s_nop 4
  v_add_f32 v22, v80, v81
  v_add_f32 v23, v82, v83
  v_mfma_f32_16x16x32_f16 v[76:79], v[212:215], v[64:67], v[76:79]
  v_pk_mul_f16 v60, v40, v41 op_sel:[0,1] op_sel_hi:[1,0]
  v_pk_mul_f16 v61, v40, v42 op_sel:[0,0] op_sel_hi:[1,1]
  s_cmp_lg_u32 s72, 1
  s_cbranch_scc1 L_cin_loop
  v_fmac_f32 v14, v68, v72
  v_fmac_f32 v14, v69, v73
  v_fmac_f32 v14, v70, v74
  v_fmac_f32 v14, v71, v75
  v_fmac_f32 v14, v76, v77
  v_fmac_f32 v14, v22, v78
  v_fmac_f32 v14, v23, v79
  s_nop 1
  v_add_f32_dpp v14, v14, v14 row_shr:1 row_mask:0xf bank_mask:0xf
  s_nop 1
  v_add_f32_dpp v14, v14, v14 row_shr:2 row_mask:0xf bank_mask:0xf
  s_nop 1
  v_add_f32_dpp v14, v14, v14 row_shr:4 row_mask:0xf bank_mask:0xf
  s_nop 1
  v_add_f32_dpp v14, v14, v14 row_shr:8 row_mask:0xf bank_mask:0xf
  s_nop 1
  v_add_f32_dpp v14, v14, v14 row_bcast:15 row_mask:0xa bank_mask:0xf
  s_nop 1
  v_add_f32_dpp v14, v14, v14 row_bcast:31 row_mask:0xc bank_mask:0xf
  s_branch L_blk
L_slow:
  v_lshlrev_b32 v22, 1, v0
  v_add_u32 v23, s74, v22
  s_mul_i32 s81, s3, 4224
  s_add_u32 s81, s81, 1024
  v_add_u32 v22, s81, v22
  v_add_u32 v8, s81, v9
  v_subrev_u32 v7, s75, v7
L_csync10:
  ds_read_b32 v4, v2 offset:12
  s_waitcnt lgkmcnt(0)
  v_cmp_gt_u32 vcc, 8, v4
  s_cbranch_vccnz L_csync10
  ds_read_u16 v52, v23 offset:0
  ds_read_u16 v53, v23 offset:128
  ds_read_u16 v54, v23 offset:256
  ds_read_u16 v55, v23 offset:384
  ds_read_u16 v56, v23 offset:512
  ds_read_u16 v57, v23 offset:640
  ds_read_u16 v58, v23 offset:768
  ds_read_u16 v59, v23 offset:896
  ds_read_u16 v60, v23 offset:1056
  ds_read_u16 v61, v23 offset:1184
  ds_read_u16 v62, v23 offset:1312
  ds_read_u16 v63, v23 offset:1440
  ds_read_u16 v64, v23 offset:1568
  ds_read_u16 v65, v23 offset:1696
  ds_read_u16 v66, v23 offset:1824
  ds_read_u16 v67, v23 offset:1952
  ds_read_u16 v68, v23 offset:2112
  ds_read_u16 v69, v23 offset:2240
  ds_read_u16 v70, v23 offset:2368
  ds_read_u16 v71, v23 offset:2496
  ds_read_u16 v72, v23 offset:2624
  ds_read_u16 v73, v23 offset:2752
  ds_read_u16 v74, v23 offset:2880
  ds_read_u16 v75, v23 offset:3008
  ds_read_u16 v76, v23 offset:3168
  ds_read_u16 v77, v23 offset:3296
  ds_read_u16 v78, v23 offset:3424
  ds_read_u16 v79, v23 offset:3552
  ds_read_u16 v80, v23 offset:3680
  ds_read_u16 v81, v23 offset:3808
  ds_read_u16 v82, v23 offset:3936
  s_waitcnt lgkmcnt(14)
  v_lshlrev_b32 v52, 16, v52
  v_lshlrev_b32 v53, 16, v53
  v_lshlrev_b32 v54, 16, v54
  v_lshlrev_b32 v55, 16, v55
  v_lshlrev_b32 v56, 16, v56
  v_lshlrev_b32 v57, 16, v57
  v_lshlrev_b32 v58, 16, v58
  v_lshlrev_b32 v59, 16, v59
  v_lshlrev_b32 v60, 16, v60
  v_lshlrev_b32 v61, 16, v61
  v_lshlrev_b32 v62, 16, v62
  v_lshlrev_b32 v63, 16, v63
  v_lshlrev_b32 v64, 16, v64
  v_lshlrev_b32 v65, 16, v65
  v_lshlrev_b32 v66, 16, v66
  v_lshlrev_b32 v67, 16, v67
  v_lshlrev_b32 v68, 16, v68
  s_waitcnt lgkmcnt(13)
  v_lshlrev_b32 v69, 16, v69
  s_waitcnt lgkmcnt(12)
  v_lshlrev_b32 v70, 16, v70
  s_waitcnt lgkmcnt(11)
  v_lshlrev_b32 v71, 16, v71
  s_waitcnt lgkmcnt(10)
  v_lshlrev_b32 v72, 16, v72
  s_waitcnt lgkmcnt(9)
  v_lshlrev_b32 v73, 16, v73
  s_waitcnt lgkmcnt(8)
  v_lshlrev_b32 v74, 16, v74
  s_waitcnt lgkmcnt(7)
  v_lshlrev_b32 v75, 16, v75
  s_waitcnt lgkmcnt(6)
  v_lshlrev_b32 v76, 16, v76
  s_waitcnt lgkmcnt(5)
  v_lshlrev_b32 v77, 16, v77
  s_waitcnt lgkmcnt(4)
  v_lshlrev_b32 v78, 16, v78
  s_waitcnt lgkmcnt(3)
  v_lshlrev_b32 v79, 16, v79
  s_waitcnt lgkmcnt(2)
  v_lshlrev_b32 v80, 16, v80
  s_waitcnt lgkmcnt(1)
  v_lshlrev_b32 v81, 16, v81
  s_waitcnt lgkmcnt(0)
  v_lshlrev_b32 v82, 16, v82
  v_max3_f32 v14, abs(v52), abs(v53), abs(v54)
  v_max3_f32 v14, v14, abs(v55), abs(v56)
  v_max3_f32 v14, v14, abs(v57), abs(v58)
  v_max3_f32 v14, v14, abs(v59), abs(v60)
  v_max3_f32 v14, v14, abs(v61), abs(v62)
  v_max3_f32 v14, v14, abs(v63), abs(v64)
  v_max3_f32 v14, v14, abs(v65), abs(v66)
  v_max3_f32 v14, v14, abs(v67), abs(v68)
  v_max3_f32 v14, v14, abs(v69), abs(v70)
  v_max3_f32 v14, v14, abs(v71), abs(v72)
  v_max3_f32 v14, v14, abs(v73), abs(v74)
  v_max3_f32 v14, v14, abs(v75), abs(v76)
  v_max3_f32 v14, v14, abs(v77), abs(v78)
  v_max3_f32 v14, v14, abs(v79), abs(v80)
  v_max3_f32 v14, v14, abs(v81), abs(v82)
  s_nop 1
  v_max_u32_dpp v14, v14, v14 row_shr:1 row_mask:0xf bank_mask:0xf
  s_nop 1
  v_max_u32_dpp v14, v14, v14 row_shr:2 row_mask:0xf bank_mask:0xf
  s_nop 1
  v_max_u32_dpp v14, v14, v14 row_shr:4 row_mask:0xf bank_mask:0xf
  s_nop 1
  v_max_u32_dpp v14, v14, v14 row_shr:8 row_mask:0xf bank_mask:0xf
  s_nop 1
  v_max_u32_dpp v14, v14, v14 row_bcast:15 row_mask:0xa bank_mask:0xf
  s_nop 1
  v_max_u32_dpp v14, v14, v14 row_bcast:31 row_mask:0xc bank_mask:0xf
  s_nop 0
  v_readlane_b32 s81, v14, 63
  s_nop 0
  s_lshr_b32 s81, s81, 23
  s_sub_i32 s81, 134, s81
  s_min_i32 s81, s81, 16
  s_lshl_b32 s49, s81, 2
  s_sub_i32 s49, s48, s49
  s_add_i32 s81, s81, 127
  s_lshl_b32 s81, s81, 23
  v_mov_b32 v83, s81
  v_mul_f32 v52, s81, v52
  v_mul_f32 v53, s81, v53
  v_mul_f32 v54, s81, v54
  v_mul_f32 v55, s81, v55
  v_mul_f32 v56, s81, v56
  v_mul_f32 v57, s81, v57
  v_mul_f32 v58, s81, v58
  v_mul_f32 v59, s81, v59
  v_mul_f32 v60, s81, v60
  v_mul_f32 v61, s81, v61
  v_mul_f32 v62, s81, v62
  v_mul_f32 v63, s81, v63
  v_mul_f32 v64, s81, v64
  v_mul_f32 v65, s81, v65
  v_mul_f32 v66, s81, v66
  v_mul_f32 v67, s81, v67
  v_mul_f32 v68, s81, v68
  v_mul_f32 v69, s81, v69
  v_mul_f32 v70, s81, v70
  v_mul_f32 v71, s81, v71
  v_mul_f32 v72, s81, v72
  v_mul_f32 v73, s81, v73
  v_mul_f32 v74, s81, v74
  v_mul_f32 v75, s81, v75
  v_mul_f32 v76, s81, v76
  v_mul_f32 v77, s81, v77
  v_mul_f32 v78, s81, v78
  v_mul_f32 v79, s81, v79
  v_mul_f32 v80, s81, v80
  v_mul_f32 v81, s81, v81
  v_mul_f32 v82, s81, v82
  ds_write_b16_d16_hi v23, v52 offset:0
  ds_write_b16_d16_hi v23, v53 offset:128
  ds_write_b16_d16_hi v23, v54 offset:256
  ds_write_b16_d16_hi v23, v55 offset:384
  ds_write_b16_d16_hi v23, v56 offset:512
  ds_write_b16_d16_hi v23, v57 offset:640
  ds_write_b16_d16_hi v23, v58 offset:768
  ds_write_b16_d16_hi v23, v59 offset:896
  ds_write_b16_d16_hi v23, v60 offset:1056
  ds_write_b16_d16_hi v23, v61 offset:1184
  ds_write_b16_d16_hi v23, v62 offset:1312
  ds_write_b16_d16_hi v23, v63 offset:1440
  ds_write_b16_d16_hi v23, v64 offset:1568
  ds_write_b16_d16_hi v23, v65 offset:1696
  ds_write_b16_d16_hi v23, v66 offset:1824
  ds_write_b16_d16_hi v23, v67 offset:1952
  ds_write_b16_d16_hi v23, v68 offset:2112
  ds_write_b16_d16_hi v23, v69 offset:2240
  ds_write_b16_d16_hi v23, v70 offset:2368
  ds_write_b16_d16_hi v23, v71 offset:2496
  ds_write_b16_d16_hi v23, v72 offset:2624
  ds_write_b16_d16_hi v23, v73 offset:2752
  ds_write_b16_d16_hi v23, v74 offset:2880
  ds_write_b16_d16_hi v23, v75 offset:3008
  ds_write_b16_d16_hi v23, v76 offset:3168
  ds_write_b16_d16_hi v23, v77 offset:3296
  ds_write_b16_d16_hi v23, v78 offset:3424
  ds_write_b16_d16_hi v23, v79 offset:3552
  ds_write_b16_d16_hi v23, v80 offset:3680
  ds_write_b16_d16_hi v23, v81 offset:3808
  ds_write_b16_d16_hi v23, v82 offset:3936
  v_mul_f32 v52, s81, v52
  v_mul_f32 v53, s81, v53
  v_mul_f32 v54, s81, v54
  v_mul_f32 v55, s81, v55
  v_mul_f32 v56, s81, v56
  v_mul_f32 v57, s81, v57
  v_mul_f32 v58, s81, v58
  v_mul_f32 v59, s81, v59
  v_mul_f32 v60, s81, v60
  v_mul_f32 v61, s81, v61
  v_mul_f32 v62, s81, v62
  v_mul_f32 v63, s81, v63
  v_mul_f32 v64, s81, v64
  v_mul_f32 v65, s81, v65
  v_mul_f32 v66, s81, v66
  v_mul_f32 v67, s81, v67
  v_mul_f32 v68, s81, v68
  v_mul_f32 v69, s81, v69
  v_mul_f32 v70, s81, v70
  v_mul_f32 v71, s81, v71
  v_mul_f32 v72, s81, v72
  v_mul_f32 v73, s81, v73
  v_mul_f32 v74, s81, v74
  v_mul_f32 v75, s81, v75
  v_mul_f32 v76, s81, v76
  v_mul_f32 v77, s81, v77
  v_mul_f32 v78, s81, v78
  v_mul_f32 v79, s81, v79
  v_mul_f32 v80, s81, v80
  v_mul_f32 v81, s81, v81
  v_mul_f32 v82, s81, v82
  v_mul_f32 v83, s81, v83
  ds_write_b16_d16_hi v22, v52 offset:0
  ds_write_b16_d16_hi v22, v53 offset:128
  ds_write_b16_d16_hi v22, v54 offset:256
  ds_write_b16_d16_hi v22, v55 offset:384
  ds_write_b16_d16_hi v22, v56 offset:512
  ds_write_b16_d16_hi v22, v57 offset:640
  ds_write_b16_d16_hi v22, v58 offset:768
  ds_write_b16_d16_hi v22, v59 offset:896
  ds_write_b16_d16_hi v22, v60 offset:1056
  ds_write_b16_d16_hi v22, v61 offset:1184
  ds_write_b16_d16_hi v22, v62 offset:1312
  ds_write_b16_d16_hi v22, v63 offset:1440
  ds_write_b16_d16_hi v22, v64 offset:1568
  ds_write_b16_d16_hi v22, v65 offset:1696
  ds_write_b16_d16_hi v22, v66 offset:1824
  ds_write_b16_d16_hi v22, v67 offset:1952
  ds_write_b16_d16_hi v22, v68 offset:2112
  ds_write_b16_d16_hi v22, v69 offset:2240
  ds_write_b16_d16_hi v22, v70 offset:2368
  ds_write_b16_d16_hi v22, v71 offset:2496
  ds_write_b16_d16_hi v22, v72 offset:2624
  ds_write_b16_d16_hi v22, v73 offset:2752
  ds_write_b16_d16_hi v22, v74 offset:2880
  ds_write_b16_d16_hi v22, v75 offset:3008
  ds_write_b16_d16_hi v22, v76 offset:3168
  ds_write_b16_d16_hi v22, v77 offset:3296
  ds_write_b16_d16_hi v22, v78 offset:3424
  ds_write_b16_d16_hi v22, v79 offset:3552
  ds_write_b16_d16_hi v22, v80 offset:3680
  ds_write_b16_d16_hi v22, v81 offset:3808
  ds_write_b16_d16_hi v22, v82 offset:3936
  ds_write_b16_d16_hi v22, v83 offset:4064
  s_mov_b32 s50, 0
  s_mov_b32 s97, 2
  s_waitcnt lgkmcnt(0)
  s_branch L_prime
L_cin_done:
  s_endpgm
L_rem:
  s_lshr_b32 s84, s3, 2
  s_and_b32 s68, s2, 7
  s_lshl_b32 s68, s68, 3
  s_add_u32 s68, s68, s3
  s_mul_i32 s68, s68, 6656
  s_lshl_b32 s76, s3, 14
  v_lshlrev_b32 v248, 4, v0
  v_lshrrev_b32 v246, 4, v0
  v_lshrrev_b32 v247, 3, v0
  v_mul_u32_u24 v13, 3328, v247
  v_and_b32 v247, 2, v247
  s_and_b32 s69, s3, 1
  s_lshl_b32 s69, s69, 2
  v_or_b32 v247, s69, v247
  v_and_b32 v9, 7, v0
  v_xor_b32 v247, v247, v9
  v_lshl_add_u32 v13, v247, 4, v13
  s_mul_i32 s74, s3, 26624
  s_add_u32 s74, s74, 3200
  s_lshl_b32 s75, s3, 10
  s_add_u32 s75, s75, 131072
  s_waitcnt lgkmcnt(0)
  s_mov_b32 s28, s4
  s_and_b32 s29, s5, 0xffff
  s_mov_b32 s30, 425984
  s_mov_b32 s31, 0x20000
  s_add_u32 m0, s76, 8192
  s_nop 0
  buffer_load_dwordx4 v248, s[28:31], s68 offen lds
  s_add_u32 s68, s68, 1024
  s_add_u32 m0, s76, 9216
  s_nop 0
  buffer_load_dwordx4 v248, s[28:31], s68 offen lds
  s_add_u32 s68, s68, 1024
  s_add_u32 m0, s76, 10240
  s_nop 0
  buffer_load_dwordx4 v248, s[28:31], s68 offen lds
  s_add_u32 s68, s68, 1024
  s_add_u32 m0, s76, 11264
  s_nop 0
  buffer_load_dwordx4 v248, s[28:31], s68 offen lds
  s_add_u32 s68, s68, 1024
  s_add_u32 m0, s76, 12288
  s_nop 0
  buffer_load_dwordx4 v248, s[28:31], s68 offen lds
  s_add_u32 s68, s68, 1024
  s_add_u32 m0, s76, 13312
  s_nop 0
  buffer_load_dwordx4 v248, s[28:31], s68 offen lds
  s_add_u32 s68, s68, 1024
  s_add_u32 m0, s76, 14336
  s_nop 0
  buffer_load_dwordx4 v248, s[28:31], s68 offen lds
  s_add_u32 s68, s68, 1024
  s_mov_b32 s44, s12
  s_and_b32 s45, s13, 0xffff
  s_mov_b32 s46, 5537792
  s_mov_b32 s47, 0x20000
  s_add_u32 m0, s75, 0
  s_nop 0
  buffer_load_dwordx4 v13, s[44:47], s74 offen lds
  s_add_u32 s74, s74, 212992
  s_mov_b32 s60, s24
  s_and_b32 s61, s25, 0xffff
  s_mov_b32 s62, 268435456
  s_mov_b32 s63, 0x20000
  s_mov_b32 s64, s22
  s_and_b32 s65, s23, 0xffff
  s_mov_b32 s66, 256
  s_mov_b32 s67, 0x20000
  v_mov_b32 v64, -1
  v_mov_b32 v65, -1
  v_mov_b32 v66, -1
  v_mov_b32 v67, -1
  s_and_b32 s70, s2, 7
  s_lshl_b32 s68, s70, 3
  s_add_u32 s68, s68, s3
  s_lshl_b32 s68, s68, 11
  s_lshl_b32 s70, s70, 2
  buffer_store_dwordx4 v[64:67], v248, s[60:63], s68 offen sc1
  buffer_store_dwordx4 v[64:67], v248, s[60:63], s68 offen offset:1024 sc1
  s_mov_b32 s48, s14
  s_and_b32 s49, s15, 0xffff
  s_mov_b32 s50, 3328
  s_mov_b32 s51, 0x20000
  s_mov_b32 s52, s16
  s_and_b32 s53, s17, 0xffff
  s_mov_b32 s54, 3328
  s_mov_b32 s55, 0x20000
  s_mov_b32 s32, s6
  s_and_b32 s33, s7, 0xffff
  s_mov_b32 s34, 12800000
  s_mov_b32 s35, 0x20000
  v_xor_b32 v248, v9, v246
  v_lshlrev_b32 v14, 4, v248
  v_xor_b32 v15, 64, v14
  v_bfe_u32 v247, v0, 2, 2
  v_lshl_add_u32 v248, v246, 3, v247
  v_lshlrev_b32 v248, 7, v248
  v_and_b32 v247, 3, v0
  v_lshl_add_u32 v248, v247, 3, v248
  v_add_u32 v248, 131072, v248
  v_bfe_u32 v247, v0, 3, 2
  v_lshl_add_u32 v1, v247, 5, v248
  v_xor_b32 v2, 32, v1
  v_xor_b32 v7, 64, v1
  v_xor_b32 v8, 96, v1
  v_and_b32 v248, 15, v0
  v_lshlrev_b32 v248, 7, v248
  v_bfe_u32 v247, v0, 1, 3
  v_xor_b32 v247, v247, v246
  v_lshl_add_u32 v248, v247, 4, v248
  v_add_u32 v11, s76, v248
  v_xor_b32 v12, 64, v11
  v_lshrrev_b32 v247, 3, v0
  v_lshl_add_u32 v248, v9, 3, v247
  v_mul_u32_u24 v248, 104, v248
  v_add_u32 v248, s76, v248
  v_mov_b32 v240, 0xc0135761
  v_mov_b32 v241, 0xc0135761
  v_mov_b32 v242, 0xbdd2d3e8
  v_mov_b32 v243, 0xbdd2d3e8
  v_mov_b32 v244, 0x71800000
  v_mov_b32 v160, 0
  v_mov_b32 v161, 0
  v_mov_b32 v162, 0
  v_mov_b32 v163, 0
  v_mov_b32 v164, 0
  v_mov_b32 v165, 0
  v_mov_b32 v166, 0
  v_mov_b32 v167, 0
  v_mov_b32 v168, 0
  v_mov_b32 v169, 0
  v_mov_b32 v170, 0
  v_mov_b32 v171, 0
  v_mov_b32 v172, 0
  v_mov_b32 v173, 0
  v_mov_b32 v174, 0
  v_mov_b32 v175, 0
  v_mov_b32 v176, 0
  v_mov_b32 v177, 0
  v_mov_b32 v178, 0
  v_mov_b32 v179, 0
  v_mov_b32 v180, 0
  v_mov_b32 v181, 0
  v_mov_b32 v182, 0
  v_mov_b32 v183, 0
  v_mov_b32 v184, 0
  v_mov_b32 v185, 0
  v_mov_b32 v186, 0
  v_mov_b32 v187, 0
  v_mov_b32 v188, 0
  v_mov_b32 v189, 0
  v_mov_b32 v190, 0
  v_mov_b32 v191, 0
  v_mov_b32 v192, 0
  v_mov_b32 v193, 0
  v_mov_b32 v194, 0
  v_mov_b32 v195, 0
  v_mov_b32 v196, 0
  v_mov_b32 v197, 0
  v_mov_b32 v198, 0
  v_mov_b32 v199, 0
  v_mov_b32 v200, 0
  v_mov_b32 v201, 0
  v_mov_b32 v202, 0
  v_mov_b32 v203, 0
  v_mov_b32 v204, 0
  v_mov_b32 v205, 0
  v_mov_b32 v206, 0
  v_mov_b32 v207, 0
  v_mov_b32 v208, 0
  v_mov_b32 v209, 0
  v_mov_b32 v210, 0
  v_mov_b32 v211, 0
  v_mov_b32 v212, 0
  v_mov_b32 v213, 0
  v_mov_b32 v214, 0
  v_mov_b32 v215, 0
  v_mov_b32 v216, 0
  v_mov_b32 v217, 0
  v_mov_b32 v218, 0
  v_mov_b32 v219, 0
  v_mov_b32 v220, 0
  v_mov_b32 v221, 0
  v_mov_b32 v222, 0
  v_mov_b32 v223, 0
  s_waitcnt vmcnt(0)
  ds_read_b64 v[32:33], v248 offset:8192
  ds_read_b64 v[34:35], v248 offset:8200
  ds_read_b64 v[36:37], v248 offset:8208
  ds_read_b64 v[38:39], v248 offset:8216
  ds_read_b64 v[40:41], v248 offset:8224
  ds_read_b64 v[42:43], v248 offset:8232
  ds_read_b64 v[44:45], v248 offset:8240
  ds_read_b64 v[46:47], v248 offset:8248
  ds_read_b64 v[48:49], v248 offset:8256
  ds_read_b64 v[50:51], v248 offset:8264
  ds_read_b64 v[52:53], v248 offset:8272
  ds_read_b64 v[54:55], v248 offset:8280
  ds_read_b64 v[56:57], v248 offset:8288
  v_mov_b32 v24, 0
  v_mov_b32 v25, 0
  v_mov_b32 v26, 0
  v_mov_b32 v27, 0
  v_mov_b32 v28, 0
  v_mov_b32 v29, 0
  v_mov_b32 v30, 0
  v_mov_b32 v31, 0
  v_mov_b32 v58, 0x7f000000
  v_mov_b32 v59, 0x7f000000
  s_waitcnt lgkmcnt(12)
  v_lshlrev_b32 v32, 7, v32
  s_nop 1
  v_add_u32_dpp v24, v32, v14 row_newbcast:0 row_mask:0xf bank_mask:0x3
  v_add_u32_dpp v25, v32, v15 row_newbcast:1 row_mask:0xf bank_mask:0x3
  v_add_u32_dpp v26, v32, v14 row_newbcast:2 row_mask:0xf bank_mask:0x3
  v_add_u32_dpp v27, v32, v15 row_newbcast:3 row_mask:0xf bank_mask:0x3
  v_add_u32_dpp v24, v32, v14 row_newbcast:8 row_mask:0xf bank_mask:0xc
  v_add_u32_dpp v25, v32, v15 row_newbcast:9 row_mask:0xf bank_mask:0xc
  v_add_u32_dpp v26, v32, v14 row_newbcast:10 row_mask:0xf bank_mask:0xc
  v_add_u32_dpp v27, v32, v15 row_newbcast:11 row_mask:0xf bank_mask:0xc
  s_add_u32 m0, s76, 0
  s_nop 0
  buffer_load_dwordx4 v24, s[32:35], 0 offen lds
  s_add_u32 m0, s76, 1024
  s_nop 0
  buffer_load_dwordx4 v25, s[32:35], 0 offen lds
  s_add_u32 m0, s76, 2048
  s_nop 0
  buffer_load_dwordx4 v26, s[32:35], 0 offen lds
  s_add_u32 m0, s76, 3072
  s_nop 0
  buffer_load_dwordx4 v27, s[32:35], 0 offen lds
  v_add_u32_dpp v28, v32, v14 row_newbcast:4 row_mask:0xf bank_mask:0x3
  v_add_u32_dpp v29, v32, v15 row_newbcast:5 row_mask:0xf bank_mask:0x3
  v_add_u32_dpp v30, v32, v14 row_newbcast:6 row_mask:0xf bank_mask:0x3
  v_add_u32_dpp v31, v32, v15 row_newbcast:7 row_mask:0xf bank_mask:0x3
  v_add_u32_dpp v28, v32, v14 row_newbcast:12 row_mask:0xf bank_mask:0xc
  v_add_u32_dpp v29, v32, v15 row_newbcast:13 row_mask:0xf bank_mask:0xc
  v_add_u32_dpp v30, v32, v14 row_newbcast:14 row_mask:0xf bank_mask:0xc
  v_add_u32_dpp v31, v32, v15 row_newbcast:15 row_mask:0xf bank_mask:0xc
  s_add_u32 m0, s76, 4096
  s_nop 0
  buffer_load_dwordx4 v28, s[32:35], 0 offen lds
  s_add_u32 m0, s76, 5120
  s_nop 0
  buffer_load_dwordx4 v29, s[32:35], 0 offen lds
  s_add_u32 m0, s76, 6144
  s_nop 0
  buffer_load_dwordx4 v30, s[32:35], 0 offen lds
  s_add_u32 m0, s76, 7168
  s_nop 0
  buffer_load_dwordx4 v31, s[32:35], 0 offen lds
  s_add_u32 m0, s75, 8192
  s_nop 0
  buffer_load_dwordx4 v13, s[44:47], s74 offen lds
  s_add_u32 s74, s74, 212992
  s_waitcnt lgkmcnt(0)
  v_lshlrev_b32 v57, 7, v57
  v_lshlrev_b32 v56, 7, v56
  v_lshlrev_b32 v55, 7, v55
  v_lshlrev_b32 v54, 7, v54
  v_lshlrev_b32 v53, 7, v53
  v_lshlrev_b32 v52, 7, v52
  v_lshlrev_b32 v51, 7, v51
  v_lshlrev_b32 v50, 7, v50
  v_lshlrev_b32 v49, 7, v49
  v_lshlrev_b32 v48, 7, v48
  v_lshlrev_b32 v47, 7, v47
  v_lshlrev_b32 v46, 7, v46
  v_lshlrev_b32 v45, 7, v45
  v_lshlrev_b32 v44, 7, v44
  v_lshlrev_b32 v43, 7, v43
  v_lshlrev_b32 v42, 7, v42
  v_lshlrev_b32 v41, 7, v41
  v_lshlrev_b32 v40, 7, v40
  v_lshlrev_b32 v39, 7, v39
  v_lshlrev_b32 v38, 7, v38
  v_lshlrev_b32 v37, 7, v37
  v_lshlrev_b32 v36, 7, v36
  v_lshlrev_b32 v35, 7, v35
  v_lshlrev_b32 v34, 7, v34
  v_lshlrev_b32 v33, 7, v33
  s_nop 1
  v_add_u32_dpp v24, v33, v14 row_newbcast:0 row_mask:0xf bank_mask:0x3
  v_add_u32_dpp v25, v33, v15 row_newbcast:1 row_mask:0xf bank_mask:0x3
  v_add_u32_dpp v26, v33, v14 row_newbcast:2 row_mask:0xf bank_mask:0x3
  v_add_u32_dpp v27, v33, v15 row_newbcast:3 row_mask:0xf bank_mask:0x3
  v_add_u32_dpp v24, v33, v14 row_newbcast:8 row_mask:0xf bank_mask:0xc
  v_add_u32_dpp v25, v33, v15 row_newbcast:9 row_mask:0xf bank_mask:0xc
  v_add_u32_dpp v26, v33, v14 row_newbcast:10 row_mask:0xf bank_mask:0xc
  v_add_u32_dpp v27, v33, v15 row_newbcast:11 row_mask:0xf bank_mask:0xc
  s_add_u32 m0, s76, 8192
  s_nop 0
  buffer_load_dwordx4 v24, s[32:35], 0 offen lds
  s_add_u32 m0, s76, 9216
  s_nop 0
  buffer_load_dwordx4 v25, s[32:35], 0 offen lds
  s_add_u32 m0, s76, 10240
  s_nop 0
  buffer_load_dwordx4 v26, s[32:35], 0 offen lds
  s_add_u32 m0, s76, 11264
  s_nop 0
  buffer_load_dwordx4 v27, s[32:35], 0 offen lds
  v_add_u32_dpp v28, v33, v14 row_newbcast:4 row_mask:0xf bank_mask:0x3
  v_add_u32_dpp v29, v33, v15 row_newbcast:5 row_mask:0xf bank_mask:0x3
  v_add_u32_dpp v30, v33, v14 row_newbcast:6 row_mask:0xf bank_mask:0x3
  v_add_u32_dpp v31, v33, v15 row_newbcast:7 row_mask:0xf bank_mask:0x3
  v_add_u32_dpp v28, v33, v14 row_newbcast:12 row_mask:0xf bank_mask:0xc
  v_add_u32_dpp v29, v33, v15 row_newbcast:13 row_mask:0xf bank_mask:0xc
  v_add_u32_dpp v30, v33, v14 row_newbcast:14 row_mask:0xf bank_mask:0xc
  v_add_u32_dpp v31, v33, v15 row_newbcast:15 row_mask:0xf bank_mask:0xc
  s_add_u32 m0, s76, 12288
  s_nop 0
  buffer_load_dwordx4 v28, s[32:35], 0 offen lds
  s_add_u32 m0, s76, 13312
  s_nop 0
  buffer_load_dwordx4 v29, s[32:35], 0 offen lds
  s_add_u32 m0, s76, 14336
  s_nop 0
  buffer_load_dwordx4 v30, s[32:35], 0 offen lds
  s_add_u32 m0, s76, 15360
  s_nop 0
  buffer_load_dwordx4 v31, s[32:35], 0 offen lds
  s_add_u32 m0, s75, 16384
  s_nop 0
  buffer_load_dwordx4 v13, s[44:47], s74 offen lds
  s_add_u32 s74, s74, 212992
  v_lshlrev_b32 v248, 3, v246
  s_mov_b32 s73, 3
  v_mov_b32 v9, v34
  s_nop 1
  v_add_u32_dpp v24, v9, v14 row_newbcast:0 row_mask:0xf bank_mask:0x3
  v_add_u32_dpp v25, v9, v15 row_newbcast:1 row_mask:0xf bank_mask:0x3
  v_add_u32_dpp v26, v9, v14 row_newbcast:2 row_mask:0xf bank_mask:0x3
  v_add_u32_dpp v27, v9, v15 row_newbcast:3 row_mask:0xf bank_mask:0x3
  v_add_u32_dpp v24, v9, v14 row_newbcast:8 row_mask:0xf bank_mask:0xc
  v_add_u32_dpp v25, v9, v15 row_newbcast:9 row_mask:0xf bank_mask:0xc
  v_add_u32_dpp v26, v9, v14 row_newbcast:10 row_mask:0xf bank_mask:0xc
  v_add_u32_dpp v27, v9, v15 row_newbcast:11 row_mask:0xf bank_mask:0xc
  s_waitcnt vmcnt(14)
  s_barrier
  ds_read_b128 v[76:79], v12 offset:2048
  ds_read_b128 v[72:75], v11 offset:2048
  ds_read_b128 v[68:71], v12 offset:0
  ds_read_b128 v[64:67], v11 offset:0
  ds_read_b64_tr_b16 v[96:97], v1 offset:0
  ds_read_b64_tr_b16 v[98:99], v1 offset:512
  ds_read_b64_tr_b16 v[100:101], v1 offset:4096
  ds_read_b64_tr_b16 v[102:103], v1 offset:4608
  ds_read_b64_tr_b16 v[104:105], v2 offset:0
  ds_read_b64_tr_b16 v[106:107], v2 offset:512
  ds_read_b64_tr_b16 v[108:109], v2 offset:4096
  ds_read_b64_tr_b16 v[110:111], v2 offset:4608
  ds_read_b64_tr_b16 v[112:113], v7 offset:0
  ds_read_b64_tr_b16 v[114:115], v7 offset:512
  ds_read_b64_tr_b16 v[116:117], v7 offset:4096
  ds_read_b64_tr_b16 v[118:119], v7 offset:4608
  ds_read_b64_tr_b16 v[120:121], v8 offset:0
  ds_read_b64_tr_b16 v[122:123], v8 offset:512
  ds_read_b64_tr_b16 v[124:125], v8 offset:4096
  ds_read_b64_tr_b16 v[126:127], v8 offset:4608
  s_cmp_lg_u32 s3, 7
  s_cbranch_scc1 L_rem_loop
  s_mov_b64 exec, 1
  buffer_store_dword v240, v14, s[64:67], s70 offen offset:128 sc1
  s_mov_b64 exec, -1
L_rem_loop:
  s_waitcnt vmcnt(9)
  s_barrier
  s_waitcnt lgkmcnt(8)
  v_mfma_f32_16x16x32_bf16 v[160:163], v[96:99], v[64:67], v[160:163]
  ds_read_b128 v[92:95], v12 offset:6144
  ds_read_b128 v[88:91], v11 offset:6144
  s_waitcnt lgkmcnt(14)
  v_mfma_f32_16x16x32_bf16 v[160:163], v[100:103], v[68:71], v[160:163]
  ds_read_b128 v[84:87], v12 offset:4096
  s_add_u32 m0, s76, 0
  s_nop 0
  buffer_load_dwordx4 v24, s[32:35], 0 offen lds
  v_mfma_f32_16x16x32_bf16 v[164:167], v[96:99], v[72:75], v[164:167]
  ds_read_b128 v[80:83], v11 offset:4096
  v_mfma_f32_16x16x32_bf16 v[164:167], v[100:103], v[76:79], v[164:167]
  ds_read_b64_tr_b16 v[128:129], v1 offset:8192
  s_waitcnt lgkmcnt(14)
  v_mfma_f32_16x16x32_bf16 v[176:179], v[104:107], v[64:67], v[176:179]
  ds_read_b64_tr_b16 v[130:131], v1 offset:8704
  s_add_u32 m0, s76, 1024
  s_nop 0
  buffer_load_dwordx4 v25, s[32:35], 0 offen lds
  s_waitcnt lgkmcnt(14)
  v_mfma_f32_16x16x32_bf16 v[176:179], v[108:111], v[68:71], v[176:179]
  ds_read_b64_tr_b16 v[132:133], v1 offset:12288
  v_mfma_f32_16x16x32_bf16 v[180:183], v[104:107], v[72:75], v[180:183]
  ds_read_b64_tr_b16 v[134:135], v1 offset:12800
  v_mfma_f32_16x16x32_bf16 v[180:183], v[108:111], v[76:79], v[180:183]
  ds_read_b64_tr_b16 v[136:137], v2 offset:8192
  s_waitcnt lgkmcnt(14)
  v_mfma_f32_16x16x32_bf16 v[192:195], v[112:115], v[64:67], v[192:195]
  ds_read_b64_tr_b16 v[138:139], v2 offset:8704
  s_add_u32 m0, s76, 2048
  s_nop 0
  buffer_load_dwordx4 v26, s[32:35], 0 offen lds
  s_waitcnt lgkmcnt(14)
  v_mfma_f32_16x16x32_bf16 v[192:195], v[116:119], v[68:71], v[192:195]
  ds_read_b64_tr_b16 v[140:141], v2 offset:12288
  v_mfma_f32_16x16x32_bf16 v[196:199], v[112:115], v[72:75], v[196:199]
  ds_read_b64_tr_b16 v[142:143], v2 offset:12800
  v_mfma_f32_16x16x32_bf16 v[196:199], v[116:119], v[76:79], v[196:199]
  v_add_u32_dpp v28, v9, v14 row_newbcast:4 row_mask:0xf bank_mask:0x3
  v_add_u32_dpp v29, v9, v15 row_newbcast:5 row_mask:0xf bank_mask:0x3
  s_waitcnt lgkmcnt(14)
  v_mfma_f32_16x16x32_bf16 v[208:211], v[120:123], v[64:67], v[208:211]
  s_add_u32 m0, s76, 3072
  s_nop 0
  buffer_load_dwordx4 v27, s[32:35], 0 offen lds
  v_add_u32_dpp v30, v9, v14 row_newbcast:6 row_mask:0xf bank_mask:0x3
  v_add_u32_dpp v31, v9, v15 row_newbcast:7 row_mask:0xf bank_mask:0x3
  s_waitcnt lgkmcnt(12)
  v_mfma_f32_16x16x32_bf16 v[208:211], v[124:127], v[68:71], v[208:211]
  v_add_u32_dpp v28, v9, v14 row_newbcast:12 row_mask:0xf bank_mask:0xc
  v_mfma_f32_16x16x32_bf16 v[212:215], v[120:123], v[72:75], v[212:215]
  v_add_u32_dpp v29, v9, v15 row_newbcast:13 row_mask:0xf bank_mask:0xc
  v_add_u32_dpp v30, v9, v14 row_newbcast:14 row_mask:0xf bank_mask:0xc
  v_mfma_f32_16x16x32_bf16 v[212:215], v[124:127], v[76:79], v[212:215]
  v_add_u32_dpp v31, v9, v15 row_newbcast:15 row_mask:0xf bank_mask:0xc
  s_waitcnt vmcnt(9)
  s_waitcnt lgkmcnt(8)
  v_mfma_f32_16x16x32_bf16 v[168:171], v[96:99], v[80:83], v[168:171]
  ds_read_b128 v[76:79], v12 offset:10240
  ds_read_b128 v[72:75], v11 offset:10240
  v_mfma_f32_16x16x32_bf16 v[168:171], v[100:103], v[84:87], v[168:171]
  ds_read_b128 v[68:71], v12 offset:8192
  s_add_u32 m0, s76, 4096
  s_nop 0
  buffer_load_dwordx4 v28, s[32:35], 0 offen lds
  v_mfma_f32_16x16x32_bf16 v[172:175], v[96:99], v[88:91], v[172:175]
  ds_read_b128 v[64:67], v11 offset:8192
  v_mfma_f32_16x16x32_bf16 v[172:175], v[100:103], v[92:95], v[172:175]
  ds_read_b64_tr_b16 v[144:145], v7 offset:8192
  v_mfma_f32_16x16x32_bf16 v[184:187], v[104:107], v[80:83], v[184:187]
  ds_read_b64_tr_b16 v[146:147], v7 offset:8704
  s_add_u32 m0, s76, 5120
  s_nop 0
  buffer_load_dwordx4 v29, s[32:35], 0 offen lds
  v_mfma_f32_16x16x32_bf16 v[184:187], v[108:111], v[84:87], v[184:187]
  ds_read_b64_tr_b16 v[148:149], v7 offset:12288
  v_mfma_f32_16x16x32_bf16 v[188:191], v[104:107], v[88:91], v[188:191]
  ds_read_b64_tr_b16 v[150:151], v7 offset:12800
  v_mfma_f32_16x16x32_bf16 v[188:191], v[108:111], v[92:95], v[188:191]
  ds_read_b64_tr_b16 v[152:153], v8 offset:8192
  s_add_u32 m0, s76, 6144
  s_nop 0
  buffer_load_dwordx4 v30, s[32:35], 0 offen lds
  v_mfma_f32_16x16x32_bf16 v[200:203], v[112:115], v[80:83], v[200:203]
  ds_read_b64_tr_b16 v[154:155], v8 offset:8704
  v_mfma_f32_16x16x32_bf16 v[200:203], v[116:119], v[84:87], v[200:203]
  ds_read_b64_tr_b16 v[156:157], v8 offset:12288
  v_mfma_f32_16x16x32_bf16 v[204:207], v[112:115], v[88:91], v[204:207]
  ds_read_b64_tr_b16 v[158:159], v8 offset:12800
  s_add_u32 m0, s76, 7168
  s_nop 0
  buffer_load_dwordx4 v31, s[32:35], 0 offen lds
  v_mfma_f32_16x16x32_bf16 v[204:207], v[116:119], v[92:95], v[204:207]
  s_set_gpr_idx_on s73, gpr_idx(SRC0)
  s_nop 0
  v_mov_b32 v9, v32
  s_set_gpr_idx_off
  s_add_u32 s73, s73, 1
  v_add_u32_dpp v24, v9, v14 row_newbcast:0 row_mask:0xf bank_mask:0x3
  v_mfma_f32_16x16x32_bf16 v[216:219], v[120:123], v[80:83], v[216:219]
  v_add_u32_dpp v25, v9, v15 row_newbcast:1 row_mask:0xf bank_mask:0x3
  v_add_u32_dpp v26, v9, v14 row_newbcast:2 row_mask:0xf bank_mask:0x3
  v_mfma_f32_16x16x32_bf16 v[216:219], v[124:127], v[84:87], v[216:219]
  s_xor_b32 s75, s75, 16384
  s_add_u32 m0, s75, 8192
  s_nop 0
  buffer_load_dwordx4 v13, s[44:47], s74 offen lds
  s_add_u32 s74, s74, 212992
  s_xor_b32 s75, s75, 16384
  v_add_u32_dpp v27, v9, v15 row_newbcast:3 row_mask:0xf bank_mask:0x3
  v_add_u32_dpp v24, v9, v14 row_newbcast:8 row_mask:0xf bank_mask:0xc
  v_mfma_f32_16x16x32_bf16 v[220:223], v[120:123], v[88:91], v[220:223]
  v_add_u32_dpp v25, v9, v15 row_newbcast:9 row_mask:0xf bank_mask:0xc
  v_add_u32_dpp v26, v9, v14 row_newbcast:10 row_mask:0xf bank_mask:0xc
  v_mfma_f32_16x16x32_bf16 v[220:223], v[124:127], v[92:95], v[220:223]
  v_add_u32_dpp v27, v9, v15 row_newbcast:11 row_mask:0xf bank_mask:0xc
  s_waitcnt vmcnt(9)
  s_barrier
  v_xor_b32 v1, 16384, v1
  v_xor_b32 v2, 16384, v2
  v_xor_b32 v7, 16384, v7
  v_xor_b32 v8, 16384, v8
  s_waitcnt lgkmcnt(8)
  v_mfma_f32_16x16x32_bf16 v[160:163], v[128:131], v[64:67], v[160:163]
  ds_read_b128 v[92:95], v12 offset:14336
  ds_read_b128 v[88:91], v11 offset:14336
  v_mfma_f32_16x16x32_bf16 v[160:163], v[132:135], v[68:71], v[160:163]
  ds_read_b128 v[84:87], v12 offset:12288
  s_add_u32 m0, s76, 8192
  s_nop 0
  buffer_load_dwordx4 v24, s[32:35], 0 offen lds
  v_mfma_f32_16x16x32_bf16 v[164:167], v[128:131], v[72:75], v[164:167]
  ds_read_b128 v[80:83], v11 offset:12288
  v_mfma_f32_16x16x32_bf16 v[164:167], v[132:135], v[76:79], v[164:167]
  ds_read_b64_tr_b16 v[96:97], v1 offset:0
  v_mfma_f32_16x16x32_bf16 v[176:179], v[136:139], v[64:67], v[176:179]
  ds_read_b64_tr_b16 v[98:99], v1 offset:512
  s_add_u32 m0, s76, 9216
  s_nop 0
  buffer_load_dwordx4 v25, s[32:35], 0 offen lds
  v_mfma_f32_16x16x32_bf16 v[176:179], v[140:143], v[68:71], v[176:179]
  ds_read_b64_tr_b16 v[100:101], v1 offset:4096
  v_mfma_f32_16x16x32_bf16 v[180:183], v[136:139], v[72:75], v[180:183]
  ds_read_b64_tr_b16 v[102:103], v1 offset:4608
  v_mfma_f32_16x16x32_bf16 v[180:183], v[140:143], v[76:79], v[180:183]
  ds_read_b64_tr_b16 v[104:105], v2 offset:0
  s_waitcnt lgkmcnt(14)
  v_mfma_f32_16x16x32_bf16 v[192:195], v[144:147], v[64:67], v[192:195]
  ds_read_b64_tr_b16 v[106:107], v2 offset:512
  s_add_u32 m0, s76, 10240
  s_nop 0
  buffer_load_dwordx4 v26, s[32:35], 0 offen lds
  s_waitcnt lgkmcnt(14)
  v_mfma_f32_16x16x32_bf16 v[192:195], v[148:151], v[68:71], v[192:195]
  ds_read_b64_tr_b16 v[108:109], v2 offset:4096
  v_mfma_f32_16x16x32_bf16 v[196:199], v[144:147], v[72:75], v[196:199]
  ds_read_b64_tr_b16 v[110:111], v2 offset:4608
  v_mfma_f32_16x16x32_bf16 v[196:199], v[148:151], v[76:79], v[196:199]
  v_add_u32_dpp v28, v9, v14 row_newbcast:4 row_mask:0xf bank_mask:0x3
  v_add_u32_dpp v29, v9, v15 row_newbcast:5 row_mask:0xf bank_mask:0x3
  s_waitcnt lgkmcnt(14)
  v_mfma_f32_16x16x32_bf16 v[208:211], v[152:155], v[64:67], v[208:211]
  s_add_u32 m0, s76, 11264
  s_nop 0
  buffer_load_dwordx4 v27, s[32:35], 0 offen lds
  v_add_u32_dpp v30, v9, v14 row_newbcast:6 row_mask:0xf bank_mask:0x3
  v_add_u32_dpp v31, v9, v15 row_newbcast:7 row_mask:0xf bank_mask:0x3
  s_waitcnt lgkmcnt(12)
  v_mfma_f32_16x16x32_bf16 v[208:211], v[156:159], v[68:71], v[208:211]
  v_add_u32_dpp v28, v9, v14 row_newbcast:12 row_mask:0xf bank_mask:0xc
  v_mfma_f32_16x16x32_bf16 v[212:215], v[152:155], v[72:75], v[212:215]
  v_add_u32_dpp v29, v9, v15 row_newbcast:13 row_mask:0xf bank_mask:0xc
  v_add_u32_dpp v30, v9, v14 row_newbcast:14 row_mask:0xf bank_mask:0xc
  v_mfma_f32_16x16x32_bf16 v[212:215], v[156:159], v[76:79], v[212:215]
  v_add_u32_dpp v31, v9, v15 row_newbcast:15 row_mask:0xf bank_mask:0xc
  s_waitcnt vmcnt(9)
  s_waitcnt lgkmcnt(8)
  v_mfma_f32_16x16x32_bf16 v[168:171], v[128:131], v[80:83], v[168:171]
  ds_read_b128 v[76:79], v12 offset:2048
  ds_read_b128 v[72:75], v11 offset:2048
  v_mfma_f32_16x16x32_bf16 v[168:171], v[132:135], v[84:87], v[168:171]
  ds_read_b128 v[68:71], v12 offset:0
  s_add_u32 m0, s76, 12288
  s_nop 0
  buffer_load_dwordx4 v28, s[32:35], 0 offen lds
  v_mfma_f32_16x16x32_bf16 v[172:175], v[128:131], v[88:91], v[172:175]
  ds_read_b128 v[64:67], v11 offset:0
  v_mfma_f32_16x16x32_bf16 v[172:175], v[132:135], v[92:95], v[172:175]
  ds_read_b64_tr_b16 v[112:113], v7 offset:0
  v_mfma_f32_16x16x32_bf16 v[184:187], v[136:139], v[80:83], v[184:187]
  ds_read_b64_tr_b16 v[114:115], v7 offset:512
  s_add_u32 m0, s76, 13312
  s_nop 0
  buffer_load_dwordx4 v29, s[32:35], 0 offen lds
  v_mfma_f32_16x16x32_bf16 v[184:187], v[140:143], v[84:87], v[184:187]
  ds_read_b64_tr_b16 v[116:117], v7 offset:4096
  v_mfma_f32_16x16x32_bf16 v[188:191], v[136:139], v[88:91], v[188:191]
  ds_read_b64_tr_b16 v[118:119], v7 offset:4608
  v_mfma_f32_16x16x32_bf16 v[188:191], v[140:143], v[92:95], v[188:191]
  ds_read_b64_tr_b16 v[120:121], v8 offset:0
  s_add_u32 m0, s76, 14336
  s_nop 0
  buffer_load_dwordx4 v30, s[32:35], 0 offen lds
  v_mfma_f32_16x16x32_bf16 v[200:203], v[144:147], v[80:83], v[200:203]
  ds_read_b64_tr_b16 v[122:123], v8 offset:512
  v_mfma_f32_16x16x32_bf16 v[200:203], v[148:151], v[84:87], v[200:203]
  ds_read_b64_tr_b16 v[124:125], v8 offset:4096
  v_mfma_f32_16x16x32_bf16 v[204:207], v[144:147], v[88:91], v[204:207]
  ds_read_b64_tr_b16 v[126:127], v8 offset:4608
  s_add_u32 m0, s76, 15360
  s_nop 0
  buffer_load_dwordx4 v31, s[32:35], 0 offen lds
  v_mfma_f32_16x16x32_bf16 v[204:207], v[148:151], v[92:95], v[204:207]
  s_set_gpr_idx_on s73, gpr_idx(SRC0)
  s_nop 0
  v_mov_b32 v9, v32
  s_set_gpr_idx_off
  s_add_u32 s73, s73, 1
  v_add_u32_dpp v24, v9, v14 row_newbcast:0 row_mask:0xf bank_mask:0x3
  v_mfma_f32_16x16x32_bf16 v[216:219], v[152:155], v[80:83], v[216:219]
  v_add_u32_dpp v25, v9, v15 row_newbcast:1 row_mask:0xf bank_mask:0x3
  v_add_u32_dpp v26, v9, v14 row_newbcast:2 row_mask:0xf bank_mask:0x3
  v_mfma_f32_16x16x32_bf16 v[216:219], v[156:159], v[84:87], v[216:219]
  s_add_u32 m0, s75, 0
  s_nop 0
  buffer_load_dwordx4 v13, s[44:47], s74 offen lds
  s_add_u32 s74, s74, 212992
  s_xor_b32 s75, s75, 16384
  v_add_u32_dpp v27, v9, v15 row_newbcast:3 row_mask:0xf bank_mask:0x3
  v_add_u32_dpp v24, v9, v14 row_newbcast:8 row_mask:0xf bank_mask:0xc
  v_mfma_f32_16x16x32_bf16 v[220:223], v[152:155], v[88:91], v[220:223]
  v_add_u32_dpp v25, v9, v15 row_newbcast:9 row_mask:0xf bank_mask:0xc
  v_add_u32_dpp v26, v9, v14 row_newbcast:10 row_mask:0xf bank_mask:0xc
  v_mfma_f32_16x16x32_bf16 v[220:223], v[156:159], v[92:95], v[220:223]
  v_add_u32_dpp v27, v9, v15 row_newbcast:11 row_mask:0xf bank_mask:0xc
  s_cmp_lt_u32 s73, 27
  s_cbranch_scc1 L_rem_loop
  s_waitcnt vmcnt(0)
  s_barrier
  s_waitcnt lgkmcnt(8)
  v_mfma_f32_16x16x32_bf16 v[160:163], v[96:99], v[64:67], v[160:163]
  ds_read_b128 v[92:95], v12 offset:6144
  ds_read_b128 v[88:91], v11 offset:6144
  v_mfma_f32_16x16x32_bf16 v[160:163], v[100:103], v[68:71], v[160:163]
  ds_read_b128 v[84:87], v12 offset:4096
  buffer_load_dwordx2 v[224:225], v248, s[48:51], 0 offen offset:3200
  v_mfma_f32_16x16x32_bf16 v[164:167], v[96:99], v[72:75], v[164:167]
  ds_read_b128 v[80:83], v11 offset:4096
  buffer_load_dwordx2 v[226:227], v248, s[48:51], 0 offen offset:3232
  v_mfma_f32_16x16x32_bf16 v[164:167], v[100:103], v[76:79], v[164:167]
  ds_read_b64_tr_b16 v[128:129], v1 offset:8192
  v_mfma_f32_16x16x32_bf16 v[176:179], v[104:107], v[64:67], v[176:179]
  ds_read_b64_tr_b16 v[130:131], v1 offset:8704
  buffer_load_dwordx2 v[228:229], v248, s[48:51], 0 offen offset:3264
  v_mfma_f32_16x16x32_bf16 v[176:179], v[108:111], v[68:71], v[176:179]
  ds_read_b64_tr_b16 v[132:133], v1 offset:12288
  v_mfma_f32_16x16x32_bf16 v[180:183], v[104:107], v[72:75], v[180:183]
  ds_read_b64_tr_b16 v[134:135], v1 offset:12800
  buffer_load_dwordx2 v[230:231], v248, s[48:51], 0 offen offset:3296
  v_mfma_f32_16x16x32_bf16 v[180:183], v[108:111], v[76:79], v[180:183]
  ds_read_b64_tr_b16 v[136:137], v2 offset:8192
  s_waitcnt lgkmcnt(14)
  v_mfma_f32_16x16x32_bf16 v[192:195], v[112:115], v[64:67], v[192:195]
  ds_read_b64_tr_b16 v[138:139], v2 offset:8704
  buffer_load_dwordx2 v[232:233], v248, s[52:55], 0 offen offset:3200
  s_waitcnt lgkmcnt(14)
  v_mfma_f32_16x16x32_bf16 v[192:195], v[116:119], v[68:71], v[192:195]
  ds_read_b64_tr_b16 v[140:141], v2 offset:12288
  v_mfma_f32_16x16x32_bf16 v[196:199], v[112:115], v[72:75], v[196:199]
  ds_read_b64_tr_b16 v[142:143], v2 offset:12800
  buffer_load_dwordx2 v[234:235], v248, s[52:55], 0 offen offset:3232
  v_mfma_f32_16x16x32_bf16 v[196:199], v[116:119], v[76:79], v[196:199]
  s_waitcnt lgkmcnt(14)
  v_mfma_f32_16x16x32_bf16 v[208:211], v[120:123], v[64:67], v[208:211]
  buffer_load_dwordx2 v[236:237], v248, s[52:55], 0 offen offset:3264
  s_waitcnt lgkmcnt(12)
  v_mfma_f32_16x16x32_bf16 v[208:211], v[124:127], v[68:71], v[208:211]
  v_mfma_f32_16x16x32_bf16 v[212:215], v[120:123], v[72:75], v[212:215]
  buffer_load_dwordx2 v[238:239], v248, s[52:55], 0 offen offset:3296
  v_mfma_f32_16x16x32_bf16 v[212:215], v[124:127], v[76:79], v[212:215]
  s_waitcnt lgkmcnt(8)
  v_mfma_f32_16x16x32_bf16 v[168:171], v[96:99], v[80:83], v[168:171]
  ds_read_b128 v[76:79], v12 offset:10240
  ds_read_b128 v[72:75], v11 offset:10240
  v_mfma_f32_16x16x32_bf16 v[168:171], v[100:103], v[84:87], v[168:171]
  ds_read_b128 v[68:71], v12 offset:8192
  v_mfma_f32_16x16x32_bf16 v[172:175], v[96:99], v[88:91], v[172:175]
  ds_read_b128 v[64:67], v11 offset:8192
  v_mfma_f32_16x16x32_bf16 v[172:175], v[100:103], v[92:95], v[172:175]
  ds_read_b64_tr_b16 v[144:145], v7 offset:8192
  v_mfma_f32_16x16x32_bf16 v[184:187], v[104:107], v[80:83], v[184:187]
  ds_read_b64_tr_b16 v[146:147], v7 offset:8704
  v_mfma_f32_16x16x32_bf16 v[184:187], v[108:111], v[84:87], v[184:187]
  ds_read_b64_tr_b16 v[148:149], v7 offset:12288
  v_mfma_f32_16x16x32_bf16 v[188:191], v[104:107], v[88:91], v[188:191]
  ds_read_b64_tr_b16 v[150:151], v7 offset:12800
  v_mfma_f32_16x16x32_bf16 v[188:191], v[108:111], v[92:95], v[188:191]
  ds_read_b64_tr_b16 v[152:153], v8 offset:8192
  v_mfma_f32_16x16x32_bf16 v[200:203], v[112:115], v[80:83], v[200:203]
  ds_read_b64_tr_b16 v[154:155], v8 offset:8704
  v_mfma_f32_16x16x32_bf16 v[200:203], v[116:119], v[84:87], v[200:203]
  ds_read_b64_tr_b16 v[156:157], v8 offset:12288
  v_mfma_f32_16x16x32_bf16 v[204:207], v[112:115], v[88:91], v[204:207]
  ds_read_b64_tr_b16 v[158:159], v8 offset:12800
  v_mfma_f32_16x16x32_bf16 v[204:207], v[116:119], v[92:95], v[204:207]
  v_mfma_f32_16x16x32_bf16 v[216:219], v[120:123], v[80:83], v[216:219]
  v_mfma_f32_16x16x32_bf16 v[216:219], v[124:127], v[84:87], v[216:219]
  v_mfma_f32_16x16x32_bf16 v[220:223], v[120:123], v[88:91], v[220:223]
  v_mfma_f32_16x16x32_bf16 v[220:223], v[124:127], v[92:95], v[220:223]
  s_waitcnt lgkmcnt(8)
  v_mfma_f32_16x16x32_bf16 v[160:163], v[128:131], v[64:67], v[160:163]
  ds_read_b128 v[92:95], v12 offset:14336
  v_mfma_f32_16x16x32_bf16 v[160:163], v[132:135], v[68:71], v[160:163]
  v_mfma_f32_16x16x32_bf16 v[164:167], v[128:131], v[72:75], v[164:167]
  ds_read_b128 v[88:91], v11 offset:14336
  v_mfma_f32_16x16x32_bf16 v[164:167], v[132:135], v[76:79], v[164:167]
  v_mfma_f32_16x16x32_bf16 v[176:179], v[136:139], v[64:67], v[176:179]
  v_mfma_f32_16x16x32_bf16 v[176:179], v[140:143], v[68:71], v[176:179]
  ds_read_b128 v[84:87], v12 offset:12288
  v_mfma_f32_16x16x32_bf16 v[180:183], v[136:139], v[72:75], v[180:183]
  v_mfma_f32_16x16x32_bf16 v[180:183], v[140:143], v[76:79], v[180:183]
  s_waitcnt lgkmcnt(9)
  v_mfma_f32_16x16x32_bf16 v[192:195], v[144:147], v[64:67], v[192:195]
  ds_read_b128 v[80:83], v11 offset:12288
  s_waitcnt lgkmcnt(8)
  v_mfma_f32_16x16x32_bf16 v[192:195], v[148:151], v[68:71], v[192:195]
  v_mfma_f32_16x16x32_bf16 v[196:199], v[144:147], v[72:75], v[196:199]
  v_mfma_f32_16x16x32_bf16 v[196:199], v[148:151], v[76:79], v[196:199]
  s_waitcnt lgkmcnt(6)
  v_mfma_f32_16x16x32_bf16 v[208:211], v[152:155], v[64:67], v[208:211]
  s_waitcnt lgkmcnt(4)
  v_mfma_f32_16x16x32_bf16 v[208:211], v[156:159], v[68:71], v[208:211]
  v_mfma_f32_16x16x32_bf16 v[212:215], v[152:155], v[72:75], v[212:215]
  v_mfma_f32_16x16x32_bf16 v[212:215], v[156:159], v[76:79], v[212:215]
  s_waitcnt lgkmcnt(0)
  v_mfma_f32_16x16x32_bf16 v[168:171], v[128:131], v[80:83], v[168:171]
  s_waitcnt vmcnt(7)
  v_lshlrev_b32 v112, 16, v224
  v_and_b32 v113, 0xffff0000, v224
  v_mfma_f32_16x16x32_bf16 v[168:171], v[132:135], v[84:87], v[168:171]
  s_waitcnt vmcnt(3)
  v_lshlrev_b32 v96, 16, v232
  v_and_b32 v97, 0xffff0000, v232
  v_mfma_f32_16x16x32_bf16 v[172:175], v[128:131], v[88:91], v[172:175]
  v_lshlrev_b32 v114, 16, v225
  v_and_b32 v115, 0xffff0000, v225
  v_mfma_f32_16x16x32_bf16 v[172:175], v[132:135], v[92:95], v[172:175]
  v_lshlrev_b32 v98, 16, v233
  v_and_b32 v99, 0xffff0000, v233
  v_mfma_f32_16x16x32_bf16 v[184:187], v[136:139], v[80:83], v[184:187]
  v_lshlrev_b32 v116, 16, v226
  v_and_b32 v117, 0xffff0000, v226
  v_mfma_f32_16x16x32_bf16 v[184:187], v[140:143], v[84:87], v[184:187]
  s_waitcnt vmcnt(2)
  v_lshlrev_b32 v100, 16, v234
  v_and_b32 v101, 0xffff0000, v234
  v_mfma_f32_16x16x32_bf16 v[188:191], v[136:139], v[88:91], v[188:191]
  v_lshlrev_b32 v118, 16, v227
  v_and_b32 v119, 0xffff0000, v227
  v_mfma_f32_16x16x32_bf16 v[188:191], v[140:143], v[92:95], v[188:191]
  v_lshlrev_b32 v102, 16, v235
  v_and_b32 v103, 0xffff0000, v235
  v_mfma_f32_16x16x32_bf16 v[200:203], v[144:147], v[80:83], v[200:203]
  v_lshlrev_b32 v120, 16, v228
  v_and_b32 v121, 0xffff0000, v228
  v_mfma_f32_16x16x32_bf16 v[200:203], v[148:151], v[84:87], v[200:203]
  s_waitcnt vmcnt(1)
  v_lshlrev_b32 v104, 16, v236
  v_and_b32 v105, 0xffff0000, v236
  v_mfma_f32_16x16x32_bf16 v[204:207], v[144:147], v[88:91], v[204:207]
  v_lshlrev_b32 v122, 16, v229
  v_and_b32 v123, 0xffff0000, v229
  v_mfma_f32_16x16x32_bf16 v[204:207], v[148:151], v[92:95], v[204:207]
  v_lshlrev_b32 v106, 16, v237
  v_and_b32 v107, 0xffff0000, v237
  v_mfma_f32_16x16x32_bf16 v[216:219], v[152:155], v[80:83], v[216:219]
  v_lshlrev_b32 v124, 16, v230
  v_and_b32 v125, 0xffff0000, v230
  v_mfma_f32_16x16x32_bf16 v[216:219], v[156:159], v[84:87], v[216:219]
  s_waitcnt vmcnt(0)
  v_lshlrev_b32 v108, 16, v238
  v_and_b32 v109, 0xffff0000, v238
  v_mfma_f32_16x16x32_bf16 v[220:223], v[152:155], v[88:91], v[220:223]
  v_lshlrev_b32 v126, 16, v231
  v_and_b32 v127, 0xffff0000, v231
  v_mfma_f32_16x16x32_bf16 v[220:223], v[156:159], v[92:95], v[220:223]
  v_lshlrev_b32 v110, 16, v239
  v_and_b32 v111, 0xffff0000, v239
  s_mov_b32 s60, s24
  s_and_b32 s61, s25, 0xffff
  s_mov_b32 s62, 268435456
  s_mov_b32 s63, 0x20000
  s_mov_b32 s64, s22
  s_and_b32 s65, s23, 0xffff
  s_mov_b32 s66, 256
  s_mov_b32 s67, 0x20000
  v_lshlrev_b32 v4, 2, v0
  s_mov_b64 exec, 0xff
  s_mov_b32 s81, 0x80000
  buffer_load_dword v255, v4, s[60:63], s81 offen
  buffer_load_dword v5, v4, s[64:67], 0 offen offset:128 sc1
  s_mov_b64 exec, -1
  v_mov_b32 v4, 0
  s_mov_b32 s56, s20
  s_and_b32 s57, s21, 0xffff
  s_mov_b32 s58, 8192
  s_mov_b32 s59, 0x20000
  s_load_dword s80, s[18:19], 0
  buffer_load_dword v255, v4, s[56:59], 0 offen
  s_and_b32 s70, s2, 7
  s_lshl_b32 s68, s70, 14
  s_lshl_b32 s69, s3, 8
  s_add_u32 s68, s68, s69
  s_add_u32 s69, s68, 4096
  s_add_u32 s71, s68, 8192
  s_lshl_b32 s70, s70, 3
  s_add_u32 s70, s70, s3
  s_lshl_b32 s70, s70, 7
  v_lshlrev_b32 v3, 2, v0
  v_lshlrev_b32 v2, 1, v0
  s_waitcnt lgkmcnt(0)
  s_lshl_b32 s80, s80, 16
  v_rcp_f32 v96, v96
  v_rcp_f32 v97, v97
  v_rcp_f32 v98, v98
  v_rcp_f32 v99, v99
  v_rcp_f32 v100, v100
  v_rcp_f32 v101, v101
  v_rcp_f32 v102, v102
  v_rcp_f32 v103, v103
  v_rcp_f32 v104, v104
  v_rcp_f32 v105, v105
  v_rcp_f32 v106, v106
  v_rcp_f32 v107, v107
  v_rcp_f32 v108, v108
  v_rcp_f32 v109, v109
  v_rcp_f32 v110, v110
  v_rcp_f32 v111, v111
  v_med3_f32 v96, v96, -v244, v244
  v_med3_f32 v97, v97, -v244, v244
  v_med3_f32 v98, v98, -v244, v244
  v_med3_f32 v99, v99, -v244, v244
  v_med3_f32 v100, v100, -v244, v244
  v_med3_f32 v101, v101, -v244, v244
  v_med3_f32 v102, v102, -v244, v244
  v_med3_f32 v103, v103, -v244, v244
  v_med3_f32 v104, v104, -v244, v244
  v_med3_f32 v105, v105, -v244, v244
  v_med3_f32 v106, v106, -v244, v244
  v_med3_f32 v107, v107, -v244, v244
  v_med3_f32 v108, v108, -v244, v244
  v_med3_f32 v109, v109, -v244, v244
  v_med3_f32 v110, v110, -v244, v244
  v_med3_f32 v111, v111, -v244, v244
  v_pk_add_f32 v[160:161], v[160:161], v[112:113]
  v_pk_add_f32 v[162:163], v[162:163], v[114:115]
  v_pk_add_f32 v[164:165], v[164:165], v[112:113]
  v_pk_add_f32 v[166:167], v[166:167], v[114:115]
  v_pk_add_f32 v[168:169], v[168:169], v[112:113]
  v_pk_add_f32 v[170:171], v[170:171], v[114:115]
  v_pk_add_f32 v[172:173], v[172:173], v[112:113]
  v_pk_add_f32 v[174:175], v[174:175], v[114:115]
  v_pk_add_f32 v[176:177], v[176:177], v[116:117]
  v_pk_add_f32 v[178:179], v[178:179], v[118:119]
  v_pk_add_f32 v[180:181], v[180:181], v[116:117]
  v_pk_add_f32 v[182:183], v[182:183], v[118:119]
  v_pk_add_f32 v[184:185], v[184:185], v[116:117]
  v_pk_add_f32 v[186:187], v[186:187], v[118:119]
  v_pk_add_f32 v[188:189], v[188:189], v[116:117]
  v_pk_add_f32 v[190:191], v[190:191], v[118:119]
  v_pk_add_f32 v[192:193], v[192:193], v[120:121]
  v_pk_add_f32 v[194:195], v[194:195], v[122:123]
  v_pk_add_f32 v[196:197], v[196:197], v[120:121]
  v_pk_add_f32 v[198:199], v[198:199], v[122:123]
  v_pk_add_f32 v[200:201], v[200:201], v[120:121]
  v_pk_add_f32 v[202:203], v[202:203], v[122:123]
  v_pk_add_f32 v[204:205], v[204:205], v[120:121]
  v_pk_add_f32 v[206:207], v[206:207], v[122:123]
  v_pk_add_f32 v[208:209], v[208:209], v[124:125]
  v_pk_add_f32 v[210:211], v[210:211], v[126:127]
  v_pk_add_f32 v[212:213], v[212:213], v[124:125]
  v_pk_add_f32 v[214:215], v[214:215], v[126:127]
  v_pk_add_f32 v[216:217], v[216:217], v[124:125]
  v_pk_add_f32 v[218:219], v[218:219], v[126:127]
  v_pk_add_f32 v[220:221], v[220:221], v[124:125]
  v_pk_add_f32 v[222:223], v[222:223], v[126:127]
  v_pk_mul_f32 v[64:65], v[160:161], v[160:161]
  v_pk_mul_f32 v[68:69], v[164:165], v[164:165]
  v_pk_mul_f32 v[72:73], v[168:169], v[168:169]
  v_pk_mul_f32 v[76:77], v[172:173], v[172:173]
  v_pk_fma_f32 v[64:65], v[64:65], v[242:243], v[240:241]
  v_pk_fma_f32 v[68:69], v[68:69], v[242:243], v[240:241]
  v_pk_fma_f32 v[72:73], v[72:73], v[242:243], v[240:241]
  v_pk_fma_f32 v[76:77], v[76:77], v[242:243], v[240:241]
  v_pk_mul_f32 v[64:65], v[64:65], v[160:161]
  v_pk_mul_f32 v[68:69], v[68:69], v[164:165]
  v_pk_mul_f32 v[72:73], v[72:73], v[168:169]
  v_pk_mul_f32 v[76:77], v[76:77], v[172:173]
  v_exp_f32 v64, v64
  v_exp_f32 v65, v65
  v_exp_f32 v68, v68
  v_exp_f32 v69, v69
  v_exp_f32 v72, v72
  v_exp_f32 v73, v73
  v_exp_f32 v76, v76
  v_exp_f32 v77, v77
  v_pk_fma_f32 v[64:65], v[64:65], v[96:97], v[96:97]
  v_pk_fma_f32 v[68:69], v[68:69], v[96:97], v[96:97]
  v_pk_fma_f32 v[72:73], v[72:73], v[96:97], v[96:97]
  v_pk_fma_f32 v[76:77], v[76:77], v[96:97], v[96:97]
  v_rcp_f32 v64, v64
  v_rcp_f32 v65, v65
  v_rcp_f32 v68, v68
  v_rcp_f32 v69, v69
  v_rcp_f32 v72, v72
  v_rcp_f32 v73, v73
  v_rcp_f32 v76, v76
  v_rcp_f32 v77, v77
  v_pk_mul_f32 v[16:17], v[64:65], v[160:161]
  v_pk_mul_f32 v[18:19], v[68:69], v[164:165]
  v_pk_mul_f32 v[20:21], v[72:73], v[168:169]
  v_pk_mul_f32 v[22:23], v[76:77], v[172:173]
  v_pk_mul_f32 v[80:81], v[162:163], v[162:163]
  v_pk_mul_f32 v[84:85], v[166:167], v[166:167]
  v_pk_mul_f32 v[88:89], v[170:171], v[170:171]
  v_pk_mul_f32 v[92:93], v[174:175], v[174:175]
  v_pk_fma_f32 v[80:81], v[80:81], v[242:243], v[240:241]
  v_pk_fma_f32 v[84:85], v[84:85], v[242:243], v[240:241]
  v_pk_fma_f32 v[88:89], v[88:89], v[242:243], v[240:241]
  v_pk_fma_f32 v[92:93], v[92:93], v[242:243], v[240:241]
  v_pk_mul_f32 v[80:81], v[80:81], v[162:163]
  v_pk_mul_f32 v[84:85], v[84:85], v[166:167]
  v_pk_mul_f32 v[88:89], v[88:89], v[170:171]
  v_pk_mul_f32 v[92:93], v[92:93], v[174:175]
  v_exp_f32 v80, v80
  v_exp_f32 v81, v81
  v_exp_f32 v84, v84
  v_exp_f32 v85, v85
  v_exp_f32 v88, v88
  v_exp_f32 v89, v89
  v_exp_f32 v92, v92
  v_exp_f32 v93, v93
  v_pk_fma_f32 v[80:81], v[80:81], v[98:99], v[98:99]
  v_pk_fma_f32 v[84:85], v[84:85], v[98:99], v[98:99]
  v_pk_fma_f32 v[88:89], v[88:89], v[98:99], v[98:99]
  v_pk_fma_f32 v[92:93], v[92:93], v[98:99], v[98:99]
  v_rcp_f32 v80, v80
  v_rcp_f32 v81, v81
  v_rcp_f32 v84, v84
  v_rcp_f32 v85, v85
  v_rcp_f32 v88, v88
  v_rcp_f32 v89, v89
  v_rcp_f32 v92, v92
  v_rcp_f32 v93, v93
  v_pk_fma_f32 v[16:17], v[80:81], v[162:163], v[16:17]
  v_pk_fma_f32 v[18:19], v[84:85], v[166:167], v[18:19]
  v_pk_fma_f32 v[20:21], v[88:89], v[170:171], v[20:21]
  v_pk_fma_f32 v[22:23], v[92:93], v[174:175], v[22:23]
  v_pk_mul_f32 v[64:65], v[176:177], v[176:177]
  v_pk_mul_f32 v[68:69], v[180:181], v[180:181]
  v_pk_mul_f32 v[72:73], v[184:185], v[184:185]
  v_pk_mul_f32 v[76:77], v[188:189], v[188:189]
  v_pk_fma_f32 v[64:65], v[64:65], v[242:243], v[240:241]
  v_pk_fma_f32 v[68:69], v[68:69], v[242:243], v[240:241]
  v_pk_fma_f32 v[72:73], v[72:73], v[242:243], v[240:241]
  v_pk_fma_f32 v[76:77], v[76:77], v[242:243], v[240:241]
  v_pk_mul_f32 v[64:65], v[64:65], v[176:177]
  v_pk_mul_f32 v[68:69], v[68:69], v[180:181]
  v_pk_mul_f32 v[72:73], v[72:73], v[184:185]
  v_pk_mul_f32 v[76:77], v[76:77], v[188:189]
  v_exp_f32 v64, v64
  v_exp_f32 v65, v65
  v_exp_f32 v68, v68
  v_exp_f32 v69, v69
  v_exp_f32 v72, v72
  v_exp_f32 v73, v73
  v_exp_f32 v76, v76
  v_exp_f32 v77, v77
  v_pk_fma_f32 v[64:65], v[64:65], v[100:101], v[100:101]
  v_pk_fma_f32 v[68:69], v[68:69], v[100:101], v[100:101]
  v_pk_fma_f32 v[72:73], v[72:73], v[100:101], v[100:101]
  v_pk_fma_f32 v[76:77], v[76:77], v[100:101], v[100:101]
  v_rcp_f32 v64, v64
  v_rcp_f32 v65, v65
  v_rcp_f32 v68, v68
  v_rcp_f32 v69, v69
  v_rcp_f32 v72, v72
  v_rcp_f32 v73, v73
  v_rcp_f32 v76, v76
  v_rcp_f32 v77, v77
  v_pk_fma_f32 v[16:17], v[64:65], v[176:177], v[16:17]
  v_pk_fma_f32 v[18:19], v[68:69], v[180:181], v[18:19]
  v_pk_fma_f32 v[20:21], v[72:73], v[184:185], v[20:21]
  v_pk_fma_f32 v[22:23], v[76:77], v[188:189], v[22:23]
  v_pk_mul_f32 v[80:81], v[178:179], v[178:179]
  v_pk_mul_f32 v[84:85], v[182:183], v[182:183]
  v_pk_mul_f32 v[88:89], v[186:187], v[186:187]
  v_pk_mul_f32 v[92:93], v[190:191], v[190:191]
  v_pk_fma_f32 v[80:81], v[80:81], v[242:243], v[240:241]
  v_pk_fma_f32 v[84:85], v[84:85], v[242:243], v[240:241]
  v_pk_fma_f32 v[88:89], v[88:89], v[242:243], v[240:241]
  v_pk_fma_f32 v[92:93], v[92:93], v[242:243], v[240:241]
  v_pk_mul_f32 v[80:81], v[80:81], v[178:179]
  v_pk_mul_f32 v[84:85], v[84:85], v[182:183]
  v_pk_mul_f32 v[88:89], v[88:89], v[186:187]
  v_pk_mul_f32 v[92:93], v[92:93], v[190:191]
  v_exp_f32 v80, v80
  v_exp_f32 v81, v81
  v_exp_f32 v84, v84
  v_exp_f32 v85, v85
  v_exp_f32 v88, v88
  v_exp_f32 v89, v89
  v_exp_f32 v92, v92
  v_exp_f32 v93, v93
  v_pk_fma_f32 v[80:81], v[80:81], v[102:103], v[102:103]
  v_pk_fma_f32 v[84:85], v[84:85], v[102:103], v[102:103]
  v_pk_fma_f32 v[88:89], v[88:89], v[102:103], v[102:103]
  v_pk_fma_f32 v[92:93], v[92:93], v[102:103], v[102:103]
  v_rcp_f32 v80, v80
  v_rcp_f32 v81, v81
  v_rcp_f32 v84, v84
  v_rcp_f32 v85, v85
  v_rcp_f32 v88, v88
  v_rcp_f32 v89, v89
  v_rcp_f32 v92, v92
  v_rcp_f32 v93, v93
  v_pk_fma_f32 v[16:17], v[80:81], v[178:179], v[16:17]
  v_pk_fma_f32 v[18:19], v[84:85], v[182:183], v[18:19]
  v_pk_fma_f32 v[20:21], v[88:89], v[186:187], v[20:21]
  v_pk_fma_f32 v[22:23], v[92:93], v[190:191], v[22:23]
  v_pk_mul_f32 v[64:65], v[192:193], v[192:193]
  v_pk_mul_f32 v[68:69], v[196:197], v[196:197]
  v_pk_mul_f32 v[72:73], v[200:201], v[200:201]
  v_pk_mul_f32 v[76:77], v[204:205], v[204:205]
  v_pk_fma_f32 v[64:65], v[64:65], v[242:243], v[240:241]
  v_pk_fma_f32 v[68:69], v[68:69], v[242:243], v[240:241]
  v_pk_fma_f32 v[72:73], v[72:73], v[242:243], v[240:241]
  v_pk_fma_f32 v[76:77], v[76:77], v[242:243], v[240:241]
  v_pk_mul_f32 v[64:65], v[64:65], v[192:193]
  v_pk_mul_f32 v[68:69], v[68:69], v[196:197]
  v_pk_mul_f32 v[72:73], v[72:73], v[200:201]
  v_pk_mul_f32 v[76:77], v[76:77], v[204:205]
  v_exp_f32 v64, v64
  v_exp_f32 v65, v65
  v_exp_f32 v68, v68
  v_exp_f32 v69, v69
  v_exp_f32 v72, v72
  v_exp_f32 v73, v73
  v_exp_f32 v76, v76
  v_exp_f32 v77, v77
  v_pk_fma_f32 v[64:65], v[64:65], v[104:105], v[104:105]
  v_pk_fma_f32 v[68:69], v[68:69], v[104:105], v[104:105]
  v_pk_fma_f32 v[72:73], v[72:73], v[104:105], v[104:105]
  v_pk_fma_f32 v[76:77], v[76:77], v[104:105], v[104:105]
  v_rcp_f32 v64, v64
  v_rcp_f32 v65, v65
  v_rcp_f32 v68, v68
  v_rcp_f32 v69, v69
  v_rcp_f32 v72, v72
  v_rcp_f32 v73, v73
  v_rcp_f32 v76, v76
  v_rcp_f32 v77, v77
  v_pk_fma_f32 v[16:17], v[64:65], v[192:193], v[16:17]
  v_pk_fma_f32 v[18:19], v[68:69], v[196:197], v[18:19]
  v_pk_fma_f32 v[20:21], v[72:73], v[200:201], v[20:21]
  v_pk_fma_f32 v[22:23], v[76:77], v[204:205], v[22:23]
  v_pk_mul_f32 v[80:81], v[194:195], v[194:195]
  v_pk_mul_f32 v[84:85], v[198:199], v[198:199]
  v_pk_mul_f32 v[88:89], v[202:203], v[202:203]
  v_pk_mul_f32 v[92:93], v[206:207], v[206:207]
  v_pk_fma_f32 v[80:81], v[80:81], v[242:243], v[240:241]
  v_pk_fma_f32 v[84:85], v[84:85], v[242:243], v[240:241]
  v_pk_fma_f32 v[88:89], v[88:89], v[242:243], v[240:241]
  v_pk_fma_f32 v[92:93], v[92:93], v[242:243], v[240:241]
  v_pk_mul_f32 v[80:81], v[80:81], v[194:195]
  v_pk_mul_f32 v[84:85], v[84:85], v[198:199]
  v_pk_mul_f32 v[88:89], v[88:89], v[202:203]
  v_pk_mul_f32 v[92:93], v[92:93], v[206:207]
  v_exp_f32 v80, v80
  v_exp_f32 v81, v81
  v_exp_f32 v84, v84
  v_exp_f32 v85, v85
  v_exp_f32 v88, v88
  v_exp_f32 v89, v89
  v_exp_f32 v92, v92
  v_exp_f32 v93, v93
  v_pk_fma_f32 v[80:81], v[80:81], v[106:107], v[106:107]
  v_pk_fma_f32 v[84:85], v[84:85], v[106:107], v[106:107]
  v_pk_fma_f32 v[88:89], v[88:89], v[106:107], v[106:107]
  v_pk_fma_f32 v[92:93], v[92:93], v[106:107], v[106:107]
  v_rcp_f32 v80, v80
  v_rcp_f32 v81, v81
  v_rcp_f32 v84, v84
  v_rcp_f32 v85, v85
  v_rcp_f32 v88, v88
  v_rcp_f32 v89, v89
  v_rcp_f32 v92, v92
  v_rcp_f32 v93, v93
  v_pk_fma_f32 v[16:17], v[80:81], v[194:195], v[16:17]
  v_pk_fma_f32 v[18:19], v[84:85], v[198:199], v[18:19]
  v_pk_fma_f32 v[20:21], v[88:89], v[202:203], v[20:21]
  v_pk_fma_f32 v[22:23], v[92:93], v[206:207], v[22:23]
  v_pk_mul_f32 v[64:65], v[208:209], v[208:209]
  v_pk_mul_f32 v[68:69], v[212:213], v[212:213]
  v_pk_mul_f32 v[72:73], v[216:217], v[216:217]
  v_pk_mul_f32 v[76:77], v[220:221], v[220:221]
  v_pk_fma_f32 v[64:65], v[64:65], v[242:243], v[240:241]
  v_pk_fma_f32 v[68:69], v[68:69], v[242:243], v[240:241]
  v_pk_fma_f32 v[72:73], v[72:73], v[242:243], v[240:241]
  v_pk_fma_f32 v[76:77], v[76:77], v[242:243], v[240:241]
  v_pk_mul_f32 v[64:65], v[64:65], v[208:209]
  v_pk_mul_f32 v[68:69], v[68:69], v[212:213]
  v_pk_mul_f32 v[72:73], v[72:73], v[216:217]
  v_pk_mul_f32 v[76:77], v[76:77], v[220:221]
  v_exp_f32 v64, v64
  v_exp_f32 v65, v65
  v_exp_f32 v68, v68
  v_exp_f32 v69, v69
  v_exp_f32 v72, v72
  v_exp_f32 v73, v73
  v_exp_f32 v76, v76
  v_exp_f32 v77, v77
  v_pk_fma_f32 v[64:65], v[64:65], v[108:109], v[108:109]
  v_pk_fma_f32 v[68:69], v[68:69], v[108:109], v[108:109]
  v_pk_fma_f32 v[72:73], v[72:73], v[108:109], v[108:109]
  v_pk_fma_f32 v[76:77], v[76:77], v[108:109], v[108:109]
  v_rcp_f32 v64, v64
  v_rcp_f32 v65, v65
  v_rcp_f32 v68, v68
  v_rcp_f32 v69, v69
  v_rcp_f32 v72, v72
  v_rcp_f32 v73, v73
  v_rcp_f32 v76, v76
  v_rcp_f32 v77, v77
  v_pk_fma_f32 v[16:17], v[64:65], v[208:209], v[16:17]
  v_pk_fma_f32 v[18:19], v[68:69], v[212:213], v[18:19]
  v_pk_fma_f32 v[20:21], v[72:73], v[216:217], v[20:21]
  v_pk_fma_f32 v[22:23], v[76:77], v[220:221], v[22:23]
  v_pk_mul_f32 v[80:81], v[210:211], v[210:211]
  v_pk_mul_f32 v[84:85], v[214:215], v[214:215]
  v_pk_mul_f32 v[88:89], v[218:219], v[218:219]
  v_pk_mul_f32 v[92:93], v[222:223], v[222:223]
  v_pk_fma_f32 v[80:81], v[80:81], v[242:243], v[240:241]
  v_pk_fma_f32 v[84:85], v[84:85], v[242:243], v[240:241]
  v_pk_fma_f32 v[88:89], v[88:89], v[242:243], v[240:241]
  v_pk_fma_f32 v[92:93], v[92:93], v[242:243], v[240:241]
  v_pk_mul_f32 v[80:81], v[80:81], v[210:211]
  v_pk_mul_f32 v[84:85], v[84:85], v[214:215]
  v_pk_mul_f32 v[88:89], v[88:89], v[218:219]
  v_pk_mul_f32 v[92:93], v[92:93], v[222:223]
  v_exp_f32 v80, v80
  v_exp_f32 v81, v81
  v_exp_f32 v84, v84
  v_exp_f32 v85, v85
  v_exp_f32 v88, v88
  v_exp_f32 v89, v89
  v_exp_f32 v92, v92
  v_exp_f32 v93, v93
  v_pk_fma_f32 v[80:81], v[80:81], v[110:111], v[110:111]
  v_pk_fma_f32 v[84:85], v[84:85], v[110:111], v[110:111]
  v_pk_fma_f32 v[88:89], v[88:89], v[110:111], v[110:111]
  v_pk_fma_f32 v[92:93], v[92:93], v[110:111], v[110:111]
  v_rcp_f32 v80, v80
  v_rcp_f32 v81, v81
  v_rcp_f32 v84, v84
  v_rcp_f32 v85, v85
  v_rcp_f32 v88, v88
  v_rcp_f32 v89, v89
  v_rcp_f32 v92, v92
  v_rcp_f32 v93, v93
  v_pk_fma_f32 v[16:17], v[80:81], v[210:211], v[16:17]
  v_pk_fma_f32 v[18:19], v[84:85], v[214:215], v[18:19]
  v_pk_fma_f32 v[20:21], v[88:89], v[218:219], v[20:21]
  v_pk_fma_f32 v[22:23], v[92:93], v[222:223], v[22:23]
  v_add_f32 v16, v16, v17
  v_add_f32 v18, v18, v19
  v_add_f32 v20, v20, v21
  v_add_f32 v22, v22, v23
  s_nop 0
  v_permlane32_swap_b32 v16, v20
  v_permlane32_swap_b32 v18, v22
  v_add_f32 v16, v16, v20
  v_add_f32 v18, v18, v22
  s_nop 1
  v_permlane16_swap_b32 v16, v18
  v_add_f32 v16, v16, v18
  v_add_f32 v16, s80, v16
  s_waitcnt vmcnt(1)
  v_cmp_eq_u32 vcc, 0, v5
  s_nop 0
  s_and_b32 vcc_lo, vcc_lo, 0xff
  s_cbranch_scc0 L_rclr_ok
  s_mov_b32 s78, 0x40000
L_rclr:
  s_sub_u32 s78, s78, 1
  s_cbranch_scc1 L_rclr_ok
  v_lshlrev_b32 v5, 2, v0
  v_and_b32 v5, 31, v5
  buffer_load_dword v5, v5, s[64:67], 0 offen offset:128 sc1
  s_waitcnt vmcnt(0)
  v_cmp_eq_u32 vcc, 0, v5
  s_nop 0
  s_and_b32 vcc_lo, vcc_lo, 0xff
  s_cbranch_scc1 L_rclr
L_rclr_ok:
  s_mov_b32 s72, 0x40000
L_poll:
  s_sub_u32 s72, s72, 1
  s_cbranch_scc1 L_pollx
  buffer_load_dword v64, v3, s[60:63], s68 offen offset:0 sc1
  buffer_load_dword v65, v3, s[60:63], s68 offen offset:2048 sc1
  buffer_load_dword v66, v3, s[60:63], s69 offen offset:0 sc1
  buffer_load_dword v67, v3, s[60:63], s69 offen offset:2048 sc1
  buffer_load_dword v68, v3, s[60:63], s71 offen offset:0 sc1
  buffer_load_dword v69, v3, s[60:63], s71 offen offset:2048 sc1
  s_waitcnt vmcnt(3)
  v_max3_u32 v72, v64, v65, v66
  s_waitcnt vmcnt(0)
  v_max3_u32 v73, v67, v68, v69
  v_max_u32 v72, v72, v73
  v_cmp_eq_u32 vcc, -1, v72
  s_cbranch_vccnz L_poll
L_pollx:
  v_add_f32 v64, v64, v65
  v_add_f32 v66, v66, v67
  v_add_f32 v68, v68, v69
  v_add_f32 v64, v64, v66
  v_add_f32 v68, v68, v16
  v_add_f32 v64, v64, v68
  v_cvt_pk_bf16_f32 v64, v64, v64
  buffer_store_short v64, v2, s[56:59], s70 offen
  s_endpgm
L_end:
  s_endpgm
.section .rodata,"a"
.p2align 6
.amdhsa_kernel standalone__deep_cross_xdeepfm__recsys_kernel
  .amdhsa_next_free_vgpr 256
  .amdhsa_next_free_sgpr 102
  .amdhsa_accum_offset 256
  .amdhsa_group_segment_fixed_size 0
  .amdhsa_kernarg_size 88
  .amdhsa_user_sgpr_count 2
  .amdhsa_user_sgpr_kernarg_segment_ptr 1
  .amdhsa_system_sgpr_workgroup_id_x 1
  .amdhsa_float_denorm_mode_32 3
.end_amdhsa_kernel
```

```asm
; @launch grid=(256,1,1) block=(512,1,1) lds=163840
.amdgcn_target "amdgcn-amd-amdhsa--gfx950"
.text
.globl standalone__deep_cross_xdeepfm__recsys_kernel
.p2align 8
.type standalone__deep_cross_xdeepfm__recsys_kernel,@function
standalone__deep_cross_xdeepfm__recsys_kernel:
  s_cmp_ge_u32 s2, 256
  s_cbranch_scc1 L_end
  s_load_dwordx16 s[4:19], s[0:1], 0
  s_load_dwordx4 s[20:23], s[0:1], 64
  s_load_dwordx2 s[24:25], s[0:1], 80
  v_lshrrev_b32 v1, 6, v0
  s_getpc_b64 s[92:93]
L_pc:
  s_and_b32 s68, s2, 0xf8
  v_add_u32 v2, s68, v1
  v_lshlrev_b32 v2, 7, v2
  v_and_b32 v3, 1, v0
  v_lshl_add_u32 v2, v3, 15, v2
  v_min_u32 v2, L_end-L_pc, v2
  v_mov_b32 v3, s93
  v_add_co_u32 v2, vcc, s92, v2
  s_nop 1
  v_addc_co_u32 v3, vcc, 0, v3, vcc
  global_load_dword v255, v[2:3], off
  v_and_b32 v0, 63, v0
  v_readfirstlane_b32 s3, v1
  s_and_b32 s68, s2, 7
  s_lshl_b32 s68, s68, 2
  s_lshr_b32 s26, s2, 6
  s_add_u32 s26, s26, s68
  s_bfe_u32 s27, s2, 0x30003
  s_and_b32 s80, s2, 0xf8
  s_add_u32 s80, s80, s3
  s_lshl_b32 s80, s80, 21
  s_cmp_ge_u32 s27, 5
  s_cbranch_scc1 L_cin
  s_mul_i32 s77, s27, 640
  s_mul_i32 s70, s3, 7
  v_min_u32 v132, 6, v0
  v_add_u32 v132, s70, v132
  v_min_u32 v132, 51, v132
  v_lshrrev_b32 v130, 1, v132
  v_mul_u32_u24 v130, 96, v130
  v_lshl_add_u32 v132, v132, 2, v130
  s_mul_i32 s78, s27, 26
  s_min_u32 s78, s78, 102
  s_lshl_b32 s71, s26, 7
  s_add_u32 s78, s78, s71
  s_mul_i32 s78, s78, 104
  s_and_b32 s70, s26, 3
  s_lshl_b32 s70, s70, 3
  s_add_u32 s70, s70, s3
  s_mul_i32 s70, s70, 3328
  s_add_u32 s81, s70, s77
  v_min_u32 v124, 15, v0
  v_lshrrev_b32 v130, 3, v124
  s_mov_b32 s70, 106496
  v_mul_u32_u24 v130, s70, v130
  v_and_b32 v124, 7, v124
  v_min_u32 v124, 4, v124
  v_lshl_add_u32 v124, v124, 7, v130
  s_xor_b32 s70, s3, 4
  s_lshl_b32 s70, s70, 4
  s_add_u32 s70, s70, s71
  v_lshrrev_b32 v128, 3, v0
  v_add_u32 v128, s70, v128
  v_mul_u32_u24 v13, 104, v128
  s_waitcnt lgkmcnt(0)
  s_mov_b32 s28, s4
  s_and_b32 s29, s5, 0xffff
  s_mov_b32 s30, 425984
  s_mov_b32 s31, 0x20000
  buffer_load_dwordx3 v[120:122], v132, s[28:31], s78 offen
  buffer_load_dwordx2 v[112:113], v13, s[28:31], 0 offen offset:0
  buffer_load_dwordx2 v[116:117], v13, s[28:31], 0 offen offset:832
  s_mov_b32 s32, s6
  s_and_b32 s33, s7, 0xffff
  s_mov_b32 s34, 12800000
  s_mov_b32 s35, 0x20000
  v_mov_b32 v136, s80
  buffer_load_dword v255, v136, s[32:35], 0 offen
  v_lshlrev_b32 v37, 4, v0
  s_mov_b32 s48, s14
  s_and_b32 s49, s15, 0xffff
  s_mov_b32 s50, 3328
  s_mov_b32 s51, 0x20000
  s_mov_b32 s44, s12
  s_and_b32 s45, s13, 0xffff
  s_mov_b32 s46, 5537792
  s_mov_b32 s47, 0x20000
  buffer_load_dword v255, v124, s[44:47], s81 offen
  s_mov_b32 m0, 155648
  s_mov_b32 exec_hi, 0xff
  buffer_load_dwordx4 v37, s[48:51], s77 offen lds
  s_mov_b64 exec, -1
  s_lshr_b32 s68, s3, 2
  s_and_b32 s69, s3, 3
  s_mov_b32 s70, 1639
  s_and_b32 s78, s69, 1
  s_lshl_b32 s78, s78, 2
  s_mov_b32 s81, 3328
  v_mov_b32 v128, v0
  v_mul_u32_u24 v129, s70, v128
  v_lshrrev_b32 v129, 16, v129
  v_mul_u32_u24 v132, 40, v129
  v_sub_u32 v132, v128, v132
  v_and_b32 v131, 2, v129
  v_or_b32 v131, s78, v131
  v_xor_b32 v132, v132, v131
  v_mul_u32_u24 v129, s81, v129
  v_lshl_add_u32 v29, v132, 4, v129
  v_add_u32 v128, 64, v128
  v_mul_u32_u24 v129, s70, v128
  v_lshrrev_b32 v129, 16, v129
  v_mul_u32_u24 v132, 40, v129
  v_sub_u32 v132, v128, v132
  v_and_b32 v131, 2, v129
  v_or_b32 v131, s78, v131
  v_xor_b32 v132, v132, v131
  v_mul_u32_u24 v129, s81, v129
  v_lshl_add_u32 v30, v132, 4, v129
  v_subrev_u32 v30, 1024, v30
  v_add_u32 v128, 64, v128
  v_mul_u32_u24 v129, s70, v128
  v_lshrrev_b32 v129, 16, v129
  v_mul_u32_u24 v132, 40, v129
  v_sub_u32 v132, v128, v132
  v_and_b32 v131, 2, v129
  v_or_b32 v131, s78, v131
  v_xor_b32 v132, v132, v131
  v_mul_u32_u24 v129, s81, v129
  v_lshl_add_u32 v31, v132, 4, v129
  v_subrev_u32 v31, 2048, v31
  v_add_u32 v128, 64, v128
  v_mul_u32_u24 v129, s70, v128
  v_lshrrev_b32 v129, 16, v129
  v_mul_u32_u24 v132, 40, v129
  v_sub_u32 v132, v128, v132
  v_and_b32 v131, 2, v129
  v_or_b32 v131, s78, v131
  v_xor_b32 v132, v132, v131
  v_mul_u32_u24 v129, s81, v129
  v_lshl_add_u32 v32, v132, 4, v129
  v_subrev_u32 v32, 3072, v32
  v_add_u32 v128, 64, v128
  v_mul_u32_u24 v129, s70, v128
  v_lshrrev_b32 v129, 16, v129
  v_mul_u32_u24 v132, 40, v129
  v_sub_u32 v132, v128, v132
  v_and_b32 v131, 2, v129
  v_or_b32 v131, s78, v131
  v_xor_b32 v132, v132, v131
  v_mul_u32_u24 v129, s81, v129
  v_lshl_add_u32 v33, v132, 4, v129
  s_mul_i32 s70, s3, 26624
  s_add_u32 s74, s70, s77
  s_mul_i32 s75, s3, 5120
  s_add_u32 s75, s75, 32768
  s_lshl_b32 s71, s68, 14
  s_lshl_b32 s76, s69, 11
  s_add_u32 s76, s76, s71
  s_xor_b32 s76, s76, 16384
  v_and_b32 v132, 7, v0
  v_lshrrev_b32 v130, 4, v0
  v_xor_b32 v132, v132, v130
  v_lshlrev_b32 v14, 4, v132
  v_xor_b32 v15, 64, v14
  v_and_b32 v132, 15, v0
  v_lshlrev_b32 v132, 7, v132
  v_bfe_u32 v131, v0, 1, 3
  v_xor_b32 v131, v131, v130
  v_lshl_add_u32 v132, v131, 4, v132
  v_add_u32 v11, s71, v132
  v_xor_b32 v12, 64, v11
  s_mov_b32 s52, s16
  s_and_b32 s53, s17, 0xffff
  s_mov_b32 s54, 3328
  s_mov_b32 s55, 0x20000
  s_mul_i32 s71, s69, 5
  v_bfe_u32 v131, v0, 2, 2
  v_lshl_add_u32 v132, v130, 3, v131
  v_mul_u32_u24 v132, 640, v132
  v_and_b32 v131, 3, v0
  v_lshl_add_u32 v132, v131, 3, v132
  v_add_u32 v132, 32768, v132
  v_bfe_u32 v131, v0, 3, 2
  v_xor_b32 v128, s71, v131
  v_lshl_add_u32 v1, v128, 5, v132
  v_add_u32 v6, 61440, v1
  s_add_u32 s71, s71, 1
  v_xor_b32 v128, s71, v131
  v_lshl_add_u32 v2, v128, 5, v132
  v_add_u32 v7, 61440, v2
  s_add_u32 s71, s71, 1
  v_xor_b32 v128, s71, v131
  v_lshl_add_u32 v3, v128, 5, v132
  v_add_u32 v8, 61440, v3
  s_add_u32 s71, s71, 1
  v_xor_b32 v128, s71, v131
  v_lshl_add_u32 v4, v128, 5, v132
  v_add_u32 v9, 61440, v4
  s_add_u32 s71, s71, 1
  v_xor_b32 v128, s71, v131
  v_lshl_add_u32 v5, v128, 5, v132
  v_add_u32 v10, 61440, v5
  s_add_u32 s71, s71, 1
  s_mul_i32 s71, s69, 160
  s_add_u32 s71, s71, 155648
  v_lshlrev_b32 v132, 3, v130
  v_add_u32 v35, s71, v132
  s_lshl_b32 s70, s69, 1
  s_add_u32 s70, s70, s68
  s_lshl_b32 s70, s70, 8
  s_add_u32 s70, s70, 156928
  v_lshlrev_b32 v36, 2, v0
  v_add_u32 v36, s70, v36
  s_add_u32 m0, s75, 0
  s_nop 0
  buffer_load_dwordx4 v29, s[44:47], s74 offen offset:0 lds
  buffer_load_dwordx4 v30, s[44:47], s74 offen offset:1024 lds
  buffer_load_dwordx4 v31, s[44:47], s74 offen offset:2048 lds
  buffer_load_dwordx4 v32, s[44:47], s74 offen offset:3072 lds
  s_add_u32 m0, m0, 4096
  s_nop 0
  buffer_load_dwordx4 v33, s[44:47], s74 offen offset:0 lds
  s_add_u32 s74, s74, 212992
  s_waitcnt vmcnt(10)
  v_lshlrev_b32 v120, 7, v120
  s_barrier
  buffer_load_dword v255, v120, s[32:35], 0 offen
  s_waitcnt vmcnt(9)
  v_lshl_add_u32 v34, v116, 7, v15
  v_lshl_add_u32 v28, v112, 7, v14
  s_add_u32 m0, s76, 0
  s_nop 0
  buffer_load_dwordx4 v28, s[32:35], 0 offen lds
  s_add_u32 m0, m0, 1024
  s_nop 0
  buffer_load_dwordx4 v34, s[32:35], 0 offen lds
  v_lshlrev_b32 v122, 7, v122
  buffer_load_dword v255, v122, s[32:35], 0 offen
  s_barrier
  s_waitcnt vmcnt(9)
  ds_read_b64 v[220:221], v35 offset:0
  ds_read_b64 v[222:223], v35 offset:32
  ds_read_b64 v[224:225], v35 offset:64
  ds_read_b64 v[226:227], v35 offset:96
  ds_read_b64 v[228:229], v35 offset:128
  s_waitcnt lgkmcnt(4)
  v_lshlrev_b32 v140, 16, v220
  v_and_b32 v141, 0xffff0000, v220
  v_lshlrev_b32 v142, 16, v221
  v_and_b32 v143, 0xffff0000, v221
  s_waitcnt lgkmcnt(3)
  v_lshlrev_b32 v156, 16, v222
  v_and_b32 v157, 0xffff0000, v222
  v_lshlrev_b32 v158, 16, v223
  v_and_b32 v159, 0xffff0000, v223
  s_waitcnt lgkmcnt(2)
  v_lshlrev_b32 v172, 16, v224
  v_and_b32 v173, 0xffff0000, v224
  v_lshlrev_b32 v174, 16, v225
  v_and_b32 v175, 0xffff0000, v225
  s_waitcnt lgkmcnt(1)
  v_lshlrev_b32 v188, 16, v226
  v_and_b32 v189, 0xffff0000, v226
  v_lshlrev_b32 v190, 16, v227
  v_and_b32 v191, 0xffff0000, v227
  s_waitcnt lgkmcnt(0)
  v_lshlrev_b32 v204, 16, v228
  v_and_b32 v205, 0xffff0000, v228
  v_lshlrev_b32 v206, 16, v229
  v_and_b32 v207, 0xffff0000, v229
  v_mov_b64 v[144:145], v[140:141]
  v_mov_b64 v[146:147], v[142:143]
  v_mov_b64 v[148:149], v[140:141]
  v_mov_b64 v[150:151], v[142:143]
  v_mov_b64 v[152:153], v[140:141]
  v_mov_b64 v[154:155], v[142:143]
  v_mov_b64 v[160:161], v[156:157]
  v_mov_b64 v[162:163], v[158:159]
  v_mov_b64 v[164:165], v[156:157]
  v_mov_b64 v[166:167], v[158:159]
  v_mov_b64 v[168:169], v[156:157]
  v_mov_b64 v[170:171], v[158:159]
  v_mov_b64 v[176:177], v[172:173]
  v_mov_b64 v[178:179], v[174:175]
  v_mov_b64 v[180:181], v[172:173]
  v_mov_b64 v[182:183], v[174:175]
  v_mov_b64 v[184:185], v[172:173]
  v_mov_b64 v[186:187], v[174:175]
  v_mov_b64 v[192:193], v[188:189]
  v_mov_b64 v[194:195], v[190:191]
  v_mov_b64 v[196:197], v[188:189]
  v_mov_b64 v[198:199], v[190:191]
  v_mov_b64 v[200:201], v[188:189]
  v_mov_b64 v[202:203], v[190:191]
  v_mov_b64 v[208:209], v[204:205]
  v_mov_b64 v[210:211], v[206:207]
  v_mov_b64 v[212:213], v[204:205]
  v_mov_b64 v[214:215], v[206:207]
  v_mov_b64 v[216:217], v[204:205]
  v_mov_b64 v[218:219], v[206:207]
  s_lshl_b32 s73, s68, 2
  s_add_u32 s73, s73, 4
  buffer_load_dwordx3 v[16:18], v13, s[28:31], s73 offen offset:0
  buffer_load_dwordx3 v[20:22], v13, s[28:31], s73 offen offset:832
  s_add_u32 s73, s73, 12
  s_mov_b32 s72, 0
  s_cmp_lg_u32 s68, 0
  s_cbranch_scc1 L_dnn_h1
L_dnn_h0:
  s_add_u32 m0, s75, 40960
  s_nop 0
  buffer_load_dwordx4 v29, s[44:47], s74 offen offset:0 lds
  buffer_load_dwordx4 v30, s[44:47], s74 offen offset:1024 lds
  buffer_load_dwordx4 v31, s[44:47], s74 offen offset:2048 lds
  buffer_load_dwordx4 v32, s[44:47], s74 offen offset:3072 lds
  s_add_u32 m0, m0, 4096
  s_nop 0
  buffer_load_dwordx4 v33, s[44:47], s74 offen offset:0 lds
  s_add_u32 s74, s74, 212992
  s_waitcnt vmcnt(11) lgkmcnt(0)
  s_barrier
  buffer_load_dwordx3 v[24:26], v13, s[28:31], s73 offen offset:0
  buffer_load_dwordx3 v[240:242], v13, s[28:31], s73 offen offset:832
  s_add_u32 s73, s73, 12
L_dnn_loop0:
  ds_read_b64_tr_b16 v[40:41], v1 offset:0
  s_add_u32 m0, s75, 81920
  s_nop 0
  buffer_load_dwordx4 v29, s[44:47], s74 offen offset:0 lds
  ds_read_b64_tr_b16 v[42:43], v1 offset:2560
  ds_read_b64_tr_b16 v[44:45], v1 offset:20480
  ds_read_b64_tr_b16 v[46:47], v1 offset:23040
  ds_read_b64_tr_b16 v[48:49], v2 offset:0
  buffer_load_dwordx4 v30, s[44:47], s74 offen offset:1024 lds
  ds_read_b64_tr_b16 v[50:51], v2 offset:2560
  ds_read_b64_tr_b16 v[52:53], v2 offset:20480
  ds_read_b64_tr_b16 v[54:55], v2 offset:23040
  ds_read_b64_tr_b16 v[56:57], v3 offset:0
  buffer_load_dwordx4 v31, s[44:47], s74 offen offset:2048 lds
  ds_read_b64_tr_b16 v[58:59], v3 offset:2560
  ds_read_b64_tr_b16 v[60:61], v3 offset:20480
  ds_read_b64_tr_b16 v[62:63], v3 offset:23040
  ds_read_b64_tr_b16 v[64:65], v4 offset:0
  buffer_load_dwordx4 v32, s[44:47], s74 offen offset:3072 lds
  ds_read_b64_tr_b16 v[66:67], v4 offset:2560
  ds_read_b64_tr_b16 v[68:69], v4 offset:20480
  ds_read_b64_tr_b16 v[70:71], v4 offset:23040
  ds_read_b128 v[80:83], v11 offset:0
  s_add_u32 m0, m0, 4096
  s_nop 0
  buffer_load_dwordx4 v33, s[44:47], s74 offen offset:0 lds
  s_add_u32 s74, s74, 212992
  ds_read_b128 v[84:87], v12 offset:0
  ds_read_b128 v[88:91], v11 offset:2048
  ds_read_b128 v[92:95], v12 offset:2048
  ds_read_b128 v[96:99], v11 offset:4096
  s_waitcnt vmcnt(12)
  v_lshl_add_u32 v34, v20, 7, v15
  v_lshl_add_u32 v28, v16, 7, v14
  s_add_u32 m0, s76, 8192
  s_nop 0
  buffer_load_dwordx4 v28, s[32:35], 0 offen lds
  ds_read_b128 v[100:103], v12 offset:4096
  ds_read_b128 v[104:107], v11 offset:6144
  ds_read_b128 v[108:111], v12 offset:6144
  ds_read_b64_tr_b16 v[72:73], v5 offset:0
  s_add_u32 m0, m0, 1024
  s_nop 0
  buffer_load_dwordx4 v34, s[32:35], 0 offen lds
  ds_read_b64_tr_b16 v[74:75], v5 offset:2560
  ds_read_b64_tr_b16 v[76:77], v5 offset:20480
  ds_read_b64_tr_b16 v[78:79], v5 offset:23040
  s_waitcnt vmcnt(9) lgkmcnt(0)
  s_barrier
  s_setprio 0
  v_mfma_f32_16x16x32_bf16 v[140:143], v[40:43], v[80:83], v[140:143]
  v_mfma_f32_16x16x32_bf16 v[140:143], v[44:47], v[84:87], v[140:143]
  v_mfma_f32_16x16x32_bf16 v[144:147], v[40:43], v[88:91], v[144:147]
  v_mfma_f32_16x16x32_bf16 v[144:147], v[44:47], v[92:95], v[144:147]
  v_mfma_f32_16x16x32_bf16 v[148:151], v[40:43], v[96:99], v[148:151]
  v_mfma_f32_16x16x32_bf16 v[148:151], v[44:47], v[100:103], v[148:151]
  v_mfma_f32_16x16x32_bf16 v[152:155], v[40:43], v[104:107], v[152:155]
  v_mfma_f32_16x16x32_bf16 v[152:155], v[44:47], v[108:111], v[152:155]
  v_mfma_f32_16x16x32_bf16 v[168:171], v[48:51], v[104:107], v[168:171]
  v_mfma_f32_16x16x32_bf16 v[168:171], v[52:55], v[108:111], v[168:171]
  v_mfma_f32_16x16x32_bf16 v[164:167], v[48:51], v[96:99], v[164:167]
  v_mfma_f32_16x16x32_bf16 v[164:167], v[52:55], v[100:103], v[164:167]
  v_mfma_f32_16x16x32_bf16 v[160:163], v[48:51], v[88:91], v[160:163]
  v_mfma_f32_16x16x32_bf16 v[160:163], v[52:55], v[92:95], v[160:163]
  v_mfma_f32_16x16x32_bf16 v[156:159], v[48:51], v[80:83], v[156:159]
  v_mfma_f32_16x16x32_bf16 v[156:159], v[52:55], v[84:87], v[156:159]
  v_mfma_f32_16x16x32_bf16 v[172:175], v[56:59], v[80:83], v[172:175]
  v_mfma_f32_16x16x32_bf16 v[172:175], v[60:63], v[84:87], v[172:175]
  v_mfma_f32_16x16x32_bf16 v[176:179], v[56:59], v[88:91], v[176:179]
  v_mfma_f32_16x16x32_bf16 v[176:179], v[60:63], v[92:95], v[176:179]
  v_mfma_f32_16x16x32_bf16 v[180:183], v[56:59], v[96:99], v[180:183]
  v_mfma_f32_16x16x32_bf16 v[180:183], v[60:63], v[100:103], v[180:183]
  v_mfma_f32_16x16x32_bf16 v[184:187], v[56:59], v[104:107], v[184:187]
  v_mfma_f32_16x16x32_bf16 v[184:187], v[60:63], v[108:111], v[184:187]
  v_mfma_f32_16x16x32_bf16 v[200:203], v[64:67], v[104:107], v[200:203]
  v_mfma_f32_16x16x32_bf16 v[200:203], v[68:71], v[108:111], v[200:203]
  v_mfma_f32_16x16x32_bf16 v[196:199], v[64:67], v[96:99], v[196:199]
  v_mfma_f32_16x16x32_bf16 v[196:199], v[68:71], v[100:103], v[196:199]
  v_mfma_f32_16x16x32_bf16 v[192:195], v[64:67], v[88:91], v[192:195]
  v_mfma_f32_16x16x32_bf16 v[192:195], v[68:71], v[92:95], v[192:195]
  v_mfma_f32_16x16x32_bf16 v[188:191], v[64:67], v[80:83], v[188:191]
  v_mfma_f32_16x16x32_bf16 v[188:191], v[68:71], v[84:87], v[188:191]
  v_mfma_f32_16x16x32_bf16 v[204:207], v[72:75], v[80:83], v[204:207]
  v_mfma_f32_16x16x32_bf16 v[204:207], v[76:79], v[84:87], v[204:207]
  v_mfma_f32_16x16x32_bf16 v[208:211], v[72:75], v[88:91], v[208:211]
  v_mfma_f32_16x16x32_bf16 v[208:211], v[76:79], v[92:95], v[208:211]
  v_mfma_f32_16x16x32_bf16 v[212:215], v[72:75], v[96:99], v[212:215]
  v_mfma_f32_16x16x32_bf16 v[212:215], v[76:79], v[100:103], v[212:215]
  v_mfma_f32_16x16x32_bf16 v[216:219], v[72:75], v[104:107], v[216:219]
  s_setprio 2
  s_waitcnt vmcnt(9)
  s_barrier
  v_mfma_f32_16x16x32_bf16 v[216:219], v[76:79], v[108:111], v[216:219]
  ds_read_b64_tr_b16 v[40:41], v1 offset:40960
  s_add_u32 m0, s75, 0
  s_nop 0
  buffer_load_dwordx4 v29, s[44:47], s74 offen offset:0 lds
  ds_read_b64_tr_b16 v[42:43], v1 offset:43520
  ds_read_b64_tr_b16 v[44:45], v6 offset:0
  ds_read_b64_tr_b16 v[46:47], v6 offset:2560
  ds_read_b64_tr_b16 v[48:49], v2 offset:40960
  buffer_load_dwordx4 v30, s[44:47], s74 offen offset:1024 lds
  ds_read_b64_tr_b16 v[50:51], v2 offset:43520
  ds_read_b64_tr_b16 v[52:53], v7 offset:0
  ds_read_b64_tr_b16 v[54:55], v7 offset:2560
  ds_read_b64_tr_b16 v[56:57], v3 offset:40960
  buffer_load_dwordx4 v31, s[44:47], s74 offen offset:2048 lds
  ds_read_b64_tr_b16 v[58:59], v3 offset:43520
  ds_read_b64_tr_b16 v[60:61], v8 offset:0
  ds_read_b64_tr_b16 v[62:63], v8 offset:2560
  ds_read_b64_tr_b16 v[64:65], v4 offset:40960
  buffer_load_dwordx4 v32, s[44:47], s74 offen offset:3072 lds
  ds_read_b64_tr_b16 v[66:67], v4 offset:43520
  ds_read_b64_tr_b16 v[68:69], v9 offset:0
  ds_read_b64_tr_b16 v[70:71], v9 offset:2560
  ds_read_b128 v[80:83], v11 offset:8192
  s_add_u32 m0, m0, 4096
  s_nop 0
  buffer_load_dwordx4 v33, s[44:47], s74 offen offset:0 lds
  s_add_u32 s74, s74, 212992
  ds_read_b128 v[84:87], v12 offset:8192
  ds_read_b128 v[88:91], v11 offset:10240
  ds_read_b128 v[92:95], v12 offset:10240
  ds_read_b128 v[96:99], v11 offset:12288
  v_lshl_add_u32 v34, v21, 7, v15
  v_lshl_add_u32 v28, v17, 7, v14
  s_add_u32 m0, s76, 0
  s_nop 0
  buffer_load_dwordx4 v28, s[32:35], 0 offen lds
  ds_read_b128 v[100:103], v12 offset:12288
  ds_read_b128 v[104:107], v11 offset:14336
  ds_read_b128 v[108:111], v12 offset:14336
  ds_read_b64_tr_b16 v[72:73], v5 offset:40960
  s_add_u32 m0, m0, 1024
  s_nop 0
  buffer_load_dwordx4 v34, s[32:35], 0 offen lds
  ds_read_b64_tr_b16 v[74:75], v5 offset:43520
  ds_read_b64_tr_b16 v[76:77], v10 offset:0
  ds_read_b64_tr_b16 v[78:79], v10 offset:2560
  s_waitcnt vmcnt(7) lgkmcnt(0)
  s_barrier
  s_setprio 0
  v_mfma_f32_16x16x32_bf16 v[140:143], v[40:43], v[80:83], v[140:143]
  v_mfma_f32_16x16x32_bf16 v[140:143], v[44:47], v[84:87], v[140:143]
  v_mfma_f32_16x16x32_bf16 v[144:147], v[40:43], v[88:91], v[144:147]
  v_mfma_f32_16x16x32_bf16 v[144:147], v[44:47], v[92:95], v[144:147]
  v_mfma_f32_16x16x32_bf16 v[148:151], v[40:43], v[96:99], v[148:151]
  v_mfma_f32_16x16x32_bf16 v[148:151], v[44:47], v[100:103], v[148:151]
  v_mfma_f32_16x16x32_bf16 v[152:155], v[40:43], v[104:107], v[152:155]
  v_mfma_f32_16x16x32_bf16 v[152:155], v[44:47], v[108:111], v[152:155]
  v_mfma_f32_16x16x32_bf16 v[168:171], v[48:51], v[104:107], v[168:171]
  v_mfma_f32_16x16x32_bf16 v[168:171], v[52:55], v[108:111], v[168:171]
  v_mfma_f32_16x16x32_bf16 v[164:167], v[48:51], v[96:99], v[164:167]
  v_mfma_f32_16x16x32_bf16 v[164:167], v[52:55], v[100:103], v[164:167]
  v_mfma_f32_16x16x32_bf16 v[160:163], v[48:51], v[88:91], v[160:163]
  v_mfma_f32_16x16x32_bf16 v[160:163], v[52:55], v[92:95], v[160:163]
  v_mfma_f32_16x16x32_bf16 v[156:159], v[48:51], v[80:83], v[156:159]
  v_mfma_f32_16x16x32_bf16 v[156:159], v[52:55], v[84:87], v[156:159]
  v_mfma_f32_16x16x32_bf16 v[172:175], v[56:59], v[80:83], v[172:175]
  v_mfma_f32_16x16x32_bf16 v[172:175], v[60:63], v[84:87], v[172:175]
  v_mfma_f32_16x16x32_bf16 v[176:179], v[56:59], v[88:91], v[176:179]
  v_mfma_f32_16x16x32_bf16 v[176:179], v[60:63], v[92:95], v[176:179]
  v_mfma_f32_16x16x32_bf16 v[180:183], v[56:59], v[96:99], v[180:183]
  v_mfma_f32_16x16x32_bf16 v[180:183], v[60:63], v[100:103], v[180:183]
  v_mfma_f32_16x16x32_bf16 v[184:187], v[56:59], v[104:107], v[184:187]
  v_mfma_f32_16x16x32_bf16 v[184:187], v[60:63], v[108:111], v[184:187]
  v_mfma_f32_16x16x32_bf16 v[200:203], v[64:67], v[104:107], v[200:203]
  v_mfma_f32_16x16x32_bf16 v[200:203], v[68:71], v[108:111], v[200:203]
  v_mfma_f32_16x16x32_bf16 v[196:199], v[64:67], v[96:99], v[196:199]
  v_mfma_f32_16x16x32_bf16 v[196:199], v[68:71], v[100:103], v[196:199]
  v_mfma_f32_16x16x32_bf16 v[192:195], v[64:67], v[88:91], v[192:195]
  v_mfma_f32_16x16x32_bf16 v[192:195], v[68:71], v[92:95], v[192:195]
  v_mfma_f32_16x16x32_bf16 v[188:191], v[64:67], v[80:83], v[188:191]
  v_mfma_f32_16x16x32_bf16 v[188:191], v[68:71], v[84:87], v[188:191]
  v_mfma_f32_16x16x32_bf16 v[204:207], v[72:75], v[80:83], v[204:207]
  v_mfma_f32_16x16x32_bf16 v[204:207], v[76:79], v[84:87], v[204:207]
  v_mfma_f32_16x16x32_bf16 v[208:211], v[72:75], v[88:91], v[208:211]
  v_mfma_f32_16x16x32_bf16 v[208:211], v[76:79], v[92:95], v[208:211]
  v_mfma_f32_16x16x32_bf16 v[212:215], v[72:75], v[96:99], v[212:215]
  v_mfma_f32_16x16x32_bf16 v[212:215], v[76:79], v[100:103], v[212:215]
  v_mfma_f32_16x16x32_bf16 v[216:219], v[72:75], v[104:107], v[216:219]
  s_setprio 2
  s_barrier
  v_mfma_f32_16x16x32_bf16 v[216:219], v[76:79], v[108:111], v[216:219]
  ds_read_b64_tr_b16 v[40:41], v6 offset:20480
  s_add_u32 m0, s75, 40960
  s_nop 0
  buffer_load_dwordx4 v29, s[44:47], s74 offen offset:0 lds
  ds_read_b64_tr_b16 v[42:43], v6 offset:23040
  ds_read_b64_tr_b16 v[44:45], v6 offset:40960
  ds_read_b64_tr_b16 v[46:47], v6 offset:43520
  ds_read_b64_tr_b16 v[48:49], v7 offset:20480
  buffer_load_dwordx4 v30, s[44:47], s74 offen offset:1024 lds
  ds_read_b64_tr_b16 v[50:51], v7 offset:23040
  ds_read_b64_tr_b16 v[52:53], v7 offset:40960
  ds_read_b64_tr_b16 v[54:55], v7 offset:43520
  ds_read_b64_tr_b16 v[56:57], v8 offset:20480
  buffer_load_dwordx4 v31, s[44:47], s74 offen offset:2048 lds
  ds_read_b64_tr_b16 v[58:59], v8 offset:23040
  ds_read_b64_tr_b16 v[60:61], v8 offset:40960
  ds_read_b64_tr_b16 v[62:63], v8 offset:43520
  ds_read_b64_tr_b16 v[64:65], v9 offset:20480
  buffer_load_dwordx4 v32, s[44:47], s74 offen offset:3072 lds
  ds_read_b64_tr_b16 v[66:67], v9 offset:23040
  ds_read_b64_tr_b16 v[68:69], v9 offset:40960
  ds_read_b64_tr_b16 v[70:71], v9 offset:43520
  ds_read_b128 v[80:83], v11 offset:0
  s_add_u32 m0, m0, 4096
  s_nop 0
  buffer_load_dwordx4 v33, s[44:47], s74 offen offset:0 lds
  s_add_u32 s74, s74, 212992
  ds_read_b128 v[84:87], v12 offset:0
  ds_read_b128 v[88:91], v11 offset:2048
  ds_read_b128 v[92:95], v12 offset:2048
  ds_read_b128 v[96:99], v11 offset:4096
  v_lshl_add_u32 v34, v22, 7, v15
  v_lshl_add_u32 v28, v18, 7, v14
  s_add_u32 m0, s76, 8192
  s_nop 0
  buffer_load_dwordx4 v28, s[32:35], 0 offen lds
  ds_read_b128 v[100:103], v12 offset:4096
  ds_read_b128 v[104:107], v11 offset:6144
  ds_read_b128 v[108:111], v12 offset:6144
  ds_read_b64_tr_b16 v[72:73], v10 offset:20480
  s_add_u32 m0, m0, 1024
  s_nop 0
  buffer_load_dwordx4 v34, s[32:35], 0 offen lds
  ds_read_b64_tr_b16 v[74:75], v10 offset:23040
  ds_read_b64_tr_b16 v[76:77], v10 offset:40960
  ds_read_b64_tr_b16 v[78:79], v10 offset:43520
  buffer_load_dwordx3 v[16:18], v13, s[28:31], s73 offen offset:0
  buffer_load_dwordx3 v[20:22], v13, s[28:31], s73 offen offset:832
  s_add_u32 s73, s73, 12
  s_waitcnt vmcnt(9) lgkmcnt(0)
  s_barrier
  s_setprio 0
  v_mfma_f32_16x16x32_bf16 v[140:143], v[40:43], v[80:83], v[140:143]
  v_mfma_f32_16x16x32_bf16 v[140:143], v[44:47], v[84:87], v[140:143]
  v_mfma_f32_16x16x32_bf16 v[144:147], v[40:43], v[88:91], v[144:147]
  v_mfma_f32_16x16x32_bf16 v[144:147], v[44:47], v[92:95], v[144:147]
  v_mfma_f32_16x16x32_bf16 v[148:151], v[40:43], v[96:99], v[148:151]
  v_mfma_f32_16x16x32_bf16 v[148:151], v[44:47], v[100:103], v[148:151]
  v_mfma_f32_16x16x32_bf16 v[152:155], v[40:43], v[104:107], v[152:155]
  v_mfma_f32_16x16x32_bf16 v[152:155], v[44:47], v[108:111], v[152:155]
  v_mfma_f32_16x16x32_bf16 v[168:171], v[48:51], v[104:107], v[168:171]
  v_mfma_f32_16x16x32_bf16 v[168:171], v[52:55], v[108:111], v[168:171]
  v_mfma_f32_16x16x32_bf16 v[164:167], v[48:51], v[96:99], v[164:167]
  v_mfma_f32_16x16x32_bf16 v[164:167], v[52:55], v[100:103], v[164:167]
  v_mfma_f32_16x16x32_bf16 v[160:163], v[48:51], v[88:91], v[160:163]
  v_mfma_f32_16x16x32_bf16 v[160:163], v[52:55], v[92:95], v[160:163]
  v_mfma_f32_16x16x32_bf16 v[156:159], v[48:51], v[80:83], v[156:159]
  v_mfma_f32_16x16x32_bf16 v[156:159], v[52:55], v[84:87], v[156:159]
  v_mfma_f32_16x16x32_bf16 v[172:175], v[56:59], v[80:83], v[172:175]
  v_mfma_f32_16x16x32_bf16 v[172:175], v[60:63], v[84:87], v[172:175]
  v_mfma_f32_16x16x32_bf16 v[176:179], v[56:59], v[88:91], v[176:179]
  v_mfma_f32_16x16x32_bf16 v[176:179], v[60:63], v[92:95], v[176:179]
  v_mfma_f32_16x16x32_bf16 v[180:183], v[56:59], v[96:99], v[180:183]
  v_mfma_f32_16x16x32_bf16 v[180:183], v[60:63], v[100:103], v[180:183]
  v_mfma_f32_16x16x32_bf16 v[184:187], v[56:59], v[104:107], v[184:187]
  v_mfma_f32_16x16x32_bf16 v[184:187], v[60:63], v[108:111], v[184:187]
  v_mfma_f32_16x16x32_bf16 v[200:203], v[64:67], v[104:107], v[200:203]
  v_mfma_f32_16x16x32_bf16 v[200:203], v[68:71], v[108:111], v[200:203]
  v_mfma_f32_16x16x32_bf16 v[196:199], v[64:67], v[96:99], v[196:199]
  v_mfma_f32_16x16x32_bf16 v[196:199], v[68:71], v[100:103], v[196:199]
  v_mfma_f32_16x16x32_bf16 v[192:195], v[64:67], v[88:91], v[192:195]
  v_mfma_f32_16x16x32_bf16 v[192:195], v[68:71], v[92:95], v[192:195]
  v_mfma_f32_16x16x32_bf16 v[188:191], v[64:67], v[80:83], v[188:191]
  v_mfma_f32_16x16x32_bf16 v[188:191], v[68:71], v[84:87], v[188:191]
  v_mfma_f32_16x16x32_bf16 v[204:207], v[72:75], v[80:83], v[204:207]
  v_mfma_f32_16x16x32_bf16 v[204:207], v[76:79], v[84:87], v[204:207]
  v_mfma_f32_16x16x32_bf16 v[208:211], v[72:75], v[88:91], v[208:211]
  v_mfma_f32_16x16x32_bf16 v[208:211], v[76:79], v[92:95], v[208:211]
  v_mfma_f32_16x16x32_bf16 v[212:215], v[72:75], v[96:99], v[212:215]
  v_mfma_f32_16x16x32_bf16 v[212:215], v[76:79], v[100:103], v[212:215]
  v_mfma_f32_16x16x32_bf16 v[216:219], v[72:75], v[104:107], v[216:219]
  s_setprio 2
  s_barrier
  v_mfma_f32_16x16x32_bf16 v[216:219], v[76:79], v[108:111], v[216:219]
  ds_read_b64_tr_b16 v[40:41], v1 offset:0
  s_add_u32 m0, s75, 81920
  s_nop 0
  buffer_load_dwordx4 v29, s[44:47], s74 offen offset:0 lds
  ds_read_b64_tr_b16 v[42:43], v1 offset:2560
  ds_read_b64_tr_b16 v[44:45], v1 offset:20480
  ds_read_b64_tr_b16 v[46:47], v1 offset:23040
  ds_read_b64_tr_b16 v[48:49], v2 offset:0
  buffer_load_dwordx4 v30, s[44:47], s74 offen offset:1024 lds
  ds_read_b64_tr_b16 v[50:51], v2 offset:2560
  ds_read_b64_tr_b16 v[52:53], v2 offset:20480
  ds_read_b64_tr_b16 v[54:55], v2 offset:23040
  ds_read_b64_tr_b16 v[56:57], v3 offset:0
  buffer_load_dwordx4 v31, s[44:47], s74 offen offset:2048 lds
  ds_read_b64_tr_b16 v[58:59], v3 offset:2560
  ds_read_b64_tr_b16 v[60:61], v3 offset:20480
  ds_read_b64_tr_b16 v[62:63], v3 offset:23040
  ds_read_b64_tr_b16 v[64:65], v4 offset:0
  buffer_load_dwordx4 v32, s[44:47], s74 offen offset:3072 lds
  ds_read_b64_tr_b16 v[66:67], v4 offset:2560
  ds_read_b64_tr_b16 v[68:69], v4 offset:20480
  ds_read_b64_tr_b16 v[70:71], v4 offset:23040
  ds_read_b128 v[80:83], v11 offset:8192
  s_add_u32 m0, m0, 4096
  s_nop 0
  buffer_load_dwordx4 v33, s[44:47], s74 offen offset:0 lds
  s_add_u32 s74, s74, 212992
  ds_read_b128 v[84:87], v12 offset:8192
  ds_read_b128 v[88:91], v11 offset:10240
  ds_read_b128 v[92:95], v12 offset:10240
  ds_read_b128 v[96:99], v11 offset:12288
  v_lshl_add_u32 v34, v240, 7, v15
  v_lshl_add_u32 v28, v24, 7, v14
  s_add_u32 m0, s76, 0
  s_nop 0
  buffer_load_dwordx4 v28, s[32:35], 0 offen lds
  ds_read_b128 v[100:103], v12 offset:12288
  ds_read_b128 v[104:107], v11 offset:14336
  ds_read_b128 v[108:111], v12 offset:14336
  ds_read_b64_tr_b16 v[72:73], v5 offset:0
  s_add_u32 m0, m0, 1024
  s_nop 0
  buffer_load_dwordx4 v34, s[32:35], 0 offen lds
  ds_read_b64_tr_b16 v[74:75], v5 offset:2560
  ds_read_b64_tr_b16 v[76:77], v5 offset:20480
  ds_read_b64_tr_b16 v[78:79], v5 offset:23040
  s_waitcnt vmcnt(9) lgkmcnt(0)
  s_barrier
  s_setprio 0
  v_mfma_f32_16x16x32_bf16 v[140:143], v[40:43], v[80:83], v[140:143]
  v_mfma_f32_16x16x32_bf16 v[140:143], v[44:47], v[84:87], v[140:143]
  v_mfma_f32_16x16x32_bf16 v[144:147], v[40:43], v[88:91], v[144:147]
  v_mfma_f32_16x16x32_bf16 v[144:147], v[44:47], v[92:95], v[144:147]
  v_mfma_f32_16x16x32_bf16 v[148:151], v[40:43], v[96:99], v[148:151]
  v_mfma_f32_16x16x32_bf16 v[148:151], v[44:47], v[100:103], v[148:151]
  v_mfma_f32_16x16x32_bf16 v[152:155], v[40:43], v[104:107], v[152:155]
  v_mfma_f32_16x16x32_bf16 v[152:155], v[44:47], v[108:111], v[152:155]
  v_mfma_f32_16x16x32_bf16 v[168:171], v[48:51], v[104:107], v[168:171]
  v_mfma_f32_16x16x32_bf16 v[168:171], v[52:55], v[108:111], v[168:171]
  v_mfma_f32_16x16x32_bf16 v[164:167], v[48:51], v[96:99], v[164:167]
  v_mfma_f32_16x16x32_bf16 v[164:167], v[52:55], v[100:103], v[164:167]
  v_mfma_f32_16x16x32_bf16 v[160:163], v[48:51], v[88:91], v[160:163]
  v_mfma_f32_16x16x32_bf16 v[160:163], v[52:55], v[92:95], v[160:163]
  v_mfma_f32_16x16x32_bf16 v[156:159], v[48:51], v[80:83], v[156:159]
  v_mfma_f32_16x16x32_bf16 v[156:159], v[52:55], v[84:87], v[156:159]
  v_mfma_f32_16x16x32_bf16 v[172:175], v[56:59], v[80:83], v[172:175]
  v_mfma_f32_16x16x32_bf16 v[172:175], v[60:63], v[84:87], v[172:175]
  v_mfma_f32_16x16x32_bf16 v[176:179], v[56:59], v[88:91], v[176:179]
  v_mfma_f32_16x16x32_bf16 v[176:179], v[60:63], v[92:95], v[176:179]
  v_mfma_f32_16x16x32_bf16 v[180:183], v[56:59], v[96:99], v[180:183]
  v_mfma_f32_16x16x32_bf16 v[180:183], v[60:63], v[100:103], v[180:183]
  v_mfma_f32_16x16x32_bf16 v[184:187], v[56:59], v[104:107], v[184:187]
  v_mfma_f32_16x16x32_bf16 v[184:187], v[60:63], v[108:111], v[184:187]
  v_mfma_f32_16x16x32_bf16 v[200:203], v[64:67], v[104:107], v[200:203]
  v_mfma_f32_16x16x32_bf16 v[200:203], v[68:71], v[108:111], v[200:203]
  v_mfma_f32_16x16x32_bf16 v[196:199], v[64:67], v[96:99], v[196:199]
  v_mfma_f32_16x16x32_bf16 v[196:199], v[68:71], v[100:103], v[196:199]
  v_mfma_f32_16x16x32_bf16 v[192:195], v[64:67], v[88:91], v[192:195]
  v_mfma_f32_16x16x32_bf16 v[192:195], v[68:71], v[92:95], v[192:195]
  v_mfma_f32_16x16x32_bf16 v[188:191], v[64:67], v[80:83], v[188:191]
  v_mfma_f32_16x16x32_bf16 v[188:191], v[68:71], v[84:87], v[188:191]
  v_mfma_f32_16x16x32_bf16 v[204:207], v[72:75], v[80:83], v[204:207]
  v_mfma_f32_16x16x32_bf16 v[204:207], v[76:79], v[84:87], v[204:207]
  v_mfma_f32_16x16x32_bf16 v[208:211], v[72:75], v[88:91], v[208:211]
  v_mfma_f32_16x16x32_bf16 v[208:211], v[76:79], v[92:95], v[208:211]
  v_mfma_f32_16x16x32_bf16 v[212:215], v[72:75], v[96:99], v[212:215]
  v_mfma_f32_16x16x32_bf16 v[212:215], v[76:79], v[100:103], v[212:215]
  v_mfma_f32_16x16x32_bf16 v[216:219], v[72:75], v[104:107], v[216:219]
  s_setprio 2
  s_barrier
  v_mfma_f32_16x16x32_bf16 v[216:219], v[76:79], v[108:111], v[216:219]
  ds_read_b64_tr_b16 v[40:41], v1 offset:40960
  s_add_u32 m0, s75, 0
  s_nop 0
  buffer_load_dwordx4 v29, s[44:47], s74 offen offset:0 lds
  ds_read_b64_tr_b16 v[42:43], v1 offset:43520
  ds_read_b64_tr_b16 v[44:45], v6 offset:0
  ds_read_b64_tr_b16 v[46:47], v6 offset:2560
  ds_read_b64_tr_b16 v[48:49], v2 offset:40960
  buffer_load_dwordx4 v30, s[44:47], s74 offen offset:1024 lds
  ds_read_b64_tr_b16 v[50:51], v2 offset:43520
  ds_read_b64_tr_b16 v[52:53], v7 offset:0
  ds_read_b64_tr_b16 v[54:55], v7 offset:2560
  ds_read_b64_tr_b16 v[56:57], v3 offset:40960
  buffer_load_dwordx4 v31, s[44:47], s74 offen offset:2048 lds
  ds_read_b64_tr_b16 v[58:59], v3 offset:43520
  ds_read_b64_tr_b16 v[60:61], v8 offset:0
  ds_read_b64_tr_b16 v[62:63], v8 offset:2560
  ds_read_b64_tr_b16 v[64:65], v4 offset:40960
  buffer_load_dwordx4 v32, s[44:47], s74 offen offset:3072 lds
  ds_read_b64_tr_b16 v[66:67], v4 offset:43520
  ds_read_b64_tr_b16 v[68:69], v9 offset:0
  ds_read_b64_tr_b16 v[70:71], v9 offset:2560
  ds_read_b128 v[80:83], v11 offset:0
  s_add_u32 m0, m0, 4096
  s_nop 0
  buffer_load_dwordx4 v33, s[44:47], s74 offen offset:0 lds
  s_add_u32 s74, s74, 212992
  ds_read_b128 v[84:87], v12 offset:0
  ds_read_b128 v[88:91], v11 offset:2048
  ds_read_b128 v[92:95], v12 offset:2048
  ds_read_b128 v[96:99], v11 offset:4096
  v_lshl_add_u32 v34, v241, 7, v15
  v_lshl_add_u32 v28, v25, 7, v14
  s_add_u32 m0, s76, 8192
  s_nop 0
  buffer_load_dwordx4 v28, s[32:35], 0 offen lds
  ds_read_b128 v[100:103], v12 offset:4096
  ds_read_b128 v[104:107], v11 offset:6144
  ds_read_b128 v[108:111], v12 offset:6144
  ds_read_b64_tr_b16 v[72:73], v5 offset:40960
  s_add_u32 m0, m0, 1024
  s_nop 0
  buffer_load_dwordx4 v34, s[32:35], 0 offen lds
  ds_read_b64_tr_b16 v[74:75], v5 offset:43520
  ds_read_b64_tr_b16 v[76:77], v10 offset:0
  ds_read_b64_tr_b16 v[78:79], v10 offset:2560
  s_waitcnt vmcnt(7) lgkmcnt(0)
  s_barrier
  s_setprio 0
  v_mfma_f32_16x16x32_bf16 v[140:143], v[40:43], v[80:83], v[140:143]
  v_mfma_f32_16x16x32_bf16 v[140:143], v[44:47], v[84:87], v[140:143]
  v_mfma_f32_16x16x32_bf16 v[144:147], v[40:43], v[88:91], v[144:147]
  v_mfma_f32_16x16x32_bf16 v[144:147], v[44:47], v[92:95], v[144:147]
  v_mfma_f32_16x16x32_bf16 v[148:151], v[40:43], v[96:99], v[148:151]
  v_mfma_f32_16x16x32_bf16 v[148:151], v[44:47], v[100:103], v[148:151]
  v_mfma_f32_16x16x32_bf16 v[152:155], v[40:43], v[104:107], v[152:155]
  v_mfma_f32_16x16x32_bf16 v[152:155], v[44:47], v[108:111], v[152:155]
  v_mfma_f32_16x16x32_bf16 v[168:171], v[48:51], v[104:107], v[168:171]
  v_mfma_f32_16x16x32_bf16 v[168:171], v[52:55], v[108:111], v[168:171]
  v_mfma_f32_16x16x32_bf16 v[164:167], v[48:51], v[96:99], v[164:167]
  v_mfma_f32_16x16x32_bf16 v[164:167], v[52:55], v[100:103], v[164:167]
  v_mfma_f32_16x16x32_bf16 v[160:163], v[48:51], v[88:91], v[160:163]
  v_mfma_f32_16x16x32_bf16 v[160:163], v[52:55], v[92:95], v[160:163]
  v_mfma_f32_16x16x32_bf16 v[156:159], v[48:51], v[80:83], v[156:159]
  v_mfma_f32_16x16x32_bf16 v[156:159], v[52:55], v[84:87], v[156:159]
  v_mfma_f32_16x16x32_bf16 v[172:175], v[56:59], v[80:83], v[172:175]
  v_mfma_f32_16x16x32_bf16 v[172:175], v[60:63], v[84:87], v[172:175]
  v_mfma_f32_16x16x32_bf16 v[176:179], v[56:59], v[88:91], v[176:179]
  v_mfma_f32_16x16x32_bf16 v[176:179], v[60:63], v[92:95], v[176:179]
  v_mfma_f32_16x16x32_bf16 v[180:183], v[56:59], v[96:99], v[180:183]
  v_mfma_f32_16x16x32_bf16 v[180:183], v[60:63], v[100:103], v[180:183]
  v_mfma_f32_16x16x32_bf16 v[184:187], v[56:59], v[104:107], v[184:187]
  v_mfma_f32_16x16x32_bf16 v[184:187], v[60:63], v[108:111], v[184:187]
  v_mfma_f32_16x16x32_bf16 v[200:203], v[64:67], v[104:107], v[200:203]
  v_mfma_f32_16x16x32_bf16 v[200:203], v[68:71], v[108:111], v[200:203]
  v_mfma_f32_16x16x32_bf16 v[196:199], v[64:67], v[96:99], v[196:199]
  v_mfma_f32_16x16x32_bf16 v[196:199], v[68:71], v[100:103], v[196:199]
  v_mfma_f32_16x16x32_bf16 v[192:195], v[64:67], v[88:91], v[192:195]
  v_mfma_f32_16x16x32_bf16 v[192:195], v[68:71], v[92:95], v[192:195]
  v_mfma_f32_16x16x32_bf16 v[188:191], v[64:67], v[80:83], v[188:191]
  v_mfma_f32_16x16x32_bf16 v[188:191], v[68:71], v[84:87], v[188:191]
  v_mfma_f32_16x16x32_bf16 v[204:207], v[72:75], v[80:83], v[204:207]
  v_mfma_f32_16x16x32_bf16 v[204:207], v[76:79], v[84:87], v[204:207]
  v_mfma_f32_16x16x32_bf16 v[208:211], v[72:75], v[88:91], v[208:211]
  v_mfma_f32_16x16x32_bf16 v[208:211], v[76:79], v[92:95], v[208:211]
  v_mfma_f32_16x16x32_bf16 v[212:215], v[72:75], v[96:99], v[212:215]
  v_mfma_f32_16x16x32_bf16 v[212:215], v[76:79], v[100:103], v[212:215]
  v_mfma_f32_16x16x32_bf16 v[216:219], v[72:75], v[104:107], v[216:219]
  s_setprio 2
  s_barrier
  v_mfma_f32_16x16x32_bf16 v[216:219], v[76:79], v[108:111], v[216:219]
  ds_read_b64_tr_b16 v[40:41], v6 offset:20480
  s_add_u32 m0, s75, 40960
  s_nop 0
  buffer_load_dwordx4 v29, s[44:47], s74 offen offset:0 lds
  ds_read_b64_tr_b16 v[42:43], v6 offset:23040
  ds_read_b64_tr_b16 v[44:45], v6 offset:40960
  ds_read_b64_tr_b16 v[46:47], v6 offset:43520
  ds_read_b64_tr_b16 v[48:49], v7 offset:20480
  buffer_load_dwordx4 v30, s[44:47], s74 offen offset:1024 lds
  ds_read_b64_tr_b16 v[50:51], v7 offset:23040
  ds_read_b64_tr_b16 v[52:53], v7 offset:40960
  ds_read_b64_tr_b16 v[54:55], v7 offset:43520
  ds_read_b64_tr_b16 v[56:57], v8 offset:20480
  buffer_load_dwordx4 v31, s[44:47], s74 offen offset:2048 lds
  ds_read_b64_tr_b16 v[58:59], v8 offset:23040
  ds_read_b64_tr_b16 v[60:61], v8 offset:40960
  ds_read_b64_tr_b16 v[62:63], v8 offset:43520
  ds_read_b64_tr_b16 v[64:65], v9 offset:20480
  buffer_load_dwordx4 v32, s[44:47], s74 offen offset:3072 lds
  ds_read_b64_tr_b16 v[66:67], v9 offset:23040
  ds_read_b64_tr_b16 v[68:69], v9 offset:40960
  ds_read_b64_tr_b16 v[70:71], v9 offset:43520
  ds_read_b128 v[80:83], v11 offset:8192
  s_add_u32 m0, m0, 4096
  s_nop 0
  buffer_load_dwordx4 v33, s[44:47], s74 offen offset:0 lds
  s_add_u32 s74, s74, 212992
  ds_read_b128 v[84:87], v12 offset:8192
  ds_read_b128 v[88:91], v11 offset:10240
  ds_read_b128 v[92:95], v12 offset:10240
  ds_read_b128 v[96:99], v11 offset:12288
  v_lshl_add_u32 v34, v242, 7, v15
  v_lshl_add_u32 v28, v26, 7, v14
  s_add_u32 m0, s76, 0
  s_nop 0
  buffer_load_dwordx4 v28, s[32:35], 0 offen lds
  ds_read_b128 v[100:103], v12 offset:12288
  ds_read_b128 v[104:107], v11 offset:14336
  ds_read_b128 v[108:111], v12 offset:14336
  ds_read_b64_tr_b16 v[72:73], v10 offset:20480
  s_add_u32 m0, m0, 1024
  s_nop 0
  buffer_load_dwordx4 v34, s[32:35], 0 offen lds
  ds_read_b64_tr_b16 v[74:75], v10 offset:23040
  ds_read_b64_tr_b16 v[76:77], v10 offset:40960
  ds_read_b64_tr_b16 v[78:79], v10 offset:43520
  buffer_load_dwordx3 v[24:26], v13, s[28:31], s73 offen offset:0
  buffer_load_dwordx3 v[240:242], v13, s[28:31], s73 offen offset:832
  s_add_u32 s73, s73, 12
  s_waitcnt vmcnt(9) lgkmcnt(0)
  s_barrier
  s_setprio 0
  v_mfma_f32_16x16x32_bf16 v[140:143], v[40:43], v[80:83], v[140:143]
  s_add_u32 s72, s72, 1
  v_mfma_f32_16x16x32_bf16 v[140:143], v[44:47], v[84:87], v[140:143]
  v_mfma_f32_16x16x32_bf16 v[144:147], v[40:43], v[88:91], v[144:147]
  v_mfma_f32_16x16x32_bf16 v[144:147], v[44:47], v[92:95], v[144:147]
  v_mfma_f32_16x16x32_bf16 v[148:151], v[40:43], v[96:99], v[148:151]
  v_mfma_f32_16x16x32_bf16 v[148:151], v[44:47], v[100:103], v[148:151]
  v_mfma_f32_16x16x32_bf16 v[152:155], v[40:43], v[104:107], v[152:155]
  v_mfma_f32_16x16x32_bf16 v[152:155], v[44:47], v[108:111], v[152:155]
  v_mfma_f32_16x16x32_bf16 v[168:171], v[48:51], v[104:107], v[168:171]
  v_mfma_f32_16x16x32_bf16 v[168:171], v[52:55], v[108:111], v[168:171]
  v_mfma_f32_16x16x32_bf16 v[164:167], v[48:51], v[96:99], v[164:167]
  v_mfma_f32_16x16x32_bf16 v[164:167], v[52:55], v[100:103], v[164:167]
  v_mfma_f32_16x16x32_bf16 v[160:163], v[48:51], v[88:91], v[160:163]
  v_mfma_f32_16x16x32_bf16 v[160:163], v[52:55], v[92:95], v[160:163]
  v_mfma_f32_16x16x32_bf16 v[156:159], v[48:51], v[80:83], v[156:159]
  v_mfma_f32_16x16x32_bf16 v[156:159], v[52:55], v[84:87], v[156:159]
  v_mfma_f32_16x16x32_bf16 v[172:175], v[56:59], v[80:83], v[172:175]
  v_mfma_f32_16x16x32_bf16 v[172:175], v[60:63], v[84:87], v[172:175]
  v_mfma_f32_16x16x32_bf16 v[176:179], v[56:59], v[88:91], v[176:179]
  v_mfma_f32_16x16x32_bf16 v[176:179], v[60:63], v[92:95], v[176:179]
  s_cmp_lt_u32 s72, 4
  v_mfma_f32_16x16x32_bf16 v[180:183], v[56:59], v[96:99], v[180:183]
  v_mfma_f32_16x16x32_bf16 v[180:183], v[60:63], v[100:103], v[180:183]
  v_mfma_f32_16x16x32_bf16 v[184:187], v[56:59], v[104:107], v[184:187]
  v_mfma_f32_16x16x32_bf16 v[184:187], v[60:63], v[108:111], v[184:187]
  v_mfma_f32_16x16x32_bf16 v[200:203], v[64:67], v[104:107], v[200:203]
  v_mfma_f32_16x16x32_bf16 v[200:203], v[68:71], v[108:111], v[200:203]
  v_mfma_f32_16x16x32_bf16 v[196:199], v[64:67], v[96:99], v[196:199]
  v_mfma_f32_16x16x32_bf16 v[196:199], v[68:71], v[100:103], v[196:199]
  v_mfma_f32_16x16x32_bf16 v[192:195], v[64:67], v[88:91], v[192:195]
  v_mfma_f32_16x16x32_bf16 v[192:195], v[68:71], v[92:95], v[192:195]
  v_mfma_f32_16x16x32_bf16 v[188:191], v[64:67], v[80:83], v[188:191]
  v_mfma_f32_16x16x32_bf16 v[188:191], v[68:71], v[84:87], v[188:191]
  v_mfma_f32_16x16x32_bf16 v[204:207], v[72:75], v[80:83], v[204:207]
  v_mfma_f32_16x16x32_bf16 v[204:207], v[76:79], v[84:87], v[204:207]
  v_mfma_f32_16x16x32_bf16 v[208:211], v[72:75], v[88:91], v[208:211]
  v_mfma_f32_16x16x32_bf16 v[208:211], v[76:79], v[92:95], v[208:211]
  v_mfma_f32_16x16x32_bf16 v[212:215], v[72:75], v[96:99], v[212:215]
  v_mfma_f32_16x16x32_bf16 v[212:215], v[76:79], v[100:103], v[212:215]
  v_mfma_f32_16x16x32_bf16 v[216:219], v[72:75], v[104:107], v[216:219]
  s_setprio 2
  s_barrier
  v_mfma_f32_16x16x32_bf16 v[216:219], v[76:79], v[108:111], v[216:219]
  s_cbranch_scc1 L_dnn_loop0
  ds_read_b64_tr_b16 v[40:41], v1 offset:0
  v_lshl_add_u32 v34, v20, 7, v15
  v_lshl_add_u32 v28, v16, 7, v14
  s_add_u32 m0, s76, 8192
  s_nop 0
  buffer_load_dwordx4 v28, s[32:35], 0 offen lds
  ds_read_b64_tr_b16 v[42:43], v1 offset:2560
  ds_read_b64_tr_b16 v[44:45], v1 offset:20480
  ds_read_b64_tr_b16 v[46:47], v1 offset:23040
  ds_read_b64_tr_b16 v[48:49], v2 offset:0
  ds_read_b64_tr_b16 v[50:51], v2 offset:2560
  ds_read_b64_tr_b16 v[52:53], v2 offset:20480
  ds_read_b64_tr_b16 v[54:55], v2 offset:23040
  ds_read_b64_tr_b16 v[56:57], v3 offset:0
  ds_read_b64_tr_b16 v[58:59], v3 offset:2560
  ds_read_b64_tr_b16 v[60:61], v3 offset:20480
  ds_read_b64_tr_b16 v[62:63], v3 offset:23040
  ds_read_b64_tr_b16 v[64:65], v4 offset:0
  ds_read_b64_tr_b16 v[66:67], v4 offset:2560
  ds_read_b64_tr_b16 v[68:69], v4 offset:20480
  ds_read_b64_tr_b16 v[70:71], v4 offset:23040
  ds_read_b128 v[80:83], v11 offset:0
  s_add_u32 m0, m0, 1024
  s_nop 0
  buffer_load_dwordx4 v34, s[32:35], 0 offen lds
  ds_read_b128 v[84:87], v12 offset:0
  ds_read_b128 v[88:91], v11 offset:2048
  ds_read_b128 v[92:95], v12 offset:2048
  ds_read_b128 v[96:99], v11 offset:4096
  ds_read_b128 v[100:103], v12 offset:4096
  ds_read_b128 v[104:107], v11 offset:6144
  ds_read_b128 v[108:111], v12 offset:6144
  ds_read_b64_tr_b16 v[72:73], v5 offset:0
  ds_read_b64_tr_b16 v[74:75], v5 offset:2560
  ds_read_b64_tr_b16 v[76:77], v5 offset:20480
  ds_read_b64_tr_b16 v[78:79], v5 offset:23040
  ds_read_b64 v[220:221], v35 offset:640
  ds_read_b64 v[222:223], v35 offset:672
  ds_read_b64 v[224:225], v35 offset:704
  ds_read_b64 v[226:227], v35 offset:736
  ds_read_b64 v[228:229], v35 offset:768
  s_mov_b32 s60, s24
  s_and_b32 s61, s25, 0xffff
  s_mov_b32 s62, 268435456
  s_mov_b32 s63, 0x20000
  s_mov_b32 s64, s22
  s_and_b32 s65, s23, 0xffff
  s_mov_b32 s66, 256
  s_mov_b32 s67, 0x20000
  v_lshlrev_b32 v28, 2, v0
  s_mov_b64 exec, 0xff
  s_mov_b32 s81, 0x80000
  buffer_load_dword v255, v28, s[60:63], s81 offen
  buffer_load_dword v37, v28, s[64:67], 0 offen offset:128 sc1
  s_mov_b64 exec, -1
  v_mov_b32 v28, 0
  s_waitcnt vmcnt(6) lgkmcnt(0)
  s_barrier
  s_setprio 0
  v_mfma_f32_16x16x32_bf16 v[140:143], v[40:43], v[80:83], v[140:143]
  v_mov_b32 v232, 0xc0135761
  v_mov_b32 v233, 0xc0135761
  v_mfma_f32_16x16x32_bf16 v[140:143], v[44:47], v[84:87], v[140:143]
  v_mov_b32 v234, 0xbdd2d3e8
  v_mfma_f32_16x16x32_bf16 v[144:147], v[40:43], v[88:91], v[144:147]
  v_mov_b32 v235, 0xbdd2d3e8
  v_mfma_f32_16x16x32_bf16 v[144:147], v[44:47], v[92:95], v[144:147]
  v_mov_b32 v236, 0x71800000
  v_mfma_f32_16x16x32_bf16 v[148:151], v[40:43], v[96:99], v[148:151]
  v_lshlrev_b32 v112, 16, v220
  v_mfma_f32_16x16x32_bf16 v[148:151], v[44:47], v[100:103], v[148:151]
  v_and_b32 v113, 0xffff0000, v220
  v_mfma_f32_16x16x32_bf16 v[152:155], v[40:43], v[104:107], v[152:155]
  v_lshlrev_b32 v114, 16, v221
  v_mfma_f32_16x16x32_bf16 v[152:155], v[44:47], v[108:111], v[152:155]
  v_and_b32 v115, 0xffff0000, v221
  v_mfma_f32_16x16x32_bf16 v[168:171], v[48:51], v[104:107], v[168:171]
  v_lshlrev_b32 v116, 16, v222
  v_mfma_f32_16x16x32_bf16 v[168:171], v[52:55], v[108:111], v[168:171]
  v_and_b32 v117, 0xffff0000, v222
  v_mfma_f32_16x16x32_bf16 v[164:167], v[48:51], v[96:99], v[164:167]
  v_lshlrev_b32 v118, 16, v223
  v_mfma_f32_16x16x32_bf16 v[164:167], v[52:55], v[100:103], v[164:167]
  v_and_b32 v119, 0xffff0000, v223
  v_mfma_f32_16x16x32_bf16 v[160:163], v[48:51], v[88:91], v[160:163]
  v_lshlrev_b32 v120, 16, v224
  v_mfma_f32_16x16x32_bf16 v[160:163], v[52:55], v[92:95], v[160:163]
  v_and_b32 v121, 0xffff0000, v224
  v_mfma_f32_16x16x32_bf16 v[156:159], v[48:51], v[80:83], v[156:159]
  v_lshlrev_b32 v122, 16, v225
  v_mfma_f32_16x16x32_bf16 v[156:159], v[52:55], v[84:87], v[156:159]
  v_and_b32 v123, 0xffff0000, v225
  v_mfma_f32_16x16x32_bf16 v[172:175], v[56:59], v[80:83], v[172:175]
  v_lshlrev_b32 v124, 16, v226
  v_mfma_f32_16x16x32_bf16 v[172:175], v[60:63], v[84:87], v[172:175]
  v_and_b32 v125, 0xffff0000, v226
  v_mfma_f32_16x16x32_bf16 v[176:179], v[56:59], v[88:91], v[176:179]
  v_lshlrev_b32 v126, 16, v227
  v_mfma_f32_16x16x32_bf16 v[176:179], v[60:63], v[92:95], v[176:179]
  v_and_b32 v127, 0xffff0000, v227
  v_mfma_f32_16x16x32_bf16 v[180:183], v[56:59], v[96:99], v[180:183]
  v_lshlrev_b32 v128, 16, v228
  v_mfma_f32_16x16x32_bf16 v[180:183], v[60:63], v[100:103], v[180:183]
  v_and_b32 v129, 0xffff0000, v228
  v_mfma_f32_16x16x32_bf16 v[184:187], v[56:59], v[104:107], v[184:187]
  v_lshlrev_b32 v130, 16, v229
  v_mfma_f32_16x16x32_bf16 v[184:187], v[60:63], v[108:111], v[184:187]
  v_and_b32 v131, 0xffff0000, v229
  v_mfma_f32_16x16x32_bf16 v[200:203], v[64:67], v[104:107], v[200:203]
  v_rcp_f32 v112, v112
  v_mfma_f32_16x16x32_bf16 v[200:203], v[68:71], v[108:111], v[200:203]
  v_rcp_f32 v113, v113
  v_mfma_f32_16x16x32_bf16 v[196:199], v[64:67], v[96:99], v[196:199]
  v_rcp_f32 v114, v114
  v_mfma_f32_16x16x32_bf16 v[196:199], v[68:71], v[100:103], v[196:199]
  v_rcp_f32 v115, v115
  v_mfma_f32_16x16x32_bf16 v[192:195], v[64:67], v[88:91], v[192:195]
  v_rcp_f32 v116, v116
  v_mfma_f32_16x16x32_bf16 v[192:195], v[68:71], v[92:95], v[192:195]
  v_rcp_f32 v117, v117
  v_mfma_f32_16x16x32_bf16 v[188:191], v[64:67], v[80:83], v[188:191]
  v_rcp_f32 v118, v118
  v_mfma_f32_16x16x32_bf16 v[188:191], v[68:71], v[84:87], v[188:191]
  v_rcp_f32 v119, v119
  v_mfma_f32_16x16x32_bf16 v[204:207], v[72:75], v[80:83], v[204:207]
  v_rcp_f32 v120, v120
  v_mfma_f32_16x16x32_bf16 v[204:207], v[76:79], v[84:87], v[204:207]
  v_rcp_f32 v121, v121
  v_mfma_f32_16x16x32_bf16 v[208:211], v[72:75], v[88:91], v[208:211]
  v_rcp_f32 v122, v122
  v_mfma_f32_16x16x32_bf16 v[208:211], v[76:79], v[92:95], v[208:211]
  v_rcp_f32 v123, v123
  v_mfma_f32_16x16x32_bf16 v[212:215], v[72:75], v[96:99], v[212:215]
  v_rcp_f32 v124, v124
  v_mfma_f32_16x16x32_bf16 v[212:215], v[76:79], v[100:103], v[212:215]
  v_rcp_f32 v125, v125
  v_mfma_f32_16x16x32_bf16 v[216:219], v[72:75], v[104:107], v[216:219]
  s_setprio 2
  s_barrier
  v_mfma_f32_16x16x32_bf16 v[216:219], v[76:79], v[108:111], v[216:219]
  ds_read_b64_tr_b16 v[40:41], v1 offset:40960
  ds_read_b64_tr_b16 v[42:43], v1 offset:43520
  ds_read_b64_tr_b16 v[44:45], v6 offset:0
  ds_read_b64_tr_b16 v[46:47], v6 offset:2560
  ds_read_b64_tr_b16 v[48:49], v2 offset:40960
  ds_read_b64_tr_b16 v[50:51], v2 offset:43520
  ds_read_b64_tr_b16 v[52:53], v7 offset:0
  ds_read_b64_tr_b16 v[54:55], v7 offset:2560
  ds_read_b64_tr_b16 v[56:57], v3 offset:40960
  ds_read_b64_tr_b16 v[58:59], v3 offset:43520
  ds_read_b64_tr_b16 v[60:61], v8 offset:0
  ds_read_b64_tr_b16 v[62:63], v8 offset:2560
  ds_read_b64_tr_b16 v[64:65], v4 offset:40960
  ds_read_b64_tr_b16 v[66:67], v4 offset:43520
  ds_read_b64_tr_b16 v[68:69], v9 offset:0
  ds_read_b64_tr_b16 v[70:71], v9 offset:2560
  ds_read_b128 v[80:83], v11 offset:8192
  ds_read_b128 v[84:87], v12 offset:8192
  ds_read_b128 v[88:91], v11 offset:10240
  ds_read_b128 v[92:95], v12 offset:10240
  ds_read_b128 v[96:99], v11 offset:12288
  ds_read_b128 v[100:103], v12 offset:12288
  ds_read_b128 v[104:107], v11 offset:14336
  ds_read_b128 v[108:111], v12 offset:14336
  ds_read_b64_tr_b16 v[72:73], v5 offset:40960
  ds_read_b64_tr_b16 v[74:75], v5 offset:43520
  ds_read_b64_tr_b16 v[76:77], v10 offset:0
  ds_read_b64_tr_b16 v[78:79], v10 offset:2560
  s_waitcnt vmcnt(2) lgkmcnt(0)
  s_barrier
  s_setprio 0
  v_mfma_f32_16x16x32_bf16 v[140:143], v[40:43], v[80:83], v[140:143]
  v_rcp_f32 v126, v126
  v_mfma_f32_16x16x32_bf16 v[140:143], v[44:47], v[84:87], v[140:143]
  v_rcp_f32 v127, v127
  v_mfma_f32_16x16x32_bf16 v[144:147], v[40:43], v[88:91], v[144:147]
  v_rcp_f32 v128, v128
  v_mfma_f32_16x16x32_bf16 v[144:147], v[44:47], v[92:95], v[144:147]
  v_mfma_f32_16x16x32_bf16 v[148:151], v[40:43], v[96:99], v[148:151]
  v_rcp_f32 v129, v129
  v_mfma_f32_16x16x32_bf16 v[148:151], v[44:47], v[100:103], v[148:151]
  v_rcp_f32 v130, v130
  v_mfma_f32_16x16x32_bf16 v[152:155], v[40:43], v[104:107], v[152:155]
  v_mfma_f32_16x16x32_bf16 v[152:155], v[44:47], v[108:111], v[152:155]
  v_rcp_f32 v131, v131
  v_mfma_f32_16x16x32_bf16 v[168:171], v[48:51], v[104:107], v[168:171]
  v_med3_f32 v112, v112, -v236, v236
  v_mfma_f32_16x16x32_bf16 v[168:171], v[52:55], v[108:111], v[168:171]
  v_mfma_f32_16x16x32_bf16 v[164:167], v[48:51], v[96:99], v[164:167]
  v_med3_f32 v113, v113, -v236, v236
  v_mfma_f32_16x16x32_bf16 v[164:167], v[52:55], v[100:103], v[164:167]
  v_med3_f32 v114, v114, -v236, v236
  v_mfma_f32_16x16x32_bf16 v[160:163], v[48:51], v[88:91], v[160:163]
  v_mfma_f32_16x16x32_bf16 v[160:163], v[52:55], v[92:95], v[160:163]
  v_med3_f32 v115, v115, -v236, v236
  v_mfma_f32_16x16x32_bf16 v[156:159], v[48:51], v[80:83], v[156:159]
  v_med3_f32 v116, v116, -v236, v236
  v_mfma_f32_16x16x32_bf16 v[156:159], v[52:55], v[84:87], v[156:159]
  v_mfma_f32_16x16x32_bf16 v[172:175], v[56:59], v[80:83], v[172:175]
  v_med3_f32 v117, v117, -v236, v236
  v_mfma_f32_16x16x32_bf16 v[172:175], v[60:63], v[84:87], v[172:175]
  v_med3_f32 v118, v118, -v236, v236
  v_mfma_f32_16x16x32_bf16 v[176:179], v[56:59], v[88:91], v[176:179]
  v_mfma_f32_16x16x32_bf16 v[176:179], v[60:63], v[92:95], v[176:179]
  v_med3_f32 v119, v119, -v236, v236
  v_mfma_f32_16x16x32_bf16 v[180:183], v[56:59], v[96:99], v[180:183]
  v_med3_f32 v120, v120, -v236, v236
  v_mfma_f32_16x16x32_bf16 v[180:183], v[60:63], v[100:103], v[180:183]
  v_med3_f32 v121, v121, -v236, v236
  v_mfma_f32_16x16x32_bf16 v[184:187], v[56:59], v[104:107], v[184:187]
  v_mfma_f32_16x16x32_bf16 v[184:187], v[60:63], v[108:111], v[184:187]
  v_med3_f32 v122, v122, -v236, v236
  v_mfma_f32_16x16x32_bf16 v[200:203], v[64:67], v[104:107], v[200:203]
  v_med3_f32 v123, v123, -v236, v236
  v_mfma_f32_16x16x32_bf16 v[200:203], v[68:71], v[108:111], v[200:203]
  v_mfma_f32_16x16x32_bf16 v[196:199], v[64:67], v[96:99], v[196:199]
  v_med3_f32 v124, v124, -v236, v236
  v_mfma_f32_16x16x32_bf16 v[196:199], v[68:71], v[100:103], v[196:199]
  v_med3_f32 v125, v125, -v236, v236
  v_mfma_f32_16x16x32_bf16 v[192:195], v[64:67], v[88:91], v[192:195]
  v_mfma_f32_16x16x32_bf16 v[192:195], v[68:71], v[92:95], v[192:195]
  v_med3_f32 v126, v126, -v236, v236
  v_mfma_f32_16x16x32_bf16 v[188:191], v[64:67], v[80:83], v[188:191]
  v_med3_f32 v127, v127, -v236, v236
  v_mfma_f32_16x16x32_bf16 v[188:191], v[68:71], v[84:87], v[188:191]
  v_mfma_f32_16x16x32_bf16 v[204:207], v[72:75], v[80:83], v[204:207]
  v_med3_f32 v128, v128, -v236, v236
  v_mfma_f32_16x16x32_bf16 v[204:207], v[76:79], v[84:87], v[204:207]
  v_med3_f32 v129, v129, -v236, v236
  v_mfma_f32_16x16x32_bf16 v[208:211], v[72:75], v[88:91], v[208:211]
  v_mfma_f32_16x16x32_bf16 v[208:211], v[76:79], v[92:95], v[208:211]
  v_med3_f32 v130, v130, -v236, v236
  v_mfma_f32_16x16x32_bf16 v[212:215], v[72:75], v[96:99], v[212:215]
  v_med3_f32 v131, v131, -v236, v236
  v_mfma_f32_16x16x32_bf16 v[212:215], v[76:79], v[100:103], v[212:215]
  v_mfma_f32_16x16x32_bf16 v[216:219], v[72:75], v[104:107], v[216:219]
  s_setprio 2
  s_barrier
  v_mfma_f32_16x16x32_bf16 v[216:219], v[76:79], v[108:111], v[216:219]
  s_setprio 0
  s_branch L_epi
L_dnn_h1:
  v_lshl_add_u32 v34, v117, 7, v15
  v_lshl_add_u32 v28, v113, 7, v14
  s_add_u32 m0, s76, 8192
  s_nop 0
  buffer_load_dwordx4 v28, s[32:35], 0 offen lds
  s_add_u32 m0, m0, 1024
  s_nop 0
  buffer_load_dwordx4 v34, s[32:35], 0 offen lds
  s_add_u32 m0, s75, 40960
  s_nop 0
  buffer_load_dwordx4 v29, s[44:47], s74 offen offset:0 lds
  buffer_load_dwordx4 v30, s[44:47], s74 offen offset:1024 lds
  buffer_load_dwordx4 v31, s[44:47], s74 offen offset:2048 lds
  buffer_load_dwordx4 v32, s[44:47], s74 offen offset:3072 lds
  s_add_u32 m0, m0, 4096
  s_nop 0
  buffer_load_dwordx4 v33, s[44:47], s74 offen offset:0 lds
  s_add_u32 s74, s74, 212992
  s_waitcnt vmcnt(13)
  s_waitcnt vmcnt(10) lgkmcnt(0)
  s_barrier
  buffer_load_dwordx3 v[24:26], v13, s[28:31], s73 offen offset:0
  buffer_load_dwordx3 v[240:242], v13, s[28:31], s73 offen offset:832
  s_add_u32 s73, s73, 12
  s_barrier
L_dnn_loop1:
  ds_read_b64_tr_b16 v[40:41], v1 offset:0
  s_add_u32 m0, s75, 81920
  s_nop 0
  buffer_load_dwordx4 v29, s[44:47], s74 offen offset:0 lds
  ds_read_b64_tr_b16 v[42:43], v1 offset:2560
  ds_read_b64_tr_b16 v[44:45], v1 offset:20480
  ds_read_b64_tr_b16 v[46:47], v1 offset:23040
  ds_read_b64_tr_b16 v[48:49], v2 offset:0
  buffer_load_dwordx4 v30, s[44:47], s74 offen offset:1024 lds
  ds_read_b64_tr_b16 v[50:51], v2 offset:2560
  ds_read_b64_tr_b16 v[52:53], v2 offset:20480
  ds_read_b64_tr_b16 v[54:55], v2 offset:23040
  ds_read_b64_tr_b16 v[56:57], v3 offset:0
  buffer_load_dwordx4 v31, s[44:47], s74 offen offset:2048 lds
  ds_read_b64_tr_b16 v[58:59], v3 offset:2560
  ds_read_b64_tr_b16 v[60:61], v3 offset:20480
  ds_read_b64_tr_b16 v[62:63], v3 offset:23040
  ds_read_b64_tr_b16 v[64:65], v4 offset:0
  buffer_load_dwordx4 v32, s[44:47], s74 offen offset:3072 lds
  ds_read_b64_tr_b16 v[66:67], v4 offset:2560
  ds_read_b64_tr_b16 v[68:69], v4 offset:20480
  ds_read_b64_tr_b16 v[70:71], v4 offset:23040
  ds_read_b128 v[80:83], v11 offset:0
  s_add_u32 m0, m0, 4096
  s_nop 0
  buffer_load_dwordx4 v33, s[44:47], s74 offen offset:0 lds
  s_add_u32 s74, s74, 212992
  ds_read_b128 v[84:87], v12 offset:0
  ds_read_b128 v[88:91], v11 offset:2048
  ds_read_b128 v[92:95], v12 offset:2048
  ds_read_b128 v[96:99], v11 offset:4096
  s_waitcnt vmcnt(14)
  v_lshl_add_u32 v34, v20, 7, v15
  v_lshl_add_u32 v28, v16, 7, v14
  s_add_u32 m0, s76, 0
  s_nop 0
  buffer_load_dwordx4 v28, s[32:35], 0 offen lds
  ds_read_b128 v[100:103], v12 offset:4096
  ds_read_b128 v[104:107], v11 offset:6144
  ds_read_b128 v[108:111], v12 offset:6144
  ds_read_b64_tr_b16 v[72:73], v5 offset:0
  s_add_u32 m0, m0, 1024
  s_nop 0
  buffer_load_dwordx4 v34, s[32:35], 0 offen lds
  ds_read_b64_tr_b16 v[74:75], v5 offset:2560
  ds_read_b64_tr_b16 v[76:77], v5 offset:20480
  ds_read_b64_tr_b16 v[78:79], v5 offset:23040
  s_waitcnt vmcnt(9) lgkmcnt(0)
  s_waitcnt vmcnt(9)
  s_barrier
  s_setprio 0
  v_mfma_f32_16x16x32_bf16 v[140:143], v[40:43], v[80:83], v[140:143]
  v_mfma_f32_16x16x32_bf16 v[140:143], v[44:47], v[84:87], v[140:143]
  v_mfma_f32_16x16x32_bf16 v[144:147], v[40:43], v[88:91], v[144:147]
  v_mfma_f32_16x16x32_bf16 v[144:147], v[44:47], v[92:95], v[144:147]
  v_mfma_f32_16x16x32_bf16 v[148:151], v[40:43], v[96:99], v[148:151]
  v_mfma_f32_16x16x32_bf16 v[148:151], v[44:47], v[100:103], v[148:151]
  v_mfma_f32_16x16x32_bf16 v[152:155], v[40:43], v[104:107], v[152:155]
  v_mfma_f32_16x16x32_bf16 v[152:155], v[44:47], v[108:111], v[152:155]
  v_mfma_f32_16x16x32_bf16 v[168:171], v[48:51], v[104:107], v[168:171]
  v_mfma_f32_16x16x32_bf16 v[168:171], v[52:55], v[108:111], v[168:171]
  v_mfma_f32_16x16x32_bf16 v[164:167], v[48:51], v[96:99], v[164:167]
  v_mfma_f32_16x16x32_bf16 v[164:167], v[52:55], v[100:103], v[164:167]
  v_mfma_f32_16x16x32_bf16 v[160:163], v[48:51], v[88:91], v[160:163]
  v_mfma_f32_16x16x32_bf16 v[160:163], v[52:55], v[92:95], v[160:163]
  v_mfma_f32_16x16x32_bf16 v[156:159], v[48:51], v[80:83], v[156:159]
  v_mfma_f32_16x16x32_bf16 v[156:159], v[52:55], v[84:87], v[156:159]
  v_mfma_f32_16x16x32_bf16 v[172:175], v[56:59], v[80:83], v[172:175]
  v_mfma_f32_16x16x32_bf16 v[172:175], v[60:63], v[84:87], v[172:175]
  v_mfma_f32_16x16x32_bf16 v[176:179], v[56:59], v[88:91], v[176:179]
  v_mfma_f32_16x16x32_bf16 v[176:179], v[60:63], v[92:95], v[176:179]
  v_mfma_f32_16x16x32_bf16 v[180:183], v[56:59], v[96:99], v[180:183]
  v_mfma_f32_16x16x32_bf16 v[180:183], v[60:63], v[100:103], v[180:183]
  v_mfma_f32_16x16x32_bf16 v[184:187], v[56:59], v[104:107], v[184:187]
  v_mfma_f32_16x16x32_bf16 v[184:187], v[60:63], v[108:111], v[184:187]
  v_mfma_f32_16x16x32_bf16 v[200:203], v[64:67], v[104:107], v[200:203]
  v_mfma_f32_16x16x32_bf16 v[200:203], v[68:71], v[108:111], v[200:203]
  v_mfma_f32_16x16x32_bf16 v[196:199], v[64:67], v[96:99], v[196:199]
  v_mfma_f32_16x16x32_bf16 v[196:199], v[68:71], v[100:103], v[196:199]
  v_mfma_f32_16x16x32_bf16 v[192:195], v[64:67], v[88:91], v[192:195]
  v_mfma_f32_16x16x32_bf16 v[192:195], v[68:71], v[92:95], v[192:195]
  v_mfma_f32_16x16x32_bf16 v[188:191], v[64:67], v[80:83], v[188:191]
  v_mfma_f32_16x16x32_bf16 v[188:191], v[68:71], v[84:87], v[188:191]
  v_mfma_f32_16x16x32_bf16 v[204:207], v[72:75], v[80:83], v[204:207]
  v_mfma_f32_16x16x32_bf16 v[204:207], v[76:79], v[84:87], v[204:207]
  v_mfma_f32_16x16x32_bf16 v[208:211], v[72:75], v[88:91], v[208:211]
  v_mfma_f32_16x16x32_bf16 v[208:211], v[76:79], v[92:95], v[208:211]
  v_mfma_f32_16x16x32_bf16 v[212:215], v[72:75], v[96:99], v[212:215]
  v_mfma_f32_16x16x32_bf16 v[212:215], v[76:79], v[100:103], v[212:215]
  v_mfma_f32_16x16x32_bf16 v[216:219], v[72:75], v[104:107], v[216:219]
  s_setprio 2
  s_barrier
  v_mfma_f32_16x16x32_bf16 v[216:219], v[76:79], v[108:111], v[216:219]
  ds_read_b64_tr_b16 v[40:41], v1 offset:40960
  s_add_u32 m0, s75, 0
  s_nop 0
  buffer_load_dwordx4 v29, s[44:47], s74 offen offset:0 lds
  ds_read_b64_tr_b16 v[42:43], v1 offset:43520
  ds_read_b64_tr_b16 v[44:45], v6 offset:0
  ds_read_b64_tr_b16 v[46:47], v6 offset:2560
  ds_read_b64_tr_b16 v[48:49], v2 offset:40960
  buffer_load_dwordx4 v30, s[44:47], s74 offen offset:1024 lds
  ds_read_b64_tr_b16 v[50:51], v2 offset:43520
  ds_read_b64_tr_b16 v[52:53], v7 offset:0
  ds_read_b64_tr_b16 v[54:55], v7 offset:2560
  ds_read_b64_tr_b16 v[56:57], v3 offset:40960
  buffer_load_dwordx4 v31, s[44:47], s74 offen offset:2048 lds
  ds_read_b64_tr_b16 v[58:59], v3 offset:43520
  ds_read_b64_tr_b16 v[60:61], v8 offset:0
  ds_read_b64_tr_b16 v[62:63], v8 offset:2560
  ds_read_b64_tr_b16 v[64:65], v4 offset:40960
  buffer_load_dwordx4 v32, s[44:47], s74 offen offset:3072 lds
  ds_read_b64_tr_b16 v[66:67], v4 offset:43520
  ds_read_b64_tr_b16 v[68:69], v9 offset:0
  ds_read_b64_tr_b16 v[70:71], v9 offset:2560
  ds_read_b128 v[80:83], v11 offset:8192
  s_add_u32 m0, m0, 4096
  s_nop 0
  buffer_load_dwordx4 v33, s[44:47], s74 offen offset:0 lds
  s_add_u32 s74, s74, 212992
  ds_read_b128 v[84:87], v12 offset:8192
  ds_read_b128 v[88:91], v11 offset:10240
  ds_read_b128 v[92:95], v12 offset:10240
  ds_read_b128 v[96:99], v11 offset:12288
  v_lshl_add_u32 v34, v21, 7, v15
  v_lshl_add_u32 v28, v17, 7, v14
  s_add_u32 m0, s76, 8192
  s_nop 0
  buffer_load_dwordx4 v28, s[32:35], 0 offen lds
  ds_read_b128 v[100:103], v12 offset:12288
  ds_read_b128 v[104:107], v11 offset:14336
  ds_read_b128 v[108:111], v12 offset:14336
  ds_read_b64_tr_b16 v[72:73], v5 offset:40960
  s_add_u32 m0, m0, 1024
  s_nop 0
  buffer_load_dwordx4 v34, s[32:35], 0 offen lds
  ds_read_b64_tr_b16 v[74:75], v5 offset:43520
  ds_read_b64_tr_b16 v[76:77], v10 offset:0
  ds_read_b64_tr_b16 v[78:79], v10 offset:2560
  s_waitcnt vmcnt(7) lgkmcnt(0)
  s_barrier
  s_setprio 0
  v_mfma_f32_16x16x32_bf16 v[140:143], v[40:43], v[80:83], v[140:143]
  v_mfma_f32_16x16x32_bf16 v[140:143], v[44:47], v[84:87], v[140:143]
  v_mfma_f32_16x16x32_bf16 v[144:147], v[40:43], v[88:91], v[144:147]
  v_mfma_f32_16x16x32_bf16 v[144:147], v[44:47], v[92:95], v[144:147]
  v_mfma_f32_16x16x32_bf16 v[148:151], v[40:43], v[96:99], v[148:151]
  v_mfma_f32_16x16x32_bf16 v[148:151], v[44:47], v[100:103], v[148:151]
  v_mfma_f32_16x16x32_bf16 v[152:155], v[40:43], v[104:107], v[152:155]
  v_mfma_f32_16x16x32_bf16 v[152:155], v[44:47], v[108:111], v[152:155]
  v_mfma_f32_16x16x32_bf16 v[168:171], v[48:51], v[104:107], v[168:171]
  v_mfma_f32_16x16x32_bf16 v[168:171], v[52:55], v[108:111], v[168:171]
  v_mfma_f32_16x16x32_bf16 v[164:167], v[48:51], v[96:99], v[164:167]
  v_mfma_f32_16x16x32_bf16 v[164:167], v[52:55], v[100:103], v[164:167]
  v_mfma_f32_16x16x32_bf16 v[160:163], v[48:51], v[88:91], v[160:163]
  v_mfma_f32_16x16x32_bf16 v[160:163], v[52:55], v[92:95], v[160:163]
  v_mfma_f32_16x16x32_bf16 v[156:159], v[48:51], v[80:83], v[156:159]
  v_mfma_f32_16x16x32_bf16 v[156:159], v[52:55], v[84:87], v[156:159]
  v_mfma_f32_16x16x32_bf16 v[172:175], v[56:59], v[80:83], v[172:175]
  v_mfma_f32_16x16x32_bf16 v[172:175], v[60:63], v[84:87], v[172:175]
  v_mfma_f32_16x16x32_bf16 v[176:179], v[56:59], v[88:91], v[176:179]
  v_mfma_f32_16x16x32_bf16 v[176:179], v[60:63], v[92:95], v[176:179]
  v_mfma_f32_16x16x32_bf16 v[180:183], v[56:59], v[96:99], v[180:183]
  v_mfma_f32_16x16x32_bf16 v[180:183], v[60:63], v[100:103], v[180:183]
  v_mfma_f32_16x16x32_bf16 v[184:187], v[56:59], v[104:107], v[184:187]
  v_mfma_f32_16x16x32_bf16 v[184:187], v[60:63], v[108:111], v[184:187]
  v_mfma_f32_16x16x32_bf16 v[200:203], v[64:67], v[104:107], v[200:203]
  v_mfma_f32_16x16x32_bf16 v[200:203], v[68:71], v[108:111], v[200:203]
  v_mfma_f32_16x16x32_bf16 v[196:199], v[64:67], v[96:99], v[196:199]
  v_mfma_f32_16x16x32_bf16 v[196:199], v[68:71], v[100:103], v[196:199]
  v_mfma_f32_16x16x32_bf16 v[192:195], v[64:67], v[88:91], v[192:195]
  v_mfma_f32_16x16x32_bf16 v[192:195], v[68:71], v[92:95], v[192:195]
  v_mfma_f32_16x16x32_bf16 v[188:191], v[64:67], v[80:83], v[188:191]
  v_mfma_f32_16x16x32_bf16 v[188:191], v[68:71], v[84:87], v[188:191]
  v_mfma_f32_16x16x32_bf16 v[204:207], v[72:75], v[80:83], v[204:207]
  v_mfma_f32_16x16x32_bf16 v[204:207], v[76:79], v[84:87], v[204:207]
  v_mfma_f32_16x16x32_bf16 v[208:211], v[72:75], v[88:91], v[208:211]
  v_mfma_f32_16x16x32_bf16 v[208:211], v[76:79], v[92:95], v[208:211]
  v_mfma_f32_16x16x32_bf16 v[212:215], v[72:75], v[96:99], v[212:215]
  v_mfma_f32_16x16x32_bf16 v[212:215], v[76:79], v[100:103], v[212:215]
  v_mfma_f32_16x16x32_bf16 v[216:219], v[72:75], v[104:107], v[216:219]
  s_setprio 2
  s_barrier
  v_mfma_f32_16x16x32_bf16 v[216:219], v[76:79], v[108:111], v[216:219]
  ds_read_b64_tr_b16 v[40:41], v6 offset:20480
  s_add_u32 m0, s75, 40960
  s_nop 0
  buffer_load_dwordx4 v29, s[44:47], s74 offen offset:0 lds
  ds_read_b64_tr_b16 v[42:43], v6 offset:23040
  ds_read_b64_tr_b16 v[44:45], v6 offset:40960
  ds_read_b64_tr_b16 v[46:47], v6 offset:43520
  ds_read_b64_tr_b16 v[48:49], v7 offset:20480
  buffer_load_dwordx4 v30, s[44:47], s74 offen offset:1024 lds
  ds_read_b64_tr_b16 v[50:51], v7 offset:23040
  ds_read_b64_tr_b16 v[52:53], v7 offset:40960
  ds_read_b64_tr_b16 v[54:55], v7 offset:43520
  ds_read_b64_tr_b16 v[56:57], v8 offset:20480
  buffer_load_dwordx4 v31, s[44:47], s74 offen offset:2048 lds
  ds_read_b64_tr_b16 v[58:59], v8 offset:23040
  ds_read_b64_tr_b16 v[60:61], v8 offset:40960
  ds_read_b64_tr_b16 v[62:63], v8 offset:43520
  ds_read_b64_tr_b16 v[64:65], v9 offset:20480
  buffer_load_dwordx4 v32, s[44:47], s74 offen offset:3072 lds
  ds_read_b64_tr_b16 v[66:67], v9 offset:23040
  ds_read_b64_tr_b16 v[68:69], v9 offset:40960
  ds_read_b64_tr_b16 v[70:71], v9 offset:43520
  ds_read_b128 v[80:83], v11 offset:0
  s_add_u32 m0, m0, 4096
  s_nop 0
  buffer_load_dwordx4 v33, s[44:47], s74 offen offset:0 lds
  s_add_u32 s74, s74, 212992
  ds_read_b128 v[84:87], v12 offset:0
  ds_read_b128 v[88:91], v11 offset:2048
  ds_read_b128 v[92:95], v12 offset:2048
  ds_read_b128 v[96:99], v11 offset:4096
  v_lshl_add_u32 v34, v22, 7, v15
  v_lshl_add_u32 v28, v18, 7, v14
  s_add_u32 m0, s76, 0
  s_nop 0
  buffer_load_dwordx4 v28, s[32:35], 0 offen lds
  ds_read_b128 v[100:103], v12 offset:4096
  ds_read_b128 v[104:107], v11 offset:6144
  ds_read_b128 v[108:111], v12 offset:6144
  ds_read_b64_tr_b16 v[72:73], v10 offset:20480
  s_add_u32 m0, m0, 1024
  s_nop 0
  buffer_load_dwordx4 v34, s[32:35], 0 offen lds
  ds_read_b64_tr_b16 v[74:75], v10 offset:23040
  ds_read_b64_tr_b16 v[76:77], v10 offset:40960
  ds_read_b64_tr_b16 v[78:79], v10 offset:43520
  buffer_load_dwordx3 v[16:18], v13, s[28:31], s73 offen offset:0
  buffer_load_dwordx3 v[20:22], v13, s[28:31], s73 offen offset:832
  s_add_u32 s73, s73, 12
  s_waitcnt vmcnt(9) lgkmcnt(0)
  s_barrier
  s_setprio 0
  v_mfma_f32_16x16x32_bf16 v[140:143], v[40:43], v[80:83], v[140:143]
  v_mfma_f32_16x16x32_bf16 v[140:143], v[44:47], v[84:87], v[140:143]
  v_mfma_f32_16x16x32_bf16 v[144:147], v[40:43], v[88:91], v[144:147]
  v_mfma_f32_16x16x32_bf16 v[144:147], v[44:47], v[92:95], v[144:147]
  v_mfma_f32_16x16x32_bf16 v[148:151], v[40:43], v[96:99], v[148:151]
  v_mfma_f32_16x16x32_bf16 v[148:151], v[44:47], v[100:103], v[148:151]
  v_mfma_f32_16x16x32_bf16 v[152:155], v[40:43], v[104:107], v[152:155]
  v_mfma_f32_16x16x32_bf16 v[152:155], v[44:47], v[108:111], v[152:155]
  v_mfma_f32_16x16x32_bf16 v[168:171], v[48:51], v[104:107], v[168:171]
  v_mfma_f32_16x16x32_bf16 v[168:171], v[52:55], v[108:111], v[168:171]
  v_mfma_f32_16x16x32_bf16 v[164:167], v[48:51], v[96:99], v[164:167]
  v_mfma_f32_16x16x32_bf16 v[164:167], v[52:55], v[100:103], v[164:167]
  v_mfma_f32_16x16x32_bf16 v[160:163], v[48:51], v[88:91], v[160:163]
  v_mfma_f32_16x16x32_bf16 v[160:163], v[52:55], v[92:95], v[160:163]
  v_mfma_f32_16x16x32_bf16 v[156:159], v[48:51], v[80:83], v[156:159]
  v_mfma_f32_16x16x32_bf16 v[156:159], v[52:55], v[84:87], v[156:159]
  v_mfma_f32_16x16x32_bf16 v[172:175], v[56:59], v[80:83], v[172:175]
  v_mfma_f32_16x16x32_bf16 v[172:175], v[60:63], v[84:87], v[172:175]
  v_mfma_f32_16x16x32_bf16 v[176:179], v[56:59], v[88:91], v[176:179]
  v_mfma_f32_16x16x32_bf16 v[176:179], v[60:63], v[92:95], v[176:179]
  v_mfma_f32_16x16x32_bf16 v[180:183], v[56:59], v[96:99], v[180:183]
  v_mfma_f32_16x16x32_bf16 v[180:183], v[60:63], v[100:103], v[180:183]
  v_mfma_f32_16x16x32_bf16 v[184:187], v[56:59], v[104:107], v[184:187]
  v_mfma_f32_16x16x32_bf16 v[184:187], v[60:63], v[108:111], v[184:187]
  v_mfma_f32_16x16x32_bf16 v[200:203], v[64:67], v[104:107], v[200:203]
  v_mfma_f32_16x16x32_bf16 v[200:203], v[68:71], v[108:111], v[200:203]
  v_mfma_f32_16x16x32_bf16 v[196:199], v[64:67], v[96:99], v[196:199]
  v_mfma_f32_16x16x32_bf16 v[196:199], v[68:71], v[100:103], v[196:199]
  v_mfma_f32_16x16x32_bf16 v[192:195], v[64:67], v[88:91], v[192:195]
  v_mfma_f32_16x16x32_bf16 v[192:195], v[68:71], v[92:95], v[192:195]
  v_mfma_f32_16x16x32_bf16 v[188:191], v[64:67], v[80:83], v[188:191]
  v_mfma_f32_16x16x32_bf16 v[188:191], v[68:71], v[84:87], v[188:191]
  v_mfma_f32_16x16x32_bf16 v[204:207], v[72:75], v[80:83], v[204:207]
  v_mfma_f32_16x16x32_bf16 v[204:207], v[76:79], v[84:87], v[204:207]
  v_mfma_f32_16x16x32_bf16 v[208:211], v[72:75], v[88:91], v[208:211]
  v_mfma_f32_16x16x32_bf16 v[208:211], v[76:79], v[92:95], v[208:211]
  v_mfma_f32_16x16x32_bf16 v[212:215], v[72:75], v[96:99], v[212:215]
  v_mfma_f32_16x16x32_bf16 v[212:215], v[76:79], v[100:103], v[212:215]
  v_mfma_f32_16x16x32_bf16 v[216:219], v[72:75], v[104:107], v[216:219]
  s_setprio 2
  s_barrier
  v_mfma_f32_16x16x32_bf16 v[216:219], v[76:79], v[108:111], v[216:219]
  ds_read_b64_tr_b16 v[40:41], v1 offset:0
  s_add_u32 m0, s75, 81920
  s_nop 0
  buffer_load_dwordx4 v29, s[44:47], s74 offen offset:0 lds
  ds_read_b64_tr_b16 v[42:43], v1 offset:2560
  ds_read_b64_tr_b16 v[44:45], v1 offset:20480
  ds_read_b64_tr_b16 v[46:47], v1 offset:23040
  ds_read_b64_tr_b16 v[48:49], v2 offset:0
  buffer_load_dwordx4 v30, s[44:47], s74 offen offset:1024 lds
  ds_read_b64_tr_b16 v[50:51], v2 offset:2560
  ds_read_b64_tr_b16 v[52:53], v2 offset:20480
  ds_read_b64_tr_b16 v[54:55], v2 offset:23040
  ds_read_b64_tr_b16 v[56:57], v3 offset:0
  buffer_load_dwordx4 v31, s[44:47], s74 offen offset:2048 lds
  ds_read_b64_tr_b16 v[58:59], v3 offset:2560
  ds_read_b64_tr_b16 v[60:61], v3 offset:20480
  ds_read_b64_tr_b16 v[62:63], v3 offset:23040
  ds_read_b64_tr_b16 v[64:65], v4 offset:0
  buffer_load_dwordx4 v32, s[44:47], s74 offen offset:3072 lds
  ds_read_b64_tr_b16 v[66:67], v4 offset:2560
  ds_read_b64_tr_b16 v[68:69], v4 offset:20480
  ds_read_b64_tr_b16 v[70:71], v4 offset:23040
  ds_read_b128 v[80:83], v11 offset:8192
  s_add_u32 m0, m0, 4096
  s_nop 0
  buffer_load_dwordx4 v33, s[44:47], s74 offen offset:0 lds
  s_add_u32 s74, s74, 212992
  ds_read_b128 v[84:87], v12 offset:8192
  ds_read_b128 v[88:91], v11 offset:10240
  ds_read_b128 v[92:95], v12 offset:10240
  ds_read_b128 v[96:99], v11 offset:12288
  v_lshl_add_u32 v34, v240, 7, v15
  v_lshl_add_u32 v28, v24, 7, v14
  s_add_u32 m0, s76, 8192
  s_nop 0
  buffer_load_dwordx4 v28, s[32:35], 0 offen lds
  ds_read_b128 v[100:103], v12 offset:12288
  ds_read_b128 v[104:107], v11 offset:14336
  ds_read_b128 v[108:111], v12 offset:14336
  ds_read_b64_tr_b16 v[72:73], v5 offset:0
  s_add_u32 m0, m0, 1024
  s_nop 0
  buffer_load_dwordx4 v34, s[32:35], 0 offen lds
  ds_read_b64_tr_b16 v[74:75], v5 offset:2560
  ds_read_b64_tr_b16 v[76:77], v5 offset:20480
  ds_read_b64_tr_b16 v[78:79], v5 offset:23040
  s_waitcnt vmcnt(9) lgkmcnt(0)
  s_barrier
  s_setprio 0
  v_mfma_f32_16x16x32_bf16 v[140:143], v[40:43], v[80:83], v[140:143]
  v_mfma_f32_16x16x32_bf16 v[140:143], v[44:47], v[84:87], v[140:143]
  v_mfma_f32_16x16x32_bf16 v[144:147], v[40:43], v[88:91], v[144:147]
  v_mfma_f32_16x16x32_bf16 v[144:147], v[44:47], v[92:95], v[144:147]
  v_mfma_f32_16x16x32_bf16 v[148:151], v[40:43], v[96:99], v[148:151]
  v_mfma_f32_16x16x32_bf16 v[148:151], v[44:47], v[100:103], v[148:151]
  v_mfma_f32_16x16x32_bf16 v[152:155], v[40:43], v[104:107], v[152:155]
  v_mfma_f32_16x16x32_bf16 v[152:155], v[44:47], v[108:111], v[152:155]
  v_mfma_f32_16x16x32_bf16 v[168:171], v[48:51], v[104:107], v[168:171]
  v_mfma_f32_16x16x32_bf16 v[168:171], v[52:55], v[108:111], v[168:171]
  v_mfma_f32_16x16x32_bf16 v[164:167], v[48:51], v[96:99], v[164:167]
  v_mfma_f32_16x16x32_bf16 v[164:167], v[52:55], v[100:103], v[164:167]
  v_mfma_f32_16x16x32_bf16 v[160:163], v[48:51], v[88:91], v[160:163]
  v_mfma_f32_16x16x32_bf16 v[160:163], v[52:55], v[92:95], v[160:163]
  v_mfma_f32_16x16x32_bf16 v[156:159], v[48:51], v[80:83], v[156:159]
  v_mfma_f32_16x16x32_bf16 v[156:159], v[52:55], v[84:87], v[156:159]
  v_mfma_f32_16x16x32_bf16 v[172:175], v[56:59], v[80:83], v[172:175]
  v_mfma_f32_16x16x32_bf16 v[172:175], v[60:63], v[84:87], v[172:175]
  v_mfma_f32_16x16x32_bf16 v[176:179], v[56:59], v[88:91], v[176:179]
  v_mfma_f32_16x16x32_bf16 v[176:179], v[60:63], v[92:95], v[176:179]
  v_mfma_f32_16x16x32_bf16 v[180:183], v[56:59], v[96:99], v[180:183]
  v_mfma_f32_16x16x32_bf16 v[180:183], v[60:63], v[100:103], v[180:183]
  v_mfma_f32_16x16x32_bf16 v[184:187], v[56:59], v[104:107], v[184:187]
  v_mfma_f32_16x16x32_bf16 v[184:187], v[60:63], v[108:111], v[184:187]
  v_mfma_f32_16x16x32_bf16 v[200:203], v[64:67], v[104:107], v[200:203]
  v_mfma_f32_16x16x32_bf16 v[200:203], v[68:71], v[108:111], v[200:203]
  v_mfma_f32_16x16x32_bf16 v[196:199], v[64:67], v[96:99], v[196:199]
  v_mfma_f32_16x16x32_bf16 v[196:199], v[68:71], v[100:103], v[196:199]
  v_mfma_f32_16x16x32_bf16 v[192:195], v[64:67], v[88:91], v[192:195]
  v_mfma_f32_16x16x32_bf16 v[192:195], v[68:71], v[92:95], v[192:195]
  v_mfma_f32_16x16x32_bf16 v[188:191], v[64:67], v[80:83], v[188:191]
  v_mfma_f32_16x16x32_bf16 v[188:191], v[68:71], v[84:87], v[188:191]
  v_mfma_f32_16x16x32_bf16 v[204:207], v[72:75], v[80:83], v[204:207]
  v_mfma_f32_16x16x32_bf16 v[204:207], v[76:79], v[84:87], v[204:207]
  v_mfma_f32_16x16x32_bf16 v[208:211], v[72:75], v[88:91], v[208:211]
  v_mfma_f32_16x16x32_bf16 v[208:211], v[76:79], v[92:95], v[208:211]
  v_mfma_f32_16x16x32_bf16 v[212:215], v[72:75], v[96:99], v[212:215]
  v_mfma_f32_16x16x32_bf16 v[212:215], v[76:79], v[100:103], v[212:215]
  v_mfma_f32_16x16x32_bf16 v[216:219], v[72:75], v[104:107], v[216:219]
  s_setprio 2
  s_barrier
  v_mfma_f32_16x16x32_bf16 v[216:219], v[76:79], v[108:111], v[216:219]
  ds_read_b64_tr_b16 v[40:41], v1 offset:40960
  s_add_u32 m0, s75, 0
  s_nop 0
  buffer_load_dwordx4 v29, s[44:47], s74 offen offset:0 lds
  ds_read_b64_tr_b16 v[42:43], v1 offset:43520
  ds_read_b64_tr_b16 v[44:45], v6 offset:0
  ds_read_b64_tr_b16 v[46:47], v6 offset:2560
  ds_read_b64_tr_b16 v[48:49], v2 offset:40960
  buffer_load_dwordx4 v30, s[44:47], s74 offen offset:1024 lds
  ds_read_b64_tr_b16 v[50:51], v2 offset:43520
  ds_read_b64_tr_b16 v[52:53], v7 offset:0
  ds_read_b64_tr_b16 v[54:55], v7 offset:2560
  ds_read_b64_tr_b16 v[56:57], v3 offset:40960
  buffer_load_dwordx4 v31, s[44:47], s74 offen offset:2048 lds
  ds_read_b64_tr_b16 v[58:59], v3 offset:43520
  ds_read_b64_tr_b16 v[60:61], v8 offset:0
  ds_read_b64_tr_b16 v[62:63], v8 offset:2560
  ds_read_b64_tr_b16 v[64:65], v4 offset:40960
  buffer_load_dwordx4 v32, s[44:47], s74 offen offset:3072 lds
  ds_read_b64_tr_b16 v[66:67], v4 offset:43520
  ds_read_b64_tr_b16 v[68:69], v9 offset:0
  ds_read_b64_tr_b16 v[70:71], v9 offset:2560
  ds_read_b128 v[80:83], v11 offset:0
  s_add_u32 m0, m0, 4096
  s_nop 0
  buffer_load_dwordx4 v33, s[44:47], s74 offen offset:0 lds
  s_add_u32 s74, s74, 212992
  ds_read_b128 v[84:87], v12 offset:0
  ds_read_b128 v[88:91], v11 offset:2048
  ds_read_b128 v[92:95], v12 offset:2048
  ds_read_b128 v[96:99], v11 offset:4096
  v_lshl_add_u32 v34, v241, 7, v15
  v_lshl_add_u32 v28, v25, 7, v14
  s_add_u32 m0, s76, 0
  s_nop 0
  buffer_load_dwordx4 v28, s[32:35], 0 offen lds
  ds_read_b128 v[100:103], v12 offset:4096
  ds_read_b128 v[104:107], v11 offset:6144
  ds_read_b128 v[108:111], v12 offset:6144
  ds_read_b64_tr_b16 v[72:73], v5 offset:40960
  s_add_u32 m0, m0, 1024
  s_nop 0
  buffer_load_dwordx4 v34, s[32:35], 0 offen lds
  ds_read_b64_tr_b16 v[74:75], v5 offset:43520
  ds_read_b64_tr_b16 v[76:77], v10 offset:0
  ds_read_b64_tr_b16 v[78:79], v10 offset:2560
  s_mov_b32 m0, 156288
  s_mov_b32 exec_hi, 0xff
  buffer_load_dwordx4 v37, s[52:55], s77 offen lds
  s_mov_b64 exec, -1
  s_waitcnt vmcnt(8) lgkmcnt(0)
  s_barrier
  s_setprio 0
  v_mfma_f32_16x16x32_bf16 v[140:143], v[40:43], v[80:83], v[140:143]
  v_mfma_f32_16x16x32_bf16 v[140:143], v[44:47], v[84:87], v[140:143]
  v_mfma_f32_16x16x32_bf16 v[144:147], v[40:43], v[88:91], v[144:147]
  v_mfma_f32_16x16x32_bf16 v[144:147], v[44:47], v[92:95], v[144:147]
  v_mfma_f32_16x16x32_bf16 v[148:151], v[40:43], v[96:99], v[148:151]
  v_mfma_f32_16x16x32_bf16 v[148:151], v[44:47], v[100:103], v[148:151]
  v_mfma_f32_16x16x32_bf16 v[152:155], v[40:43], v[104:107], v[152:155]
  v_mfma_f32_16x16x32_bf16 v[152:155], v[44:47], v[108:111], v[152:155]
  v_mfma_f32_16x16x32_bf16 v[168:171], v[48:51], v[104:107], v[168:171]
  v_mfma_f32_16x16x32_bf16 v[168:171], v[52:55], v[108:111], v[168:171]
  v_mfma_f32_16x16x32_bf16 v[164:167], v[48:51], v[96:99], v[164:167]
  v_mfma_f32_16x16x32_bf16 v[164:167], v[52:55], v[100:103], v[164:167]
  v_mfma_f32_16x16x32_bf16 v[160:163], v[48:51], v[88:91], v[160:163]
  v_mfma_f32_16x16x32_bf16 v[160:163], v[52:55], v[92:95], v[160:163]
  v_mfma_f32_16x16x32_bf16 v[156:159], v[48:51], v[80:83], v[156:159]
  v_mfma_f32_16x16x32_bf16 v[156:159], v[52:55], v[84:87], v[156:159]
  v_mfma_f32_16x16x32_bf16 v[172:175], v[56:59], v[80:83], v[172:175]
  v_mfma_f32_16x16x32_bf16 v[172:175], v[60:63], v[84:87], v[172:175]
  v_mfma_f32_16x16x32_bf16 v[176:179], v[56:59], v[88:91], v[176:179]
  v_mfma_f32_16x16x32_bf16 v[176:179], v[60:63], v[92:95], v[176:179]
  v_mfma_f32_16x16x32_bf16 v[180:183], v[56:59], v[96:99], v[180:183]
  v_mfma_f32_16x16x32_bf16 v[180:183], v[60:63], v[100:103], v[180:183]
  v_mfma_f32_16x16x32_bf16 v[184:187], v[56:59], v[104:107], v[184:187]
  v_mfma_f32_16x16x32_bf16 v[184:187], v[60:63], v[108:111], v[184:187]
  v_mfma_f32_16x16x32_bf16 v[200:203], v[64:67], v[104:107], v[200:203]
  v_mfma_f32_16x16x32_bf16 v[200:203], v[68:71], v[108:111], v[200:203]
  v_mfma_f32_16x16x32_bf16 v[196:199], v[64:67], v[96:99], v[196:199]
  v_mfma_f32_16x16x32_bf16 v[196:199], v[68:71], v[100:103], v[196:199]
  v_mfma_f32_16x16x32_bf16 v[192:195], v[64:67], v[88:91], v[192:195]
  v_mfma_f32_16x16x32_bf16 v[192:195], v[68:71], v[92:95], v[192:195]
  v_mfma_f32_16x16x32_bf16 v[188:191], v[64:67], v[80:83], v[188:191]
  v_mfma_f32_16x16x32_bf16 v[188:191], v[68:71], v[84:87], v[188:191]
  v_mfma_f32_16x16x32_bf16 v[204:207], v[72:75], v[80:83], v[204:207]
  v_mfma_f32_16x16x32_bf16 v[204:207], v[76:79], v[84:87], v[204:207]
  v_mfma_f32_16x16x32_bf16 v[208:211], v[72:75], v[88:91], v[208:211]
  v_mfma_f32_16x16x32_bf16 v[208:211], v[76:79], v[92:95], v[208:211]
  v_mfma_f32_16x16x32_bf16 v[212:215], v[72:75], v[96:99], v[212:215]
  v_mfma_f32_16x16x32_bf16 v[212:215], v[76:79], v[100:103], v[212:215]
  v_mfma_f32_16x16x32_bf16 v[216:219], v[72:75], v[104:107], v[216:219]
  s_setprio 2
  s_barrier
  v_mfma_f32_16x16x32_bf16 v[216:219], v[76:79], v[108:111], v[216:219]
  ds_read_b64_tr_b16 v[40:41], v6 offset:20480
  s_add_u32 m0, s75, 40960
  s_nop 0
  buffer_load_dwordx4 v29, s[44:47], s74 offen offset:0 lds
  ds_read_b64_tr_b16 v[42:43], v6 offset:23040
  ds_read_b64_tr_b16 v[44:45], v6 offset:40960
  ds_read_b64_tr_b16 v[46:47], v6 offset:43520
  ds_read_b64_tr_b16 v[48:49], v7 offset:20480
  buffer_load_dwordx4 v30, s[44:47], s74 offen offset:1024 lds
  ds_read_b64_tr_b16 v[50:51], v7 offset:23040
  ds_read_b64_tr_b16 v[52:53], v7 offset:40960
  ds_read_b64_tr_b16 v[54:55], v7 offset:43520
  ds_read_b64_tr_b16 v[56:57], v8 offset:20480
  buffer_load_dwordx4 v31, s[44:47], s74 offen offset:2048 lds
  ds_read_b64_tr_b16 v[58:59], v8 offset:23040
  ds_read_b64_tr_b16 v[60:61], v8 offset:40960
  ds_read_b64_tr_b16 v[62:63], v8 offset:43520
  ds_read_b64_tr_b16 v[64:65], v9 offset:20480
  buffer_load_dwordx4 v32, s[44:47], s74 offen offset:3072 lds
  ds_read_b64_tr_b16 v[66:67], v9 offset:23040
  ds_read_b64_tr_b16 v[68:69], v9 offset:40960
  ds_read_b64_tr_b16 v[70:71], v9 offset:43520
  ds_read_b128 v[80:83], v11 offset:8192
  s_add_u32 m0, m0, 4096
  s_nop 0
  buffer_load_dwordx4 v33, s[44:47], s74 offen offset:0 lds
  s_add_u32 s74, s74, 212992
  ds_read_b128 v[84:87], v12 offset:8192
  ds_read_b128 v[88:91], v11 offset:10240
  ds_read_b128 v[92:95], v12 offset:10240
  ds_read_b128 v[96:99], v11 offset:12288
  v_lshl_add_u32 v34, v242, 7, v15
  v_lshl_add_u32 v28, v26, 7, v14
  s_add_u32 m0, s76, 8192
  s_nop 0
  buffer_load_dwordx4 v28, s[32:35], 0 offen lds
  ds_read_b128 v[100:103], v12 offset:12288
  ds_read_b128 v[104:107], v11 offset:14336
  ds_read_b128 v[108:111], v12 offset:14336
  ds_read_b64_tr_b16 v[72:73], v10 offset:20480
  s_add_u32 m0, m0, 1024
  s_nop 0
  buffer_load_dwordx4 v34, s[32:35], 0 offen lds
  ds_read_b64_tr_b16 v[74:75], v10 offset:23040
  ds_read_b64_tr_b16 v[76:77], v10 offset:40960
  ds_read_b64_tr_b16 v[78:79], v10 offset:43520
  buffer_load_dwordx3 v[24:26], v13, s[28:31], s73 offen offset:0
  buffer_load_dwordx3 v[240:242], v13, s[28:31], s73 offen offset:832
  s_add_u32 s73, s73, 12
  s_waitcnt vmcnt(10) lgkmcnt(0)
  s_barrier
  s_setprio 0
  v_mfma_f32_16x16x32_bf16 v[140:143], v[40:43], v[80:83], v[140:143]
  s_add_u32 s72, s72, 1
  v_mfma_f32_16x16x32_bf16 v[140:143], v[44:47], v[84:87], v[140:143]
  v_mfma_f32_16x16x32_bf16 v[144:147], v[40:43], v[88:91], v[144:147]
  v_mfma_f32_16x16x32_bf16 v[144:147], v[44:47], v[92:95], v[144:147]
  v_mfma_f32_16x16x32_bf16 v[148:151], v[40:43], v[96:99], v[148:151]
  v_mfma_f32_16x16x32_bf16 v[148:151], v[44:47], v[100:103], v[148:151]
  v_mfma_f32_16x16x32_bf16 v[152:155], v[40:43], v[104:107], v[152:155]
  v_mfma_f32_16x16x32_bf16 v[152:155], v[44:47], v[108:111], v[152:155]
  v_mfma_f32_16x16x32_bf16 v[168:171], v[48:51], v[104:107], v[168:171]
  v_mfma_f32_16x16x32_bf16 v[168:171], v[52:55], v[108:111], v[168:171]
  v_mfma_f32_16x16x32_bf16 v[164:167], v[48:51], v[96:99], v[164:167]
  v_mfma_f32_16x16x32_bf16 v[164:167], v[52:55], v[100:103], v[164:167]
  v_mfma_f32_16x16x32_bf16 v[160:163], v[48:51], v[88:91], v[160:163]
  v_mfma_f32_16x16x32_bf16 v[160:163], v[52:55], v[92:95], v[160:163]
  v_mfma_f32_16x16x32_bf16 v[156:159], v[48:51], v[80:83], v[156:159]
  v_mfma_f32_16x16x32_bf16 v[156:159], v[52:55], v[84:87], v[156:159]
  v_mfma_f32_16x16x32_bf16 v[172:175], v[56:59], v[80:83], v[172:175]
  v_mfma_f32_16x16x32_bf16 v[172:175], v[60:63], v[84:87], v[172:175]
  v_mfma_f32_16x16x32_bf16 v[176:179], v[56:59], v[88:91], v[176:179]
  v_mfma_f32_16x16x32_bf16 v[176:179], v[60:63], v[92:95], v[176:179]
  s_cmp_lt_u32 s72, 4
  v_mfma_f32_16x16x32_bf16 v[180:183], v[56:59], v[96:99], v[180:183]
  v_mfma_f32_16x16x32_bf16 v[180:183], v[60:63], v[100:103], v[180:183]
  v_mfma_f32_16x16x32_bf16 v[184:187], v[56:59], v[104:107], v[184:187]
  v_mfma_f32_16x16x32_bf16 v[184:187], v[60:63], v[108:111], v[184:187]
  v_mfma_f32_16x16x32_bf16 v[200:203], v[64:67], v[104:107], v[200:203]
  v_mfma_f32_16x16x32_bf16 v[200:203], v[68:71], v[108:111], v[200:203]
  v_mfma_f32_16x16x32_bf16 v[196:199], v[64:67], v[96:99], v[196:199]
  v_mfma_f32_16x16x32_bf16 v[196:199], v[68:71], v[100:103], v[196:199]
  v_mfma_f32_16x16x32_bf16 v[192:195], v[64:67], v[88:91], v[192:195]
  v_mfma_f32_16x16x32_bf16 v[192:195], v[68:71], v[92:95], v[192:195]
  v_mfma_f32_16x16x32_bf16 v[188:191], v[64:67], v[80:83], v[188:191]
  v_mfma_f32_16x16x32_bf16 v[188:191], v[68:71], v[84:87], v[188:191]
  v_mfma_f32_16x16x32_bf16 v[204:207], v[72:75], v[80:83], v[204:207]
  v_mfma_f32_16x16x32_bf16 v[204:207], v[76:79], v[84:87], v[204:207]
  v_mfma_f32_16x16x32_bf16 v[208:211], v[72:75], v[88:91], v[208:211]
  v_mfma_f32_16x16x32_bf16 v[208:211], v[76:79], v[92:95], v[208:211]
  v_mfma_f32_16x16x32_bf16 v[212:215], v[72:75], v[96:99], v[212:215]
  v_mfma_f32_16x16x32_bf16 v[212:215], v[76:79], v[100:103], v[212:215]
  v_mfma_f32_16x16x32_bf16 v[216:219], v[72:75], v[104:107], v[216:219]
  s_setprio 2
  s_barrier
  v_mfma_f32_16x16x32_bf16 v[216:219], v[76:79], v[108:111], v[216:219]
  s_cbranch_scc1 L_dnn_loop1
  ds_read_b64_tr_b16 v[40:41], v1 offset:0
  ds_read_b64_tr_b16 v[42:43], v1 offset:2560
  ds_read_b64_tr_b16 v[44:45], v1 offset:20480
  ds_read_b64_tr_b16 v[46:47], v1 offset:23040
  ds_read_b64_tr_b16 v[48:49], v2 offset:0
  ds_read_b64_tr_b16 v[50:51], v2 offset:2560
  ds_read_b64_tr_b16 v[52:53], v2 offset:20480
  ds_read_b64_tr_b16 v[54:55], v2 offset:23040
  ds_read_b64_tr_b16 v[56:57], v3 offset:0
  ds_read_b64_tr_b16 v[58:59], v3 offset:2560
  ds_read_b64_tr_b16 v[60:61], v3 offset:20480
  ds_read_b64_tr_b16 v[62:63], v3 offset:23040
  ds_read_b64_tr_b16 v[64:65], v4 offset:0
  ds_read_b64_tr_b16 v[66:67], v4 offset:2560
  ds_read_b64_tr_b16 v[68:69], v4 offset:20480
  ds_read_b64_tr_b16 v[70:71], v4 offset:23040
  ds_read_b128 v[80:83], v11 offset:0
  ds_read_b128 v[84:87], v12 offset:0
  ds_read_b128 v[88:91], v11 offset:2048
  ds_read_b128 v[92:95], v12 offset:2048
  ds_read_b128 v[96:99], v11 offset:4096
  ds_read_b128 v[100:103], v12 offset:4096
  ds_read_b128 v[104:107], v11 offset:6144
  ds_read_b128 v[108:111], v12 offset:6144
  ds_read_b64_tr_b16 v[72:73], v5 offset:0
  ds_read_b64_tr_b16 v[74:75], v5 offset:2560
  ds_read_b64_tr_b16 v[76:77], v5 offset:20480
  ds_read_b64_tr_b16 v[78:79], v5 offset:23040
  ds_read_b64 v[220:221], v35 offset:640
  ds_read_b64 v[222:223], v35 offset:672
  ds_read_b64 v[224:225], v35 offset:704
  ds_read_b64 v[226:227], v35 offset:736
  ds_read_b64 v[228:229], v35 offset:768
  s_waitcnt vmcnt(2) lgkmcnt(0)
  s_barrier
  s_setprio 0
  v_mfma_f32_16x16x32_bf16 v[140:143], v[40:43], v[80:83], v[140:143]
  v_mov_b32 v232, 0xc0135761
  v_mov_b32 v233, 0xc0135761
  v_mfma_f32_16x16x32_bf16 v[140:143], v[44:47], v[84:87], v[140:143]
  v_mov_b32 v234, 0xbdd2d3e8
  v_mfma_f32_16x16x32_bf16 v[144:147], v[40:43], v[88:91], v[144:147]
  v_mov_b32 v235, 0xbdd2d3e8
  v_mfma_f32_16x16x32_bf16 v[144:147], v[44:47], v[92:95], v[144:147]
  v_mov_b32 v236, 0x71800000
  v_mfma_f32_16x16x32_bf16 v[148:151], v[40:43], v[96:99], v[148:151]
  v_lshlrev_b32 v112, 16, v220
  v_mfma_f32_16x16x32_bf16 v[148:151], v[44:47], v[100:103], v[148:151]
  v_and_b32 v113, 0xffff0000, v220
  v_mfma_f32_16x16x32_bf16 v[152:155], v[40:43], v[104:107], v[152:155]
  v_lshlrev_b32 v114, 16, v221
  v_mfma_f32_16x16x32_bf16 v[152:155], v[44:47], v[108:111], v[152:155]
  v_and_b32 v115, 0xffff0000, v221
  v_mfma_f32_16x16x32_bf16 v[168:171], v[48:51], v[104:107], v[168:171]
  v_lshlrev_b32 v116, 16, v222
  v_mfma_f32_16x16x32_bf16 v[168:171], v[52:55], v[108:111], v[168:171]
  v_and_b32 v117, 0xffff0000, v222
  v_mfma_f32_16x16x32_bf16 v[164:167], v[48:51], v[96:99], v[164:167]
  v_lshlrev_b32 v118, 16, v223
  v_mfma_f32_16x16x32_bf16 v[164:167], v[52:55], v[100:103], v[164:167]
  v_and_b32 v119, 0xffff0000, v223
  v_mfma_f32_16x16x32_bf16 v[160:163], v[48:51], v[88:91], v[160:163]
  v_lshlrev_b32 v120, 16, v224
  v_mfma_f32_16x16x32_bf16 v[160:163], v[52:55], v[92:95], v[160:163]
  v_and_b32 v121, 0xffff0000, v224
  v_mfma_f32_16x16x32_bf16 v[156:159], v[48:51], v[80:83], v[156:159]
  v_lshlrev_b32 v122, 16, v225
  v_mfma_f32_16x16x32_bf16 v[156:159], v[52:55], v[84:87], v[156:159]
  v_and_b32 v123, 0xffff0000, v225
  v_mfma_f32_16x16x32_bf16 v[172:175], v[56:59], v[80:83], v[172:175]
  v_lshlrev_b32 v124, 16, v226
  v_mfma_f32_16x16x32_bf16 v[172:175], v[60:63], v[84:87], v[172:175]
  v_and_b32 v125, 0xffff0000, v226
  v_mfma_f32_16x16x32_bf16 v[176:179], v[56:59], v[88:91], v[176:179]
  v_lshlrev_b32 v126, 16, v227
  v_mfma_f32_16x16x32_bf16 v[176:179], v[60:63], v[92:95], v[176:179]
  v_and_b32 v127, 0xffff0000, v227
  v_mfma_f32_16x16x32_bf16 v[180:183], v[56:59], v[96:99], v[180:183]
  v_lshlrev_b32 v128, 16, v228
  v_mfma_f32_16x16x32_bf16 v[180:183], v[60:63], v[100:103], v[180:183]
  v_and_b32 v129, 0xffff0000, v228
  v_mfma_f32_16x16x32_bf16 v[184:187], v[56:59], v[104:107], v[184:187]
  v_lshlrev_b32 v130, 16, v229
  v_mfma_f32_16x16x32_bf16 v[184:187], v[60:63], v[108:111], v[184:187]
  v_and_b32 v131, 0xffff0000, v229
  v_mfma_f32_16x16x32_bf16 v[200:203], v[64:67], v[104:107], v[200:203]
  v_rcp_f32 v112, v112
  v_mfma_f32_16x16x32_bf16 v[200:203], v[68:71], v[108:111], v[200:203]
  v_rcp_f32 v113, v113
  v_mfma_f32_16x16x32_bf16 v[196:199], v[64:67], v[96:99], v[196:199]
  v_rcp_f32 v114, v114
  v_mfma_f32_16x16x32_bf16 v[196:199], v[68:71], v[100:103], v[196:199]
  v_rcp_f32 v115, v115
  v_mfma_f32_16x16x32_bf16 v[192:195], v[64:67], v[88:91], v[192:195]
  v_rcp_f32 v116, v116
  v_mfma_f32_16x16x32_bf16 v[192:195], v[68:71], v[92:95], v[192:195]
  v_rcp_f32 v117, v117
  v_mfma_f32_16x16x32_bf16 v[188:191], v[64:67], v[80:83], v[188:191]
  v_rcp_f32 v118, v118
  v_mfma_f32_16x16x32_bf16 v[188:191], v[68:71], v[84:87], v[188:191]
  v_rcp_f32 v119, v119
  v_mfma_f32_16x16x32_bf16 v[204:207], v[72:75], v[80:83], v[204:207]
  v_rcp_f32 v120, v120
  v_mfma_f32_16x16x32_bf16 v[204:207], v[76:79], v[84:87], v[204:207]
  v_rcp_f32 v121, v121
  v_mfma_f32_16x16x32_bf16 v[208:211], v[72:75], v[88:91], v[208:211]
  v_rcp_f32 v122, v122
  v_mfma_f32_16x16x32_bf16 v[208:211], v[76:79], v[92:95], v[208:211]
  v_rcp_f32 v123, v123
  v_mfma_f32_16x16x32_bf16 v[212:215], v[72:75], v[96:99], v[212:215]
  v_rcp_f32 v124, v124
  v_mfma_f32_16x16x32_bf16 v[212:215], v[76:79], v[100:103], v[212:215]
  v_rcp_f32 v125, v125
  v_mfma_f32_16x16x32_bf16 v[216:219], v[72:75], v[104:107], v[216:219]
  s_setprio 2
  s_barrier
  v_mfma_f32_16x16x32_bf16 v[216:219], v[76:79], v[108:111], v[216:219]
  ds_read_b64_tr_b16 v[40:41], v1 offset:40960
  ds_read_b64_tr_b16 v[42:43], v1 offset:43520
  ds_read_b64_tr_b16 v[44:45], v6 offset:0
  ds_read_b64_tr_b16 v[46:47], v6 offset:2560
  ds_read_b64_tr_b16 v[48:49], v2 offset:40960
  ds_read_b64_tr_b16 v[50:51], v2 offset:43520
  ds_read_b64_tr_b16 v[52:53], v7 offset:0
  ds_read_b64_tr_b16 v[54:55], v7 offset:2560
  ds_read_b64_tr_b16 v[56:57], v3 offset:40960
  ds_read_b64_tr_b16 v[58:59], v3 offset:43520
  ds_read_b64_tr_b16 v[60:61], v8 offset:0
  ds_read_b64_tr_b16 v[62:63], v8 offset:2560
  ds_read_b64_tr_b16 v[64:65], v4 offset:40960
  ds_read_b64_tr_b16 v[66:67], v4 offset:43520
  ds_read_b64_tr_b16 v[68:69], v9 offset:0
  ds_read_b64_tr_b16 v[70:71], v9 offset:2560
  ds_read_b128 v[80:83], v11 offset:8192
  ds_read_b128 v[84:87], v12 offset:8192
  ds_read_b128 v[88:91], v11 offset:10240
  ds_read_b128 v[92:95], v12 offset:10240
  ds_read_b128 v[96:99], v11 offset:12288
  ds_read_b128 v[100:103], v12 offset:12288
  ds_read_b128 v[104:107], v11 offset:14336
  ds_read_b128 v[108:111], v12 offset:14336
  ds_read_b64_tr_b16 v[72:73], v5 offset:40960
  ds_read_b64_tr_b16 v[74:75], v5 offset:43520
  ds_read_b64_tr_b16 v[76:77], v10 offset:0
  ds_read_b64_tr_b16 v[78:79], v10 offset:2560
  s_waitcnt lgkmcnt(0)
  s_barrier
  v_mfma_f32_16x16x32_bf16 v[140:143], v[40:43], v[80:83], v[140:143]
  v_rcp_f32 v126, v126
  v_mfma_f32_16x16x32_bf16 v[140:143], v[44:47], v[84:87], v[140:143]
  v_rcp_f32 v127, v127
  v_mfma_f32_16x16x32_bf16 v[144:147], v[40:43], v[88:91], v[144:147]
  v_rcp_f32 v128, v128
  v_mfma_f32_16x16x32_bf16 v[144:147], v[44:47], v[92:95], v[144:147]
  v_mfma_f32_16x16x32_bf16 v[148:151], v[40:43], v[96:99], v[148:151]
  v_rcp_f32 v129, v129
  v_mfma_f32_16x16x32_bf16 v[148:151], v[44:47], v[100:103], v[148:151]
  v_rcp_f32 v130, v130
  v_mfma_f32_16x16x32_bf16 v[152:155], v[40:43], v[104:107], v[152:155]
  v_mfma_f32_16x16x32_bf16 v[152:155], v[44:47], v[108:111], v[152:155]
  v_rcp_f32 v131, v131
  v_mfma_f32_16x16x32_bf16 v[168:171], v[48:51], v[104:107], v[168:171]
  v_med3_f32 v112, v112, -v236, v236
  v_mfma_f32_16x16x32_bf16 v[168:171], v[52:55], v[108:111], v[168:171]
  v_mfma_f32_16x16x32_bf16 v[164:167], v[48:51], v[96:99], v[164:167]
  v_med3_f32 v113, v113, -v236, v236
  v_mfma_f32_16x16x32_bf16 v[164:167], v[52:55], v[100:103], v[164:167]
  v_med3_f32 v114, v114, -v236, v236
  v_mfma_f32_16x16x32_bf16 v[160:163], v[48:51], v[88:91], v[160:163]
  v_mfma_f32_16x16x32_bf16 v[160:163], v[52:55], v[92:95], v[160:163]
  v_med3_f32 v115, v115, -v236, v236
  v_mfma_f32_16x16x32_bf16 v[156:159], v[48:51], v[80:83], v[156:159]
  v_med3_f32 v116, v116, -v236, v236
  v_mfma_f32_16x16x32_bf16 v[156:159], v[52:55], v[84:87], v[156:159]
  v_mfma_f32_16x16x32_bf16 v[172:175], v[56:59], v[80:83], v[172:175]
  v_med3_f32 v117, v117, -v236, v236
  v_mfma_f32_16x16x32_bf16 v[172:175], v[60:63], v[84:87], v[172:175]
  v_med3_f32 v118, v118, -v236, v236
  v_mfma_f32_16x16x32_bf16 v[176:179], v[56:59], v[88:91], v[176:179]
  v_mfma_f32_16x16x32_bf16 v[176:179], v[60:63], v[92:95], v[176:179]
  v_med3_f32 v119, v119, -v236, v236
  v_mfma_f32_16x16x32_bf16 v[180:183], v[56:59], v[96:99], v[180:183]
  v_med3_f32 v120, v120, -v236, v236
  v_mfma_f32_16x16x32_bf16 v[180:183], v[60:63], v[100:103], v[180:183]
  v_med3_f32 v121, v121, -v236, v236
  v_mfma_f32_16x16x32_bf16 v[184:187], v[56:59], v[104:107], v[184:187]
  v_mfma_f32_16x16x32_bf16 v[184:187], v[60:63], v[108:111], v[184:187]
  v_med3_f32 v122, v122, -v236, v236
  v_mfma_f32_16x16x32_bf16 v[200:203], v[64:67], v[104:107], v[200:203]
  v_med3_f32 v123, v123, -v236, v236
  v_mfma_f32_16x16x32_bf16 v[200:203], v[68:71], v[108:111], v[200:203]
  v_mfma_f32_16x16x32_bf16 v[196:199], v[64:67], v[96:99], v[196:199]
  v_med3_f32 v124, v124, -v236, v236
  v_mfma_f32_16x16x32_bf16 v[196:199], v[68:71], v[100:103], v[196:199]
  v_med3_f32 v125, v125, -v236, v236
  v_mfma_f32_16x16x32_bf16 v[192:195], v[64:67], v[88:91], v[192:195]
  v_mfma_f32_16x16x32_bf16 v[192:195], v[68:71], v[92:95], v[192:195]
  v_med3_f32 v126, v126, -v236, v236
  v_mfma_f32_16x16x32_bf16 v[188:191], v[64:67], v[80:83], v[188:191]
  v_med3_f32 v127, v127, -v236, v236
  v_mfma_f32_16x16x32_bf16 v[188:191], v[68:71], v[84:87], v[188:191]
  v_mfma_f32_16x16x32_bf16 v[204:207], v[72:75], v[80:83], v[204:207]
  v_med3_f32 v128, v128, -v236, v236
  v_mfma_f32_16x16x32_bf16 v[204:207], v[76:79], v[84:87], v[204:207]
  v_med3_f32 v129, v129, -v236, v236
  v_mfma_f32_16x16x32_bf16 v[208:211], v[72:75], v[88:91], v[208:211]
  v_mfma_f32_16x16x32_bf16 v[208:211], v[76:79], v[92:95], v[208:211]
  v_med3_f32 v130, v130, -v236, v236
  v_mfma_f32_16x16x32_bf16 v[212:215], v[72:75], v[96:99], v[212:215]
  v_med3_f32 v131, v131, -v236, v236
  v_mfma_f32_16x16x32_bf16 v[212:215], v[76:79], v[100:103], v[212:215]
  v_mfma_f32_16x16x32_bf16 v[216:219], v[72:75], v[104:107], v[216:219]
  v_mfma_f32_16x16x32_bf16 v[216:219], v[76:79], v[108:111], v[216:219]
  s_setprio 0
  s_nop 0
L_epi:
  s_lshl_b32 s69, s27, 11
  s_and_b32 s71, s26, 3
  s_lshl_b32 s71, s71, 9
  s_add_u32 s69, s69, s71
  s_lshr_b32 s68, s26, 2
  s_lshl_b32 s68, s68, 14
  s_add_u32 s69, s69, s68
  v_lshlrev_b32 v3, 3, v0
  v_add_u32 v2, 156928, v3
  v_pk_mul_f32 v[40:41], v[140:141], v[140:141]
  v_pk_mul_f32 v[44:45], v[144:145], v[144:145]
  v_pk_mul_f32 v[48:49], v[148:149], v[148:149]
  v_pk_mul_f32 v[52:53], v[152:153], v[152:153]
  v_pk_fma_f32 v[40:41], v[40:41], v[234:235], v[232:233]
  v_pk_fma_f32 v[44:45], v[44:45], v[234:235], v[232:233]
  v_pk_fma_f32 v[48:49], v[48:49], v[234:235], v[232:233]
  v_pk_fma_f32 v[52:53], v[52:53], v[234:235], v[232:233]
  v_pk_mul_f32 v[40:41], v[40:41], v[140:141]
  v_pk_mul_f32 v[44:45], v[44:45], v[144:145]
  v_pk_mul_f32 v[48:49], v[48:49], v[148:149]
  v_pk_mul_f32 v[52:53], v[52:53], v[152:153]
  v_exp_f32 v40, v40
  v_exp_f32 v41, v41
  v_exp_f32 v44, v44
  v_exp_f32 v45, v45
  v_exp_f32 v48, v48
  v_exp_f32 v49, v49
  v_exp_f32 v52, v52
  v_exp_f32 v53, v53
  v_pk_fma_f32 v[40:41], v[40:41], v[112:113], v[112:113]
  v_pk_fma_f32 v[44:45], v[44:45], v[112:113], v[112:113]
  v_pk_fma_f32 v[48:49], v[48:49], v[112:113], v[112:113]
  v_pk_fma_f32 v[52:53], v[52:53], v[112:113], v[112:113]
  v_rcp_f32 v40, v40
  v_rcp_f32 v41, v41
  v_rcp_f32 v44, v44
  v_rcp_f32 v45, v45
  v_rcp_f32 v48, v48
  v_rcp_f32 v49, v49
  v_rcp_f32 v52, v52
  v_rcp_f32 v53, v53
  v_pk_mul_f32 v[16:17], v[40:41], v[140:141]
  v_pk_mul_f32 v[18:19], v[44:45], v[144:145]
  v_pk_mul_f32 v[20:21], v[48:49], v[148:149]
  v_pk_mul_f32 v[22:23], v[52:53], v[152:153]
  v_pk_mul_f32 v[56:57], v[142:143], v[142:143]
  v_pk_mul_f32 v[60:61], v[146:147], v[146:147]
  v_pk_mul_f32 v[64:65], v[150:151], v[150:151]
  v_pk_mul_f32 v[68:69], v[154:155], v[154:155]
  v_pk_fma_f32 v[56:57], v[56:57], v[234:235], v[232:233]
  v_pk_fma_f32 v[60:61], v[60:61], v[234:235], v[232:233]
  v_pk_fma_f32 v[64:65], v[64:65], v[234:235], v[232:233]
  v_pk_fma_f32 v[68:69], v[68:69], v[234:235], v[232:233]
  v_pk_mul_f32 v[56:57], v[56:57], v[142:143]
  v_pk_mul_f32 v[60:61], v[60:61], v[146:147]
  v_pk_mul_f32 v[64:65], v[64:65], v[150:151]
  v_pk_mul_f32 v[68:69], v[68:69], v[154:155]
  v_exp_f32 v56, v56
  v_exp_f32 v57, v57
  v_exp_f32 v60, v60
  v_exp_f32 v61, v61
  v_exp_f32 v64, v64
  v_exp_f32 v65, v65
  v_exp_f32 v68, v68
  v_exp_f32 v69, v69
  v_pk_fma_f32 v[56:57], v[56:57], v[114:115], v[114:115]
  v_pk_fma_f32 v[60:61], v[60:61], v[114:115], v[114:115]
  v_pk_fma_f32 v[64:65], v[64:65], v[114:115], v[114:115]
  v_pk_fma_f32 v[68:69], v[68:69], v[114:115], v[114:115]
  v_rcp_f32 v56, v56
  v_rcp_f32 v57, v57
  v_rcp_f32 v60, v60
  v_rcp_f32 v61, v61
  v_rcp_f32 v64, v64
  v_rcp_f32 v65, v65
  v_rcp_f32 v68, v68
  v_rcp_f32 v69, v69
  v_pk_fma_f32 v[16:17], v[56:57], v[142:143], v[16:17]
  v_pk_fma_f32 v[18:19], v[60:61], v[146:147], v[18:19]
  v_pk_fma_f32 v[20:21], v[64:65], v[150:151], v[20:21]
  v_pk_fma_f32 v[22:23], v[68:69], v[154:155], v[22:23]
  v_pk_mul_f32 v[40:41], v[156:157], v[156:157]
  v_pk_mul_f32 v[44:45], v[160:161], v[160:161]
  v_pk_mul_f32 v[48:49], v[164:165], v[164:165]
  v_pk_mul_f32 v[52:53], v[168:169], v[168:169]
  v_pk_fma_f32 v[40:41], v[40:41], v[234:235], v[232:233]
  v_pk_fma_f32 v[44:45], v[44:45], v[234:235], v[232:233]
  v_pk_fma_f32 v[48:49], v[48:49], v[234:235], v[232:233]
  v_pk_fma_f32 v[52:53], v[52:53], v[234:235], v[232:233]
  v_pk_mul_f32 v[40:41], v[40:41], v[156:157]
  v_pk_mul_f32 v[44:45], v[44:45], v[160:161]
  v_pk_mul_f32 v[48:49], v[48:49], v[164:165]
  v_pk_mul_f32 v[52:53], v[52:53], v[168:169]
  v_exp_f32 v40, v40
  v_exp_f32 v41, v41
  v_exp_f32 v44, v44
  v_exp_f32 v45, v45
  v_exp_f32 v48, v48
  v_exp_f32 v49, v49
  v_exp_f32 v52, v52
  v_exp_f32 v53, v53
  v_pk_fma_f32 v[40:41], v[40:41], v[116:117], v[116:117]
  v_pk_fma_f32 v[44:45], v[44:45], v[116:117], v[116:117]
  v_pk_fma_f32 v[48:49], v[48:49], v[116:117], v[116:117]
  v_pk_fma_f32 v[52:53], v[52:53], v[116:117], v[116:117]
  v_rcp_f32 v40, v40
  v_rcp_f32 v41, v41
  v_rcp_f32 v44, v44
  v_rcp_f32 v45, v45
  v_rcp_f32 v48, v48
  v_rcp_f32 v49, v49
  v_rcp_f32 v52, v52
  v_rcp_f32 v53, v53
  v_pk_fma_f32 v[16:17], v[40:41], v[156:157], v[16:17]
  v_pk_fma_f32 v[18:19], v[44:45], v[160:161], v[18:19]
  v_pk_fma_f32 v[20:21], v[48:49], v[164:165], v[20:21]
  v_pk_fma_f32 v[22:23], v[52:53], v[168:169], v[22:23]
  v_pk_mul_f32 v[56:57], v[158:159], v[158:159]
  v_pk_mul_f32 v[60:61], v[162:163], v[162:163]
  v_pk_mul_f32 v[64:65], v[166:167], v[166:167]
  v_pk_mul_f32 v[68:69], v[170:171], v[170:171]
  v_pk_fma_f32 v[56:57], v[56:57], v[234:235], v[232:233]
  v_pk_fma_f32 v[60:61], v[60:61], v[234:235], v[232:233]
  v_pk_fma_f32 v[64:65], v[64:65], v[234:235], v[232:233]
  v_pk_fma_f32 v[68:69], v[68:69], v[234:235], v[232:233]
  v_pk_mul_f32 v[56:57], v[56:57], v[158:159]
  v_pk_mul_f32 v[60:61], v[60:61], v[162:163]
  v_pk_mul_f32 v[64:65], v[64:65], v[166:167]
  v_pk_mul_f32 v[68:69], v[68:69], v[170:171]
  v_exp_f32 v56, v56
  v_exp_f32 v57, v57
  v_exp_f32 v60, v60
  v_exp_f32 v61, v61
  v_exp_f32 v64, v64
  v_exp_f32 v65, v65
  v_exp_f32 v68, v68
  v_exp_f32 v69, v69
  v_pk_fma_f32 v[56:57], v[56:57], v[118:119], v[118:119]
  v_pk_fma_f32 v[60:61], v[60:61], v[118:119], v[118:119]
  v_pk_fma_f32 v[64:65], v[64:65], v[118:119], v[118:119]
  v_pk_fma_f32 v[68:69], v[68:69], v[118:119], v[118:119]
  v_rcp_f32 v56, v56
  v_rcp_f32 v57, v57
  v_rcp_f32 v60, v60
  v_rcp_f32 v61, v61
  v_rcp_f32 v64, v64
  v_rcp_f32 v65, v65
  v_rcp_f32 v68, v68
  v_rcp_f32 v69, v69
  v_pk_fma_f32 v[16:17], v[56:57], v[158:159], v[16:17]
  v_pk_fma_f32 v[18:19], v[60:61], v[162:163], v[18:19]
  v_pk_fma_f32 v[20:21], v[64:65], v[166:167], v[20:21]
  v_pk_fma_f32 v[22:23], v[68:69], v[170:171], v[22:23]
  v_pk_mul_f32 v[40:41], v[172:173], v[172:173]
  v_pk_mul_f32 v[44:45], v[176:177], v[176:177]
  v_pk_mul_f32 v[48:49], v[180:181], v[180:181]
  v_pk_mul_f32 v[52:53], v[184:185], v[184:185]
  v_pk_fma_f32 v[40:41], v[40:41], v[234:235], v[232:233]
  v_pk_fma_f32 v[44:45], v[44:45], v[234:235], v[232:233]
  v_pk_fma_f32 v[48:49], v[48:49], v[234:235], v[232:233]
  v_pk_fma_f32 v[52:53], v[52:53], v[234:235], v[232:233]
  v_pk_mul_f32 v[40:41], v[40:41], v[172:173]
  v_pk_mul_f32 v[44:45], v[44:45], v[176:177]
  v_pk_mul_f32 v[48:49], v[48:49], v[180:181]
  v_pk_mul_f32 v[52:53], v[52:53], v[184:185]
  v_exp_f32 v40, v40
  v_exp_f32 v41, v41
  v_exp_f32 v44, v44
  v_exp_f32 v45, v45
  v_exp_f32 v48, v48
  v_exp_f32 v49, v49
  v_exp_f32 v52, v52
  v_exp_f32 v53, v53
  v_pk_fma_f32 v[40:41], v[40:41], v[120:121], v[120:121]
  v_pk_fma_f32 v[44:45], v[44:45], v[120:121], v[120:121]
  v_pk_fma_f32 v[48:49], v[48:49], v[120:121], v[120:121]
  v_pk_fma_f32 v[52:53], v[52:53], v[120:121], v[120:121]
  v_rcp_f32 v40, v40
  v_rcp_f32 v41, v41
  v_rcp_f32 v44, v44
  v_rcp_f32 v45, v45
  v_rcp_f32 v48, v48
  v_rcp_f32 v49, v49
  v_rcp_f32 v52, v52
  v_rcp_f32 v53, v53
  v_pk_fma_f32 v[16:17], v[40:41], v[172:173], v[16:17]
  v_pk_fma_f32 v[18:19], v[44:45], v[176:177], v[18:19]
  v_pk_fma_f32 v[20:21], v[48:49], v[180:181], v[20:21]
  v_pk_fma_f32 v[22:23], v[52:53], v[184:185], v[22:23]
  v_pk_mul_f32 v[56:57], v[174:175], v[174:175]
  v_pk_mul_f32 v[60:61], v[178:179], v[178:179]
  v_pk_mul_f32 v[64:65], v[182:183], v[182:183]
  v_pk_mul_f32 v[68:69], v[186:187], v[186:187]
  v_pk_fma_f32 v[56:57], v[56:57], v[234:235], v[232:233]
  v_pk_fma_f32 v[60:61], v[60:61], v[234:235], v[232:233]
  v_pk_fma_f32 v[64:65], v[64:65], v[234:235], v[232:233]
  v_pk_fma_f32 v[68:69], v[68:69], v[234:235], v[232:233]
  v_pk_mul_f32 v[56:57], v[56:57], v[174:175]
  v_pk_mul_f32 v[60:61], v[60:61], v[178:179]
  v_pk_mul_f32 v[64:65], v[64:65], v[182:183]
  v_pk_mul_f32 v[68:69], v[68:69], v[186:187]
  v_exp_f32 v56, v56
  v_exp_f32 v57, v57
  v_exp_f32 v60, v60
  v_exp_f32 v61, v61
  v_exp_f32 v64, v64
  v_exp_f32 v65, v65
  v_exp_f32 v68, v68
  v_exp_f32 v69, v69
  v_pk_fma_f32 v[56:57], v[56:57], v[122:123], v[122:123]
  v_pk_fma_f32 v[60:61], v[60:61], v[122:123], v[122:123]
  v_pk_fma_f32 v[64:65], v[64:65], v[122:123], v[122:123]
  v_pk_fma_f32 v[68:69], v[68:69], v[122:123], v[122:123]
  v_rcp_f32 v56, v56
  v_rcp_f32 v57, v57
  v_rcp_f32 v60, v60
  v_rcp_f32 v61, v61
  v_rcp_f32 v64, v64
  v_rcp_f32 v65, v65
  v_rcp_f32 v68, v68
  v_rcp_f32 v69, v69
  v_pk_fma_f32 v[16:17], v[56:57], v[174:175], v[16:17]
  v_pk_fma_f32 v[18:19], v[60:61], v[178:179], v[18:19]
  v_pk_fma_f32 v[20:21], v[64:65], v[182:183], v[20:21]
  v_pk_fma_f32 v[22:23], v[68:69], v[186:187], v[22:23]
  v_pk_mul_f32 v[40:41], v[188:189], v[188:189]
  v_pk_mul_f32 v[44:45], v[192:193], v[192:193]
  v_pk_mul_f32 v[48:49], v[196:197], v[196:197]
  v_pk_mul_f32 v[52:53], v[200:201], v[200:201]
  v_pk_fma_f32 v[40:41], v[40:41], v[234:235], v[232:233]
  v_pk_fma_f32 v[44:45], v[44:45], v[234:235], v[232:233]
  v_pk_fma_f32 v[48:49], v[48:49], v[234:235], v[232:233]
  v_pk_fma_f32 v[52:53], v[52:53], v[234:235], v[232:233]
  v_pk_mul_f32 v[40:41], v[40:41], v[188:189]
  v_pk_mul_f32 v[44:45], v[44:45], v[192:193]
  v_pk_mul_f32 v[48:49], v[48:49], v[196:197]
  v_pk_mul_f32 v[52:53], v[52:53], v[200:201]
  v_exp_f32 v40, v40
  v_exp_f32 v41, v41
  v_exp_f32 v44, v44
  v_exp_f32 v45, v45
  v_exp_f32 v48, v48
  v_exp_f32 v49, v49
  v_exp_f32 v52, v52
  v_exp_f32 v53, v53
  v_pk_fma_f32 v[40:41], v[40:41], v[124:125], v[124:125]
  v_pk_fma_f32 v[44:45], v[44:45], v[124:125], v[124:125]
  v_pk_fma_f32 v[48:49], v[48:49], v[124:125], v[124:125]
  v_pk_fma_f32 v[52:53], v[52:53], v[124:125], v[124:125]
  v_rcp_f32 v40, v40
  v_rcp_f32 v41, v41
  v_rcp_f32 v44, v44
  v_rcp_f32 v45, v45
  v_rcp_f32 v48, v48
  v_rcp_f32 v49, v49
  v_rcp_f32 v52, v52
  v_rcp_f32 v53, v53
  v_pk_fma_f32 v[16:17], v[40:41], v[188:189], v[16:17]
  v_pk_fma_f32 v[18:19], v[44:45], v[192:193], v[18:19]
  v_pk_fma_f32 v[20:21], v[48:49], v[196:197], v[20:21]
  v_pk_fma_f32 v[22:23], v[52:53], v[200:201], v[22:23]
  v_pk_mul_f32 v[56:57], v[190:191], v[190:191]
  v_pk_mul_f32 v[60:61], v[194:195], v[194:195]
  v_pk_mul_f32 v[64:65], v[198:199], v[198:199]
  v_pk_mul_f32 v[68:69], v[202:203], v[202:203]
  v_pk_fma_f32 v[56:57], v[56:57], v[234:235], v[232:233]
  v_pk_fma_f32 v[60:61], v[60:61], v[234:235], v[232:233]
  v_pk_fma_f32 v[64:65], v[64:65], v[234:235], v[232:233]
  v_pk_fma_f32 v[68:69], v[68:69], v[234:235], v[232:233]
  v_pk_mul_f32 v[56:57], v[56:57], v[190:191]
  v_pk_mul_f32 v[60:61], v[60:61], v[194:195]
  v_pk_mul_f32 v[64:65], v[64:65], v[198:199]
  v_pk_mul_f32 v[68:69], v[68:69], v[202:203]
  v_exp_f32 v56, v56
  v_exp_f32 v57, v57
  v_exp_f32 v60, v60
  v_exp_f32 v61, v61
  v_exp_f32 v64, v64
  v_exp_f32 v65, v65
  v_exp_f32 v68, v68
  v_exp_f32 v69, v69
  v_pk_fma_f32 v[56:57], v[56:57], v[126:127], v[126:127]
  v_pk_fma_f32 v[60:61], v[60:61], v[126:127], v[126:127]
  v_pk_fma_f32 v[64:65], v[64:65], v[126:127], v[126:127]
  v_pk_fma_f32 v[68:69], v[68:69], v[126:127], v[126:127]
  v_rcp_f32 v56, v56
  v_rcp_f32 v57, v57
  v_rcp_f32 v60, v60
  v_rcp_f32 v61, v61
  v_rcp_f32 v64, v64
  v_rcp_f32 v65, v65
  v_rcp_f32 v68, v68
  v_rcp_f32 v69, v69
  v_pk_fma_f32 v[16:17], v[56:57], v[190:191], v[16:17]
  v_pk_fma_f32 v[18:19], v[60:61], v[194:195], v[18:19]
  v_pk_fma_f32 v[20:21], v[64:65], v[198:199], v[20:21]
  v_pk_fma_f32 v[22:23], v[68:69], v[202:203], v[22:23]
  v_pk_mul_f32 v[40:41], v[204:205], v[204:205]
  v_pk_mul_f32 v[44:45], v[208:209], v[208:209]
  v_pk_mul_f32 v[48:49], v[212:213], v[212:213]
  v_pk_mul_f32 v[52:53], v[216:217], v[216:217]
  v_pk_fma_f32 v[40:41], v[40:41], v[234:235], v[232:233]
  v_pk_fma_f32 v[44:45], v[44:45], v[234:235], v[232:233]
  v_pk_fma_f32 v[48:49], v[48:49], v[234:235], v[232:233]
  v_pk_fma_f32 v[52:53], v[52:53], v[234:235], v[232:233]
  v_pk_mul_f32 v[40:41], v[40:41], v[204:205]
  v_pk_mul_f32 v[44:45], v[44:45], v[208:209]
  v_pk_mul_f32 v[48:49], v[48:49], v[212:213]
  v_pk_mul_f32 v[52:53], v[52:53], v[216:217]
  v_exp_f32 v40, v40
  v_exp_f32 v41, v41
  v_exp_f32 v44, v44
  v_exp_f32 v45, v45
  v_exp_f32 v48, v48
  v_exp_f32 v49, v49
  v_exp_f32 v52, v52
  v_exp_f32 v53, v53
  v_pk_fma_f32 v[40:41], v[40:41], v[128:129], v[128:129]
  v_pk_fma_f32 v[44:45], v[44:45], v[128:129], v[128:129]
  v_pk_fma_f32 v[48:49], v[48:49], v[128:129], v[128:129]
  v_pk_fma_f32 v[52:53], v[52:53], v[128:129], v[128:129]
  v_rcp_f32 v40, v40
  v_rcp_f32 v41, v41
  v_rcp_f32 v44, v44
  v_rcp_f32 v45, v45
  v_rcp_f32 v48, v48
  v_rcp_f32 v49, v49
  v_rcp_f32 v52, v52
  v_rcp_f32 v53, v53
  v_pk_fma_f32 v[16:17], v[40:41], v[204:205], v[16:17]
  v_pk_fma_f32 v[18:19], v[44:45], v[208:209], v[18:19]
  v_pk_fma_f32 v[20:21], v[48:49], v[212:213], v[20:21]
  v_pk_fma_f32 v[22:23], v[52:53], v[216:217], v[22:23]
  v_pk_mul_f32 v[56:57], v[206:207], v[206:207]
  v_pk_mul_f32 v[60:61], v[210:211], v[210:211]
  v_pk_mul_f32 v[64:65], v[214:215], v[214:215]
  v_pk_mul_f32 v[68:69], v[218:219], v[218:219]
  v_pk_fma_f32 v[56:57], v[56:57], v[234:235], v[232:233]
  v_pk_fma_f32 v[60:61], v[60:61], v[234:235], v[232:233]
  v_pk_fma_f32 v[64:65], v[64:65], v[234:235], v[232:233]
  v_pk_fma_f32 v[68:69], v[68:69], v[234:235], v[232:233]
  v_pk_mul_f32 v[56:57], v[56:57], v[206:207]
  v_pk_mul_f32 v[60:61], v[60:61], v[210:211]
  v_pk_mul_f32 v[64:65], v[64:65], v[214:215]
  v_pk_mul_f32 v[68:69], v[68:69], v[218:219]
  v_exp_f32 v56, v56
  v_exp_f32 v57, v57
  v_exp_f32 v60, v60
  v_exp_f32 v61, v61
  v_exp_f32 v64, v64
  v_exp_f32 v65, v65
  v_exp_f32 v68, v68
  v_exp_f32 v69, v69
  v_pk_fma_f32 v[56:57], v[56:57], v[130:131], v[130:131]
  v_pk_fma_f32 v[60:61], v[60:61], v[130:131], v[130:131]
  v_pk_fma_f32 v[64:65], v[64:65], v[130:131], v[130:131]
  v_pk_fma_f32 v[68:69], v[68:69], v[130:131], v[130:131]
  v_rcp_f32 v56, v56
  v_rcp_f32 v57, v57
  v_rcp_f32 v60, v60
  v_rcp_f32 v61, v61
  v_rcp_f32 v64, v64
  v_rcp_f32 v65, v65
  v_rcp_f32 v68, v68
  v_rcp_f32 v69, v69
  v_pk_fma_f32 v[16:17], v[56:57], v[206:207], v[16:17]
  v_pk_fma_f32 v[18:19], v[60:61], v[210:211], v[18:19]
  v_pk_fma_f32 v[20:21], v[64:65], v[214:215], v[20:21]
  v_pk_fma_f32 v[22:23], v[68:69], v[218:219], v[22:23]
  v_add_f32 v16, v16, v17
  v_add_f32 v18, v18, v19
  v_add_f32 v20, v20, v21
  v_add_f32 v22, v22, v23
  s_nop 0
  v_permlane32_swap_b32 v16, v20
  v_permlane32_swap_b32 v18, v22
  v_add_f32 v16, v16, v20
  v_add_f32 v18, v18, v22
  s_nop 1
  v_permlane16_swap_b32 v16, v18
  v_add_f32 v16, v16, v18
  ds_write_b32 v36, v16
  s_waitcnt lgkmcnt(0)
  s_cmp_eq_u32 s3, 0
  s_cbranch_scc1 L_dpub
  s_barrier
  s_endpgm
L_dpub:
  s_mov_b32 s60, s24
  s_and_b32 s61, s25, 0xffff
  s_mov_b32 s62, 268435456
  s_mov_b32 s63, 0x20000
  s_mov_b32 s64, s22
  s_and_b32 s65, s23, 0xffff
  s_mov_b32 s66, 256
  s_mov_b32 s67, 0x20000
  s_waitcnt vmcnt(0)
  v_cmp_eq_u32 vcc, 0, v37
  s_nop 0
  s_and_b32 vcc_lo, vcc_lo, 0xff
  s_cbranch_scc0 L_dclr_ok
  s_mov_b32 s78, 0x40000
L_dclr:
  s_sub_u32 s78, s78, 1
  s_cbranch_scc1 L_dclr_ok
  v_lshlrev_b32 v37, 2, v0
  v_and_b32 v37, 31, v37
  buffer_load_dword v37, v37, s[64:67], 0 offen offset:128 sc1
  s_waitcnt vmcnt(0)
  v_cmp_eq_u32 vcc, 0, v37
  s_nop 0
  s_and_b32 vcc_lo, vcc_lo, 0xff
  s_cbranch_scc1 L_dclr
L_dclr_ok:
  s_barrier
  ds_read_b64 v[64:65], v2 offset:0
  ds_read_b64 v[66:67], v2 offset:512
  ds_read_b64 v[68:69], v2 offset:1024
  ds_read_b64 v[70:71], v2 offset:1536
  s_waitcnt lgkmcnt(2)
  v_pk_add_f32 v[64:65], v[64:65], v[66:67]
  s_waitcnt lgkmcnt(0)
  v_pk_add_f32 v[68:69], v[68:69], v[70:71]
  v_pk_add_f32 v[64:65], v[64:65], v[68:69]
  v_and_b32 v64, -2, v64
  v_and_b32 v65, -2, v65
  buffer_store_dwordx2 v[64:65], v3, s[60:63], s69 offen sc1
  s_endpgm
L_cin:
  s_and_b32 s68, s26, 3
  s_mul_i32 s68, s68, 3
  s_add_u32 s27, s68, s27
  s_sub_u32 s27, s27, 6
  s_cbranch_scc1 L_rem
  s_and_b32 s79, s3, 3
  s_lshr_b32 s84, s3, 2
  s_lshl_b32 s100, s27, 3
  s_add_u32 s100, s100, s3
  s_mul_i32 s68, s100, 1280
  v_min_u32 v40, 9, v0
  v_lshlrev_b32 v40, 7, v40
  v_lshlrev_b32 v48, 4, v0
  s_lshl_b32 s95, s79, 10
  s_cmp_eq_u32 s79, 2
  s_cselect_b64 s[82:83], 0x1fffff, -1
  s_cmp_eq_u32 s79, 3
  s_cselect_b32 s96, 0, 32768
  s_add_u32 s96, s96, s95
  s_mul_i32 s69, s27, 2979
  s_lshr_b32 s69, s69, 6
  s_mul_i32 s98, s27, 44
  s_and_b32 s70, s2, 7
  s_add_u32 s85, s98, s3
  s_lshl_b32 s85, s85, 2
  s_lshl_b32 s98, s70, 14
  s_add_u32 s85, s85, s98
  s_add_u32 s85, s85, 10240
  s_mul_i32 s98, s27, 44
  s_lshl_b32 s77, s70, 9
  s_add_u32 s94, s77, s98
  s_add_u32 s77, s77, s69
  s_add_u32 s94, s94, s3
  s_mul_i32 s94, s94, 104
  s_lshl_b32 s98, s27, 2
  s_add_u32 s98, s98, s3
  s_add_u32 s98, s98, s70
  s_and_b32 s98, s98, 7
  s_mul_i32 s98, s98, 16640
  s_add_u32 s98, s98, 12288
  s_sub_u32 s72, 6, s84
  s_lshl_b32 s99, s84, 1
  s_mov_b32 s26, -1
  v_lshrrev_b32 v43, 3, v0
  v_min_u32 v43, 6, v43
  v_lshlrev_b32 v17, 4, v43
  s_mul_i32 s70, s70, 88
  s_add_u32 s70, s100, s70
  s_mov_b32 s71, 704
  v_mov_b32 v44, s70
  v_mad_u32_u24 v19, v0, s71, v44
  s_mul_i32 s70, s100, 104
  s_sub_u32 s70, s70, 313
  v_min_u32 v44, 16, v0
  v_mul_u32_u24 v45, 26, v44
  v_add_u32 v45, s70, v45
  v_cmp_lt_u32 vcc, 12, v44
  s_nop 1
  v_cndmask_b32 v19, v19, v45, vcc
  v_lshlrev_b32 v19, 7, v19
  s_mov_b32 s101, 212992
  v_mov_b32 v2, 110464
  v_lshlrev_b32 v1, 20, v0
  v_add_u32 v1, 110464, v1
  v_and_b32 v44, 7, v0
  v_lshlrev_b32 v18, 4, v44
  v_and_b32 v44, 15, v0
  v_lshl_add_u32 v44, v44, 2, v2
  v_mov_b32 v3, 0
  ds_write_b32 v44, v3
  v_lshrrev_b32 v41, 5, v0
  v_and_b32 v42, 31, v0
  s_waitcnt lgkmcnt(0)
  v_mov_b32 v3, 1
  s_mov_b32 s32, s6
  s_and_b32 s33, s7, 0xffff
  s_mov_b32 s34, 12800000
  s_mov_b32 s35, 0x20000
  v_mov_b32 v45, s80
  buffer_load_dword v255, v45, s[32:35], 0 offen
  s_mov_b32 s36, s8
  s_and_b32 s37, s9, 0xffff
  s_mov_b32 s38, 105456
  s_mov_b32 s39, 0x20000
  buffer_load_dword v255, v40, s[36:39], s68 offen
  s_mov_b32 s44, s12
  s_and_b32 s45, s13, 0xffff
  s_mov_b32 s46, 5537792
  s_mov_b32 s47, 0x20000
  s_barrier
  s_mov_b64 exec, 131071
  buffer_load_dword v255, v19, s[44:47], s101 offen
  s_mov_b64 exec, -1
  s_add_u32 s101, s101, 1171456
  s_mov_b32 s28, s4
  s_and_b32 s29, s5, 0xffff
  s_mov_b32 s30, 425984
  s_mov_b32 s31, 0x20000
  s_cmp_lg_u32 s84, 0
  s_cbranch_scc1 L_g1a
  s_mov_b32 s40, s10
  s_and_b32 s41, s11, 0xffff
  s_mov_b32 s42, 156
  s_mov_b32 s43, 0x20000
  s_mov_b32 m0, 110272
  s_mov_b64 exec, 0x7ff
  buffer_load_dwordx4 v48, s[40:43], 0 offen lds
  s_mov_b64 exec, -1
  s_add_u32 m0, s95, 71552
  s_add_u32 s81, s95, 70304
  buffer_load_dwordx4 v48, s[36:39], s81 offen lds
  s_add_u32 m0, s95, 75648
  s_add_u32 s81, s95, 74400
  buffer_load_dwordx4 v48, s[36:39], s81 offen lds
  s_add_u32 m0, s95, 79744
  s_add_u32 s81, s95, 78496
  buffer_load_dwordx4 v48, s[36:39], s81 offen lds
  s_add_u32 m0, s95, 83840
  s_add_u32 s81, s95, 82592
  buffer_load_dwordx4 v48, s[36:39], s81 offen lds
  s_add_u32 m0, s95, 87936
  s_add_u32 s81, s95, 86688
  buffer_load_dwordx4 v48, s[36:39], s81 offen lds
  s_add_u32 m0, s95, 92032
  s_add_u32 s81, s95, 90784
  buffer_load_dwordx4 v48, s[36:39], s81 offen lds
  s_add_u32 m0, s95, 96128
  s_add_u32 s81, s95, 94880
  buffer_load_dwordx4 v48, s[36:39], s81 offen lds
  s_add_u32 m0, s95, 100224
  s_add_u32 s81, s95, 98976
  buffer_load_dwordx4 v48, s[36:39], s81 offen lds
  s_add_u32 m0, s96, 71552
  s_add_u32 s81, s96, 70304
  s_mov_b64 exec, s[82:83]
  buffer_load_dwordx4 v48, s[36:39], s81 offen lds
  s_mov_b64 exec, -1
  s_add_u32 m0, s95, 36288
  s_add_u32 s81, s95, 35152
  buffer_load_dwordx4 v48, s[36:39], s81 offen lds
  s_add_u32 m0, s95, 40384
  s_add_u32 s81, s95, 39248
  buffer_load_dwordx4 v48, s[36:39], s81 offen lds
  s_add_u32 m0, s95, 44480
  s_add_u32 s81, s95, 43344
  buffer_load_dwordx4 v48, s[36:39], s81 offen lds
  s_add_u32 m0, s95, 48576
  s_add_u32 s81, s95, 47440
  buffer_load_dwordx4 v48, s[36:39], s81 offen lds
  s_branch L_addrc
L_g1a:
  s_setprio 1
  v_bfe_u32 v43, v0, 2, 2
  v_lshl_add_u32 v43, v41, 3, v43
  v_bfe_u32 v44, v0, 4, 1
  v_lshlrev_b32 v44, 5, v44
  v_and_b32 v45, 3, v0
  v_lshl_add_u32 v44, v45, 3, v44
  v_lshl_add_u32 v240, v43, 6, v44
  v_add_u32 v240, 106816, v240
  s_lshl_b32 s68, s79, 6
  s_add_u32 s68, s68, 36288
  v_add_u32 v44, s68, v44
  v_mul_u32_u24 v45, 1352, v43
  v_add_u32 v241, v44, v45
  v_add_u32 v45, 16, v43
  v_min_u32 v45, 25, v45
  v_mul_u32_u24 v45, 1352, v45
  v_add_u32 v242, v44, v45
  v_add_u32 v45, 20, v43
  v_min_u32 v45, 25, v45
  v_mul_u32_u24 v45, 1352, v45
  v_add_u32 v243, v44, v45
  s_lshl_b32 s68, s79, 5
  v_add_u32 v246, s68, v42
  v_mul_u32_u24 v43, 52, v246
  v_lshl_add_u32 v43, v41, 3, v43
  v_add_u32 v244, 71552, v43
  v_lshlrev_b32 v43, 1, v246
  v_add_u32 v245, 108864, v43
  v_mov_b32 v216, 0
  v_mov_b32 v217, 0
  v_lshlrev_b32 v43, 3, v0
  v_add_u32 v44, 106816, v43
  s_lshl_b32 s68, s79, 9
  v_add_u32 v44, s68, v44
  ds_write_b64 v44, v[216:217]
  v_lshl_add_u32 v43, v41, 7, v246
  s_mov_b32 s69, 2521
  s_mov_b32 s70, 106816
  v_mul_u32_u24 v44, s69, v43
  v_lshrrev_b32 v44, 16, v44
  v_mad_u32_u24 v44, v44, 12, s70
  v_lshl_add_u32 v68, v43, 1, v44
  v_add_u32 v43, 256, v43
  v_mul_u32_u24 v44, s69, v43
  v_lshrrev_b32 v44, 16, v44
  v_mad_u32_u24 v44, v44, 12, s70
  v_lshl_add_u32 v69, v43, 1, v44
  v_add_u32 v43, 256, v43
  v_mul_u32_u24 v44, s69, v43
  v_lshrrev_b32 v44, 16, v44
  v_mad_u32_u24 v44, v44, 12, s70
  v_lshl_add_u32 v70, v43, 1, v44
  v_mov_b32 v44, 676
  v_cmp_gt_u32 s[92:93], v44, v43
  v_add_u32 v43, 0, v246
  v_mul_u32_u24 v44, s69, v43
  v_lshrrev_b32 v44, 16, v44
  v_lshl_add_u32 v44, v44, 2, v244
  v_add_u32 v72, 0, v44
  v_add_u32 v43, 128, v246
  v_mul_u32_u24 v44, s69, v43
  v_lshrrev_b32 v44, 16, v44
  v_lshl_add_u32 v44, v44, 2, v244
  v_add_u32 v73, 6656, v44
  v_add_u32 v43, 256, v246
  v_mul_u32_u24 v44, s69, v43
  v_lshrrev_b32 v44, 16, v44
  v_lshl_add_u32 v44, v44, 2, v244
  v_add_u32 v74, 13312, v44
  v_add_u32 v43, 384, v246
  v_mul_u32_u24 v44, s69, v43
  v_lshrrev_b32 v44, 16, v44
  v_lshl_add_u32 v44, v44, 2, v244
  v_add_u32 v75, 19968, v44
  v_add_u32 v43, 512, v246
  v_mul_u32_u24 v44, s69, v43
  v_lshrrev_b32 v44, 16, v44
  v_lshl_add_u32 v44, v44, 2, v244
  v_add_u32 v76, 26624, v44
  v_add_u32 v43, 640, v246
  v_mul_u32_u24 v44, s69, v43
  v_lshrrev_b32 v44, 16, v44
  v_lshl_add_u32 v44, v44, 2, v244
  v_add_u32 v77, 33280, v44
  v_lshlrev_b32 v78, 4, v41
  v_add_u32 v78, 110376, v78
  v_lshlrev_b32 v79, 1, v0
  v_add_u32 v79, 110272, v79
  v_lshlrev_b32 v80, 6, v0
  v_add_u32 v80, 106868, v80
L_addrc:
  s_and_b32 s70, s3, 1
  s_lshl_b32 s70, s70, 1
  v_add_u32 v46, s70, v41
  v_min_u32 v43, 25, v42
  s_mul_i32 s68, s84, 4
  s_add_u32 s68, s68, 1352
  s_mul_i32 s69, s84, 70528
  s_add_u32 s69, s69, 1024
  v_mul_u32_u24 v44, s68, v43
  v_add_u32 v44, s69, v44
  v_lshlrev_b32 v247, 2, v43
  v_add_u32 v247, 70528, v247
  v_mul_u32_u24 v65, 52, v43
  v_lshl_add_u32 v65, v46, 1, v65
  v_add_u32 v65, 108864, v65
  v_lshlrev_b32 v67, 1, v43
  v_add_u32 v67, 110272, v67
  v_mad_u32_u24 v60, v46, 52, v44
  v_lshl_add_u32 v61, v46, 1, v44
  v_lshl_add_u32 v49, v46, 1, v60
  v_lshlrev_b32 v43, 3, v46
  s_mov_b32 s68, 0x01000100
  v_bfe_i32 v45, s68, v43, 8
  v_lshl_add_u32 v50, v45, 1, v60
  v_mad_i32_i24 v51, v45, 52, v61
  s_mov_b32 s68, 0xff00ff00
  v_bfe_i32 v45, s68, v43, 8
  v_lshl_add_u32 v52, v45, 1, v60
  v_mad_i32_i24 v53, v45, 52, v61
  s_mov_b32 s68, 0xff020100
  v_bfe_i32 v45, s68, v43, 8
  v_lshl_add_u32 v54, v45, 1, v60
  v_mad_i32_i24 v55, v45, 52, v61
  s_mov_b32 s68, 0x0b0a0100
  v_bfe_i32 v45, s68, v43, 8
  v_lshl_add_u32 v56, v45, 1, v60
  v_mad_i32_i24 v57, v45, 52, v61
  s_mov_b32 s68, 0xf3f20100
  v_bfe_i32 v45, s68, v43, 8
  v_lshl_add_u32 v58, v45, 1, v60
  v_mad_i32_i24 v59, v45, 52, v61
  s_mov_b32 s68, 0x00023600
  v_bfe_u32 v45, s68, v43, 8
  v_add_u32 v60, v45, v44
  v_add_u32 v61, 52, v44
  v_mov_b32 v47, 1048576
  v_cmp_eq_u32 vcc, 3, v46
  s_nop 1
  v_cndmask_b32 v60, v60, v47, vcc
  v_cndmask_b32 v67, v47, v67, vcc
  v_cmp_eq_u32 vcc, 2, v46
  s_nop 1
  v_cndmask_b32 v61, v47, v61, vcc
  v_cmp_gt_u32 vcc, 2, v46
  s_nop 1
  v_cndmask_b32 v64, v47, v65, vcc
  s_lshr_b32 s69, s79, 1
  s_mul_i32 s69, s69, 6144
  s_mul_i32 s68, s84, 6144
  v_lshlrev_b32 v45, 8, v46
  v_lshl_add_u32 v43, v42, 4, v45
  v_add_u32 v63, 1024, v43
  v_add_u32 v66, 36288, v43
  v_bfe_u32 v43, v0, 2, 2
  v_lshl_add_u32 v45, v43, 4, v45
  v_and_b32 v43, 3, v0
  v_lshl_add_u32 v44, v43, 6, v45
  v_add_u32 v44, 12288, v44
  v_cmp_lt_u32 vcc, 15, v42
  s_nop 1
  v_cndmask_b32 v63, v63, v44, vcc
  v_add_u32 v44, 16, v44
  v_cndmask_b32 v66, v66, v44, vcc
  v_lshl_add_u32 v44, v43, 5, v45
  v_add_u32 v44, 24560, v44
  v_cmp_lt_u32 vcc, 19, v42
  s_nop 1
  v_cndmask_b32 v63, v63, v44, vcc
  v_add_u32 v63, s69, v63
  v_add_u32 v66, s68, v66
  v_cmp_lt_u32 vcc, 25, v42
  s_nop 1
  v_cndmask_b32 v63, v63, v47, vcc
  v_cndmask_b32 v66, v66, v47, vcc
  v_mov_b32 v62, 0
  s_mul_i32 s74, s3, 4224
  s_add_u32 s74, s74, 111040
  s_mov_b32 s75, -39488
  v_add_u32 v28, 1024, v48
  v_and_b32 v43, 11, v0
  v_cmp_eq_u32 vcc, 11, v43
  s_nop 1
  v_cndmask_b32 v31, v28, v47, vcc
  v_and_b32 v43, 3, v0
  v_cmp_eq_u32 vcc, 0, v43
  s_nop 1
  v_cndmask_b32 v30, v31, v47, vcc
  v_lshrrev_b32 v46, 4, v0
  v_bfe_u32 v43, v0, 1, 3
  v_lshlrev_b32 v45, 4, v43
  v_add_u32 v45, 24576, v45
  v_and_b32 v43, 10, v0
  v_cmp_eq_u32 vcc, 10, v43
  s_nop 1
  v_cndmask_b32 v45, v45, v47, vcc
  v_and_b32 v44, 1, v0
  v_lshl_add_u32 v29, v46, 9, v45
  v_lshl_add_u32 v29, v44, 2, v29
  v_add_u32 v29, 1024, v29
  v_lshl_add_u32 v22, v46, 8, v45
  v_lshl_add_u32 v22, v44, 20, v22
  v_and_b32 v47, 15, v0
  s_mov_b32 s68, 1056
  v_lshlrev_b32 v43, 1, v47
  v_add_u32 v43, s74, v43
  v_mad_u32_u24 v7, v46, s68, v43
  s_lshl_b32 s68, s3, 10
  s_add_u32 s68, s68, 144832
  v_add_u32 v10, s68, v48
  v_add_u32 v43, 256, v48
  v_and_b32 v43, 1023, v43
  v_add_u32 v11, s68, v43
  v_xor_b32 v43, 512, v48
  v_add_u32 v12, s68, v43
  v_lshlrev_b32 v13, 4, v41
  v_mov_b32 v32, 0
  v_mov_b32 v33, 0
  v_mov_b32 v34, 0
  v_mov_b32 v35, 0
  v_mov_b32 v36, 0
  v_mov_b32 v37, 0
  v_mov_b32 v38, 0
  v_mov_b32 v39, 0
  v_mov_b32 v216, 0
  v_mov_b32 v217, 0
  v_mov_b32 v218, 0
  v_mov_b32 v219, 0
  v_mov_b32 v220, 0
  v_mov_b32 v221, 0
  v_mov_b32 v222, 0
  v_mov_b32 v223, 0
  v_mov_b32 v224, 0
  v_mov_b32 v225, 0
  v_mov_b32 v226, 0
  v_mov_b32 v227, 0
  v_mov_b32 v228, 0
  v_mov_b32 v229, 0
  v_mov_b32 v230, 0
  v_mov_b32 v231, 0
  v_mov_b32 v232, 0
  v_mov_b32 v233, 0
  v_mov_b32 v234, 0
  v_mov_b32 v235, 0
  v_mov_b32 v236, 0
  v_mov_b32 v237, 0
  v_mov_b32 v238, 0
  v_mov_b32 v239, 0
  v_mul_u32_u24 v44, 1056, v46
  v_bfe_u32 v45, v0, 2, 2
  v_lshl_add_u32 v44, v45, 7, v44
  v_and_b32 v45, 3, v0
  v_lshl_add_u32 v9, v45, 3, v44
  v_add_u32 v8, s74, v9
  v_and_b32 v45, 1, v0
  s_mov_b32 s68, 0xaaaaaaaa
  v_mul_lo_u32 v16, s68, v45
  v_or_b32 v16, 0x44444444, v16
  v_lshlrev_b32 v15, 1, v0
  v_add_u32 v15, s74, v15
  v_mov_b32 v14, 0x3f80
  ds_write_b16 v15, v14 offset:4064
  v_add_u32 v15, s75, v15
  s_mul_i32 s71, s3, 6
  s_add_u32 s77, s77, s71
  s_mul_i32 s77, s77, 104
  s_add_u32 s73, s77, 80
  s_add_u32 s77, s77, 16
  s_mov_b32 s71, 10923
  v_min_u32 v43, 35, v0
  v_mul_u32_u24 v44, s71, v43
  v_lshrrev_b32 v44, 16, v44
  v_mul_u32_u24 v44, 80, v44
  v_lshl_add_u32 v20, v43, 2, v44
  s_cmp_eq_u32 s84, 0
  s_cbranch_scc1 L_g0pf
  s_waitcnt lgkmcnt(0)
  ds_add_u32 v1, v3 offset:0
  s_sub_u32 s94, s94, 416
  buffer_load_dwordx4 v[204:207], v17, s[28:31], s94 offen offset:0
  s_add_u32 s94, s94, 416
  buffer_load_dwordx4 v[24:27], v17, s[28:31], s94 offen offset:0
  s_add_u32 s94, s94, 832
  s_sub_u32 s68, s77, 2496
  buffer_load_dword v208, v20, s[28:31], s68 offen
  buffer_load_dword v209, v20, s[28:31], s77 offen
  s_add_u32 s77, s77, 24
  buffer_load_dword v21, v20, s[28:31], s77 offen
  s_cmp_eq_u32 s77, s73
  s_cselect_b32 s73, 0x7000000, s73
  s_cselect_b32 s77, 0x7000000, s77
  s_add_u32 s77, s77, 24
  s_min_u32 s77, s77, s73
L_csync1:
  ds_read_b32 v4, v2 offset:0
  s_waitcnt lgkmcnt(0)
  v_cmp_gt_u32 vcc, 8, v4
  s_cbranch_vccnz L_csync1
  ds_read_b64 v[132:133], v78 offset:0
  ds_read_b64 v[134:135], v78 offset:8
  ds_read_b64 v[136:137], v78 offset:32
  ds_read_b64 v[138:139], v78 offset:40
  ds_read_u16 v45, v79 offset:52
  ds_read_b64_tr_b16 v[84:85], v241 offset:35264
  ds_read_b64_tr_b16 v[86:87], v241 offset:40672
  ds_read_b64_tr_b16 v[88:89], v242 offset:35264
  ds_read_b64_tr_b16 v[90:91], v243 offset:35264
  ds_read_b64_tr_b16 v[92:93], v241 offset:35520
  ds_read_b64_tr_b16 v[94:95], v241 offset:40928
  ds_read_b64_tr_b16 v[96:97], v242 offset:35520
  ds_read_b64_tr_b16 v[98:99], v243 offset:35520
  ds_read_b64_tr_b16 v[100:101], v241 offset:35776
  ds_read_b64_tr_b16 v[102:103], v241 offset:41184
  ds_read_b64_tr_b16 v[104:105], v242 offset:35776
  ds_read_b64_tr_b16 v[106:107], v243 offset:35776
  ds_read_b64_tr_b16 v[108:109], v241 offset:36032
  ds_read_b64_tr_b16 v[110:111], v241 offset:41440
  ds_read_b64_tr_b16 v[112:113], v242 offset:36032
  ds_read_b64_tr_b16 v[114:115], v243 offset:36032
  s_waitcnt lgkmcnt(14)
  v_mfma_f32_32x32x16_bf16 v[140:155], v[132:135], v[84:87], 0
  s_waitcnt lgkmcnt(12)
  v_mfma_f32_32x32x16_bf16 v[140:155], v[136:139], v[88:91], v[140:155]
  ds_read_b64_tr_b16 v[116:117], v241 offset:36288
  ds_read_b64_tr_b16 v[118:119], v241 offset:41696
  ds_read_b64_tr_b16 v[120:121], v242 offset:36288
  ds_read_b64_tr_b16 v[122:123], v243 offset:36288
  s_waitcnt lgkmcnt(14)
  v_mfma_f32_32x32x16_bf16 v[156:171], v[132:135], v[92:95], 0
  s_waitcnt lgkmcnt(12)
  v_mfma_f32_32x32x16_bf16 v[156:171], v[136:139], v[96:99], v[156:171]
  ds_read_b64_tr_b16 v[124:125], v241 offset:36544
  ds_read_b64_tr_b16 v[126:127], v241 offset:41952
  ds_read_b64_tr_b16 v[128:129], v242 offset:36544
  ds_read_b64_tr_b16 v[130:131], v243 offset:36544
  s_waitcnt lgkmcnt(14)
  v_mfma_f32_32x32x16_bf16 v[172:187], v[132:135], v[100:103], 0
  s_waitcnt lgkmcnt(12)
  v_mfma_f32_32x32x16_bf16 v[172:187], v[136:139], v[104:107], v[172:187]
  v_cvt_pk_bf16_f32 v81, v140, 0
  s_waitcnt lgkmcnt(10)
  v_mfma_f32_32x32x16_bf16 v[188:203], v[132:135], v[108:111], 0
  s_waitcnt lgkmcnt(8)
  v_mfma_f32_32x32x16_bf16 v[188:203], v[136:139], v[112:115], v[188:203]
  s_mov_b32 exec_lo, 0
  v_cvt_pk_bf16_f32 v81, v156, 0
  s_mov_b32 exec_lo, -1
  ds_write_b16 v68, v81
  s_waitcnt lgkmcnt(7)
  v_mfma_f32_32x32x16_bf16 v[140:155], v[132:135], v[116:119], 0
  s_waitcnt lgkmcnt(5)
  v_mfma_f32_32x32x16_bf16 v[140:155], v[136:139], v[120:123], v[140:155]
  v_cvt_pk_bf16_f32 v82, v172, 0
  s_waitcnt lgkmcnt(3)
  v_mfma_f32_32x32x16_bf16 v[156:171], v[132:135], v[124:127], 0
  s_waitcnt lgkmcnt(1)
  v_mfma_f32_32x32x16_bf16 v[156:171], v[136:139], v[128:131], v[156:171]
  s_mov_b32 exec_lo, 0
  v_cvt_pk_bf16_f32 v82, v188, 0
  s_mov_b32 exec_lo, -1
  ds_write_b16 v69, v82
  s_nop 2
  v_cvt_pk_bf16_f32 v83, v140, 0
  s_mov_b32 exec_lo, 0
  s_nop 2
  v_cvt_pk_bf16_f32 v83, v156, 0
  s_mov_b64 exec, s[92:93]
  ds_write_b16 v70, v83
  s_mov_b64 exec, 0x3ffffff
  ds_write_b16 v80, v45
  s_mov_b64 exec, -1
  s_waitcnt lgkmcnt(0)
  ds_add_u32 v1, v3 offset:32
  s_mov_b64 exec, 131071
  buffer_load_dword v255, v19, s[44:47], s101 offen
  s_mov_b64 exec, -1
  s_add_u32 s101, s101, 1171456
  v_cmp_gt_u32 s[92:93], 36, v246
  s_waitcnt vmcnt(3)
  v_lshlrev_b32 v208, 7, v208
  buffer_load_dword v255, v208, s[32:35], 0 offen
  s_waitcnt vmcnt(3)
  v_lshlrev_b32 v209, 7, v209
  buffer_load_dword v255, v209, s[32:35], 0 offen
L_csync2:
  ds_read_b32 v4, v2 offset:4
  s_waitcnt lgkmcnt(0)
  v_cmp_gt_u32 vcc, 4, v4
  s_cbranch_vccnz L_csync2
  ds_read_b64_tr_b16 v[84:85], v241 offset:0
  ds_read_b64_tr_b16 v[86:87], v241 offset:5408
  ds_read_b64_tr_b16 v[88:89], v242 offset:0
  ds_read_b64_tr_b16 v[90:91], v243 offset:0
  ds_read_b64_tr_b16 v[92:93], v241 offset:256
  ds_read_b64_tr_b16 v[94:95], v241 offset:5664
  ds_read_b64_tr_b16 v[96:97], v242 offset:256
  ds_read_b64_tr_b16 v[98:99], v243 offset:256
  ds_read_b64_tr_b16 v[100:101], v241 offset:512
  ds_read_b64_tr_b16 v[102:103], v241 offset:5920
  ds_read_b64_tr_b16 v[104:105], v242 offset:512
  ds_read_b64_tr_b16 v[106:107], v243 offset:512
  ds_read_b64_tr_b16 v[108:109], v241 offset:768
  ds_read_b64_tr_b16 v[110:111], v241 offset:6176
  ds_read_b64_tr_b16 v[112:113], v242 offset:768
  ds_read_b64_tr_b16 v[114:115], v243 offset:768
  ds_read_b64_tr_b16 v[116:117], v241 offset:1024
  ds_read_b64_tr_b16 v[118:119], v241 offset:6432
  ds_read_b64_tr_b16 v[120:121], v242 offset:1024
  ds_read_b64_tr_b16 v[122:123], v243 offset:1024
  ds_read_b64_tr_b16 v[124:125], v241 offset:1280
  ds_read_b64_tr_b16 v[126:127], v241 offset:6688
  ds_read_b64_tr_b16 v[128:129], v242 offset:1280
  ds_read_b64_tr_b16 v[130:131], v243 offset:1280
L_csync3:
  ds_read_b32 v4, v2 offset:32
  s_waitcnt lgkmcnt(0)
  v_cmp_gt_u32 vcc, 4, v4
  s_cbranch_vccnz L_csync3
  s_setprio 1
  ds_read_b64_tr_b16 v[132:133], v240 offset:0
  ds_read_b64_tr_b16 v[134:135], v240 offset:256
  ds_read_b64_tr_b16 v[136:137], v240 offset:1024
  ds_read_b64_tr_b16 v[138:139], v240 offset:1280
  s_waitcnt lgkmcnt(2)
  v_mfma_f32_32x32x16_bf16 v[140:155], v[132:135], v[84:87], 0
  s_waitcnt lgkmcnt(0)
  v_mfma_f32_32x32x16_bf16 v[140:155], v[136:139], v[88:91], v[140:155]
  v_mfma_f32_32x32x16_bf16 v[156:171], v[132:135], v[92:95], 0
  v_mfma_f32_32x32x16_bf16 v[156:171], v[136:139], v[96:99], v[156:171]
  v_mfma_f32_32x32x16_bf16 v[172:187], v[132:135], v[100:103], 0
  v_mfma_f32_32x32x16_bf16 v[172:187], v[136:139], v[104:107], v[172:187]
  s_nop 7
  v_cvt_pk_bf16_f32 v84, v140, v141
  v_cvt_pk_bf16_f32 v85, v142, v143
  v_cvt_pk_bf16_f32 v86, v144, v145
  v_cvt_pk_bf16_f32 v87, v146, v147
  v_cvt_pk_bf16_f32 v88, v148, v149
  v_cvt_pk_bf16_f32 v89, v150, v151
  v_cvt_pk_bf16_f32 v90, v152, v153
  v_cvt_pk_bf16_f32 v91, v154, v155
  ds_write2_b32 v72, v84, v85 offset0:0 offset1:1
  v_max3_f32 v62, v62, abs(v140), abs(v141)
  v_max3_f32 v62, v62, abs(v142), abs(v143)
  v_max3_f32 v62, v62, abs(v144), abs(v145)
  ds_write2_b32 v72, v86, v87 offset0:4 offset1:5
  v_max3_f32 v62, v62, abs(v146), abs(v147)
  v_max3_f32 v62, v62, abs(v148), abs(v149)
  ds_write2_b32 v72, v88, v89 offset0:8 offset1:9
  v_max3_f32 v62, v62, abs(v150), abs(v151)
  v_max3_f32 v62, v62, abs(v152), abs(v153)
  v_mfma_f32_32x32x16_bf16 v[188:203], v[132:135], v[108:111], 0
  v_mfma_f32_32x32x16_bf16 v[188:203], v[136:139], v[112:115], v[188:203]
  v_cvt_pk_bf16_f32 v92, v156, v157
  v_cvt_pk_bf16_f32 v93, v158, v159
  v_cvt_pk_bf16_f32 v94, v160, v161
  v_cvt_pk_bf16_f32 v95, v162, v163
  v_cvt_pk_bf16_f32 v96, v164, v165
  v_cvt_pk_bf16_f32 v97, v166, v167
  v_cvt_pk_bf16_f32 v98, v168, v169
  v_cvt_pk_bf16_f32 v99, v170, v171
  ds_write2_b32 v73, v92, v93 offset0:0 offset1:1
  v_max3_f32 v62, v62, abs(v156), abs(v157)
  v_max3_f32 v62, v62, abs(v158), abs(v159)
  v_max3_f32 v62, v62, abs(v160), abs(v161)
  ds_write2_b32 v73, v94, v95 offset0:4 offset1:5
  v_max3_f32 v62, v62, abs(v162), abs(v163)
  v_max3_f32 v62, v62, abs(v164), abs(v165)
  ds_write2_b32 v73, v96, v97 offset0:8 offset1:9
  v_max3_f32 v62, v62, abs(v166), abs(v167)
  v_max3_f32 v62, v62, abs(v168), abs(v169)
  v_mfma_f32_32x32x16_bf16 v[140:155], v[132:135], v[116:119], 0
  v_mfma_f32_32x32x16_bf16 v[140:155], v[136:139], v[120:123], v[140:155]
  v_cvt_pk_bf16_f32 v100, v172, v173
  v_cvt_pk_bf16_f32 v101, v174, v175
  v_cvt_pk_bf16_f32 v102, v176, v177
  v_cvt_pk_bf16_f32 v103, v178, v179
  v_cvt_pk_bf16_f32 v104, v180, v181
  v_cvt_pk_bf16_f32 v105, v182, v183
  v_cvt_pk_bf16_f32 v106, v184, v185
  v_cvt_pk_bf16_f32 v107, v186, v187
  ds_write2_b32 v74, v100, v101 offset0:0 offset1:1
  v_max3_f32 v62, v62, abs(v172), abs(v173)
  v_max3_f32 v62, v62, abs(v174), abs(v175)
  v_max3_f32 v62, v62, abs(v176), abs(v177)
  ds_write2_b32 v74, v102, v103 offset0:4 offset1:5
  v_max3_f32 v62, v62, abs(v178), abs(v179)
  v_max3_f32 v62, v62, abs(v180), abs(v181)
  ds_write2_b32 v74, v104, v105 offset0:8 offset1:9
  v_max3_f32 v62, v62, abs(v182), abs(v183)
  v_max3_f32 v62, v62, abs(v184), abs(v185)
  v_mfma_f32_32x32x16_bf16 v[156:171], v[132:135], v[124:127], 0
  v_mfma_f32_32x32x16_bf16 v[156:171], v[136:139], v[128:131], v[156:171]
  v_cvt_pk_bf16_f32 v108, v188, v189
  v_cvt_pk_bf16_f32 v109, v190, v191
  v_cvt_pk_bf16_f32 v110, v192, v193
  v_cvt_pk_bf16_f32 v111, v194, v195
  v_cvt_pk_bf16_f32 v112, v196, v197
  v_cvt_pk_bf16_f32 v113, v198, v199
  v_cvt_pk_bf16_f32 v114, v200, v201
  v_cvt_pk_bf16_f32 v115, v202, v203
  ds_write2_b32 v75, v108, v109 offset0:0 offset1:1
  v_max3_f32 v62, v62, abs(v188), abs(v189)
  v_max3_f32 v62, v62, abs(v190), abs(v191)
  v_max3_f32 v62, v62, abs(v192), abs(v193)
  ds_write2_b32 v75, v110, v111 offset0:4 offset1:5
  v_max3_f32 v62, v62, abs(v194), abs(v195)
  v_max3_f32 v62, v62, abs(v196), abs(v197)
  ds_write2_b32 v75, v112, v113 offset0:8 offset1:9
  v_max3_f32 v62, v62, abs(v198), abs(v199)
  v_max3_f32 v62, v62, abs(v200), abs(v201)
  v_cvt_pk_bf16_f32 v116, v140, v141
  v_cvt_pk_bf16_f32 v117, v142, v143
  v_cvt_pk_bf16_f32 v118, v144, v145
  v_cvt_pk_bf16_f32 v119, v146, v147
  v_cvt_pk_bf16_f32 v120, v148, v149
  v_cvt_pk_bf16_f32 v121, v150, v151
  v_cvt_pk_bf16_f32 v122, v152, v153
  v_cvt_pk_bf16_f32 v123, v154, v155
  ds_write2_b32 v76, v116, v117 offset0:0 offset1:1
  v_max3_f32 v62, v62, abs(v140), abs(v141)
  v_max3_f32 v62, v62, abs(v142), abs(v143)
  v_max3_f32 v62, v62, abs(v144), abs(v145)
  ds_write2_b32 v76, v118, v119 offset0:4 offset1:5
  v_max3_f32 v62, v62, abs(v146), abs(v147)
  v_max3_f32 v62, v62, abs(v148), abs(v149)
  ds_write2_b32 v76, v120, v121 offset0:8 offset1:9
  v_max3_f32 v62, v62, abs(v150), abs(v151)
  v_max3_f32 v62, v62, abs(v152), abs(v153)
  v_cvt_pk_bf16_f32 v124, v156, v157
  v_cvt_pk_bf16_f32 v125, v158, v159
  v_cvt_pk_bf16_f32 v126, v160, v161
  v_cvt_pk_bf16_f32 v127, v162, v163
  v_cvt_pk_bf16_f32 v128, v164, v165
  v_cvt_pk_bf16_f32 v129, v166, v167
  v_cvt_pk_bf16_f32 v130, v168, v169
  v_cvt_pk_bf16_f32 v131, v170, v171
  s_mov_b64 exec, s[92:93]
  ds_write2_b32 v77, v124, v125 offset0:0 offset1:1
  v_max3_f32 v62, v62, abs(v156), abs(v157)
  v_max3_f32 v62, v62, abs(v158), abs(v159)
  v_max3_f32 v62, v62, abs(v160), abs(v161)
  ds_write2_b32 v77, v126, v127 offset0:4 offset1:5
  v_max3_f32 v62, v62, abs(v162), abs(v163)
  v_max3_f32 v62, v62, abs(v164), abs(v165)
  ds_write2_b32 v77, v128, v129 offset0:8 offset1:9
  v_max3_f32 v62, v62, abs(v166), abs(v167)
  v_max3_f32 v62, v62, abs(v168), abs(v169)
  s_mov_b32 exec_hi, 0
  ds_write_b32 v77, v130 offset:48
  ds_write_b16 v245, v131 offset:1280
  s_mov_b32 exec_lo, -1
  ds_write_b32 v76, v122 offset:48
  ds_write_b16 v245, v123 offset:1024
  ds_write_b32 v75, v114 offset:48
  ds_write_b16 v245, v115 offset:768
  ds_write_b32 v74, v106 offset:48
  ds_write_b16 v245, v107 offset:512
  ds_write_b32 v73, v98 offset:48
  ds_write_b16 v245, v99 offset:256
  ds_write_b32 v72, v90 offset:48
  ds_write_b16 v245, v91 offset:0
  s_mov_b64 exec, -1
  v_max_u32_dpp v62, v62, v62 row_shr:1 row_mask:0xf bank_mask:0xf
  s_nop 1
  v_max_u32_dpp v62, v62, v62 row_shr:2 row_mask:0xf bank_mask:0xf
  s_nop 1
  v_max_u32_dpp v62, v62, v62 row_shr:4 row_mask:0xf bank_mask:0xf
  s_nop 1
  v_max_u32_dpp v62, v62, v62 row_shr:8 row_mask:0xf bank_mask:0xf
  s_nop 1
  v_max_u32_dpp v62, v62, v62 row_bcast:15 row_mask:0xa bank_mask:0xf
  s_nop 1
  v_max_u32_dpp v62, v62, v62 row_bcast:31 row_mask:0xc bank_mask:0xf
  s_nop 0
  v_readlane_b32 s68, v62, 63
  s_nop 1
  v_mov_b32 v62, s68
  ds_max_u32 v1, v62 offset:28
  ds_add_u32 v1, v3 offset:24
  s_setprio 0
  v_lshl_add_u32 v24, v24, 7, v18
  v_lshl_add_u32 v25, v25, 7, v18
  s_mov_b32 exec_hi, 0x0000ffff
  v_lshl_add_u32 v26, v26, 7, v18
  v_lshl_add_u32 v27, v27, 7, v18
  s_mov_b32 exec_lo, 0
  s_mov_b32 exec_hi, 0xffff0000
  v_mov_b32 v27, v25
  v_mov_b32 v26, v25
  s_mov_b32 exec_hi, 0x00ff0000
  v_mov_b32 v26, v24
  s_mov_b64 exec, -1
  s_add_u32 m0, s74, 0
  s_nop 0
  buffer_load_dwordx4 v24, s[32:35], 0 offen lds
  s_add_u32 m0, s74, 1056
  s_nop 0
  buffer_load_dwordx4 v25, s[32:35], 0 offen lds
  s_add_u32 m0, s74, 2112
  s_nop 0
  buffer_load_dwordx4 v26, s[32:35], 0 offen lds
  s_add_u32 m0, s74, 3168
  s_mov_b32 exec_hi, 0x00ffffff
  buffer_load_dwordx4 v27, s[32:35], 0 offen lds
  s_mov_b32 exec_hi, -1
  v_lshl_add_u32 v204, v204, 7, v18
  v_lshl_add_u32 v205, v205, 7, v18
  s_mov_b32 exec_hi, 0x0000ffff
  v_lshl_add_u32 v206, v206, 7, v18
  v_lshl_add_u32 v207, v207, 7, v18
  s_mov_b32 exec_lo, 0
  s_mov_b32 exec_hi, 0xffff0000
  v_mov_b32 v207, v205
  v_mov_b32 v206, v205
  s_mov_b32 exec_hi, 0x00ff0000
  v_mov_b32 v206, v204
  s_mov_b64 exec, -1
  s_add_u32 m0, s74, -16896
  s_nop 0
  buffer_load_dwordx4 v204, s[32:35], 0 offen lds
  s_add_u32 m0, s74, -15840
  s_nop 0
  buffer_load_dwordx4 v205, s[32:35], 0 offen lds
  s_add_u32 m0, s74, -14784
  s_nop 0
  buffer_load_dwordx4 v206, s[32:35], 0 offen lds
  s_add_u32 m0, s74, -13728
  s_mov_b32 exec_hi, 0x00ffffff
  buffer_load_dwordx4 v207, s[32:35], 0 offen lds
  s_mov_b32 exec_hi, -1
  buffer_load_dwordx4 v[24:27], v17, s[28:31], s94 offen offset:0
  s_add_u32 s94, s94, 832
  s_branch L_uph
L_g0pf:
  s_waitcnt vmcnt(4) lgkmcnt(0)
  ds_add_u32 v1, v3 offset:0
  s_add_u32 m0, s95, 52672
  s_add_u32 s81, s95, 51536
  buffer_load_dwordx4 v48, s[36:39], s81 offen lds
  s_add_u32 m0, s95, 56768
  s_add_u32 s81, s95, 55632
  buffer_load_dwordx4 v48, s[36:39], s81 offen lds
  s_add_u32 m0, s95, 60864
  s_add_u32 s81, s95, 59728
  buffer_load_dwordx4 v48, s[36:39], s81 offen lds
  s_add_u32 m0, s95, 64960
  s_add_u32 s81, s95, 63824
  buffer_load_dwordx4 v48, s[36:39], s81 offen lds
  s_add_u32 m0, s96, 36288
  s_add_u32 s81, s96, 35152
  s_mov_b64 exec, s[82:83]
  buffer_load_dwordx4 v48, s[36:39], s81 offen lds
  s_mov_b64 exec, -1
  s_add_u32 m0, s95, 1024
  s_add_u32 s81, s95, 0
  buffer_load_dwordx4 v48, s[36:39], s81 offen lds
  s_add_u32 m0, s95, 5120
  s_add_u32 s81, s95, 4096
  buffer_load_dwordx4 v48, s[36:39], s81 offen lds
  s_add_u32 m0, s95, 9216
  s_add_u32 s81, s95, 8192
  buffer_load_dwordx4 v48, s[36:39], s81 offen lds
  s_add_u32 m0, s95, 13312
  s_add_u32 s81, s95, 12288
  buffer_load_dwordx4 v48, s[36:39], s81 offen lds
  s_waitcnt vmcnt(4) lgkmcnt(0)
  ds_add_u32 v1, v3 offset:4
  s_add_u32 m0, s95, 17408
  s_add_u32 s81, s95, 16384
  buffer_load_dwordx4 v48, s[36:39], s81 offen lds
  s_add_u32 m0, s95, 21504
  s_add_u32 s81, s95, 20480
  buffer_load_dwordx4 v48, s[36:39], s81 offen lds
  s_add_u32 m0, s95, 25600
  s_add_u32 s81, s95, 24576
  buffer_load_dwordx4 v48, s[36:39], s81 offen lds
  s_add_u32 m0, s95, 29696
  s_add_u32 s81, s95, 28672
  buffer_load_dwordx4 v48, s[36:39], s81 offen lds
  s_add_u32 m0, s96, 1024
  s_add_u32 s81, s96, 0
  s_mov_b64 exec, s[82:83]
  buffer_load_dwordx4 v48, s[36:39], s81 offen lds
  s_mov_b64 exec, -1
  s_add_u32 s94, s94, 832
  s_add_u32 s77, s77, 24
  buffer_load_dwordx4 v[24:27], v17, s[28:31], s94 offen offset:0
  s_add_u32 s94, s94, 832
  buffer_load_dword v21, v20, s[28:31], s77 offen
  s_cmp_eq_u32 s77, s73
  s_cselect_b32 s73, 0x7000000, s73
  s_cselect_b32 s77, 0x7000000, s77
  s_add_u32 s77, s77, 24
  s_min_u32 s77, s77, s73
  s_mov_b64 exec, 131071
  buffer_load_dword v255, v19, s[44:47], s101 offen
  s_mov_b64 exec, -1
  s_add_u32 s101, s101, 1171456
  s_waitcnt vmcnt(3) lgkmcnt(0)
  ds_add_u32 v1, v3 offset:8
  s_mov_b32 s97, 0
L_csync4:
  ds_read_b32 v4, v2 offset:8
  s_waitcnt lgkmcnt(0)
  v_cmp_gt_u32 vcc, 4, v4
  s_cbranch_vccnz L_csync4
  s_cmp_ge_u32 s79, 2
  s_cbranch_scc1 L_chunk2
L_chunk0:
  ds_read_u16_d16_hi v216, v49 offset:0
  ds_read_u16_d16_hi v218, v49 offset:648
  ds_read_u16_d16_hi v220, v49 offset:216
  ds_read_u16_d16_hi v222, v49 offset:864
  ds_read_u16_d16_hi v224, v49 offset:432
  ds_read_u16_d16_hi v226, v49 offset:1080
  ds_read_u16_d16_hi v228, v49 offset:8
  ds_read_u16_d16_hi v229, v49 offset:208
  ds_read_u16_d16_hi v230, v49 offset:656
  ds_read_u16_d16_hi v231, v49 offset:856
  s_waitcnt lgkmcnt(8)
  v_mov_b32 v85, v218
  v_mov_b32 v84, v216
  v_max3_f32 v62, v62, abs(v84), abs(v85)
  ds_read_u16_d16_hi v232, v49 offset:32
  ds_read_u16_d16_hi v233, v49 offset:832
  ds_read_u16_d16_hi v234, v49 offset:632
  ds_read_u16_d16_hi v235, v49 offset:232
  s_waitcnt lgkmcnt(10)
  v_mov_b32 v87, v222
  v_mov_b32 v86, v220
  v_max3_f32 v62, v62, abs(v86), abs(v87)
  ds_read_u16_d16_hi v236, v49 offset:16
  ds_read_u16_d16_hi v237, v49 offset:416
  ds_read_u16_d16_hi v238, v49 offset:664
  ds_read_u16_d16_hi v239, v49 offset:1064
  s_waitcnt lgkmcnt(12)
  v_mov_b32 v89, v226
  v_mov_b32 v88, v224
  v_max3_f32 v62, v62, abs(v88), abs(v89)
  ds_read_u16_d16_hi v216, v49 offset:40
  ds_read_u16_d16_hi v217, v49 offset:1040
  ds_read_u16_d16_hi v218, v49 offset:640
  ds_read_u16_d16_hi v219, v49 offset:440
  s_waitcnt lgkmcnt(12)
  v_add_f32 v91, v230, v231
  v_add_f32 v90, v228, v229
  v_max3_f32 v62, v62, abs(v90), abs(v91)
  ds_read_u16_d16_hi v220, v49 offset:224
  ds_read_u16_d16_hi v221, v49 offset:424
  ds_read_u16_d16_hi v222, v49 offset:872
  ds_read_u16_d16_hi v223, v49 offset:1072
  s_waitcnt lgkmcnt(12)
  v_add_f32 v93, v234, v235
  v_add_f32 v92, v232, v233
  v_max3_f32 v62, v62, abs(v92), abs(v93)
  ds_read_u16_d16_hi v224, v49 offset:248
  ds_read_u16_d16_hi v225, v49 offset:1048
  ds_read_u16_d16_hi v226, v49 offset:848
  ds_read_u16_d16_hi v227, v49 offset:448
  s_waitcnt lgkmcnt(12)
  v_add_f32 v95, v238, v239
  v_add_f32 v94, v236, v237
  v_max3_f32 v62, v62, abs(v94), abs(v95)
  ds_read_u16_d16_hi v228, v50 offset:48
  ds_read_u16_d16_hi v229, v51 offset:1248
  ds_read_u16_d16_hi v230, v50 offset:672
  ds_read_u16_d16_hi v231, v51 offset:1272
  s_waitcnt lgkmcnt(12)
  v_add_f32 v97, v218, v219
  v_add_f32 v96, v216, v217
  v_max3_f32 v62, v62, abs(v96), abs(v97)
  ds_read_u16_d16_hi v232, v50 offset:256
  ds_read_u16_d16_hi v233, v51 offset:1256
  ds_read_u16_d16_hi v234, v50 offset:880
  ds_read_u16_d16_hi v235, v51 offset:1280
  s_waitcnt lgkmcnt(12)
  v_add_f32 v99, v222, v223
  v_add_f32 v98, v220, v221
  v_max3_f32 v62, v62, abs(v98), abs(v99)
  ds_read_u16_d16_hi v236, v50 offset:464
  ds_read_u16_d16_hi v237, v51 offset:1264
  ds_read_u16_d16_hi v238, v50 offset:1088
  ds_read_u16_d16_hi v239, v51 offset:1288
  s_waitcnt lgkmcnt(12)
  v_add_f32 v101, v226, v227
  v_add_f32 v100, v224, v225
  v_max3_f32 v62, v62, abs(v100), abs(v101)
  s_waitcnt lgkmcnt(8)
  v_add_f32 v103, v230, v231
  v_add_f32 v102, v228, v229
  v_max3_f32 v62, v62, abs(v102), abs(v103)
  s_waitcnt lgkmcnt(4)
  v_add_f32 v105, v234, v235
  v_add_f32 v104, v232, v233
  v_max3_f32 v62, v62, abs(v104), abs(v105)
  s_waitcnt lgkmcnt(0)
  v_add_f32 v107, v238, v239
  v_add_f32 v106, v236, v237
  v_max3_f32 v62, v62, abs(v106), abs(v107)
  s_cmp_lg_u32 s97, 0
  s_cbranch_scc1 L_uconv0
L_chunk1:
  ds_read_u16_d16_hi v216, v49 offset:24
  ds_read_u16_d16_hi v217, v49 offset:624
  ds_read_u16_d16_hi v218, v49 offset:240
  ds_read_u16_d16_hi v219, v49 offset:840
  ds_read_u16_d16_hi v220, v49 offset:456
  ds_read_u16_d16_hi v221, v49 offset:1056
  ds_read_u16_d16_hi v222, v60 offset:1296
  ds_read_u16_d16_hi v223, v61 offset:1296
  ds_read_u16_d16_hi v224, v52 offset:50
  ds_read_u16_d16_hi v225, v53 offset:1300
  ds_read_u16_d16_hi v226, v52 offset:674
  ds_read_u16_d16_hi v227, v53 offset:1324
  ds_read_u16_d16_hi v228, v52 offset:258
  ds_read_u16_d16_hi v229, v53 offset:1308
  ds_read_u16_d16_hi v230, v52 offset:882
  ds_read_u16_d16_hi v231, v53 offset:1332
  s_waitcnt lgkmcnt(12)
  v_add_f32 v109, v218, v219
  v_add_f32 v108, v216, v217
  v_max3_f32 v62, v62, abs(v108), abs(v109)
  ds_read_u16_d16_hi v232, v52 offset:466
  ds_read_u16_d16_hi v233, v53 offset:1316
  ds_read_u16_d16_hi v234, v52 offset:1090
  ds_read_u16_d16_hi v235, v53 offset:1340
  s_waitcnt lgkmcnt(12)
  v_add_f32 v111, v222, v223
  v_add_f32 v110, v220, v221
  v_max3_f32 v62, v62, abs(v110), abs(v111)
  ds_read_u16_d16_hi v236, v54 offset:2
  ds_read_u16_d16_hi v237, v55 offset:52
  ds_read_u16_d16_hi v238, v54 offset:650
  ds_read_u16_d16_hi v239, v55 offset:700
  s_waitcnt lgkmcnt(12)
  v_add_f32 v113, v226, v227
  v_add_f32 v112, v224, v225
  v_max3_f32 v62, v62, abs(v112), abs(v113)
  ds_read_u16_d16_hi v216, v54 offset:26
  ds_read_u16_d16_hi v217, v55 offset:676
  ds_read_u16_d16_hi v218, v54 offset:626
  ds_read_u16_d16_hi v219, v55 offset:76
  s_waitcnt lgkmcnt(12)
  v_add_f32 v115, v230, v231
  v_add_f32 v114, v228, v229
  v_max3_f32 v62, v62, abs(v114), abs(v115)
  ds_read_u16_d16_hi v220, v54 offset:10
  ds_read_u16_d16_hi v221, v55 offset:260
  ds_read_u16_d16_hi v222, v54 offset:658
  ds_read_u16_d16_hi v223, v55 offset:908
  s_waitcnt lgkmcnt(12)
  v_add_f32 v117, v234, v235
  v_add_f32 v116, v232, v233
  v_max3_f32 v62, v62, abs(v116), abs(v117)
  ds_read_u16_d16_hi v224, v54 offset:34
  ds_read_u16_d16_hi v225, v55 offset:884
  ds_read_u16_d16_hi v226, v54 offset:634
  ds_read_u16_d16_hi v227, v55 offset:284
  s_waitcnt lgkmcnt(12)
  v_add_f32 v119, v238, v239
  v_add_f32 v118, v236, v237
  v_max3_f32 v62, v62, abs(v118), abs(v119)
  ds_read_u16_d16_hi v228, v54 offset:18
  ds_read_u16_d16_hi v229, v55 offset:468
  ds_read_u16_d16_hi v230, v54 offset:666
  ds_read_u16_d16_hi v231, v55 offset:1116
  s_waitcnt lgkmcnt(12)
  v_add_f32 v121, v218, v219
  v_add_f32 v120, v216, v217
  v_max3_f32 v62, v62, abs(v120), abs(v121)
  ds_read_u16_d16_hi v232, v54 offset:42
  ds_read_u16_d16_hi v233, v55 offset:1092
  ds_read_u16_d16_hi v234, v54 offset:642
  ds_read_u16_d16_hi v235, v55 offset:492
  s_waitcnt lgkmcnt(12)
  v_add_f32 v123, v222, v223
  v_add_f32 v122, v220, v221
  v_max3_f32 v62, v62, abs(v122), abs(v123)
  ds_read_u16_d16_hi v236, v54 offset:210
  ds_read_u16_d16_hi v237, v55 offset:60
  ds_read_u16_d16_hi v238, v54 offset:858
  ds_read_u16_d16_hi v239, v55 offset:708
  s_waitcnt lgkmcnt(12)
  v_add_f32 v125, v226, v227
  v_add_f32 v124, v224, v225
  v_max3_f32 v62, v62, abs(v124), abs(v125)
  s_waitcnt lgkmcnt(8)
  v_add_f32 v127, v230, v231
  v_add_f32 v126, v228, v229
  v_max3_f32 v62, v62, abs(v126), abs(v127)
  s_waitcnt lgkmcnt(4)
  v_add_f32 v129, v234, v235
  v_add_f32 v128, v232, v233
  v_max3_f32 v62, v62, abs(v128), abs(v129)
  s_waitcnt lgkmcnt(0)
  v_add_f32 v131, v238, v239
  v_add_f32 v130, v236, v237
  v_max3_f32 v62, v62, abs(v130), abs(v131)
  s_cmp_lg_u32 s97, 0
  s_cbranch_scc1 L_uconv1
  s_branch L_w1conv
L_chunk2:
  ds_read_u16_d16_hi v216, v54 offset:234
  ds_read_u16_d16_hi v217, v55 offset:684
  ds_read_u16_d16_hi v218, v54 offset:834
  ds_read_u16_d16_hi v219, v55 offset:84
  ds_read_u16_d16_hi v220, v54 offset:218
  ds_read_u16_d16_hi v221, v55 offset:268
  ds_read_u16_d16_hi v222, v54 offset:866
  ds_read_u16_d16_hi v223, v55 offset:916
  ds_read_u16_d16_hi v224, v54 offset:242
  ds_read_u16_d16_hi v225, v55 offset:892
  ds_read_u16_d16_hi v226, v54 offset:842
  ds_read_u16_d16_hi v227, v55 offset:292
  ds_read_u16_d16_hi v228, v54 offset:226
  ds_read_u16_d16_hi v229, v55 offset:476
  ds_read_u16_d16_hi v230, v54 offset:874
  ds_read_u16_d16_hi v231, v55 offset:1124
  s_waitcnt lgkmcnt(12)
  v_add_f32 v85, v218, v219
  v_add_f32 v84, v216, v217
  v_max3_f32 v62, v62, abs(v84), abs(v85)
  ds_read_u16_d16_hi v232, v54 offset:250
  ds_read_u16_d16_hi v233, v55 offset:1100
  ds_read_u16_d16_hi v234, v54 offset:850
  ds_read_u16_d16_hi v235, v55 offset:500
  s_waitcnt lgkmcnt(12)
  v_add_f32 v87, v222, v223
  v_add_f32 v86, v220, v221
  v_max3_f32 v62, v62, abs(v86), abs(v87)
  ds_read_u16_d16_hi v236, v54 offset:418
  ds_read_u16_d16_hi v237, v55 offset:68
  ds_read_u16_d16_hi v238, v54 offset:1066
  ds_read_u16_d16_hi v239, v55 offset:716
  s_waitcnt lgkmcnt(12)
  v_add_f32 v89, v226, v227
  v_add_f32 v88, v224, v225
  v_max3_f32 v62, v62, abs(v88), abs(v89)
  ds_read_u16_d16_hi v216, v54 offset:442
  ds_read_u16_d16_hi v217, v55 offset:692
  ds_read_u16_d16_hi v218, v54 offset:1042
  ds_read_u16_d16_hi v219, v55 offset:92
  s_waitcnt lgkmcnt(12)
  v_add_f32 v91, v230, v231
  v_add_f32 v90, v228, v229
  v_max3_f32 v62, v62, abs(v90), abs(v91)
  ds_read_u16_d16_hi v220, v54 offset:426
  ds_read_u16_d16_hi v221, v55 offset:276
  ds_read_u16_d16_hi v222, v54 offset:1074
  ds_read_u16_d16_hi v223, v55 offset:924
  s_waitcnt lgkmcnt(12)
  v_add_f32 v93, v234, v235
  v_add_f32 v92, v232, v233
  v_max3_f32 v62, v62, abs(v92), abs(v93)
  ds_read_u16_d16_hi v224, v54 offset:450
  ds_read_u16_d16_hi v225, v55 offset:900
  ds_read_u16_d16_hi v226, v54 offset:1050
  ds_read_u16_d16_hi v227, v55 offset:300
  s_waitcnt lgkmcnt(12)
  v_add_f32 v95, v238, v239
  v_add_f32 v94, v236, v237
  v_max3_f32 v62, v62, abs(v94), abs(v95)
  ds_read_u16_d16_hi v228, v54 offset:434
  ds_read_u16_d16_hi v229, v55 offset:484
  ds_read_u16_d16_hi v230, v54 offset:1082
  ds_read_u16_d16_hi v231, v55 offset:1132
  s_waitcnt lgkmcnt(12)
  v_add_f32 v97, v218, v219
  v_add_f32 v96, v216, v217
  v_max3_f32 v62, v62, abs(v96), abs(v97)
  ds_read_u16_d16_hi v232, v54 offset:458
  ds_read_u16_d16_hi v233, v55 offset:1108
  ds_read_u16_d16_hi v234, v54 offset:1058
  ds_read_u16_d16_hi v235, v55 offset:508
  s_waitcnt lgkmcnt(12)
  v_add_f32 v99, v222, v223
  v_add_f32 v98, v220, v221
  v_max3_f32 v62, v62, abs(v98), abs(v99)
  ds_read_u16_d16_hi v236, v56 offset:4
  ds_read_u16_d16_hi v237, v57 offset:104
  ds_read_u16_d16_hi v238, v58 offset:652
  ds_read_u16_d16_hi v239, v59 offset:752
  s_waitcnt lgkmcnt(12)
  v_add_f32 v101, v226, v227
  v_add_f32 v100, v224, v225
  v_max3_f32 v62, v62, abs(v100), abs(v101)
  s_waitcnt lgkmcnt(8)
  v_add_f32 v103, v230, v231
  v_add_f32 v102, v228, v229
  v_max3_f32 v62, v62, abs(v102), abs(v103)
  s_waitcnt lgkmcnt(4)
  v_add_f32 v105, v234, v235
  v_add_f32 v104, v232, v233
  v_max3_f32 v62, v62, abs(v104), abs(v105)
  s_waitcnt lgkmcnt(0)
  v_add_f32 v107, v238, v239
  v_add_f32 v106, v236, v237
  v_max3_f32 v62, v62, abs(v106), abs(v107)
  s_cmp_lg_u32 s97, 0
  s_cbranch_scc1 L_uconv0
L_chunk3:
  ds_read_u16_d16_hi v216, v56 offset:220
  ds_read_u16_d16_hi v217, v57 offset:320
  ds_read_u16_d16_hi v218, v58 offset:868
  ds_read_u16_d16_hi v219, v59 offset:968
  ds_read_u16_d16_hi v220, v56 offset:436
  ds_read_u16_d16_hi v221, v57 offset:536
  ds_read_u16_d16_hi v222, v58 offset:1084
  ds_read_u16_d16_hi v223, v59 offset:1184
  ds_read_u16_d16_hi v224, v56 offset:12
  ds_read_u16_d16_hi v225, v57 offset:312
  ds_read_u16_d16_hi v226, v58 offset:660
  ds_read_u16_d16_hi v227, v59 offset:960
  ds_read_u16_d16_hi v228, v58 offset:36
  ds_read_u16_d16_hi v229, v59 offset:936
  ds_read_u16_d16_hi v230, v56 offset:636
  ds_read_u16_d16_hi v231, v57 offset:336
  s_waitcnt lgkmcnt(12)
  v_add_f32 v109, v218, v219
  v_add_f32 v108, v216, v217
  v_max3_f32 v62, v62, abs(v108), abs(v109)
  ds_read_u16_d16_hi v232, v56 offset:20
  ds_read_u16_d16_hi v233, v57 offset:520
  ds_read_u16_d16_hi v234, v58 offset:668
  ds_read_u16_d16_hi v235, v59 offset:1168
  s_waitcnt lgkmcnt(12)
  v_add_f32 v111, v222, v223
  v_add_f32 v110, v220, v221
  v_max3_f32 v62, v62, abs(v110), abs(v111)
  ds_read_u16_d16_hi v236, v58 offset:44
  ds_read_u16_d16_hi v237, v59 offset:1144
  ds_read_u16_d16_hi v238, v56 offset:644
  ds_read_u16_d16_hi v239, v57 offset:544
  s_waitcnt lgkmcnt(12)
  v_add_f32 v113, v226, v227
  v_add_f32 v112, v224, v225
  v_max3_f32 v62, v62, abs(v112), abs(v113)
  ds_read_u16_d16_hi v216, v56 offset:228
  ds_read_u16_d16_hi v217, v57 offset:528
  ds_read_u16_d16_hi v218, v58 offset:876
  ds_read_u16_d16_hi v219, v59 offset:1176
  s_waitcnt lgkmcnt(12)
  v_add_f32 v115, v230, v231
  v_add_f32 v114, v228, v229
  v_max3_f32 v62, v62, abs(v114), abs(v115)
  ds_read_u16_d16_hi v220, v58 offset:252
  ds_read_u16_d16_hi v221, v59 offset:1152
  ds_read_u16_d16_hi v222, v56 offset:852
  ds_read_u16_d16_hi v223, v57 offset:552
  s_waitcnt lgkmcnt(12)
  v_add_f32 v117, v234, v235
  v_add_f32 v116, v232, v233
  v_max3_f32 v62, v62, abs(v116), abs(v117)
  ds_read_u16_d16_hi v224, v65 offset:0
  ds_read_u16_d16_hi v225, v65 offset:8
  ds_read_u16_d16_hi v226, v65 offset:16
  ds_read_u16_d16_hi v227, v65 offset:24
  ds_read_u16_d16_hi v228, v65 offset:32
  ds_read_u16_d16_hi v229, v65 offset:40
  ds_read_u16_d16_hi v230, v64 offset:48
  ds_read_u16_d16_hi v231, v67
  s_waitcnt lgkmcnt(14)
  v_add_f32 v119, v238, v239
  v_add_f32 v118, v236, v237
  v_max3_f32 v62, v62, abs(v118), abs(v119)
  s_waitcnt lgkmcnt(12)
  v_add_f32 v121, v218, v219
  v_add_f32 v120, v216, v217
  v_max3_f32 v62, v62, abs(v120), abs(v121)
  s_waitcnt lgkmcnt(8)
  v_add_f32 v123, v222, v223
  v_add_f32 v122, v220, v221
  v_max3_f32 v62, v62, abs(v122), abs(v123)
  s_cmp_lg_u32 s97, 0
  s_cbranch_scc1 L_uconv1
L_w1conv:
  v_max_u32_dpp v62, v62, v62 row_shr:1 row_mask:0xf bank_mask:0xf
  s_nop 1
  v_max_u32_dpp v62, v62, v62 row_shr:2 row_mask:0xf bank_mask:0xf
  s_nop 1
  v_max_u32_dpp v62, v62, v62 row_shr:4 row_mask:0xf bank_mask:0xf
  s_nop 1
  v_max_u32_dpp v62, v62, v62 row_shr:8 row_mask:0xf bank_mask:0xf
  s_nop 1
  v_max_u32_dpp v62, v62, v62 row_bcast:15 row_mask:0xa bank_mask:0xf
  s_nop 1
  v_max_u32_dpp v62, v62, v62 row_bcast:31 row_mask:0xc bank_mask:0xf
  s_nop 0
  v_readlane_b32 s68, v62, 63
  s_nop 1
  v_mov_b32 v62, s68
  ds_max_u32 v1, v62 offset:20
  ds_add_u32 v1, v3 offset:16
  v_add_u32 v49, v49, v247
  v_add_u32 v50, v50, v247
  v_add_u32 v51, v51, v247
  v_add_u32 v52, v52, v247
  v_add_u32 v53, v53, v247
  v_add_u32 v54, v54, v247
  v_add_u32 v55, v55, v247
  v_add_u32 v56, v56, v247
  v_add_u32 v57, v57, v247
  v_add_u32 v58, v58, v247
  v_add_u32 v59, v59, v247
  v_add_u32 v60, v60, v247
  v_add_u32 v61, v61, v247
L_csync5:
  ds_read_b64 v[40:41], v2 offset:16
  s_waitcnt lgkmcnt(0)
  v_cmp_gt_u32 vcc, 4, v40
  s_cbranch_vccnz L_csync5
  v_readfirstlane_b32 s70, v41
  s_nop 0
  s_lshr_b32 s70, s70, 23
  s_sub_i32 s70, 141, s70
  s_min_i32 s70, s70, 40
  s_add_i32 s51, s70, 127
  s_lshl_b32 s51, s51, 23
  v_fma_mixlo_f16 v132, v84, s51, 0
  v_fma_mixlo_f16 v133, v86, s51, 0
  v_fma_mixlo_f16 v134, v88, s51, 0
  v_fma_mixlo_f16 v135, v90, s51, 0
  v_fma_mixhi_f16 v132, v85, s51, 0
  v_fma_mixhi_f16 v133, v87, s51, 0
  v_fma_mixhi_f16 v134, v89, s51, 0
  v_fma_mixhi_f16 v135, v91, s51, 0
  v_fma_mixlo_f16 v136, v92, s51, 0
  v_fma_mixlo_f16 v137, v94, s51, 0
  v_fma_mixlo_f16 v138, v96, s51, 0
  v_fma_mixlo_f16 v139, v98, s51, 0
  v_fma_mixhi_f16 v136, v93, s51, 0
  v_fma_mixhi_f16 v137, v95, s51, 0
  v_fma_mixhi_f16 v138, v97, s51, 0
  v_fma_mixhi_f16 v139, v99, s51, 0
  ds_write_b128 v63, v[132:135] offset:0
  v_fma_mixlo_f16 v140, v100, s51, 0
  v_fma_mixlo_f16 v141, v102, s51, 0
  v_fma_mixlo_f16 v142, v104, s51, 0
  v_fma_mixlo_f16 v143, v106, s51, 0
  v_fma_mixhi_f16 v140, v101, s51, 0
  v_fma_mixhi_f16 v141, v103, s51, 0
  v_fma_mixhi_f16 v142, v105, s51, 0
  v_fma_mixhi_f16 v143, v107, s51, 0
  ds_write_b128 v63, v[136:139] offset:1024
  v_fma_mixlo_f16 v144, v108, s51, 0
  v_fma_mixlo_f16 v145, v110, s51, 0
  v_fma_mixlo_f16 v146, v112, s51, 0
  v_fma_mixlo_f16 v147, v114, s51, 0
  v_fma_mixhi_f16 v144, v109, s51, 0
  v_fma_mixhi_f16 v145, v111, s51, 0
  v_fma_mixhi_f16 v146, v113, s51, 0
  v_fma_mixhi_f16 v147, v115, s51, 0
  ds_write_b128 v63, v[140:143] offset:2048
  v_fma_mixlo_f16 v148, v116, s51, 0
  v_fma_mixlo_f16 v149, v118, s51, 0
  v_fma_mixlo_f16 v150, v120, s51, 0
  v_fma_mixlo_f16 v151, v122, s51, 0
  v_fma_mixhi_f16 v148, v117, s51, 0
  v_fma_mixhi_f16 v149, v119, s51, 0
  v_fma_mixhi_f16 v150, v121, s51, 0
  v_fma_mixhi_f16 v151, v123, s51, 0
  ds_write_b128 v63, v[144:147] offset:3072
  ds_write_b128 v63, v[148:151] offset:4096
  s_cmp_ge_u32 s79, 2
  s_cbranch_scc1 L_w1x
  v_fma_mixlo_f16 v152, v124, s51, 0
  v_fma_mixlo_f16 v153, v126, s51, 0
  v_fma_mixlo_f16 v154, v128, s51, 0
  v_fma_mixlo_f16 v155, v130, s51, 0
  v_fma_mixhi_f16 v152, v125, s51, 0
  v_fma_mixhi_f16 v153, v127, s51, 0
  v_fma_mixhi_f16 v154, v129, s51, 0
  v_fma_mixhi_f16 v155, v131, s51, 0
  ds_write_b128 v63, v[152:155] offset:5120
L_w1x:
L_uph:
L_csync6:
  ds_read_b64 v[40:41], v2 offset:24
  s_waitcnt lgkmcnt(0)
  v_cmp_gt_u32 vcc, 4, v40
  s_cbranch_vccnz L_csync6
  v_readfirstlane_b32 s71, v41
  s_nop 0
  s_lshr_b32 s71, s71, 23
  s_sub_i32 s71, 140, s71
  s_min_i32 s71, s71, 40
  s_add_i32 s51, s71, 127
  s_lshl_b32 s51, s51, 23
  s_mov_b32 s97, 1
  s_lshr_b32 s69, s3, 1
  s_cmp_eq_u32 s69, 0
  s_cbranch_scc1 L_chunk0
  s_cmp_eq_u32 s69, 1
  s_cbranch_scc1 L_chunk1
  s_cmp_eq_u32 s69, 2
  s_cbranch_scc1 L_chunk2
  s_branch L_chunk3
L_uconv0:
  v_fma_mixlo_f16 v132, v84, s51, 0
  v_fma_mixlo_f16 v133, v86, s51, 0
  v_fma_mixlo_f16 v134, v88, s51, 0
  v_fma_mixlo_f16 v135, v90, s51, 0
  v_fma_mixhi_f16 v132, v85, s51, 0
  v_fma_mixhi_f16 v133, v87, s51, 0
  v_fma_mixhi_f16 v134, v89, s51, 0
  v_fma_mixhi_f16 v135, v91, s51, 0
L_csync7:
  ds_read_b64 v[40:41], v2 offset:16
  s_waitcnt lgkmcnt(0)
  v_cmp_gt_u32 vcc, 4, v40
  s_cbranch_vccnz L_csync7
  v_readfirstlane_b32 s70, v41
  s_nop 0
  s_lshr_b32 s70, s70, 23
  s_sub_i32 s70, 141, s70
  s_min_i32 s70, s70, 40
  ds_write_b128 v66, v[132:135] offset:0
  v_fma_mixlo_f16 v136, v92, s51, 0
  v_fma_mixlo_f16 v137, v94, s51, 0
  v_fma_mixlo_f16 v138, v96, s51, 0
  v_fma_mixlo_f16 v139, v98, s51, 0
  v_fma_mixhi_f16 v136, v93, s51, 0
  v_fma_mixhi_f16 v137, v95, s51, 0
  v_fma_mixhi_f16 v138, v97, s51, 0
  v_fma_mixhi_f16 v139, v99, s51, 0
  ds_write_b128 v66, v[136:139] offset:1024
  v_fma_mixlo_f16 v140, v100, s51, 0
  v_fma_mixlo_f16 v141, v102, s51, 0
  v_fma_mixlo_f16 v142, v104, s51, 0
  v_fma_mixlo_f16 v143, v106, s51, 0
  v_fma_mixhi_f16 v140, v101, s51, 0
  v_fma_mixhi_f16 v141, v103, s51, 0
  v_fma_mixhi_f16 v142, v105, s51, 0
  v_fma_mixhi_f16 v143, v107, s51, 0
  ds_write_b128 v66, v[140:143] offset:2048
  s_branch L_built
L_uconv1:
  v_fma_mixlo_f16 v144, v108, s51, 0
  v_fma_mixlo_f16 v145, v110, s51, 0
  v_fma_mixlo_f16 v146, v112, s51, 0
  v_fma_mixlo_f16 v147, v114, s51, 0
  v_fma_mixhi_f16 v144, v109, s51, 0
  v_fma_mixhi_f16 v145, v111, s51, 0
  v_fma_mixhi_f16 v146, v113, s51, 0
  v_fma_mixhi_f16 v147, v115, s51, 0
L_csync8:
  ds_read_b64 v[40:41], v2 offset:16
  s_waitcnt lgkmcnt(0)
  v_cmp_gt_u32 vcc, 4, v40
  s_cbranch_vccnz L_csync8
  v_readfirstlane_b32 s70, v41
  s_nop 0
  s_lshr_b32 s70, s70, 23
  s_sub_i32 s70, 141, s70
  s_min_i32 s70, s70, 40
  ds_write_b128 v66, v[144:147] offset:3072
  v_fma_mixlo_f16 v148, v116, s51, 0
  v_fma_mixlo_f16 v149, v118, s51, 0
  v_fma_mixlo_f16 v150, v120, s51, 0
  v_fma_mixlo_f16 v151, v122, s51, 0
  v_fma_mixhi_f16 v148, v117, s51, 0
  v_fma_mixhi_f16 v149, v119, s51, 0
  v_fma_mixhi_f16 v150, v121, s51, 0
  v_fma_mixhi_f16 v151, v123, s51, 0
  ds_write_b128 v66, v[148:151] offset:4096
  s_cmp_lg_u32 s84, 0
  s_cbranch_scc1 L_ulin
  v_fma_mixlo_f16 v152, v124, s51, 0
  v_fma_mixlo_f16 v153, v126, s51, 0
  v_fma_mixlo_f16 v154, v128, s51, 0
  v_fma_mixlo_f16 v155, v130, s51, 0
  v_fma_mixhi_f16 v152, v125, s51, 0
  v_fma_mixhi_f16 v153, v127, s51, 0
  v_fma_mixhi_f16 v154, v129, s51, 0
  v_fma_mixhi_f16 v155, v131, s51, 0
  ds_write_b128 v66, v[152:155] offset:5120
  s_branch L_built
L_ulin:
  v_mul_f32 v224, s51, v224
  v_mul_f32 v225, s51, v225
  v_mul_f32 v226, s51, v226
  v_mul_f32 v227, s51, v227
  v_mul_f32 v228, s51, v228
  v_mul_f32 v229, s51, v229
  v_mul_f32 v230, s51, v230
  v_mul_f32 v231, s51, v231
  v_cvt_pk_bf16_f32 v152, v224, v225
  v_cvt_pk_bf16_f32 v153, v226, v227
  v_cvt_pk_bf16_f32 v154, v228, v229
  v_cvt_pk_bf16_f32 v155, v230, v231
  ds_write_b128 v66, v[152:155] offset:5120
L_built:
  s_waitcnt vmcnt(1)
  v_mov_b32 v4, s84
  ds_add_u32 v1, v4 offset:36
  s_mov_b32 s60, s24
  s_and_b32 s61, s25, 0xffff
  s_mov_b32 s62, 268435456
  s_mov_b32 s63, 0x20000
  s_mov_b32 s64, s22
  s_and_b32 s65, s23, 0xffff
  s_mov_b32 s66, 256
  s_mov_b32 s67, 0x20000
  v_lshlrev_b32 v251, 2, v0
  s_mov_b64 exec, 0xff
  s_mov_b32 s81, 0x80000
  buffer_load_dword v255, v251, s[60:63], s81 offen
  buffer_load_dword v250, v251, s[64:67], 0 offen offset:128 sc1
  s_mov_b64 exec, -1
  v_mov_b32 v251, 0
  s_add_i32 s48, s70, s71
L_csync9:
  ds_read_b32 v4, v2 offset:36
  s_waitcnt lgkmcnt(0)
  v_cmp_gt_u32 vcc, 4, v4
  s_cbranch_vccnz L_csync9
  ds_read_u16_d16_hi v32, v7 offset:0
  ds_read_u16_d16_hi v33, v7 offset:128
  ds_read_u16_d16_hi v34, v7 offset:256
  ds_read_u16_d16_hi v35, v7 offset:384
  ds_read_u16_d16_hi v36, v7 offset:512
  ds_read_u16_d16_hi v37, v7 offset:640
  ds_read_u16_d16_hi v38, v7 offset:768
  ds_read_u16_d16_hi v39, v7 offset:896
  s_waitcnt lgkmcnt(0)
  v_cvt_pk_f16_f32 v43, v38, v39
  v_cvt_pk_f16_f32 v40, v32, v35
  v_cvt_pk_f16_f32 v41, v33, v36
  v_cvt_pk_f16_f32 v42, v34, v37
  ds_write_b128 v10, v[40:43]
  ds_read_b64_tr_b16 v[52:53], v8 offset:0
  ds_read_b64_tr_b16 v[54:55], v8 offset:512
  v_pk_mul_f16 v56, v40, v40 op_sel:[0,0] op_sel_hi:[1,1]
  v_pk_mul_f16 v57, v41, v41 op_sel:[0,0] op_sel_hi:[1,1]
  v_pk_mul_f16 v58, v42, v42 op_sel:[0,0] op_sel_hi:[1,1]
  v_pk_mul_f16 v59, v40, v41 op_sel:[0,0] op_sel_hi:[1,1]
  ds_read_b128 v[44:47], v11
  ds_read_b128 v[48:51], v12
  v_pk_mul_f16 v60, v40, v41 op_sel:[0,1] op_sel_hi:[1,0]
  v_pk_mul_f16 v61, v40, v42 op_sel:[0,0] op_sel_hi:[1,1]
  s_waitcnt vmcnt(3)
  v_lshlrev_b32 v21, 7, v21
  buffer_load_dword v255, v21, s[32:35], 0 offen
  s_mov_b64 exec, 131071
  buffer_load_dword v255, v19, s[44:47], s101 offen
  s_mov_b64 exec, -1
  s_add_u32 s101, s101, 1171456
  s_waitcnt lgkmcnt(0)
  s_barrier
  s_setprio 1
  ds_read_b128 v[216:219], v22
  ds_read_b128 v[240:243], v28 offset:46528
  ds_read_b128 v[128:131], v28 offset:35264
  ds_read_b128 v[84:87], v28 offset:0
  ds_read_b128 v[244:247], v30 offset:22528
  ds_read_b128 v[172:175], v31 offset:11264
  ds_read_b128 v[176:179], v31 offset:12288
  ds_read_b128 v[180:183], v31 offset:13312
  ds_read2_b32 v[220:221], v29 offset0:0 offset1:2
  ds_read2_b32 v[222:223], v29 offset0:64 offset1:66
  v_add_u32 v29, 2048, v29
  ds_read_b128 v[88:91], v28 offset:1024
  s_cmp_lg_u32 s84, 0
  s_cbranch_scc1 L_prf
  s_setprio 2
L_prf:
  s_waitcnt lgkmcnt(10)
  v_mfma_f32_16x16x32_f16 v[80:83], v[216:219], v[56:59], 0
  ds_read_b128 v[92:95], v28 offset:2048
  s_waitcnt lgkmcnt(10)
  v_mfma_f32_16x16x32_bf16 v[72:75], v[240:243], v[52:55], 0
  ds_read_b128 v[132:135], v28 offset:36288
  v_pk_mul_f16 v62, v40, v42 op_sel:[0,1] op_sel_hi:[1,0]
  v_pk_mul_f16 v63, v41, v42 op_sel:[0,0] op_sel_hi:[1,1]
  s_waitcnt lgkmcnt(10)
  v_mfma_f32_16x16x32_f16 v[72:75], v[128:131], v[56:59], v[72:75]
  ds_read_b128 v[136:139], v28 offset:37312
  s_waitcnt lgkmcnt(10)
  v_mfma_f32_16x16x32_f16 v[68:71], v[84:87], v[56:59], 0
  ds_read_b128 v[140:143], v28 offset:38336
  v_pk_mul_f16 v64, v41, v42 op_sel:[0,1] op_sel_hi:[1,0]
  s_waitcnt lgkmcnt(10)
  v_mfma_f32_16x16x32_bf16 v[76:79], v[244:247], v[52:55], 0
  ds_read_b128 v[144:147], v28 offset:39360
  v_pk_mul_f16 v65, v40, v43 op_sel:[0,0] op_sel_hi:[1,0]
  v_pk_mul_f16 v66, v41, v43 op_sel:[0,0] op_sel_hi:[1,0]
  s_waitcnt lgkmcnt(10)
  v_mfma_f32_16x16x32_f16 v[76:79], v[172:175], v[56:59], v[76:79]
  ds_read2_b32 v[224:225], v29 offset0:0 offset1:2
  ds_read2_b32 v[226:227], v29 offset0:64 offset1:66
  v_add_u32 v29, 2048, v29
  v_pk_mul_f16 v67, v42, v43 op_sel:[0,0] op_sel_hi:[1,0]
  s_waitcnt lgkmcnt(11)
  v_mfma_f32_16x16x32_f16 v[76:79], v[176:179], v[60:63], v[76:79]
  ds_read_b128 v[96:99], v28 offset:3072
  v_mul_f16_sdwa v52, v40, v40 dst_sel:WORD_0 dst_unused:UNUSED_PAD src0_sel:WORD_0 src1_sel:WORD_1
  v_mul_f16_sdwa v53, v42, v42 dst_sel:WORD_0 dst_unused:UNUSED_PAD src0_sel:WORD_0 src1_sel:WORD_1
  s_waitcnt lgkmcnt(11)
  v_mfma_f32_16x16x32_f16 v[76:79], v[180:183], v[64:67], v[76:79]
  ds_read_b128 v[100:103], v28 offset:4096
  v_alignbit_b32 v48, v48, v48, v13
  s_waitcnt lgkmcnt(10)
  v_smfmac_f32_16x16x64_f16 v[80:83], v[220:223], v[60:67], v16
  ds_read_b128 v[184:187], v31 offset:14336
  v_mul_f16_sdwa v52, v41, v41 dst_sel:WORD_1 dst_unused:UNUSED_PRESERVE src0_sel:WORD_0 src1_sel:WORD_1
  v_mul_f16_sdwa v53, v43, v43 dst_sel:WORD_1 dst_unused:UNUSED_PRESERVE src0_sel:WORD_0 src1_sel:WORD_1
  s_waitcnt lgkmcnt(10)
  v_mfma_f32_16x16x32_f16 v[68:71], v[88:91], v[60:63], v[68:71]
  ds_read_b128 v[188:191], v31 offset:15360
  v_pk_mul_f16 v54, v40, v47 op_sel:[0,0] op_sel_hi:[1,0]
  s_waitcnt lgkmcnt(10)
  v_mfma_f32_16x16x32_f16 v[68:71], v[92:95], v[64:67], v[68:71]
  ds_read_b128 v[192:195], v31 offset:16384
  v_pk_mul_f16 v55, v41, v47 op_sel:[0,0] op_sel_hi:[1,0]
  v_pk_mul_f16 v56, v42, v47 op_sel:[0,0] op_sel_hi:[1,0]
  s_waitcnt lgkmcnt(10)
  v_mfma_f32_16x16x32_f16 v[72:75], v[132:135], v[60:63], v[72:75]
  ds_read_b128 v[196:199], v31 offset:17408
  v_pk_mul_f16 v57, v40, v44 op_sel:[0,0] op_sel_hi:[1,1]
  v_pk_mul_f16 v58, v40, v44 op_sel:[0,1] op_sel_hi:[1,0]
  s_waitcnt lgkmcnt(10)
  v_mfma_f32_16x16x32_f16 v[72:75], v[136:139], v[64:67], v[72:75]
  ds_read2_b32 v[228:229], v29 offset0:0 offset1:2
  ds_read2_b32 v[230:231], v29 offset0:64 offset1:66
  v_add_u32 v29, 2048, v29
  v_pk_mul_f16 v59, v40, v45 op_sel:[0,0] op_sel_hi:[1,1]
  s_waitcnt lgkmcnt(11)
  v_mfma_f32_16x16x32_f16 v[72:75], v[140:143], v[52:55], v[72:75]
  ds_read_b128 v[104:107], v28 offset:5120
  v_pk_mul_f16 v60, v40, v45 op_sel:[0,1] op_sel_hi:[1,0]
  v_pk_mul_f16 v61, v40, v46 op_sel:[0,0] op_sel_hi:[1,1]
  s_waitcnt lgkmcnt(11)
  v_mfma_f32_16x16x32_f16 v[72:75], v[144:147], v[56:59], v[72:75]
  ds_read_b128 v[108:111], v28 offset:6144
  v_pk_mul_f16 v62, v40, v46 op_sel:[0,1] op_sel_hi:[1,0]
  s_waitcnt lgkmcnt(10)
  v_smfmac_f32_16x16x64_f16 v[80:83], v[224:227], v[52:59], v16
  ds_read_b128 v[148:151], v28 offset:40384
  v_pk_mul_f16 v63, v41, v44 op_sel:[0,0] op_sel_hi:[1,1]
  v_pk_mul_f16 v64, v41, v44 op_sel:[0,1] op_sel_hi:[1,0]
  s_waitcnt lgkmcnt(10)
  v_mfma_f32_16x16x32_f16 v[68:71], v[96:99], v[52:55], v[68:71]
  ds_read_b128 v[152:155], v28 offset:41408
  v_pk_mul_f16 v65, v41, v45 op_sel:[0,0] op_sel_hi:[1,1]
  s_waitcnt lgkmcnt(10)
  v_mfma_f32_16x16x32_f16 v[68:71], v[100:103], v[56:59], v[68:71]
  ds_read_b128 v[156:159], v28 offset:42432
  v_pk_mul_f16 v66, v41, v45 op_sel:[0,1] op_sel_hi:[1,0]
  v_pk_mul_f16 v67, v41, v46 op_sel:[0,0] op_sel_hi:[1,1]
  ds_write_b16 v15, v14 offset:4064
  s_waitcnt vmcnt(2)
  v_cmp_eq_u32 vcc, 0, v250
  s_nop 0
  s_and_b32 vcc_lo, vcc_lo, 0xff
  s_cbranch_scc0 L_cclr_ok
  s_mov_b32 s78, 0x40000
L_cclr:
  s_sub_u32 s78, s78, 1
  s_cbranch_scc1 L_cclr_ok
  v_lshlrev_b32 v250, 2, v0
  v_and_b32 v250, 31, v250
  buffer_load_dword v250, v250, s[64:67], 0 offen offset:128 sc1
  s_waitcnt vmcnt(0)
  v_cmp_eq_u32 vcc, 0, v250
  s_nop 0
  s_and_b32 vcc_lo, vcc_lo, 0xff
  s_cbranch_scc1 L_cclr
L_cclr_ok:
  v_lshl_add_u32 v24, v24, 7, v18
  v_lshl_add_u32 v25, v25, 7, v18
  s_mov_b32 exec_hi, 0x0000ffff
  v_lshl_add_u32 v26, v26, 7, v18
  v_lshl_add_u32 v27, v27, 7, v18
  s_mov_b32 exec_lo, 0
  s_mov_b32 exec_hi, 0xffff0000
  v_mov_b32 v27, v25
  v_mov_b32 v26, v25
  s_mov_b32 exec_hi, 0x00ff0000
  v_mov_b32 v26, v24
  s_mov_b64 exec, -1
  s_add_u32 m0, s74, -39488
  s_nop 0
  buffer_load_dwordx4 v24, s[32:35], 0 offen lds
  s_add_u32 m0, s74, -38432
  s_nop 0
  buffer_load_dwordx4 v25, s[32:35], 0 offen lds
  s_add_u32 m0, s74, -37376
  s_nop 0
  buffer_load_dwordx4 v26, s[32:35], 0 offen lds
  s_add_u32 m0, s74, -36320
  s_mov_b32 exec_hi, 0x00ffffff
  buffer_load_dwordx4 v27, s[32:35], 0 offen lds
  s_mov_b32 exec_hi, -1
  s_mov_b64 exec, 131071
  buffer_load_dword v255, v19, s[44:47], s101 offen
  s_mov_b64 exec, -1
  s_add_u32 s101, s101, 1171456
  s_sub_i32 s48, 0, s48
  s_mov_b32 s49, s48
  s_mov_b32 s97, 1
  s_mov_b32 s50, 1
  s_mov_b32 s96, 0
  s_cmp_lg_u32 s3, 7
  s_cbranch_scc1 L_nw0
  s_mov_b32 s52, s16
  s_and_b32 s53, s17, 0xffff
  s_mov_b32 s54, 3328
  s_mov_b32 s55, 0x20000
  v_lshlrev_b32 v22, 7, v0
  buffer_load_dword v255, v22, s[52:55], 0 offen
L_nw0:
  s_waitcnt lgkmcnt(11)
  v_mfma_f32_16x16x32_f16 v[76:79], v[184:187], v[52:55], v[76:79]
  ds_read_b128 v[160:163], v28 offset:43456
  v_alignbit_b32 v49, v49, v49, v13
  v_alignbit_b32 v50, v50, v50, v13
  s_waitcnt lgkmcnt(11)
  v_mfma_f32_16x16x32_f16 v[76:79], v[188:191], v[56:59], v[76:79]
  ds_read2_b32 v[232:233], v29 offset0:0 offset1:2
  ds_read2_b32 v[234:235], v29 offset0:64 offset1:66
  v_add_u32 v29, 2048, v29
  v_pk_mul_f16 v52, v41, v46 op_sel:[0,1] op_sel_hi:[1,0]
  v_pk_mul_f16 v53, v42, v44 op_sel:[0,0] op_sel_hi:[1,1]
  s_waitcnt lgkmcnt(12)
  v_mfma_f32_16x16x32_f16 v[76:79], v[192:195], v[60:63], v[76:79]
  ds_read_b128 v[112:115], v28 offset:7168
  v_pk_mul_f16 v54, v42, v44 op_sel:[0,1] op_sel_hi:[1,0]
  v_pk_mul_f16 v55, v42, v45 op_sel:[0,0] op_sel_hi:[1,1]
  s_waitcnt lgkmcnt(12)
  v_mfma_f32_16x16x32_f16 v[76:79], v[196:199], v[64:67], v[76:79]
  ds_read_b128 v[116:119], v28 offset:8192
  v_pk_mul_f16 v56, v42, v45 op_sel:[0,1] op_sel_hi:[1,0]
  v_pk_mul_f16 v57, v42, v46 op_sel:[0,0] op_sel_hi:[1,1]
  s_waitcnt lgkmcnt(11)
  v_smfmac_f32_16x16x64_f16 v[80:83], v[228:231], v[60:67], v16
  ds_read_b128 v[200:203], v31 offset:18432
  v_pk_mul_f16 v58, v42, v46 op_sel:[0,1] op_sel_hi:[1,0]
  v_pk_mul_f16 v59, v40, v48 op_sel:[0,0] op_sel_hi:[1,1]
  s_waitcnt lgkmcnt(11)
  v_mfma_f32_16x16x32_f16 v[68:71], v[104:107], v[60:63], v[68:71]
  ds_read_b128 v[204:207], v31 offset:19456
  ds_read_u16_d16_hi v32, v7 offset:32
  ds_read_u16_d16_hi v33, v7 offset:160
  s_waitcnt lgkmcnt(13)
  v_mfma_f32_16x16x32_f16 v[68:71], v[108:111], v[64:67], v[68:71]
  ds_read_b128 v[164:167], v28 offset:44480
  ds_read_u16_d16_hi v34, v7 offset:288
  ds_read_u16_d16_hi v35, v7 offset:416
  s_waitcnt lgkmcnt(14)
  v_mfma_f32_16x16x32_f16 v[72:75], v[148:151], v[60:63], v[72:75]
  ds_read_b128 v[168:171], v28 offset:45504
  ds_read_u16_d16_hi v36, v7 offset:544
  ds_read_u16_d16_hi v37, v7 offset:672
  v_mfma_f32_16x16x32_f16 v[72:75], v[152:155], v[64:67], v[72:75]
  ds_read2_b32 v[236:237], v29 offset0:0 offset1:2
  ds_read2_b32 v[238:239], v29 offset0:64 offset1:66
  v_add_u32 v29, 2048, v29
  ds_read_u16_d16_hi v38, v7 offset:800
  ds_read_u16_d16_hi v39, v7 offset:928
  s_waitcnt lgkmcnt(14)
  v_mfma_f32_16x16x32_f16 v[72:75], v[156:159], v[52:55], v[72:75]
  ds_read_b128 v[120:123], v28 offset:9216
  v_pk_mul_f16 v60, v41, v49 op_sel:[0,0] op_sel_hi:[1,1]
  v_pk_mul_f16 v61, v42, v50 op_sel:[0,0] op_sel_hi:[1,1]
  v_mfma_f32_16x16x32_f16 v[72:75], v[160:163], v[56:59], v[72:75]
  ds_read_b128 v[124:127], v28 offset:10240
  v_pk_mul_f16 v62, v40, v49 op_sel:[0,0] op_sel_hi:[1,1]
  v_pk_mul_f16 v63, v40, v49 op_sel:[0,1] op_sel_hi:[1,0]
  v_smfmac_f32_16x16x64_f16 v[80:83], v[232:235], v[52:59], v16
  ds_read_b128 v[208:211], v31 offset:20480
  v_pk_mul_f16 v64, v40, v50 op_sel:[0,0] op_sel_hi:[1,1]
  v_pk_mul_f16 v65, v40, v50 op_sel:[0,1] op_sel_hi:[1,0]
  v_mfma_f32_16x16x32_f16 v[68:71], v[112:115], v[52:55], v[68:71]
  ds_read_b128 v[212:215], v31 offset:21504
  v_pk_mul_f16 v66, v41, v50 op_sel:[0,0] op_sel_hi:[1,1]
  v_pk_mul_f16 v67, v41, v50 op_sel:[0,1] op_sel_hi:[1,0]
  v_mfma_f32_16x16x32_f16 v[68:71], v[116:119], v[56:59], v[68:71]
  s_waitcnt lgkmcnt(4)
  v_cvt_pk_f16_f32 v43, v38, v39
  v_cvt_pk_f16_f32 v40, v32, v35
  v_mfma_f32_16x16x32_f16 v[76:79], v[200:203], v[52:55], v[76:79]
  ds_read_b64_tr_b16 v[52:53], v8 offset:32
  ds_read_b64_tr_b16 v[54:55], v8 offset:544
  v_mfma_f32_16x16x32_f16 v[76:79], v[204:207], v[56:59], v[76:79]
  v_cvt_pk_f16_f32 v41, v33, v36
  v_cvt_pk_f16_f32 v42, v34, v37
  v_mfma_f32_16x16x32_f16 v[72:75], v[164:167], v[60:63], v[72:75]
  ds_write_b128 v10, v[40:43]
  v_mfma_f32_16x16x32_f16 v[72:75], v[168:171], v[64:67], v[72:75]
  v_pk_mul_f16 v56, v40, v40 op_sel:[0,0] op_sel_hi:[1,1]
  v_pk_mul_f16 v57, v41, v41 op_sel:[0,0] op_sel_hi:[1,1]
  v_smfmac_f32_16x16x64_f16 v[80:83], v[236:239], v[60:67], v16
  v_pk_mul_f16 v58, v42, v42 op_sel:[0,0] op_sel_hi:[1,1]
  v_pk_mul_f16 v59, v40, v41 op_sel:[0,0] op_sel_hi:[1,1]
  s_waitcnt lgkmcnt(6)
  v_mfma_f32_16x16x32_f16 v[68:71], v[120:123], v[60:63], v[68:71]
  ds_read_b128 v[44:47], v11
  ds_read_b128 v[48:51], v12
  s_waitcnt lgkmcnt(7)
  v_mfma_f32_16x16x32_f16 v[68:71], v[124:127], v[64:67], v[68:71]
  v_or3_b32 v15, v56, v57, v58
  s_waitcnt lgkmcnt(6)
  v_mfma_f32_16x16x32_f16 v[76:79], v[208:211], v[60:63], v[76:79]
  v_add_f32 v22, v80, v81
  v_add_f32 v23, v82, v83
  s_waitcnt lgkmcnt(5)
  v_mfma_f32_16x16x32_f16 v[76:79], v[212:215], v[64:67], v[76:79]
  v_pk_mul_f16 v60, v40, v41 op_sel:[0,1] op_sel_hi:[1,0]
  v_pk_mul_f16 v61, v40, v42 op_sel:[0,0] op_sel_hi:[1,1]
  ds_add_u32 v1, v3 offset:12
  s_branch L_grp1
L_prime:
  v_mov_b32 v68, 0
  v_mov_b32 v69, 0
  v_mov_b32 v70, 0
  v_mov_b32 v71, 0
  v_mov_b32 v72, 0
  v_mov_b32 v73, 0
  v_mov_b32 v74, 0
  v_mov_b32 v75, 0
  v_mov_b32 v76, 0
  v_mov_b32 v77, 0
  v_mov_b32 v78, 0
  v_mov_b32 v79, 0
  v_mov_b32 v80, 0
  v_mov_b32 v81, 0
  v_mov_b32 v82, 0
  v_mov_b32 v83, 0
  v_mov_b32 v22, 0
  v_mov_b32 v23, 0
  ds_read_u16_d16_hi v32, v7 offset:0
  ds_read_u16_d16_hi v33, v7 offset:128
  ds_read_u16_d16_hi v34, v7 offset:256
  ds_read_u16_d16_hi v35, v7 offset:384
  ds_read_u16_d16_hi v36, v7 offset:512
  ds_read_u16_d16_hi v37, v7 offset:640
  ds_read_u16_d16_hi v38, v7 offset:768
  ds_read_u16_d16_hi v39, v7 offset:896
  s_waitcnt lgkmcnt(0)
  v_cvt_pk_f16_f32 v43, v38, v39
  v_cvt_pk_f16_f32 v40, v32, v35
  v_cvt_pk_f16_f32 v41, v33, v36
  v_cvt_pk_f16_f32 v42, v34, v37
  ds_write_b128 v10, v[40:43]
  ds_read_b64_tr_b16 v[52:53], v8 offset:0
  ds_read_b64_tr_b16 v[54:55], v8 offset:512
  v_pk_mul_f16 v56, v40, v40 op_sel:[0,0] op_sel_hi:[1,1]
  v_pk_mul_f16 v57, v41, v41 op_sel:[0,0] op_sel_hi:[1,1]
  v_pk_mul_f16 v58, v42, v42 op_sel:[0,0] op_sel_hi:[1,1]
  v_pk_mul_f16 v59, v40, v41 op_sel:[0,0] op_sel_hi:[1,1]
  ds_read_b128 v[44:47], v11
  ds_read_b128 v[48:51], v12
  v_pk_mul_f16 v60, v40, v41 op_sel:[0,1] op_sel_hi:[1,0]
  v_pk_mul_f16 v61, v40, v42 op_sel:[0,0] op_sel_hi:[1,1]
L_cin_loop:
  s_cmp_lg_u32 s84, 0
  s_cbranch_scc1 L_pr0
  s_setprio 2
L_pr0:
  v_mfma_f32_16x16x32_f16 v[80:83], v[216:219], v[56:59], 0
  v_fmac_f32 v14, v68, v72
  v_fmac_f32 v14, v69, v73
  v_fmac_f32 v14, v70, v74
  v_fmac_f32 v14, v71, v75
  s_waitcnt lgkmcnt(2)
  v_mfma_f32_16x16x32_bf16 v[72:75], v[240:243], v[52:55], 0
  v_pk_mul_f16 v62, v40, v42 op_sel:[0,1] op_sel_hi:[1,0]
  v_pk_mul_f16 v63, v41, v42 op_sel:[0,0] op_sel_hi:[1,1]
  v_mfma_f32_16x16x32_f16 v[72:75], v[128:131], v[56:59], v[72:75]
  v_fmac_f32 v14, v76, v77
  v_fmac_f32 v14, v22, v78
  v_mfma_f32_16x16x32_f16 v[68:71], v[84:87], v[56:59], 0
  v_fmac_f32 v14, v23, v79
  v_pk_mul_f16 v64, v41, v42 op_sel:[0,1] op_sel_hi:[1,0]
  v_mfma_f32_16x16x32_bf16 v[76:79], v[244:247], v[52:55], 0
  v_pk_mul_f16 v65, v40, v43 op_sel:[0,0] op_sel_hi:[1,0]
  v_pk_mul_f16 v66, v41, v43 op_sel:[0,0] op_sel_hi:[1,0]
  v_mfma_f32_16x16x32_f16 v[76:79], v[172:175], v[56:59], v[76:79]
  v_pk_mul_f16 v67, v42, v43 op_sel:[0,0] op_sel_hi:[1,0]
  v_add_f32_dpp v14, v14, v14 row_shr:1 row_mask:0xf bank_mask:0xf
  v_mfma_f32_16x16x32_f16 v[76:79], v[176:179], v[60:63], v[76:79]
  v_mul_f16_sdwa v52, v40, v40 dst_sel:WORD_0 dst_unused:UNUSED_PAD src0_sel:WORD_0 src1_sel:WORD_1
  v_mul_f16_sdwa v53, v42, v42 dst_sel:WORD_0 dst_unused:UNUSED_PAD src0_sel:WORD_0 src1_sel:WORD_1
  v_mfma_f32_16x16x32_f16 v[76:79], v[180:183], v[64:67], v[76:79]
  v_add_f32_dpp v14, v14, v14 row_shr:2 row_mask:0xf bank_mask:0xf
  s_waitcnt lgkmcnt(0)
  v_alignbit_b32 v48, v48, v48, v13
  v_smfmac_f32_16x16x64_f16 v[80:83], v[220:223], v[60:67], v16
  v_mul_f16_sdwa v52, v41, v41 dst_sel:WORD_1 dst_unused:UNUSED_PRESERVE src0_sel:WORD_0 src1_sel:WORD_1
  v_mul_f16_sdwa v53, v43, v43 dst_sel:WORD_1 dst_unused:UNUSED_PRESERVE src0_sel:WORD_0 src1_sel:WORD_1
  v_mfma_f32_16x16x32_f16 v[68:71], v[88:91], v[60:63], v[68:71]
  v_add_f32_dpp v14, v14, v14 row_shr:4 row_mask:0xf bank_mask:0xf
  v_pk_mul_f16 v54, v40, v47 op_sel:[0,0] op_sel_hi:[1,0]
  v_mfma_f32_16x16x32_f16 v[68:71], v[92:95], v[64:67], v[68:71]
  v_pk_mul_f16 v55, v41, v47 op_sel:[0,0] op_sel_hi:[1,0]
  v_pk_mul_f16 v56, v42, v47 op_sel:[0,0] op_sel_hi:[1,0]
  v_mfma_f32_16x16x32_f16 v[72:75], v[132:135], v[60:63], v[72:75]
  v_pk_mul_f16 v57, v40, v44 op_sel:[0,0] op_sel_hi:[1,1]
  v_pk_mul_f16 v58, v40, v44 op_sel:[0,1] op_sel_hi:[1,0]
  v_mfma_f32_16x16x32_f16 v[72:75], v[136:139], v[64:67], v[72:75]
  v_pk_mul_f16 v59, v40, v45 op_sel:[0,0] op_sel_hi:[1,1]
  v_add_f32_dpp v14, v14, v14 row_shr:8 row_mask:0xf bank_mask:0xf
  v_mfma_f32_16x16x32_f16 v[72:75], v[140:143], v[52:55], v[72:75]
  v_pk_mul_f16 v60, v40, v45 op_sel:[0,1] op_sel_hi:[1,0]
  v_pk_mul_f16 v61, v40, v46 op_sel:[0,0] op_sel_hi:[1,1]
  v_mfma_f32_16x16x32_f16 v[72:75], v[144:147], v[56:59], v[72:75]
  v_add_f32_dpp v14, v14, v14 row_bcast:15 row_mask:0xa bank_mask:0xf
  v_pk_mul_f16 v62, v40, v46 op_sel:[0,1] op_sel_hi:[1,0]
  v_smfmac_f32_16x16x64_f16 v[80:83], v[224:227], v[52:59], v16
  v_pk_mul_f16 v63, v41, v44 op_sel:[0,0] op_sel_hi:[1,1]
  v_pk_mul_f16 v64, v41, v44 op_sel:[0,1] op_sel_hi:[1,0]
  v_mfma_f32_16x16x32_f16 v[68:71], v[96:99], v[52:55], v[68:71]
  v_add_f32_dpp v14, v14, v14 row_bcast:31 row_mask:0xc bank_mask:0xf
  v_pk_mul_f16 v65, v41, v45 op_sel:[0,0] op_sel_hi:[1,1]
  v_mfma_f32_16x16x32_f16 v[68:71], v[100:103], v[56:59], v[68:71]
  v_pk_mul_f16 v66, v41, v45 op_sel:[0,1] op_sel_hi:[1,0]
  v_pk_mul_f16 v67, v41, v46 op_sel:[0,0] op_sel_hi:[1,1]
  s_waitcnt vmcnt(0)
  s_cmp_le_u32 s72, 3
  s_cbranch_scc1 L_blk
  s_mov_b64 exec, 131071
  buffer_load_dword v255, v19, s[44:47], s101 offen
  s_mov_b64 exec, -1
  s_add_u32 s101, s101, 1171456
L_blk:
  s_cmp_eq_u32 s50, 0
  s_cbranch_scc1 L_blkend
  v_readlane_b32 s81, v14, 63
  v_ldexp_f32 v14, v14, s49
  v_and_b32 v14, -2, v14
  s_cmp_eq_u32 s50, 2
  s_cbranch_scc1 L_good
  s_cmp_eq_u64 s[90:91], 0
  s_cbranch_scc1 L_slow
  s_bfe_u32 s81, s81, 0x80017
  s_cmp_eq_u32 s81, 255
  s_cbranch_scc1 L_slow
L_good:
  s_mov_b32 exec_lo, 0
  s_mov_b32 exec_hi, 0x80000000
  buffer_store_dword v14, v251, s[60:63], s85 offen sc1
  s_mov_b64 exec, -1
  s_add_u32 s85, s85, 32
  s_sub_u32 s72, s72, 1
  s_cmp_eq_u32 s72, 0
  s_cbranch_scc1 L_cin_done
  s_cmp_eq_u32 s72, 1
  s_cbranch_scc1 L_lastnext
  v_lshl_add_u32 v24, v24, 7, v18
  v_lshl_add_u32 v25, v25, 7, v18
  s_mov_b32 exec_hi, 0x0000ffff
  v_lshl_add_u32 v26, v26, 7, v18
  v_lshl_add_u32 v27, v27, 7, v18
  s_mov_b32 exec_lo, 0
  s_mov_b32 exec_hi, 0xffff0000
  v_mov_b32 v27, v25
  v_mov_b32 v26, v25
  s_mov_b32 exec_hi, 0x00ff0000
  v_mov_b32 v26, v24
  s_mov_b64 exec, -1
  s_add_u32 m0, s74, 0
  s_nop 0
  buffer_load_dwordx4 v24, s[32:35], 0 offen lds
  s_add_u32 m0, s74, 1056
  s_nop 0
  buffer_load_dwordx4 v25, s[32:35], 0 offen lds
  s_add_u32 m0, s74, 2112
  s_nop 0
  buffer_load_dwordx4 v26, s[32:35], 0 offen lds
  s_add_u32 m0, s74, 3168
  s_mov_b32 exec_hi, 0x00ffffff
  buffer_load_dwordx4 v27, s[32:35], 0 offen lds
  s_mov_b32 exec_hi, -1
  s_add_u32 s94, s94, 832
  s_cmp_lg_u32 s72, s99
  s_cbranch_scc1 L_nodma
  v_mov_b32 v250, 1
  s_mov_b64 exec, 1
  buffer_atomic_add v250, v251, s[60:63], s98 offen sc0
  s_mov_b64 exec, -1
  s_mov_b32 s99, 8
  s_branch L_nodma
L_lastnext:
  s_cmp_lt_i32 s26, 0
  s_cselect_b32 s85, s85, s26
L_nodma:
  s_add_u32 s74, s74, s75
  s_sub_u32 s75, 0, s75
  s_mov_b32 s49, s48
  s_mov_b32 s97, 1
L_blkend:
  s_mov_b32 s50, s97
  v_mfma_f32_16x16x32_f16 v[76:79], v[184:187], v[52:55], v[76:79]
  v_alignbit_b32 v49, v49, v49, v13
  v_alignbit_b32 v50, v50, v50, v13
  v_mfma_f32_16x16x32_f16 v[76:79], v[188:191], v[56:59], v[76:79]
  v_pk_mul_f16 v52, v41, v46 op_sel:[0,1] op_sel_hi:[1,0]
  v_pk_mul_f16 v53, v42, v44 op_sel:[0,0] op_sel_hi:[1,1]
  v_mfma_f32_16x16x32_f16 v[76:79], v[192:195], v[60:63], v[76:79]
  v_pk_mul_f16 v54, v42, v44 op_sel:[0,1] op_sel_hi:[1,0]
  v_pk_mul_f16 v55, v42, v45 op_sel:[0,0] op_sel_hi:[1,1]
  v_mfma_f32_16x16x32_f16 v[76:79], v[196:199], v[64:67], v[76:79]
  v_pk_mul_f16 v56, v42, v45 op_sel:[0,1] op_sel_hi:[1,0]
  v_pk_mul_f16 v57, v42, v46 op_sel:[0,0] op_sel_hi:[1,1]
  v_smfmac_f32_16x16x64_f16 v[80:83], v[228:231], v[60:67], v16
  v_pk_mul_f16 v58, v42, v46 op_sel:[0,1] op_sel_hi:[1,0]
  v_pk_mul_f16 v59, v40, v48 op_sel:[0,0] op_sel_hi:[1,1]
  v_mfma_f32_16x16x32_f16 v[68:71], v[104:107], v[60:63], v[68:71]
  ds_read_u16_d16_hi v32, v7 offset:32
  ds_read_u16_d16_hi v33, v7 offset:160
  v_mfma_f32_16x16x32_f16 v[68:71], v[108:111], v[64:67], v[68:71]
  ds_read_u16_d16_hi v34, v7 offset:288
  ds_read_u16_d16_hi v35, v7 offset:416
  v_mfma_f32_16x16x32_f16 v[72:75], v[148:151], v[60:63], v[72:75]
  ds_read_u16_d16_hi v36, v7 offset:544
  ds_read_u16_d16_hi v37, v7 offset:672
  v_mfma_f32_16x16x32_f16 v[72:75], v[152:155], v[64:67], v[72:75]
  ds_read_u16_d16_hi v38, v7 offset:800
  ds_read_u16_d16_hi v39, v7 offset:928
  v_mfma_f32_16x16x32_f16 v[72:75], v[156:159], v[52:55], v[72:75]
  v_pk_mul_f16 v60, v41, v49 op_sel:[0,0] op_sel_hi:[1,1]
  v_pk_mul_f16 v61, v42, v50 op_sel:[0,0] op_sel_hi:[1,1]
  v_mfma_f32_16x16x32_f16 v[72:75], v[160:163], v[56:59], v[72:75]
  v_pk_mul_f16 v62, v40, v49 op_sel:[0,0] op_sel_hi:[1,1]
  v_pk_mul_f16 v63, v40, v49 op_sel:[0,1] op_sel_hi:[1,0]
  v_smfmac_f32_16x16x64_f16 v[80:83], v[232:235], v[52:59], v16
  v_pk_mul_f16 v64, v40, v50 op_sel:[0,0] op_sel_hi:[1,1]
  v_pk_mul_f16 v65, v40, v50 op_sel:[0,1] op_sel_hi:[1,0]
  v_mfma_f32_16x16x32_f16 v[68:71], v[112:115], v[52:55], v[68:71]
  v_pk_mul_f16 v66, v41, v50 op_sel:[0,0] op_sel_hi:[1,1]
  v_pk_mul_f16 v67, v41, v50 op_sel:[0,1] op_sel_hi:[1,0]
  v_mfma_f32_16x16x32_f16 v[68:71], v[116:119], v[56:59], v[68:71]
  s_waitcnt lgkmcnt(0)
  v_cvt_pk_f16_f32 v43, v38, v39
  v_cvt_pk_f16_f32 v40, v32, v35
  v_mfma_f32_16x16x32_f16 v[76:79], v[200:203], v[52:55], v[76:79]
  ds_read_b64_tr_b16 v[52:53], v8 offset:32
  ds_read_b64_tr_b16 v[54:55], v8 offset:544
  v_mfma_f32_16x16x32_f16 v[76:79], v[204:207], v[56:59], v[76:79]
  v_cvt_pk_f16_f32 v41, v33, v36
  v_cvt_pk_f16_f32 v42, v34, v37
  v_mfma_f32_16x16x32_f16 v[72:75], v[164:167], v[60:63], v[72:75]
  ds_write_b128 v10, v[40:43]
  v_mfma_f32_16x16x32_f16 v[72:75], v[168:171], v[64:67], v[72:75]
  v_pk_mul_f16 v56, v40, v40 op_sel:[0,0] op_sel_hi:[1,1]
  v_pk_mul_f16 v57, v41, v41 op_sel:[0,0] op_sel_hi:[1,1]
  v_smfmac_f32_16x16x64_f16 v[80:83], v[236:239], v[60:67], v16
  v_pk_mul_f16 v58, v42, v42 op_sel:[0,0] op_sel_hi:[1,1]
  v_pk_mul_f16 v59, v40, v41 op_sel:[0,0] op_sel_hi:[1,1]
  v_mfma_f32_16x16x32_f16 v[68:71], v[120:123], v[60:63], v[68:71]
  ds_read_b128 v[44:47], v11
  ds_read_b128 v[48:51], v12
  v_mfma_f32_16x16x32_f16 v[68:71], v[124:127], v[64:67], v[68:71]
  v_or3_b32 v15, v56, v57, v58
  v_mfma_f32_16x16x32_f16 v[76:79], v[208:211], v[60:63], v[76:79]
  v_add_f32 v22, v80, v81
  v_add_f32 v23, v82, v83
  v_mfma_f32_16x16x32_f16 v[76:79], v[212:215], v[64:67], v[76:79]
  v_pk_mul_f16 v60, v40, v41 op_sel:[0,1] op_sel_hi:[1,0]
  v_pk_mul_f16 v61, v40, v42 op_sel:[0,0] op_sel_hi:[1,1]
L_grp1:
  v_mfma_f32_16x16x32_f16 v[80:83], v[216:219], v[56:59], 0
  v_mul_f32 v14, v68, v72
  v_fmac_f32 v14, v69, v73
  v_fmac_f32 v14, v70, v74
  v_fmac_f32 v14, v71, v75
  s_waitcnt lgkmcnt(3)
  v_mfma_f32_16x16x32_bf16 v[72:75], v[240:243], v[52:55], 0
  v_pk_mul_f16 v62, v40, v42 op_sel:[0,1] op_sel_hi:[1,0]
  v_pk_mul_f16 v63, v41, v42 op_sel:[0,0] op_sel_hi:[1,1]
  v_mfma_f32_16x16x32_f16 v[72:75], v[128:131], v[56:59], v[72:75]
  v_fmac_f32 v14, v76, v77
  v_fmac_f32 v14, v22, v78
  v_mfma_f32_16x16x32_f16 v[68:71], v[84:87], v[56:59], 0
  v_fmac_f32 v14, v23, v79
  v_pk_mul_f16 v64, v41, v42 op_sel:[0,1] op_sel_hi:[1,0]
  v_mfma_f32_16x16x32_bf16 v[76:79], v[244:247], v[52:55], 0
  v_pk_mul_f16 v65, v40, v43 op_sel:[0,0] op_sel_hi:[1,0]
  v_pk_mul_f16 v66, v41, v43 op_sel:[0,0] op_sel_hi:[1,0]
  v_mfma_f32_16x16x32_f16 v[76:79], v[172:175], v[56:59], v[76:79]
  v_pk_mul_f16 v67, v42, v43 op_sel:[0,0] op_sel_hi:[1,0]
  s_waitcnt lgkmcnt(0)
  v_alignbit_b32 v48, v48, v48, v13
  v_mfma_f32_16x16x32_f16 v[76:79], v[176:179], v[60:63], v[76:79]
  v_mul_f16_sdwa v52, v40, v40 dst_sel:WORD_0 dst_unused:UNUSED_PAD src0_sel:WORD_0 src1_sel:WORD_1
  v_mul_f16_sdwa v53, v42, v42 dst_sel:WORD_0 dst_unused:UNUSED_PAD src0_sel:WORD_0 src1_sel:WORD_1
  v_mfma_f32_16x16x32_f16 v[76:79], v[180:183], v[64:67], v[76:79]
  v_mul_f16_sdwa v52, v41, v41 dst_sel:WORD_1 dst_unused:UNUSED_PRESERVE src0_sel:WORD_0 src1_sel:WORD_1
  v_mul_f16_sdwa v53, v43, v43 dst_sel:WORD_1 dst_unused:UNUSED_PRESERVE src0_sel:WORD_0 src1_sel:WORD_1
  v_smfmac_f32_16x16x64_f16 v[80:83], v[220:223], v[60:67], v16
  v_pk_mul_f16 v54, v40, v47 op_sel:[0,0] op_sel_hi:[1,0]
  v_pk_mul_f16 v55, v41, v47 op_sel:[0,0] op_sel_hi:[1,0]
  v_mfma_f32_16x16x32_f16 v[68:71], v[88:91], v[60:63], v[68:71]
  v_pk_mul_f16 v56, v42, v47 op_sel:[0,0] op_sel_hi:[1,0]
  v_pk_mul_f16 v57, v40, v44 op_sel:[0,0] op_sel_hi:[1,1]
  v_mfma_f32_16x16x32_f16 v[68:71], v[92:95], v[64:67], v[68:71]
  v_pk_mul_f16 v58, v40, v44 op_sel:[0,1] op_sel_hi:[1,0]
  v_pk_mul_f16 v59, v40, v45 op_sel:[0,0] op_sel_hi:[1,1]
  v_mfma_f32_16x16x32_f16 v[72:75], v[132:135], v[60:63], v[72:75]
  v_pk_mul_f16 v60, v40, v45 op_sel:[0,1] op_sel_hi:[1,0]
  v_pk_mul_f16 v61, v40, v46 op_sel:[0,0] op_sel_hi:[1,1]
  v_mfma_f32_16x16x32_f16 v[72:75], v[136:139], v[64:67], v[72:75]
  v_pk_mul_f16 v62, v40, v46 op_sel:[0,1] op_sel_hi:[1,0]
  v_pk_mul_f16 v63, v41, v44 op_sel:[0,0] op_sel_hi:[1,1]
  v_mfma_f32_16x16x32_f16 v[72:75], v[140:143], v[52:55], v[72:75]
  v_pk_mul_f16 v64, v41, v44 op_sel:[0,1] op_sel_hi:[1,0]
  v_pk_mul_f16 v65, v41, v45 op_sel:[0,0] op_sel_hi:[1,1]
  v_mfma_f32_16x16x32_f16 v[72:75], v[144:147], v[56:59], v[72:75]
  v_pk_mul_f16 v66, v41, v45 op_sel:[0,1] op_sel_hi:[1,0]
  v_pk_mul_f16 v67, v41, v46 op_sel:[0,0] op_sel_hi:[1,1]
  v_smfmac_f32_16x16x64_f16 v[80:83], v[224:227], v[52:59], v16
  v_alignbit_b32 v49, v49, v49, v13
  v_alignbit_b32 v50, v50, v50, v13
  v_mfma_f32_16x16x32_f16 v[68:71], v[96:99], v[52:55], v[68:71]
  ds_read_u16_d16_hi v32, v7 offset:64
  ds_read_u16_d16_hi v33, v7 offset:192
  v_mfma_f32_16x16x32_f16 v[68:71], v[100:103], v[56:59], v[68:71]
  ds_read_u16_d16_hi v34, v7 offset:320
  ds_read_u16_d16_hi v35, v7 offset:448
  v_mfma_f32_16x16x32_f16 v[76:79], v[184:187], v[52:55], v[76:79]
  v_pk_mul_f16 v52, v41, v46 op_sel:[0,1] op_sel_hi:[1,0]
  v_pk_mul_f16 v53, v42, v44 op_sel:[0,0] op_sel_hi:[1,1]
  v_mfma_f32_16x16x32_f16 v[76:79], v[188:191], v[56:59], v[76:79]
  v_pk_mul_f16 v54, v42, v44 op_sel:[0,1] op_sel_hi:[1,0]
  v_pk_mul_f16 v55, v42, v45 op_sel:[0,0] op_sel_hi:[1,1]
  v_mfma_f32_16x16x32_f16 v[76:79], v[192:195], v[60:63], v[76:79]
  v_pk_mul_f16 v56, v42, v45 op_sel:[0,1] op_sel_hi:[1,0]
  v_pk_mul_f16 v57, v42, v46 op_sel:[0,0] op_sel_hi:[1,1]
  v_mfma_f32_16x16x32_f16 v[76:79], v[196:199], v[64:67], v[76:79]
  v_pk_mul_f16 v58, v42, v46 op_sel:[0,1] op_sel_hi:[1,0]
  v_pk_mul_f16 v59, v40, v48 op_sel:[0,0] op_sel_hi:[1,1]
  v_smfmac_f32_16x16x64_f16 v[80:83], v[228:231], v[60:67], v16
  ds_read_u16_d16_hi v36, v7 offset:576
  ds_read_u16_d16_hi v37, v7 offset:704
  v_mfma_f32_16x16x32_f16 v[68:71], v[104:107], v[60:63], v[68:71]
  ds_read_u16_d16_hi v38, v7 offset:832
  ds_read_u16_d16_hi v39, v7 offset:960
  v_mfma_f32_16x16x32_f16 v[68:71], v[108:111], v[64:67], v[68:71]
  v_and_b32 v15, 0x60006000, v15
  v_cmp_ne_u32 s[90:91], 0, v15
  v_mfma_f32_16x16x32_f16 v[72:75], v[148:151], v[60:63], v[72:75]
  v_pk_mul_f16 v60, v41, v49 op_sel:[0,0] op_sel_hi:[1,1]
  v_pk_mul_f16 v61, v42, v50 op_sel:[0,0] op_sel_hi:[1,1]
  v_mfma_f32_16x16x32_f16 v[72:75], v[152:155], v[64:67], v[72:75]
  v_pk_mul_f16 v62, v40, v49 op_sel:[0,0] op_sel_hi:[1,1]
  v_pk_mul_f16 v63, v40, v49 op_sel:[0,1] op_sel_hi:[1,0]
  v_mfma_f32_16x16x32_f16 v[72:75], v[156:159], v[52:55], v[72:75]
  v_pk_mul_f16 v64, v40, v50 op_sel:[0,0] op_sel_hi:[1,1]
  v_pk_mul_f16 v65, v40, v50 op_sel:[0,1] op_sel_hi:[1,0]
  v_mfma_f32_16x16x32_f16 v[72:75], v[160:163], v[56:59], v[72:75]
  v_pk_mul_f16 v66, v41, v50 op_sel:[0,0] op_sel_hi:[1,1]
  v_pk_mul_f16 v67, v41, v50 op_sel:[0,1] op_sel_hi:[1,0]
  v_smfmac_f32_16x16x64_f16 v[80:83], v[232:235], v[52:59], v16
  s_waitcnt lgkmcnt(0)
  v_cvt_pk_f16_f32 v43, v38, v39
  v_cvt_pk_f16_f32 v40, v32, v35
  v_mfma_f32_16x16x32_f16 v[68:71], v[112:115], v[52:55], v[68:71]
  v_cvt_pk_f16_f32 v41, v33, v36
  v_cvt_pk_f16_f32 v42, v34, v37
  v_mfma_f32_16x16x32_f16 v[68:71], v[116:119], v[56:59], v[68:71]
  ds_write_b128 v10, v[40:43]
  v_mfma_f32_16x16x32_f16 v[76:79], v[200:203], v[52:55], v[76:79]
  ds_read_b64_tr_b16 v[52:53], v8 offset:64
  ds_read_b64_tr_b16 v[54:55], v8 offset:576
  v_mfma_f32_16x16x32_f16 v[76:79], v[204:207], v[56:59], v[76:79]
  v_pk_mul_f16 v56, v40, v40 op_sel:[0,0] op_sel_hi:[1,1]
  v_pk_mul_f16 v57, v41, v41 op_sel:[0,0] op_sel_hi:[1,1]
  v_mfma_f32_16x16x32_f16 v[72:75], v[164:167], v[60:63], v[72:75]
  v_pk_mul_f16 v58, v42, v42 op_sel:[0,0] op_sel_hi:[1,1]
  v_pk_mul_f16 v59, v40, v41 op_sel:[0,0] op_sel_hi:[1,1]
  v_mfma_f32_16x16x32_f16 v[72:75], v[168:171], v[64:67], v[72:75]
  ds_read_b128 v[44:47], v11
  ds_read_b128 v[48:51], v12
  v_smfmac_f32_16x16x64_f16 v[80:83], v[236:239], v[60:67], v16
  v_mfma_f32_16x16x32_f16 v[68:71], v[120:123], v[60:63], v[68:71]
  v_mfma_f32_16x16x32_f16 v[68:71], v[124:127], v[64:67], v[68:71]
  v_mfma_f32_16x16x32_f16 v[76:79], v[208:211], v[60:63], v[76:79]
  s_nop 4
  v_add_f32 v22, v80, v81
  v_add_f32 v23, v82, v83
  v_mfma_f32_16x16x32_f16 v[76:79], v[212:215], v[64:67], v[76:79]
  v_pk_mul_f16 v60, v40, v41 op_sel:[0,1] op_sel_hi:[1,0]
  v_pk_mul_f16 v61, v40, v42 op_sel:[0,0] op_sel_hi:[1,1]
  s_cmp_eq_u32 s72, s96
  s_cbranch_scc1 L_htail
  v_mfma_f32_16x16x32_f16 v[80:83], v[216:219], v[56:59], 0
  v_fmac_f32 v14, v68, v72
  v_fmac_f32 v14, v69, v73
  v_fmac_f32 v14, v70, v74
  v_fmac_f32 v14, v71, v75
  s_waitcnt lgkmcnt(2)
  v_mfma_f32_16x16x32_bf16 v[72:75], v[240:243], v[52:55], 0
  v_pk_mul_f16 v62, v40, v42 op_sel:[0,1] op_sel_hi:[1,0]
  v_pk_mul_f16 v63, v41, v42 op_sel:[0,0] op_sel_hi:[1,1]
  v_mfma_f32_16x16x32_f16 v[72:75], v[128:131], v[56:59], v[72:75]
  v_fmac_f32 v14, v76, v77
  v_fmac_f32 v14, v22, v78
  v_mfma_f32_16x16x32_f16 v[68:71], v[84:87], v[56:59], 0
  v_fmac_f32 v14, v23, v79
  v_pk_mul_f16 v64, v41, v42 op_sel:[0,1] op_sel_hi:[1,0]
  v_mfma_f32_16x16x32_bf16 v[76:79], v[244:247], v[52:55], 0
  v_pk_mul_f16 v65, v40, v43 op_sel:[0,0] op_sel_hi:[1,0]
  v_pk_mul_f16 v66, v41, v43 op_sel:[0,0] op_sel_hi:[1,0]
  v_mfma_f32_16x16x32_f16 v[76:79], v[172:175], v[56:59], v[76:79]
  v_pk_mul_f16 v67, v42, v43 op_sel:[0,0] op_sel_hi:[1,0]
  s_waitcnt lgkmcnt(0)
  v_alignbit_b32 v48, v48, v48, v13
  v_mfma_f32_16x16x32_f16 v[76:79], v[176:179], v[60:63], v[76:79]
  v_mul_f16_sdwa v52, v40, v40 dst_sel:WORD_0 dst_unused:UNUSED_PAD src0_sel:WORD_0 src1_sel:WORD_1
  v_mul_f16_sdwa v53, v42, v42 dst_sel:WORD_0 dst_unused:UNUSED_PAD src0_sel:WORD_0 src1_sel:WORD_1
  v_mfma_f32_16x16x32_f16 v[76:79], v[180:183], v[64:67], v[76:79]
  v_mul_f16_sdwa v52, v41, v41 dst_sel:WORD_1 dst_unused:UNUSED_PRESERVE src0_sel:WORD_0 src1_sel:WORD_1
  v_mul_f16_sdwa v53, v43, v43 dst_sel:WORD_1 dst_unused:UNUSED_PRESERVE src0_sel:WORD_0 src1_sel:WORD_1
  v_smfmac_f32_16x16x64_f16 v[80:83], v[220:223], v[60:67], v16
  v_pk_mul_f16 v54, v40, v47 op_sel:[0,0] op_sel_hi:[1,0]
  v_pk_mul_f16 v55, v41, v47 op_sel:[0,0] op_sel_hi:[1,0]
  v_mfma_f32_16x16x32_f16 v[68:71], v[88:91], v[60:63], v[68:71]
  v_pk_mul_f16 v56, v42, v47 op_sel:[0,0] op_sel_hi:[1,0]
  v_pk_mul_f16 v57, v40, v44 op_sel:[0,0] op_sel_hi:[1,1]
  v_mfma_f32_16x16x32_f16 v[68:71], v[92:95], v[64:67], v[68:71]
  v_pk_mul_f16 v58, v40, v44 op_sel:[0,1] op_sel_hi:[1,0]
  v_pk_mul_f16 v59, v40, v45 op_sel:[0,0] op_sel_hi:[1,1]
  v_mfma_f32_16x16x32_f16 v[72:75], v[132:135], v[60:63], v[72:75]
  v_pk_mul_f16 v60, v40, v45 op_sel:[0,1] op_sel_hi:[1,0]
  v_pk_mul_f16 v61, v40, v46 op_sel:[0,0] op_sel_hi:[1,1]
  v_mfma_f32_16x16x32_f16 v[72:75], v[136:139], v[64:67], v[72:75]
  v_pk_mul_f16 v62, v40, v46 op_sel:[0,1] op_sel_hi:[1,0]
  v_pk_mul_f16 v63, v41, v44 op_sel:[0,0] op_sel_hi:[1,1]
  v_mfma_f32_16x16x32_f16 v[72:75], v[140:143], v[52:55], v[72:75]
  v_pk_mul_f16 v64, v41, v44 op_sel:[0,1] op_sel_hi:[1,0]
  v_pk_mul_f16 v65, v41, v45 op_sel:[0,0] op_sel_hi:[1,1]
  v_mfma_f32_16x16x32_f16 v[72:75], v[144:147], v[56:59], v[72:75]
  v_pk_mul_f16 v66, v41, v45 op_sel:[0,1] op_sel_hi:[1,0]
  v_pk_mul_f16 v67, v41, v46 op_sel:[0,0] op_sel_hi:[1,1]
  v_smfmac_f32_16x16x64_f16 v[80:83], v[224:227], v[52:59], v16
  v_alignbit_b32 v49, v49, v49, v13
  v_alignbit_b32 v50, v50, v50, v13
  v_mfma_f32_16x16x32_f16 v[68:71], v[96:99], v[52:55], v[68:71]
  ds_read_u16_d16_hi v32, v7 offset:96
  ds_read_u16_d16_hi v33, v7 offset:224
  v_mfma_f32_16x16x32_f16 v[68:71], v[100:103], v[56:59], v[68:71]
  ds_read_u16_d16_hi v34, v7 offset:352
  ds_read_u16_d16_hi v35, v7 offset:480
  s_cmp_lg_u32 s99, 8
  s_cbranch_scc1 L_hk
  s_waitcnt vmcnt(0)
  v_readfirstlane_b32 s81, v250
  s_mov_b32 s99, 0
  s_add_u32 s81, s81, 1
  s_cmp_ge_u32 s81, 36
  s_cbranch_scc1 L_hk
  s_add_u32 s72, s72, 1
  s_mov_b32 s26, 10240
  s_cmp_lt_u32 s81, 20
  s_cbranch_scc1 L_hkf
  s_add_u32 s81, s81, 20
  s_and_b32 s94, s81, 1
  s_lshr_b32 s81, s81, 1
  s_mov_b32 s96, 1
  s_lshl_b32 s94, s94, 6
  v_xor_b32 v18, s94, v18
  s_lshl_b32 s94, s94, 5
  s_add_u32 s26, s26, s94
L_hkf:
  s_add_u32 s81, s81, 484
  s_lshl_b32 s94, s81, 2
  s_add_u32 s26, s26, s94
  s_andn2_b32 s94, s98, 0x3fff
  s_add_u32 s26, s26, s94
  s_lshr_b32 s94, s94, 5
  s_add_u32 s94, s94, s81
  s_mul_i32 s94, s94, 104
L_hk:
  buffer_load_dwordx4 v[24:27], v17, s[28:31], s94 offen offset:0
  v_mfma_f32_16x16x32_f16 v[76:79], v[184:187], v[52:55], v[76:79]
  v_pk_mul_f16 v52, v41, v46 op_sel:[0,1] op_sel_hi:[1,0]
  v_pk_mul_f16 v53, v42, v44 op_sel:[0,0] op_sel_hi:[1,1]
  v_mfma_f32_16x16x32_f16 v[76:79], v[188:191], v[56:59], v[76:79]
  v_pk_mul_f16 v54, v42, v44 op_sel:[0,1] op_sel_hi:[1,0]
  v_pk_mul_f16 v55, v42, v45 op_sel:[0,0] op_sel_hi:[1,1]
  v_mfma_f32_16x16x32_f16 v[76:79], v[192:195], v[60:63], v[76:79]
  v_pk_mul_f16 v56, v42, v45 op_sel:[0,1] op_sel_hi:[1,0]
  v_pk_mul_f16 v57, v42, v46 op_sel:[0,0] op_sel_hi:[1,1]
  v_mfma_f32_16x16x32_f16 v[76:79], v[196:199], v[64:67], v[76:79]
  v_pk_mul_f16 v58, v42, v46 op_sel:[0,1] op_sel_hi:[1,0]
  v_pk_mul_f16 v59, v40, v48 op_sel:[0,0] op_sel_hi:[1,1]
  v_smfmac_f32_16x16x64_f16 v[80:83], v[228:231], v[60:67], v16
  ds_read_u16_d16_hi v36, v7 offset:608
  ds_read_u16_d16_hi v37, v7 offset:736
  v_mfma_f32_16x16x32_f16 v[68:71], v[104:107], v[60:63], v[68:71]
  ds_read_u16_d16_hi v38, v7 offset:864
  ds_read_u16_d16_hi v39, v7 offset:992
  v_mfma_f32_16x16x32_f16 v[68:71], v[108:111], v[64:67], v[68:71]
  v_mfma_f32_16x16x32_f16 v[72:75], v[148:151], v[60:63], v[72:75]
  v_pk_mul_f16 v60, v41, v49 op_sel:[0,0] op_sel_hi:[1,1]
  v_pk_mul_f16 v61, v42, v50 op_sel:[0,0] op_sel_hi:[1,1]
  v_mfma_f32_16x16x32_f16 v[72:75], v[152:155], v[64:67], v[72:75]
  v_pk_mul_f16 v62, v40, v49 op_sel:[0,0] op_sel_hi:[1,1]
  v_pk_mul_f16 v63, v40, v49 op_sel:[0,1] op_sel_hi:[1,0]
  v_mfma_f32_16x16x32_f16 v[72:75], v[156:159], v[52:55], v[72:75]
  v_pk_mul_f16 v64, v40, v50 op_sel:[0,0] op_sel_hi:[1,1]
  v_pk_mul_f16 v65, v40, v50 op_sel:[0,1] op_sel_hi:[1,0]
  s_cmp_lg_u32 s84, 0
  s_cbranch_scc1 L_pr110
  s_setprio 0
L_pr110:
  v_mfma_f32_16x16x32_f16 v[72:75], v[160:163], v[56:59], v[72:75]
  v_pk_mul_f16 v66, v41, v50 op_sel:[0,0] op_sel_hi:[1,1]
  v_pk_mul_f16 v67, v41, v50 op_sel:[0,1] op_sel_hi:[1,0]
  v_smfmac_f32_16x16x64_f16 v[80:83], v[232:235], v[52:59], v16
  s_waitcnt lgkmcnt(0)
  v_cvt_pk_f16_f32 v43, v38, v39
  v_cvt_pk_f16_f32 v40, v32, v35
  v_mfma_f32_16x16x32_f16 v[68:71], v[112:115], v[52:55], v[68:71]
  v_cvt_pk_f16_f32 v41, v33, v36
  v_cvt_pk_f16_f32 v42, v34, v37
  v_mfma_f32_16x16x32_f16 v[68:71], v[116:119], v[56:59], v[68:71]
  ds_write_b128 v10, v[40:43]
  v_mfma_f32_16x16x32_f16 v[76:79], v[200:203], v[52:55], v[76:79]
  ds_read_b64_tr_b16 v[52:53], v8 offset:96
  ds_read_b64_tr_b16 v[54:55], v8 offset:608
  v_mfma_f32_16x16x32_f16 v[76:79], v[204:207], v[56:59], v[76:79]
  v_pk_mul_f16 v56, v40, v40 op_sel:[0,0] op_sel_hi:[1,1]
  v_pk_mul_f16 v57, v41, v41 op_sel:[0,0] op_sel_hi:[1,1]
  v_mfma_f32_16x16x32_f16 v[72:75], v[164:167], v[60:63], v[72:75]
  v_pk_mul_f16 v58, v42, v42 op_sel:[0,0] op_sel_hi:[1,1]
  v_pk_mul_f16 v59, v40, v41 op_sel:[0,0] op_sel_hi:[1,1]
  v_mfma_f32_16x16x32_f16 v[72:75], v[168:171], v[64:67], v[72:75]
  ds_read_b128 v[44:47], v11
  ds_read_b128 v[48:51], v12
  v_smfmac_f32_16x16x64_f16 v[80:83], v[236:239], v[60:67], v16
  v_mfma_f32_16x16x32_f16 v[68:71], v[120:123], v[60:63], v[68:71]
  v_mfma_f32_16x16x32_f16 v[68:71], v[124:127], v[64:67], v[68:71]
  v_mfma_f32_16x16x32_f16 v[76:79], v[208:211], v[60:63], v[76:79]
  s_nop 4
  v_add_f32 v22, v80, v81
  v_add_f32 v23, v82, v83
  v_mfma_f32_16x16x32_f16 v[76:79], v[212:215], v[64:67], v[76:79]
  v_pk_mul_f16 v60, v40, v41 op_sel:[0,1] op_sel_hi:[1,0]
  v_pk_mul_f16 v61, v40, v42 op_sel:[0,0] op_sel_hi:[1,1]
  v_mfma_f32_16x16x32_f16 v[80:83], v[216:219], v[56:59], 0
  v_fmac_f32 v14, v68, v72
  v_fmac_f32 v14, v69, v73
  v_fmac_f32 v14, v70, v74
  v_fmac_f32 v14, v71, v75
  s_waitcnt lgkmcnt(2)
  v_mfma_f32_16x16x32_bf16 v[72:75], v[240:243], v[52:55], 0
  v_pk_mul_f16 v62, v40, v42 op_sel:[0,1] op_sel_hi:[1,0]
  v_pk_mul_f16 v63, v41, v42 op_sel:[0,0] op_sel_hi:[1,1]
  v_mfma_f32_16x16x32_f16 v[72:75], v[128:131], v[56:59], v[72:75]
  v_fmac_f32 v14, v76, v77
  v_fmac_f32 v14, v22, v78
  v_mfma_f32_16x16x32_f16 v[68:71], v[84:87], v[56:59], 0
  v_fmac_f32 v14, v23, v79
  v_pk_mul_f16 v64, v41, v42 op_sel:[0,1] op_sel_hi:[1,0]
  v_mfma_f32_16x16x32_bf16 v[76:79], v[244:247], v[52:55], 0
  v_pk_mul_f16 v65, v40, v43 op_sel:[0,0] op_sel_hi:[1,0]
  v_pk_mul_f16 v66, v41, v43 op_sel:[0,0] op_sel_hi:[1,0]
  v_mfma_f32_16x16x32_f16 v[76:79], v[172:175], v[56:59], v[76:79]
  v_pk_mul_f16 v67, v42, v43 op_sel:[0,0] op_sel_hi:[1,0]
  s_waitcnt lgkmcnt(0)
  v_alignbit_b32 v48, v48, v48, v13
  v_mfma_f32_16x16x32_f16 v[76:79], v[176:179], v[60:63], v[76:79]
  v_mul_f16_sdwa v52, v40, v40 dst_sel:WORD_0 dst_unused:UNUSED_PAD src0_sel:WORD_0 src1_sel:WORD_1
  v_mul_f16_sdwa v53, v42, v42 dst_sel:WORD_0 dst_unused:UNUSED_PAD src0_sel:WORD_0 src1_sel:WORD_1
  v_mfma_f32_16x16x32_f16 v[76:79], v[180:183], v[64:67], v[76:79]
  v_mul_f16_sdwa v52, v41, v41 dst_sel:WORD_1 dst_unused:UNUSED_PRESERVE src0_sel:WORD_0 src1_sel:WORD_1
  v_mul_f16_sdwa v53, v43, v43 dst_sel:WORD_1 dst_unused:UNUSED_PRESERVE src0_sel:WORD_0 src1_sel:WORD_1
  v_smfmac_f32_16x16x64_f16 v[80:83], v[220:223], v[60:67], v16
  v_pk_mul_f16 v54, v40, v47 op_sel:[0,0] op_sel_hi:[1,0]
  v_pk_mul_f16 v55, v41, v47 op_sel:[0,0] op_sel_hi:[1,0]
  v_mfma_f32_16x16x32_f16 v[68:71], v[88:91], v[60:63], v[68:71]
  v_pk_mul_f16 v56, v42, v47 op_sel:[0,0] op_sel_hi:[1,0]
  v_pk_mul_f16 v57, v40, v44 op_sel:[0,0] op_sel_hi:[1,1]
  v_mfma_f32_16x16x32_f16 v[68:71], v[92:95], v[64:67], v[68:71]
  v_add_u32 v7, s75, v7
  s_waitcnt vmcnt(1)
  v_pk_mul_f16 v58, v40, v44 op_sel:[0,1] op_sel_hi:[1,0]
  v_mfma_f32_16x16x32_f16 v[72:75], v[132:135], v[60:63], v[72:75]
  v_pk_mul_f16 v59, v40, v45 op_sel:[0,0] op_sel_hi:[1,1]
  v_pk_mul_f16 v60, v40, v45 op_sel:[0,1] op_sel_hi:[1,0]
  v_mfma_f32_16x16x32_f16 v[72:75], v[136:139], v[64:67], v[72:75]
  v_pk_mul_f16 v61, v40, v46 op_sel:[0,0] op_sel_hi:[1,1]
  v_pk_mul_f16 v62, v40, v46 op_sel:[0,1] op_sel_hi:[1,0]
  v_mfma_f32_16x16x32_f16 v[72:75], v[140:143], v[52:55], v[72:75]
  v_pk_mul_f16 v63, v41, v44 op_sel:[0,0] op_sel_hi:[1,1]
  v_pk_mul_f16 v64, v41, v44 op_sel:[0,1] op_sel_hi:[1,0]
  v_mfma_f32_16x16x32_f16 v[72:75], v[144:147], v[56:59], v[72:75]
  v_pk_mul_f16 v65, v41, v45 op_sel:[0,0] op_sel_hi:[1,1]
  v_pk_mul_f16 v66, v41, v45 op_sel:[0,1] op_sel_hi:[1,0]
  v_smfmac_f32_16x16x64_f16 v[80:83], v[224:227], v[52:59], v16
  v_pk_mul_f16 v67, v41, v46 op_sel:[0,0] op_sel_hi:[1,1]
  v_alignbit_b32 v49, v49, v49, v13
  v_mfma_f32_16x16x32_f16 v[68:71], v[96:99], v[52:55], v[68:71]
  v_alignbit_b32 v50, v50, v50, v13
  ds_read_u16_d16_hi v32, v7 offset:0
  v_mfma_f32_16x16x32_f16 v[68:71], v[100:103], v[56:59], v[68:71]
  ds_read_u16_d16_hi v33, v7 offset:128
  ds_read_u16_d16_hi v34, v7 offset:256
  v_mfma_f32_16x16x32_f16 v[76:79], v[184:187], v[52:55], v[76:79]
  v_pk_mul_f16 v52, v41, v46 op_sel:[0,1] op_sel_hi:[1,0]
  v_pk_mul_f16 v53, v42, v44 op_sel:[0,0] op_sel_hi:[1,1]
  v_mfma_f32_16x16x32_f16 v[76:79], v[188:191], v[56:59], v[76:79]
  v_pk_mul_f16 v54, v42, v44 op_sel:[0,1] op_sel_hi:[1,0]
  v_pk_mul_f16 v55, v42, v45 op_sel:[0,0] op_sel_hi:[1,1]
  v_mfma_f32_16x16x32_f16 v[76:79], v[192:195], v[60:63], v[76:79]
  v_pk_mul_f16 v56, v42, v45 op_sel:[0,1] op_sel_hi:[1,0]
  v_pk_mul_f16 v57, v42, v46 op_sel:[0,0] op_sel_hi:[1,1]
  v_mfma_f32_16x16x32_f16 v[76:79], v[196:199], v[64:67], v[76:79]
  v_pk_mul_f16 v58, v42, v46 op_sel:[0,1] op_sel_hi:[1,0]
  v_pk_mul_f16 v59, v40, v48 op_sel:[0,0] op_sel_hi:[1,1]
  v_smfmac_f32_16x16x64_f16 v[80:83], v[228:231], v[60:67], v16
  ds_read_u16_d16_hi v35, v7 offset:384
  ds_read_u16_d16_hi v36, v7 offset:512
  v_mfma_f32_16x16x32_f16 v[68:71], v[104:107], v[60:63], v[68:71]
  ds_read_u16_d16_hi v37, v7 offset:640
  ds_read_u16_d16_hi v38, v7 offset:768
  v_mfma_f32_16x16x32_f16 v[68:71], v[108:111], v[64:67], v[68:71]
  ds_read_u16_d16_hi v39, v7 offset:896
  s_add_u32 s81, s74, s75
  v_add_u32 v8, s81, v9
  v_mfma_f32_16x16x32_f16 v[72:75], v[148:151], v[60:63], v[72:75]
  v_pk_mul_f16 v60, v41, v49 op_sel:[0,0] op_sel_hi:[1,1]
  v_pk_mul_f16 v61, v42, v50 op_sel:[0,0] op_sel_hi:[1,1]
  v_mfma_f32_16x16x32_f16 v[72:75], v[152:155], v[64:67], v[72:75]
  v_pk_mul_f16 v62, v40, v49 op_sel:[0,0] op_sel_hi:[1,1]
  v_pk_mul_f16 v63, v40, v49 op_sel:[0,1] op_sel_hi:[1,0]
  v_mfma_f32_16x16x32_f16 v[72:75], v[156:159], v[52:55], v[72:75]
  v_pk_mul_f16 v64, v40, v50 op_sel:[0,0] op_sel_hi:[1,1]
  v_pk_mul_f16 v65, v40, v50 op_sel:[0,1] op_sel_hi:[1,0]
  v_mfma_f32_16x16x32_f16 v[72:75], v[160:163], v[56:59], v[72:75]
  v_pk_mul_f16 v66, v41, v50 op_sel:[0,0] op_sel_hi:[1,1]
  v_pk_mul_f16 v67, v41, v50 op_sel:[0,1] op_sel_hi:[1,0]
  v_smfmac_f32_16x16x64_f16 v[80:83], v[232:235], v[52:59], v16
  s_waitcnt lgkmcnt(0)
  v_cvt_pk_f16_f32 v43, v38, v39
  v_cvt_pk_f16_f32 v40, v32, v35
  v_mfma_f32_16x16x32_f16 v[68:71], v[112:115], v[52:55], v[68:71]
  v_cvt_pk_f16_f32 v41, v33, v36
  v_cvt_pk_f16_f32 v42, v34, v37
  v_mfma_f32_16x16x32_f16 v[68:71], v[116:119], v[56:59], v[68:71]
  ds_write_b128 v10, v[40:43]
  v_mfma_f32_16x16x32_f16 v[76:79], v[200:203], v[52:55], v[76:79]
  ds_read_b64_tr_b16 v[52:53], v8 offset:0
  ds_read_b64_tr_b16 v[54:55], v8 offset:512
  v_mfma_f32_16x16x32_f16 v[76:79], v[204:207], v[56:59], v[76:79]
  v_pk_mul_f16 v56, v40, v40 op_sel:[0,0] op_sel_hi:[1,1]
  v_pk_mul_f16 v57, v41, v41 op_sel:[0,0] op_sel_hi:[1,1]
  v_mfma_f32_16x16x32_f16 v[72:75], v[164:167], v[60:63], v[72:75]
  v_pk_mul_f16 v58, v42, v42 op_sel:[0,0] op_sel_hi:[1,1]
  v_pk_mul_f16 v59, v40, v41 op_sel:[0,0] op_sel_hi:[1,1]
  v_mfma_f32_16x16x32_f16 v[72:75], v[168:171], v[64:67], v[72:75]
  ds_read_b128 v[44:47], v11
  ds_read_b128 v[48:51], v12
  v_smfmac_f32_16x16x64_f16 v[80:83], v[236:239], v[60:67], v16
  v_mfma_f32_16x16x32_f16 v[68:71], v[120:123], v[60:63], v[68:71]
  v_mfma_f32_16x16x32_f16 v[68:71], v[124:127], v[64:67], v[68:71]
  v_mfma_f32_16x16x32_f16 v[76:79], v[208:211], v[60:63], v[76:79]
  s_nop 4
  v_add_f32 v22, v80, v81
  v_add_f32 v23, v82, v83
  v_mfma_f32_16x16x32_f16 v[76:79], v[212:215], v[64:67], v[76:79]
  v_pk_mul_f16 v60, v40, v41 op_sel:[0,1] op_sel_hi:[1,0]
  v_pk_mul_f16 v61, v40, v42 op_sel:[0,0] op_sel_hi:[1,1]
  s_cmp_lg_u32 s72, 1
  s_cbranch_scc1 L_cin_loop
  v_fmac_f32 v14, v68, v72
  v_fmac_f32 v14, v69, v73
  v_fmac_f32 v14, v70, v74
  v_fmac_f32 v14, v71, v75
  v_fmac_f32 v14, v76, v77
  v_fmac_f32 v14, v22, v78
  v_fmac_f32 v14, v23, v79
  s_nop 1
  v_add_f32_dpp v14, v14, v14 row_shr:1 row_mask:0xf bank_mask:0xf
  s_nop 1
  v_add_f32_dpp v14, v14, v14 row_shr:2 row_mask:0xf bank_mask:0xf
  s_nop 1
  v_add_f32_dpp v14, v14, v14 row_shr:4 row_mask:0xf bank_mask:0xf
  s_nop 1
  v_add_f32_dpp v14, v14, v14 row_shr:8 row_mask:0xf bank_mask:0xf
  s_nop 1
  v_add_f32_dpp v14, v14, v14 row_bcast:15 row_mask:0xa bank_mask:0xf
  s_nop 1
  v_add_f32_dpp v14, v14, v14 row_bcast:31 row_mask:0xc bank_mask:0xf
  s_branch L_blk
L_htail:
  v_fmac_f32 v14, v68, v72
  v_fmac_f32 v14, v69, v73
  v_fmac_f32 v14, v70, v74
  v_fmac_f32 v14, v71, v75
  v_fmac_f32 v14, v76, v77
  v_fmac_f32 v14, v22, v78
  v_fmac_f32 v14, v23, v79
  s_nop 1
  v_add_f32_dpp v14, v14, v14 row_shr:1 row_mask:0xf bank_mask:0xf
  s_nop 1
  v_add_f32_dpp v14, v14, v14 row_shr:2 row_mask:0xf bank_mask:0xf
  s_nop 1
  v_add_f32_dpp v14, v14, v14 row_shr:4 row_mask:0xf bank_mask:0xf
  s_nop 1
  v_add_f32_dpp v14, v14, v14 row_shr:8 row_mask:0xf bank_mask:0xf
  s_nop 1
  v_add_f32_dpp v14, v14, v14 row_bcast:15 row_mask:0xa bank_mask:0xf
  s_nop 1
  v_add_f32_dpp v14, v14, v14 row_bcast:31 row_mask:0xc bank_mask:0xf
  v_add_u32 v7, s75, v7
  s_branch L_blk
L_slow:
  v_lshlrev_b32 v22, 1, v0
  v_add_u32 v23, s74, v22
  s_mul_i32 s81, s3, 4224
  s_add_u32 s81, s81, 1024
  v_add_u32 v22, s81, v22
  v_add_u32 v8, s81, v9
  v_subrev_u32 v7, s75, v7
L_csync10:
  ds_read_b32 v4, v2 offset:12
  s_waitcnt lgkmcnt(0)
  v_cmp_gt_u32 vcc, 8, v4
  s_cbranch_vccnz L_csync10
  ds_read_u16 v52, v23 offset:0
  ds_read_u16 v53, v23 offset:128
  ds_read_u16 v54, v23 offset:256
  ds_read_u16 v55, v23 offset:384
  ds_read_u16 v56, v23 offset:512
  ds_read_u16 v57, v23 offset:640
  ds_read_u16 v58, v23 offset:768
  ds_read_u16 v59, v23 offset:896
  ds_read_u16 v60, v23 offset:1056
  ds_read_u16 v61, v23 offset:1184
  ds_read_u16 v62, v23 offset:1312
  ds_read_u16 v63, v23 offset:1440
  ds_read_u16 v64, v23 offset:1568
  ds_read_u16 v65, v23 offset:1696
  ds_read_u16 v66, v23 offset:1824
  ds_read_u16 v67, v23 offset:1952
  ds_read_u16 v68, v23 offset:2112
  ds_read_u16 v69, v23 offset:2240
  ds_read_u16 v70, v23 offset:2368
  ds_read_u16 v71, v23 offset:2496
  ds_read_u16 v72, v23 offset:2624
  ds_read_u16 v73, v23 offset:2752
  ds_read_u16 v74, v23 offset:2880
  ds_read_u16 v75, v23 offset:3008
  ds_read_u16 v76, v23 offset:3168
  ds_read_u16 v77, v23 offset:3296
  ds_read_u16 v78, v23 offset:3424
  ds_read_u16 v79, v23 offset:3552
  ds_read_u16 v80, v23 offset:3680
  ds_read_u16 v81, v23 offset:3808
  ds_read_u16 v82, v23 offset:3936
  s_waitcnt lgkmcnt(14)
  v_lshlrev_b32 v52, 16, v52
  v_lshlrev_b32 v53, 16, v53
  v_lshlrev_b32 v54, 16, v54
  v_lshlrev_b32 v55, 16, v55
  v_lshlrev_b32 v56, 16, v56
  v_lshlrev_b32 v57, 16, v57
  v_lshlrev_b32 v58, 16, v58
  v_lshlrev_b32 v59, 16, v59
  v_lshlrev_b32 v60, 16, v60
  v_lshlrev_b32 v61, 16, v61
  v_lshlrev_b32 v62, 16, v62
  v_lshlrev_b32 v63, 16, v63
  v_lshlrev_b32 v64, 16, v64
  v_lshlrev_b32 v65, 16, v65
  v_lshlrev_b32 v66, 16, v66
  v_lshlrev_b32 v67, 16, v67
  v_lshlrev_b32 v68, 16, v68
  s_waitcnt lgkmcnt(13)
  v_lshlrev_b32 v69, 16, v69
  s_waitcnt lgkmcnt(12)
  v_lshlrev_b32 v70, 16, v70
  s_waitcnt lgkmcnt(11)
  v_lshlrev_b32 v71, 16, v71
  s_waitcnt lgkmcnt(10)
  v_lshlrev_b32 v72, 16, v72
  s_waitcnt lgkmcnt(9)
  v_lshlrev_b32 v73, 16, v73
  s_waitcnt lgkmcnt(8)
  v_lshlrev_b32 v74, 16, v74
  s_waitcnt lgkmcnt(7)
  v_lshlrev_b32 v75, 16, v75
  s_waitcnt lgkmcnt(6)
  v_lshlrev_b32 v76, 16, v76
  s_waitcnt lgkmcnt(5)
  v_lshlrev_b32 v77, 16, v77
  s_waitcnt lgkmcnt(4)
  v_lshlrev_b32 v78, 16, v78
  s_waitcnt lgkmcnt(3)
  v_lshlrev_b32 v79, 16, v79
  s_waitcnt lgkmcnt(2)
  v_lshlrev_b32 v80, 16, v80
  s_waitcnt lgkmcnt(1)
  v_lshlrev_b32 v81, 16, v81
  s_waitcnt lgkmcnt(0)
  v_lshlrev_b32 v82, 16, v82
  v_max3_f32 v14, abs(v52), abs(v53), abs(v54)
  v_max3_f32 v14, v14, abs(v55), abs(v56)
  v_max3_f32 v14, v14, abs(v57), abs(v58)
  v_max3_f32 v14, v14, abs(v59), abs(v60)
  v_max3_f32 v14, v14, abs(v61), abs(v62)
  v_max3_f32 v14, v14, abs(v63), abs(v64)
  v_max3_f32 v14, v14, abs(v65), abs(v66)
  v_max3_f32 v14, v14, abs(v67), abs(v68)
  v_max3_f32 v14, v14, abs(v69), abs(v70)
  v_max3_f32 v14, v14, abs(v71), abs(v72)
  v_max3_f32 v14, v14, abs(v73), abs(v74)
  v_max3_f32 v14, v14, abs(v75), abs(v76)
  v_max3_f32 v14, v14, abs(v77), abs(v78)
  v_max3_f32 v14, v14, abs(v79), abs(v80)
  v_max3_f32 v14, v14, abs(v81), abs(v82)
  s_nop 1
  v_max_u32_dpp v14, v14, v14 row_shr:1 row_mask:0xf bank_mask:0xf
  s_nop 1
  v_max_u32_dpp v14, v14, v14 row_shr:2 row_mask:0xf bank_mask:0xf
  s_nop 1
  v_max_u32_dpp v14, v14, v14 row_shr:4 row_mask:0xf bank_mask:0xf
  s_nop 1
  v_max_u32_dpp v14, v14, v14 row_shr:8 row_mask:0xf bank_mask:0xf
  s_nop 1
  v_max_u32_dpp v14, v14, v14 row_bcast:15 row_mask:0xa bank_mask:0xf
  s_nop 1
  v_max_u32_dpp v14, v14, v14 row_bcast:31 row_mask:0xc bank_mask:0xf
  s_nop 0
  v_readlane_b32 s81, v14, 63
  s_nop 0
  s_lshr_b32 s81, s81, 23
  s_sub_i32 s81, 134, s81
  s_min_i32 s81, s81, 16
  s_lshl_b32 s49, s81, 2
  s_sub_i32 s49, s48, s49
  s_add_i32 s81, s81, 127
  s_lshl_b32 s81, s81, 23
  v_mov_b32 v83, s81
  v_mul_f32 v52, s81, v52
  v_mul_f32 v53, s81, v53
  v_mul_f32 v54, s81, v54
  v_mul_f32 v55, s81, v55
  v_mul_f32 v56, s81, v56
  v_mul_f32 v57, s81, v57
  v_mul_f32 v58, s81, v58
  v_mul_f32 v59, s81, v59
  v_mul_f32 v60, s81, v60
  v_mul_f32 v61, s81, v61
  v_mul_f32 v62, s81, v62
  v_mul_f32 v63, s81, v63
  v_mul_f32 v64, s81, v64
  v_mul_f32 v65, s81, v65
  v_mul_f32 v66, s81, v66
  v_mul_f32 v67, s81, v67
  v_mul_f32 v68, s81, v68
  v_mul_f32 v69, s81, v69
  v_mul_f32 v70, s81, v70
  v_mul_f32 v71, s81, v71
  v_mul_f32 v72, s81, v72
  v_mul_f32 v73, s81, v73
  v_mul_f32 v74, s81, v74
  v_mul_f32 v75, s81, v75
  v_mul_f32 v76, s81, v76
  v_mul_f32 v77, s81, v77
  v_mul_f32 v78, s81, v78
  v_mul_f32 v79, s81, v79
  v_mul_f32 v80, s81, v80
  v_mul_f32 v81, s81, v81
  v_mul_f32 v82, s81, v82
  ds_write_b16_d16_hi v23, v52 offset:0
  ds_write_b16_d16_hi v23, v53 offset:128
  ds_write_b16_d16_hi v23, v54 offset:256
  ds_write_b16_d16_hi v23, v55 offset:384
  ds_write_b16_d16_hi v23, v56 offset:512
  ds_write_b16_d16_hi v23, v57 offset:640
  ds_write_b16_d16_hi v23, v58 offset:768
  ds_write_b16_d16_hi v23, v59 offset:896
  ds_write_b16_d16_hi v23, v60 offset:1056
  ds_write_b16_d16_hi v23, v61 offset:1184
  ds_write_b16_d16_hi v23, v62 offset:1312
  ds_write_b16_d16_hi v23, v63 offset:1440
  ds_write_b16_d16_hi v23, v64 offset:1568
  ds_write_b16_d16_hi v23, v65 offset:1696
  ds_write_b16_d16_hi v23, v66 offset:1824
  ds_write_b16_d16_hi v23, v67 offset:1952
  ds_write_b16_d16_hi v23, v68 offset:2112
  ds_write_b16_d16_hi v23, v69 offset:2240
  ds_write_b16_d16_hi v23, v70 offset:2368
  ds_write_b16_d16_hi v23, v71 offset:2496
  ds_write_b16_d16_hi v23, v72 offset:2624
  ds_write_b16_d16_hi v23, v73 offset:2752
  ds_write_b16_d16_hi v23, v74 offset:2880
  ds_write_b16_d16_hi v23, v75 offset:3008
  ds_write_b16_d16_hi v23, v76 offset:3168
  ds_write_b16_d16_hi v23, v77 offset:3296
  ds_write_b16_d16_hi v23, v78 offset:3424
  ds_write_b16_d16_hi v23, v79 offset:3552
  ds_write_b16_d16_hi v23, v80 offset:3680
  ds_write_b16_d16_hi v23, v81 offset:3808
  ds_write_b16_d16_hi v23, v82 offset:3936
  v_mul_f32 v52, s81, v52
  v_mul_f32 v53, s81, v53
  v_mul_f32 v54, s81, v54
  v_mul_f32 v55, s81, v55
  v_mul_f32 v56, s81, v56
  v_mul_f32 v57, s81, v57
  v_mul_f32 v58, s81, v58
  v_mul_f32 v59, s81, v59
  v_mul_f32 v60, s81, v60
  v_mul_f32 v61, s81, v61
  v_mul_f32 v62, s81, v62
  v_mul_f32 v63, s81, v63
  v_mul_f32 v64, s81, v64
  v_mul_f32 v65, s81, v65
  v_mul_f32 v66, s81, v66
  v_mul_f32 v67, s81, v67
  v_mul_f32 v68, s81, v68
  v_mul_f32 v69, s81, v69
  v_mul_f32 v70, s81, v70
  v_mul_f32 v71, s81, v71
  v_mul_f32 v72, s81, v72
  v_mul_f32 v73, s81, v73
  v_mul_f32 v74, s81, v74
  v_mul_f32 v75, s81, v75
  v_mul_f32 v76, s81, v76
  v_mul_f32 v77, s81, v77
  v_mul_f32 v78, s81, v78
  v_mul_f32 v79, s81, v79
  v_mul_f32 v80, s81, v80
  v_mul_f32 v81, s81, v81
  v_mul_f32 v82, s81, v82
  v_mul_f32 v83, s81, v83
  ds_write_b16_d16_hi v22, v52 offset:0
  ds_write_b16_d16_hi v22, v53 offset:128
  ds_write_b16_d16_hi v22, v54 offset:256
  ds_write_b16_d16_hi v22, v55 offset:384
  ds_write_b16_d16_hi v22, v56 offset:512
  ds_write_b16_d16_hi v22, v57 offset:640
  ds_write_b16_d16_hi v22, v58 offset:768
  ds_write_b16_d16_hi v22, v59 offset:896
  ds_write_b16_d16_hi v22, v60 offset:1056
  ds_write_b16_d16_hi v22, v61 offset:1184
  ds_write_b16_d16_hi v22, v62 offset:1312
  ds_write_b16_d16_hi v22, v63 offset:1440
  ds_write_b16_d16_hi v22, v64 offset:1568
  ds_write_b16_d16_hi v22, v65 offset:1696
  ds_write_b16_d16_hi v22, v66 offset:1824
  ds_write_b16_d16_hi v22, v67 offset:1952
  ds_write_b16_d16_hi v22, v68 offset:2112
  ds_write_b16_d16_hi v22, v69 offset:2240
  ds_write_b16_d16_hi v22, v70 offset:2368
  ds_write_b16_d16_hi v22, v71 offset:2496
  ds_write_b16_d16_hi v22, v72 offset:2624
  ds_write_b16_d16_hi v22, v73 offset:2752
  ds_write_b16_d16_hi v22, v74 offset:2880
  ds_write_b16_d16_hi v22, v75 offset:3008
  ds_write_b16_d16_hi v22, v76 offset:3168
  ds_write_b16_d16_hi v22, v77 offset:3296
  ds_write_b16_d16_hi v22, v78 offset:3424
  ds_write_b16_d16_hi v22, v79 offset:3552
  ds_write_b16_d16_hi v22, v80 offset:3680
  ds_write_b16_d16_hi v22, v81 offset:3808
  ds_write_b16_d16_hi v22, v82 offset:3936
  ds_write_b16_d16_hi v22, v83 offset:4064
  s_mov_b32 s50, 0
  s_mov_b32 s97, 2
  s_waitcnt lgkmcnt(0)
  s_branch L_prime
L_cin_done:
  s_endpgm
L_rem:
  s_lshr_b32 s84, s3, 2
  s_and_b32 s68, s2, 7
  s_lshl_b32 s68, s68, 3
  s_add_u32 s68, s68, s3
  s_mul_i32 s68, s68, 6656
  s_lshl_b32 s76, s3, 14
  v_lshlrev_b32 v248, 4, v0
  v_lshrrev_b32 v246, 4, v0
  v_lshrrev_b32 v247, 3, v0
  v_mul_u32_u24 v13, 3328, v247
  v_and_b32 v247, 2, v247
  s_and_b32 s69, s3, 1
  s_lshl_b32 s69, s69, 2
  v_or_b32 v247, s69, v247
  v_and_b32 v9, 7, v0
  v_xor_b32 v247, v247, v9
  v_lshl_add_u32 v13, v247, 4, v13
  s_mul_i32 s74, s3, 26624
  s_add_u32 s74, s74, 3200
  s_lshl_b32 s75, s3, 10
  s_add_u32 s75, s75, 131072
  s_waitcnt lgkmcnt(0)
  s_mov_b32 s28, s4
  s_and_b32 s29, s5, 0xffff
  s_mov_b32 s30, 425984
  s_mov_b32 s31, 0x20000
  s_add_u32 m0, s76, 8192
  s_nop 0
  buffer_load_dwordx4 v248, s[28:31], s68 offen lds
  s_add_u32 s68, s68, 1024
  s_add_u32 m0, s76, 9216
  s_nop 0
  buffer_load_dwordx4 v248, s[28:31], s68 offen lds
  s_add_u32 s68, s68, 1024
  s_add_u32 m0, s76, 10240
  s_nop 0
  buffer_load_dwordx4 v248, s[28:31], s68 offen lds
  s_add_u32 s68, s68, 1024
  s_add_u32 m0, s76, 11264
  s_nop 0
  buffer_load_dwordx4 v248, s[28:31], s68 offen lds
  s_add_u32 s68, s68, 1024
  s_add_u32 m0, s76, 12288
  s_nop 0
  buffer_load_dwordx4 v248, s[28:31], s68 offen lds
  s_add_u32 s68, s68, 1024
  s_add_u32 m0, s76, 13312
  s_nop 0
  buffer_load_dwordx4 v248, s[28:31], s68 offen lds
  s_add_u32 s68, s68, 1024
  s_add_u32 m0, s76, 14336
  s_nop 0
  buffer_load_dwordx4 v248, s[28:31], s68 offen lds
  s_add_u32 s68, s68, 1024
  s_mov_b32 s44, s12
  s_and_b32 s45, s13, 0xffff
  s_mov_b32 s46, 5537792
  s_mov_b32 s47, 0x20000
  s_add_u32 m0, s75, 0
  s_nop 0
  buffer_load_dwordx4 v13, s[44:47], s74 offen lds
  s_add_u32 s74, s74, 212992
  s_mov_b32 s60, s24
  s_and_b32 s61, s25, 0xffff
  s_mov_b32 s62, 268435456
  s_mov_b32 s63, 0x20000
  s_mov_b32 s64, s22
  s_and_b32 s65, s23, 0xffff
  s_mov_b32 s66, 256
  s_mov_b32 s67, 0x20000
  v_mov_b32 v64, -1
  v_mov_b32 v65, -1
  v_mov_b32 v66, -1
  v_mov_b32 v67, -1
  s_and_b32 s70, s2, 7
  s_lshl_b32 s68, s70, 3
  s_add_u32 s68, s68, s3
  s_lshl_b32 s68, s68, 11
  s_lshl_b32 s70, s70, 2
  buffer_store_dwordx4 v[64:67], v248, s[60:63], s68 offen sc1
  buffer_store_dwordx4 v[64:67], v248, s[60:63], s68 offen offset:1024 sc1
  s_mov_b32 s48, s14
  s_and_b32 s49, s15, 0xffff
  s_mov_b32 s50, 3328
  s_mov_b32 s51, 0x20000
  s_mov_b32 s52, s16
  s_and_b32 s53, s17, 0xffff
  s_mov_b32 s54, 3328
  s_mov_b32 s55, 0x20000
  s_mov_b32 s32, s6
  s_and_b32 s33, s7, 0xffff
  s_mov_b32 s34, 12800000
  s_mov_b32 s35, 0x20000
  v_xor_b32 v248, v9, v246
  v_lshlrev_b32 v14, 4, v248
  v_xor_b32 v15, 64, v14
  v_bfe_u32 v247, v0, 2, 2
  v_lshl_add_u32 v248, v246, 3, v247
  v_lshlrev_b32 v248, 7, v248
  v_and_b32 v247, 3, v0
  v_lshl_add_u32 v248, v247, 3, v248
  v_add_u32 v248, 131072, v248
  v_bfe_u32 v247, v0, 3, 2
  v_lshl_add_u32 v1, v247, 5, v248
  v_xor_b32 v2, 32, v1
  v_xor_b32 v7, 64, v1
  v_xor_b32 v8, 96, v1
  v_and_b32 v248, 15, v0
  v_lshlrev_b32 v248, 7, v248
  v_bfe_u32 v247, v0, 1, 3
  v_xor_b32 v247, v247, v246
  v_lshl_add_u32 v248, v247, 4, v248
  v_add_u32 v11, s76, v248
  v_xor_b32 v12, 64, v11
  v_lshrrev_b32 v247, 3, v0
  v_lshl_add_u32 v248, v9, 3, v247
  v_mul_u32_u24 v248, 104, v248
  v_add_u32 v248, s76, v248
  v_mov_b32 v240, 0xc0135761
  v_mov_b32 v241, 0xc0135761
  v_mov_b32 v242, 0xbdd2d3e8
  v_mov_b32 v243, 0xbdd2d3e8
  v_mov_b32 v244, 0x71800000
  v_mov_b32 v160, 0
  v_mov_b32 v161, 0
  v_mov_b32 v162, 0
  v_mov_b32 v163, 0
  v_mov_b32 v164, 0
  v_mov_b32 v165, 0
  v_mov_b32 v166, 0
  v_mov_b32 v167, 0
  v_mov_b32 v168, 0
  v_mov_b32 v169, 0
  v_mov_b32 v170, 0
  v_mov_b32 v171, 0
  v_mov_b32 v172, 0
  v_mov_b32 v173, 0
  v_mov_b32 v174, 0
  v_mov_b32 v175, 0
  v_mov_b32 v176, 0
  v_mov_b32 v177, 0
  v_mov_b32 v178, 0
  v_mov_b32 v179, 0
  v_mov_b32 v180, 0
  v_mov_b32 v181, 0
  v_mov_b32 v182, 0
  v_mov_b32 v183, 0
  v_mov_b32 v184, 0
  v_mov_b32 v185, 0
  v_mov_b32 v186, 0
  v_mov_b32 v187, 0
  v_mov_b32 v188, 0
  v_mov_b32 v189, 0
  v_mov_b32 v190, 0
  v_mov_b32 v191, 0
  v_mov_b32 v192, 0
  v_mov_b32 v193, 0
  v_mov_b32 v194, 0
  v_mov_b32 v195, 0
  v_mov_b32 v196, 0
  v_mov_b32 v197, 0
  v_mov_b32 v198, 0
  v_mov_b32 v199, 0
  v_mov_b32 v200, 0
  v_mov_b32 v201, 0
  v_mov_b32 v202, 0
  v_mov_b32 v203, 0
  v_mov_b32 v204, 0
  v_mov_b32 v205, 0
  v_mov_b32 v206, 0
  v_mov_b32 v207, 0
  v_mov_b32 v208, 0
  v_mov_b32 v209, 0
  v_mov_b32 v210, 0
  v_mov_b32 v211, 0
  v_mov_b32 v212, 0
  v_mov_b32 v213, 0
  v_mov_b32 v214, 0
  v_mov_b32 v215, 0
  v_mov_b32 v216, 0
  v_mov_b32 v217, 0
  v_mov_b32 v218, 0
  v_mov_b32 v219, 0
  v_mov_b32 v220, 0
  v_mov_b32 v221, 0
  v_mov_b32 v222, 0
  v_mov_b32 v223, 0
  s_waitcnt vmcnt(0)
  ds_read_b64 v[32:33], v248 offset:8192
  ds_read_b64 v[34:35], v248 offset:8200
  ds_read_b64 v[36:37], v248 offset:8208
  ds_read_b64 v[38:39], v248 offset:8216
  ds_read_b64 v[40:41], v248 offset:8224
  ds_read_b64 v[42:43], v248 offset:8232
  ds_read_b64 v[44:45], v248 offset:8240
  ds_read_b64 v[46:47], v248 offset:8248
  ds_read_b64 v[48:49], v248 offset:8256
  ds_read_b64 v[50:51], v248 offset:8264
  ds_read_b64 v[52:53], v248 offset:8272
  ds_read_b64 v[54:55], v248 offset:8280
  ds_read_b64 v[56:57], v248 offset:8288
  v_mov_b32 v24, 0
  v_mov_b32 v25, 0
  v_mov_b32 v26, 0
  v_mov_b32 v27, 0
  v_mov_b32 v28, 0
  v_mov_b32 v29, 0
  v_mov_b32 v30, 0
  v_mov_b32 v31, 0
  v_mov_b32 v58, 0x7f000000
  v_mov_b32 v59, 0x7f000000
  s_waitcnt lgkmcnt(12)
  v_lshlrev_b32 v32, 7, v32
  s_nop 1
  v_add_u32_dpp v24, v32, v14 row_newbcast:0 row_mask:0xf bank_mask:0x3
  v_add_u32_dpp v25, v32, v15 row_newbcast:1 row_mask:0xf bank_mask:0x3
  v_add_u32_dpp v26, v32, v14 row_newbcast:2 row_mask:0xf bank_mask:0x3
  v_add_u32_dpp v27, v32, v15 row_newbcast:3 row_mask:0xf bank_mask:0x3
  v_add_u32_dpp v24, v32, v14 row_newbcast:8 row_mask:0xf bank_mask:0xc
  v_add_u32_dpp v25, v32, v15 row_newbcast:9 row_mask:0xf bank_mask:0xc
  v_add_u32_dpp v26, v32, v14 row_newbcast:10 row_mask:0xf bank_mask:0xc
  v_add_u32_dpp v27, v32, v15 row_newbcast:11 row_mask:0xf bank_mask:0xc
  s_add_u32 m0, s76, 0
  s_nop 0
  buffer_load_dwordx4 v24, s[32:35], 0 offen lds
  s_add_u32 m0, s76, 1024
  s_nop 0
  buffer_load_dwordx4 v25, s[32:35], 0 offen lds
  s_add_u32 m0, s76, 2048
  s_nop 0
  buffer_load_dwordx4 v26, s[32:35], 0 offen lds
  s_add_u32 m0, s76, 3072
  s_nop 0
  buffer_load_dwordx4 v27, s[32:35], 0 offen lds
  v_add_u32_dpp v28, v32, v14 row_newbcast:4 row_mask:0xf bank_mask:0x3
  v_add_u32_dpp v29, v32, v15 row_newbcast:5 row_mask:0xf bank_mask:0x3
  v_add_u32_dpp v30, v32, v14 row_newbcast:6 row_mask:0xf bank_mask:0x3
  v_add_u32_dpp v31, v32, v15 row_newbcast:7 row_mask:0xf bank_mask:0x3
  v_add_u32_dpp v28, v32, v14 row_newbcast:12 row_mask:0xf bank_mask:0xc
  v_add_u32_dpp v29, v32, v15 row_newbcast:13 row_mask:0xf bank_mask:0xc
  v_add_u32_dpp v30, v32, v14 row_newbcast:14 row_mask:0xf bank_mask:0xc
  v_add_u32_dpp v31, v32, v15 row_newbcast:15 row_mask:0xf bank_mask:0xc
  s_add_u32 m0, s76, 4096
  s_nop 0
  buffer_load_dwordx4 v28, s[32:35], 0 offen lds
  s_add_u32 m0, s76, 5120
  s_nop 0
  buffer_load_dwordx4 v29, s[32:35], 0 offen lds
  s_add_u32 m0, s76, 6144
  s_nop 0
  buffer_load_dwordx4 v30, s[32:35], 0 offen lds
  s_add_u32 m0, s76, 7168
  s_nop 0
  buffer_load_dwordx4 v31, s[32:35], 0 offen lds
  s_add_u32 m0, s75, 8192
  s_nop 0
  buffer_load_dwordx4 v13, s[44:47], s74 offen lds
  s_add_u32 s74, s74, 212992
  s_waitcnt lgkmcnt(0)
  v_lshlrev_b32 v57, 7, v57
  v_lshlrev_b32 v56, 7, v56
  v_lshlrev_b32 v55, 7, v55
  v_lshlrev_b32 v54, 7, v54
  v_lshlrev_b32 v53, 7, v53
  v_lshlrev_b32 v52, 7, v52
  v_lshlrev_b32 v51, 7, v51
  v_lshlrev_b32 v50, 7, v50
  v_lshlrev_b32 v49, 7, v49
  v_lshlrev_b32 v48, 7, v48
  v_lshlrev_b32 v47, 7, v47
  v_lshlrev_b32 v46, 7, v46
  v_lshlrev_b32 v45, 7, v45
  v_lshlrev_b32 v44, 7, v44
  v_lshlrev_b32 v43, 7, v43
  v_lshlrev_b32 v42, 7, v42
  v_lshlrev_b32 v41, 7, v41
  v_lshlrev_b32 v40, 7, v40
  v_lshlrev_b32 v39, 7, v39
  v_lshlrev_b32 v38, 7, v38
  v_lshlrev_b32 v37, 7, v37
  v_lshlrev_b32 v36, 7, v36
  v_lshlrev_b32 v35, 7, v35
  v_lshlrev_b32 v34, 7, v34
  v_lshlrev_b32 v33, 7, v33
  s_nop 1
  v_add_u32_dpp v24, v33, v14 row_newbcast:0 row_mask:0xf bank_mask:0x3
  v_add_u32_dpp v25, v33, v15 row_newbcast:1 row_mask:0xf bank_mask:0x3
  v_add_u32_dpp v26, v33, v14 row_newbcast:2 row_mask:0xf bank_mask:0x3
  v_add_u32_dpp v27, v33, v15 row_newbcast:3 row_mask:0xf bank_mask:0x3
  v_add_u32_dpp v24, v33, v14 row_newbcast:8 row_mask:0xf bank_mask:0xc
  v_add_u32_dpp v25, v33, v15 row_newbcast:9 row_mask:0xf bank_mask:0xc
  v_add_u32_dpp v26, v33, v14 row_newbcast:10 row_mask:0xf bank_mask:0xc
  v_add_u32_dpp v27, v33, v15 row_newbcast:11 row_mask:0xf bank_mask:0xc
  s_add_u32 m0, s76, 8192
  s_nop 0
  buffer_load_dwordx4 v24, s[32:35], 0 offen lds
  s_add_u32 m0, s76, 9216
  s_nop 0
  buffer_load_dwordx4 v25, s[32:35], 0 offen lds
  s_add_u32 m0, s76, 10240
  s_nop 0
  buffer_load_dwordx4 v26, s[32:35], 0 offen lds
  s_add_u32 m0, s76, 11264
  s_nop 0
  buffer_load_dwordx4 v27, s[32:35], 0 offen lds
  v_add_u32_dpp v28, v33, v14 row_newbcast:4 row_mask:0xf bank_mask:0x3
  v_add_u32_dpp v29, v33, v15 row_newbcast:5 row_mask:0xf bank_mask:0x3
  v_add_u32_dpp v30, v33, v14 row_newbcast:6 row_mask:0xf bank_mask:0x3
  v_add_u32_dpp v31, v33, v15 row_newbcast:7 row_mask:0xf bank_mask:0x3
  v_add_u32_dpp v28, v33, v14 row_newbcast:12 row_mask:0xf bank_mask:0xc
  v_add_u32_dpp v29, v33, v15 row_newbcast:13 row_mask:0xf bank_mask:0xc
  v_add_u32_dpp v30, v33, v14 row_newbcast:14 row_mask:0xf bank_mask:0xc
  v_add_u32_dpp v31, v33, v15 row_newbcast:15 row_mask:0xf bank_mask:0xc
  s_add_u32 m0, s76, 12288
  s_nop 0
  buffer_load_dwordx4 v28, s[32:35], 0 offen lds
  s_add_u32 m0, s76, 13312
  s_nop 0
  buffer_load_dwordx4 v29, s[32:35], 0 offen lds
  s_add_u32 m0, s76, 14336
  s_nop 0
  buffer_load_dwordx4 v30, s[32:35], 0 offen lds
  s_add_u32 m0, s76, 15360
  s_nop 0
  buffer_load_dwordx4 v31, s[32:35], 0 offen lds
  s_add_u32 m0, s75, 16384
  s_nop 0
  buffer_load_dwordx4 v13, s[44:47], s74 offen lds
  s_add_u32 s74, s74, 212992
  v_lshlrev_b32 v248, 3, v246
  s_mov_b32 s73, 3
  v_mov_b32 v9, v34
  s_nop 1
  v_add_u32_dpp v24, v9, v14 row_newbcast:0 row_mask:0xf bank_mask:0x3
  v_add_u32_dpp v25, v9, v15 row_newbcast:1 row_mask:0xf bank_mask:0x3
  v_add_u32_dpp v26, v9, v14 row_newbcast:2 row_mask:0xf bank_mask:0x3
  v_add_u32_dpp v27, v9, v15 row_newbcast:3 row_mask:0xf bank_mask:0x3
  v_add_u32_dpp v24, v9, v14 row_newbcast:8 row_mask:0xf bank_mask:0xc
  v_add_u32_dpp v25, v9, v15 row_newbcast:9 row_mask:0xf bank_mask:0xc
  v_add_u32_dpp v26, v9, v14 row_newbcast:10 row_mask:0xf bank_mask:0xc
  v_add_u32_dpp v27, v9, v15 row_newbcast:11 row_mask:0xf bank_mask:0xc
  s_waitcnt vmcnt(14)
  s_barrier
  ds_read_b128 v[76:79], v12 offset:2048
  ds_read_b128 v[72:75], v11 offset:2048
  ds_read_b128 v[68:71], v12 offset:0
  ds_read_b128 v[64:67], v11 offset:0
  ds_read_b64_tr_b16 v[96:97], v1 offset:0
  ds_read_b64_tr_b16 v[98:99], v1 offset:512
  ds_read_b64_tr_b16 v[100:101], v1 offset:4096
  ds_read_b64_tr_b16 v[102:103], v1 offset:4608
  ds_read_b64_tr_b16 v[104:105], v2 offset:0
  ds_read_b64_tr_b16 v[106:107], v2 offset:512
  ds_read_b64_tr_b16 v[108:109], v2 offset:4096
  ds_read_b64_tr_b16 v[110:111], v2 offset:4608
  ds_read_b64_tr_b16 v[112:113], v7 offset:0
  ds_read_b64_tr_b16 v[114:115], v7 offset:512
  ds_read_b64_tr_b16 v[116:117], v7 offset:4096
  ds_read_b64_tr_b16 v[118:119], v7 offset:4608
  ds_read_b64_tr_b16 v[120:121], v8 offset:0
  ds_read_b64_tr_b16 v[122:123], v8 offset:512
  ds_read_b64_tr_b16 v[124:125], v8 offset:4096
  ds_read_b64_tr_b16 v[126:127], v8 offset:4608
  s_cmp_lg_u32 s3, 7
  s_cbranch_scc1 L_rem_loop
  s_mov_b64 exec, 1
  buffer_store_dword v240, v14, s[64:67], s70 offen offset:128 sc1
  s_mov_b64 exec, -1
L_rem_loop:
  s_waitcnt vmcnt(9)
  s_barrier
  s_waitcnt lgkmcnt(8)
  v_mfma_f32_16x16x32_bf16 v[160:163], v[96:99], v[64:67], v[160:163]
  ds_read_b128 v[92:95], v12 offset:6144
  ds_read_b128 v[88:91], v11 offset:6144
  s_waitcnt lgkmcnt(14)
  v_mfma_f32_16x16x32_bf16 v[160:163], v[100:103], v[68:71], v[160:163]
  ds_read_b128 v[84:87], v12 offset:4096
  s_add_u32 m0, s76, 0
  s_nop 0
  buffer_load_dwordx4 v24, s[32:35], 0 offen lds
  v_mfma_f32_16x16x32_bf16 v[164:167], v[96:99], v[72:75], v[164:167]
  ds_read_b128 v[80:83], v11 offset:4096
  v_mfma_f32_16x16x32_bf16 v[164:167], v[100:103], v[76:79], v[164:167]
  ds_read_b64_tr_b16 v[128:129], v1 offset:8192
  s_waitcnt lgkmcnt(14)
  v_mfma_f32_16x16x32_bf16 v[176:179], v[104:107], v[64:67], v[176:179]
  ds_read_b64_tr_b16 v[130:131], v1 offset:8704
  s_add_u32 m0, s76, 1024
  s_nop 0
  buffer_load_dwordx4 v25, s[32:35], 0 offen lds
  s_waitcnt lgkmcnt(14)
  v_mfma_f32_16x16x32_bf16 v[176:179], v[108:111], v[68:71], v[176:179]
  ds_read_b64_tr_b16 v[132:133], v1 offset:12288
  v_mfma_f32_16x16x32_bf16 v[180:183], v[104:107], v[72:75], v[180:183]
  ds_read_b64_tr_b16 v[134:135], v1 offset:12800
  v_mfma_f32_16x16x32_bf16 v[180:183], v[108:111], v[76:79], v[180:183]
  ds_read_b64_tr_b16 v[136:137], v2 offset:8192
  s_waitcnt lgkmcnt(14)
  v_mfma_f32_16x16x32_bf16 v[192:195], v[112:115], v[64:67], v[192:195]
  ds_read_b64_tr_b16 v[138:139], v2 offset:8704
  s_add_u32 m0, s76, 2048
  s_nop 0
  buffer_load_dwordx4 v26, s[32:35], 0 offen lds
  s_waitcnt lgkmcnt(14)
  v_mfma_f32_16x16x32_bf16 v[192:195], v[116:119], v[68:71], v[192:195]
  ds_read_b64_tr_b16 v[140:141], v2 offset:12288
  v_mfma_f32_16x16x32_bf16 v[196:199], v[112:115], v[72:75], v[196:199]
  ds_read_b64_tr_b16 v[142:143], v2 offset:12800
  v_mfma_f32_16x16x32_bf16 v[196:199], v[116:119], v[76:79], v[196:199]
  v_add_u32_dpp v28, v9, v14 row_newbcast:4 row_mask:0xf bank_mask:0x3
  v_add_u32_dpp v29, v9, v15 row_newbcast:5 row_mask:0xf bank_mask:0x3
  s_waitcnt lgkmcnt(14)
  v_mfma_f32_16x16x32_bf16 v[208:211], v[120:123], v[64:67], v[208:211]
  s_add_u32 m0, s76, 3072
  s_nop 0
  buffer_load_dwordx4 v27, s[32:35], 0 offen lds
  v_add_u32_dpp v30, v9, v14 row_newbcast:6 row_mask:0xf bank_mask:0x3
  v_add_u32_dpp v31, v9, v15 row_newbcast:7 row_mask:0xf bank_mask:0x3
  s_waitcnt lgkmcnt(12)
  v_mfma_f32_16x16x32_bf16 v[208:211], v[124:127], v[68:71], v[208:211]
  v_add_u32_dpp v28, v9, v14 row_newbcast:12 row_mask:0xf bank_mask:0xc
  v_mfma_f32_16x16x32_bf16 v[212:215], v[120:123], v[72:75], v[212:215]
  v_add_u32_dpp v29, v9, v15 row_newbcast:13 row_mask:0xf bank_mask:0xc
  v_add_u32_dpp v30, v9, v14 row_newbcast:14 row_mask:0xf bank_mask:0xc
  v_mfma_f32_16x16x32_bf16 v[212:215], v[124:127], v[76:79], v[212:215]
  v_add_u32_dpp v31, v9, v15 row_newbcast:15 row_mask:0xf bank_mask:0xc
  s_waitcnt vmcnt(9)
  s_waitcnt lgkmcnt(8)
  v_mfma_f32_16x16x32_bf16 v[168:171], v[96:99], v[80:83], v[168:171]
  ds_read_b128 v[76:79], v12 offset:10240
  ds_read_b128 v[72:75], v11 offset:10240
  v_mfma_f32_16x16x32_bf16 v[168:171], v[100:103], v[84:87], v[168:171]
  ds_read_b128 v[68:71], v12 offset:8192
  s_add_u32 m0, s76, 4096
  s_nop 0
  buffer_load_dwordx4 v28, s[32:35], 0 offen lds
  v_mfma_f32_16x16x32_bf16 v[172:175], v[96:99], v[88:91], v[172:175]
  ds_read_b128 v[64:67], v11 offset:8192
  v_mfma_f32_16x16x32_bf16 v[172:175], v[100:103], v[92:95], v[172:175]
  ds_read_b64_tr_b16 v[144:145], v7 offset:8192
  v_mfma_f32_16x16x32_bf16 v[184:187], v[104:107], v[80:83], v[184:187]
  ds_read_b64_tr_b16 v[146:147], v7 offset:8704
  s_add_u32 m0, s76, 5120
  s_nop 0
  buffer_load_dwordx4 v29, s[32:35], 0 offen lds
  v_mfma_f32_16x16x32_bf16 v[184:187], v[108:111], v[84:87], v[184:187]
  ds_read_b64_tr_b16 v[148:149], v7 offset:12288
  v_mfma_f32_16x16x32_bf16 v[188:191], v[104:107], v[88:91], v[188:191]
  ds_read_b64_tr_b16 v[150:151], v7 offset:12800
  v_mfma_f32_16x16x32_bf16 v[188:191], v[108:111], v[92:95], v[188:191]
  ds_read_b64_tr_b16 v[152:153], v8 offset:8192
  s_add_u32 m0, s76, 6144
  s_nop 0
  buffer_load_dwordx4 v30, s[32:35], 0 offen lds
  v_mfma_f32_16x16x32_bf16 v[200:203], v[112:115], v[80:83], v[200:203]
  ds_read_b64_tr_b16 v[154:155], v8 offset:8704
  v_mfma_f32_16x16x32_bf16 v[200:203], v[116:119], v[84:87], v[200:203]
  ds_read_b64_tr_b16 v[156:157], v8 offset:12288
  v_mfma_f32_16x16x32_bf16 v[204:207], v[112:115], v[88:91], v[204:207]
  ds_read_b64_tr_b16 v[158:159], v8 offset:12800
  s_add_u32 m0, s76, 7168
  s_nop 0
  buffer_load_dwordx4 v31, s[32:35], 0 offen lds
  v_mfma_f32_16x16x32_bf16 v[204:207], v[116:119], v[92:95], v[204:207]
  s_set_gpr_idx_on s73, gpr_idx(SRC0)
  s_nop 0
  v_mov_b32 v9, v32
  s_set_gpr_idx_off
  s_add_u32 s73, s73, 1
  v_add_u32_dpp v24, v9, v14 row_newbcast:0 row_mask:0xf bank_mask:0x3
  v_mfma_f32_16x16x32_bf16 v[216:219], v[120:123], v[80:83], v[216:219]
  v_add_u32_dpp v25, v9, v15 row_newbcast:1 row_mask:0xf bank_mask:0x3
  v_add_u32_dpp v26, v9, v14 row_newbcast:2 row_mask:0xf bank_mask:0x3
  v_mfma_f32_16x16x32_bf16 v[216:219], v[124:127], v[84:87], v[216:219]
  s_xor_b32 s75, s75, 16384
  s_add_u32 m0, s75, 8192
  s_nop 0
  buffer_load_dwordx4 v13, s[44:47], s74 offen lds
  s_add_u32 s74, s74, 212992
  s_xor_b32 s75, s75, 16384
  v_add_u32_dpp v27, v9, v15 row_newbcast:3 row_mask:0xf bank_mask:0x3
  v_add_u32_dpp v24, v9, v14 row_newbcast:8 row_mask:0xf bank_mask:0xc
  v_mfma_f32_16x16x32_bf16 v[220:223], v[120:123], v[88:91], v[220:223]
  v_add_u32_dpp v25, v9, v15 row_newbcast:9 row_mask:0xf bank_mask:0xc
  v_add_u32_dpp v26, v9, v14 row_newbcast:10 row_mask:0xf bank_mask:0xc
  v_mfma_f32_16x16x32_bf16 v[220:223], v[124:127], v[92:95], v[220:223]
  v_add_u32_dpp v27, v9, v15 row_newbcast:11 row_mask:0xf bank_mask:0xc
  s_waitcnt vmcnt(9)
  s_barrier
  v_xor_b32 v1, 16384, v1
  v_xor_b32 v2, 16384, v2
  v_xor_b32 v7, 16384, v7
  v_xor_b32 v8, 16384, v8
  s_waitcnt lgkmcnt(8)
  v_mfma_f32_16x16x32_bf16 v[160:163], v[128:131], v[64:67], v[160:163]
  ds_read_b128 v[92:95], v12 offset:14336
  ds_read_b128 v[88:91], v11 offset:14336
  v_mfma_f32_16x16x32_bf16 v[160:163], v[132:135], v[68:71], v[160:163]
  ds_read_b128 v[84:87], v12 offset:12288
  s_add_u32 m0, s76, 8192
  s_nop 0
  buffer_load_dwordx4 v24, s[32:35], 0 offen lds
  v_mfma_f32_16x16x32_bf16 v[164:167], v[128:131], v[72:75], v[164:167]
  ds_read_b128 v[80:83], v11 offset:12288
  v_mfma_f32_16x16x32_bf16 v[164:167], v[132:135], v[76:79], v[164:167]
  ds_read_b64_tr_b16 v[96:97], v1 offset:0
  v_mfma_f32_16x16x32_bf16 v[176:179], v[136:139], v[64:67], v[176:179]
  ds_read_b64_tr_b16 v[98:99], v1 offset:512
  s_add_u32 m0, s76, 9216
  s_nop 0
  buffer_load_dwordx4 v25, s[32:35], 0 offen lds
  v_mfma_f32_16x16x32_bf16 v[176:179], v[140:143], v[68:71], v[176:179]
  ds_read_b64_tr_b16 v[100:101], v1 offset:4096
  v_mfma_f32_16x16x32_bf16 v[180:183], v[136:139], v[72:75], v[180:183]
  ds_read_b64_tr_b16 v[102:103], v1 offset:4608
  v_mfma_f32_16x16x32_bf16 v[180:183], v[140:143], v[76:79], v[180:183]
  ds_read_b64_tr_b16 v[104:105], v2 offset:0
  s_waitcnt lgkmcnt(14)
  v_mfma_f32_16x16x32_bf16 v[192:195], v[144:147], v[64:67], v[192:195]
  ds_read_b64_tr_b16 v[106:107], v2 offset:512
  s_add_u32 m0, s76, 10240
  s_nop 0
  buffer_load_dwordx4 v26, s[32:35], 0 offen lds
  s_waitcnt lgkmcnt(14)
  v_mfma_f32_16x16x32_bf16 v[192:195], v[148:151], v[68:71], v[192:195]
  ds_read_b64_tr_b16 v[108:109], v2 offset:4096
  v_mfma_f32_16x16x32_bf16 v[196:199], v[144:147], v[72:75], v[196:199]
  ds_read_b64_tr_b16 v[110:111], v2 offset:4608
  v_mfma_f32_16x16x32_bf16 v[196:199], v[148:151], v[76:79], v[196:199]
  v_add_u32_dpp v28, v9, v14 row_newbcast:4 row_mask:0xf bank_mask:0x3
  v_add_u32_dpp v29, v9, v15 row_newbcast:5 row_mask:0xf bank_mask:0x3
  s_waitcnt lgkmcnt(14)
  v_mfma_f32_16x16x32_bf16 v[208:211], v[152:155], v[64:67], v[208:211]
  s_add_u32 m0, s76, 11264
  s_nop 0
  buffer_load_dwordx4 v27, s[32:35], 0 offen lds
  v_add_u32_dpp v30, v9, v14 row_newbcast:6 row_mask:0xf bank_mask:0x3
  v_add_u32_dpp v31, v9, v15 row_newbcast:7 row_mask:0xf bank_mask:0x3
  s_waitcnt lgkmcnt(12)
  v_mfma_f32_16x16x32_bf16 v[208:211], v[156:159], v[68:71], v[208:211]
  v_add_u32_dpp v28, v9, v14 row_newbcast:12 row_mask:0xf bank_mask:0xc
  v_mfma_f32_16x16x32_bf16 v[212:215], v[152:155], v[72:75], v[212:215]
  v_add_u32_dpp v29, v9, v15 row_newbcast:13 row_mask:0xf bank_mask:0xc
  v_add_u32_dpp v30, v9, v14 row_newbcast:14 row_mask:0xf bank_mask:0xc
  v_mfma_f32_16x16x32_bf16 v[212:215], v[156:159], v[76:79], v[212:215]
  v_add_u32_dpp v31, v9, v15 row_newbcast:15 row_mask:0xf bank_mask:0xc
  s_waitcnt vmcnt(9)
  s_waitcnt lgkmcnt(8)
  v_mfma_f32_16x16x32_bf16 v[168:171], v[128:131], v[80:83], v[168:171]
  ds_read_b128 v[76:79], v12 offset:2048
  ds_read_b128 v[72:75], v11 offset:2048
  v_mfma_f32_16x16x32_bf16 v[168:171], v[132:135], v[84:87], v[168:171]
  ds_read_b128 v[68:71], v12 offset:0
  s_add_u32 m0, s76, 12288
  s_nop 0
  buffer_load_dwordx4 v28, s[32:35], 0 offen lds
  v_mfma_f32_16x16x32_bf16 v[172:175], v[128:131], v[88:91], v[172:175]
  ds_read_b128 v[64:67], v11 offset:0
  v_mfma_f32_16x16x32_bf16 v[172:175], v[132:135], v[92:95], v[172:175]
  ds_read_b64_tr_b16 v[112:113], v7 offset:0
  v_mfma_f32_16x16x32_bf16 v[184:187], v[136:139], v[80:83], v[184:187]
  ds_read_b64_tr_b16 v[114:115], v7 offset:512
  s_add_u32 m0, s76, 13312
  s_nop 0
  buffer_load_dwordx4 v29, s[32:35], 0 offen lds
  v_mfma_f32_16x16x32_bf16 v[184:187], v[140:143], v[84:87], v[184:187]
  ds_read_b64_tr_b16 v[116:117], v7 offset:4096
  v_mfma_f32_16x16x32_bf16 v[188:191], v[136:139], v[88:91], v[188:191]
  ds_read_b64_tr_b16 v[118:119], v7 offset:4608
  v_mfma_f32_16x16x32_bf16 v[188:191], v[140:143], v[92:95], v[188:191]
  ds_read_b64_tr_b16 v[120:121], v8 offset:0
  s_add_u32 m0, s76, 14336
  s_nop 0
  buffer_load_dwordx4 v30, s[32:35], 0 offen lds
  v_mfma_f32_16x16x32_bf16 v[200:203], v[144:147], v[80:83], v[200:203]
  ds_read_b64_tr_b16 v[122:123], v8 offset:512
  v_mfma_f32_16x16x32_bf16 v[200:203], v[148:151], v[84:87], v[200:203]
  ds_read_b64_tr_b16 v[124:125], v8 offset:4096
  v_mfma_f32_16x16x32_bf16 v[204:207], v[144:147], v[88:91], v[204:207]
  ds_read_b64_tr_b16 v[126:127], v8 offset:4608
  s_add_u32 m0, s76, 15360
  s_nop 0
  buffer_load_dwordx4 v31, s[32:35], 0 offen lds
  v_mfma_f32_16x16x32_bf16 v[204:207], v[148:151], v[92:95], v[204:207]
  s_set_gpr_idx_on s73, gpr_idx(SRC0)
  s_nop 0
  v_mov_b32 v9, v32
  s_set_gpr_idx_off
  s_add_u32 s73, s73, 1
  v_add_u32_dpp v24, v9, v14 row_newbcast:0 row_mask:0xf bank_mask:0x3
  v_mfma_f32_16x16x32_bf16 v[216:219], v[152:155], v[80:83], v[216:219]
  v_add_u32_dpp v25, v9, v15 row_newbcast:1 row_mask:0xf bank_mask:0x3
  v_add_u32_dpp v26, v9, v14 row_newbcast:2 row_mask:0xf bank_mask:0x3
  v_mfma_f32_16x16x32_bf16 v[216:219], v[156:159], v[84:87], v[216:219]
  s_add_u32 m0, s75, 0
  s_nop 0
  buffer_load_dwordx4 v13, s[44:47], s74 offen lds
  s_add_u32 s74, s74, 212992
  s_xor_b32 s75, s75, 16384
  v_add_u32_dpp v27, v9, v15 row_newbcast:3 row_mask:0xf bank_mask:0x3
  v_add_u32_dpp v24, v9, v14 row_newbcast:8 row_mask:0xf bank_mask:0xc
  v_mfma_f32_16x16x32_bf16 v[220:223], v[152:155], v[88:91], v[220:223]
  v_add_u32_dpp v25, v9, v15 row_newbcast:9 row_mask:0xf bank_mask:0xc
  v_add_u32_dpp v26, v9, v14 row_newbcast:10 row_mask:0xf bank_mask:0xc
  v_mfma_f32_16x16x32_bf16 v[220:223], v[156:159], v[92:95], v[220:223]
  v_add_u32_dpp v27, v9, v15 row_newbcast:11 row_mask:0xf bank_mask:0xc
  s_cmp_lt_u32 s73, 27
  s_cbranch_scc1 L_rem_loop
  s_waitcnt vmcnt(0)
  s_barrier
  s_waitcnt lgkmcnt(8)
  v_mfma_f32_16x16x32_bf16 v[160:163], v[96:99], v[64:67], v[160:163]
  ds_read_b128 v[92:95], v12 offset:6144
  ds_read_b128 v[88:91], v11 offset:6144
  v_mfma_f32_16x16x32_bf16 v[160:163], v[100:103], v[68:71], v[160:163]
  ds_read_b128 v[84:87], v12 offset:4096
  buffer_load_dwordx2 v[224:225], v248, s[48:51], 0 offen offset:3200
  v_mfma_f32_16x16x32_bf16 v[164:167], v[96:99], v[72:75], v[164:167]
  ds_read_b128 v[80:83], v11 offset:4096
  buffer_load_dwordx2 v[226:227], v248, s[48:51], 0 offen offset:3232
  v_mfma_f32_16x16x32_bf16 v[164:167], v[100:103], v[76:79], v[164:167]
  ds_read_b64_tr_b16 v[128:129], v1 offset:8192
  v_mfma_f32_16x16x32_bf16 v[176:179], v[104:107], v[64:67], v[176:179]
  ds_read_b64_tr_b16 v[130:131], v1 offset:8704
  buffer_load_dwordx2 v[228:229], v248, s[48:51], 0 offen offset:3264
  v_mfma_f32_16x16x32_bf16 v[176:179], v[108:111], v[68:71], v[176:179]
  ds_read_b64_tr_b16 v[132:133], v1 offset:12288
  v_mfma_f32_16x16x32_bf16 v[180:183], v[104:107], v[72:75], v[180:183]
  ds_read_b64_tr_b16 v[134:135], v1 offset:12800
  buffer_load_dwordx2 v[230:231], v248, s[48:51], 0 offen offset:3296
  v_mfma_f32_16x16x32_bf16 v[180:183], v[108:111], v[76:79], v[180:183]
  ds_read_b64_tr_b16 v[136:137], v2 offset:8192
  s_waitcnt lgkmcnt(14)
  v_mfma_f32_16x16x32_bf16 v[192:195], v[112:115], v[64:67], v[192:195]
  ds_read_b64_tr_b16 v[138:139], v2 offset:8704
  buffer_load_dwordx2 v[232:233], v248, s[52:55], 0 offen offset:3200
  s_waitcnt lgkmcnt(14)
  v_mfma_f32_16x16x32_bf16 v[192:195], v[116:119], v[68:71], v[192:195]
  ds_read_b64_tr_b16 v[140:141], v2 offset:12288
  v_mfma_f32_16x16x32_bf16 v[196:199], v[112:115], v[72:75], v[196:199]
  ds_read_b64_tr_b16 v[142:143], v2 offset:12800
  buffer_load_dwordx2 v[234:235], v248, s[52:55], 0 offen offset:3232
  v_mfma_f32_16x16x32_bf16 v[196:199], v[116:119], v[76:79], v[196:199]
  s_waitcnt lgkmcnt(14)
  v_mfma_f32_16x16x32_bf16 v[208:211], v[120:123], v[64:67], v[208:211]
  buffer_load_dwordx2 v[236:237], v248, s[52:55], 0 offen offset:3264
  s_waitcnt lgkmcnt(12)
  v_mfma_f32_16x16x32_bf16 v[208:211], v[124:127], v[68:71], v[208:211]
  v_mfma_f32_16x16x32_bf16 v[212:215], v[120:123], v[72:75], v[212:215]
  buffer_load_dwordx2 v[238:239], v248, s[52:55], 0 offen offset:3296
  v_mfma_f32_16x16x32_bf16 v[212:215], v[124:127], v[76:79], v[212:215]
  s_waitcnt lgkmcnt(8)
  v_mfma_f32_16x16x32_bf16 v[168:171], v[96:99], v[80:83], v[168:171]
  ds_read_b128 v[76:79], v12 offset:10240
  ds_read_b128 v[72:75], v11 offset:10240
  v_mfma_f32_16x16x32_bf16 v[168:171], v[100:103], v[84:87], v[168:171]
  ds_read_b128 v[68:71], v12 offset:8192
  v_mfma_f32_16x16x32_bf16 v[172:175], v[96:99], v[88:91], v[172:175]
  ds_read_b128 v[64:67], v11 offset:8192
  v_mfma_f32_16x16x32_bf16 v[172:175], v[100:103], v[92:95], v[172:175]
  ds_read_b64_tr_b16 v[144:145], v7 offset:8192
  v_mfma_f32_16x16x32_bf16 v[184:187], v[104:107], v[80:83], v[184:187]
  ds_read_b64_tr_b16 v[146:147], v7 offset:8704
  v_mfma_f32_16x16x32_bf16 v[184:187], v[108:111], v[84:87], v[184:187]
  ds_read_b64_tr_b16 v[148:149], v7 offset:12288
  v_mfma_f32_16x16x32_bf16 v[188:191], v[104:107], v[88:91], v[188:191]
  ds_read_b64_tr_b16 v[150:151], v7 offset:12800
  v_mfma_f32_16x16x32_bf16 v[188:191], v[108:111], v[92:95], v[188:191]
  ds_read_b64_tr_b16 v[152:153], v8 offset:8192
  v_mfma_f32_16x16x32_bf16 v[200:203], v[112:115], v[80:83], v[200:203]
  ds_read_b64_tr_b16 v[154:155], v8 offset:8704
  v_mfma_f32_16x16x32_bf16 v[200:203], v[116:119], v[84:87], v[200:203]
  ds_read_b64_tr_b16 v[156:157], v8 offset:12288
  v_mfma_f32_16x16x32_bf16 v[204:207], v[112:115], v[88:91], v[204:207]
  ds_read_b64_tr_b16 v[158:159], v8 offset:12800
  v_mfma_f32_16x16x32_bf16 v[204:207], v[116:119], v[92:95], v[204:207]
  v_mfma_f32_16x16x32_bf16 v[216:219], v[120:123], v[80:83], v[216:219]
  v_mfma_f32_16x16x32_bf16 v[216:219], v[124:127], v[84:87], v[216:219]
  v_mfma_f32_16x16x32_bf16 v[220:223], v[120:123], v[88:91], v[220:223]
  v_mfma_f32_16x16x32_bf16 v[220:223], v[124:127], v[92:95], v[220:223]
  s_waitcnt lgkmcnt(8)
  v_mfma_f32_16x16x32_bf16 v[160:163], v[128:131], v[64:67], v[160:163]
  ds_read_b128 v[92:95], v12 offset:14336
  v_mfma_f32_16x16x32_bf16 v[160:163], v[132:135], v[68:71], v[160:163]
  v_mfma_f32_16x16x32_bf16 v[164:167], v[128:131], v[72:75], v[164:167]
  ds_read_b128 v[88:91], v11 offset:14336
  v_mfma_f32_16x16x32_bf16 v[164:167], v[132:135], v[76:79], v[164:167]
  v_mfma_f32_16x16x32_bf16 v[176:179], v[136:139], v[64:67], v[176:179]
  v_mfma_f32_16x16x32_bf16 v[176:179], v[140:143], v[68:71], v[176:179]
  ds_read_b128 v[84:87], v12 offset:12288
  v_mfma_f32_16x16x32_bf16 v[180:183], v[136:139], v[72:75], v[180:183]
  v_mfma_f32_16x16x32_bf16 v[180:183], v[140:143], v[76:79], v[180:183]
  s_waitcnt lgkmcnt(9)
  v_mfma_f32_16x16x32_bf16 v[192:195], v[144:147], v[64:67], v[192:195]
  ds_read_b128 v[80:83], v11 offset:12288
  s_waitcnt lgkmcnt(8)
  v_mfma_f32_16x16x32_bf16 v[192:195], v[148:151], v[68:71], v[192:195]
  v_mfma_f32_16x16x32_bf16 v[196:199], v[144:147], v[72:75], v[196:199]
  v_mfma_f32_16x16x32_bf16 v[196:199], v[148:151], v[76:79], v[196:199]
  s_waitcnt lgkmcnt(6)
  v_mfma_f32_16x16x32_bf16 v[208:211], v[152:155], v[64:67], v[208:211]
  s_waitcnt lgkmcnt(4)
  v_mfma_f32_16x16x32_bf16 v[208:211], v[156:159], v[68:71], v[208:211]
  v_mfma_f32_16x16x32_bf16 v[212:215], v[152:155], v[72:75], v[212:215]
  v_mfma_f32_16x16x32_bf16 v[212:215], v[156:159], v[76:79], v[212:215]
  s_waitcnt lgkmcnt(0)
  v_mfma_f32_16x16x32_bf16 v[168:171], v[128:131], v[80:83], v[168:171]
  s_waitcnt vmcnt(7)
  v_lshlrev_b32 v112, 16, v224
  v_and_b32 v113, 0xffff0000, v224
  v_mfma_f32_16x16x32_bf16 v[168:171], v[132:135], v[84:87], v[168:171]
  s_waitcnt vmcnt(3)
  v_lshlrev_b32 v96, 16, v232
  v_and_b32 v97, 0xffff0000, v232
  v_mfma_f32_16x16x32_bf16 v[172:175], v[128:131], v[88:91], v[172:175]
  v_lshlrev_b32 v114, 16, v225
  v_and_b32 v115, 0xffff0000, v225
  v_mfma_f32_16x16x32_bf16 v[172:175], v[132:135], v[92:95], v[172:175]
  v_lshlrev_b32 v98, 16, v233
  v_and_b32 v99, 0xffff0000, v233
  v_mfma_f32_16x16x32_bf16 v[184:187], v[136:139], v[80:83], v[184:187]
  v_lshlrev_b32 v116, 16, v226
  v_and_b32 v117, 0xffff0000, v226
  v_mfma_f32_16x16x32_bf16 v[184:187], v[140:143], v[84:87], v[184:187]
  s_waitcnt vmcnt(2)
  v_lshlrev_b32 v100, 16, v234
  v_and_b32 v101, 0xffff0000, v234
  v_mfma_f32_16x16x32_bf16 v[188:191], v[136:139], v[88:91], v[188:191]
  v_lshlrev_b32 v118, 16, v227
  v_and_b32 v119, 0xffff0000, v227
  v_mfma_f32_16x16x32_bf16 v[188:191], v[140:143], v[92:95], v[188:191]
  v_lshlrev_b32 v102, 16, v235
  v_and_b32 v103, 0xffff0000, v235
  v_mfma_f32_16x16x32_bf16 v[200:203], v[144:147], v[80:83], v[200:203]
  v_lshlrev_b32 v120, 16, v228
  v_and_b32 v121, 0xffff0000, v228
  v_mfma_f32_16x16x32_bf16 v[200:203], v[148:151], v[84:87], v[200:203]
  s_waitcnt vmcnt(1)
  v_lshlrev_b32 v104, 16, v236
  v_and_b32 v105, 0xffff0000, v236
  v_mfma_f32_16x16x32_bf16 v[204:207], v[144:147], v[88:91], v[204:207]
  v_lshlrev_b32 v122, 16, v229
  v_and_b32 v123, 0xffff0000, v229
  v_mfma_f32_16x16x32_bf16 v[204:207], v[148:151], v[92:95], v[204:207]
  v_lshlrev_b32 v106, 16, v237
  v_and_b32 v107, 0xffff0000, v237
  v_mfma_f32_16x16x32_bf16 v[216:219], v[152:155], v[80:83], v[216:219]
  v_lshlrev_b32 v124, 16, v230
  v_and_b32 v125, 0xffff0000, v230
  v_mfma_f32_16x16x32_bf16 v[216:219], v[156:159], v[84:87], v[216:219]
  s_waitcnt vmcnt(0)
  v_lshlrev_b32 v108, 16, v238
  v_and_b32 v109, 0xffff0000, v238
  v_mfma_f32_16x16x32_bf16 v[220:223], v[152:155], v[88:91], v[220:223]
  v_lshlrev_b32 v126, 16, v231
  v_and_b32 v127, 0xffff0000, v231
  v_mfma_f32_16x16x32_bf16 v[220:223], v[156:159], v[92:95], v[220:223]
  v_lshlrev_b32 v110, 16, v239
  v_and_b32 v111, 0xffff0000, v239
  s_mov_b32 s60, s24
  s_and_b32 s61, s25, 0xffff
  s_mov_b32 s62, 268435456
  s_mov_b32 s63, 0x20000
  s_mov_b32 s64, s22
  s_and_b32 s65, s23, 0xffff
  s_mov_b32 s66, 256
  s_mov_b32 s67, 0x20000
  v_lshlrev_b32 v4, 2, v0
  s_mov_b64 exec, 0xff
  s_mov_b32 s81, 0x80000
  buffer_load_dword v255, v4, s[60:63], s81 offen
  buffer_load_dword v5, v4, s[64:67], 0 offen offset:128 sc1
  s_mov_b64 exec, -1
  v_mov_b32 v4, 0
  s_mov_b32 s56, s20
  s_and_b32 s57, s21, 0xffff
  s_mov_b32 s58, 8192
  s_mov_b32 s59, 0x20000
  s_load_dword s80, s[18:19], 0
  buffer_load_dword v255, v4, s[56:59], 0 offen
  s_and_b32 s70, s2, 7
  s_lshl_b32 s68, s70, 14
  s_lshl_b32 s69, s3, 8
  s_add_u32 s68, s68, s69
  s_add_u32 s69, s68, 4096
  s_add_u32 s71, s68, 8192
  s_lshl_b32 s70, s70, 3
  s_add_u32 s70, s70, s3
  s_lshl_b32 s70, s70, 7
  v_lshlrev_b32 v3, 2, v0
  v_lshlrev_b32 v2, 1, v0
  s_waitcnt lgkmcnt(0)
  s_lshl_b32 s80, s80, 16
  s_lshl_b32 s81, s3, 6
  v_add_u32 v1, s81, v0
  v_cmp_lt_u32 vcc, 503, v1
  v_add_u32 v1, 4096, v3
  v_mov_b32 v6, 0x7f000000
  v_cndmask_b32 v1, v6, v1, vcc
  v_rcp_f32 v96, v96
  v_rcp_f32 v97, v97
  v_rcp_f32 v98, v98
  v_rcp_f32 v99, v99
  v_rcp_f32 v100, v100
  v_rcp_f32 v101, v101
  v_rcp_f32 v102, v102
  v_rcp_f32 v103, v103
  v_rcp_f32 v104, v104
  v_rcp_f32 v105, v105
  v_rcp_f32 v106, v106
  v_rcp_f32 v107, v107
  v_rcp_f32 v108, v108
  v_rcp_f32 v109, v109
  v_rcp_f32 v110, v110
  v_rcp_f32 v111, v111
  v_med3_f32 v96, v96, -v244, v244
  v_med3_f32 v97, v97, -v244, v244
  v_med3_f32 v98, v98, -v244, v244
  v_med3_f32 v99, v99, -v244, v244
  v_med3_f32 v100, v100, -v244, v244
  v_med3_f32 v101, v101, -v244, v244
  v_med3_f32 v102, v102, -v244, v244
  v_med3_f32 v103, v103, -v244, v244
  v_med3_f32 v104, v104, -v244, v244
  v_med3_f32 v105, v105, -v244, v244
  v_med3_f32 v106, v106, -v244, v244
  v_med3_f32 v107, v107, -v244, v244
  v_med3_f32 v108, v108, -v244, v244
  v_med3_f32 v109, v109, -v244, v244
  v_med3_f32 v110, v110, -v244, v244
  v_med3_f32 v111, v111, -v244, v244
  v_pk_add_f32 v[160:161], v[160:161], v[112:113]
  v_pk_add_f32 v[162:163], v[162:163], v[114:115]
  v_pk_add_f32 v[164:165], v[164:165], v[112:113]
  v_pk_add_f32 v[166:167], v[166:167], v[114:115]
  v_pk_add_f32 v[168:169], v[168:169], v[112:113]
  v_pk_add_f32 v[170:171], v[170:171], v[114:115]
  v_pk_add_f32 v[172:173], v[172:173], v[112:113]
  v_pk_add_f32 v[174:175], v[174:175], v[114:115]
  v_pk_add_f32 v[176:177], v[176:177], v[116:117]
  v_pk_add_f32 v[178:179], v[178:179], v[118:119]
  v_pk_add_f32 v[180:181], v[180:181], v[116:117]
  v_pk_add_f32 v[182:183], v[182:183], v[118:119]
  v_pk_add_f32 v[184:185], v[184:185], v[116:117]
  v_pk_add_f32 v[186:187], v[186:187], v[118:119]
  v_pk_add_f32 v[188:189], v[188:189], v[116:117]
  v_pk_add_f32 v[190:191], v[190:191], v[118:119]
  v_pk_add_f32 v[192:193], v[192:193], v[120:121]
  v_pk_add_f32 v[194:195], v[194:195], v[122:123]
  v_pk_add_f32 v[196:197], v[196:197], v[120:121]
  v_pk_add_f32 v[198:199], v[198:199], v[122:123]
  v_pk_add_f32 v[200:201], v[200:201], v[120:121]
  v_pk_add_f32 v[202:203], v[202:203], v[122:123]
  v_pk_add_f32 v[204:205], v[204:205], v[120:121]
  v_pk_add_f32 v[206:207], v[206:207], v[122:123]
  v_pk_add_f32 v[208:209], v[208:209], v[124:125]
  v_pk_add_f32 v[210:211], v[210:211], v[126:127]
  v_pk_add_f32 v[212:213], v[212:213], v[124:125]
  v_pk_add_f32 v[214:215], v[214:215], v[126:127]
  v_pk_add_f32 v[216:217], v[216:217], v[124:125]
  v_pk_add_f32 v[218:219], v[218:219], v[126:127]
  v_pk_add_f32 v[220:221], v[220:221], v[124:125]
  v_pk_add_f32 v[222:223], v[222:223], v[126:127]
  v_pk_mul_f32 v[64:65], v[160:161], v[160:161]
  v_pk_mul_f32 v[68:69], v[164:165], v[164:165]
  v_pk_mul_f32 v[72:73], v[168:169], v[168:169]
  v_pk_mul_f32 v[76:77], v[172:173], v[172:173]
  v_pk_fma_f32 v[64:65], v[64:65], v[242:243], v[240:241]
  v_pk_fma_f32 v[68:69], v[68:69], v[242:243], v[240:241]
  v_pk_fma_f32 v[72:73], v[72:73], v[242:243], v[240:241]
  v_pk_fma_f32 v[76:77], v[76:77], v[242:243], v[240:241]
  v_pk_mul_f32 v[64:65], v[64:65], v[160:161]
  v_pk_mul_f32 v[68:69], v[68:69], v[164:165]
  v_pk_mul_f32 v[72:73], v[72:73], v[168:169]
  v_pk_mul_f32 v[76:77], v[76:77], v[172:173]
  v_exp_f32 v64, v64
  v_exp_f32 v65, v65
  v_exp_f32 v68, v68
  v_exp_f32 v69, v69
  v_exp_f32 v72, v72
  v_exp_f32 v73, v73
  v_exp_f32 v76, v76
  v_exp_f32 v77, v77
  v_pk_fma_f32 v[64:65], v[64:65], v[96:97], v[96:97]
  v_pk_fma_f32 v[68:69], v[68:69], v[96:97], v[96:97]
  v_pk_fma_f32 v[72:73], v[72:73], v[96:97], v[96:97]
  v_pk_fma_f32 v[76:77], v[76:77], v[96:97], v[96:97]
  v_rcp_f32 v64, v64
  v_rcp_f32 v65, v65
  v_rcp_f32 v68, v68
  v_rcp_f32 v69, v69
  v_rcp_f32 v72, v72
  v_rcp_f32 v73, v73
  v_rcp_f32 v76, v76
  v_rcp_f32 v77, v77
  v_pk_mul_f32 v[16:17], v[64:65], v[160:161]
  v_pk_mul_f32 v[18:19], v[68:69], v[164:165]
  v_pk_mul_f32 v[20:21], v[72:73], v[168:169]
  v_pk_mul_f32 v[22:23], v[76:77], v[172:173]
  v_pk_mul_f32 v[80:81], v[162:163], v[162:163]
  v_pk_mul_f32 v[84:85], v[166:167], v[166:167]
  v_pk_mul_f32 v[88:89], v[170:171], v[170:171]
  v_pk_mul_f32 v[92:93], v[174:175], v[174:175]
  v_pk_fma_f32 v[80:81], v[80:81], v[242:243], v[240:241]
  v_pk_fma_f32 v[84:85], v[84:85], v[242:243], v[240:241]
  v_pk_fma_f32 v[88:89], v[88:89], v[242:243], v[240:241]
  v_pk_fma_f32 v[92:93], v[92:93], v[242:243], v[240:241]
  v_pk_mul_f32 v[80:81], v[80:81], v[162:163]
  v_pk_mul_f32 v[84:85], v[84:85], v[166:167]
  v_pk_mul_f32 v[88:89], v[88:89], v[170:171]
  v_pk_mul_f32 v[92:93], v[92:93], v[174:175]
  v_exp_f32 v80, v80
  v_exp_f32 v81, v81
  v_exp_f32 v84, v84
  v_exp_f32 v85, v85
  v_exp_f32 v88, v88
  v_exp_f32 v89, v89
  v_exp_f32 v92, v92
  v_exp_f32 v93, v93
  v_pk_fma_f32 v[80:81], v[80:81], v[98:99], v[98:99]
  v_pk_fma_f32 v[84:85], v[84:85], v[98:99], v[98:99]
  v_pk_fma_f32 v[88:89], v[88:89], v[98:99], v[98:99]
  v_pk_fma_f32 v[92:93], v[92:93], v[98:99], v[98:99]
  v_rcp_f32 v80, v80
  v_rcp_f32 v81, v81
  v_rcp_f32 v84, v84
  v_rcp_f32 v85, v85
  v_rcp_f32 v88, v88
  v_rcp_f32 v89, v89
  v_rcp_f32 v92, v92
  v_rcp_f32 v93, v93
  v_pk_fma_f32 v[16:17], v[80:81], v[162:163], v[16:17]
  v_pk_fma_f32 v[18:19], v[84:85], v[166:167], v[18:19]
  v_pk_fma_f32 v[20:21], v[88:89], v[170:171], v[20:21]
  v_pk_fma_f32 v[22:23], v[92:93], v[174:175], v[22:23]
  v_pk_mul_f32 v[64:65], v[176:177], v[176:177]
  v_pk_mul_f32 v[68:69], v[180:181], v[180:181]
  v_pk_mul_f32 v[72:73], v[184:185], v[184:185]
  v_pk_mul_f32 v[76:77], v[188:189], v[188:189]
  v_pk_fma_f32 v[64:65], v[64:65], v[242:243], v[240:241]
  v_pk_fma_f32 v[68:69], v[68:69], v[242:243], v[240:241]
  v_pk_fma_f32 v[72:73], v[72:73], v[242:243], v[240:241]
  v_pk_fma_f32 v[76:77], v[76:77], v[242:243], v[240:241]
  v_pk_mul_f32 v[64:65], v[64:65], v[176:177]
  v_pk_mul_f32 v[68:69], v[68:69], v[180:181]
  v_pk_mul_f32 v[72:73], v[72:73], v[184:185]
  v_pk_mul_f32 v[76:77], v[76:77], v[188:189]
  v_exp_f32 v64, v64
  v_exp_f32 v65, v65
  v_exp_f32 v68, v68
  v_exp_f32 v69, v69
  v_exp_f32 v72, v72
  v_exp_f32 v73, v73
  v_exp_f32 v76, v76
  v_exp_f32 v77, v77
  v_pk_fma_f32 v[64:65], v[64:65], v[100:101], v[100:101]
  v_pk_fma_f32 v[68:69], v[68:69], v[100:101], v[100:101]
  v_pk_fma_f32 v[72:73], v[72:73], v[100:101], v[100:101]
  v_pk_fma_f32 v[76:77], v[76:77], v[100:101], v[100:101]
  v_rcp_f32 v64, v64
  v_rcp_f32 v65, v65
  v_rcp_f32 v68, v68
  v_rcp_f32 v69, v69
  v_rcp_f32 v72, v72
  v_rcp_f32 v73, v73
  v_rcp_f32 v76, v76
  v_rcp_f32 v77, v77
  v_pk_fma_f32 v[16:17], v[64:65], v[176:177], v[16:17]
  v_pk_fma_f32 v[18:19], v[68:69], v[180:181], v[18:19]
  v_pk_fma_f32 v[20:21], v[72:73], v[184:185], v[20:21]
  v_pk_fma_f32 v[22:23], v[76:77], v[188:189], v[22:23]
  v_pk_mul_f32 v[80:81], v[178:179], v[178:179]
  v_pk_mul_f32 v[84:85], v[182:183], v[182:183]
  v_pk_mul_f32 v[88:89], v[186:187], v[186:187]
  v_pk_mul_f32 v[92:93], v[190:191], v[190:191]
  v_pk_fma_f32 v[80:81], v[80:81], v[242:243], v[240:241]
  v_pk_fma_f32 v[84:85], v[84:85], v[242:243], v[240:241]
  v_pk_fma_f32 v[88:89], v[88:89], v[242:243], v[240:241]
  v_pk_fma_f32 v[92:93], v[92:93], v[242:243], v[240:241]
  v_pk_mul_f32 v[80:81], v[80:81], v[178:179]
  v_pk_mul_f32 v[84:85], v[84:85], v[182:183]
  v_pk_mul_f32 v[88:89], v[88:89], v[186:187]
  v_pk_mul_f32 v[92:93], v[92:93], v[190:191]
  v_exp_f32 v80, v80
  v_exp_f32 v81, v81
  v_exp_f32 v84, v84
  v_exp_f32 v85, v85
  v_exp_f32 v88, v88
  v_exp_f32 v89, v89
  v_exp_f32 v92, v92
  v_exp_f32 v93, v93
  v_pk_fma_f32 v[80:81], v[80:81], v[102:103], v[102:103]
  v_pk_fma_f32 v[84:85], v[84:85], v[102:103], v[102:103]
  v_pk_fma_f32 v[88:89], v[88:89], v[102:103], v[102:103]
  v_pk_fma_f32 v[92:93], v[92:93], v[102:103], v[102:103]
  v_rcp_f32 v80, v80
  v_rcp_f32 v81, v81
  v_rcp_f32 v84, v84
  v_rcp_f32 v85, v85
  v_rcp_f32 v88, v88
  v_rcp_f32 v89, v89
  v_rcp_f32 v92, v92
  v_rcp_f32 v93, v93
  v_pk_fma_f32 v[16:17], v[80:81], v[178:179], v[16:17]
  v_pk_fma_f32 v[18:19], v[84:85], v[182:183], v[18:19]
  v_pk_fma_f32 v[20:21], v[88:89], v[186:187], v[20:21]
  v_pk_fma_f32 v[22:23], v[92:93], v[190:191], v[22:23]
  v_pk_mul_f32 v[64:65], v[192:193], v[192:193]
  v_pk_mul_f32 v[68:69], v[196:197], v[196:197]
  v_pk_mul_f32 v[72:73], v[200:201], v[200:201]
  v_pk_mul_f32 v[76:77], v[204:205], v[204:205]
  v_pk_fma_f32 v[64:65], v[64:65], v[242:243], v[240:241]
  v_pk_fma_f32 v[68:69], v[68:69], v[242:243], v[240:241]
  v_pk_fma_f32 v[72:73], v[72:73], v[242:243], v[240:241]
  v_pk_fma_f32 v[76:77], v[76:77], v[242:243], v[240:241]
  v_pk_mul_f32 v[64:65], v[64:65], v[192:193]
  v_pk_mul_f32 v[68:69], v[68:69], v[196:197]
  v_pk_mul_f32 v[72:73], v[72:73], v[200:201]
  v_pk_mul_f32 v[76:77], v[76:77], v[204:205]
  v_exp_f32 v64, v64
  v_exp_f32 v65, v65
  v_exp_f32 v68, v68
  v_exp_f32 v69, v69
  v_exp_f32 v72, v72
  v_exp_f32 v73, v73
  v_exp_f32 v76, v76
  v_exp_f32 v77, v77
  v_pk_fma_f32 v[64:65], v[64:65], v[104:105], v[104:105]
  v_pk_fma_f32 v[68:69], v[68:69], v[104:105], v[104:105]
  v_pk_fma_f32 v[72:73], v[72:73], v[104:105], v[104:105]
  v_pk_fma_f32 v[76:77], v[76:77], v[104:105], v[104:105]
  v_rcp_f32 v64, v64
  v_rcp_f32 v65, v65
  v_rcp_f32 v68, v68
  v_rcp_f32 v69, v69
  v_rcp_f32 v72, v72
  v_rcp_f32 v73, v73
  v_rcp_f32 v76, v76
  v_rcp_f32 v77, v77
  v_pk_fma_f32 v[16:17], v[64:65], v[192:193], v[16:17]
  v_pk_fma_f32 v[18:19], v[68:69], v[196:197], v[18:19]
  v_pk_fma_f32 v[20:21], v[72:73], v[200:201], v[20:21]
  v_pk_fma_f32 v[22:23], v[76:77], v[204:205], v[22:23]
  v_pk_mul_f32 v[80:81], v[194:195], v[194:195]
  v_pk_mul_f32 v[84:85], v[198:199], v[198:199]
  v_pk_mul_f32 v[88:89], v[202:203], v[202:203]
  v_pk_mul_f32 v[92:93], v[206:207], v[206:207]
  v_pk_fma_f32 v[80:81], v[80:81], v[242:243], v[240:241]
  v_pk_fma_f32 v[84:85], v[84:85], v[242:243], v[240:241]
  v_pk_fma_f32 v[88:89], v[88:89], v[242:243], v[240:241]
  v_pk_fma_f32 v[92:93], v[92:93], v[242:243], v[240:241]
  v_pk_mul_f32 v[80:81], v[80:81], v[194:195]
  v_pk_mul_f32 v[84:85], v[84:85], v[198:199]
  v_pk_mul_f32 v[88:89], v[88:89], v[202:203]
  v_pk_mul_f32 v[92:93], v[92:93], v[206:207]
  v_exp_f32 v80, v80
  v_exp_f32 v81, v81
  v_exp_f32 v84, v84
  v_exp_f32 v85, v85
  v_exp_f32 v88, v88
  v_exp_f32 v89, v89
  v_exp_f32 v92, v92
  v_exp_f32 v93, v93
  v_pk_fma_f32 v[80:81], v[80:81], v[106:107], v[106:107]
  v_pk_fma_f32 v[84:85], v[84:85], v[106:107], v[106:107]
  v_pk_fma_f32 v[88:89], v[88:89], v[106:107], v[106:107]
  v_pk_fma_f32 v[92:93], v[92:93], v[106:107], v[106:107]
  v_rcp_f32 v80, v80
  v_rcp_f32 v81, v81
  v_rcp_f32 v84, v84
  v_rcp_f32 v85, v85
  v_rcp_f32 v88, v88
  v_rcp_f32 v89, v89
  v_rcp_f32 v92, v92
  v_rcp_f32 v93, v93
  v_pk_fma_f32 v[16:17], v[80:81], v[194:195], v[16:17]
  v_pk_fma_f32 v[18:19], v[84:85], v[198:199], v[18:19]
  v_pk_fma_f32 v[20:21], v[88:89], v[202:203], v[20:21]
  v_pk_fma_f32 v[22:23], v[92:93], v[206:207], v[22:23]
  v_pk_mul_f32 v[64:65], v[208:209], v[208:209]
  v_pk_mul_f32 v[68:69], v[212:213], v[212:213]
  v_pk_mul_f32 v[72:73], v[216:217], v[216:217]
  v_pk_mul_f32 v[76:77], v[220:221], v[220:221]
  v_pk_fma_f32 v[64:65], v[64:65], v[242:243], v[240:241]
  v_pk_fma_f32 v[68:69], v[68:69], v[242:243], v[240:241]
  v_pk_fma_f32 v[72:73], v[72:73], v[242:243], v[240:241]
  v_pk_fma_f32 v[76:77], v[76:77], v[242:243], v[240:241]
  v_pk_mul_f32 v[64:65], v[64:65], v[208:209]
  v_pk_mul_f32 v[68:69], v[68:69], v[212:213]
  v_pk_mul_f32 v[72:73], v[72:73], v[216:217]
  v_pk_mul_f32 v[76:77], v[76:77], v[220:221]
  v_exp_f32 v64, v64
  v_exp_f32 v65, v65
  v_exp_f32 v68, v68
  v_exp_f32 v69, v69
  v_exp_f32 v72, v72
  v_exp_f32 v73, v73
  v_exp_f32 v76, v76
  v_exp_f32 v77, v77
  v_pk_fma_f32 v[64:65], v[64:65], v[108:109], v[108:109]
  v_pk_fma_f32 v[68:69], v[68:69], v[108:109], v[108:109]
  v_pk_fma_f32 v[72:73], v[72:73], v[108:109], v[108:109]
  v_pk_fma_f32 v[76:77], v[76:77], v[108:109], v[108:109]
  v_rcp_f32 v64, v64
  v_rcp_f32 v65, v65
  v_rcp_f32 v68, v68
  v_rcp_f32 v69, v69
  v_rcp_f32 v72, v72
  v_rcp_f32 v73, v73
  v_rcp_f32 v76, v76
  v_rcp_f32 v77, v77
  v_pk_fma_f32 v[16:17], v[64:65], v[208:209], v[16:17]
  v_pk_fma_f32 v[18:19], v[68:69], v[212:213], v[18:19]
  v_pk_fma_f32 v[20:21], v[72:73], v[216:217], v[20:21]
  v_pk_fma_f32 v[22:23], v[76:77], v[220:221], v[22:23]
  v_pk_mul_f32 v[80:81], v[210:211], v[210:211]
  v_pk_mul_f32 v[84:85], v[214:215], v[214:215]
  v_pk_mul_f32 v[88:89], v[218:219], v[218:219]
  v_pk_mul_f32 v[92:93], v[222:223], v[222:223]
  v_pk_fma_f32 v[80:81], v[80:81], v[242:243], v[240:241]
  v_pk_fma_f32 v[84:85], v[84:85], v[242:243], v[240:241]
  v_pk_fma_f32 v[88:89], v[88:89], v[242:243], v[240:241]
  v_pk_fma_f32 v[92:93], v[92:93], v[242:243], v[240:241]
  v_pk_mul_f32 v[80:81], v[80:81], v[210:211]
  v_pk_mul_f32 v[84:85], v[84:85], v[214:215]
  v_pk_mul_f32 v[88:89], v[88:89], v[218:219]
  v_pk_mul_f32 v[92:93], v[92:93], v[222:223]
  v_exp_f32 v80, v80
  v_exp_f32 v81, v81
  v_exp_f32 v84, v84
  v_exp_f32 v85, v85
  v_exp_f32 v88, v88
  v_exp_f32 v89, v89
  v_exp_f32 v92, v92
  v_exp_f32 v93, v93
  v_pk_fma_f32 v[80:81], v[80:81], v[110:111], v[110:111]
  v_pk_fma_f32 v[84:85], v[84:85], v[110:111], v[110:111]
  v_pk_fma_f32 v[88:89], v[88:89], v[110:111], v[110:111]
  v_pk_fma_f32 v[92:93], v[92:93], v[110:111], v[110:111]
  v_rcp_f32 v80, v80
  v_rcp_f32 v81, v81
  v_rcp_f32 v84, v84
  v_rcp_f32 v85, v85
  v_rcp_f32 v88, v88
  v_rcp_f32 v89, v89
  v_rcp_f32 v92, v92
  v_rcp_f32 v93, v93
  v_pk_fma_f32 v[16:17], v[80:81], v[210:211], v[16:17]
  v_pk_fma_f32 v[18:19], v[84:85], v[214:215], v[18:19]
  v_pk_fma_f32 v[20:21], v[88:89], v[218:219], v[20:21]
  v_pk_fma_f32 v[22:23], v[92:93], v[222:223], v[22:23]
  v_add_f32 v16, v16, v17
  v_add_f32 v18, v18, v19
  v_add_f32 v20, v20, v21
  v_add_f32 v22, v22, v23
  s_nop 0
  v_permlane32_swap_b32 v16, v20
  v_permlane32_swap_b32 v18, v22
  v_add_f32 v16, v16, v20
  v_add_f32 v18, v18, v22
  s_nop 1
  v_permlane16_swap_b32 v16, v18
  v_add_f32 v16, v16, v18
  v_add_f32 v16, s80, v16
  s_waitcnt vmcnt(1)
  v_cmp_eq_u32 vcc, 0, v5
  s_nop 0
  s_and_b32 vcc_lo, vcc_lo, 0xff
  s_cbranch_scc0 L_rclr_ok
  s_mov_b32 s78, 0x40000
L_rclr:
  s_sub_u32 s78, s78, 1
  s_cbranch_scc1 L_rclr_ok
  v_lshlrev_b32 v5, 2, v0
  v_and_b32 v5, 31, v5
  buffer_load_dword v5, v5, s[64:67], 0 offen offset:128 sc1
  s_waitcnt vmcnt(0)
  v_cmp_eq_u32 vcc, 0, v5
  s_nop 0
  s_and_b32 vcc_lo, vcc_lo, 0xff
  s_cbranch_scc1 L_rclr
L_rclr_ok:
  s_mov_b32 s72, 0x40000
L_poll:
  s_sub_u32 s72, s72, 1
  s_cbranch_scc1 L_pollx
  buffer_load_dword v64, v3, s[60:63], s68 offen offset:0 sc1
  buffer_load_dword v65, v3, s[60:63], s68 offen offset:2048 sc1
  buffer_load_dword v66, v3, s[60:63], s69 offen offset:0 sc1
  buffer_load_dword v67, v3, s[60:63], s69 offen offset:2048 sc1
  buffer_load_dword v68, v3, s[60:63], s71 offen offset:0 sc1
  buffer_load_dword v69, v3, s[60:63], s71 offen offset:2048 sc1
  buffer_load_dword v70, v1, s[60:63], s71 offen sc1
  s_waitcnt vmcnt(4)
  v_max3_u32 v72, v64, v65, v66
  s_waitcnt vmcnt(1)
  v_max3_u32 v73, v67, v68, v69
  s_waitcnt vmcnt(0)
  v_max3_u32 v72, v72, v73, v70
  v_cmp_eq_u32 vcc, -1, v72
  s_cbranch_vccnz L_poll
L_pollx:
  v_add_f32 v64, v64, v65
  v_add_f32 v66, v66, v67
  v_add_f32 v68, v68, v69
  v_add_f32 v16, v16, v70
  v_add_f32 v64, v64, v66
  v_add_f32 v68, v68, v16
  v_add_f32 v64, v64, v68
  v_cvt_pk_bf16_f32 v64, v64, v64
  buffer_store_short v64, v2, s[56:59], s70 offen
  s_endpgm
L_end:
  s_endpgm
.section .rodata,"a"
.p2align 6
.amdhsa_kernel standalone__deep_cross_xdeepfm__recsys_kernel
  .amdhsa_next_free_vgpr 256
  .amdhsa_next_free_sgpr 102
  .amdhsa_accum_offset 256
  .amdhsa_group_segment_fixed_size 0
  .amdhsa_kernarg_size 88
  .amdhsa_user_sgpr_count 2
  .amdhsa_user_sgpr_kernarg_segment_ptr 1
  .amdhsa_system_sgpr_workgroup_id_x 1
  .amdhsa_float_denorm_mode_32 3
.end_amdhsa_kernel
```

```asm
; @launch grid=(256,1,1) block=(512,1,1) lds=163840
.amdgcn_target "amdgcn-amd-amdhsa--gfx950"
.text
.globl standalone__deep_cross_xdeepfm__recsys_kernel
.p2align 8
.type standalone__deep_cross_xdeepfm__recsys_kernel,@function
standalone__deep_cross_xdeepfm__recsys_kernel:
  s_cmp_ge_u32 s2, 256
  s_cbranch_scc1 L_end
  s_load_dwordx16 s[4:19], s[0:1], 0
  s_load_dwordx4 s[20:23], s[0:1], 64
  s_load_dwordx2 s[24:25], s[0:1], 80
  v_lshrrev_b32 v1, 6, v0
  s_getpc_b64 s[92:93]
L_pc:
  s_and_b32 s68, s2, 0xf8
  v_add_u32 v2, s68, v1
  v_lshlrev_b32 v2, 7, v2
  v_and_b32 v3, 1, v0
  v_lshl_add_u32 v2, v3, 15, v2
  v_min_u32 v2, L_end-L_pc, v2
  v_mov_b32 v3, s93
  v_add_co_u32 v2, vcc, s92, v2
  s_nop 1
  v_addc_co_u32 v3, vcc, 0, v3, vcc
  global_load_dword v255, v[2:3], off
  v_and_b32 v0, 63, v0
  v_readfirstlane_b32 s3, v1
  s_and_b32 s68, s2, 7
  s_lshl_b32 s68, s68, 2
  s_lshr_b32 s26, s2, 6
  s_add_u32 s26, s26, s68
  s_bfe_u32 s27, s2, 0x30003
  s_and_b32 s80, s2, 0xf8
  s_add_u32 s80, s80, s3
  s_lshl_b32 s80, s80, 21
  s_cmp_ge_u32 s27, 5
  s_cbranch_scc1 L_cin
  s_mul_i32 s77, s27, 640
  s_mul_i32 s70, s3, 7
  v_min_u32 v132, 6, v0
  v_add_u32 v132, s70, v132
  v_min_u32 v132, 51, v132
  v_lshrrev_b32 v130, 1, v132
  v_mul_u32_u24 v130, 96, v130
  v_lshl_add_u32 v132, v132, 2, v130
  s_mul_i32 s78, s27, 26
  s_min_u32 s78, s78, 102
  s_lshl_b32 s71, s26, 7
  s_add_u32 s78, s78, s71
  s_mul_i32 s78, s78, 104
  s_and_b32 s70, s26, 3
  s_lshl_b32 s70, s70, 3
  s_add_u32 s70, s70, s3
  s_mul_i32 s70, s70, 3328
  s_add_u32 s81, s70, s77
  v_min_u32 v124, 15, v0
  v_lshrrev_b32 v130, 3, v124
  s_mov_b32 s70, 106496
  v_mul_u32_u24 v130, s70, v130
  v_and_b32 v124, 7, v124
  v_min_u32 v124, 4, v124
  v_lshl_add_u32 v124, v124, 7, v130
  s_xor_b32 s70, s3, 4
  s_lshl_b32 s70, s70, 4
  s_add_u32 s70, s70, s71
  v_lshrrev_b32 v128, 3, v0
  v_add_u32 v128, s70, v128
  v_mul_u32_u24 v13, 104, v128
  s_waitcnt lgkmcnt(0)
  s_mov_b32 s28, s4
  s_and_b32 s29, s5, 0xffff
  s_mov_b32 s30, 425984
  s_mov_b32 s31, 0x20000
  buffer_load_dwordx3 v[120:122], v132, s[28:31], s78 offen
  buffer_load_dwordx2 v[112:113], v13, s[28:31], 0 offen offset:0
  buffer_load_dwordx2 v[116:117], v13, s[28:31], 0 offen offset:832
  s_mov_b32 s32, s6
  s_and_b32 s33, s7, 0xffff
  s_mov_b32 s34, 12800000
  s_mov_b32 s35, 0x20000
  v_mov_b32 v136, s80
  buffer_load_dword v255, v136, s[32:35], 0 offen
  v_lshlrev_b32 v37, 4, v0
  s_mov_b32 s48, s14
  s_and_b32 s49, s15, 0xffff
  s_mov_b32 s50, 3328
  s_mov_b32 s51, 0x20000
  s_mov_b32 s44, s12
  s_and_b32 s45, s13, 0xffff
  s_mov_b32 s46, 5537792
  s_mov_b32 s47, 0x20000
  buffer_load_dword v255, v124, s[44:47], s81 offen
  s_mov_b32 m0, 155648
  s_mov_b32 exec_hi, 0xff
  buffer_load_dwordx4 v37, s[48:51], s77 offen lds
  s_mov_b64 exec, -1
  s_lshr_b32 s68, s3, 2
  s_and_b32 s69, s3, 3
  s_mov_b32 s70, 1639
  s_and_b32 s78, s69, 1
  s_lshl_b32 s78, s78, 2
  s_mov_b32 s81, 3328
  v_mov_b32 v128, v0
  v_mul_u32_u24 v129, s70, v128
  v_lshrrev_b32 v129, 16, v129
  v_mul_u32_u24 v132, 40, v129
  v_sub_u32 v132, v128, v132
  v_and_b32 v131, 2, v129
  v_or_b32 v131, s78, v131
  v_xor_b32 v132, v132, v131
  v_mul_u32_u24 v129, s81, v129
  v_lshl_add_u32 v29, v132, 4, v129
  v_add_u32 v128, 64, v128
  v_mul_u32_u24 v129, s70, v128
  v_lshrrev_b32 v129, 16, v129
  v_mul_u32_u24 v132, 40, v129
  v_sub_u32 v132, v128, v132
  v_and_b32 v131, 2, v129
  v_or_b32 v131, s78, v131
  v_xor_b32 v132, v132, v131
  v_mul_u32_u24 v129, s81, v129
  v_lshl_add_u32 v30, v132, 4, v129
  v_subrev_u32 v30, 1024, v30
  v_add_u32 v128, 64, v128
  v_mul_u32_u24 v129, s70, v128
  v_lshrrev_b32 v129, 16, v129
  v_mul_u32_u24 v132, 40, v129
  v_sub_u32 v132, v128, v132
  v_and_b32 v131, 2, v129
  v_or_b32 v131, s78, v131
  v_xor_b32 v132, v132, v131
  v_mul_u32_u24 v129, s81, v129
  v_lshl_add_u32 v31, v132, 4, v129
  v_subrev_u32 v31, 2048, v31
  v_add_u32 v128, 64, v128
  v_mul_u32_u24 v129, s70, v128
  v_lshrrev_b32 v129, 16, v129
  v_mul_u32_u24 v132, 40, v129
  v_sub_u32 v132, v128, v132
  v_and_b32 v131, 2, v129
  v_or_b32 v131, s78, v131
  v_xor_b32 v132, v132, v131
  v_mul_u32_u24 v129, s81, v129
  v_lshl_add_u32 v32, v132, 4, v129
  v_subrev_u32 v32, 3072, v32
  v_add_u32 v128, 64, v128
  v_mul_u32_u24 v129, s70, v128
  v_lshrrev_b32 v129, 16, v129
  v_mul_u32_u24 v132, 40, v129
  v_sub_u32 v132, v128, v132
  v_and_b32 v131, 2, v129
  v_or_b32 v131, s78, v131
  v_xor_b32 v132, v132, v131
  v_mul_u32_u24 v129, s81, v129
  v_lshl_add_u32 v33, v132, 4, v129
  s_mul_i32 s70, s3, 26624
  s_add_u32 s74, s70, s77
  s_mul_i32 s75, s3, 5120
  s_add_u32 s75, s75, 32768
  s_lshl_b32 s71, s68, 14
  s_lshl_b32 s76, s69, 11
  s_add_u32 s76, s76, s71
  s_xor_b32 s76, s76, 16384
  v_and_b32 v132, 7, v0
  v_lshrrev_b32 v130, 4, v0
  v_xor_b32 v132, v132, v130
  v_lshlrev_b32 v14, 4, v132
  v_xor_b32 v15, 64, v14
  v_and_b32 v132, 15, v0
  v_lshlrev_b32 v132, 7, v132
  v_bfe_u32 v131, v0, 1, 3
  v_xor_b32 v131, v131, v130
  v_lshl_add_u32 v132, v131, 4, v132
  v_add_u32 v11, s71, v132
  v_xor_b32 v12, 64, v11
  s_mov_b32 s52, s16
  s_and_b32 s53, s17, 0xffff
  s_mov_b32 s54, 3328
  s_mov_b32 s55, 0x20000
  s_mul_i32 s71, s69, 5
  v_bfe_u32 v131, v0, 2, 2
  v_lshl_add_u32 v132, v130, 3, v131
  v_mul_u32_u24 v132, 640, v132
  v_and_b32 v131, 3, v0
  v_lshl_add_u32 v132, v131, 3, v132
  v_add_u32 v132, 32768, v132
  v_bfe_u32 v131, v0, 3, 2
  v_xor_b32 v128, s71, v131
  v_lshl_add_u32 v1, v128, 5, v132
  v_add_u32 v6, 61440, v1
  s_add_u32 s71, s71, 1
  v_xor_b32 v128, s71, v131
  v_lshl_add_u32 v2, v128, 5, v132
  v_add_u32 v7, 61440, v2
  s_add_u32 s71, s71, 1
  v_xor_b32 v128, s71, v131
  v_lshl_add_u32 v3, v128, 5, v132
  v_add_u32 v8, 61440, v3
  s_add_u32 s71, s71, 1
  v_xor_b32 v128, s71, v131
  v_lshl_add_u32 v4, v128, 5, v132
  v_add_u32 v9, 61440, v4
  s_add_u32 s71, s71, 1
  v_xor_b32 v128, s71, v131
  v_lshl_add_u32 v5, v128, 5, v132
  v_add_u32 v10, 61440, v5
  s_add_u32 s71, s71, 1
  s_mul_i32 s71, s69, 160
  s_add_u32 s71, s71, 155648
  v_lshlrev_b32 v132, 3, v130
  v_add_u32 v35, s71, v132
  s_lshl_b32 s70, s69, 1
  s_add_u32 s70, s70, s68
  s_lshl_b32 s70, s70, 8
  s_add_u32 s70, s70, 156928
  v_lshlrev_b32 v36, 2, v0
  v_add_u32 v36, s70, v36
  s_add_u32 m0, s75, 0
  s_nop 0
  buffer_load_dwordx4 v29, s[44:47], s74 offen offset:0 lds
  buffer_load_dwordx4 v30, s[44:47], s74 offen offset:1024 lds
  buffer_load_dwordx4 v31, s[44:47], s74 offen offset:2048 lds
  buffer_load_dwordx4 v32, s[44:47], s74 offen offset:3072 lds
  s_add_u32 m0, m0, 4096
  s_nop 0
  buffer_load_dwordx4 v33, s[44:47], s74 offen offset:0 lds
  s_add_u32 s74, s74, 212992
  s_waitcnt vmcnt(10)
  v_lshlrev_b32 v120, 7, v120
  s_barrier
  buffer_load_dword v255, v120, s[32:35], 0 offen
  s_waitcnt vmcnt(9)
  v_lshl_add_u32 v34, v116, 7, v15
  v_lshl_add_u32 v28, v112, 7, v14
  s_add_u32 m0, s76, 0
  s_nop 0
  buffer_load_dwordx4 v28, s[32:35], 0 offen lds
  s_add_u32 m0, m0, 1024
  s_nop 0
  buffer_load_dwordx4 v34, s[32:35], 0 offen lds
  v_lshlrev_b32 v122, 7, v122
  buffer_load_dword v255, v122, s[32:35], 0 offen
  s_barrier
  s_waitcnt vmcnt(9)
  ds_read_b64 v[220:221], v35 offset:0
  ds_read_b64 v[222:223], v35 offset:32
  ds_read_b64 v[224:225], v35 offset:64
  ds_read_b64 v[226:227], v35 offset:96
  ds_read_b64 v[228:229], v35 offset:128
  s_waitcnt lgkmcnt(4)
  v_lshlrev_b32 v140, 16, v220
  v_and_b32 v141, 0xffff0000, v220
  v_lshlrev_b32 v142, 16, v221
  v_and_b32 v143, 0xffff0000, v221
  s_waitcnt lgkmcnt(3)
  v_lshlrev_b32 v156, 16, v222
  v_and_b32 v157, 0xffff0000, v222
  v_lshlrev_b32 v158, 16, v223
  v_and_b32 v159, 0xffff0000, v223
  s_waitcnt lgkmcnt(2)
  v_lshlrev_b32 v172, 16, v224
  v_and_b32 v173, 0xffff0000, v224
  v_lshlrev_b32 v174, 16, v225
  v_and_b32 v175, 0xffff0000, v225
  s_waitcnt lgkmcnt(1)
  v_lshlrev_b32 v188, 16, v226
  v_and_b32 v189, 0xffff0000, v226
  v_lshlrev_b32 v190, 16, v227
  v_and_b32 v191, 0xffff0000, v227
  s_waitcnt lgkmcnt(0)
  v_lshlrev_b32 v204, 16, v228
  v_and_b32 v205, 0xffff0000, v228
  v_lshlrev_b32 v206, 16, v229
  v_and_b32 v207, 0xffff0000, v229
  v_mov_b64 v[144:145], v[140:141]
  v_mov_b64 v[146:147], v[142:143]
  v_mov_b64 v[148:149], v[140:141]
  v_mov_b64 v[150:151], v[142:143]
  v_mov_b64 v[152:153], v[140:141]
  v_mov_b64 v[154:155], v[142:143]
  v_mov_b64 v[160:161], v[156:157]
  v_mov_b64 v[162:163], v[158:159]
  v_mov_b64 v[164:165], v[156:157]
  v_mov_b64 v[166:167], v[158:159]
  v_mov_b64 v[168:169], v[156:157]
  v_mov_b64 v[170:171], v[158:159]
  v_mov_b64 v[176:177], v[172:173]
  v_mov_b64 v[178:179], v[174:175]
  v_mov_b64 v[180:181], v[172:173]
  v_mov_b64 v[182:183], v[174:175]
  v_mov_b64 v[184:185], v[172:173]
  v_mov_b64 v[186:187], v[174:175]
  v_mov_b64 v[192:193], v[188:189]
  v_mov_b64 v[194:195], v[190:191]
  v_mov_b64 v[196:197], v[188:189]
  v_mov_b64 v[198:199], v[190:191]
  v_mov_b64 v[200:201], v[188:189]
  v_mov_b64 v[202:203], v[190:191]
  v_mov_b64 v[208:209], v[204:205]
  v_mov_b64 v[210:211], v[206:207]
  v_mov_b64 v[212:213], v[204:205]
  v_mov_b64 v[214:215], v[206:207]
  v_mov_b64 v[216:217], v[204:205]
  v_mov_b64 v[218:219], v[206:207]
  s_lshl_b32 s73, s68, 2
  s_add_u32 s73, s73, 4
  buffer_load_dwordx3 v[16:18], v13, s[28:31], s73 offen offset:0
  buffer_load_dwordx3 v[20:22], v13, s[28:31], s73 offen offset:832
  s_add_u32 s73, s73, 12
  s_mov_b32 s72, 0
  s_cmp_lg_u32 s68, 0
  s_cbranch_scc1 L_dnn_h1
L_dnn_h0:
  s_add_u32 m0, s75, 40960
  s_nop 0
  buffer_load_dwordx4 v29, s[44:47], s74 offen offset:0 lds
  buffer_load_dwordx4 v30, s[44:47], s74 offen offset:1024 lds
  buffer_load_dwordx4 v31, s[44:47], s74 offen offset:2048 lds
  buffer_load_dwordx4 v32, s[44:47], s74 offen offset:3072 lds
  s_add_u32 m0, m0, 4096
  s_nop 0
  buffer_load_dwordx4 v33, s[44:47], s74 offen offset:0 lds
  s_add_u32 s74, s74, 212992
  s_waitcnt vmcnt(11) lgkmcnt(0)
  s_barrier
  buffer_load_dwordx3 v[24:26], v13, s[28:31], s73 offen offset:0
  buffer_load_dwordx3 v[240:242], v13, s[28:31], s73 offen offset:832
  s_add_u32 s73, s73, 12
L_dnn_loop0:
  ds_read_b64_tr_b16 v[40:41], v1 offset:0
  s_add_u32 m0, s75, 81920
  s_nop 0
  buffer_load_dwordx4 v29, s[44:47], s74 offen offset:0 lds
  ds_read_b64_tr_b16 v[42:43], v1 offset:2560
  ds_read_b64_tr_b16 v[44:45], v1 offset:20480
  ds_read_b64_tr_b16 v[46:47], v1 offset:23040
  ds_read_b64_tr_b16 v[48:49], v2 offset:0
  buffer_load_dwordx4 v30, s[44:47], s74 offen offset:1024 lds
  ds_read_b64_tr_b16 v[50:51], v2 offset:2560
  ds_read_b64_tr_b16 v[52:53], v2 offset:20480
  ds_read_b64_tr_b16 v[54:55], v2 offset:23040
  ds_read_b64_tr_b16 v[56:57], v3 offset:0
  buffer_load_dwordx4 v31, s[44:47], s74 offen offset:2048 lds
  ds_read_b64_tr_b16 v[58:59], v3 offset:2560
  ds_read_b64_tr_b16 v[60:61], v3 offset:20480
  ds_read_b64_tr_b16 v[62:63], v3 offset:23040
  ds_read_b64_tr_b16 v[64:65], v4 offset:0
  buffer_load_dwordx4 v32, s[44:47], s74 offen offset:3072 lds
  ds_read_b64_tr_b16 v[66:67], v4 offset:2560
  ds_read_b64_tr_b16 v[68:69], v4 offset:20480
  ds_read_b64_tr_b16 v[70:71], v4 offset:23040
  ds_read_b128 v[80:83], v11 offset:0
  s_add_u32 m0, m0, 4096
  s_nop 0
  buffer_load_dwordx4 v33, s[44:47], s74 offen offset:0 lds
  s_add_u32 s74, s74, 212992
  ds_read_b128 v[84:87], v12 offset:0
  ds_read_b128 v[88:91], v11 offset:2048
  ds_read_b128 v[92:95], v12 offset:2048
  ds_read_b128 v[96:99], v11 offset:4096
  s_waitcnt vmcnt(12)
  v_lshl_add_u32 v34, v20, 7, v15
  v_lshl_add_u32 v28, v16, 7, v14
  s_add_u32 m0, s76, 8192
  s_nop 0
  buffer_load_dwordx4 v28, s[32:35], 0 offen lds
  ds_read_b128 v[100:103], v12 offset:4096
  ds_read_b128 v[104:107], v11 offset:6144
  ds_read_b128 v[108:111], v12 offset:6144
  ds_read_b64_tr_b16 v[72:73], v5 offset:0
  s_add_u32 m0, m0, 1024
  s_nop 0
  buffer_load_dwordx4 v34, s[32:35], 0 offen lds
  ds_read_b64_tr_b16 v[74:75], v5 offset:2560
  ds_read_b64_tr_b16 v[76:77], v5 offset:20480
  ds_read_b64_tr_b16 v[78:79], v5 offset:23040
  s_waitcnt vmcnt(9) lgkmcnt(0)
  s_barrier
  s_setprio 0
  v_mfma_f32_16x16x32_bf16 v[140:143], v[40:43], v[80:83], v[140:143]
  v_mfma_f32_16x16x32_bf16 v[140:143], v[44:47], v[84:87], v[140:143]
  v_mfma_f32_16x16x32_bf16 v[144:147], v[40:43], v[88:91], v[144:147]
  v_mfma_f32_16x16x32_bf16 v[144:147], v[44:47], v[92:95], v[144:147]
  v_mfma_f32_16x16x32_bf16 v[148:151], v[40:43], v[96:99], v[148:151]
  v_mfma_f32_16x16x32_bf16 v[148:151], v[44:47], v[100:103], v[148:151]
  v_mfma_f32_16x16x32_bf16 v[152:155], v[40:43], v[104:107], v[152:155]
  v_mfma_f32_16x16x32_bf16 v[152:155], v[44:47], v[108:111], v[152:155]
  v_mfma_f32_16x16x32_bf16 v[168:171], v[48:51], v[104:107], v[168:171]
  v_mfma_f32_16x16x32_bf16 v[168:171], v[52:55], v[108:111], v[168:171]
  v_mfma_f32_16x16x32_bf16 v[164:167], v[48:51], v[96:99], v[164:167]
  v_mfma_f32_16x16x32_bf16 v[164:167], v[52:55], v[100:103], v[164:167]
  v_mfma_f32_16x16x32_bf16 v[160:163], v[48:51], v[88:91], v[160:163]
  v_mfma_f32_16x16x32_bf16 v[160:163], v[52:55], v[92:95], v[160:163]
  v_mfma_f32_16x16x32_bf16 v[156:159], v[48:51], v[80:83], v[156:159]
  v_mfma_f32_16x16x32_bf16 v[156:159], v[52:55], v[84:87], v[156:159]
  v_mfma_f32_16x16x32_bf16 v[172:175], v[56:59], v[80:83], v[172:175]
  v_mfma_f32_16x16x32_bf16 v[172:175], v[60:63], v[84:87], v[172:175]
  v_mfma_f32_16x16x32_bf16 v[176:179], v[56:59], v[88:91], v[176:179]
  v_mfma_f32_16x16x32_bf16 v[176:179], v[60:63], v[92:95], v[176:179]
  v_mfma_f32_16x16x32_bf16 v[180:183], v[56:59], v[96:99], v[180:183]
  v_mfma_f32_16x16x32_bf16 v[180:183], v[60:63], v[100:103], v[180:183]
  v_mfma_f32_16x16x32_bf16 v[184:187], v[56:59], v[104:107], v[184:187]
  v_mfma_f32_16x16x32_bf16 v[184:187], v[60:63], v[108:111], v[184:187]
  v_mfma_f32_16x16x32_bf16 v[200:203], v[64:67], v[104:107], v[200:203]
  v_mfma_f32_16x16x32_bf16 v[200:203], v[68:71], v[108:111], v[200:203]
  v_mfma_f32_16x16x32_bf16 v[196:199], v[64:67], v[96:99], v[196:199]
  v_mfma_f32_16x16x32_bf16 v[196:199], v[68:71], v[100:103], v[196:199]
  v_mfma_f32_16x16x32_bf16 v[192:195], v[64:67], v[88:91], v[192:195]
  v_mfma_f32_16x16x32_bf16 v[192:195], v[68:71], v[92:95], v[192:195]
  v_mfma_f32_16x16x32_bf16 v[188:191], v[64:67], v[80:83], v[188:191]
  v_mfma_f32_16x16x32_bf16 v[188:191], v[68:71], v[84:87], v[188:191]
  v_mfma_f32_16x16x32_bf16 v[204:207], v[72:75], v[80:83], v[204:207]
  v_mfma_f32_16x16x32_bf16 v[204:207], v[76:79], v[84:87], v[204:207]
  v_mfma_f32_16x16x32_bf16 v[208:211], v[72:75], v[88:91], v[208:211]
  v_mfma_f32_16x16x32_bf16 v[208:211], v[76:79], v[92:95], v[208:211]
  v_mfma_f32_16x16x32_bf16 v[212:215], v[72:75], v[96:99], v[212:215]
  v_mfma_f32_16x16x32_bf16 v[212:215], v[76:79], v[100:103], v[212:215]
  v_mfma_f32_16x16x32_bf16 v[216:219], v[72:75], v[104:107], v[216:219]
  s_setprio 2
  s_waitcnt vmcnt(9)
  s_barrier
  v_mfma_f32_16x16x32_bf16 v[216:219], v[76:79], v[108:111], v[216:219]
  ds_read_b64_tr_b16 v[40:41], v1 offset:40960
  s_add_u32 m0, s75, 0
  s_nop 0
  buffer_load_dwordx4 v29, s[44:47], s74 offen offset:0 lds
  ds_read_b64_tr_b16 v[42:43], v1 offset:43520
  ds_read_b64_tr_b16 v[44:45], v6 offset:0
  ds_read_b64_tr_b16 v[46:47], v6 offset:2560
  ds_read_b64_tr_b16 v[48:49], v2 offset:40960
  buffer_load_dwordx4 v30, s[44:47], s74 offen offset:1024 lds
  ds_read_b64_tr_b16 v[50:51], v2 offset:43520
  ds_read_b64_tr_b16 v[52:53], v7 offset:0
  ds_read_b64_tr_b16 v[54:55], v7 offset:2560
  ds_read_b64_tr_b16 v[56:57], v3 offset:40960
  buffer_load_dwordx4 v31, s[44:47], s74 offen offset:2048 lds
  ds_read_b64_tr_b16 v[58:59], v3 offset:43520
  ds_read_b64_tr_b16 v[60:61], v8 offset:0
  ds_read_b64_tr_b16 v[62:63], v8 offset:2560
  ds_read_b64_tr_b16 v[64:65], v4 offset:40960
  buffer_load_dwordx4 v32, s[44:47], s74 offen offset:3072 lds
  ds_read_b64_tr_b16 v[66:67], v4 offset:43520
  ds_read_b64_tr_b16 v[68:69], v9 offset:0
  ds_read_b64_tr_b16 v[70:71], v9 offset:2560
  ds_read_b128 v[80:83], v11 offset:8192
  s_add_u32 m0, m0, 4096
  s_nop 0
  buffer_load_dwordx4 v33, s[44:47], s74 offen offset:0 lds
  s_add_u32 s74, s74, 212992
  ds_read_b128 v[84:87], v12 offset:8192
  ds_read_b128 v[88:91], v11 offset:10240
  ds_read_b128 v[92:95], v12 offset:10240
  ds_read_b128 v[96:99], v11 offset:12288
  v_lshl_add_u32 v34, v21, 7, v15
  v_lshl_add_u32 v28, v17, 7, v14
  s_add_u32 m0, s76, 0
  s_nop 0
  buffer_load_dwordx4 v28, s[32:35], 0 offen lds
  ds_read_b128 v[100:103], v12 offset:12288
  ds_read_b128 v[104:107], v11 offset:14336
  ds_read_b128 v[108:111], v12 offset:14336
  ds_read_b64_tr_b16 v[72:73], v5 offset:40960
  s_add_u32 m0, m0, 1024
  s_nop 0
  buffer_load_dwordx4 v34, s[32:35], 0 offen lds
  ds_read_b64_tr_b16 v[74:75], v5 offset:43520
  ds_read_b64_tr_b16 v[76:77], v10 offset:0
  ds_read_b64_tr_b16 v[78:79], v10 offset:2560
  s_waitcnt vmcnt(7) lgkmcnt(0)
  s_barrier
  s_setprio 0
  v_mfma_f32_16x16x32_bf16 v[140:143], v[40:43], v[80:83], v[140:143]
  v_mfma_f32_16x16x32_bf16 v[140:143], v[44:47], v[84:87], v[140:143]
  v_mfma_f32_16x16x32_bf16 v[144:147], v[40:43], v[88:91], v[144:147]
  v_mfma_f32_16x16x32_bf16 v[144:147], v[44:47], v[92:95], v[144:147]
  v_mfma_f32_16x16x32_bf16 v[148:151], v[40:43], v[96:99], v[148:151]
  v_mfma_f32_16x16x32_bf16 v[148:151], v[44:47], v[100:103], v[148:151]
  v_mfma_f32_16x16x32_bf16 v[152:155], v[40:43], v[104:107], v[152:155]
  v_mfma_f32_16x16x32_bf16 v[152:155], v[44:47], v[108:111], v[152:155]
  v_mfma_f32_16x16x32_bf16 v[168:171], v[48:51], v[104:107], v[168:171]
  v_mfma_f32_16x16x32_bf16 v[168:171], v[52:55], v[108:111], v[168:171]
  v_mfma_f32_16x16x32_bf16 v[164:167], v[48:51], v[96:99], v[164:167]
  v_mfma_f32_16x16x32_bf16 v[164:167], v[52:55], v[100:103], v[164:167]
  v_mfma_f32_16x16x32_bf16 v[160:163], v[48:51], v[88:91], v[160:163]
  v_mfma_f32_16x16x32_bf16 v[160:163], v[52:55], v[92:95], v[160:163]
  v_mfma_f32_16x16x32_bf16 v[156:159], v[48:51], v[80:83], v[156:159]
  v_mfma_f32_16x16x32_bf16 v[156:159], v[52:55], v[84:87], v[156:159]
  v_mfma_f32_16x16x32_bf16 v[172:175], v[56:59], v[80:83], v[172:175]
  v_mfma_f32_16x16x32_bf16 v[172:175], v[60:63], v[84:87], v[172:175]
  v_mfma_f32_16x16x32_bf16 v[176:179], v[56:59], v[88:91], v[176:179]
  v_mfma_f32_16x16x32_bf16 v[176:179], v[60:63], v[92:95], v[176:179]
  v_mfma_f32_16x16x32_bf16 v[180:183], v[56:59], v[96:99], v[180:183]
  v_mfma_f32_16x16x32_bf16 v[180:183], v[60:63], v[100:103], v[180:183]
  v_mfma_f32_16x16x32_bf16 v[184:187], v[56:59], v[104:107], v[184:187]
  v_mfma_f32_16x16x32_bf16 v[184:187], v[60:63], v[108:111], v[184:187]
  v_mfma_f32_16x16x32_bf16 v[200:203], v[64:67], v[104:107], v[200:203]
  v_mfma_f32_16x16x32_bf16 v[200:203], v[68:71], v[108:111], v[200:203]
  v_mfma_f32_16x16x32_bf16 v[196:199], v[64:67], v[96:99], v[196:199]
  v_mfma_f32_16x16x32_bf16 v[196:199], v[68:71], v[100:103], v[196:199]
  v_mfma_f32_16x16x32_bf16 v[192:195], v[64:67], v[88:91], v[192:195]
  v_mfma_f32_16x16x32_bf16 v[192:195], v[68:71], v[92:95], v[192:195]
  v_mfma_f32_16x16x32_bf16 v[188:191], v[64:67], v[80:83], v[188:191]
  v_mfma_f32_16x16x32_bf16 v[188:191], v[68:71], v[84:87], v[188:191]
  v_mfma_f32_16x16x32_bf16 v[204:207], v[72:75], v[80:83], v[204:207]
  v_mfma_f32_16x16x32_bf16 v[204:207], v[76:79], v[84:87], v[204:207]
  v_mfma_f32_16x16x32_bf16 v[208:211], v[72:75], v[88:91], v[208:211]
  v_mfma_f32_16x16x32_bf16 v[208:211], v[76:79], v[92:95], v[208:211]
  v_mfma_f32_16x16x32_bf16 v[212:215], v[72:75], v[96:99], v[212:215]
  v_mfma_f32_16x16x32_bf16 v[212:215], v[76:79], v[100:103], v[212:215]
  v_mfma_f32_16x16x32_bf16 v[216:219], v[72:75], v[104:107], v[216:219]
  s_setprio 2
  s_barrier
  v_mfma_f32_16x16x32_bf16 v[216:219], v[76:79], v[108:111], v[216:219]
  ds_read_b64_tr_b16 v[40:41], v6 offset:20480
  s_add_u32 m0, s75, 40960
  s_nop 0
  buffer_load_dwordx4 v29, s[44:47], s74 offen offset:0 lds
  ds_read_b64_tr_b16 v[42:43], v6 offset:23040
  ds_read_b64_tr_b16 v[44:45], v6 offset:40960
  ds_read_b64_tr_b16 v[46:47], v6 offset:43520
  ds_read_b64_tr_b16 v[48:49], v7 offset:20480
  buffer_load_dwordx4 v30, s[44:47], s74 offen offset:1024 lds
  ds_read_b64_tr_b16 v[50:51], v7 offset:23040
  ds_read_b64_tr_b16 v[52:53], v7 offset:40960
  ds_read_b64_tr_b16 v[54:55], v7 offset:43520
  ds_read_b64_tr_b16 v[56:57], v8 offset:20480
  buffer_load_dwordx4 v31, s[44:47], s74 offen offset:2048 lds
  ds_read_b64_tr_b16 v[58:59], v8 offset:23040
  ds_read_b64_tr_b16 v[60:61], v8 offset:40960
  ds_read_b64_tr_b16 v[62:63], v8 offset:43520
  ds_read_b64_tr_b16 v[64:65], v9 offset:20480
  buffer_load_dwordx4 v32, s[44:47], s74 offen offset:3072 lds
  ds_read_b64_tr_b16 v[66:67], v9 offset:23040
  ds_read_b64_tr_b16 v[68:69], v9 offset:40960
  ds_read_b64_tr_b16 v[70:71], v9 offset:43520
  ds_read_b128 v[80:83], v11 offset:0
  s_add_u32 m0, m0, 4096
  s_nop 0
  buffer_load_dwordx4 v33, s[44:47], s74 offen offset:0 lds
  s_add_u32 s74, s74, 212992
  ds_read_b128 v[84:87], v12 offset:0
  ds_read_b128 v[88:91], v11 offset:2048
  ds_read_b128 v[92:95], v12 offset:2048
  ds_read_b128 v[96:99], v11 offset:4096
  v_lshl_add_u32 v34, v22, 7, v15
  v_lshl_add_u32 v28, v18, 7, v14
  s_add_u32 m0, s76, 8192
  s_nop 0
  buffer_load_dwordx4 v28, s[32:35], 0 offen lds
  ds_read_b128 v[100:103], v12 offset:4096
  ds_read_b128 v[104:107], v11 offset:6144
  ds_read_b128 v[108:111], v12 offset:6144
  ds_read_b64_tr_b16 v[72:73], v10 offset:20480
  s_add_u32 m0, m0, 1024
  s_nop 0
  buffer_load_dwordx4 v34, s[32:35], 0 offen lds
  ds_read_b64_tr_b16 v[74:75], v10 offset:23040
  ds_read_b64_tr_b16 v[76:77], v10 offset:40960
  ds_read_b64_tr_b16 v[78:79], v10 offset:43520
  buffer_load_dwordx3 v[16:18], v13, s[28:31], s73 offen offset:0
  buffer_load_dwordx3 v[20:22], v13, s[28:31], s73 offen offset:832
  s_add_u32 s73, s73, 12
  s_waitcnt vmcnt(9) lgkmcnt(0)
  s_barrier
  s_setprio 0
  v_mfma_f32_16x16x32_bf16 v[140:143], v[40:43], v[80:83], v[140:143]
  v_mfma_f32_16x16x32_bf16 v[140:143], v[44:47], v[84:87], v[140:143]
  v_mfma_f32_16x16x32_bf16 v[144:147], v[40:43], v[88:91], v[144:147]
  v_mfma_f32_16x16x32_bf16 v[144:147], v[44:47], v[92:95], v[144:147]
  v_mfma_f32_16x16x32_bf16 v[148:151], v[40:43], v[96:99], v[148:151]
  v_mfma_f32_16x16x32_bf16 v[148:151], v[44:47], v[100:103], v[148:151]
  v_mfma_f32_16x16x32_bf16 v[152:155], v[40:43], v[104:107], v[152:155]
  v_mfma_f32_16x16x32_bf16 v[152:155], v[44:47], v[108:111], v[152:155]
  v_mfma_f32_16x16x32_bf16 v[168:171], v[48:51], v[104:107], v[168:171]
  v_mfma_f32_16x16x32_bf16 v[168:171], v[52:55], v[108:111], v[168:171]
  v_mfma_f32_16x16x32_bf16 v[164:167], v[48:51], v[96:99], v[164:167]
  v_mfma_f32_16x16x32_bf16 v[164:167], v[52:55], v[100:103], v[164:167]
  v_mfma_f32_16x16x32_bf16 v[160:163], v[48:51], v[88:91], v[160:163]
  v_mfma_f32_16x16x32_bf16 v[160:163], v[52:55], v[92:95], v[160:163]
  v_mfma_f32_16x16x32_bf16 v[156:159], v[48:51], v[80:83], v[156:159]
  v_mfma_f32_16x16x32_bf16 v[156:159], v[52:55], v[84:87], v[156:159]
  v_mfma_f32_16x16x32_bf16 v[172:175], v[56:59], v[80:83], v[172:175]
  v_mfma_f32_16x16x32_bf16 v[172:175], v[60:63], v[84:87], v[172:175]
  v_mfma_f32_16x16x32_bf16 v[176:179], v[56:59], v[88:91], v[176:179]
  v_mfma_f32_16x16x32_bf16 v[176:179], v[60:63], v[92:95], v[176:179]
  v_mfma_f32_16x16x32_bf16 v[180:183], v[56:59], v[96:99], v[180:183]
  v_mfma_f32_16x16x32_bf16 v[180:183], v[60:63], v[100:103], v[180:183]
  v_mfma_f32_16x16x32_bf16 v[184:187], v[56:59], v[104:107], v[184:187]
  v_mfma_f32_16x16x32_bf16 v[184:187], v[60:63], v[108:111], v[184:187]
  v_mfma_f32_16x16x32_bf16 v[200:203], v[64:67], v[104:107], v[200:203]
  v_mfma_f32_16x16x32_bf16 v[200:203], v[68:71], v[108:111], v[200:203]
  v_mfma_f32_16x16x32_bf16 v[196:199], v[64:67], v[96:99], v[196:199]
  v_mfma_f32_16x16x32_bf16 v[196:199], v[68:71], v[100:103], v[196:199]
  v_mfma_f32_16x16x32_bf16 v[192:195], v[64:67], v[88:91], v[192:195]
  v_mfma_f32_16x16x32_bf16 v[192:195], v[68:71], v[92:95], v[192:195]
  v_mfma_f32_16x16x32_bf16 v[188:191], v[64:67], v[80:83], v[188:191]
  v_mfma_f32_16x16x32_bf16 v[188:191], v[68:71], v[84:87], v[188:191]
  v_mfma_f32_16x16x32_bf16 v[204:207], v[72:75], v[80:83], v[204:207]
  v_mfma_f32_16x16x32_bf16 v[204:207], v[76:79], v[84:87], v[204:207]
  v_mfma_f32_16x16x32_bf16 v[208:211], v[72:75], v[88:91], v[208:211]
  v_mfma_f32_16x16x32_bf16 v[208:211], v[76:79], v[92:95], v[208:211]
  v_mfma_f32_16x16x32_bf16 v[212:215], v[72:75], v[96:99], v[212:215]
  v_mfma_f32_16x16x32_bf16 v[212:215], v[76:79], v[100:103], v[212:215]
  v_mfma_f32_16x16x32_bf16 v[216:219], v[72:75], v[104:107], v[216:219]
  s_setprio 2
  s_barrier
  v_mfma_f32_16x16x32_bf16 v[216:219], v[76:79], v[108:111], v[216:219]
  ds_read_b64_tr_b16 v[40:41], v1 offset:0
  s_add_u32 m0, s75, 81920
  s_nop 0
  buffer_load_dwordx4 v29, s[44:47], s74 offen offset:0 lds
  ds_read_b64_tr_b16 v[42:43], v1 offset:2560
  ds_read_b64_tr_b16 v[44:45], v1 offset:20480
  ds_read_b64_tr_b16 v[46:47], v1 offset:23040
  ds_read_b64_tr_b16 v[48:49], v2 offset:0
  buffer_load_dwordx4 v30, s[44:47], s74 offen offset:1024 lds
  ds_read_b64_tr_b16 v[50:51], v2 offset:2560
  ds_read_b64_tr_b16 v[52:53], v2 offset:20480
  ds_read_b64_tr_b16 v[54:55], v2 offset:23040
  ds_read_b64_tr_b16 v[56:57], v3 offset:0
  buffer_load_dwordx4 v31, s[44:47], s74 offen offset:2048 lds
  ds_read_b64_tr_b16 v[58:59], v3 offset:2560
  ds_read_b64_tr_b16 v[60:61], v3 offset:20480
  ds_read_b64_tr_b16 v[62:63], v3 offset:23040
  ds_read_b64_tr_b16 v[64:65], v4 offset:0
  buffer_load_dwordx4 v32, s[44:47], s74 offen offset:3072 lds
  ds_read_b64_tr_b16 v[66:67], v4 offset:2560
  ds_read_b64_tr_b16 v[68:69], v4 offset:20480
  ds_read_b64_tr_b16 v[70:71], v4 offset:23040
  ds_read_b128 v[80:83], v11 offset:8192
  s_add_u32 m0, m0, 4096
  s_nop 0
  buffer_load_dwordx4 v33, s[44:47], s74 offen offset:0 lds
  s_add_u32 s74, s74, 212992
  ds_read_b128 v[84:87], v12 offset:8192
  ds_read_b128 v[88:91], v11 offset:10240
  ds_read_b128 v[92:95], v12 offset:10240
  ds_read_b128 v[96:99], v11 offset:12288
  v_lshl_add_u32 v34, v240, 7, v15
  v_lshl_add_u32 v28, v24, 7, v14
  s_add_u32 m0, s76, 0
  s_nop 0
  buffer_load_dwordx4 v28, s[32:35], 0 offen lds
  ds_read_b128 v[100:103], v12 offset:12288
  ds_read_b128 v[104:107], v11 offset:14336
  ds_read_b128 v[108:111], v12 offset:14336
  ds_read_b64_tr_b16 v[72:73], v5 offset:0
  s_add_u32 m0, m0, 1024
  s_nop 0
  buffer_load_dwordx4 v34, s[32:35], 0 offen lds
  ds_read_b64_tr_b16 v[74:75], v5 offset:2560
  ds_read_b64_tr_b16 v[76:77], v5 offset:20480
  ds_read_b64_tr_b16 v[78:79], v5 offset:23040
  s_waitcnt vmcnt(9) lgkmcnt(0)
  s_barrier
  s_setprio 0
  v_mfma_f32_16x16x32_bf16 v[140:143], v[40:43], v[80:83], v[140:143]
  v_mfma_f32_16x16x32_bf16 v[140:143], v[44:47], v[84:87], v[140:143]
  v_mfma_f32_16x16x32_bf16 v[144:147], v[40:43], v[88:91], v[144:147]
  v_mfma_f32_16x16x32_bf16 v[144:147], v[44:47], v[92:95], v[144:147]
  v_mfma_f32_16x16x32_bf16 v[148:151], v[40:43], v[96:99], v[148:151]
  v_mfma_f32_16x16x32_bf16 v[148:151], v[44:47], v[100:103], v[148:151]
  v_mfma_f32_16x16x32_bf16 v[152:155], v[40:43], v[104:107], v[152:155]
  v_mfma_f32_16x16x32_bf16 v[152:155], v[44:47], v[108:111], v[152:155]
  v_mfma_f32_16x16x32_bf16 v[168:171], v[48:51], v[104:107], v[168:171]
  v_mfma_f32_16x16x32_bf16 v[168:171], v[52:55], v[108:111], v[168:171]
  v_mfma_f32_16x16x32_bf16 v[164:167], v[48:51], v[96:99], v[164:167]
  v_mfma_f32_16x16x32_bf16 v[164:167], v[52:55], v[100:103], v[164:167]
  v_mfma_f32_16x16x32_bf16 v[160:163], v[48:51], v[88:91], v[160:163]
  v_mfma_f32_16x16x32_bf16 v[160:163], v[52:55], v[92:95], v[160:163]
  v_mfma_f32_16x16x32_bf16 v[156:159], v[48:51], v[80:83], v[156:159]
  v_mfma_f32_16x16x32_bf16 v[156:159], v[52:55], v[84:87], v[156:159]
  v_mfma_f32_16x16x32_bf16 v[172:175], v[56:59], v[80:83], v[172:175]
  v_mfma_f32_16x16x32_bf16 v[172:175], v[60:63], v[84:87], v[172:175]
  v_mfma_f32_16x16x32_bf16 v[176:179], v[56:59], v[88:91], v[176:179]
  v_mfma_f32_16x16x32_bf16 v[176:179], v[60:63], v[92:95], v[176:179]
  v_mfma_f32_16x16x32_bf16 v[180:183], v[56:59], v[96:99], v[180:183]
  v_mfma_f32_16x16x32_bf16 v[180:183], v[60:63], v[100:103], v[180:183]
  v_mfma_f32_16x16x32_bf16 v[184:187], v[56:59], v[104:107], v[184:187]
  v_mfma_f32_16x16x32_bf16 v[184:187], v[60:63], v[108:111], v[184:187]
  v_mfma_f32_16x16x32_bf16 v[200:203], v[64:67], v[104:107], v[200:203]
  v_mfma_f32_16x16x32_bf16 v[200:203], v[68:71], v[108:111], v[200:203]
  v_mfma_f32_16x16x32_bf16 v[196:199], v[64:67], v[96:99], v[196:199]
  v_mfma_f32_16x16x32_bf16 v[196:199], v[68:71], v[100:103], v[196:199]
  v_mfma_f32_16x16x32_bf16 v[192:195], v[64:67], v[88:91], v[192:195]
  v_mfma_f32_16x16x32_bf16 v[192:195], v[68:71], v[92:95], v[192:195]
  v_mfma_f32_16x16x32_bf16 v[188:191], v[64:67], v[80:83], v[188:191]
  v_mfma_f32_16x16x32_bf16 v[188:191], v[68:71], v[84:87], v[188:191]
  v_mfma_f32_16x16x32_bf16 v[204:207], v[72:75], v[80:83], v[204:207]
  v_mfma_f32_16x16x32_bf16 v[204:207], v[76:79], v[84:87], v[204:207]
  v_mfma_f32_16x16x32_bf16 v[208:211], v[72:75], v[88:91], v[208:211]
  v_mfma_f32_16x16x32_bf16 v[208:211], v[76:79], v[92:95], v[208:211]
  v_mfma_f32_16x16x32_bf16 v[212:215], v[72:75], v[96:99], v[212:215]
  v_mfma_f32_16x16x32_bf16 v[212:215], v[76:79], v[100:103], v[212:215]
  v_mfma_f32_16x16x32_bf16 v[216:219], v[72:75], v[104:107], v[216:219]
  s_setprio 2
  s_barrier
  v_mfma_f32_16x16x32_bf16 v[216:219], v[76:79], v[108:111], v[216:219]
  ds_read_b64_tr_b16 v[40:41], v1 offset:40960
  s_add_u32 m0, s75, 0
  s_nop 0
  buffer_load_dwordx4 v29, s[44:47], s74 offen offset:0 lds
  ds_read_b64_tr_b16 v[42:43], v1 offset:43520
  ds_read_b64_tr_b16 v[44:45], v6 offset:0
  ds_read_b64_tr_b16 v[46:47], v6 offset:2560
  ds_read_b64_tr_b16 v[48:49], v2 offset:40960
  buffer_load_dwordx4 v30, s[44:47], s74 offen offset:1024 lds
  ds_read_b64_tr_b16 v[50:51], v2 offset:43520
  ds_read_b64_tr_b16 v[52:53], v7 offset:0
  ds_read_b64_tr_b16 v[54:55], v7 offset:2560
  ds_read_b64_tr_b16 v[56:57], v3 offset:40960
  buffer_load_dwordx4 v31, s[44:47], s74 offen offset:2048 lds
  ds_read_b64_tr_b16 v[58:59], v3 offset:43520
  ds_read_b64_tr_b16 v[60:61], v8 offset:0
  ds_read_b64_tr_b16 v[62:63], v8 offset:2560
  ds_read_b64_tr_b16 v[64:65], v4 offset:40960
  buffer_load_dwordx4 v32, s[44:47], s74 offen offset:3072 lds
  ds_read_b64_tr_b16 v[66:67], v4 offset:43520
  ds_read_b64_tr_b16 v[68:69], v9 offset:0
  ds_read_b64_tr_b16 v[70:71], v9 offset:2560
  ds_read_b128 v[80:83], v11 offset:0
  s_add_u32 m0, m0, 4096
  s_nop 0
  buffer_load_dwordx4 v33, s[44:47], s74 offen offset:0 lds
  s_add_u32 s74, s74, 212992
  ds_read_b128 v[84:87], v12 offset:0
  ds_read_b128 v[88:91], v11 offset:2048
  ds_read_b128 v[92:95], v12 offset:2048
  ds_read_b128 v[96:99], v11 offset:4096
  v_lshl_add_u32 v34, v241, 7, v15
  v_lshl_add_u32 v28, v25, 7, v14
  s_add_u32 m0, s76, 8192
  s_nop 0
  buffer_load_dwordx4 v28, s[32:35], 0 offen lds
  ds_read_b128 v[100:103], v12 offset:4096
  ds_read_b128 v[104:107], v11 offset:6144
  ds_read_b128 v[108:111], v12 offset:6144
  ds_read_b64_tr_b16 v[72:73], v5 offset:40960
  s_add_u32 m0, m0, 1024
  s_nop 0
  buffer_load_dwordx4 v34, s[32:35], 0 offen lds
  ds_read_b64_tr_b16 v[74:75], v5 offset:43520
  ds_read_b64_tr_b16 v[76:77], v10 offset:0
  ds_read_b64_tr_b16 v[78:79], v10 offset:2560
  s_waitcnt vmcnt(7) lgkmcnt(0)
  s_barrier
  s_setprio 0
  v_mfma_f32_16x16x32_bf16 v[140:143], v[40:43], v[80:83], v[140:143]
  v_mfma_f32_16x16x32_bf16 v[140:143], v[44:47], v[84:87], v[140:143]
  v_mfma_f32_16x16x32_bf16 v[144:147], v[40:43], v[88:91], v[144:147]
  v_mfma_f32_16x16x32_bf16 v[144:147], v[44:47], v[92:95], v[144:147]
  v_mfma_f32_16x16x32_bf16 v[148:151], v[40:43], v[96:99], v[148:151]
  v_mfma_f32_16x16x32_bf16 v[148:151], v[44:47], v[100:103], v[148:151]
  v_mfma_f32_16x16x32_bf16 v[152:155], v[40:43], v[104:107], v[152:155]
  v_mfma_f32_16x16x32_bf16 v[152:155], v[44:47], v[108:111], v[152:155]
  v_mfma_f32_16x16x32_bf16 v[168:171], v[48:51], v[104:107], v[168:171]
  v_mfma_f32_16x16x32_bf16 v[168:171], v[52:55], v[108:111], v[168:171]
  v_mfma_f32_16x16x32_bf16 v[164:167], v[48:51], v[96:99], v[164:167]
  v_mfma_f32_16x16x32_bf16 v[164:167], v[52:55], v[100:103], v[164:167]
  v_mfma_f32_16x16x32_bf16 v[160:163], v[48:51], v[88:91], v[160:163]
  v_mfma_f32_16x16x32_bf16 v[160:163], v[52:55], v[92:95], v[160:163]
  v_mfma_f32_16x16x32_bf16 v[156:159], v[48:51], v[80:83], v[156:159]
  v_mfma_f32_16x16x32_bf16 v[156:159], v[52:55], v[84:87], v[156:159]
  v_mfma_f32_16x16x32_bf16 v[172:175], v[56:59], v[80:83], v[172:175]
  v_mfma_f32_16x16x32_bf16 v[172:175], v[60:63], v[84:87], v[172:175]
  v_mfma_f32_16x16x32_bf16 v[176:179], v[56:59], v[88:91], v[176:179]
  v_mfma_f32_16x16x32_bf16 v[176:179], v[60:63], v[92:95], v[176:179]
  v_mfma_f32_16x16x32_bf16 v[180:183], v[56:59], v[96:99], v[180:183]
  v_mfma_f32_16x16x32_bf16 v[180:183], v[60:63], v[100:103], v[180:183]
  v_mfma_f32_16x16x32_bf16 v[184:187], v[56:59], v[104:107], v[184:187]
  v_mfma_f32_16x16x32_bf16 v[184:187], v[60:63], v[108:111], v[184:187]
  v_mfma_f32_16x16x32_bf16 v[200:203], v[64:67], v[104:107], v[200:203]
  v_mfma_f32_16x16x32_bf16 v[200:203], v[68:71], v[108:111], v[200:203]
  v_mfma_f32_16x16x32_bf16 v[196:199], v[64:67], v[96:99], v[196:199]
  v_mfma_f32_16x16x32_bf16 v[196:199], v[68:71], v[100:103], v[196:199]
  v_mfma_f32_16x16x32_bf16 v[192:195], v[64:67], v[88:91], v[192:195]
  v_mfma_f32_16x16x32_bf16 v[192:195], v[68:71], v[92:95], v[192:195]
  v_mfma_f32_16x16x32_bf16 v[188:191], v[64:67], v[80:83], v[188:191]
  v_mfma_f32_16x16x32_bf16 v[188:191], v[68:71], v[84:87], v[188:191]
  v_mfma_f32_16x16x32_bf16 v[204:207], v[72:75], v[80:83], v[204:207]
  v_mfma_f32_16x16x32_bf16 v[204:207], v[76:79], v[84:87], v[204:207]
  v_mfma_f32_16x16x32_bf16 v[208:211], v[72:75], v[88:91], v[208:211]
  v_mfma_f32_16x16x32_bf16 v[208:211], v[76:79], v[92:95], v[208:211]
  v_mfma_f32_16x16x32_bf16 v[212:215], v[72:75], v[96:99], v[212:215]
  v_mfma_f32_16x16x32_bf16 v[212:215], v[76:79], v[100:103], v[212:215]
  v_mfma_f32_16x16x32_bf16 v[216:219], v[72:75], v[104:107], v[216:219]
  s_setprio 2
  s_barrier
  v_mfma_f32_16x16x32_bf16 v[216:219], v[76:79], v[108:111], v[216:219]
  ds_read_b64_tr_b16 v[40:41], v6 offset:20480
  s_add_u32 m0, s75, 40960
  s_nop 0
  buffer_load_dwordx4 v29, s[44:47], s74 offen offset:0 lds
  ds_read_b64_tr_b16 v[42:43], v6 offset:23040
  ds_read_b64_tr_b16 v[44:45], v6 offset:40960
  ds_read_b64_tr_b16 v[46:47], v6 offset:43520
  ds_read_b64_tr_b16 v[48:49], v7 offset:20480
  buffer_load_dwordx4 v30, s[44:47], s74 offen offset:1024 lds
  ds_read_b64_tr_b16 v[50:51], v7 offset:23040
  ds_read_b64_tr_b16 v[52:53], v7 offset:40960
  ds_read_b64_tr_b16 v[54:55], v7 offset:43520
  ds_read_b64_tr_b16 v[56:57], v8 offset:20480
  buffer_load_dwordx4 v31, s[44:47], s74 offen offset:2048 lds
  ds_read_b64_tr_b16 v[58:59], v8 offset:23040
  ds_read_b64_tr_b16 v[60:61], v8 offset:40960
  ds_read_b64_tr_b16 v[62:63], v8 offset:43520
  ds_read_b64_tr_b16 v[64:65], v9 offset:20480
  buffer_load_dwordx4 v32, s[44:47], s74 offen offset:3072 lds
  ds_read_b64_tr_b16 v[66:67], v9 offset:23040
  ds_read_b64_tr_b16 v[68:69], v9 offset:40960
  ds_read_b64_tr_b16 v[70:71], v9 offset:43520
  ds_read_b128 v[80:83], v11 offset:8192
  s_add_u32 m0, m0, 4096
  s_nop 0
  buffer_load_dwordx4 v33, s[44:47], s74 offen offset:0 lds
  s_add_u32 s74, s74, 212992
  ds_read_b128 v[84:87], v12 offset:8192
  ds_read_b128 v[88:91], v11 offset:10240
  ds_read_b128 v[92:95], v12 offset:10240
  ds_read_b128 v[96:99], v11 offset:12288
  v_lshl_add_u32 v34, v242, 7, v15
  v_lshl_add_u32 v28, v26, 7, v14
  s_add_u32 m0, s76, 0
  s_nop 0
  buffer_load_dwordx4 v28, s[32:35], 0 offen lds
  ds_read_b128 v[100:103], v12 offset:12288
  ds_read_b128 v[104:107], v11 offset:14336
  ds_read_b128 v[108:111], v12 offset:14336
  ds_read_b64_tr_b16 v[72:73], v10 offset:20480
  s_add_u32 m0, m0, 1024
  s_nop 0
  buffer_load_dwordx4 v34, s[32:35], 0 offen lds
  ds_read_b64_tr_b16 v[74:75], v10 offset:23040
  ds_read_b64_tr_b16 v[76:77], v10 offset:40960
  ds_read_b64_tr_b16 v[78:79], v10 offset:43520
  buffer_load_dwordx3 v[24:26], v13, s[28:31], s73 offen offset:0
  buffer_load_dwordx3 v[240:242], v13, s[28:31], s73 offen offset:832
  s_add_u32 s73, s73, 12
  s_waitcnt vmcnt(9) lgkmcnt(0)
  s_barrier
  s_setprio 0
  v_mfma_f32_16x16x32_bf16 v[140:143], v[40:43], v[80:83], v[140:143]
  s_add_u32 s72, s72, 1
  v_mfma_f32_16x16x32_bf16 v[140:143], v[44:47], v[84:87], v[140:143]
  v_mfma_f32_16x16x32_bf16 v[144:147], v[40:43], v[88:91], v[144:147]
  v_mfma_f32_16x16x32_bf16 v[144:147], v[44:47], v[92:95], v[144:147]
  v_mfma_f32_16x16x32_bf16 v[148:151], v[40:43], v[96:99], v[148:151]
  v_mfma_f32_16x16x32_bf16 v[148:151], v[44:47], v[100:103], v[148:151]
  v_mfma_f32_16x16x32_bf16 v[152:155], v[40:43], v[104:107], v[152:155]
  v_mfma_f32_16x16x32_bf16 v[152:155], v[44:47], v[108:111], v[152:155]
  v_mfma_f32_16x16x32_bf16 v[168:171], v[48:51], v[104:107], v[168:171]
  v_mfma_f32_16x16x32_bf16 v[168:171], v[52:55], v[108:111], v[168:171]
  v_mfma_f32_16x16x32_bf16 v[164:167], v[48:51], v[96:99], v[164:167]
  v_mfma_f32_16x16x32_bf16 v[164:167], v[52:55], v[100:103], v[164:167]
  v_mfma_f32_16x16x32_bf16 v[160:163], v[48:51], v[88:91], v[160:163]
  v_mfma_f32_16x16x32_bf16 v[160:163], v[52:55], v[92:95], v[160:163]
  v_mfma_f32_16x16x32_bf16 v[156:159], v[48:51], v[80:83], v[156:159]
  v_mfma_f32_16x16x32_bf16 v[156:159], v[52:55], v[84:87], v[156:159]
  v_mfma_f32_16x16x32_bf16 v[172:175], v[56:59], v[80:83], v[172:175]
  v_mfma_f32_16x16x32_bf16 v[172:175], v[60:63], v[84:87], v[172:175]
  v_mfma_f32_16x16x32_bf16 v[176:179], v[56:59], v[88:91], v[176:179]
  v_mfma_f32_16x16x32_bf16 v[176:179], v[60:63], v[92:95], v[176:179]
  s_cmp_lt_u32 s72, 4
  v_mfma_f32_16x16x32_bf16 v[180:183], v[56:59], v[96:99], v[180:183]
  v_mfma_f32_16x16x32_bf16 v[180:183], v[60:63], v[100:103], v[180:183]
  v_mfma_f32_16x16x32_bf16 v[184:187], v[56:59], v[104:107], v[184:187]
  v_mfma_f32_16x16x32_bf16 v[184:187], v[60:63], v[108:111], v[184:187]
  v_mfma_f32_16x16x32_bf16 v[200:203], v[64:67], v[104:107], v[200:203]
  v_mfma_f32_16x16x32_bf16 v[200:203], v[68:71], v[108:111], v[200:203]
  v_mfma_f32_16x16x32_bf16 v[196:199], v[64:67], v[96:99], v[196:199]
  v_mfma_f32_16x16x32_bf16 v[196:199], v[68:71], v[100:103], v[196:199]
  v_mfma_f32_16x16x32_bf16 v[192:195], v[64:67], v[88:91], v[192:195]
  v_mfma_f32_16x16x32_bf16 v[192:195], v[68:71], v[92:95], v[192:195]
  v_mfma_f32_16x16x32_bf16 v[188:191], v[64:67], v[80:83], v[188:191]
  v_mfma_f32_16x16x32_bf16 v[188:191], v[68:71], v[84:87], v[188:191]
  v_mfma_f32_16x16x32_bf16 v[204:207], v[72:75], v[80:83], v[204:207]
  v_mfma_f32_16x16x32_bf16 v[204:207], v[76:79], v[84:87], v[204:207]
  v_mfma_f32_16x16x32_bf16 v[208:211], v[72:75], v[88:91], v[208:211]
  v_mfma_f32_16x16x32_bf16 v[208:211], v[76:79], v[92:95], v[208:211]
  v_mfma_f32_16x16x32_bf16 v[212:215], v[72:75], v[96:99], v[212:215]
  v_mfma_f32_16x16x32_bf16 v[212:215], v[76:79], v[100:103], v[212:215]
  v_mfma_f32_16x16x32_bf16 v[216:219], v[72:75], v[104:107], v[216:219]
  s_setprio 2
  s_barrier
  v_mfma_f32_16x16x32_bf16 v[216:219], v[76:79], v[108:111], v[216:219]
  s_cbranch_scc1 L_dnn_loop0
  ds_read_b64_tr_b16 v[40:41], v1 offset:0
  v_lshl_add_u32 v34, v20, 7, v15
  v_lshl_add_u32 v28, v16, 7, v14
  s_add_u32 m0, s76, 8192
  s_nop 0
  buffer_load_dwordx4 v28, s[32:35], 0 offen lds
  ds_read_b64_tr_b16 v[42:43], v1 offset:2560
  ds_read_b64_tr_b16 v[44:45], v1 offset:20480
  ds_read_b64_tr_b16 v[46:47], v1 offset:23040
  ds_read_b64_tr_b16 v[48:49], v2 offset:0
  ds_read_b64_tr_b16 v[50:51], v2 offset:2560
  ds_read_b64_tr_b16 v[52:53], v2 offset:20480
  ds_read_b64_tr_b16 v[54:55], v2 offset:23040
  ds_read_b64_tr_b16 v[56:57], v3 offset:0
  ds_read_b64_tr_b16 v[58:59], v3 offset:2560
  ds_read_b64_tr_b16 v[60:61], v3 offset:20480
  ds_read_b64_tr_b16 v[62:63], v3 offset:23040
  ds_read_b64_tr_b16 v[64:65], v4 offset:0
  ds_read_b64_tr_b16 v[66:67], v4 offset:2560
  ds_read_b64_tr_b16 v[68:69], v4 offset:20480
  ds_read_b64_tr_b16 v[70:71], v4 offset:23040
  ds_read_b128 v[80:83], v11 offset:0
  s_add_u32 m0, m0, 1024
  s_nop 0
  buffer_load_dwordx4 v34, s[32:35], 0 offen lds
  ds_read_b128 v[84:87], v12 offset:0
  ds_read_b128 v[88:91], v11 offset:2048
  ds_read_b128 v[92:95], v12 offset:2048
  ds_read_b128 v[96:99], v11 offset:4096
  ds_read_b128 v[100:103], v12 offset:4096
  ds_read_b128 v[104:107], v11 offset:6144
  ds_read_b128 v[108:111], v12 offset:6144
  ds_read_b64_tr_b16 v[72:73], v5 offset:0
  ds_read_b64_tr_b16 v[74:75], v5 offset:2560
  ds_read_b64_tr_b16 v[76:77], v5 offset:20480
  ds_read_b64_tr_b16 v[78:79], v5 offset:23040
  ds_read_b64 v[220:221], v35 offset:640
  ds_read_b64 v[222:223], v35 offset:672
  ds_read_b64 v[224:225], v35 offset:704
  ds_read_b64 v[226:227], v35 offset:736
  ds_read_b64 v[228:229], v35 offset:768
  s_mov_b32 s60, s24
  s_and_b32 s61, s25, 0xffff
  s_mov_b32 s62, 268435456
  s_mov_b32 s63, 0x20000
  s_mov_b32 s64, s22
  s_and_b32 s65, s23, 0xffff
  s_mov_b32 s66, 256
  s_mov_b32 s67, 0x20000
  v_lshlrev_b32 v28, 2, v0
  s_mov_b64 exec, 0xff
  s_mov_b32 s81, 0x80000
  buffer_load_dword v255, v28, s[60:63], s81 offen
  buffer_load_dword v37, v28, s[64:67], 0 offen offset:128 sc1
  s_mov_b64 exec, -1
  v_mov_b32 v28, 0
  s_waitcnt vmcnt(6) lgkmcnt(0)
  s_barrier
  s_setprio 0
  v_mfma_f32_16x16x32_bf16 v[140:143], v[40:43], v[80:83], v[140:143]
  v_mov_b32 v232, 0xc0135761
  v_mov_b32 v233, 0xc0135761
  v_mfma_f32_16x16x32_bf16 v[140:143], v[44:47], v[84:87], v[140:143]
  v_mov_b32 v234, 0xbdd2d3e8
  v_mfma_f32_16x16x32_bf16 v[144:147], v[40:43], v[88:91], v[144:147]
  v_mov_b32 v235, 0xbdd2d3e8
  v_mfma_f32_16x16x32_bf16 v[144:147], v[44:47], v[92:95], v[144:147]
  v_mov_b32 v236, 0x71800000
  v_mfma_f32_16x16x32_bf16 v[148:151], v[40:43], v[96:99], v[148:151]
  v_lshlrev_b32 v112, 16, v220
  v_mfma_f32_16x16x32_bf16 v[148:151], v[44:47], v[100:103], v[148:151]
  v_and_b32 v113, 0xffff0000, v220
  v_mfma_f32_16x16x32_bf16 v[152:155], v[40:43], v[104:107], v[152:155]
  v_lshlrev_b32 v114, 16, v221
  v_mfma_f32_16x16x32_bf16 v[152:155], v[44:47], v[108:111], v[152:155]
  v_and_b32 v115, 0xffff0000, v221
  v_mfma_f32_16x16x32_bf16 v[168:171], v[48:51], v[104:107], v[168:171]
  v_lshlrev_b32 v116, 16, v222
  v_mfma_f32_16x16x32_bf16 v[168:171], v[52:55], v[108:111], v[168:171]
  v_and_b32 v117, 0xffff0000, v222
  v_mfma_f32_16x16x32_bf16 v[164:167], v[48:51], v[96:99], v[164:167]
  v_lshlrev_b32 v118, 16, v223
  v_mfma_f32_16x16x32_bf16 v[164:167], v[52:55], v[100:103], v[164:167]
  v_and_b32 v119, 0xffff0000, v223
  v_mfma_f32_16x16x32_bf16 v[160:163], v[48:51], v[88:91], v[160:163]
  v_lshlrev_b32 v120, 16, v224
  v_mfma_f32_16x16x32_bf16 v[160:163], v[52:55], v[92:95], v[160:163]
  v_and_b32 v121, 0xffff0000, v224
  v_mfma_f32_16x16x32_bf16 v[156:159], v[48:51], v[80:83], v[156:159]
  v_lshlrev_b32 v122, 16, v225
  v_mfma_f32_16x16x32_bf16 v[156:159], v[52:55], v[84:87], v[156:159]
  v_and_b32 v123, 0xffff0000, v225
  v_mfma_f32_16x16x32_bf16 v[172:175], v[56:59], v[80:83], v[172:175]
  v_lshlrev_b32 v124, 16, v226
  v_mfma_f32_16x16x32_bf16 v[172:175], v[60:63], v[84:87], v[172:175]
  v_and_b32 v125, 0xffff0000, v226
  v_mfma_f32_16x16x32_bf16 v[176:179], v[56:59], v[88:91], v[176:179]
  v_lshlrev_b32 v126, 16, v227
  v_mfma_f32_16x16x32_bf16 v[176:179], v[60:63], v[92:95], v[176:179]
  v_and_b32 v127, 0xffff0000, v227
  v_mfma_f32_16x16x32_bf16 v[180:183], v[56:59], v[96:99], v[180:183]
  v_lshlrev_b32 v128, 16, v228
  v_mfma_f32_16x16x32_bf16 v[180:183], v[60:63], v[100:103], v[180:183]
  v_and_b32 v129, 0xffff0000, v228
  v_mfma_f32_16x16x32_bf16 v[184:187], v[56:59], v[104:107], v[184:187]
  v_lshlrev_b32 v130, 16, v229
  v_mfma_f32_16x16x32_bf16 v[184:187], v[60:63], v[108:111], v[184:187]
  v_and_b32 v131, 0xffff0000, v229
  v_mfma_f32_16x16x32_bf16 v[200:203], v[64:67], v[104:107], v[200:203]
  v_rcp_f32 v112, v112
  v_mfma_f32_16x16x32_bf16 v[200:203], v[68:71], v[108:111], v[200:203]
  v_rcp_f32 v113, v113
  v_mfma_f32_16x16x32_bf16 v[196:199], v[64:67], v[96:99], v[196:199]
  v_rcp_f32 v114, v114
  v_mfma_f32_16x16x32_bf16 v[196:199], v[68:71], v[100:103], v[196:199]
  v_rcp_f32 v115, v115
  v_mfma_f32_16x16x32_bf16 v[192:195], v[64:67], v[88:91], v[192:195]
  v_rcp_f32 v116, v116
  v_mfma_f32_16x16x32_bf16 v[192:195], v[68:71], v[92:95], v[192:195]
  v_rcp_f32 v117, v117
  v_mfma_f32_16x16x32_bf16 v[188:191], v[64:67], v[80:83], v[188:191]
  v_rcp_f32 v118, v118
  v_mfma_f32_16x16x32_bf16 v[188:191], v[68:71], v[84:87], v[188:191]
  v_rcp_f32 v119, v119
  v_mfma_f32_16x16x32_bf16 v[204:207], v[72:75], v[80:83], v[204:207]
  v_rcp_f32 v120, v120
  v_mfma_f32_16x16x32_bf16 v[204:207], v[76:79], v[84:87], v[204:207]
  v_rcp_f32 v121, v121
  v_mfma_f32_16x16x32_bf16 v[208:211], v[72:75], v[88:91], v[208:211]
  v_rcp_f32 v122, v122
  v_mfma_f32_16x16x32_bf16 v[208:211], v[76:79], v[92:95], v[208:211]
  v_rcp_f32 v123, v123
  v_mfma_f32_16x16x32_bf16 v[212:215], v[72:75], v[96:99], v[212:215]
  v_rcp_f32 v124, v124
  v_mfma_f32_16x16x32_bf16 v[212:215], v[76:79], v[100:103], v[212:215]
  v_rcp_f32 v125, v125
  v_mfma_f32_16x16x32_bf16 v[216:219], v[72:75], v[104:107], v[216:219]
  s_setprio 2
  s_barrier
  v_mfma_f32_16x16x32_bf16 v[216:219], v[76:79], v[108:111], v[216:219]
  ds_read_b64_tr_b16 v[40:41], v1 offset:40960
  ds_read_b64_tr_b16 v[42:43], v1 offset:43520
  ds_read_b64_tr_b16 v[44:45], v6 offset:0
  ds_read_b64_tr_b16 v[46:47], v6 offset:2560
  ds_read_b64_tr_b16 v[48:49], v2 offset:40960
  ds_read_b64_tr_b16 v[50:51], v2 offset:43520
  ds_read_b64_tr_b16 v[52:53], v7 offset:0
  ds_read_b64_tr_b16 v[54:55], v7 offset:2560
  ds_read_b64_tr_b16 v[56:57], v3 offset:40960
  ds_read_b64_tr_b16 v[58:59], v3 offset:43520
  ds_read_b64_tr_b16 v[60:61], v8 offset:0
  ds_read_b64_tr_b16 v[62:63], v8 offset:2560
  ds_read_b64_tr_b16 v[64:65], v4 offset:40960
  ds_read_b64_tr_b16 v[66:67], v4 offset:43520
  ds_read_b64_tr_b16 v[68:69], v9 offset:0
  ds_read_b64_tr_b16 v[70:71], v9 offset:2560
  ds_read_b128 v[80:83], v11 offset:8192
  ds_read_b128 v[84:87], v12 offset:8192
  ds_read_b128 v[88:91], v11 offset:10240
  ds_read_b128 v[92:95], v12 offset:10240
  ds_read_b128 v[96:99], v11 offset:12288
  ds_read_b128 v[100:103], v12 offset:12288
  ds_read_b128 v[104:107], v11 offset:14336
  ds_read_b128 v[108:111], v12 offset:14336
  ds_read_b64_tr_b16 v[72:73], v5 offset:40960
  ds_read_b64_tr_b16 v[74:75], v5 offset:43520
  ds_read_b64_tr_b16 v[76:77], v10 offset:0
  ds_read_b64_tr_b16 v[78:79], v10 offset:2560
  s_waitcnt vmcnt(2) lgkmcnt(0)
  s_barrier
  s_setprio 0
  v_mfma_f32_16x16x32_bf16 v[140:143], v[40:43], v[80:83], v[140:143]
  v_rcp_f32 v126, v126
  v_mfma_f32_16x16x32_bf16 v[140:143], v[44:47], v[84:87], v[140:143]
  v_rcp_f32 v127, v127
  v_mfma_f32_16x16x32_bf16 v[144:147], v[40:43], v[88:91], v[144:147]
  v_rcp_f32 v128, v128
  v_mfma_f32_16x16x32_bf16 v[144:147], v[44:47], v[92:95], v[144:147]
  v_mfma_f32_16x16x32_bf16 v[148:151], v[40:43], v[96:99], v[148:151]
  v_rcp_f32 v129, v129
  v_mfma_f32_16x16x32_bf16 v[148:151], v[44:47], v[100:103], v[148:151]
  v_rcp_f32 v130, v130
  v_mfma_f32_16x16x32_bf16 v[152:155], v[40:43], v[104:107], v[152:155]
  v_mfma_f32_16x16x32_bf16 v[152:155], v[44:47], v[108:111], v[152:155]
  v_rcp_f32 v131, v131
  v_mfma_f32_16x16x32_bf16 v[168:171], v[48:51], v[104:107], v[168:171]
  v_med3_f32 v112, v112, -v236, v236
  v_mfma_f32_16x16x32_bf16 v[168:171], v[52:55], v[108:111], v[168:171]
  v_mfma_f32_16x16x32_bf16 v[164:167], v[48:51], v[96:99], v[164:167]
  v_med3_f32 v113, v113, -v236, v236
  v_mfma_f32_16x16x32_bf16 v[164:167], v[52:55], v[100:103], v[164:167]
  v_med3_f32 v114, v114, -v236, v236
  v_mfma_f32_16x16x32_bf16 v[160:163], v[48:51], v[88:91], v[160:163]
  v_mfma_f32_16x16x32_bf16 v[160:163], v[52:55], v[92:95], v[160:163]
  v_med3_f32 v115, v115, -v236, v236
  v_mfma_f32_16x16x32_bf16 v[156:159], v[48:51], v[80:83], v[156:159]
  v_med3_f32 v116, v116, -v236, v236
  v_mfma_f32_16x16x32_bf16 v[156:159], v[52:55], v[84:87], v[156:159]
  v_mfma_f32_16x16x32_bf16 v[172:175], v[56:59], v[80:83], v[172:175]
  v_med3_f32 v117, v117, -v236, v236
  v_mfma_f32_16x16x32_bf16 v[172:175], v[60:63], v[84:87], v[172:175]
  v_med3_f32 v118, v118, -v236, v236
  v_mfma_f32_16x16x32_bf16 v[176:179], v[56:59], v[88:91], v[176:179]
  v_mfma_f32_16x16x32_bf16 v[176:179], v[60:63], v[92:95], v[176:179]
  v_med3_f32 v119, v119, -v236, v236
  v_mfma_f32_16x16x32_bf16 v[180:183], v[56:59], v[96:99], v[180:183]
  v_med3_f32 v120, v120, -v236, v236
  v_mfma_f32_16x16x32_bf16 v[180:183], v[60:63], v[100:103], v[180:183]
  v_med3_f32 v121, v121, -v236, v236
  v_mfma_f32_16x16x32_bf16 v[184:187], v[56:59], v[104:107], v[184:187]
  v_mfma_f32_16x16x32_bf16 v[184:187], v[60:63], v[108:111], v[184:187]
  v_med3_f32 v122, v122, -v236, v236
  v_mfma_f32_16x16x32_bf16 v[200:203], v[64:67], v[104:107], v[200:203]
  v_med3_f32 v123, v123, -v236, v236
  v_mfma_f32_16x16x32_bf16 v[200:203], v[68:71], v[108:111], v[200:203]
  v_mfma_f32_16x16x32_bf16 v[196:199], v[64:67], v[96:99], v[196:199]
  v_med3_f32 v124, v124, -v236, v236
  v_mfma_f32_16x16x32_bf16 v[196:199], v[68:71], v[100:103], v[196:199]
  v_med3_f32 v125, v125, -v236, v236
  v_mfma_f32_16x16x32_bf16 v[192:195], v[64:67], v[88:91], v[192:195]
  v_mfma_f32_16x16x32_bf16 v[192:195], v[68:71], v[92:95], v[192:195]
  v_med3_f32 v126, v126, -v236, v236
  v_mfma_f32_16x16x32_bf16 v[188:191], v[64:67], v[80:83], v[188:191]
  v_med3_f32 v127, v127, -v236, v236
  v_mfma_f32_16x16x32_bf16 v[188:191], v[68:71], v[84:87], v[188:191]
  v_mfma_f32_16x16x32_bf16 v[204:207], v[72:75], v[80:83], v[204:207]
  v_med3_f32 v128, v128, -v236, v236
  v_mfma_f32_16x16x32_bf16 v[204:207], v[76:79], v[84:87], v[204:207]
  v_med3_f32 v129, v129, -v236, v236
  v_mfma_f32_16x16x32_bf16 v[208:211], v[72:75], v[88:91], v[208:211]
  v_mfma_f32_16x16x32_bf16 v[208:211], v[76:79], v[92:95], v[208:211]
  v_med3_f32 v130, v130, -v236, v236
  v_mfma_f32_16x16x32_bf16 v[212:215], v[72:75], v[96:99], v[212:215]
  v_med3_f32 v131, v131, -v236, v236
  v_mfma_f32_16x16x32_bf16 v[212:215], v[76:79], v[100:103], v[212:215]
  v_mfma_f32_16x16x32_bf16 v[216:219], v[72:75], v[104:107], v[216:219]
  s_setprio 2
  s_barrier
  v_mfma_f32_16x16x32_bf16 v[216:219], v[76:79], v[108:111], v[216:219]
  s_setprio 0
  s_branch L_epi
L_dnn_h1:
  v_lshl_add_u32 v34, v117, 7, v15
  v_lshl_add_u32 v28, v113, 7, v14
  s_add_u32 m0, s76, 8192
  s_nop 0
  buffer_load_dwordx4 v28, s[32:35], 0 offen lds
  s_add_u32 m0, m0, 1024
  s_nop 0
  buffer_load_dwordx4 v34, s[32:35], 0 offen lds
  s_add_u32 m0, s75, 40960
  s_nop 0
  buffer_load_dwordx4 v29, s[44:47], s74 offen offset:0 lds
  buffer_load_dwordx4 v30, s[44:47], s74 offen offset:1024 lds
  buffer_load_dwordx4 v31, s[44:47], s74 offen offset:2048 lds
  buffer_load_dwordx4 v32, s[44:47], s74 offen offset:3072 lds
  s_add_u32 m0, m0, 4096
  s_nop 0
  buffer_load_dwordx4 v33, s[44:47], s74 offen offset:0 lds
  s_add_u32 s74, s74, 212992
  s_waitcnt vmcnt(13)
  s_waitcnt vmcnt(10) lgkmcnt(0)
  s_barrier
  buffer_load_dwordx3 v[24:26], v13, s[28:31], s73 offen offset:0
  buffer_load_dwordx3 v[240:242], v13, s[28:31], s73 offen offset:832
  s_add_u32 s73, s73, 12
  s_barrier
L_dnn_loop1:
  ds_read_b64_tr_b16 v[40:41], v1 offset:0
  s_add_u32 m0, s75, 81920
  s_nop 0
  buffer_load_dwordx4 v29, s[44:47], s74 offen offset:0 lds
  ds_read_b64_tr_b16 v[42:43], v1 offset:2560
  ds_read_b64_tr_b16 v[44:45], v1 offset:20480
  ds_read_b64_tr_b16 v[46:47], v1 offset:23040
  ds_read_b64_tr_b16 v[48:49], v2 offset:0
  buffer_load_dwordx4 v30, s[44:47], s74 offen offset:1024 lds
  ds_read_b64_tr_b16 v[50:51], v2 offset:2560
  ds_read_b64_tr_b16 v[52:53], v2 offset:20480
  ds_read_b64_tr_b16 v[54:55], v2 offset:23040
  ds_read_b64_tr_b16 v[56:57], v3 offset:0
  buffer_load_dwordx4 v31, s[44:47], s74 offen offset:2048 lds
  ds_read_b64_tr_b16 v[58:59], v3 offset:2560
  ds_read_b64_tr_b16 v[60:61], v3 offset:20480
  ds_read_b64_tr_b16 v[62:63], v3 offset:23040
  ds_read_b64_tr_b16 v[64:65], v4 offset:0
  buffer_load_dwordx4 v32, s[44:47], s74 offen offset:3072 lds
  ds_read_b64_tr_b16 v[66:67], v4 offset:2560
  ds_read_b64_tr_b16 v[68:69], v4 offset:20480
  ds_read_b64_tr_b16 v[70:71], v4 offset:23040
  ds_read_b128 v[80:83], v11 offset:0
  s_add_u32 m0, m0, 4096
  s_nop 0
  buffer_load_dwordx4 v33, s[44:47], s74 offen offset:0 lds
  s_add_u32 s74, s74, 212992
  ds_read_b128 v[84:87], v12 offset:0
  ds_read_b128 v[88:91], v11 offset:2048
  ds_read_b128 v[92:95], v12 offset:2048
  ds_read_b128 v[96:99], v11 offset:4096
  s_waitcnt vmcnt(14)
  v_lshl_add_u32 v34, v20, 7, v15
  v_lshl_add_u32 v28, v16, 7, v14
  s_add_u32 m0, s76, 0
  s_nop 0
  buffer_load_dwordx4 v28, s[32:35], 0 offen lds
  ds_read_b128 v[100:103], v12 offset:4096
  ds_read_b128 v[104:107], v11 offset:6144
  ds_read_b128 v[108:111], v12 offset:6144
  ds_read_b64_tr_b16 v[72:73], v5 offset:0
  s_add_u32 m0, m0, 1024
  s_nop 0
  buffer_load_dwordx4 v34, s[32:35], 0 offen lds
  ds_read_b64_tr_b16 v[74:75], v5 offset:2560
  ds_read_b64_tr_b16 v[76:77], v5 offset:20480
  ds_read_b64_tr_b16 v[78:79], v5 offset:23040
  s_waitcnt vmcnt(9) lgkmcnt(0)
  s_waitcnt vmcnt(9)
  s_barrier
  s_setprio 0
  v_mfma_f32_16x16x32_bf16 v[140:143], v[40:43], v[80:83], v[140:143]
  v_mfma_f32_16x16x32_bf16 v[140:143], v[44:47], v[84:87], v[140:143]
  v_mfma_f32_16x16x32_bf16 v[144:147], v[40:43], v[88:91], v[144:147]
  v_mfma_f32_16x16x32_bf16 v[144:147], v[44:47], v[92:95], v[144:147]
  v_mfma_f32_16x16x32_bf16 v[148:151], v[40:43], v[96:99], v[148:151]
  v_mfma_f32_16x16x32_bf16 v[148:151], v[44:47], v[100:103], v[148:151]
  v_mfma_f32_16x16x32_bf16 v[152:155], v[40:43], v[104:107], v[152:155]
  v_mfma_f32_16x16x32_bf16 v[152:155], v[44:47], v[108:111], v[152:155]
  v_mfma_f32_16x16x32_bf16 v[168:171], v[48:51], v[104:107], v[168:171]
  v_mfma_f32_16x16x32_bf16 v[168:171], v[52:55], v[108:111], v[168:171]
  v_mfma_f32_16x16x32_bf16 v[164:167], v[48:51], v[96:99], v[164:167]
  v_mfma_f32_16x16x32_bf16 v[164:167], v[52:55], v[100:103], v[164:167]
  v_mfma_f32_16x16x32_bf16 v[160:163], v[48:51], v[88:91], v[160:163]
  v_mfma_f32_16x16x32_bf16 v[160:163], v[52:55], v[92:95], v[160:163]
  v_mfma_f32_16x16x32_bf16 v[156:159], v[48:51], v[80:83], v[156:159]
  v_mfma_f32_16x16x32_bf16 v[156:159], v[52:55], v[84:87], v[156:159]
  v_mfma_f32_16x16x32_bf16 v[172:175], v[56:59], v[80:83], v[172:175]
  v_mfma_f32_16x16x32_bf16 v[172:175], v[60:63], v[84:87], v[172:175]
  v_mfma_f32_16x16x32_bf16 v[176:179], v[56:59], v[88:91], v[176:179]
  v_mfma_f32_16x16x32_bf16 v[176:179], v[60:63], v[92:95], v[176:179]
  v_mfma_f32_16x16x32_bf16 v[180:183], v[56:59], v[96:99], v[180:183]
  v_mfma_f32_16x16x32_bf16 v[180:183], v[60:63], v[100:103], v[180:183]
  v_mfma_f32_16x16x32_bf16 v[184:187], v[56:59], v[104:107], v[184:187]
  v_mfma_f32_16x16x32_bf16 v[184:187], v[60:63], v[108:111], v[184:187]
  v_mfma_f32_16x16x32_bf16 v[200:203], v[64:67], v[104:107], v[200:203]
  v_mfma_f32_16x16x32_bf16 v[200:203], v[68:71], v[108:111], v[200:203]
  v_mfma_f32_16x16x32_bf16 v[196:199], v[64:67], v[96:99], v[196:199]
  v_mfma_f32_16x16x32_bf16 v[196:199], v[68:71], v[100:103], v[196:199]
  v_mfma_f32_16x16x32_bf16 v[192:195], v[64:67], v[88:91], v[192:195]
  v_mfma_f32_16x16x32_bf16 v[192:195], v[68:71], v[92:95], v[192:195]
  v_mfma_f32_16x16x32_bf16 v[188:191], v[64:67], v[80:83], v[188:191]
  v_mfma_f32_16x16x32_bf16 v[188:191], v[68:71], v[84:87], v[188:191]
  v_mfma_f32_16x16x32_bf16 v[204:207], v[72:75], v[80:83], v[204:207]
  v_mfma_f32_16x16x32_bf16 v[204:207], v[76:79], v[84:87], v[204:207]
  v_mfma_f32_16x16x32_bf16 v[208:211], v[72:75], v[88:91], v[208:211]
  v_mfma_f32_16x16x32_bf16 v[208:211], v[76:79], v[92:95], v[208:211]
  v_mfma_f32_16x16x32_bf16 v[212:215], v[72:75], v[96:99], v[212:215]
  v_mfma_f32_16x16x32_bf16 v[212:215], v[76:79], v[100:103], v[212:215]
  v_mfma_f32_16x16x32_bf16 v[216:219], v[72:75], v[104:107], v[216:219]
  s_setprio 2
  s_barrier
  v_mfma_f32_16x16x32_bf16 v[216:219], v[76:79], v[108:111], v[216:219]
  ds_read_b64_tr_b16 v[40:41], v1 offset:40960
  s_add_u32 m0, s75, 0
  s_nop 0
  buffer_load_dwordx4 v29, s[44:47], s74 offen offset:0 lds
  ds_read_b64_tr_b16 v[42:43], v1 offset:43520
  ds_read_b64_tr_b16 v[44:45], v6 offset:0
  ds_read_b64_tr_b16 v[46:47], v6 offset:2560
  ds_read_b64_tr_b16 v[48:49], v2 offset:40960
  buffer_load_dwordx4 v30, s[44:47], s74 offen offset:1024 lds
  ds_read_b64_tr_b16 v[50:51], v2 offset:43520
  ds_read_b64_tr_b16 v[52:53], v7 offset:0
  ds_read_b64_tr_b16 v[54:55], v7 offset:2560
  ds_read_b64_tr_b16 v[56:57], v3 offset:40960
  buffer_load_dwordx4 v31, s[44:47], s74 offen offset:2048 lds
  ds_read_b64_tr_b16 v[58:59], v3 offset:43520
  ds_read_b64_tr_b16 v[60:61], v8 offset:0
  ds_read_b64_tr_b16 v[62:63], v8 offset:2560
  ds_read_b64_tr_b16 v[64:65], v4 offset:40960
  buffer_load_dwordx4 v32, s[44:47], s74 offen offset:3072 lds
  ds_read_b64_tr_b16 v[66:67], v4 offset:43520
  ds_read_b64_tr_b16 v[68:69], v9 offset:0
  ds_read_b64_tr_b16 v[70:71], v9 offset:2560
  ds_read_b128 v[80:83], v11 offset:8192
  s_add_u32 m0, m0, 4096
  s_nop 0
  buffer_load_dwordx4 v33, s[44:47], s74 offen offset:0 lds
  s_add_u32 s74, s74, 212992
  ds_read_b128 v[84:87], v12 offset:8192
  ds_read_b128 v[88:91], v11 offset:10240
  ds_read_b128 v[92:95], v12 offset:10240
  ds_read_b128 v[96:99], v11 offset:12288
  v_lshl_add_u32 v34, v21, 7, v15
  v_lshl_add_u32 v28, v17, 7, v14
  s_add_u32 m0, s76, 8192
  s_nop 0
  buffer_load_dwordx4 v28, s[32:35], 0 offen lds
  ds_read_b128 v[100:103], v12 offset:12288
  ds_read_b128 v[104:107], v11 offset:14336
  ds_read_b128 v[108:111], v12 offset:14336
  ds_read_b64_tr_b16 v[72:73], v5 offset:40960
  s_add_u32 m0, m0, 1024
  s_nop 0
  buffer_load_dwordx4 v34, s[32:35], 0 offen lds
  ds_read_b64_tr_b16 v[74:75], v5 offset:43520
  ds_read_b64_tr_b16 v[76:77], v10 offset:0
  ds_read_b64_tr_b16 v[78:79], v10 offset:2560
  s_waitcnt vmcnt(7) lgkmcnt(0)
  s_barrier
  s_setprio 0
  v_mfma_f32_16x16x32_bf16 v[140:143], v[40:43], v[80:83], v[140:143]
  v_mfma_f32_16x16x32_bf16 v[140:143], v[44:47], v[84:87], v[140:143]
  v_mfma_f32_16x16x32_bf16 v[144:147], v[40:43], v[88:91], v[144:147]
  v_mfma_f32_16x16x32_bf16 v[144:147], v[44:47], v[92:95], v[144:147]
  v_mfma_f32_16x16x32_bf16 v[148:151], v[40:43], v[96:99], v[148:151]
  v_mfma_f32_16x16x32_bf16 v[148:151], v[44:47], v[100:103], v[148:151]
  v_mfma_f32_16x16x32_bf16 v[152:155], v[40:43], v[104:107], v[152:155]
  v_mfma_f32_16x16x32_bf16 v[152:155], v[44:47], v[108:111], v[152:155]
  v_mfma_f32_16x16x32_bf16 v[168:171], v[48:51], v[104:107], v[168:171]
  v_mfma_f32_16x16x32_bf16 v[168:171], v[52:55], v[108:111], v[168:171]
  v_mfma_f32_16x16x32_bf16 v[164:167], v[48:51], v[96:99], v[164:167]
  v_mfma_f32_16x16x32_bf16 v[164:167], v[52:55], v[100:103], v[164:167]
  v_mfma_f32_16x16x32_bf16 v[160:163], v[48:51], v[88:91], v[160:163]
  v_mfma_f32_16x16x32_bf16 v[160:163], v[52:55], v[92:95], v[160:163]
  v_mfma_f32_16x16x32_bf16 v[156:159], v[48:51], v[80:83], v[156:159]
  v_mfma_f32_16x16x32_bf16 v[156:159], v[52:55], v[84:87], v[156:159]
  v_mfma_f32_16x16x32_bf16 v[172:175], v[56:59], v[80:83], v[172:175]
  v_mfma_f32_16x16x32_bf16 v[172:175], v[60:63], v[84:87], v[172:175]
  v_mfma_f32_16x16x32_bf16 v[176:179], v[56:59], v[88:91], v[176:179]
  v_mfma_f32_16x16x32_bf16 v[176:179], v[60:63], v[92:95], v[176:179]
  v_mfma_f32_16x16x32_bf16 v[180:183], v[56:59], v[96:99], v[180:183]
  v_mfma_f32_16x16x32_bf16 v[180:183], v[60:63], v[100:103], v[180:183]
  v_mfma_f32_16x16x32_bf16 v[184:187], v[56:59], v[104:107], v[184:187]
  v_mfma_f32_16x16x32_bf16 v[184:187], v[60:63], v[108:111], v[184:187]
  v_mfma_f32_16x16x32_bf16 v[200:203], v[64:67], v[104:107], v[200:203]
  v_mfma_f32_16x16x32_bf16 v[200:203], v[68:71], v[108:111], v[200:203]
  v_mfma_f32_16x16x32_bf16 v[196:199], v[64:67], v[96:99], v[196:199]
  v_mfma_f32_16x16x32_bf16 v[196:199], v[68:71], v[100:103], v[196:199]
  v_mfma_f32_16x16x32_bf16 v[192:195], v[64:67], v[88:91], v[192:195]
  v_mfma_f32_16x16x32_bf16 v[192:195], v[68:71], v[92:95], v[192:195]
  v_mfma_f32_16x16x32_bf16 v[188:191], v[64:67], v[80:83], v[188:191]
  v_mfma_f32_16x16x32_bf16 v[188:191], v[68:71], v[84:87], v[188:191]
  v_mfma_f32_16x16x32_bf16 v[204:207], v[72:75], v[80:83], v[204:207]
  v_mfma_f32_16x16x32_bf16 v[204:207], v[76:79], v[84:87], v[204:207]
  v_mfma_f32_16x16x32_bf16 v[208:211], v[72:75], v[88:91], v[208:211]
  v_mfma_f32_16x16x32_bf16 v[208:211], v[76:79], v[92:95], v[208:211]
  v_mfma_f32_16x16x32_bf16 v[212:215], v[72:75], v[96:99], v[212:215]
  v_mfma_f32_16x16x32_bf16 v[212:215], v[76:79], v[100:103], v[212:215]
  v_mfma_f32_16x16x32_bf16 v[216:219], v[72:75], v[104:107], v[216:219]
  s_setprio 2
  s_barrier
  v_mfma_f32_16x16x32_bf16 v[216:219], v[76:79], v[108:111], v[216:219]
  ds_read_b64_tr_b16 v[40:41], v6 offset:20480
  s_add_u32 m0, s75, 40960
  s_nop 0
  buffer_load_dwordx4 v29, s[44:47], s74 offen offset:0 lds
  ds_read_b64_tr_b16 v[42:43], v6 offset:23040
  ds_read_b64_tr_b16 v[44:45], v6 offset:40960
  ds_read_b64_tr_b16 v[46:47], v6 offset:43520
  ds_read_b64_tr_b16 v[48:49], v7 offset:20480
  buffer_load_dwordx4 v30, s[44:47], s74 offen offset:1024 lds
  ds_read_b64_tr_b16 v[50:51], v7 offset:23040
  ds_read_b64_tr_b16 v[52:53], v7 offset:40960
  ds_read_b64_tr_b16 v[54:55], v7 offset:43520
  ds_read_b64_tr_b16 v[56:57], v8 offset:20480
  buffer_load_dwordx4 v31, s[44:47], s74 offen offset:2048 lds
  ds_read_b64_tr_b16 v[58:59], v8 offset:23040
  ds_read_b64_tr_b16 v[60:61], v8 offset:40960
  ds_read_b64_tr_b16 v[62:63], v8 offset:43520
  ds_read_b64_tr_b16 v[64:65], v9 offset:20480
  buffer_load_dwordx4 v32, s[44:47], s74 offen offset:3072 lds
  ds_read_b64_tr_b16 v[66:67], v9 offset:23040
  ds_read_b64_tr_b16 v[68:69], v9 offset:40960
  ds_read_b64_tr_b16 v[70:71], v9 offset:43520
  ds_read_b128 v[80:83], v11 offset:0
  s_add_u32 m0, m0, 4096
  s_nop 0
  buffer_load_dwordx4 v33, s[44:47], s74 offen offset:0 lds
  s_add_u32 s74, s74, 212992
  ds_read_b128 v[84:87], v12 offset:0
  ds_read_b128 v[88:91], v11 offset:2048
  ds_read_b128 v[92:95], v12 offset:2048
  ds_read_b128 v[96:99], v11 offset:4096
  v_lshl_add_u32 v34, v22, 7, v15
  v_lshl_add_u32 v28, v18, 7, v14
  s_add_u32 m0, s76, 0
  s_nop 0
  buffer_load_dwordx4 v28, s[32:35], 0 offen lds
  ds_read_b128 v[100:103], v12 offset:4096
  ds_read_b128 v[104:107], v11 offset:6144
  ds_read_b128 v[108:111], v12 offset:6144
  ds_read_b64_tr_b16 v[72:73], v10 offset:20480
  s_add_u32 m0, m0, 1024
  s_nop 0
  buffer_load_dwordx4 v34, s[32:35], 0 offen lds
  ds_read_b64_tr_b16 v[74:75], v10 offset:23040
  ds_read_b64_tr_b16 v[76:77], v10 offset:40960
  ds_read_b64_tr_b16 v[78:79], v10 offset:43520
  buffer_load_dwordx3 v[16:18], v13, s[28:31], s73 offen offset:0
  buffer_load_dwordx3 v[20:22], v13, s[28:31], s73 offen offset:832
  s_add_u32 s73, s73, 12
  s_waitcnt vmcnt(9) lgkmcnt(0)
  s_barrier
  s_setprio 0
  v_mfma_f32_16x16x32_bf16 v[140:143], v[40:43], v[80:83], v[140:143]
  v_mfma_f32_16x16x32_bf16 v[140:143], v[44:47], v[84:87], v[140:143]
  v_mfma_f32_16x16x32_bf16 v[144:147], v[40:43], v[88:91], v[144:147]
  v_mfma_f32_16x16x32_bf16 v[144:147], v[44:47], v[92:95], v[144:147]
  v_mfma_f32_16x16x32_bf16 v[148:151], v[40:43], v[96:99], v[148:151]
  v_mfma_f32_16x16x32_bf16 v[148:151], v[44:47], v[100:103], v[148:151]
  v_mfma_f32_16x16x32_bf16 v[152:155], v[40:43], v[104:107], v[152:155]
  v_mfma_f32_16x16x32_bf16 v[152:155], v[44:47], v[108:111], v[152:155]
  v_mfma_f32_16x16x32_bf16 v[168:171], v[48:51], v[104:107], v[168:171]
  v_mfma_f32_16x16x32_bf16 v[168:171], v[52:55], v[108:111], v[168:171]
  v_mfma_f32_16x16x32_bf16 v[164:167], v[48:51], v[96:99], v[164:167]
  v_mfma_f32_16x16x32_bf16 v[164:167], v[52:55], v[100:103], v[164:167]
  v_mfma_f32_16x16x32_bf16 v[160:163], v[48:51], v[88:91], v[160:163]
  v_mfma_f32_16x16x32_bf16 v[160:163], v[52:55], v[92:95], v[160:163]
  v_mfma_f32_16x16x32_bf16 v[156:159], v[48:51], v[80:83], v[156:159]
  v_mfma_f32_16x16x32_bf16 v[156:159], v[52:55], v[84:87], v[156:159]
  v_mfma_f32_16x16x32_bf16 v[172:175], v[56:59], v[80:83], v[172:175]
  v_mfma_f32_16x16x32_bf16 v[172:175], v[60:63], v[84:87], v[172:175]
  v_mfma_f32_16x16x32_bf16 v[176:179], v[56:59], v[88:91], v[176:179]
  v_mfma_f32_16x16x32_bf16 v[176:179], v[60:63], v[92:95], v[176:179]
  v_mfma_f32_16x16x32_bf16 v[180:183], v[56:59], v[96:99], v[180:183]
  v_mfma_f32_16x16x32_bf16 v[180:183], v[60:63], v[100:103], v[180:183]
  v_mfma_f32_16x16x32_bf16 v[184:187], v[56:59], v[104:107], v[184:187]
  v_mfma_f32_16x16x32_bf16 v[184:187], v[60:63], v[108:111], v[184:187]
  v_mfma_f32_16x16x32_bf16 v[200:203], v[64:67], v[104:107], v[200:203]
  v_mfma_f32_16x16x32_bf16 v[200:203], v[68:71], v[108:111], v[200:203]
  v_mfma_f32_16x16x32_bf16 v[196:199], v[64:67], v[96:99], v[196:199]
  v_mfma_f32_16x16x32_bf16 v[196:199], v[68:71], v[100:103], v[196:199]
  v_mfma_f32_16x16x32_bf16 v[192:195], v[64:67], v[88:91], v[192:195]
  v_mfma_f32_16x16x32_bf16 v[192:195], v[68:71], v[92:95], v[192:195]
  v_mfma_f32_16x16x32_bf16 v[188:191], v[64:67], v[80:83], v[188:191]
  v_mfma_f32_16x16x32_bf16 v[188:191], v[68:71], v[84:87], v[188:191]
  v_mfma_f32_16x16x32_bf16 v[204:207], v[72:75], v[80:83], v[204:207]
  v_mfma_f32_16x16x32_bf16 v[204:207], v[76:79], v[84:87], v[204:207]
  v_mfma_f32_16x16x32_bf16 v[208:211], v[72:75], v[88:91], v[208:211]
  v_mfma_f32_16x16x32_bf16 v[208:211], v[76:79], v[92:95], v[208:211]
  v_mfma_f32_16x16x32_bf16 v[212:215], v[72:75], v[96:99], v[212:215]
  v_mfma_f32_16x16x32_bf16 v[212:215], v[76:79], v[100:103], v[212:215]
  v_mfma_f32_16x16x32_bf16 v[216:219], v[72:75], v[104:107], v[216:219]
  s_setprio 2
  s_barrier
  v_mfma_f32_16x16x32_bf16 v[216:219], v[76:79], v[108:111], v[216:219]
  ds_read_b64_tr_b16 v[40:41], v1 offset:0
  s_add_u32 m0, s75, 81920
  s_nop 0
  buffer_load_dwordx4 v29, s[44:47], s74 offen offset:0 lds
  ds_read_b64_tr_b16 v[42:43], v1 offset:2560
  ds_read_b64_tr_b16 v[44:45], v1 offset:20480
  ds_read_b64_tr_b16 v[46:47], v1 offset:23040
  ds_read_b64_tr_b16 v[48:49], v2 offset:0
  buffer_load_dwordx4 v30, s[44:47], s74 offen offset:1024 lds
  ds_read_b64_tr_b16 v[50:51], v2 offset:2560
  ds_read_b64_tr_b16 v[52:53], v2 offset:20480
  ds_read_b64_tr_b16 v[54:55], v2 offset:23040
  ds_read_b64_tr_b16 v[56:57], v3 offset:0
  buffer_load_dwordx4 v31, s[44:47], s74 offen offset:2048 lds
  ds_read_b64_tr_b16 v[58:59], v3 offset:2560
  ds_read_b64_tr_b16 v[60:61], v3 offset:20480
  ds_read_b64_tr_b16 v[62:63], v3 offset:23040
  ds_read_b64_tr_b16 v[64:65], v4 offset:0
  buffer_load_dwordx4 v32, s[44:47], s74 offen offset:3072 lds
  ds_read_b64_tr_b16 v[66:67], v4 offset:2560
  ds_read_b64_tr_b16 v[68:69], v4 offset:20480
  ds_read_b64_tr_b16 v[70:71], v4 offset:23040
  ds_read_b128 v[80:83], v11 offset:8192
  s_add_u32 m0, m0, 4096
  s_nop 0
  buffer_load_dwordx4 v33, s[44:47], s74 offen offset:0 lds
  s_add_u32 s74, s74, 212992
  ds_read_b128 v[84:87], v12 offset:8192
  ds_read_b128 v[88:91], v11 offset:10240
  ds_read_b128 v[92:95], v12 offset:10240
  ds_read_b128 v[96:99], v11 offset:12288
  v_lshl_add_u32 v34, v240, 7, v15
  v_lshl_add_u32 v28, v24, 7, v14
  s_add_u32 m0, s76, 8192
  s_nop 0
  buffer_load_dwordx4 v28, s[32:35], 0 offen lds
  ds_read_b128 v[100:103], v12 offset:12288
  ds_read_b128 v[104:107], v11 offset:14336
  ds_read_b128 v[108:111], v12 offset:14336
  ds_read_b64_tr_b16 v[72:73], v5 offset:0
  s_add_u32 m0, m0, 1024
  s_nop 0
  buffer_load_dwordx4 v34, s[32:35], 0 offen lds
  ds_read_b64_tr_b16 v[74:75], v5 offset:2560
  ds_read_b64_tr_b16 v[76:77], v5 offset:20480
  ds_read_b64_tr_b16 v[78:79], v5 offset:23040
  s_waitcnt vmcnt(9) lgkmcnt(0)
  s_barrier
  s_setprio 0
  v_mfma_f32_16x16x32_bf16 v[140:143], v[40:43], v[80:83], v[140:143]
  v_mfma_f32_16x16x32_bf16 v[140:143], v[44:47], v[84:87], v[140:143]
  v_mfma_f32_16x16x32_bf16 v[144:147], v[40:43], v[88:91], v[144:147]
  v_mfma_f32_16x16x32_bf16 v[144:147], v[44:47], v[92:95], v[144:147]
  v_mfma_f32_16x16x32_bf16 v[148:151], v[40:43], v[96:99], v[148:151]
  v_mfma_f32_16x16x32_bf16 v[148:151], v[44:47], v[100:103], v[148:151]
  v_mfma_f32_16x16x32_bf16 v[152:155], v[40:43], v[104:107], v[152:155]
  v_mfma_f32_16x16x32_bf16 v[152:155], v[44:47], v[108:111], v[152:155]
  v_mfma_f32_16x16x32_bf16 v[168:171], v[48:51], v[104:107], v[168:171]
  v_mfma_f32_16x16x32_bf16 v[168:171], v[52:55], v[108:111], v[168:171]
  v_mfma_f32_16x16x32_bf16 v[164:167], v[48:51], v[96:99], v[164:167]
  v_mfma_f32_16x16x32_bf16 v[164:167], v[52:55], v[100:103], v[164:167]
  v_mfma_f32_16x16x32_bf16 v[160:163], v[48:51], v[88:91], v[160:163]
  v_mfma_f32_16x16x32_bf16 v[160:163], v[52:55], v[92:95], v[160:163]
  v_mfma_f32_16x16x32_bf16 v[156:159], v[48:51], v[80:83], v[156:159]
  v_mfma_f32_16x16x32_bf16 v[156:159], v[52:55], v[84:87], v[156:159]
  v_mfma_f32_16x16x32_bf16 v[172:175], v[56:59], v[80:83], v[172:175]
  v_mfma_f32_16x16x32_bf16 v[172:175], v[60:63], v[84:87], v[172:175]
  v_mfma_f32_16x16x32_bf16 v[176:179], v[56:59], v[88:91], v[176:179]
  v_mfma_f32_16x16x32_bf16 v[176:179], v[60:63], v[92:95], v[176:179]
  v_mfma_f32_16x16x32_bf16 v[180:183], v[56:59], v[96:99], v[180:183]
  v_mfma_f32_16x16x32_bf16 v[180:183], v[60:63], v[100:103], v[180:183]
  v_mfma_f32_16x16x32_bf16 v[184:187], v[56:59], v[104:107], v[184:187]
  v_mfma_f32_16x16x32_bf16 v[184:187], v[60:63], v[108:111], v[184:187]
  v_mfma_f32_16x16x32_bf16 v[200:203], v[64:67], v[104:107], v[200:203]
  v_mfma_f32_16x16x32_bf16 v[200:203], v[68:71], v[108:111], v[200:203]
  v_mfma_f32_16x16x32_bf16 v[196:199], v[64:67], v[96:99], v[196:199]
  v_mfma_f32_16x16x32_bf16 v[196:199], v[68:71], v[100:103], v[196:199]
  v_mfma_f32_16x16x32_bf16 v[192:195], v[64:67], v[88:91], v[192:195]
  v_mfma_f32_16x16x32_bf16 v[192:195], v[68:71], v[92:95], v[192:195]
  v_mfma_f32_16x16x32_bf16 v[188:191], v[64:67], v[80:83], v[188:191]
  v_mfma_f32_16x16x32_bf16 v[188:191], v[68:71], v[84:87], v[188:191]
  v_mfma_f32_16x16x32_bf16 v[204:207], v[72:75], v[80:83], v[204:207]
  v_mfma_f32_16x16x32_bf16 v[204:207], v[76:79], v[84:87], v[204:207]
  v_mfma_f32_16x16x32_bf16 v[208:211], v[72:75], v[88:91], v[208:211]
  v_mfma_f32_16x16x32_bf16 v[208:211], v[76:79], v[92:95], v[208:211]
  v_mfma_f32_16x16x32_bf16 v[212:215], v[72:75], v[96:99], v[212:215]
  v_mfma_f32_16x16x32_bf16 v[212:215], v[76:79], v[100:103], v[212:215]
  v_mfma_f32_16x16x32_bf16 v[216:219], v[72:75], v[104:107], v[216:219]
  s_setprio 2
  s_barrier
  v_mfma_f32_16x16x32_bf16 v[216:219], v[76:79], v[108:111], v[216:219]
  ds_read_b64_tr_b16 v[40:41], v1 offset:40960
  s_add_u32 m0, s75, 0
  s_nop 0
  buffer_load_dwordx4 v29, s[44:47], s74 offen offset:0 lds
  ds_read_b64_tr_b16 v[42:43], v1 offset:43520
  ds_read_b64_tr_b16 v[44:45], v6 offset:0
  ds_read_b64_tr_b16 v[46:47], v6 offset:2560
  ds_read_b64_tr_b16 v[48:49], v2 offset:40960
  buffer_load_dwordx4 v30, s[44:47], s74 offen offset:1024 lds
  ds_read_b64_tr_b16 v[50:51], v2 offset:43520
  ds_read_b64_tr_b16 v[52:53], v7 offset:0
  ds_read_b64_tr_b16 v[54:55], v7 offset:2560
  ds_read_b64_tr_b16 v[56:57], v3 offset:40960
  buffer_load_dwordx4 v31, s[44:47], s74 offen offset:2048 lds
  ds_read_b64_tr_b16 v[58:59], v3 offset:43520
  ds_read_b64_tr_b16 v[60:61], v8 offset:0
  ds_read_b64_tr_b16 v[62:63], v8 offset:2560
  ds_read_b64_tr_b16 v[64:65], v4 offset:40960
  buffer_load_dwordx4 v32, s[44:47], s74 offen offset:3072 lds
  ds_read_b64_tr_b16 v[66:67], v4 offset:43520
  ds_read_b64_tr_b16 v[68:69], v9 offset:0
  ds_read_b64_tr_b16 v[70:71], v9 offset:2560
  ds_read_b128 v[80:83], v11 offset:0
  s_add_u32 m0, m0, 4096
  s_nop 0
  buffer_load_dwordx4 v33, s[44:47], s74 offen offset:0 lds
  s_add_u32 s74, s74, 212992
  ds_read_b128 v[84:87], v12 offset:0
  ds_read_b128 v[88:91], v11 offset:2048
  ds_read_b128 v[92:95], v12 offset:2048
  ds_read_b128 v[96:99], v11 offset:4096
  v_lshl_add_u32 v34, v241, 7, v15
  v_lshl_add_u32 v28, v25, 7, v14
  s_add_u32 m0, s76, 0
  s_nop 0
  buffer_load_dwordx4 v28, s[32:35], 0 offen lds
  ds_read_b128 v[100:103], v12 offset:4096
  ds_read_b128 v[104:107], v11 offset:6144
  ds_read_b128 v[108:111], v12 offset:6144
  ds_read_b64_tr_b16 v[72:73], v5 offset:40960
  s_add_u32 m0, m0, 1024
  s_nop 0
  buffer_load_dwordx4 v34, s[32:35], 0 offen lds
  ds_read_b64_tr_b16 v[74:75], v5 offset:43520
  ds_read_b64_tr_b16 v[76:77], v10 offset:0
  ds_read_b64_tr_b16 v[78:79], v10 offset:2560
  s_mov_b32 m0, 156288
  s_mov_b32 exec_hi, 0xff
  buffer_load_dwordx4 v37, s[52:55], s77 offen lds
  s_mov_b64 exec, -1
  s_waitcnt vmcnt(8) lgkmcnt(0)
  s_barrier
  s_setprio 0
  v_mfma_f32_16x16x32_bf16 v[140:143], v[40:43], v[80:83], v[140:143]
  v_mfma_f32_16x16x32_bf16 v[140:143], v[44:47], v[84:87], v[140:143]
  v_mfma_f32_16x16x32_bf16 v[144:147], v[40:43], v[88:91], v[144:147]
  v_mfma_f32_16x16x32_bf16 v[144:147], v[44:47], v[92:95], v[144:147]
  v_mfma_f32_16x16x32_bf16 v[148:151], v[40:43], v[96:99], v[148:151]
  v_mfma_f32_16x16x32_bf16 v[148:151], v[44:47], v[100:103], v[148:151]
  v_mfma_f32_16x16x32_bf16 v[152:155], v[40:43], v[104:107], v[152:155]
  v_mfma_f32_16x16x32_bf16 v[152:155], v[44:47], v[108:111], v[152:155]
  v_mfma_f32_16x16x32_bf16 v[168:171], v[48:51], v[104:107], v[168:171]
  v_mfma_f32_16x16x32_bf16 v[168:171], v[52:55], v[108:111], v[168:171]
  v_mfma_f32_16x16x32_bf16 v[164:167], v[48:51], v[96:99], v[164:167]
  v_mfma_f32_16x16x32_bf16 v[164:167], v[52:55], v[100:103], v[164:167]
  v_mfma_f32_16x16x32_bf16 v[160:163], v[48:51], v[88:91], v[160:163]
  v_mfma_f32_16x16x32_bf16 v[160:163], v[52:55], v[92:95], v[160:163]
  v_mfma_f32_16x16x32_bf16 v[156:159], v[48:51], v[80:83], v[156:159]
  v_mfma_f32_16x16x32_bf16 v[156:159], v[52:55], v[84:87], v[156:159]
  v_mfma_f32_16x16x32_bf16 v[172:175], v[56:59], v[80:83], v[172:175]
  v_mfma_f32_16x16x32_bf16 v[172:175], v[60:63], v[84:87], v[172:175]
  v_mfma_f32_16x16x32_bf16 v[176:179], v[56:59], v[88:91], v[176:179]
  v_mfma_f32_16x16x32_bf16 v[176:179], v[60:63], v[92:95], v[176:179]
  v_mfma_f32_16x16x32_bf16 v[180:183], v[56:59], v[96:99], v[180:183]
  v_mfma_f32_16x16x32_bf16 v[180:183], v[60:63], v[100:103], v[180:183]
  v_mfma_f32_16x16x32_bf16 v[184:187], v[56:59], v[104:107], v[184:187]
  v_mfma_f32_16x16x32_bf16 v[184:187], v[60:63], v[108:111], v[184:187]
  v_mfma_f32_16x16x32_bf16 v[200:203], v[64:67], v[104:107], v[200:203]
  v_mfma_f32_16x16x32_bf16 v[200:203], v[68:71], v[108:111], v[200:203]
  v_mfma_f32_16x16x32_bf16 v[196:199], v[64:67], v[96:99], v[196:199]
  v_mfma_f32_16x16x32_bf16 v[196:199], v[68:71], v[100:103], v[196:199]
  v_mfma_f32_16x16x32_bf16 v[192:195], v[64:67], v[88:91], v[192:195]
  v_mfma_f32_16x16x32_bf16 v[192:195], v[68:71], v[92:95], v[192:195]
  v_mfma_f32_16x16x32_bf16 v[188:191], v[64:67], v[80:83], v[188:191]
  v_mfma_f32_16x16x32_bf16 v[188:191], v[68:71], v[84:87], v[188:191]
  v_mfma_f32_16x16x32_bf16 v[204:207], v[72:75], v[80:83], v[204:207]
  v_mfma_f32_16x16x32_bf16 v[204:207], v[76:79], v[84:87], v[204:207]
  v_mfma_f32_16x16x32_bf16 v[208:211], v[72:75], v[88:91], v[208:211]
  v_mfma_f32_16x16x32_bf16 v[208:211], v[76:79], v[92:95], v[208:211]
  v_mfma_f32_16x16x32_bf16 v[212:215], v[72:75], v[96:99], v[212:215]
  v_mfma_f32_16x16x32_bf16 v[212:215], v[76:79], v[100:103], v[212:215]
  v_mfma_f32_16x16x32_bf16 v[216:219], v[72:75], v[104:107], v[216:219]
  s_setprio 2
  s_barrier
  v_mfma_f32_16x16x32_bf16 v[216:219], v[76:79], v[108:111], v[216:219]
  ds_read_b64_tr_b16 v[40:41], v6 offset:20480
  s_add_u32 m0, s75, 40960
  s_nop 0
  buffer_load_dwordx4 v29, s[44:47], s74 offen offset:0 lds
  ds_read_b64_tr_b16 v[42:43], v6 offset:23040
  ds_read_b64_tr_b16 v[44:45], v6 offset:40960
  ds_read_b64_tr_b16 v[46:47], v6 offset:43520
  ds_read_b64_tr_b16 v[48:49], v7 offset:20480
  buffer_load_dwordx4 v30, s[44:47], s74 offen offset:1024 lds
  ds_read_b64_tr_b16 v[50:51], v7 offset:23040
  ds_read_b64_tr_b16 v[52:53], v7 offset:40960
  ds_read_b64_tr_b16 v[54:55], v7 offset:43520
  ds_read_b64_tr_b16 v[56:57], v8 offset:20480
  buffer_load_dwordx4 v31, s[44:47], s74 offen offset:2048 lds
  ds_read_b64_tr_b16 v[58:59], v8 offset:23040
  ds_read_b64_tr_b16 v[60:61], v8 offset:40960
  ds_read_b64_tr_b16 v[62:63], v8 offset:43520
  ds_read_b64_tr_b16 v[64:65], v9 offset:20480
  buffer_load_dwordx4 v32, s[44:47], s74 offen offset:3072 lds
  ds_read_b64_tr_b16 v[66:67], v9 offset:23040
  ds_read_b64_tr_b16 v[68:69], v9 offset:40960
  ds_read_b64_tr_b16 v[70:71], v9 offset:43520
  ds_read_b128 v[80:83], v11 offset:8192
  s_add_u32 m0, m0, 4096
  s_nop 0
  buffer_load_dwordx4 v33, s[44:47], s74 offen offset:0 lds
  s_add_u32 s74, s74, 212992
  ds_read_b128 v[84:87], v12 offset:8192
  ds_read_b128 v[88:91], v11 offset:10240
  ds_read_b128 v[92:95], v12 offset:10240
  ds_read_b128 v[96:99], v11 offset:12288
  v_lshl_add_u32 v34, v242, 7, v15
  v_lshl_add_u32 v28, v26, 7, v14
  s_add_u32 m0, s76, 8192
  s_nop 0
  buffer_load_dwordx4 v28, s[32:35], 0 offen lds
  ds_read_b128 v[100:103], v12 offset:12288
  ds_read_b128 v[104:107], v11 offset:14336
  ds_read_b128 v[108:111], v12 offset:14336
  ds_read_b64_tr_b16 v[72:73], v10 offset:20480
  s_add_u32 m0, m0, 1024
  s_nop 0
  buffer_load_dwordx4 v34, s[32:35], 0 offen lds
  ds_read_b64_tr_b16 v[74:75], v10 offset:23040
  ds_read_b64_tr_b16 v[76:77], v10 offset:40960
  ds_read_b64_tr_b16 v[78:79], v10 offset:43520
  buffer_load_dwordx3 v[24:26], v13, s[28:31], s73 offen offset:0
  buffer_load_dwordx3 v[240:242], v13, s[28:31], s73 offen offset:832
  s_add_u32 s73, s73, 12
  s_waitcnt vmcnt(10) lgkmcnt(0)
  s_barrier
  s_setprio 0
  v_mfma_f32_16x16x32_bf16 v[140:143], v[40:43], v[80:83], v[140:143]
  s_add_u32 s72, s72, 1
  v_mfma_f32_16x16x32_bf16 v[140:143], v[44:47], v[84:87], v[140:143]
  v_mfma_f32_16x16x32_bf16 v[144:147], v[40:43], v[88:91], v[144:147]
  v_mfma_f32_16x16x32_bf16 v[144:147], v[44:47], v[92:95], v[144:147]
  v_mfma_f32_16x16x32_bf16 v[148:151], v[40:43], v[96:99], v[148:151]
  v_mfma_f32_16x16x32_bf16 v[148:151], v[44:47], v[100:103], v[148:151]
  v_mfma_f32_16x16x32_bf16 v[152:155], v[40:43], v[104:107], v[152:155]
  v_mfma_f32_16x16x32_bf16 v[152:155], v[44:47], v[108:111], v[152:155]
  v_mfma_f32_16x16x32_bf16 v[168:171], v[48:51], v[104:107], v[168:171]
  v_mfma_f32_16x16x32_bf16 v[168:171], v[52:55], v[108:111], v[168:171]
  v_mfma_f32_16x16x32_bf16 v[164:167], v[48:51], v[96:99], v[164:167]
  v_mfma_f32_16x16x32_bf16 v[164:167], v[52:55], v[100:103], v[164:167]
  v_mfma_f32_16x16x32_bf16 v[160:163], v[48:51], v[88:91], v[160:163]
  v_mfma_f32_16x16x32_bf16 v[160:163], v[52:55], v[92:95], v[160:163]
  v_mfma_f32_16x16x32_bf16 v[156:159], v[48:51], v[80:83], v[156:159]
  v_mfma_f32_16x16x32_bf16 v[156:159], v[52:55], v[84:87], v[156:159]
  v_mfma_f32_16x16x32_bf16 v[172:175], v[56:59], v[80:83], v[172:175]
  v_mfma_f32_16x16x32_bf16 v[172:175], v[60:63], v[84:87], v[172:175]
  v_mfma_f32_16x16x32_bf16 v[176:179], v[56:59], v[88:91], v[176:179]
  v_mfma_f32_16x16x32_bf16 v[176:179], v[60:63], v[92:95], v[176:179]
  s_cmp_lt_u32 s72, 4
  v_mfma_f32_16x16x32_bf16 v[180:183], v[56:59], v[96:99], v[180:183]
  v_mfma_f32_16x16x32_bf16 v[180:183], v[60:63], v[100:103], v[180:183]
  v_mfma_f32_16x16x32_bf16 v[184:187], v[56:59], v[104:107], v[184:187]
  v_mfma_f32_16x16x32_bf16 v[184:187], v[60:63], v[108:111], v[184:187]
  v_mfma_f32_16x16x32_bf16 v[200:203], v[64:67], v[104:107], v[200:203]
  v_mfma_f32_16x16x32_bf16 v[200:203], v[68:71], v[108:111], v[200:203]
  v_mfma_f32_16x16x32_bf16 v[196:199], v[64:67], v[96:99], v[196:199]
  v_mfma_f32_16x16x32_bf16 v[196:199], v[68:71], v[100:103], v[196:199]
  v_mfma_f32_16x16x32_bf16 v[192:195], v[64:67], v[88:91], v[192:195]
  v_mfma_f32_16x16x32_bf16 v[192:195], v[68:71], v[92:95], v[192:195]
  v_mfma_f32_16x16x32_bf16 v[188:191], v[64:67], v[80:83], v[188:191]
  v_mfma_f32_16x16x32_bf16 v[188:191], v[68:71], v[84:87], v[188:191]
  v_mfma_f32_16x16x32_bf16 v[204:207], v[72:75], v[80:83], v[204:207]
  v_mfma_f32_16x16x32_bf16 v[204:207], v[76:79], v[84:87], v[204:207]
  v_mfma_f32_16x16x32_bf16 v[208:211], v[72:75], v[88:91], v[208:211]
  v_mfma_f32_16x16x32_bf16 v[208:211], v[76:79], v[92:95], v[208:211]
  v_mfma_f32_16x16x32_bf16 v[212:215], v[72:75], v[96:99], v[212:215]
  v_mfma_f32_16x16x32_bf16 v[212:215], v[76:79], v[100:103], v[212:215]
  v_mfma_f32_16x16x32_bf16 v[216:219], v[72:75], v[104:107], v[216:219]
  s_setprio 2
  s_barrier
  v_mfma_f32_16x16x32_bf16 v[216:219], v[76:79], v[108:111], v[216:219]
  s_cbranch_scc1 L_dnn_loop1
  ds_read_b64_tr_b16 v[40:41], v1 offset:0
  ds_read_b64_tr_b16 v[42:43], v1 offset:2560
  ds_read_b64_tr_b16 v[44:45], v1 offset:20480
  ds_read_b64_tr_b16 v[46:47], v1 offset:23040
  ds_read_b64_tr_b16 v[48:49], v2 offset:0
  ds_read_b64_tr_b16 v[50:51], v2 offset:2560
  ds_read_b64_tr_b16 v[52:53], v2 offset:20480
  ds_read_b64_tr_b16 v[54:55], v2 offset:23040
  ds_read_b64_tr_b16 v[56:57], v3 offset:0
  ds_read_b64_tr_b16 v[58:59], v3 offset:2560
  ds_read_b64_tr_b16 v[60:61], v3 offset:20480
  ds_read_b64_tr_b16 v[62:63], v3 offset:23040
  ds_read_b64_tr_b16 v[64:65], v4 offset:0
  ds_read_b64_tr_b16 v[66:67], v4 offset:2560
  ds_read_b64_tr_b16 v[68:69], v4 offset:20480
  ds_read_b64_tr_b16 v[70:71], v4 offset:23040
  ds_read_b128 v[80:83], v11 offset:0
  ds_read_b128 v[84:87], v12 offset:0
  ds_read_b128 v[88:91], v11 offset:2048
  ds_read_b128 v[92:95], v12 offset:2048
  ds_read_b128 v[96:99], v11 offset:4096
  ds_read_b128 v[100:103], v12 offset:4096
  ds_read_b128 v[104:107], v11 offset:6144
  ds_read_b128 v[108:111], v12 offset:6144
  ds_read_b64_tr_b16 v[72:73], v5 offset:0
  ds_read_b64_tr_b16 v[74:75], v5 offset:2560
  ds_read_b64_tr_b16 v[76:77], v5 offset:20480
  ds_read_b64_tr_b16 v[78:79], v5 offset:23040
  ds_read_b64 v[220:221], v35 offset:640
  ds_read_b64 v[222:223], v35 offset:672
  ds_read_b64 v[224:225], v35 offset:704
  ds_read_b64 v[226:227], v35 offset:736
  ds_read_b64 v[228:229], v35 offset:768
  s_waitcnt vmcnt(2) lgkmcnt(0)
  s_barrier
  s_setprio 0
  v_mfma_f32_16x16x32_bf16 v[140:143], v[40:43], v[80:83], v[140:143]
  v_mov_b32 v232, 0xc0135761
  v_mov_b32 v233, 0xc0135761
  v_mfma_f32_16x16x32_bf16 v[140:143], v[44:47], v[84:87], v[140:143]
  v_mov_b32 v234, 0xbdd2d3e8
  v_mfma_f32_16x16x32_bf16 v[144:147], v[40:43], v[88:91], v[144:147]
  v_mov_b32 v235, 0xbdd2d3e8
  v_mfma_f32_16x16x32_bf16 v[144:147], v[44:47], v[92:95], v[144:147]
  v_mov_b32 v236, 0x71800000
  v_mfma_f32_16x16x32_bf16 v[148:151], v[40:43], v[96:99], v[148:151]
  v_lshlrev_b32 v112, 16, v220
  v_mfma_f32_16x16x32_bf16 v[148:151], v[44:47], v[100:103], v[148:151]
  v_and_b32 v113, 0xffff0000, v220
  v_mfma_f32_16x16x32_bf16 v[152:155], v[40:43], v[104:107], v[152:155]
  v_lshlrev_b32 v114, 16, v221
  v_mfma_f32_16x16x32_bf16 v[152:155], v[44:47], v[108:111], v[152:155]
  v_and_b32 v115, 0xffff0000, v221
  v_mfma_f32_16x16x32_bf16 v[168:171], v[48:51], v[104:107], v[168:171]
  v_lshlrev_b32 v116, 16, v222
  v_mfma_f32_16x16x32_bf16 v[168:171], v[52:55], v[108:111], v[168:171]
  v_and_b32 v117, 0xffff0000, v222
  v_mfma_f32_16x16x32_bf16 v[164:167], v[48:51], v[96:99], v[164:167]
  v_lshlrev_b32 v118, 16, v223
  v_mfma_f32_16x16x32_bf16 v[164:167], v[52:55], v[100:103], v[164:167]
  v_and_b32 v119, 0xffff0000, v223
  v_mfma_f32_16x16x32_bf16 v[160:163], v[48:51], v[88:91], v[160:163]
  v_lshlrev_b32 v120, 16, v224
  v_mfma_f32_16x16x32_bf16 v[160:163], v[52:55], v[92:95], v[160:163]
  v_and_b32 v121, 0xffff0000, v224
  v_mfma_f32_16x16x32_bf16 v[156:159], v[48:51], v[80:83], v[156:159]
  v_lshlrev_b32 v122, 16, v225
  v_mfma_f32_16x16x32_bf16 v[156:159], v[52:55], v[84:87], v[156:159]
  v_and_b32 v123, 0xffff0000, v225
  v_mfma_f32_16x16x32_bf16 v[172:175], v[56:59], v[80:83], v[172:175]
  v_lshlrev_b32 v124, 16, v226
  v_mfma_f32_16x16x32_bf16 v[172:175], v[60:63], v[84:87], v[172:175]
  v_and_b32 v125, 0xffff0000, v226
  v_mfma_f32_16x16x32_bf16 v[176:179], v[56:59], v[88:91], v[176:179]
  v_lshlrev_b32 v126, 16, v227
  v_mfma_f32_16x16x32_bf16 v[176:179], v[60:63], v[92:95], v[176:179]
  v_and_b32 v127, 0xffff0000, v227
  v_mfma_f32_16x16x32_bf16 v[180:183], v[56:59], v[96:99], v[180:183]
  v_lshlrev_b32 v128, 16, v228
  v_mfma_f32_16x16x32_bf16 v[180:183], v[60:63], v[100:103], v[180:183]
  v_and_b32 v129, 0xffff0000, v228
  v_mfma_f32_16x16x32_bf16 v[184:187], v[56:59], v[104:107], v[184:187]
  v_lshlrev_b32 v130, 16, v229
  v_mfma_f32_16x16x32_bf16 v[184:187], v[60:63], v[108:111], v[184:187]
  v_and_b32 v131, 0xffff0000, v229
  v_mfma_f32_16x16x32_bf16 v[200:203], v[64:67], v[104:107], v[200:203]
  v_rcp_f32 v112, v112
  v_mfma_f32_16x16x32_bf16 v[200:203], v[68:71], v[108:111], v[200:203]
  v_rcp_f32 v113, v113
  v_mfma_f32_16x16x32_bf16 v[196:199], v[64:67], v[96:99], v[196:199]
  v_rcp_f32 v114, v114
  v_mfma_f32_16x16x32_bf16 v[196:199], v[68:71], v[100:103], v[196:199]
  v_rcp_f32 v115, v115
  v_mfma_f32_16x16x32_bf16 v[192:195], v[64:67], v[88:91], v[192:195]
  v_rcp_f32 v116, v116
  v_mfma_f32_16x16x32_bf16 v[192:195], v[68:71], v[92:95], v[192:195]
  v_rcp_f32 v117, v117
  v_mfma_f32_16x16x32_bf16 v[188:191], v[64:67], v[80:83], v[188:191]
  v_rcp_f32 v118, v118
  v_mfma_f32_16x16x32_bf16 v[188:191], v[68:71], v[84:87], v[188:191]
  v_rcp_f32 v119, v119
  v_mfma_f32_16x16x32_bf16 v[204:207], v[72:75], v[80:83], v[204:207]
  v_rcp_f32 v120, v120
  v_mfma_f32_16x16x32_bf16 v[204:207], v[76:79], v[84:87], v[204:207]
  v_rcp_f32 v121, v121
  v_mfma_f32_16x16x32_bf16 v[208:211], v[72:75], v[88:91], v[208:211]
  v_rcp_f32 v122, v122
  v_mfma_f32_16x16x32_bf16 v[208:211], v[76:79], v[92:95], v[208:211]
  v_rcp_f32 v123, v123
  v_mfma_f32_16x16x32_bf16 v[212:215], v[72:75], v[96:99], v[212:215]
  v_rcp_f32 v124, v124
  v_mfma_f32_16x16x32_bf16 v[212:215], v[76:79], v[100:103], v[212:215]
  v_rcp_f32 v125, v125
  v_mfma_f32_16x16x32_bf16 v[216:219], v[72:75], v[104:107], v[216:219]
  s_setprio 2
  s_barrier
  v_mfma_f32_16x16x32_bf16 v[216:219], v[76:79], v[108:111], v[216:219]
  ds_read_b64_tr_b16 v[40:41], v1 offset:40960
  ds_read_b64_tr_b16 v[42:43], v1 offset:43520
  ds_read_b64_tr_b16 v[44:45], v6 offset:0
  ds_read_b64_tr_b16 v[46:47], v6 offset:2560
  ds_read_b64_tr_b16 v[48:49], v2 offset:40960
  ds_read_b64_tr_b16 v[50:51], v2 offset:43520
  ds_read_b64_tr_b16 v[52:53], v7 offset:0
  ds_read_b64_tr_b16 v[54:55], v7 offset:2560
  ds_read_b64_tr_b16 v[56:57], v3 offset:40960
  ds_read_b64_tr_b16 v[58:59], v3 offset:43520
  ds_read_b64_tr_b16 v[60:61], v8 offset:0
  ds_read_b64_tr_b16 v[62:63], v8 offset:2560
  ds_read_b64_tr_b16 v[64:65], v4 offset:40960
  ds_read_b64_tr_b16 v[66:67], v4 offset:43520
  ds_read_b64_tr_b16 v[68:69], v9 offset:0
  ds_read_b64_tr_b16 v[70:71], v9 offset:2560
  ds_read_b128 v[80:83], v11 offset:8192
  ds_read_b128 v[84:87], v12 offset:8192
  ds_read_b128 v[88:91], v11 offset:10240
  ds_read_b128 v[92:95], v12 offset:10240
  ds_read_b128 v[96:99], v11 offset:12288
  ds_read_b128 v[100:103], v12 offset:12288
  ds_read_b128 v[104:107], v11 offset:14336
  ds_read_b128 v[108:111], v12 offset:14336
  ds_read_b64_tr_b16 v[72:73], v5 offset:40960
  ds_read_b64_tr_b16 v[74:75], v5 offset:43520
  ds_read_b64_tr_b16 v[76:77], v10 offset:0
  ds_read_b64_tr_b16 v[78:79], v10 offset:2560
  s_waitcnt lgkmcnt(0)
  s_barrier
  v_mfma_f32_16x16x32_bf16 v[140:143], v[40:43], v[80:83], v[140:143]
  v_rcp_f32 v126, v126
  v_mfma_f32_16x16x32_bf16 v[140:143], v[44:47], v[84:87], v[140:143]
  v_rcp_f32 v127, v127
  v_mfma_f32_16x16x32_bf16 v[144:147], v[40:43], v[88:91], v[144:147]
  v_rcp_f32 v128, v128
  v_mfma_f32_16x16x32_bf16 v[144:147], v[44:47], v[92:95], v[144:147]
  v_mfma_f32_16x16x32_bf16 v[148:151], v[40:43], v[96:99], v[148:151]
  v_rcp_f32 v129, v129
  v_mfma_f32_16x16x32_bf16 v[148:151], v[44:47], v[100:103], v[148:151]
  v_rcp_f32 v130, v130
  v_mfma_f32_16x16x32_bf16 v[152:155], v[40:43], v[104:107], v[152:155]
  v_mfma_f32_16x16x32_bf16 v[152:155], v[44:47], v[108:111], v[152:155]
  v_rcp_f32 v131, v131
  v_mfma_f32_16x16x32_bf16 v[168:171], v[48:51], v[104:107], v[168:171]
  v_med3_f32 v112, v112, -v236, v236
  v_mfma_f32_16x16x32_bf16 v[168:171], v[52:55], v[108:111], v[168:171]
  v_mfma_f32_16x16x32_bf16 v[164:167], v[48:51], v[96:99], v[164:167]
  v_med3_f32 v113, v113, -v236, v236
  v_mfma_f32_16x16x32_bf16 v[164:167], v[52:55], v[100:103], v[164:167]
  v_med3_f32 v114, v114, -v236, v236
  v_mfma_f32_16x16x32_bf16 v[160:163], v[48:51], v[88:91], v[160:163]
  v_mfma_f32_16x16x32_bf16 v[160:163], v[52:55], v[92:95], v[160:163]
  v_med3_f32 v115, v115, -v236, v236
  v_mfma_f32_16x16x32_bf16 v[156:159], v[48:51], v[80:83], v[156:159]
  v_med3_f32 v116, v116, -v236, v236
  v_mfma_f32_16x16x32_bf16 v[156:159], v[52:55], v[84:87], v[156:159]
  v_mfma_f32_16x16x32_bf16 v[172:175], v[56:59], v[80:83], v[172:175]
  v_med3_f32 v117, v117, -v236, v236
  v_mfma_f32_16x16x32_bf16 v[172:175], v[60:63], v[84:87], v[172:175]
  v_med3_f32 v118, v118, -v236, v236
  v_mfma_f32_16x16x32_bf16 v[176:179], v[56:59], v[88:91], v[176:179]
  v_mfma_f32_16x16x32_bf16 v[176:179], v[60:63], v[92:95], v[176:179]
  v_med3_f32 v119, v119, -v236, v236
  v_mfma_f32_16x16x32_bf16 v[180:183], v[56:59], v[96:99], v[180:183]
  v_med3_f32 v120, v120, -v236, v236
  v_mfma_f32_16x16x32_bf16 v[180:183], v[60:63], v[100:103], v[180:183]
  v_med3_f32 v121, v121, -v236, v236
  v_mfma_f32_16x16x32_bf16 v[184:187], v[56:59], v[104:107], v[184:187]
  v_mfma_f32_16x16x32_bf16 v[184:187], v[60:63], v[108:111], v[184:187]
  v_med3_f32 v122, v122, -v236, v236
  v_mfma_f32_16x16x32_bf16 v[200:203], v[64:67], v[104:107], v[200:203]
  v_med3_f32 v123, v123, -v236, v236
  v_mfma_f32_16x16x32_bf16 v[200:203], v[68:71], v[108:111], v[200:203]
  v_mfma_f32_16x16x32_bf16 v[196:199], v[64:67], v[96:99], v[196:199]
  v_med3_f32 v124, v124, -v236, v236
  v_mfma_f32_16x16x32_bf16 v[196:199], v[68:71], v[100:103], v[196:199]
  v_med3_f32 v125, v125, -v236, v236
  v_mfma_f32_16x16x32_bf16 v[192:195], v[64:67], v[88:91], v[192:195]
  v_mfma_f32_16x16x32_bf16 v[192:195], v[68:71], v[92:95], v[192:195]
  v_med3_f32 v126, v126, -v236, v236
  v_mfma_f32_16x16x32_bf16 v[188:191], v[64:67], v[80:83], v[188:191]
  v_med3_f32 v127, v127, -v236, v236
  v_mfma_f32_16x16x32_bf16 v[188:191], v[68:71], v[84:87], v[188:191]
  v_mfma_f32_16x16x32_bf16 v[204:207], v[72:75], v[80:83], v[204:207]
  v_med3_f32 v128, v128, -v236, v236
  v_mfma_f32_16x16x32_bf16 v[204:207], v[76:79], v[84:87], v[204:207]
  v_med3_f32 v129, v129, -v236, v236
  v_mfma_f32_16x16x32_bf16 v[208:211], v[72:75], v[88:91], v[208:211]
  v_mfma_f32_16x16x32_bf16 v[208:211], v[76:79], v[92:95], v[208:211]
  v_med3_f32 v130, v130, -v236, v236
  v_mfma_f32_16x16x32_bf16 v[212:215], v[72:75], v[96:99], v[212:215]
  v_med3_f32 v131, v131, -v236, v236
  v_mfma_f32_16x16x32_bf16 v[212:215], v[76:79], v[100:103], v[212:215]
  v_mfma_f32_16x16x32_bf16 v[216:219], v[72:75], v[104:107], v[216:219]
  v_mfma_f32_16x16x32_bf16 v[216:219], v[76:79], v[108:111], v[216:219]
  s_setprio 0
  s_nop 0
L_epi:
  s_lshl_b32 s69, s27, 11
  s_and_b32 s71, s26, 3
  s_lshl_b32 s71, s71, 9
  s_add_u32 s69, s69, s71
  s_lshr_b32 s68, s26, 2
  s_lshl_b32 s68, s68, 14
  s_add_u32 s69, s69, s68
  v_lshlrev_b32 v3, 3, v0
  v_add_u32 v2, 156928, v3
  v_pk_mul_f32 v[40:41], v[140:141], v[140:141]
  v_pk_mul_f32 v[44:45], v[144:145], v[144:145]
  v_pk_mul_f32 v[48:49], v[148:149], v[148:149]
  v_pk_mul_f32 v[52:53], v[152:153], v[152:153]
  v_pk_fma_f32 v[40:41], v[40:41], v[234:235], v[232:233]
  v_pk_fma_f32 v[44:45], v[44:45], v[234:235], v[232:233]
  v_pk_fma_f32 v[48:49], v[48:49], v[234:235], v[232:233]
  v_pk_fma_f32 v[52:53], v[52:53], v[234:235], v[232:233]
  v_pk_mul_f32 v[40:41], v[40:41], v[140:141]
  v_pk_mul_f32 v[44:45], v[44:45], v[144:145]
  v_pk_mul_f32 v[48:49], v[48:49], v[148:149]
  v_pk_mul_f32 v[52:53], v[52:53], v[152:153]
  v_exp_f32 v40, v40
  v_exp_f32 v41, v41
  v_exp_f32 v44, v44
  v_exp_f32 v45, v45
  v_exp_f32 v48, v48
  v_exp_f32 v49, v49
  v_exp_f32 v52, v52
  v_exp_f32 v53, v53
  v_pk_fma_f32 v[40:41], v[40:41], v[112:113], v[112:113]
  v_pk_fma_f32 v[44:45], v[44:45], v[112:113], v[112:113]
  v_pk_fma_f32 v[48:49], v[48:49], v[112:113], v[112:113]
  v_pk_fma_f32 v[52:53], v[52:53], v[112:113], v[112:113]
  v_rcp_f32 v40, v40
  v_rcp_f32 v41, v41
  v_rcp_f32 v44, v44
  v_rcp_f32 v45, v45
  v_rcp_f32 v48, v48
  v_rcp_f32 v49, v49
  v_rcp_f32 v52, v52
  v_rcp_f32 v53, v53
  v_pk_mul_f32 v[16:17], v[40:41], v[140:141]
  v_pk_mul_f32 v[18:19], v[44:45], v[144:145]
  v_pk_mul_f32 v[20:21], v[48:49], v[148:149]
  v_pk_mul_f32 v[22:23], v[52:53], v[152:153]
  v_pk_mul_f32 v[56:57], v[142:143], v[142:143]
  v_pk_mul_f32 v[60:61], v[146:147], v[146:147]
  v_pk_mul_f32 v[64:65], v[150:151], v[150:151]
  v_pk_mul_f32 v[68:69], v[154:155], v[154:155]
  v_pk_fma_f32 v[56:57], v[56:57], v[234:235], v[232:233]
  v_pk_fma_f32 v[60:61], v[60:61], v[234:235], v[232:233]
  v_pk_fma_f32 v[64:65], v[64:65], v[234:235], v[232:233]
  v_pk_fma_f32 v[68:69], v[68:69], v[234:235], v[232:233]
  v_pk_mul_f32 v[56:57], v[56:57], v[142:143]
  v_pk_mul_f32 v[60:61], v[60:61], v[146:147]
  v_pk_mul_f32 v[64:65], v[64:65], v[150:151]
  v_pk_mul_f32 v[68:69], v[68:69], v[154:155]
  v_exp_f32 v56, v56
  v_exp_f32 v57, v57
  v_exp_f32 v60, v60
  v_exp_f32 v61, v61
  v_exp_f32 v64, v64
  v_exp_f32 v65, v65
  v_exp_f32 v68, v68
  v_exp_f32 v69, v69
  v_pk_fma_f32 v[56:57], v[56:57], v[114:115], v[114:115]
  v_pk_fma_f32 v[60:61], v[60:61], v[114:115], v[114:115]
  v_pk_fma_f32 v[64:65], v[64:65], v[114:115], v[114:115]
  v_pk_fma_f32 v[68:69], v[68:69], v[114:115], v[114:115]
  v_rcp_f32 v56, v56
  v_rcp_f32 v57, v57
  v_rcp_f32 v60, v60
  v_rcp_f32 v61, v61
  v_rcp_f32 v64, v64
  v_rcp_f32 v65, v65
  v_rcp_f32 v68, v68
  v_rcp_f32 v69, v69
  v_pk_fma_f32 v[16:17], v[56:57], v[142:143], v[16:17]
  v_pk_fma_f32 v[18:19], v[60:61], v[146:147], v[18:19]
  v_pk_fma_f32 v[20:21], v[64:65], v[150:151], v[20:21]
  v_pk_fma_f32 v[22:23], v[68:69], v[154:155], v[22:23]
  v_pk_mul_f32 v[40:41], v[156:157], v[156:157]
  v_pk_mul_f32 v[44:45], v[160:161], v[160:161]
  v_pk_mul_f32 v[48:49], v[164:165], v[164:165]
  v_pk_mul_f32 v[52:53], v[168:169], v[168:169]
  v_pk_fma_f32 v[40:41], v[40:41], v[234:235], v[232:233]
  v_pk_fma_f32 v[44:45], v[44:45], v[234:235], v[232:233]
  v_pk_fma_f32 v[48:49], v[48:49], v[234:235], v[232:233]
  v_pk_fma_f32 v[52:53], v[52:53], v[234:235], v[232:233]
  v_pk_mul_f32 v[40:41], v[40:41], v[156:157]
  v_pk_mul_f32 v[44:45], v[44:45], v[160:161]
  v_pk_mul_f32 v[48:49], v[48:49], v[164:165]
  v_pk_mul_f32 v[52:53], v[52:53], v[168:169]
  v_exp_f32 v40, v40
  v_exp_f32 v41, v41
  v_exp_f32 v44, v44
  v_exp_f32 v45, v45
  v_exp_f32 v48, v48
  v_exp_f32 v49, v49
  v_exp_f32 v52, v52
  v_exp_f32 v53, v53
  v_pk_fma_f32 v[40:41], v[40:41], v[116:117], v[116:117]
  v_pk_fma_f32 v[44:45], v[44:45], v[116:117], v[116:117]
  v_pk_fma_f32 v[48:49], v[48:49], v[116:117], v[116:117]
  v_pk_fma_f32 v[52:53], v[52:53], v[116:117], v[116:117]
  v_rcp_f32 v40, v40
  v_rcp_f32 v41, v41
  v_rcp_f32 v44, v44
  v_rcp_f32 v45, v45
  v_rcp_f32 v48, v48
  v_rcp_f32 v49, v49
  v_rcp_f32 v52, v52
  v_rcp_f32 v53, v53
  v_pk_fma_f32 v[16:17], v[40:41], v[156:157], v[16:17]
  v_pk_fma_f32 v[18:19], v[44:45], v[160:161], v[18:19]
  v_pk_fma_f32 v[20:21], v[48:49], v[164:165], v[20:21]
  v_pk_fma_f32 v[22:23], v[52:53], v[168:169], v[22:23]
  v_pk_mul_f32 v[56:57], v[158:159], v[158:159]
  v_pk_mul_f32 v[60:61], v[162:163], v[162:163]
  v_pk_mul_f32 v[64:65], v[166:167], v[166:167]
  v_pk_mul_f32 v[68:69], v[170:171], v[170:171]
  v_pk_fma_f32 v[56:57], v[56:57], v[234:235], v[232:233]
  v_pk_fma_f32 v[60:61], v[60:61], v[234:235], v[232:233]
  v_pk_fma_f32 v[64:65], v[64:65], v[234:235], v[232:233]
  v_pk_fma_f32 v[68:69], v[68:69], v[234:235], v[232:233]
  v_pk_mul_f32 v[56:57], v[56:57], v[158:159]
  v_pk_mul_f32 v[60:61], v[60:61], v[162:163]
  v_pk_mul_f32 v[64:65], v[64:65], v[166:167]
  v_pk_mul_f32 v[68:69], v[68:69], v[170:171]
  v_exp_f32 v56, v56
  v_exp_f32 v57, v57
  v_exp_f32 v60, v60
  v_exp_f32 v61, v61
  v_exp_f32 v64, v64
  v_exp_f32 v65, v65
  v_exp_f32 v68, v68
  v_exp_f32 v69, v69
  v_pk_fma_f32 v[56:57], v[56:57], v[118:119], v[118:119]
  v_pk_fma_f32 v[60:61], v[60:61], v[118:119], v[118:119]
  v_pk_fma_f32 v[64:65], v[64:65], v[118:119], v[118:119]
  v_pk_fma_f32 v[68:69], v[68:69], v[118:119], v[118:119]
  v_rcp_f32 v56, v56
  v_rcp_f32 v57, v57
  v_rcp_f32 v60, v60
  v_rcp_f32 v61, v61
  v_rcp_f32 v64, v64
  v_rcp_f32 v65, v65
  v_rcp_f32 v68, v68
  v_rcp_f32 v69, v69
  v_pk_fma_f32 v[16:17], v[56:57], v[158:159], v[16:17]
  v_pk_fma_f32 v[18:19], v[60:61], v[162:163], v[18:19]
  v_pk_fma_f32 v[20:21], v[64:65], v[166:167], v[20:21]
  v_pk_fma_f32 v[22:23], v[68:69], v[170:171], v[22:23]
  v_pk_mul_f32 v[40:41], v[172:173], v[172:173]
  v_pk_mul_f32 v[44:45], v[176:177], v[176:177]
  v_pk_mul_f32 v[48:49], v[180:181], v[180:181]
  v_pk_mul_f32 v[52:53], v[184:185], v[184:185]
  v_pk_fma_f32 v[40:41], v[40:41], v[234:235], v[232:233]
  v_pk_fma_f32 v[44:45], v[44:45], v[234:235], v[232:233]
  v_pk_fma_f32 v[48:49], v[48:49], v[234:235], v[232:233]
  v_pk_fma_f32 v[52:53], v[52:53], v[234:235], v[232:233]
  v_pk_mul_f32 v[40:41], v[40:41], v[172:173]
  v_pk_mul_f32 v[44:45], v[44:45], v[176:177]
  v_pk_mul_f32 v[48:49], v[48:49], v[180:181]
  v_pk_mul_f32 v[52:53], v[52:53], v[184:185]
  v_exp_f32 v40, v40
  v_exp_f32 v41, v41
  v_exp_f32 v44, v44
  v_exp_f32 v45, v45
  v_exp_f32 v48, v48
  v_exp_f32 v49, v49
  v_exp_f32 v52, v52
  v_exp_f32 v53, v53
  v_pk_fma_f32 v[40:41], v[40:41], v[120:121], v[120:121]
  v_pk_fma_f32 v[44:45], v[44:45], v[120:121], v[120:121]
  v_pk_fma_f32 v[48:49], v[48:49], v[120:121], v[120:121]
  v_pk_fma_f32 v[52:53], v[52:53], v[120:121], v[120:121]
  v_rcp_f32 v40, v40
  v_rcp_f32 v41, v41
  v_rcp_f32 v44, v44
  v_rcp_f32 v45, v45
  v_rcp_f32 v48, v48
  v_rcp_f32 v49, v49
  v_rcp_f32 v52, v52
  v_rcp_f32 v53, v53
  v_pk_fma_f32 v[16:17], v[40:41], v[172:173], v[16:17]
  v_pk_fma_f32 v[18:19], v[44:45], v[176:177], v[18:19]
  v_pk_fma_f32 v[20:21], v[48:49], v[180:181], v[20:21]
  v_pk_fma_f32 v[22:23], v[52:53], v[184:185], v[22:23]
  v_pk_mul_f32 v[56:57], v[174:175], v[174:175]
  v_pk_mul_f32 v[60:61], v[178:179], v[178:179]
  v_pk_mul_f32 v[64:65], v[182:183], v[182:183]
  v_pk_mul_f32 v[68:69], v[186:187], v[186:187]
  v_pk_fma_f32 v[56:57], v[56:57], v[234:235], v[232:233]
  v_pk_fma_f32 v[60:61], v[60:61], v[234:235], v[232:233]
  v_pk_fma_f32 v[64:65], v[64:65], v[234:235], v[232:233]
  v_pk_fma_f32 v[68:69], v[68:69], v[234:235], v[232:233]
  v_pk_mul_f32 v[56:57], v[56:57], v[174:175]
  v_pk_mul_f32 v[60:61], v[60:61], v[178:179]
  v_pk_mul_f32 v[64:65], v[64:65], v[182:183]
  v_pk_mul_f32 v[68:69], v[68:69], v[186:187]
  v_exp_f32 v56, v56
  v_exp_f32 v57, v57
  v_exp_f32 v60, v60
  v_exp_f32 v61, v61
  v_exp_f32 v64, v64
  v_exp_f32 v65, v65
  v_exp_f32 v68, v68
  v_exp_f32 v69, v69
  v_pk_fma_f32 v[56:57], v[56:57], v[122:123], v[122:123]
  v_pk_fma_f32 v[60:61], v[60:61], v[122:123], v[122:123]
  v_pk_fma_f32 v[64:65], v[64:65], v[122:123], v[122:123]
  v_pk_fma_f32 v[68:69], v[68:69], v[122:123], v[122:123]
  v_rcp_f32 v56, v56
  v_rcp_f32 v57, v57
  v_rcp_f32 v60, v60
  v_rcp_f32 v61, v61
  v_rcp_f32 v64, v64
  v_rcp_f32 v65, v65
  v_rcp_f32 v68, v68
  v_rcp_f32 v69, v69
  v_pk_fma_f32 v[16:17], v[56:57], v[174:175], v[16:17]
  v_pk_fma_f32 v[18:19], v[60:61], v[178:179], v[18:19]
  v_pk_fma_f32 v[20:21], v[64:65], v[182:183], v[20:21]
  v_pk_fma_f32 v[22:23], v[68:69], v[186:187], v[22:23]
  v_pk_mul_f32 v[40:41], v[188:189], v[188:189]
  v_pk_mul_f32 v[44:45], v[192:193], v[192:193]
  v_pk_mul_f32 v[48:49], v[196:197], v[196:197]
  v_pk_mul_f32 v[52:53], v[200:201], v[200:201]
  v_pk_fma_f32 v[40:41], v[40:41], v[234:235], v[232:233]
  v_pk_fma_f32 v[44:45], v[44:45], v[234:235], v[232:233]
  v_pk_fma_f32 v[48:49], v[48:49], v[234:235], v[232:233]
  v_pk_fma_f32 v[52:53], v[52:53], v[234:235], v[232:233]
  v_pk_mul_f32 v[40:41], v[40:41], v[188:189]
  v_pk_mul_f32 v[44:45], v[44:45], v[192:193]
  v_pk_mul_f32 v[48:49], v[48:49], v[196:197]
  v_pk_mul_f32 v[52:53], v[52:53], v[200:201]
  v_exp_f32 v40, v40
  v_exp_f32 v41, v41
  v_exp_f32 v44, v44
  v_exp_f32 v45, v45
  v_exp_f32 v48, v48
  v_exp_f32 v49, v49
  v_exp_f32 v52, v52
  v_exp_f32 v53, v53
  v_pk_fma_f32 v[40:41], v[40:41], v[124:125], v[124:125]
  v_pk_fma_f32 v[44:45], v[44:45], v[124:125], v[124:125]
  v_pk_fma_f32 v[48:49], v[48:49], v[124:125], v[124:125]
  v_pk_fma_f32 v[52:53], v[52:53], v[124:125], v[124:125]
  v_rcp_f32 v40, v40
  v_rcp_f32 v41, v41
  v_rcp_f32 v44, v44
  v_rcp_f32 v45, v45
  v_rcp_f32 v48, v48
  v_rcp_f32 v49, v49
  v_rcp_f32 v52, v52
  v_rcp_f32 v53, v53
  v_pk_fma_f32 v[16:17], v[40:41], v[188:189], v[16:17]
  v_pk_fma_f32 v[18:19], v[44:45], v[192:193], v[18:19]
  v_pk_fma_f32 v[20:21], v[48:49], v[196:197], v[20:21]
  v_pk_fma_f32 v[22:23], v[52:53], v[200:201], v[22:23]
  v_pk_mul_f32 v[56:57], v[190:191], v[190:191]
  v_pk_mul_f32 v[60:61], v[194:195], v[194:195]
  v_pk_mul_f32 v[64:65], v[198:199], v[198:199]
  v_pk_mul_f32 v[68:69], v[202:203], v[202:203]
  v_pk_fma_f32 v[56:57], v[56:57], v[234:235], v[232:233]
  v_pk_fma_f32 v[60:61], v[60:61], v[234:235], v[232:233]
  v_pk_fma_f32 v[64:65], v[64:65], v[234:235], v[232:233]
  v_pk_fma_f32 v[68:69], v[68:69], v[234:235], v[232:233]
  v_pk_mul_f32 v[56:57], v[56:57], v[190:191]
  v_pk_mul_f32 v[60:61], v[60:61], v[194:195]
  v_pk_mul_f32 v[64:65], v[64:65], v[198:199]
  v_pk_mul_f32 v[68:69], v[68:69], v[202:203]
  v_exp_f32 v56, v56
  v_exp_f32 v57, v57
  v_exp_f32 v60, v60
  v_exp_f32 v61, v61
  v_exp_f32 v64, v64
  v_exp_f32 v65, v65
  v_exp_f32 v68, v68
  v_exp_f32 v69, v69
  v_pk_fma_f32 v[56:57], v[56:57], v[126:127], v[126:127]
  v_pk_fma_f32 v[60:61], v[60:61], v[126:127], v[126:127]
  v_pk_fma_f32 v[64:65], v[64:65], v[126:127], v[126:127]
  v_pk_fma_f32 v[68:69], v[68:69], v[126:127], v[126:127]
  v_rcp_f32 v56, v56
  v_rcp_f32 v57, v57
  v_rcp_f32 v60, v60
  v_rcp_f32 v61, v61
  v_rcp_f32 v64, v64
  v_rcp_f32 v65, v65
  v_rcp_f32 v68, v68
  v_rcp_f32 v69, v69
  v_pk_fma_f32 v[16:17], v[56:57], v[190:191], v[16:17]
  v_pk_fma_f32 v[18:19], v[60:61], v[194:195], v[18:19]
  v_pk_fma_f32 v[20:21], v[64:65], v[198:199], v[20:21]
  v_pk_fma_f32 v[22:23], v[68:69], v[202:203], v[22:23]
  v_pk_mul_f32 v[40:41], v[204:205], v[204:205]
  v_pk_mul_f32 v[44:45], v[208:209], v[208:209]
  v_pk_mul_f32 v[48:49], v[212:213], v[212:213]
  v_pk_mul_f32 v[52:53], v[216:217], v[216:217]
  v_pk_fma_f32 v[40:41], v[40:41], v[234:235], v[232:233]
  v_pk_fma_f32 v[44:45], v[44:45], v[234:235], v[232:233]
  v_pk_fma_f32 v[48:49], v[48:49], v[234:235], v[232:233]
  v_pk_fma_f32 v[52:53], v[52:53], v[234:235], v[232:233]
  v_pk_mul_f32 v[40:41], v[40:41], v[204:205]
  v_pk_mul_f32 v[44:45], v[44:45], v[208:209]
  v_pk_mul_f32 v[48:49], v[48:49], v[212:213]
  v_pk_mul_f32 v[52:53], v[52:53], v[216:217]
  v_exp_f32 v40, v40
  v_exp_f32 v41, v41
  v_exp_f32 v44, v44
  v_exp_f32 v45, v45
  v_exp_f32 v48, v48
  v_exp_f32 v49, v49
  v_exp_f32 v52, v52
  v_exp_f32 v53, v53
  v_pk_fma_f32 v[40:41], v[40:41], v[128:129], v[128:129]
  v_pk_fma_f32 v[44:45], v[44:45], v[128:129], v[128:129]
  v_pk_fma_f32 v[48:49], v[48:49], v[128:129], v[128:129]
  v_pk_fma_f32 v[52:53], v[52:53], v[128:129], v[128:129]
  v_rcp_f32 v40, v40
  v_rcp_f32 v41, v41
  v_rcp_f32 v44, v44
  v_rcp_f32 v45, v45
  v_rcp_f32 v48, v48
  v_rcp_f32 v49, v49
  v_rcp_f32 v52, v52
  v_rcp_f32 v53, v53
  v_pk_fma_f32 v[16:17], v[40:41], v[204:205], v[16:17]
  v_pk_fma_f32 v[18:19], v[44:45], v[208:209], v[18:19]
  v_pk_fma_f32 v[20:21], v[48:49], v[212:213], v[20:21]
  v_pk_fma_f32 v[22:23], v[52:53], v[216:217], v[22:23]
  v_pk_mul_f32 v[56:57], v[206:207], v[206:207]
  v_pk_mul_f32 v[60:61], v[210:211], v[210:211]
  v_pk_mul_f32 v[64:65], v[214:215], v[214:215]
  v_pk_mul_f32 v[68:69], v[218:219], v[218:219]
  v_pk_fma_f32 v[56:57], v[56:57], v[234:235], v[232:233]
  v_pk_fma_f32 v[60:61], v[60:61], v[234:235], v[232:233]
  v_pk_fma_f32 v[64:65], v[64:65], v[234:235], v[232:233]
  v_pk_fma_f32 v[68:69], v[68:69], v[234:235], v[232:233]
  v_pk_mul_f32 v[56:57], v[56:57], v[206:207]
  v_pk_mul_f32 v[60:61], v[60:61], v[210:211]
  v_pk_mul_f32 v[64:65], v[64:65], v[214:215]
  v_pk_mul_f32 v[68:69], v[68:69], v[218:219]
  v_exp_f32 v56, v56
  v_exp_f32 v57, v57
  v_exp_f32 v60, v60
  v_exp_f32 v61, v61
  v_exp_f32 v64, v64
  v_exp_f32 v65, v65
  v_exp_f32 v68, v68
  v_exp_f32 v69, v69
  v_pk_fma_f32 v[56:57], v[56:57], v[130:131], v[130:131]
  v_pk_fma_f32 v[60:61], v[60:61], v[130:131], v[130:131]
  v_pk_fma_f32 v[64:65], v[64:65], v[130:131], v[130:131]
  v_pk_fma_f32 v[68:69], v[68:69], v[130:131], v[130:131]
  v_rcp_f32 v56, v56
  v_rcp_f32 v57, v57
  v_rcp_f32 v60, v60
  v_rcp_f32 v61, v61
  v_rcp_f32 v64, v64
  v_rcp_f32 v65, v65
  v_rcp_f32 v68, v68
  v_rcp_f32 v69, v69
  v_pk_fma_f32 v[16:17], v[56:57], v[206:207], v[16:17]
  v_pk_fma_f32 v[18:19], v[60:61], v[210:211], v[18:19]
  v_pk_fma_f32 v[20:21], v[64:65], v[214:215], v[20:21]
  v_pk_fma_f32 v[22:23], v[68:69], v[218:219], v[22:23]
  v_add_f32 v16, v16, v17
  v_add_f32 v18, v18, v19
  v_add_f32 v20, v20, v21
  v_add_f32 v22, v22, v23
  s_nop 0
  v_permlane32_swap_b32 v16, v20
  v_permlane32_swap_b32 v18, v22
  v_add_f32 v16, v16, v20
  v_add_f32 v18, v18, v22
  s_nop 1
  v_permlane16_swap_b32 v16, v18
  v_add_f32 v16, v16, v18
  ds_write_b32 v36, v16
  s_waitcnt lgkmcnt(0)
  s_cmp_eq_u32 s3, 0
  s_cbranch_scc1 L_dpub
  s_barrier
  s_endpgm
L_dpub:
  s_mov_b32 s60, s24
  s_and_b32 s61, s25, 0xffff
  s_mov_b32 s62, 268435456
  s_mov_b32 s63, 0x20000
  s_mov_b32 s64, s22
  s_and_b32 s65, s23, 0xffff
  s_mov_b32 s66, 256
  s_mov_b32 s67, 0x20000
  s_waitcnt vmcnt(0)
  v_cmp_eq_u32 vcc, 0, v37
  s_nop 0
  s_and_b32 vcc_lo, vcc_lo, 0xff
  s_cbranch_scc0 L_dclr_ok
  s_mov_b32 s78, 0x40000
L_dclr:
  s_sub_u32 s78, s78, 1
  s_cbranch_scc1 L_dclr_ok
  v_lshlrev_b32 v37, 2, v0
  v_and_b32 v37, 31, v37
  buffer_load_dword v37, v37, s[64:67], 0 offen offset:128 sc1
  s_waitcnt vmcnt(0)
  v_cmp_eq_u32 vcc, 0, v37
  s_nop 0
  s_and_b32 vcc_lo, vcc_lo, 0xff
  s_cbranch_scc1 L_dclr
L_dclr_ok:
  s_barrier
  ds_read_b64 v[64:65], v2 offset:0
  ds_read_b64 v[66:67], v2 offset:512
  ds_read_b64 v[68:69], v2 offset:1024
  ds_read_b64 v[70:71], v2 offset:1536
  s_waitcnt lgkmcnt(2)
  v_pk_add_f32 v[64:65], v[64:65], v[66:67]
  s_waitcnt lgkmcnt(0)
  v_pk_add_f32 v[68:69], v[68:69], v[70:71]
  v_pk_add_f32 v[64:65], v[64:65], v[68:69]
  v_and_b32 v64, -2, v64
  v_and_b32 v65, -2, v65
  buffer_store_dwordx2 v[64:65], v3, s[60:63], s69 offen sc1
  s_endpgm
L_cin:
  s_and_b32 s68, s26, 3
  s_mul_i32 s68, s68, 3
  s_add_u32 s27, s68, s27
  s_sub_u32 s27, s27, 6
  s_cbranch_scc1 L_rem
  s_and_b32 s79, s3, 3
  s_lshr_b32 s84, s3, 2
  s_lshl_b32 s100, s27, 3
  s_add_u32 s100, s100, s3
  s_mul_i32 s68, s100, 1280
  v_min_u32 v40, 9, v0
  v_lshlrev_b32 v40, 7, v40
  v_lshlrev_b32 v48, 4, v0
  s_lshl_b32 s95, s79, 10
  s_cmp_eq_u32 s79, 2
  s_cselect_b64 s[82:83], 0x1fffff, -1
  s_cmp_eq_u32 s79, 3
  s_cselect_b32 s96, 0, 32768
  s_add_u32 s96, s96, s95
  s_mul_i32 s69, s27, 2979
  s_lshr_b32 s69, s69, 6
  s_mul_i32 s98, s27, 44
  s_and_b32 s70, s2, 7
  s_add_u32 s85, s98, s3
  s_lshl_b32 s85, s85, 2
  s_lshl_b32 s98, s70, 14
  s_add_u32 s85, s85, s98
  s_add_u32 s85, s85, 10240
  s_mul_i32 s98, s27, 44
  s_lshl_b32 s77, s70, 9
  s_add_u32 s94, s77, s98
  s_add_u32 s77, s77, s69
  s_add_u32 s94, s94, s3
  s_mul_i32 s94, s94, 104
  s_lshl_b32 s98, s27, 2
  s_add_u32 s98, s98, s3
  s_add_u32 s98, s98, s70
  s_and_b32 s98, s98, 7
  s_mul_i32 s98, s98, 16640
  s_add_u32 s98, s98, 12288
  s_sub_u32 s72, 6, s84
  s_lshl_b32 s99, s84, 1
  s_mov_b32 s26, -1
  v_lshrrev_b32 v43, 3, v0
  v_min_u32 v43, 6, v43
  v_lshlrev_b32 v17, 4, v43
  s_mul_i32 s70, s70, 88
  s_add_u32 s70, s100, s70
  s_mov_b32 s71, 704
  v_mov_b32 v44, s70
  v_mad_u32_u24 v19, v0, s71, v44
  s_mul_i32 s70, s100, 104
  s_sub_u32 s70, s70, 313
  v_min_u32 v44, 16, v0
  v_mul_u32_u24 v45, 26, v44
  v_add_u32 v45, s70, v45
  v_cmp_lt_u32 vcc, 12, v44
  s_nop 1
  v_cndmask_b32 v19, v19, v45, vcc
  v_lshlrev_b32 v19, 7, v19
  s_mov_b32 s101, 212992
  v_mov_b32 v2, 110464
  v_lshlrev_b32 v1, 20, v0
  v_add_u32 v1, 110464, v1
  v_and_b32 v44, 7, v0
  v_lshlrev_b32 v18, 4, v44
  v_and_b32 v44, 15, v0
  v_lshl_add_u32 v44, v44, 2, v2
  v_mov_b32 v3, 0
  ds_write_b32 v44, v3
  v_lshrrev_b32 v41, 5, v0
  v_and_b32 v42, 31, v0
  s_waitcnt lgkmcnt(0)
  v_mov_b32 v3, 1
  s_mov_b32 s32, s6
  s_and_b32 s33, s7, 0xffff
  s_mov_b32 s34, 12800000
  s_mov_b32 s35, 0x20000
  v_mov_b32 v45, s80
  buffer_load_dword v255, v45, s[32:35], 0 offen
  s_mov_b32 s36, s8
  s_and_b32 s37, s9, 0xffff
  s_mov_b32 s38, 105456
  s_mov_b32 s39, 0x20000
  buffer_load_dword v255, v40, s[36:39], s68 offen
  s_mov_b32 s44, s12
  s_and_b32 s45, s13, 0xffff
  s_mov_b32 s46, 5537792
  s_mov_b32 s47, 0x20000
  s_barrier
  s_mov_b64 exec, 131071
  buffer_load_dword v255, v19, s[44:47], s101 offen
  s_mov_b64 exec, -1
  s_add_u32 s101, s101, 1171456
  s_mov_b32 s28, s4
  s_and_b32 s29, s5, 0xffff
  s_mov_b32 s30, 425984
  s_mov_b32 s31, 0x20000
  s_cmp_lg_u32 s84, 0
  s_cbranch_scc1 L_g1a
  s_mov_b32 s40, s10
  s_and_b32 s41, s11, 0xffff
  s_mov_b32 s42, 156
  s_mov_b32 s43, 0x20000
  s_mov_b32 m0, 110272
  s_mov_b64 exec, 0x7ff
  buffer_load_dwordx4 v48, s[40:43], 0 offen lds
  s_mov_b64 exec, -1
  s_add_u32 m0, s95, 71552
  s_add_u32 s81, s95, 70304
  buffer_load_dwordx4 v48, s[36:39], s81 offen lds
  s_add_u32 m0, s95, 75648
  s_add_u32 s81, s95, 74400
  buffer_load_dwordx4 v48, s[36:39], s81 offen lds
  s_add_u32 m0, s95, 79744
  s_add_u32 s81, s95, 78496
  buffer_load_dwordx4 v48, s[36:39], s81 offen lds
  s_add_u32 m0, s95, 83840
  s_add_u32 s81, s95, 82592
  buffer_load_dwordx4 v48, s[36:39], s81 offen lds
  s_add_u32 m0, s95, 87936
  s_add_u32 s81, s95, 86688
  buffer_load_dwordx4 v48, s[36:39], s81 offen lds
  s_add_u32 m0, s95, 92032
  s_add_u32 s81, s95, 90784
  buffer_load_dwordx4 v48, s[36:39], s81 offen lds
  s_add_u32 m0, s95, 96128
  s_add_u32 s81, s95, 94880
  buffer_load_dwordx4 v48, s[36:39], s81 offen lds
  s_add_u32 m0, s95, 100224
  s_add_u32 s81, s95, 98976
  buffer_load_dwordx4 v48, s[36:39], s81 offen lds
  s_add_u32 m0, s96, 71552
  s_add_u32 s81, s96, 70304
  s_mov_b64 exec, s[82:83]
  buffer_load_dwordx4 v48, s[36:39], s81 offen lds
  s_mov_b64 exec, -1
  s_add_u32 m0, s95, 36288
  s_add_u32 s81, s95, 35152
  buffer_load_dwordx4 v48, s[36:39], s81 offen lds
  s_add_u32 m0, s95, 40384
  s_add_u32 s81, s95, 39248
  buffer_load_dwordx4 v48, s[36:39], s81 offen lds
  s_add_u32 m0, s95, 44480
  s_add_u32 s81, s95, 43344
  buffer_load_dwordx4 v48, s[36:39], s81 offen lds
  s_add_u32 m0, s95, 48576
  s_add_u32 s81, s95, 47440
  buffer_load_dwordx4 v48, s[36:39], s81 offen lds
  s_branch L_addrc
L_g1a:
  s_setprio 1
  v_bfe_u32 v43, v0, 2, 2
  v_lshl_add_u32 v43, v41, 3, v43
  v_bfe_u32 v44, v0, 4, 1
  v_lshlrev_b32 v44, 5, v44
  v_and_b32 v45, 3, v0
  v_lshl_add_u32 v44, v45, 3, v44
  v_lshl_add_u32 v240, v43, 6, v44
  v_add_u32 v240, 106816, v240
  s_lshl_b32 s68, s79, 6
  s_add_u32 s68, s68, 36288
  v_add_u32 v44, s68, v44
  v_mul_u32_u24 v45, 1352, v43
  v_add_u32 v241, v44, v45
  v_add_u32 v45, 16, v43
  v_min_u32 v45, 25, v45
  v_mul_u32_u24 v45, 1352, v45
  v_add_u32 v242, v44, v45
  v_add_u32 v45, 20, v43
  v_min_u32 v45, 25, v45
  v_mul_u32_u24 v45, 1352, v45
  v_add_u32 v243, v44, v45
  s_lshl_b32 s68, s79, 5
  v_add_u32 v246, s68, v42
  v_mul_u32_u24 v43, 52, v246
  v_lshl_add_u32 v43, v41, 3, v43
  v_add_u32 v244, 71552, v43
  v_lshlrev_b32 v43, 1, v246
  v_add_u32 v245, 108864, v43
  v_mov_b32 v216, 0
  v_mov_b32 v217, 0
  v_lshlrev_b32 v43, 3, v0
  v_add_u32 v44, 106816, v43
  s_lshl_b32 s68, s79, 9
  v_add_u32 v44, s68, v44
  ds_write_b64 v44, v[216:217]
  v_lshl_add_u32 v43, v41, 7, v246
  s_mov_b32 s69, 2521
  s_mov_b32 s70, 106816
  v_mul_u32_u24 v44, s69, v43
  v_lshrrev_b32 v44, 16, v44
  v_mad_u32_u24 v44, v44, 12, s70
  v_lshl_add_u32 v68, v43, 1, v44
  v_add_u32 v43, 256, v43
  v_mul_u32_u24 v44, s69, v43
  v_lshrrev_b32 v44, 16, v44
  v_mad_u32_u24 v44, v44, 12, s70
  v_lshl_add_u32 v69, v43, 1, v44
  v_add_u32 v43, 256, v43
  v_mul_u32_u24 v44, s69, v43
  v_lshrrev_b32 v44, 16, v44
  v_mad_u32_u24 v44, v44, 12, s70
  v_lshl_add_u32 v70, v43, 1, v44
  v_mov_b32 v44, 676
  v_cmp_gt_u32 s[92:93], v44, v43
  v_add_u32 v43, 0, v246
  v_mul_u32_u24 v44, s69, v43
  v_lshrrev_b32 v44, 16, v44
  v_lshl_add_u32 v44, v44, 2, v244
  v_add_u32 v72, 0, v44
  v_add_u32 v43, 128, v246
  v_mul_u32_u24 v44, s69, v43
  v_lshrrev_b32 v44, 16, v44
  v_lshl_add_u32 v44, v44, 2, v244
  v_add_u32 v73, 6656, v44
  v_add_u32 v43, 256, v246
  v_mul_u32_u24 v44, s69, v43
  v_lshrrev_b32 v44, 16, v44
  v_lshl_add_u32 v44, v44, 2, v244
  v_add_u32 v74, 13312, v44
  v_add_u32 v43, 384, v246
  v_mul_u32_u24 v44, s69, v43
  v_lshrrev_b32 v44, 16, v44
  v_lshl_add_u32 v44, v44, 2, v244
  v_add_u32 v75, 19968, v44
  v_add_u32 v43, 512, v246
  v_mul_u32_u24 v44, s69, v43
  v_lshrrev_b32 v44, 16, v44
  v_lshl_add_u32 v44, v44, 2, v244
  v_add_u32 v76, 26624, v44
  v_add_u32 v43, 640, v246
  v_mul_u32_u24 v44, s69, v43
  v_lshrrev_b32 v44, 16, v44
  v_lshl_add_u32 v44, v44, 2, v244
  v_add_u32 v77, 33280, v44
  v_lshlrev_b32 v78, 4, v41
  v_add_u32 v78, 110376, v78
  v_lshlrev_b32 v79, 1, v0
  v_add_u32 v79, 110272, v79
  v_lshlrev_b32 v80, 6, v0
  v_add_u32 v80, 106868, v80
L_addrc:
  s_and_b32 s70, s3, 1
  s_lshl_b32 s70, s70, 1
  v_add_u32 v46, s70, v41
  v_min_u32 v43, 25, v42
  s_mul_i32 s68, s84, 4
  s_add_u32 s68, s68, 1352
  s_mul_i32 s69, s84, 70528
  s_add_u32 s69, s69, 1024
  v_mul_u32_u24 v44, s68, v43
  v_add_u32 v44, s69, v44
  v_lshlrev_b32 v247, 2, v43
  v_add_u32 v247, 70528, v247
  v_mul_u32_u24 v65, 52, v43
  v_lshl_add_u32 v65, v46, 1, v65
  v_add_u32 v65, 108864, v65
  v_lshlrev_b32 v67, 1, v43
  v_add_u32 v67, 110272, v67
  v_mad_u32_u24 v60, v46, 52, v44
  v_lshl_add_u32 v61, v46, 1, v44
  v_lshl_add_u32 v49, v46, 1, v60
  v_lshlrev_b32 v43, 3, v46
  s_mov_b32 s68, 0x01000100
  v_bfe_i32 v45, s68, v43, 8
  v_lshl_add_u32 v50, v45, 1, v60
  v_mad_i32_i24 v51, v45, 52, v61
  s_mov_b32 s68, 0xff00ff00
  v_bfe_i32 v45, s68, v43, 8
  v_lshl_add_u32 v52, v45, 1, v60
  v_mad_i32_i24 v53, v45, 52, v61
  s_mov_b32 s68, 0xff020100
  v_bfe_i32 v45, s68, v43, 8
  v_lshl_add_u32 v54, v45, 1, v60
  v_mad_i32_i24 v55, v45, 52, v61
  s_mov_b32 s68, 0x0b0a0100
  v_bfe_i32 v45, s68, v43, 8
  v_lshl_add_u32 v56, v45, 1, v60
  v_mad_i32_i24 v57, v45, 52, v61
  s_mov_b32 s68, 0xf3f20100
  v_bfe_i32 v45, s68, v43, 8
  v_lshl_add_u32 v58, v45, 1, v60
  v_mad_i32_i24 v59, v45, 52, v61
  s_mov_b32 s68, 0x00023600
  v_bfe_u32 v45, s68, v43, 8
  v_add_u32 v60, v45, v44
  v_add_u32 v61, 52, v44
  v_mov_b32 v47, 1048576
  v_cmp_eq_u32 vcc, 3, v46
  s_nop 1
  v_cndmask_b32 v60, v60, v47, vcc
  v_cndmask_b32 v67, v47, v67, vcc
  v_cmp_eq_u32 vcc, 2, v46
  s_nop 1
  v_cndmask_b32 v61, v47, v61, vcc
  v_cmp_gt_u32 vcc, 2, v46
  s_nop 1
  v_cndmask_b32 v64, v47, v65, vcc
  s_lshr_b32 s69, s79, 1
  s_mul_i32 s69, s69, 6144
  s_mul_i32 s68, s84, 6144
  v_lshlrev_b32 v45, 8, v46
  v_lshl_add_u32 v43, v42, 4, v45
  v_add_u32 v63, 1024, v43
  v_add_u32 v66, 36288, v43
  v_bfe_u32 v43, v0, 2, 2
  v_lshl_add_u32 v45, v43, 4, v45
  v_and_b32 v43, 3, v0
  v_lshl_add_u32 v44, v43, 6, v45
  v_add_u32 v44, 12288, v44
  v_cmp_lt_u32 vcc, 15, v42
  s_nop 1
  v_cndmask_b32 v63, v63, v44, vcc
  v_add_u32 v44, 16, v44
  v_cndmask_b32 v66, v66, v44, vcc
  v_lshl_add_u32 v44, v43, 5, v45
  v_add_u32 v44, 24560, v44
  v_cmp_lt_u32 vcc, 19, v42
  s_nop 1
  v_cndmask_b32 v63, v63, v44, vcc
  v_add_u32 v63, s69, v63
  v_add_u32 v66, s68, v66
  v_cmp_lt_u32 vcc, 25, v42
  s_nop 1
  v_cndmask_b32 v63, v63, v47, vcc
  v_cndmask_b32 v66, v66, v47, vcc
  v_mov_b32 v62, 0
  s_mul_i32 s74, s3, 4224
  s_add_u32 s74, s74, 111040
  s_mov_b32 s75, -39488
  v_add_u32 v28, 1024, v48
  v_and_b32 v43, 11, v0
  v_cmp_eq_u32 vcc, 11, v43
  s_nop 1
  v_cndmask_b32 v31, v28, v47, vcc
  v_and_b32 v43, 3, v0
  v_cmp_eq_u32 vcc, 0, v43
  s_nop 1
  v_cndmask_b32 v30, v31, v47, vcc
  v_lshrrev_b32 v46, 4, v0
  v_bfe_u32 v43, v0, 1, 3
  v_lshlrev_b32 v45, 4, v43
  v_add_u32 v45, 24576, v45
  v_and_b32 v43, 10, v0
  v_cmp_eq_u32 vcc, 10, v43
  s_nop 1
  v_cndmask_b32 v45, v45, v47, vcc
  v_and_b32 v44, 1, v0
  v_lshl_add_u32 v29, v46, 9, v45
  v_lshl_add_u32 v29, v44, 2, v29
  v_add_u32 v29, 1024, v29
  v_lshl_add_u32 v22, v46, 8, v45
  v_lshl_add_u32 v22, v44, 20, v22
  v_and_b32 v47, 15, v0
  s_mov_b32 s68, 1056
  v_lshlrev_b32 v43, 1, v47
  v_add_u32 v43, s74, v43
  v_mad_u32_u24 v7, v46, s68, v43
  s_lshl_b32 s68, s3, 10
  s_add_u32 s68, s68, 144832
  v_add_u32 v10, s68, v48
  v_add_u32 v43, 256, v48
  v_and_b32 v43, 1023, v43
  v_add_u32 v11, s68, v43
  v_xor_b32 v43, 512, v48
  v_add_u32 v12, s68, v43
  v_lshlrev_b32 v13, 4, v41
  v_mov_b32 v32, 0
  v_mov_b32 v33, 0
  v_mov_b32 v34, 0
  v_mov_b32 v35, 0
  v_mov_b32 v36, 0
  v_mov_b32 v37, 0
  v_mov_b32 v38, 0
  v_mov_b32 v39, 0
  v_mov_b32 v216, 0
  v_mov_b32 v217, 0
  v_mov_b32 v218, 0
  v_mov_b32 v219, 0
  v_mov_b32 v220, 0
  v_mov_b32 v221, 0
  v_mov_b32 v222, 0
  v_mov_b32 v223, 0
  v_mov_b32 v224, 0
  v_mov_b32 v225, 0
  v_mov_b32 v226, 0
  v_mov_b32 v227, 0
  v_mov_b32 v228, 0
  v_mov_b32 v229, 0
  v_mov_b32 v230, 0
  v_mov_b32 v231, 0
  v_mov_b32 v232, 0
  v_mov_b32 v233, 0
  v_mov_b32 v234, 0
  v_mov_b32 v235, 0
  v_mov_b32 v236, 0
  v_mov_b32 v237, 0
  v_mov_b32 v238, 0
  v_mov_b32 v239, 0
  v_mul_u32_u24 v44, 1056, v46
  v_bfe_u32 v45, v0, 2, 2
  v_lshl_add_u32 v44, v45, 7, v44
  v_and_b32 v45, 3, v0
  v_lshl_add_u32 v9, v45, 3, v44
  v_add_u32 v8, s74, v9
  v_and_b32 v45, 1, v0
  s_mov_b32 s68, 0xaaaaaaaa
  v_mul_lo_u32 v16, s68, v45
  v_or_b32 v16, 0x44444444, v16
  v_lshlrev_b32 v15, 1, v0
  v_add_u32 v15, s74, v15
  v_mov_b32 v14, 0x3f80
  ds_write_b16 v15, v14 offset:4064
  v_add_u32 v15, s75, v15
  s_mul_i32 s71, s3, 6
  s_add_u32 s77, s77, s71
  s_mul_i32 s77, s77, 104
  s_add_u32 s73, s77, 80
  s_add_u32 s77, s77, 16
  s_mov_b32 s71, 10923
  v_min_u32 v43, 35, v0
  v_mul_u32_u24 v44, s71, v43
  v_lshrrev_b32 v44, 16, v44
  v_mul_u32_u24 v44, 80, v44
  v_lshl_add_u32 v20, v43, 2, v44
  s_cmp_eq_u32 s84, 0
  s_cbranch_scc1 L_g0pf
  s_waitcnt lgkmcnt(0)
  ds_add_u32 v1, v3 offset:0
  s_sub_u32 s94, s94, 416
  buffer_load_dwordx4 v[204:207], v17, s[28:31], s94 offen offset:0
  s_add_u32 s94, s94, 416
  buffer_load_dwordx4 v[24:27], v17, s[28:31], s94 offen offset:0
  s_add_u32 s94, s94, 832
  s_sub_u32 s68, s77, 2496
  buffer_load_dword v208, v20, s[28:31], s68 offen
  buffer_load_dword v209, v20, s[28:31], s77 offen
  s_add_u32 s77, s77, 24
  buffer_load_dword v21, v20, s[28:31], s77 offen
  s_cmp_eq_u32 s77, s73
  s_cselect_b32 s73, 0x7000000, s73
  s_cselect_b32 s77, 0x7000000, s77
  s_add_u32 s77, s77, 24
  s_min_u32 s77, s77, s73
L_csync1:
  ds_read_b32 v4, v2 offset:0
  s_waitcnt lgkmcnt(0)
  v_cmp_gt_u32 vcc, 8, v4
  s_cbranch_vccnz L_csync1
  ds_read_b64 v[132:133], v78 offset:0
  ds_read_b64 v[134:135], v78 offset:8
  ds_read_b64 v[136:137], v78 offset:32
  ds_read_b64 v[138:139], v78 offset:40
  ds_read_u16 v45, v79 offset:52
  ds_read_b64_tr_b16 v[84:85], v241 offset:35264
  ds_read_b64_tr_b16 v[86:87], v241 offset:40672
  ds_read_b64_tr_b16 v[88:89], v242 offset:35264
  ds_read_b64_tr_b16 v[90:91], v243 offset:35264
  ds_read_b64_tr_b16 v[92:93], v241 offset:35520
  ds_read_b64_tr_b16 v[94:95], v241 offset:40928
  ds_read_b64_tr_b16 v[96:97], v242 offset:35520
  ds_read_b64_tr_b16 v[98:99], v243 offset:35520
  ds_read_b64_tr_b16 v[100:101], v241 offset:35776
  ds_read_b64_tr_b16 v[102:103], v241 offset:41184
  ds_read_b64_tr_b16 v[104:105], v242 offset:35776
  ds_read_b64_tr_b16 v[106:107], v243 offset:35776
  ds_read_b64_tr_b16 v[108:109], v241 offset:36032
  ds_read_b64_tr_b16 v[110:111], v241 offset:41440
  ds_read_b64_tr_b16 v[112:113], v242 offset:36032
  ds_read_b64_tr_b16 v[114:115], v243 offset:36032
  s_waitcnt lgkmcnt(14)
  v_mfma_f32_32x32x16_bf16 v[140:155], v[132:135], v[84:87], 0
  s_waitcnt lgkmcnt(12)
  v_mfma_f32_32x32x16_bf16 v[140:155], v[136:139], v[88:91], v[140:155]
  ds_read_b64_tr_b16 v[116:117], v241 offset:36288
  ds_read_b64_tr_b16 v[118:119], v241 offset:41696
  ds_read_b64_tr_b16 v[120:121], v242 offset:36288
  ds_read_b64_tr_b16 v[122:123], v243 offset:36288
  s_waitcnt lgkmcnt(14)
  v_mfma_f32_32x32x16_bf16 v[156:171], v[132:135], v[92:95], 0
  s_waitcnt lgkmcnt(12)
  v_mfma_f32_32x32x16_bf16 v[156:171], v[136:139], v[96:99], v[156:171]
  ds_read_b64_tr_b16 v[124:125], v241 offset:36544
  ds_read_b64_tr_b16 v[126:127], v241 offset:41952
  ds_read_b64_tr_b16 v[128:129], v242 offset:36544
  ds_read_b64_tr_b16 v[130:131], v243 offset:36544
  s_waitcnt lgkmcnt(14)
  v_mfma_f32_32x32x16_bf16 v[172:187], v[132:135], v[100:103], 0
  s_waitcnt lgkmcnt(12)
  v_mfma_f32_32x32x16_bf16 v[172:187], v[136:139], v[104:107], v[172:187]
  v_cvt_pk_bf16_f32 v81, v140, 0
  s_waitcnt lgkmcnt(10)
  v_mfma_f32_32x32x16_bf16 v[188:203], v[132:135], v[108:111], 0
  s_waitcnt lgkmcnt(8)
  v_mfma_f32_32x32x16_bf16 v[188:203], v[136:139], v[112:115], v[188:203]
  s_mov_b32 exec_lo, 0
  v_cvt_pk_bf16_f32 v81, v156, 0
  s_mov_b32 exec_lo, -1
  ds_write_b16 v68, v81
  s_waitcnt lgkmcnt(7)
  v_mfma_f32_32x32x16_bf16 v[140:155], v[132:135], v[116:119], 0
  s_waitcnt lgkmcnt(5)
  v_mfma_f32_32x32x16_bf16 v[140:155], v[136:139], v[120:123], v[140:155]
  v_cvt_pk_bf16_f32 v82, v172, 0
  s_waitcnt lgkmcnt(3)
  v_mfma_f32_32x32x16_bf16 v[156:171], v[132:135], v[124:127], 0
  s_waitcnt lgkmcnt(1)
  v_mfma_f32_32x32x16_bf16 v[156:171], v[136:139], v[128:131], v[156:171]
  s_mov_b32 exec_lo, 0
  v_cvt_pk_bf16_f32 v82, v188, 0
  s_mov_b32 exec_lo, -1
  ds_write_b16 v69, v82
  s_nop 2
  v_cvt_pk_bf16_f32 v83, v140, 0
  s_mov_b32 exec_lo, 0
  s_nop 2
  v_cvt_pk_bf16_f32 v83, v156, 0
  s_mov_b64 exec, s[92:93]
  ds_write_b16 v70, v83
  s_mov_b64 exec, 0x3ffffff
  ds_write_b16 v80, v45
  s_mov_b64 exec, -1
  s_waitcnt lgkmcnt(0)
  ds_add_u32 v1, v3 offset:32
  s_mov_b64 exec, 131071
  buffer_load_dword v255, v19, s[44:47], s101 offen
  s_mov_b64 exec, -1
  s_add_u32 s101, s101, 1171456
  v_cmp_gt_u32 s[92:93], 36, v246
  s_waitcnt vmcnt(3)
  v_lshlrev_b32 v208, 7, v208
  buffer_load_dword v255, v208, s[32:35], 0 offen
  s_waitcnt vmcnt(3)
  v_lshlrev_b32 v209, 7, v209
  buffer_load_dword v255, v209, s[32:35], 0 offen
L_csync2:
  ds_read_b32 v4, v2 offset:4
  s_waitcnt lgkmcnt(0)
  v_cmp_gt_u32 vcc, 4, v4
  s_cbranch_vccnz L_csync2
  ds_read_b64_tr_b16 v[84:85], v241 offset:0
  ds_read_b64_tr_b16 v[86:87], v241 offset:5408
  ds_read_b64_tr_b16 v[88:89], v242 offset:0
  ds_read_b64_tr_b16 v[90:91], v243 offset:0
  ds_read_b64_tr_b16 v[92:93], v241 offset:256
  ds_read_b64_tr_b16 v[94:95], v241 offset:5664
  ds_read_b64_tr_b16 v[96:97], v242 offset:256
  ds_read_b64_tr_b16 v[98:99], v243 offset:256
  ds_read_b64_tr_b16 v[100:101], v241 offset:512
  ds_read_b64_tr_b16 v[102:103], v241 offset:5920
  ds_read_b64_tr_b16 v[104:105], v242 offset:512
  ds_read_b64_tr_b16 v[106:107], v243 offset:512
  ds_read_b64_tr_b16 v[108:109], v241 offset:768
  ds_read_b64_tr_b16 v[110:111], v241 offset:6176
  ds_read_b64_tr_b16 v[112:113], v242 offset:768
  ds_read_b64_tr_b16 v[114:115], v243 offset:768
  ds_read_b64_tr_b16 v[116:117], v241 offset:1024
  ds_read_b64_tr_b16 v[118:119], v241 offset:6432
  ds_read_b64_tr_b16 v[120:121], v242 offset:1024
  ds_read_b64_tr_b16 v[122:123], v243 offset:1024
  ds_read_b64_tr_b16 v[124:125], v241 offset:1280
  ds_read_b64_tr_b16 v[126:127], v241 offset:6688
  ds_read_b64_tr_b16 v[128:129], v242 offset:1280
  ds_read_b64_tr_b16 v[130:131], v243 offset:1280
L_csync3:
  ds_read_b32 v4, v2 offset:32
  s_waitcnt lgkmcnt(0)
  v_cmp_gt_u32 vcc, 4, v4
  s_cbranch_vccnz L_csync3
  s_setprio 1
  ds_read_b64_tr_b16 v[132:133], v240 offset:0
  ds_read_b64_tr_b16 v[134:135], v240 offset:256
  ds_read_b64_tr_b16 v[136:137], v240 offset:1024
  ds_read_b64_tr_b16 v[138:139], v240 offset:1280
  s_waitcnt lgkmcnt(2)
  v_mfma_f32_32x32x16_bf16 v[140:155], v[132:135], v[84:87], 0
  s_waitcnt lgkmcnt(0)
  v_mfma_f32_32x32x16_bf16 v[140:155], v[136:139], v[88:91], v[140:155]
  v_mfma_f32_32x32x16_bf16 v[156:171], v[132:135], v[92:95], 0
  v_mfma_f32_32x32x16_bf16 v[156:171], v[136:139], v[96:99], v[156:171]
  v_mfma_f32_32x32x16_bf16 v[172:187], v[132:135], v[100:103], 0
  v_mfma_f32_32x32x16_bf16 v[172:187], v[136:139], v[104:107], v[172:187]
  s_nop 7
  v_cvt_pk_bf16_f32 v84, v140, v141
  v_cvt_pk_bf16_f32 v85, v142, v143
  v_cvt_pk_bf16_f32 v86, v144, v145
  v_cvt_pk_bf16_f32 v87, v146, v147
  v_cvt_pk_bf16_f32 v88, v148, v149
  v_cvt_pk_bf16_f32 v89, v150, v151
  v_cvt_pk_bf16_f32 v90, v152, v153
  v_cvt_pk_bf16_f32 v91, v154, v155
  ds_write2_b32 v72, v84, v85 offset0:0 offset1:1
  v_max3_f32 v62, v62, abs(v140), abs(v141)
  v_max3_f32 v62, v62, abs(v142), abs(v143)
  v_max3_f32 v62, v62, abs(v144), abs(v145)
  ds_write2_b32 v72, v86, v87 offset0:4 offset1:5
  v_max3_f32 v62, v62, abs(v146), abs(v147)
  v_max3_f32 v62, v62, abs(v148), abs(v149)
  ds_write2_b32 v72, v88, v89 offset0:8 offset1:9
  v_max3_f32 v62, v62, abs(v150), abs(v151)
  v_max3_f32 v62, v62, abs(v152), abs(v153)
  v_mfma_f32_32x32x16_bf16 v[188:203], v[132:135], v[108:111], 0
  v_mfma_f32_32x32x16_bf16 v[188:203], v[136:139], v[112:115], v[188:203]
  v_cvt_pk_bf16_f32 v92, v156, v157
  v_cvt_pk_bf16_f32 v93, v158, v159
  v_cvt_pk_bf16_f32 v94, v160, v161
  v_cvt_pk_bf16_f32 v95, v162, v163
  v_cvt_pk_bf16_f32 v96, v164, v165
  v_cvt_pk_bf16_f32 v97, v166, v167
  v_cvt_pk_bf16_f32 v98, v168, v169
  v_cvt_pk_bf16_f32 v99, v170, v171
  ds_write2_b32 v73, v92, v93 offset0:0 offset1:1
  v_max3_f32 v62, v62, abs(v156), abs(v157)
  v_max3_f32 v62, v62, abs(v158), abs(v159)
  v_max3_f32 v62, v62, abs(v160), abs(v161)
  ds_write2_b32 v73, v94, v95 offset0:4 offset1:5
  v_max3_f32 v62, v62, abs(v162), abs(v163)
  v_max3_f32 v62, v62, abs(v164), abs(v165)
  ds_write2_b32 v73, v96, v97 offset0:8 offset1:9
  v_max3_f32 v62, v62, abs(v166), abs(v167)
  v_max3_f32 v62, v62, abs(v168), abs(v169)
  v_mfma_f32_32x32x16_bf16 v[140:155], v[132:135], v[116:119], 0
  v_mfma_f32_32x32x16_bf16 v[140:155], v[136:139], v[120:123], v[140:155]
  v_cvt_pk_bf16_f32 v100, v172, v173
  v_cvt_pk_bf16_f32 v101, v174, v175
  v_cvt_pk_bf16_f32 v102, v176, v177
  v_cvt_pk_bf16_f32 v103, v178, v179
  v_cvt_pk_bf16_f32 v104, v180, v181
  v_cvt_pk_bf16_f32 v105, v182, v183
  v_cvt_pk_bf16_f32 v106, v184, v185
  v_cvt_pk_bf16_f32 v107, v186, v187
  ds_write2_b32 v74, v100, v101 offset0:0 offset1:1
  v_max3_f32 v62, v62, abs(v172), abs(v173)
  v_max3_f32 v62, v62, abs(v174), abs(v175)
  v_max3_f32 v62, v62, abs(v176), abs(v177)
  ds_write2_b32 v74, v102, v103 offset0:4 offset1:5
  v_max3_f32 v62, v62, abs(v178), abs(v179)
  v_max3_f32 v62, v62, abs(v180), abs(v181)
  ds_write2_b32 v74, v104, v105 offset0:8 offset1:9
  v_max3_f32 v62, v62, abs(v182), abs(v183)
  v_max3_f32 v62, v62, abs(v184), abs(v185)
  v_mfma_f32_32x32x16_bf16 v[156:171], v[132:135], v[124:127], 0
  v_mfma_f32_32x32x16_bf16 v[156:171], v[136:139], v[128:131], v[156:171]
  v_cvt_pk_bf16_f32 v108, v188, v189
  v_cvt_pk_bf16_f32 v109, v190, v191
  v_cvt_pk_bf16_f32 v110, v192, v193
  v_cvt_pk_bf16_f32 v111, v194, v195
  v_cvt_pk_bf16_f32 v112, v196, v197
  v_cvt_pk_bf16_f32 v113, v198, v199
  v_cvt_pk_bf16_f32 v114, v200, v201
  v_cvt_pk_bf16_f32 v115, v202, v203
  ds_write2_b32 v75, v108, v109 offset0:0 offset1:1
  v_max3_f32 v62, v62, abs(v188), abs(v189)
  v_max3_f32 v62, v62, abs(v190), abs(v191)
  v_max3_f32 v62, v62, abs(v192), abs(v193)
  ds_write2_b32 v75, v110, v111 offset0:4 offset1:5
  v_max3_f32 v62, v62, abs(v194), abs(v195)
  v_max3_f32 v62, v62, abs(v196), abs(v197)
  ds_write2_b32 v75, v112, v113 offset0:8 offset1:9
  v_max3_f32 v62, v62, abs(v198), abs(v199)
  v_max3_f32 v62, v62, abs(v200), abs(v201)
  v_cvt_pk_bf16_f32 v116, v140, v141
  v_cvt_pk_bf16_f32 v117, v142, v143
  v_cvt_pk_bf16_f32 v118, v144, v145
  v_cvt_pk_bf16_f32 v119, v146, v147
  v_cvt_pk_bf16_f32 v120, v148, v149
  v_cvt_pk_bf16_f32 v121, v150, v151
  v_cvt_pk_bf16_f32 v122, v152, v153
  v_cvt_pk_bf16_f32 v123, v154, v155
  ds_write2_b32 v76, v116, v117 offset0:0 offset1:1
  v_max3_f32 v62, v62, abs(v140), abs(v141)
  v_max3_f32 v62, v62, abs(v142), abs(v143)
  v_max3_f32 v62, v62, abs(v144), abs(v145)
  ds_write2_b32 v76, v118, v119 offset0:4 offset1:5
  v_max3_f32 v62, v62, abs(v146), abs(v147)
  v_max3_f32 v62, v62, abs(v148), abs(v149)
  ds_write2_b32 v76, v120, v121 offset0:8 offset1:9
  v_max3_f32 v62, v62, abs(v150), abs(v151)
  v_max3_f32 v62, v62, abs(v152), abs(v153)
  v_cvt_pk_bf16_f32 v124, v156, v157
  v_cvt_pk_bf16_f32 v125, v158, v159
  v_cvt_pk_bf16_f32 v126, v160, v161
  v_cvt_pk_bf16_f32 v127, v162, v163
  v_cvt_pk_bf16_f32 v128, v164, v165
  v_cvt_pk_bf16_f32 v129, v166, v167
  v_cvt_pk_bf16_f32 v130, v168, v169
  v_cvt_pk_bf16_f32 v131, v170, v171
  s_mov_b64 exec, s[92:93]
  ds_write2_b32 v77, v124, v125 offset0:0 offset1:1
  v_max3_f32 v62, v62, abs(v156), abs(v157)
  v_max3_f32 v62, v62, abs(v158), abs(v159)
  v_max3_f32 v62, v62, abs(v160), abs(v161)
  ds_write2_b32 v77, v126, v127 offset0:4 offset1:5
  v_max3_f32 v62, v62, abs(v162), abs(v163)
  v_max3_f32 v62, v62, abs(v164), abs(v165)
  ds_write2_b32 v77, v128, v129 offset0:8 offset1:9
  v_max3_f32 v62, v62, abs(v166), abs(v167)
  v_max3_f32 v62, v62, abs(v168), abs(v169)
  s_mov_b32 exec_hi, 0
  ds_write_b32 v77, v130 offset:48
  ds_write_b16 v245, v131 offset:1280
  s_mov_b32 exec_lo, -1
  ds_write_b32 v76, v122 offset:48
  ds_write_b16 v245, v123 offset:1024
  ds_write_b32 v75, v114 offset:48
  ds_write_b16 v245, v115 offset:768
  ds_write_b32 v74, v106 offset:48
  ds_write_b16 v245, v107 offset:512
  ds_write_b32 v73, v98 offset:48
  ds_write_b16 v245, v99 offset:256
  ds_write_b32 v72, v90 offset:48
  ds_write_b16 v245, v91 offset:0
  s_mov_b64 exec, -1
  v_max_u32_dpp v62, v62, v62 row_shr:1 row_mask:0xf bank_mask:0xf
  s_nop 1
  v_max_u32_dpp v62, v62, v62 row_shr:2 row_mask:0xf bank_mask:0xf
  s_nop 1
  v_max_u32_dpp v62, v62, v62 row_shr:4 row_mask:0xf bank_mask:0xf
  s_nop 1
  v_max_u32_dpp v62, v62, v62 row_shr:8 row_mask:0xf bank_mask:0xf
  s_nop 1
  v_max_u32_dpp v62, v62, v62 row_bcast:15 row_mask:0xa bank_mask:0xf
  s_nop 1
  v_max_u32_dpp v62, v62, v62 row_bcast:31 row_mask:0xc bank_mask:0xf
  s_nop 0
  v_readlane_b32 s68, v62, 63
  s_nop 1
  v_mov_b32 v62, s68
  ds_max_u32 v1, v62 offset:28
  ds_add_u32 v1, v3 offset:24
  s_setprio 0
  v_lshl_add_u32 v24, v24, 7, v18
  v_lshl_add_u32 v25, v25, 7, v18
  s_mov_b32 exec_hi, 0x0000ffff
  v_lshl_add_u32 v26, v26, 7, v18
  v_lshl_add_u32 v27, v27, 7, v18
  s_mov_b32 exec_lo, 0
  s_mov_b32 exec_hi, 0xffff0000
  v_mov_b32 v27, v25
  v_mov_b32 v26, v25
  s_mov_b32 exec_hi, 0x00ff0000
  v_mov_b32 v26, v24
  s_mov_b64 exec, -1
  s_add_u32 m0, s74, 0
  s_nop 0
  buffer_load_dwordx4 v24, s[32:35], 0 offen lds
  s_add_u32 m0, s74, 1056
  s_nop 0
  buffer_load_dwordx4 v25, s[32:35], 0 offen lds
  s_add_u32 m0, s74, 2112
  s_nop 0
  buffer_load_dwordx4 v26, s[32:35], 0 offen lds
  s_add_u32 m0, s74, 3168
  s_mov_b32 exec_hi, 0x00ffffff
  buffer_load_dwordx4 v27, s[32:35], 0 offen lds
  s_mov_b32 exec_hi, -1
  v_lshl_add_u32 v204, v204, 7, v18
  v_lshl_add_u32 v205, v205, 7, v18
  s_mov_b32 exec_hi, 0x0000ffff
  v_lshl_add_u32 v206, v206, 7, v18
  v_lshl_add_u32 v207, v207, 7, v18
  s_mov_b32 exec_lo, 0
  s_mov_b32 exec_hi, 0xffff0000
  v_mov_b32 v207, v205
  v_mov_b32 v206, v205
  s_mov_b32 exec_hi, 0x00ff0000
  v_mov_b32 v206, v204
  s_mov_b64 exec, -1
  s_add_u32 m0, s74, -16896
  s_nop 0
  buffer_load_dwordx4 v204, s[32:35], 0 offen lds
  s_add_u32 m0, s74, -15840
  s_nop 0
  buffer_load_dwordx4 v205, s[32:35], 0 offen lds
  s_add_u32 m0, s74, -14784
  s_nop 0
  buffer_load_dwordx4 v206, s[32:35], 0 offen lds
  s_add_u32 m0, s74, -13728
  s_mov_b32 exec_hi, 0x00ffffff
  buffer_load_dwordx4 v207, s[32:35], 0 offen lds
  s_mov_b32 exec_hi, -1
  buffer_load_dwordx4 v[24:27], v17, s[28:31], s94 offen offset:0
  s_add_u32 s94, s94, 832
  s_branch L_uph
L_g0pf:
  s_waitcnt vmcnt(4) lgkmcnt(0)
  ds_add_u32 v1, v3 offset:0
  s_add_u32 m0, s95, 52672
  s_add_u32 s81, s95, 51536
  buffer_load_dwordx4 v48, s[36:39], s81 offen lds
  s_add_u32 m0, s95, 56768
  s_add_u32 s81, s95, 55632
  buffer_load_dwordx4 v48, s[36:39], s81 offen lds
  s_add_u32 m0, s95, 60864
  s_add_u32 s81, s95, 59728
  buffer_load_dwordx4 v48, s[36:39], s81 offen lds
  s_add_u32 m0, s95, 64960
  s_add_u32 s81, s95, 63824
  buffer_load_dwordx4 v48, s[36:39], s81 offen lds
  s_add_u32 m0, s96, 36288
  s_add_u32 s81, s96, 35152
  s_mov_b64 exec, s[82:83]
  buffer_load_dwordx4 v48, s[36:39], s81 offen lds
  s_mov_b64 exec, -1
  s_add_u32 m0, s95, 1024
  s_add_u32 s81, s95, 0
  buffer_load_dwordx4 v48, s[36:39], s81 offen lds
  s_add_u32 m0, s95, 5120
  s_add_u32 s81, s95, 4096
  buffer_load_dwordx4 v48, s[36:39], s81 offen lds
  s_add_u32 m0, s95, 9216
  s_add_u32 s81, s95, 8192
  buffer_load_dwordx4 v48, s[36:39], s81 offen lds
  s_add_u32 m0, s95, 13312
  s_add_u32 s81, s95, 12288
  buffer_load_dwordx4 v48, s[36:39], s81 offen lds
  s_waitcnt vmcnt(4) lgkmcnt(0)
  ds_add_u32 v1, v3 offset:4
  s_add_u32 m0, s95, 17408
  s_add_u32 s81, s95, 16384
  buffer_load_dwordx4 v48, s[36:39], s81 offen lds
  s_add_u32 m0, s95, 21504
  s_add_u32 s81, s95, 20480
  buffer_load_dwordx4 v48, s[36:39], s81 offen lds
  s_add_u32 m0, s95, 25600
  s_add_u32 s81, s95, 24576
  buffer_load_dwordx4 v48, s[36:39], s81 offen lds
  s_add_u32 m0, s95, 29696
  s_add_u32 s81, s95, 28672
  buffer_load_dwordx4 v48, s[36:39], s81 offen lds
  s_add_u32 m0, s96, 1024
  s_add_u32 s81, s96, 0
  s_mov_b64 exec, s[82:83]
  buffer_load_dwordx4 v48, s[36:39], s81 offen lds
  s_mov_b64 exec, -1
  s_add_u32 s94, s94, 832
  s_add_u32 s77, s77, 24
  buffer_load_dwordx4 v[24:27], v17, s[28:31], s94 offen offset:0
  s_add_u32 s94, s94, 832
  buffer_load_dword v21, v20, s[28:31], s77 offen
  s_cmp_eq_u32 s77, s73
  s_cselect_b32 s73, 0x7000000, s73
  s_cselect_b32 s77, 0x7000000, s77
  s_add_u32 s77, s77, 24
  s_min_u32 s77, s77, s73
  s_mov_b64 exec, 131071
  buffer_load_dword v255, v19, s[44:47], s101 offen
  s_mov_b64 exec, -1
  s_add_u32 s101, s101, 1171456
  s_waitcnt vmcnt(3) lgkmcnt(0)
  ds_add_u32 v1, v3 offset:8
  s_mov_b32 s97, 0
L_csync4:
  ds_read_b32 v4, v2 offset:8
  s_waitcnt lgkmcnt(0)
  v_cmp_gt_u32 vcc, 4, v4
  s_cbranch_vccnz L_csync4
  s_cmp_ge_u32 s79, 2
  s_cbranch_scc1 L_chunk2
L_chunk0:
  ds_read_u16_d16_hi v216, v49 offset:0
  ds_read_u16_d16_hi v218, v49 offset:648
  ds_read_u16_d16_hi v220, v49 offset:216
  ds_read_u16_d16_hi v222, v49 offset:864
  ds_read_u16_d16_hi v224, v49 offset:432
  ds_read_u16_d16_hi v226, v49 offset:1080
  ds_read_u16_d16_hi v228, v49 offset:8
  ds_read_u16_d16_hi v229, v49 offset:208
  ds_read_u16_d16_hi v230, v49 offset:656
  ds_read_u16_d16_hi v231, v49 offset:856
  s_waitcnt lgkmcnt(8)
  v_mov_b32 v85, v218
  v_mov_b32 v84, v216
  v_max3_f32 v62, v62, abs(v84), abs(v85)
  ds_read_u16_d16_hi v232, v49 offset:32
  ds_read_u16_d16_hi v233, v49 offset:832
  ds_read_u16_d16_hi v234, v49 offset:632
  ds_read_u16_d16_hi v235, v49 offset:232
  s_waitcnt lgkmcnt(10)
  v_mov_b32 v87, v222
  v_mov_b32 v86, v220
  v_max3_f32 v62, v62, abs(v86), abs(v87)
  ds_read_u16_d16_hi v236, v49 offset:16
  ds_read_u16_d16_hi v237, v49 offset:416
  ds_read_u16_d16_hi v238, v49 offset:664
  ds_read_u16_d16_hi v239, v49 offset:1064
  s_waitcnt lgkmcnt(12)
  v_mov_b32 v89, v226
  v_mov_b32 v88, v224
  v_max3_f32 v62, v62, abs(v88), abs(v89)
  ds_read_u16_d16_hi v216, v49 offset:40
  ds_read_u16_d16_hi v217, v49 offset:1040
  ds_read_u16_d16_hi v218, v49 offset:640
  ds_read_u16_d16_hi v219, v49 offset:440
  s_waitcnt lgkmcnt(12)
  v_add_f32 v91, v230, v231
  v_add_f32 v90, v228, v229
  v_max3_f32 v62, v62, abs(v90), abs(v91)
  ds_read_u16_d16_hi v220, v49 offset:224
  ds_read_u16_d16_hi v221, v49 offset:424
  ds_read_u16_d16_hi v222, v49 offset:872
  ds_read_u16_d16_hi v223, v49 offset:1072
  s_waitcnt lgkmcnt(12)
  v_add_f32 v93, v234, v235
  v_add_f32 v92, v232, v233
  v_max3_f32 v62, v62, abs(v92), abs(v93)
  ds_read_u16_d16_hi v224, v49 offset:248
  ds_read_u16_d16_hi v225, v49 offset:1048
  ds_read_u16_d16_hi v226, v49 offset:848
  ds_read_u16_d16_hi v227, v49 offset:448
  s_waitcnt lgkmcnt(12)
  v_add_f32 v95, v238, v239
  v_add_f32 v94, v236, v237
  v_max3_f32 v62, v62, abs(v94), abs(v95)
  ds_read_u16_d16_hi v228, v50 offset:48
  ds_read_u16_d16_hi v229, v51 offset:1248
  ds_read_u16_d16_hi v230, v50 offset:672
  ds_read_u16_d16_hi v231, v51 offset:1272
  s_waitcnt lgkmcnt(12)
  v_add_f32 v97, v218, v219
  v_add_f32 v96, v216, v217
  v_max3_f32 v62, v62, abs(v96), abs(v97)
  ds_read_u16_d16_hi v232, v50 offset:256
  ds_read_u16_d16_hi v233, v51 offset:1256
  ds_read_u16_d16_hi v234, v50 offset:880
  ds_read_u16_d16_hi v235, v51 offset:1280
  s_waitcnt lgkmcnt(12)
  v_add_f32 v99, v222, v223
  v_add_f32 v98, v220, v221
  v_max3_f32 v62, v62, abs(v98), abs(v99)
  ds_read_u16_d16_hi v236, v50 offset:464
  ds_read_u16_d16_hi v237, v51 offset:1264
  ds_read_u16_d16_hi v238, v50 offset:1088
  ds_read_u16_d16_hi v239, v51 offset:1288
  s_waitcnt lgkmcnt(12)
  v_add_f32 v101, v226, v227
  v_add_f32 v100, v224, v225
  v_max3_f32 v62, v62, abs(v100), abs(v101)
  s_waitcnt lgkmcnt(8)
  v_add_f32 v103, v230, v231
  v_add_f32 v102, v228, v229
  v_max3_f32 v62, v62, abs(v102), abs(v103)
  s_waitcnt lgkmcnt(4)
  v_add_f32 v105, v234, v235
  v_add_f32 v104, v232, v233
  v_max3_f32 v62, v62, abs(v104), abs(v105)
  s_waitcnt lgkmcnt(0)
  v_add_f32 v107, v238, v239
  v_add_f32 v106, v236, v237
  v_max3_f32 v62, v62, abs(v106), abs(v107)
  s_cmp_lg_u32 s97, 0
  s_cbranch_scc1 L_uconv0
L_chunk1:
  ds_read_u16_d16_hi v216, v49 offset:24
  ds_read_u16_d16_hi v217, v49 offset:624
  ds_read_u16_d16_hi v218, v49 offset:240
  ds_read_u16_d16_hi v219, v49 offset:840
  ds_read_u16_d16_hi v220, v49 offset:456
  ds_read_u16_d16_hi v221, v49 offset:1056
  ds_read_u16_d16_hi v222, v60 offset:1296
  ds_read_u16_d16_hi v223, v61 offset:1296
  ds_read_u16_d16_hi v224, v52 offset:50
  ds_read_u16_d16_hi v225, v53 offset:1300
  ds_read_u16_d16_hi v226, v52 offset:674
  ds_read_u16_d16_hi v227, v53 offset:1324
  ds_read_u16_d16_hi v228, v52 offset:258
  ds_read_u16_d16_hi v229, v53 offset:1308
  ds_read_u16_d16_hi v230, v52 offset:882
  ds_read_u16_d16_hi v231, v53 offset:1332
  s_waitcnt lgkmcnt(12)
  v_add_f32 v109, v218, v219
  v_add_f32 v108, v216, v217
  v_max3_f32 v62, v62, abs(v108), abs(v109)
  ds_read_u16_d16_hi v232, v52 offset:466
  ds_read_u16_d16_hi v233, v53 offset:1316
  ds_read_u16_d16_hi v234, v52 offset:1090
  ds_read_u16_d16_hi v235, v53 offset:1340
  s_waitcnt lgkmcnt(12)
  v_add_f32 v111, v222, v223
  v_add_f32 v110, v220, v221
  v_max3_f32 v62, v62, abs(v110), abs(v111)
  ds_read_u16_d16_hi v236, v54 offset:2
  ds_read_u16_d16_hi v237, v55 offset:52
  ds_read_u16_d16_hi v238, v54 offset:650
  ds_read_u16_d16_hi v239, v55 offset:700
  s_waitcnt lgkmcnt(12)
  v_add_f32 v113, v226, v227
  v_add_f32 v112, v224, v225
  v_max3_f32 v62, v62, abs(v112), abs(v113)
  ds_read_u16_d16_hi v216, v54 offset:26
  ds_read_u16_d16_hi v217, v55 offset:676
  ds_read_u16_d16_hi v218, v54 offset:626
  ds_read_u16_d16_hi v219, v55 offset:76
  s_waitcnt lgkmcnt(12)
  v_add_f32 v115, v230, v231
  v_add_f32 v114, v228, v229
  v_max3_f32 v62, v62, abs(v114), abs(v115)
  ds_read_u16_d16_hi v220, v54 offset:10
  ds_read_u16_d16_hi v221, v55 offset:260
  ds_read_u16_d16_hi v222, v54 offset:658
  ds_read_u16_d16_hi v223, v55 offset:908
  s_waitcnt lgkmcnt(12)
  v_add_f32 v117, v234, v235
  v_add_f32 v116, v232, v233
  v_max3_f32 v62, v62, abs(v116), abs(v117)
  ds_read_u16_d16_hi v224, v54 offset:34
  ds_read_u16_d16_hi v225, v55 offset:884
  ds_read_u16_d16_hi v226, v54 offset:634
  ds_read_u16_d16_hi v227, v55 offset:284
  s_waitcnt lgkmcnt(12)
  v_add_f32 v119, v238, v239
  v_add_f32 v118, v236, v237
  v_max3_f32 v62, v62, abs(v118), abs(v119)
  ds_read_u16_d16_hi v228, v54 offset:18
  ds_read_u16_d16_hi v229, v55 offset:468
  ds_read_u16_d16_hi v230, v54 offset:666
  ds_read_u16_d16_hi v231, v55 offset:1116
  s_waitcnt lgkmcnt(12)
  v_add_f32 v121, v218, v219
  v_add_f32 v120, v216, v217
  v_max3_f32 v62, v62, abs(v120), abs(v121)
  ds_read_u16_d16_hi v232, v54 offset:42
  ds_read_u16_d16_hi v233, v55 offset:1092
  ds_read_u16_d16_hi v234, v54 offset:642
  ds_read_u16_d16_hi v235, v55 offset:492
  s_waitcnt lgkmcnt(12)
  v_add_f32 v123, v222, v223
  v_add_f32 v122, v220, v221
  v_max3_f32 v62, v62, abs(v122), abs(v123)
  ds_read_u16_d16_hi v236, v54 offset:210
  ds_read_u16_d16_hi v237, v55 offset:60
  ds_read_u16_d16_hi v238, v54 offset:858
  ds_read_u16_d16_hi v239, v55 offset:708
  s_waitcnt lgkmcnt(12)
  v_add_f32 v125, v226, v227
  v_add_f32 v124, v224, v225
  v_max3_f32 v62, v62, abs(v124), abs(v125)
  s_waitcnt lgkmcnt(8)
  v_add_f32 v127, v230, v231
  v_add_f32 v126, v228, v229
  v_max3_f32 v62, v62, abs(v126), abs(v127)
  s_waitcnt lgkmcnt(4)
  v_add_f32 v129, v234, v235
  v_add_f32 v128, v232, v233
  v_max3_f32 v62, v62, abs(v128), abs(v129)
  s_waitcnt lgkmcnt(0)
  v_add_f32 v131, v238, v239
  v_add_f32 v130, v236, v237
  v_max3_f32 v62, v62, abs(v130), abs(v131)
  s_cmp_lg_u32 s97, 0
  s_cbranch_scc1 L_uconv1
  s_branch L_w1conv
L_chunk2:
  ds_read_u16_d16_hi v216, v54 offset:234
  ds_read_u16_d16_hi v217, v55 offset:684
  ds_read_u16_d16_hi v218, v54 offset:834
  ds_read_u16_d16_hi v219, v55 offset:84
  ds_read_u16_d16_hi v220, v54 offset:218
  ds_read_u16_d16_hi v221, v55 offset:268
  ds_read_u16_d16_hi v222, v54 offset:866
  ds_read_u16_d16_hi v223, v55 offset:916
  ds_read_u16_d16_hi v224, v54 offset:242
  ds_read_u16_d16_hi v225, v55 offset:892
  ds_read_u16_d16_hi v226, v54 offset:842
  ds_read_u16_d16_hi v227, v55 offset:292
  ds_read_u16_d16_hi v228, v54 offset:226
  ds_read_u16_d16_hi v229, v55 offset:476
  ds_read_u16_d16_hi v230, v54 offset:874
  ds_read_u16_d16_hi v231, v55 offset:1124
  s_waitcnt lgkmcnt(12)
  v_add_f32 v85, v218, v219
  v_add_f32 v84, v216, v217
  v_max3_f32 v62, v62, abs(v84), abs(v85)
  ds_read_u16_d16_hi v232, v54 offset:250
  ds_read_u16_d16_hi v233, v55 offset:1100
  ds_read_u16_d16_hi v234, v54 offset:850
  ds_read_u16_d16_hi v235, v55 offset:500
  s_waitcnt lgkmcnt(12)
  v_add_f32 v87, v222, v223
  v_add_f32 v86, v220, v221
  v_max3_f32 v62, v62, abs(v86), abs(v87)
  ds_read_u16_d16_hi v236, v54 offset:418
  ds_read_u16_d16_hi v237, v55 offset:68
  ds_read_u16_d16_hi v238, v54 offset:1066
  ds_read_u16_d16_hi v239, v55 offset:716
  s_waitcnt lgkmcnt(12)
  v_add_f32 v89, v226, v227
  v_add_f32 v88, v224, v225
  v_max3_f32 v62, v62, abs(v88), abs(v89)
  ds_read_u16_d16_hi v216, v54 offset:442
  ds_read_u16_d16_hi v217, v55 offset:692
  ds_read_u16_d16_hi v218, v54 offset:1042
  ds_read_u16_d16_hi v219, v55 offset:92
  s_waitcnt lgkmcnt(12)
  v_add_f32 v91, v230, v231
  v_add_f32 v90, v228, v229
  v_max3_f32 v62, v62, abs(v90), abs(v91)
  ds_read_u16_d16_hi v220, v54 offset:426
  ds_read_u16_d16_hi v221, v55 offset:276
  ds_read_u16_d16_hi v222, v54 offset:1074
  ds_read_u16_d16_hi v223, v55 offset:924
  s_waitcnt lgkmcnt(12)
  v_add_f32 v93, v234, v235
  v_add_f32 v92, v232, v233
  v_max3_f32 v62, v62, abs(v92), abs(v93)
  ds_read_u16_d16_hi v224, v54 offset:450
  ds_read_u16_d16_hi v225, v55 offset:900
  ds_read_u16_d16_hi v226, v54 offset:1050
  ds_read_u16_d16_hi v227, v55 offset:300
  s_waitcnt lgkmcnt(12)
  v_add_f32 v95, v238, v239
  v_add_f32 v94, v236, v237
  v_max3_f32 v62, v62, abs(v94), abs(v95)
  ds_read_u16_d16_hi v228, v54 offset:434
  ds_read_u16_d16_hi v229, v55 offset:484
  ds_read_u16_d16_hi v230, v54 offset:1082
  ds_read_u16_d16_hi v231, v55 offset:1132
  s_waitcnt lgkmcnt(12)
  v_add_f32 v97, v218, v219
  v_add_f32 v96, v216, v217
  v_max3_f32 v62, v62, abs(v96), abs(v97)
  ds_read_u16_d16_hi v232, v54 offset:458
  ds_read_u16_d16_hi v233, v55 offset:1108
  ds_read_u16_d16_hi v234, v54 offset:1058
  ds_read_u16_d16_hi v235, v55 offset:508
  s_waitcnt lgkmcnt(12)
  v_add_f32 v99, v222, v223
  v_add_f32 v98, v220, v221
  v_max3_f32 v62, v62, abs(v98), abs(v99)
  ds_read_u16_d16_hi v236, v56 offset:4
  ds_read_u16_d16_hi v237, v57 offset:104
  ds_read_u16_d16_hi v238, v58 offset:652
  ds_read_u16_d16_hi v239, v59 offset:752
  s_waitcnt lgkmcnt(12)
  v_add_f32 v101, v226, v227
  v_add_f32 v100, v224, v225
  v_max3_f32 v62, v62, abs(v100), abs(v101)
  s_waitcnt lgkmcnt(8)
  v_add_f32 v103, v230, v231
  v_add_f32 v102, v228, v229
  v_max3_f32 v62, v62, abs(v102), abs(v103)
  s_waitcnt lgkmcnt(4)
  v_add_f32 v105, v234, v235
  v_add_f32 v104, v232, v233
  v_max3_f32 v62, v62, abs(v104), abs(v105)
  s_waitcnt lgkmcnt(0)
  v_add_f32 v107, v238, v239
  v_add_f32 v106, v236, v237
  v_max3_f32 v62, v62, abs(v106), abs(v107)
  s_cmp_lg_u32 s97, 0
  s_cbranch_scc1 L_uconv0
L_chunk3:
  ds_read_u16_d16_hi v216, v56 offset:220
  ds_read_u16_d16_hi v217, v57 offset:320
  ds_read_u16_d16_hi v218, v58 offset:868
  ds_read_u16_d16_hi v219, v59 offset:968
  ds_read_u16_d16_hi v220, v56 offset:436
  ds_read_u16_d16_hi v221, v57 offset:536
  ds_read_u16_d16_hi v222, v58 offset:1084
  ds_read_u16_d16_hi v223, v59 offset:1184
  ds_read_u16_d16_hi v224, v56 offset:12
  ds_read_u16_d16_hi v225, v57 offset:312
  ds_read_u16_d16_hi v226, v58 offset:660
  ds_read_u16_d16_hi v227, v59 offset:960
  ds_read_u16_d16_hi v228, v58 offset:36
  ds_read_u16_d16_hi v229, v59 offset:936
  ds_read_u16_d16_hi v230, v56 offset:636
  ds_read_u16_d16_hi v231, v57 offset:336
  s_waitcnt lgkmcnt(12)
  v_add_f32 v109, v218, v219
  v_add_f32 v108, v216, v217
  v_max3_f32 v62, v62, abs(v108), abs(v109)
  ds_read_u16_d16_hi v232, v56 offset:20
  ds_read_u16_d16_hi v233, v57 offset:520
  ds_read_u16_d16_hi v234, v58 offset:668
  ds_read_u16_d16_hi v235, v59 offset:1168
  s_waitcnt lgkmcnt(12)
  v_add_f32 v111, v222, v223
  v_add_f32 v110, v220, v221
  v_max3_f32 v62, v62, abs(v110), abs(v111)
  ds_read_u16_d16_hi v236, v58 offset:44
  ds_read_u16_d16_hi v237, v59 offset:1144
  ds_read_u16_d16_hi v238, v56 offset:644
  ds_read_u16_d16_hi v239, v57 offset:544
  s_waitcnt lgkmcnt(12)
  v_add_f32 v113, v226, v227
  v_add_f32 v112, v224, v225
  v_max3_f32 v62, v62, abs(v112), abs(v113)
  ds_read_u16_d16_hi v216, v56 offset:228
  ds_read_u16_d16_hi v217, v57 offset:528
  ds_read_u16_d16_hi v218, v58 offset:876
  ds_read_u16_d16_hi v219, v59 offset:1176
  s_waitcnt lgkmcnt(12)
  v_add_f32 v115, v230, v231
  v_add_f32 v114, v228, v229
  v_max3_f32 v62, v62, abs(v114), abs(v115)
  ds_read_u16_d16_hi v220, v58 offset:252
  ds_read_u16_d16_hi v221, v59 offset:1152
  ds_read_u16_d16_hi v222, v56 offset:852
  ds_read_u16_d16_hi v223, v57 offset:552
  s_waitcnt lgkmcnt(12)
  v_add_f32 v117, v234, v235
  v_add_f32 v116, v232, v233
  v_max3_f32 v62, v62, abs(v116), abs(v117)
  ds_read_u16_d16_hi v224, v65 offset:0
  ds_read_u16_d16_hi v225, v65 offset:8
  ds_read_u16_d16_hi v226, v65 offset:16
  ds_read_u16_d16_hi v227, v65 offset:24
  ds_read_u16_d16_hi v228, v65 offset:32
  ds_read_u16_d16_hi v229, v65 offset:40
  ds_read_u16_d16_hi v230, v64 offset:48
  ds_read_u16_d16_hi v231, v67
  s_waitcnt lgkmcnt(14)
  v_add_f32 v119, v238, v239
  v_add_f32 v118, v236, v237
  v_max3_f32 v62, v62, abs(v118), abs(v119)
  s_waitcnt lgkmcnt(12)
  v_add_f32 v121, v218, v219
  v_add_f32 v120, v216, v217
  v_max3_f32 v62, v62, abs(v120), abs(v121)
  s_waitcnt lgkmcnt(8)
  v_add_f32 v123, v222, v223
  v_add_f32 v122, v220, v221
  v_max3_f32 v62, v62, abs(v122), abs(v123)
  s_cmp_lg_u32 s97, 0
  s_cbranch_scc1 L_uconv1
L_w1conv:
  v_max_u32_dpp v62, v62, v62 row_shr:1 row_mask:0xf bank_mask:0xf
  s_nop 1
  v_max_u32_dpp v62, v62, v62 row_shr:2 row_mask:0xf bank_mask:0xf
  s_nop 1
  v_max_u32_dpp v62, v62, v62 row_shr:4 row_mask:0xf bank_mask:0xf
  s_nop 1
  v_max_u32_dpp v62, v62, v62 row_shr:8 row_mask:0xf bank_mask:0xf
  s_nop 1
  v_max_u32_dpp v62, v62, v62 row_bcast:15 row_mask:0xa bank_mask:0xf
  s_nop 1
  v_max_u32_dpp v62, v62, v62 row_bcast:31 row_mask:0xc bank_mask:0xf
  s_nop 0
  v_readlane_b32 s68, v62, 63
  s_nop 1
  v_mov_b32 v62, s68
  ds_max_u32 v1, v62 offset:20
  ds_add_u32 v1, v3 offset:16
  v_add_u32 v49, v49, v247
  v_add_u32 v50, v50, v247
  v_add_u32 v51, v51, v247
  v_add_u32 v52, v52, v247
  v_add_u32 v53, v53, v247
  v_add_u32 v54, v54, v247
  v_add_u32 v55, v55, v247
  v_add_u32 v56, v56, v247
  v_add_u32 v57, v57, v247
  v_add_u32 v58, v58, v247
  v_add_u32 v59, v59, v247
  v_add_u32 v60, v60, v247
  v_add_u32 v61, v61, v247
L_csync5:
  ds_read_b64 v[40:41], v2 offset:16
  s_waitcnt lgkmcnt(0)
  v_cmp_gt_u32 vcc, 4, v40
  s_cbranch_vccnz L_csync5
  v_readfirstlane_b32 s70, v41
  s_nop 0
  s_lshr_b32 s70, s70, 23
  s_sub_i32 s70, 141, s70
  s_min_i32 s70, s70, 40
  s_add_i32 s51, s70, 127
  s_lshl_b32 s51, s51, 23
  v_fma_mixlo_f16 v132, v84, s51, 0
  v_fma_mixlo_f16 v133, v86, s51, 0
  v_fma_mixlo_f16 v134, v88, s51, 0
  v_fma_mixlo_f16 v135, v90, s51, 0
  v_fma_mixhi_f16 v132, v85, s51, 0
  v_fma_mixhi_f16 v133, v87, s51, 0
  v_fma_mixhi_f16 v134, v89, s51, 0
  v_fma_mixhi_f16 v135, v91, s51, 0
  v_fma_mixlo_f16 v136, v92, s51, 0
  v_fma_mixlo_f16 v137, v94, s51, 0
  v_fma_mixlo_f16 v138, v96, s51, 0
  v_fma_mixlo_f16 v139, v98, s51, 0
  v_fma_mixhi_f16 v136, v93, s51, 0
  v_fma_mixhi_f16 v137, v95, s51, 0
  v_fma_mixhi_f16 v138, v97, s51, 0
  v_fma_mixhi_f16 v139, v99, s51, 0
  ds_write_b128 v63, v[132:135] offset:0
  v_fma_mixlo_f16 v140, v100, s51, 0
  v_fma_mixlo_f16 v141, v102, s51, 0
  v_fma_mixlo_f16 v142, v104, s51, 0
  v_fma_mixlo_f16 v143, v106, s51, 0
  v_fma_mixhi_f16 v140, v101, s51, 0
  v_fma_mixhi_f16 v141, v103, s51, 0
  v_fma_mixhi_f16 v142, v105, s51, 0
  v_fma_mixhi_f16 v143, v107, s51, 0
  ds_write_b128 v63, v[136:139] offset:1024
  v_fma_mixlo_f16 v144, v108, s51, 0
  v_fma_mixlo_f16 v145, v110, s51, 0
  v_fma_mixlo_f16 v146, v112, s51, 0
  v_fma_mixlo_f16 v147, v114, s51, 0
  v_fma_mixhi_f16 v144, v109, s51, 0
  v_fma_mixhi_f16 v145, v111, s51, 0
  v_fma_mixhi_f16 v146, v113, s51, 0
  v_fma_mixhi_f16 v147, v115, s51, 0
  ds_write_b128 v63, v[140:143] offset:2048
  v_fma_mixlo_f16 v148, v116, s51, 0
  v_fma_mixlo_f16 v149, v118, s51, 0
  v_fma_mixlo_f16 v150, v120, s51, 0
  v_fma_mixlo_f16 v151, v122, s51, 0
  v_fma_mixhi_f16 v148, v117, s51, 0
  v_fma_mixhi_f16 v149, v119, s51, 0
  v_fma_mixhi_f16 v150, v121, s51, 0
  v_fma_mixhi_f16 v151, v123, s51, 0
  ds_write_b128 v63, v[144:147] offset:3072
  ds_write_b128 v63, v[148:151] offset:4096
  s_cmp_ge_u32 s79, 2
  s_cbranch_scc1 L_w1x
  v_fma_mixlo_f16 v152, v124, s51, 0
  v_fma_mixlo_f16 v153, v126, s51, 0
  v_fma_mixlo_f16 v154, v128, s51, 0
  v_fma_mixlo_f16 v155, v130, s51, 0
  v_fma_mixhi_f16 v152, v125, s51, 0
  v_fma_mixhi_f16 v153, v127, s51, 0
  v_fma_mixhi_f16 v154, v129, s51, 0
  v_fma_mixhi_f16 v155, v131, s51, 0
  ds_write_b128 v63, v[152:155] offset:5120
L_w1x:
L_uph:
L_csync6:
  ds_read_b64 v[40:41], v2 offset:24
  s_waitcnt lgkmcnt(0)
  v_cmp_gt_u32 vcc, 4, v40
  s_cbranch_vccnz L_csync6
  v_readfirstlane_b32 s71, v41
  s_nop 0
  s_lshr_b32 s71, s71, 23
  s_sub_i32 s71, 140, s71
  s_min_i32 s71, s71, 40
  s_add_i32 s51, s71, 127
  s_lshl_b32 s51, s51, 23
  s_mov_b32 s97, 1
  s_lshr_b32 s69, s3, 1
  s_cmp_eq_u32 s69, 0
  s_cbranch_scc1 L_chunk0
  s_cmp_eq_u32 s69, 1
  s_cbranch_scc1 L_chunk1
  s_cmp_eq_u32 s69, 2
  s_cbranch_scc1 L_chunk2
  s_branch L_chunk3
L_uconv0:
  v_fma_mixlo_f16 v132, v84, s51, 0
  v_fma_mixlo_f16 v133, v86, s51, 0
  v_fma_mixlo_f16 v134, v88, s51, 0
  v_fma_mixlo_f16 v135, v90, s51, 0
  v_fma_mixhi_f16 v132, v85, s51, 0
  v_fma_mixhi_f16 v133, v87, s51, 0
  v_fma_mixhi_f16 v134, v89, s51, 0
  v_fma_mixhi_f16 v135, v91, s51, 0
L_csync7:
  ds_read_b64 v[40:41], v2 offset:16
  s_waitcnt lgkmcnt(0)
  v_cmp_gt_u32 vcc, 4, v40
  s_cbranch_vccnz L_csync7
  v_readfirstlane_b32 s70, v41
  s_nop 0
  s_lshr_b32 s70, s70, 23
  s_sub_i32 s70, 141, s70
  s_min_i32 s70, s70, 40
  ds_write_b128 v66, v[132:135] offset:0
  v_fma_mixlo_f16 v136, v92, s51, 0
  v_fma_mixlo_f16 v137, v94, s51, 0
  v_fma_mixlo_f16 v138, v96, s51, 0
  v_fma_mixlo_f16 v139, v98, s51, 0
  v_fma_mixhi_f16 v136, v93, s51, 0
  v_fma_mixhi_f16 v137, v95, s51, 0
  v_fma_mixhi_f16 v138, v97, s51, 0
  v_fma_mixhi_f16 v139, v99, s51, 0
  ds_write_b128 v66, v[136:139] offset:1024
  v_fma_mixlo_f16 v140, v100, s51, 0
  v_fma_mixlo_f16 v141, v102, s51, 0
  v_fma_mixlo_f16 v142, v104, s51, 0
  v_fma_mixlo_f16 v143, v106, s51, 0
  v_fma_mixhi_f16 v140, v101, s51, 0
  v_fma_mixhi_f16 v141, v103, s51, 0
  v_fma_mixhi_f16 v142, v105, s51, 0
  v_fma_mixhi_f16 v143, v107, s51, 0
  ds_write_b128 v66, v[140:143] offset:2048
  s_branch L_built
L_uconv1:
  v_fma_mixlo_f16 v144, v108, s51, 0
  v_fma_mixlo_f16 v145, v110, s51, 0
  v_fma_mixlo_f16 v146, v112, s51, 0
  v_fma_mixlo_f16 v147, v114, s51, 0
  v_fma_mixhi_f16 v144, v109, s51, 0
  v_fma_mixhi_f16 v145, v111, s51, 0
  v_fma_mixhi_f16 v146, v113, s51, 0
  v_fma_mixhi_f16 v147, v115, s51, 0
L_csync8:
  ds_read_b64 v[40:41], v2 offset:16
  s_waitcnt lgkmcnt(0)
  v_cmp_gt_u32 vcc, 4, v40
  s_cbranch_vccnz L_csync8
  v_readfirstlane_b32 s70, v41
  s_nop 0
  s_lshr_b32 s70, s70, 23
  s_sub_i32 s70, 141, s70
  s_min_i32 s70, s70, 40
  ds_write_b128 v66, v[144:147] offset:3072
  v_fma_mixlo_f16 v148, v116, s51, 0
  v_fma_mixlo_f16 v149, v118, s51, 0
  v_fma_mixlo_f16 v150, v120, s51, 0
  v_fma_mixlo_f16 v151, v122, s51, 0
  v_fma_mixhi_f16 v148, v117, s51, 0
  v_fma_mixhi_f16 v149, v119, s51, 0
  v_fma_mixhi_f16 v150, v121, s51, 0
  v_fma_mixhi_f16 v151, v123, s51, 0
  ds_write_b128 v66, v[148:151] offset:4096
  s_cmp_lg_u32 s84, 0
  s_cbranch_scc1 L_ulin
  v_fma_mixlo_f16 v152, v124, s51, 0
  v_fma_mixlo_f16 v153, v126, s51, 0
  v_fma_mixlo_f16 v154, v128, s51, 0
  v_fma_mixlo_f16 v155, v130, s51, 0
  v_fma_mixhi_f16 v152, v125, s51, 0
  v_fma_mixhi_f16 v153, v127, s51, 0
  v_fma_mixhi_f16 v154, v129, s51, 0
  v_fma_mixhi_f16 v155, v131, s51, 0
  ds_write_b128 v66, v[152:155] offset:5120
  s_branch L_built
L_ulin:
  v_mul_f32 v224, s51, v224
  v_mul_f32 v225, s51, v225
  v_mul_f32 v226, s51, v226
  v_mul_f32 v227, s51, v227
  v_mul_f32 v228, s51, v228
  v_mul_f32 v229, s51, v229
  v_mul_f32 v230, s51, v230
  v_mul_f32 v231, s51, v231
  v_cvt_pk_bf16_f32 v152, v224, v225
  v_cvt_pk_bf16_f32 v153, v226, v227
  v_cvt_pk_bf16_f32 v154, v228, v229
  v_cvt_pk_bf16_f32 v155, v230, v231
  ds_write_b128 v66, v[152:155] offset:5120
L_built:
  s_waitcnt vmcnt(1)
  v_mov_b32 v4, s84
  ds_add_u32 v1, v4 offset:36
  s_mov_b32 s60, s24
  s_and_b32 s61, s25, 0xffff
  s_mov_b32 s62, 268435456
  s_mov_b32 s63, 0x20000
  s_mov_b32 s64, s22
  s_and_b32 s65, s23, 0xffff
  s_mov_b32 s66, 256
  s_mov_b32 s67, 0x20000
  v_lshlrev_b32 v251, 2, v0
  s_mov_b64 exec, 0xff
  s_mov_b32 s81, 0x80000
  buffer_load_dword v255, v251, s[60:63], s81 offen
  buffer_load_dword v250, v251, s[64:67], 0 offen offset:128 sc1
  s_mov_b64 exec, -1
  v_mov_b32 v251, 0
  s_add_i32 s48, s70, s71
L_csync9:
  ds_read_b32 v4, v2 offset:36
  s_waitcnt lgkmcnt(0)
  v_cmp_gt_u32 vcc, 4, v4
  s_cbranch_vccnz L_csync9
  ds_read_u16_d16_hi v32, v7 offset:0
  ds_read_u16_d16_hi v33, v7 offset:128
  ds_read_u16_d16_hi v34, v7 offset:256
  ds_read_u16_d16_hi v35, v7 offset:384
  ds_read_u16_d16_hi v36, v7 offset:512
  ds_read_u16_d16_hi v37, v7 offset:640
  ds_read_u16_d16_hi v38, v7 offset:768
  ds_read_u16_d16_hi v39, v7 offset:896
  s_waitcnt lgkmcnt(0)
  v_cvt_pk_f16_f32 v43, v38, v39
  v_cvt_pk_f16_f32 v40, v32, v35
  v_cvt_pk_f16_f32 v41, v33, v36
  v_cvt_pk_f16_f32 v42, v34, v37
  ds_write_b128 v10, v[40:43]
  ds_read_b64_tr_b16 v[52:53], v8 offset:0
  ds_read_b64_tr_b16 v[54:55], v8 offset:512
  v_pk_mul_f16 v56, v40, v40 op_sel:[0,0] op_sel_hi:[1,1]
  v_pk_mul_f16 v57, v41, v41 op_sel:[0,0] op_sel_hi:[1,1]
  v_pk_mul_f16 v58, v42, v42 op_sel:[0,0] op_sel_hi:[1,1]
  v_pk_mul_f16 v59, v40, v41 op_sel:[0,0] op_sel_hi:[1,1]
  ds_read_b128 v[44:47], v11
  ds_read_b128 v[48:51], v12
  v_pk_mul_f16 v60, v40, v41 op_sel:[0,1] op_sel_hi:[1,0]
  v_pk_mul_f16 v61, v40, v42 op_sel:[0,0] op_sel_hi:[1,1]
  s_waitcnt vmcnt(3)
  v_lshlrev_b32 v21, 7, v21
  buffer_load_dword v255, v21, s[32:35], 0 offen
  s_mov_b64 exec, 131071
  buffer_load_dword v255, v19, s[44:47], s101 offen
  s_mov_b64 exec, -1
  s_add_u32 s101, s101, 1171456
  s_waitcnt lgkmcnt(0)
  s_barrier
  s_setprio 1
  ds_read_b128 v[216:219], v22
  ds_read_b128 v[240:243], v28 offset:46528
  ds_read_b128 v[128:131], v28 offset:35264
  ds_read_b128 v[84:87], v28 offset:0
  ds_read_b128 v[244:247], v30 offset:22528
  ds_read_b128 v[172:175], v31 offset:11264
  ds_read_b128 v[176:179], v31 offset:12288
  ds_read_b128 v[180:183], v31 offset:13312
  ds_read2_b32 v[220:221], v29 offset0:0 offset1:2
  ds_read2_b32 v[222:223], v29 offset0:64 offset1:66
  v_add_u32 v29, 2048, v29
  ds_read_b128 v[88:91], v28 offset:1024
  s_cmp_lg_u32 s84, 0
  s_cbranch_scc1 L_prf
  s_setprio 2
L_prf:
  s_waitcnt lgkmcnt(10)
  v_mfma_f32_16x16x32_f16 v[80:83], v[216:219], v[56:59], 0
  ds_read_b128 v[92:95], v28 offset:2048
  s_waitcnt lgkmcnt(10)
  v_mfma_f32_16x16x32_bf16 v[72:75], v[240:243], v[52:55], 0
  ds_read_b128 v[132:135], v28 offset:36288
  v_pk_mul_f16 v62, v40, v42 op_sel:[0,1] op_sel_hi:[1,0]
  v_pk_mul_f16 v63, v41, v42 op_sel:[0,0] op_sel_hi:[1,1]
  s_waitcnt lgkmcnt(10)
  v_mfma_f32_16x16x32_f16 v[72:75], v[128:131], v[56:59], v[72:75]
  ds_read_b128 v[136:139], v28 offset:37312
  s_waitcnt lgkmcnt(10)
  v_mfma_f32_16x16x32_f16 v[68:71], v[84:87], v[56:59], 0
  ds_read_b128 v[140:143], v28 offset:38336
  v_pk_mul_f16 v64, v41, v42 op_sel:[0,1] op_sel_hi:[1,0]
  s_waitcnt lgkmcnt(10)
  v_mfma_f32_16x16x32_bf16 v[76:79], v[244:247], v[52:55], 0
  ds_read_b128 v[144:147], v28 offset:39360
  v_pk_mul_f16 v65, v40, v43 op_sel:[0,0] op_sel_hi:[1,0]
  v_pk_mul_f16 v66, v41, v43 op_sel:[0,0] op_sel_hi:[1,0]
  s_waitcnt lgkmcnt(10)
  v_mfma_f32_16x16x32_f16 v[76:79], v[172:175], v[56:59], v[76:79]
  ds_read2_b32 v[224:225], v29 offset0:0 offset1:2
  ds_read2_b32 v[226:227], v29 offset0:64 offset1:66
  v_add_u32 v29, 2048, v29
  v_pk_mul_f16 v67, v42, v43 op_sel:[0,0] op_sel_hi:[1,0]
  s_waitcnt lgkmcnt(11)
  v_mfma_f32_16x16x32_f16 v[76:79], v[176:179], v[60:63], v[76:79]
  ds_read_b128 v[96:99], v28 offset:3072
  v_mul_f16_sdwa v52, v40, v40 dst_sel:WORD_0 dst_unused:UNUSED_PAD src0_sel:WORD_0 src1_sel:WORD_1
  v_mul_f16_sdwa v53, v42, v42 dst_sel:WORD_0 dst_unused:UNUSED_PAD src0_sel:WORD_0 src1_sel:WORD_1
  s_waitcnt lgkmcnt(11)
  v_mfma_f32_16x16x32_f16 v[76:79], v[180:183], v[64:67], v[76:79]
  ds_read_b128 v[100:103], v28 offset:4096
  v_alignbit_b32 v48, v48, v48, v13
  s_waitcnt lgkmcnt(10)
  v_smfmac_f32_16x16x64_f16 v[80:83], v[220:223], v[60:67], v16
  ds_read_b128 v[184:187], v31 offset:14336
  v_mul_f16_sdwa v52, v41, v41 dst_sel:WORD_1 dst_unused:UNUSED_PRESERVE src0_sel:WORD_0 src1_sel:WORD_1
  v_mul_f16_sdwa v53, v43, v43 dst_sel:WORD_1 dst_unused:UNUSED_PRESERVE src0_sel:WORD_0 src1_sel:WORD_1
  s_waitcnt lgkmcnt(10)
  v_mfma_f32_16x16x32_f16 v[68:71], v[88:91], v[60:63], v[68:71]
  ds_read_b128 v[188:191], v31 offset:15360
  v_pk_mul_f16 v54, v40, v47 op_sel:[0,0] op_sel_hi:[1,0]
  s_waitcnt lgkmcnt(10)
  v_mfma_f32_16x16x32_f16 v[68:71], v[92:95], v[64:67], v[68:71]
  ds_read_b128 v[192:195], v31 offset:16384
  v_pk_mul_f16 v55, v41, v47 op_sel:[0,0] op_sel_hi:[1,0]
  v_pk_mul_f16 v56, v42, v47 op_sel:[0,0] op_sel_hi:[1,0]
  s_waitcnt lgkmcnt(10)
  v_mfma_f32_16x16x32_f16 v[72:75], v[132:135], v[60:63], v[72:75]
  ds_read_b128 v[196:199], v31 offset:17408
  v_pk_mul_f16 v57, v40, v44 op_sel:[0,0] op_sel_hi:[1,1]
  v_pk_mul_f16 v58, v40, v44 op_sel:[0,1] op_sel_hi:[1,0]
  s_waitcnt lgkmcnt(10)
  v_mfma_f32_16x16x32_f16 v[72:75], v[136:139], v[64:67], v[72:75]
  ds_read2_b32 v[228:229], v29 offset0:0 offset1:2
  ds_read2_b32 v[230:231], v29 offset0:64 offset1:66
  v_add_u32 v29, 2048, v29
  v_pk_mul_f16 v59, v40, v45 op_sel:[0,0] op_sel_hi:[1,1]
  s_waitcnt lgkmcnt(11)
  v_mfma_f32_16x16x32_f16 v[72:75], v[140:143], v[52:55], v[72:75]
  ds_read_b128 v[104:107], v28 offset:5120
  v_pk_mul_f16 v60, v40, v45 op_sel:[0,1] op_sel_hi:[1,0]
  v_pk_mul_f16 v61, v40, v46 op_sel:[0,0] op_sel_hi:[1,1]
  s_waitcnt lgkmcnt(11)
  v_mfma_f32_16x16x32_f16 v[72:75], v[144:147], v[56:59], v[72:75]
  ds_read_b128 v[108:111], v28 offset:6144
  v_pk_mul_f16 v62, v40, v46 op_sel:[0,1] op_sel_hi:[1,0]
  s_waitcnt lgkmcnt(10)
  v_smfmac_f32_16x16x64_f16 v[80:83], v[224:227], v[52:59], v16
  ds_read_b128 v[148:151], v28 offset:40384
  v_pk_mul_f16 v63, v41, v44 op_sel:[0,0] op_sel_hi:[1,1]
  v_pk_mul_f16 v64, v41, v44 op_sel:[0,1] op_sel_hi:[1,0]
  s_waitcnt lgkmcnt(10)
  v_mfma_f32_16x16x32_f16 v[68:71], v[96:99], v[52:55], v[68:71]
  ds_read_b128 v[152:155], v28 offset:41408
  v_pk_mul_f16 v65, v41, v45 op_sel:[0,0] op_sel_hi:[1,1]
  s_waitcnt lgkmcnt(10)
  v_mfma_f32_16x16x32_f16 v[68:71], v[100:103], v[56:59], v[68:71]
  ds_read_b128 v[156:159], v28 offset:42432
  v_pk_mul_f16 v66, v41, v45 op_sel:[0,1] op_sel_hi:[1,0]
  v_pk_mul_f16 v67, v41, v46 op_sel:[0,0] op_sel_hi:[1,1]
  ds_write_b16 v15, v14 offset:4064
  s_waitcnt vmcnt(2)
  v_cmp_eq_u32 vcc, 0, v250
  s_nop 0
  s_and_b32 vcc_lo, vcc_lo, 0xff
  s_cbranch_scc0 L_cclr_ok
  s_mov_b32 s78, 0x40000
L_cclr:
  s_sub_u32 s78, s78, 1
  s_cbranch_scc1 L_cclr_ok
  v_lshlrev_b32 v250, 2, v0
  v_and_b32 v250, 31, v250
  buffer_load_dword v250, v250, s[64:67], 0 offen offset:128 sc1
  s_waitcnt vmcnt(0)
  v_cmp_eq_u32 vcc, 0, v250
  s_nop 0
  s_and_b32 vcc_lo, vcc_lo, 0xff
  s_cbranch_scc1 L_cclr
L_cclr_ok:
  v_lshl_add_u32 v24, v24, 7, v18
  v_lshl_add_u32 v25, v25, 7, v18
  s_mov_b32 exec_hi, 0x0000ffff
  v_lshl_add_u32 v26, v26, 7, v18
  v_lshl_add_u32 v27, v27, 7, v18
  s_mov_b32 exec_lo, 0
  s_mov_b32 exec_hi, 0xffff0000
  v_mov_b32 v27, v25
  v_mov_b32 v26, v25
  s_mov_b32 exec_hi, 0x00ff0000
  v_mov_b32 v26, v24
  s_mov_b64 exec, -1
  s_add_u32 m0, s74, -39488
  s_nop 0
  buffer_load_dwordx4 v24, s[32:35], 0 offen lds
  s_add_u32 m0, s74, -38432
  s_nop 0
  buffer_load_dwordx4 v25, s[32:35], 0 offen lds
  s_add_u32 m0, s74, -37376
  s_nop 0
  buffer_load_dwordx4 v26, s[32:35], 0 offen lds
  s_add_u32 m0, s74, -36320
  s_mov_b32 exec_hi, 0x00ffffff
  buffer_load_dwordx4 v27, s[32:35], 0 offen lds
  s_mov_b32 exec_hi, -1
  s_mov_b64 exec, 131071
  buffer_load_dword v255, v19, s[44:47], s101 offen
  s_mov_b64 exec, -1
  s_add_u32 s101, s101, 1171456
  s_sub_i32 s48, 0, s48
  s_mov_b32 s49, s48
  s_mov_b32 s97, 1
  s_mov_b32 s50, 1
  s_mov_b32 s96, 0
  s_cmp_lg_u32 s3, 7
  s_cbranch_scc1 L_nw0
  s_mov_b32 s52, s16
  s_and_b32 s53, s17, 0xffff
  s_mov_b32 s54, 3328
  s_mov_b32 s55, 0x20000
  v_lshlrev_b32 v22, 7, v0
  buffer_load_dword v255, v22, s[52:55], 0 offen
L_nw0:
  s_waitcnt lgkmcnt(11)
  v_mfma_f32_16x16x32_f16 v[76:79], v[184:187], v[52:55], v[76:79]
  ds_read_b128 v[160:163], v28 offset:43456
  v_alignbit_b32 v49, v49, v49, v13
  v_alignbit_b32 v50, v50, v50, v13
  s_waitcnt lgkmcnt(11)
  v_mfma_f32_16x16x32_f16 v[76:79], v[188:191], v[56:59], v[76:79]
  ds_read2_b32 v[232:233], v29 offset0:0 offset1:2
  ds_read2_b32 v[234:235], v29 offset0:64 offset1:66
  v_add_u32 v29, 2048, v29
  v_pk_mul_f16 v52, v41, v46 op_sel:[0,1] op_sel_hi:[1,0]
  v_pk_mul_f16 v53, v42, v44 op_sel:[0,0] op_sel_hi:[1,1]
  s_waitcnt lgkmcnt(12)
  v_mfma_f32_16x16x32_f16 v[76:79], v[192:195], v[60:63], v[76:79]
  ds_read_b128 v[112:115], v28 offset:7168
  v_pk_mul_f16 v54, v42, v44 op_sel:[0,1] op_sel_hi:[1,0]
  v_pk_mul_f16 v55, v42, v45 op_sel:[0,0] op_sel_hi:[1,1]
  s_waitcnt lgkmcnt(12)
  v_mfma_f32_16x16x32_f16 v[76:79], v[196:199], v[64:67], v[76:79]
  ds_read_b128 v[116:119], v28 offset:8192
  v_pk_mul_f16 v56, v42, v45 op_sel:[0,1] op_sel_hi:[1,0]
  v_pk_mul_f16 v57, v42, v46 op_sel:[0,0] op_sel_hi:[1,1]
  s_waitcnt lgkmcnt(11)
  v_smfmac_f32_16x16x64_f16 v[80:83], v[228:231], v[60:67], v16
  ds_read_b128 v[200:203], v31 offset:18432
  v_pk_mul_f16 v58, v42, v46 op_sel:[0,1] op_sel_hi:[1,0]
  v_pk_mul_f16 v59, v40, v48 op_sel:[0,0] op_sel_hi:[1,1]
  s_waitcnt lgkmcnt(11)
  v_mfma_f32_16x16x32_f16 v[68:71], v[104:107], v[60:63], v[68:71]
  ds_read_b128 v[204:207], v31 offset:19456
  ds_read_u16_d16_hi v32, v7 offset:32
  ds_read_u16_d16_hi v33, v7 offset:160
  s_waitcnt lgkmcnt(13)
  v_mfma_f32_16x16x32_f16 v[68:71], v[108:111], v[64:67], v[68:71]
  ds_read_b128 v[164:167], v28 offset:44480
  ds_read_u16_d16_hi v34, v7 offset:288
  ds_read_u16_d16_hi v35, v7 offset:416
  s_waitcnt lgkmcnt(14)
  v_mfma_f32_16x16x32_f16 v[72:75], v[148:151], v[60:63], v[72:75]
  ds_read_b128 v[168:171], v28 offset:45504
  ds_read_u16_d16_hi v36, v7 offset:544
  ds_read_u16_d16_hi v37, v7 offset:672
  v_mfma_f32_16x16x32_f16 v[72:75], v[152:155], v[64:67], v[72:75]
  ds_read2_b32 v[236:237], v29 offset0:0 offset1:2
  ds_read2_b32 v[238:239], v29 offset0:64 offset1:66
  v_add_u32 v29, 2048, v29
  ds_read_u16_d16_hi v38, v7 offset:800
  ds_read_u16_d16_hi v39, v7 offset:928
  s_waitcnt lgkmcnt(14)
  v_mfma_f32_16x16x32_f16 v[72:75], v[156:159], v[52:55], v[72:75]
  ds_read_b128 v[120:123], v28 offset:9216
  v_pk_mul_f16 v60, v41, v49 op_sel:[0,0] op_sel_hi:[1,1]
  v_pk_mul_f16 v61, v42, v50 op_sel:[0,0] op_sel_hi:[1,1]
  v_mfma_f32_16x16x32_f16 v[72:75], v[160:163], v[56:59], v[72:75]
  ds_read_b128 v[124:127], v28 offset:10240
  v_pk_mul_f16 v62, v40, v49 op_sel:[0,0] op_sel_hi:[1,1]
  v_pk_mul_f16 v63, v40, v49 op_sel:[0,1] op_sel_hi:[1,0]
  v_smfmac_f32_16x16x64_f16 v[80:83], v[232:235], v[52:59], v16
  ds_read_b128 v[208:211], v31 offset:20480
  v_pk_mul_f16 v64, v40, v50 op_sel:[0,0] op_sel_hi:[1,1]
  v_pk_mul_f16 v65, v40, v50 op_sel:[0,1] op_sel_hi:[1,0]
  v_mfma_f32_16x16x32_f16 v[68:71], v[112:115], v[52:55], v[68:71]
  ds_read_b128 v[212:215], v31 offset:21504
  v_pk_mul_f16 v66, v41, v50 op_sel:[0,0] op_sel_hi:[1,1]
  v_pk_mul_f16 v67, v41, v50 op_sel:[0,1] op_sel_hi:[1,0]
  v_mfma_f32_16x16x32_f16 v[68:71], v[116:119], v[56:59], v[68:71]
  s_waitcnt lgkmcnt(4)
  v_cvt_pk_f16_f32 v43, v38, v39
  v_cvt_pk_f16_f32 v40, v32, v35
  v_mfma_f32_16x16x32_f16 v[76:79], v[200:203], v[52:55], v[76:79]
  ds_read_b64_tr_b16 v[52:53], v8 offset:32
  ds_read_b64_tr_b16 v[54:55], v8 offset:544
  v_mfma_f32_16x16x32_f16 v[76:79], v[204:207], v[56:59], v[76:79]
  v_cvt_pk_f16_f32 v41, v33, v36
  v_cvt_pk_f16_f32 v42, v34, v37
  v_mfma_f32_16x16x32_f16 v[72:75], v[164:167], v[60:63], v[72:75]
  ds_write_b128 v10, v[40:43]
  v_mfma_f32_16x16x32_f16 v[72:75], v[168:171], v[64:67], v[72:75]
  v_pk_mul_f16 v56, v40, v40 op_sel:[0,0] op_sel_hi:[1,1]
  v_pk_mul_f16 v57, v41, v41 op_sel:[0,0] op_sel_hi:[1,1]
  v_smfmac_f32_16x16x64_f16 v[80:83], v[236:239], v[60:67], v16
  v_pk_mul_f16 v58, v42, v42 op_sel:[0,0] op_sel_hi:[1,1]
  v_pk_mul_f16 v59, v40, v41 op_sel:[0,0] op_sel_hi:[1,1]
  s_waitcnt lgkmcnt(6)
  v_mfma_f32_16x16x32_f16 v[68:71], v[120:123], v[60:63], v[68:71]
  ds_read_b128 v[44:47], v11
  ds_read_b128 v[48:51], v12
  s_waitcnt lgkmcnt(7)
  v_mfma_f32_16x16x32_f16 v[68:71], v[124:127], v[64:67], v[68:71]
  v_or3_b32 v15, v56, v57, v58
  s_waitcnt lgkmcnt(6)
  v_mfma_f32_16x16x32_f16 v[76:79], v[208:211], v[60:63], v[76:79]
  v_add_f32 v22, v80, v81
  v_add_f32 v23, v82, v83
  s_waitcnt lgkmcnt(5)
  v_mfma_f32_16x16x32_f16 v[76:79], v[212:215], v[64:67], v[76:79]
  v_pk_mul_f16 v60, v40, v41 op_sel:[0,1] op_sel_hi:[1,0]
  v_pk_mul_f16 v61, v40, v42 op_sel:[0,0] op_sel_hi:[1,1]
  ds_add_u32 v1, v3 offset:12
  s_branch L_grp1
L_prime:
  v_mov_b32 v68, 0
  v_mov_b32 v69, 0
  v_mov_b32 v70, 0
  v_mov_b32 v71, 0
  v_mov_b32 v72, 0
  v_mov_b32 v73, 0
  v_mov_b32 v74, 0
  v_mov_b32 v75, 0
  v_mov_b32 v76, 0
  v_mov_b32 v77, 0
  v_mov_b32 v78, 0
  v_mov_b32 v79, 0
  v_mov_b32 v80, 0
  v_mov_b32 v81, 0
  v_mov_b32 v82, 0
  v_mov_b32 v83, 0
  v_mov_b32 v22, 0
  v_mov_b32 v23, 0
  ds_read_u16_d16_hi v32, v7 offset:0
  ds_read_u16_d16_hi v33, v7 offset:128
  ds_read_u16_d16_hi v34, v7 offset:256
  ds_read_u16_d16_hi v35, v7 offset:384
  ds_read_u16_d16_hi v36, v7 offset:512
  ds_read_u16_d16_hi v37, v7 offset:640
  ds_read_u16_d16_hi v38, v7 offset:768
  ds_read_u16_d16_hi v39, v7 offset:896
  s_waitcnt lgkmcnt(0)
  v_cvt_pk_f16_f32 v43, v38, v39
  v_cvt_pk_f16_f32 v40, v32, v35
  v_cvt_pk_f16_f32 v41, v33, v36
  v_cvt_pk_f16_f32 v42, v34, v37
  ds_write_b128 v10, v[40:43]
  ds_read_b64_tr_b16 v[52:53], v8 offset:0
  ds_read_b64_tr_b16 v[54:55], v8 offset:512
  v_pk_mul_f16 v56, v40, v40 op_sel:[0,0] op_sel_hi:[1,1]
  v_pk_mul_f16 v57, v41, v41 op_sel:[0,0] op_sel_hi:[1,1]
  v_pk_mul_f16 v58, v42, v42 op_sel:[0,0] op_sel_hi:[1,1]
  v_pk_mul_f16 v59, v40, v41 op_sel:[0,0] op_sel_hi:[1,1]
  ds_read_b128 v[44:47], v11
  ds_read_b128 v[48:51], v12
  v_pk_mul_f16 v60, v40, v41 op_sel:[0,1] op_sel_hi:[1,0]
  v_pk_mul_f16 v61, v40, v42 op_sel:[0,0] op_sel_hi:[1,1]
L_cin_loop:
  s_cmp_lg_u32 s84, 0
  s_cbranch_scc1 L_pr0
  s_setprio 2
L_pr0:
  v_mfma_f32_16x16x32_f16 v[80:83], v[216:219], v[56:59], 0
  v_fmac_f32 v14, v68, v72
  v_fmac_f32 v14, v69, v73
  v_fmac_f32 v14, v70, v74
  v_fmac_f32 v14, v71, v75
  s_waitcnt lgkmcnt(2)
  v_mfma_f32_16x16x32_bf16 v[72:75], v[240:243], v[52:55], 0
  v_pk_mul_f16 v62, v40, v42 op_sel:[0,1] op_sel_hi:[1,0]
  v_pk_mul_f16 v63, v41, v42 op_sel:[0,0] op_sel_hi:[1,1]
  v_mfma_f32_16x16x32_f16 v[72:75], v[128:131], v[56:59], v[72:75]
  v_fmac_f32 v14, v76, v77
  v_fmac_f32 v14, v22, v78
  v_mfma_f32_16x16x32_f16 v[68:71], v[84:87], v[56:59], 0
  v_fmac_f32 v14, v23, v79
  v_pk_mul_f16 v64, v41, v42 op_sel:[0,1] op_sel_hi:[1,0]
  v_mfma_f32_16x16x32_bf16 v[76:79], v[244:247], v[52:55], 0
  v_pk_mul_f16 v65, v40, v43 op_sel:[0,0] op_sel_hi:[1,0]
  v_pk_mul_f16 v66, v41, v43 op_sel:[0,0] op_sel_hi:[1,0]
  v_mfma_f32_16x16x32_f16 v[76:79], v[172:175], v[56:59], v[76:79]
  v_pk_mul_f16 v67, v42, v43 op_sel:[0,0] op_sel_hi:[1,0]
  v_add_f32_dpp v14, v14, v14 row_shr:1 row_mask:0xf bank_mask:0xf
  v_mfma_f32_16x16x32_f16 v[76:79], v[176:179], v[60:63], v[76:79]
  v_mul_f16_sdwa v52, v40, v40 dst_sel:WORD_0 dst_unused:UNUSED_PAD src0_sel:WORD_0 src1_sel:WORD_1
  v_mul_f16_sdwa v53, v42, v42 dst_sel:WORD_0 dst_unused:UNUSED_PAD src0_sel:WORD_0 src1_sel:WORD_1
  v_mfma_f32_16x16x32_f16 v[76:79], v[180:183], v[64:67], v[76:79]
  v_add_f32_dpp v14, v14, v14 row_shr:2 row_mask:0xf bank_mask:0xf
  s_waitcnt lgkmcnt(0)
  v_alignbit_b32 v48, v48, v48, v13
  v_smfmac_f32_16x16x64_f16 v[80:83], v[220:223], v[60:67], v16
  v_mul_f16_sdwa v52, v41, v41 dst_sel:WORD_1 dst_unused:UNUSED_PRESERVE src0_sel:WORD_0 src1_sel:WORD_1
  v_mul_f16_sdwa v53, v43, v43 dst_sel:WORD_1 dst_unused:UNUSED_PRESERVE src0_sel:WORD_0 src1_sel:WORD_1
  v_mfma_f32_16x16x32_f16 v[68:71], v[88:91], v[60:63], v[68:71]
  v_add_f32_dpp v14, v14, v14 row_shr:4 row_mask:0xf bank_mask:0xf
  v_pk_mul_f16 v54, v40, v47 op_sel:[0,0] op_sel_hi:[1,0]
  v_mfma_f32_16x16x32_f16 v[68:71], v[92:95], v[64:67], v[68:71]
  v_pk_mul_f16 v55, v41, v47 op_sel:[0,0] op_sel_hi:[1,0]
  v_pk_mul_f16 v56, v42, v47 op_sel:[0,0] op_sel_hi:[1,0]
  v_mfma_f32_16x16x32_f16 v[72:75], v[132:135], v[60:63], v[72:75]
  v_pk_mul_f16 v57, v40, v44 op_sel:[0,0] op_sel_hi:[1,1]
  v_pk_mul_f16 v58, v40, v44 op_sel:[0,1] op_sel_hi:[1,0]
  v_mfma_f32_16x16x32_f16 v[72:75], v[136:139], v[64:67], v[72:75]
  v_pk_mul_f16 v59, v40, v45 op_sel:[0,0] op_sel_hi:[1,1]
  v_add_f32_dpp v14, v14, v14 row_shr:8 row_mask:0xf bank_mask:0xf
  v_mfma_f32_16x16x32_f16 v[72:75], v[140:143], v[52:55], v[72:75]
  v_pk_mul_f16 v60, v40, v45 op_sel:[0,1] op_sel_hi:[1,0]
  v_pk_mul_f16 v61, v40, v46 op_sel:[0,0] op_sel_hi:[1,1]
  v_mfma_f32_16x16x32_f16 v[72:75], v[144:147], v[56:59], v[72:75]
  v_add_f32_dpp v14, v14, v14 row_bcast:15 row_mask:0xa bank_mask:0xf
  v_pk_mul_f16 v62, v40, v46 op_sel:[0,1] op_sel_hi:[1,0]
  v_smfmac_f32_16x16x64_f16 v[80:83], v[224:227], v[52:59], v16
  v_pk_mul_f16 v63, v41, v44 op_sel:[0,0] op_sel_hi:[1,1]
  v_pk_mul_f16 v64, v41, v44 op_sel:[0,1] op_sel_hi:[1,0]
  v_mfma_f32_16x16x32_f16 v[68:71], v[96:99], v[52:55], v[68:71]
  v_add_f32_dpp v14, v14, v14 row_bcast:31 row_mask:0xc bank_mask:0xf
  v_pk_mul_f16 v65, v41, v45 op_sel:[0,0] op_sel_hi:[1,1]
  v_mfma_f32_16x16x32_f16 v[68:71], v[100:103], v[56:59], v[68:71]
  v_pk_mul_f16 v66, v41, v45 op_sel:[0,1] op_sel_hi:[1,0]
  v_pk_mul_f16 v67, v41, v46 op_sel:[0,0] op_sel_hi:[1,1]
  s_waitcnt vmcnt(0)
  s_cmp_le_u32 s72, 3
  s_cbranch_scc1 L_blk
  s_mov_b64 exec, 131071
  buffer_load_dword v255, v19, s[44:47], s101 offen
  s_mov_b64 exec, -1
  s_add_u32 s101, s101, 1171456
L_blk:
  s_cmp_eq_u32 s50, 0
  s_cbranch_scc1 L_blkend
  v_readlane_b32 s81, v14, 63
  v_ldexp_f32 v14, v14, s49
  v_and_b32 v14, -2, v14
  s_cmp_ge_u32 s50, 2
  s_cbranch_scc1 L_good
  s_cmp_eq_u64 s[90:91], 0
  s_cbranch_scc1 L_slow
  s_bfe_u32 s81, s81, 0x80017
  s_cmp_eq_u32 s81, 255
  s_cbranch_scc1 L_slow
L_good:
  s_mov_b32 exec_lo, 0
  s_mov_b32 exec_hi, 0x80000000
  buffer_store_dword v14, v251, s[60:63], s85 offen sc1
  s_mov_b64 exec, -1
  s_add_u32 s85, s85, 32
  s_sub_u32 s72, s72, 1
  s_cmp_eq_u32 s72, 0
  s_cbranch_scc1 L_cin_done
  s_cmp_eq_u32 s72, 1
  s_cbranch_scc1 L_lastnext
  v_lshl_add_u32 v24, v24, 7, v18
  v_lshl_add_u32 v25, v25, 7, v18
  s_mov_b32 exec_hi, 0x0000ffff
  v_lshl_add_u32 v26, v26, 7, v18
  v_lshl_add_u32 v27, v27, 7, v18
  s_mov_b32 exec_lo, 0
  s_mov_b32 exec_hi, 0xffff0000
  v_mov_b32 v27, v25
  v_mov_b32 v26, v25
  s_mov_b32 exec_hi, 0x00ff0000
  v_mov_b32 v26, v24
  s_mov_b64 exec, -1
  s_add_u32 m0, s74, 0
  s_nop 0
  buffer_load_dwordx4 v24, s[32:35], 0 offen lds
  s_add_u32 m0, s74, 1056
  s_nop 0
  buffer_load_dwordx4 v25, s[32:35], 0 offen lds
  s_add_u32 m0, s74, 2112
  s_nop 0
  buffer_load_dwordx4 v26, s[32:35], 0 offen lds
  s_add_u32 m0, s74, 3168
  s_mov_b32 exec_hi, 0x00ffffff
  buffer_load_dwordx4 v27, s[32:35], 0 offen lds
  s_mov_b32 exec_hi, -1
  s_add_u32 s94, s94, 832
  s_cmp_lg_u32 s72, s99
  s_cbranch_scc1 L_nodma
  v_mov_b32 v250, 1
  s_mov_b64 exec, 1
  buffer_atomic_add v250, v251, s[60:63], s98 offen sc0
  s_mov_b64 exec, -1
  s_mov_b32 s99, 8
  s_branch L_nodma
L_lastnext:
  s_cmp_lt_i32 s26, 0
  s_cselect_b32 s85, s85, s26
L_nodma:
  s_add_u32 s74, s74, s75
  s_sub_u32 s75, 0, s75
  s_mov_b32 s49, s48
  s_mov_b32 s97, 1
  s_cmp_eq_u32 s50, 3
  s_cbranch_scc1 L_slow2
L_blkend:
  s_mov_b32 s50, s97
  v_mfma_f32_16x16x32_f16 v[76:79], v[184:187], v[52:55], v[76:79]
  v_alignbit_b32 v49, v49, v49, v13
  v_alignbit_b32 v50, v50, v50, v13
  v_mfma_f32_16x16x32_f16 v[76:79], v[188:191], v[56:59], v[76:79]
  v_pk_mul_f16 v52, v41, v46 op_sel:[0,1] op_sel_hi:[1,0]
  v_pk_mul_f16 v53, v42, v44 op_sel:[0,0] op_sel_hi:[1,1]
  v_mfma_f32_16x16x32_f16 v[76:79], v[192:195], v[60:63], v[76:79]
  v_pk_mul_f16 v54, v42, v44 op_sel:[0,1] op_sel_hi:[1,0]
  v_pk_mul_f16 v55, v42, v45 op_sel:[0,0] op_sel_hi:[1,1]
  v_mfma_f32_16x16x32_f16 v[76:79], v[196:199], v[64:67], v[76:79]
  v_pk_mul_f16 v56, v42, v45 op_sel:[0,1] op_sel_hi:[1,0]
  v_pk_mul_f16 v57, v42, v46 op_sel:[0,0] op_sel_hi:[1,1]
  v_smfmac_f32_16x16x64_f16 v[80:83], v[228:231], v[60:67], v16
  v_pk_mul_f16 v58, v42, v46 op_sel:[0,1] op_sel_hi:[1,0]
  v_pk_mul_f16 v59, v40, v48 op_sel:[0,0] op_sel_hi:[1,1]
  v_mfma_f32_16x16x32_f16 v[68:71], v[104:107], v[60:63], v[68:71]
  ds_read_u16_d16_hi v32, v7 offset:32
  ds_read_u16_d16_hi v33, v7 offset:160
  v_mfma_f32_16x16x32_f16 v[68:71], v[108:111], v[64:67], v[68:71]
  ds_read_u16_d16_hi v34, v7 offset:288
  ds_read_u16_d16_hi v35, v7 offset:416
  v_mfma_f32_16x16x32_f16 v[72:75], v[148:151], v[60:63], v[72:75]
  ds_read_u16_d16_hi v36, v7 offset:544
  ds_read_u16_d16_hi v37, v7 offset:672
  v_mfma_f32_16x16x32_f16 v[72:75], v[152:155], v[64:67], v[72:75]
  ds_read_u16_d16_hi v38, v7 offset:800
  ds_read_u16_d16_hi v39, v7 offset:928
  v_mfma_f32_16x16x32_f16 v[72:75], v[156:159], v[52:55], v[72:75]
  v_pk_mul_f16 v60, v41, v49 op_sel:[0,0] op_sel_hi:[1,1]
  v_pk_mul_f16 v61, v42, v50 op_sel:[0,0] op_sel_hi:[1,1]
  v_mfma_f32_16x16x32_f16 v[72:75], v[160:163], v[56:59], v[72:75]
  v_pk_mul_f16 v62, v40, v49 op_sel:[0,0] op_sel_hi:[1,1]
  v_pk_mul_f16 v63, v40, v49 op_sel:[0,1] op_sel_hi:[1,0]
  v_smfmac_f32_16x16x64_f16 v[80:83], v[232:235], v[52:59], v16
  v_pk_mul_f16 v64, v40, v50 op_sel:[0,0] op_sel_hi:[1,1]
  v_pk_mul_f16 v65, v40, v50 op_sel:[0,1] op_sel_hi:[1,0]
  v_mfma_f32_16x16x32_f16 v[68:71], v[112:115], v[52:55], v[68:71]
  v_pk_mul_f16 v66, v41, v50 op_sel:[0,0] op_sel_hi:[1,1]
  v_pk_mul_f16 v67, v41, v50 op_sel:[0,1] op_sel_hi:[1,0]
  v_mfma_f32_16x16x32_f16 v[68:71], v[116:119], v[56:59], v[68:71]
  s_waitcnt lgkmcnt(0)
  v_cvt_pk_f16_f32 v43, v38, v39
  v_cvt_pk_f16_f32 v40, v32, v35
  v_mfma_f32_16x16x32_f16 v[76:79], v[200:203], v[52:55], v[76:79]
  ds_read_b64_tr_b16 v[52:53], v8 offset:32
  ds_read_b64_tr_b16 v[54:55], v8 offset:544
  v_mfma_f32_16x16x32_f16 v[76:79], v[204:207], v[56:59], v[76:79]
  v_cvt_pk_f16_f32 v41, v33, v36
  v_cvt_pk_f16_f32 v42, v34, v37
  v_mfma_f32_16x16x32_f16 v[72:75], v[164:167], v[60:63], v[72:75]
  ds_write_b128 v10, v[40:43]
  v_mfma_f32_16x16x32_f16 v[72:75], v[168:171], v[64:67], v[72:75]
  v_pk_mul_f16 v56, v40, v40 op_sel:[0,0] op_sel_hi:[1,1]
  v_pk_mul_f16 v57, v41, v41 op_sel:[0,0] op_sel_hi:[1,1]
  v_smfmac_f32_16x16x64_f16 v[80:83], v[236:239], v[60:67], v16
  v_pk_mul_f16 v58, v42, v42 op_sel:[0,0] op_sel_hi:[1,1]
  v_pk_mul_f16 v59, v40, v41 op_sel:[0,0] op_sel_hi:[1,1]
  v_mfma_f32_16x16x32_f16 v[68:71], v[120:123], v[60:63], v[68:71]
  ds_read_b128 v[44:47], v11
  ds_read_b128 v[48:51], v12
  v_mfma_f32_16x16x32_f16 v[68:71], v[124:127], v[64:67], v[68:71]
  v_or3_b32 v15, v56, v57, v58
  v_mfma_f32_16x16x32_f16 v[76:79], v[208:211], v[60:63], v[76:79]
  v_add_f32 v22, v80, v81
  v_add_f32 v23, v82, v83
  v_mfma_f32_16x16x32_f16 v[76:79], v[212:215], v[64:67], v[76:79]
  v_pk_mul_f16 v60, v40, v41 op_sel:[0,1] op_sel_hi:[1,0]
  v_pk_mul_f16 v61, v40, v42 op_sel:[0,0] op_sel_hi:[1,1]
L_grp1:
  v_mfma_f32_16x16x32_f16 v[80:83], v[216:219], v[56:59], 0
  v_mul_f32 v14, v68, v72
  v_fmac_f32 v14, v69, v73
  v_fmac_f32 v14, v70, v74
  v_fmac_f32 v14, v71, v75
  s_waitcnt lgkmcnt(3)
  v_mfma_f32_16x16x32_bf16 v[72:75], v[240:243], v[52:55], 0
  v_pk_mul_f16 v62, v40, v42 op_sel:[0,1] op_sel_hi:[1,0]
  v_pk_mul_f16 v63, v41, v42 op_sel:[0,0] op_sel_hi:[1,1]
  v_mfma_f32_16x16x32_f16 v[72:75], v[128:131], v[56:59], v[72:75]
  v_fmac_f32 v14, v76, v77
  v_fmac_f32 v14, v22, v78
  v_mfma_f32_16x16x32_f16 v[68:71], v[84:87], v[56:59], 0
  v_fmac_f32 v14, v23, v79
  v_pk_mul_f16 v64, v41, v42 op_sel:[0,1] op_sel_hi:[1,0]
  v_mfma_f32_16x16x32_bf16 v[76:79], v[244:247], v[52:55], 0
  v_pk_mul_f16 v65, v40, v43 op_sel:[0,0] op_sel_hi:[1,0]
  v_pk_mul_f16 v66, v41, v43 op_sel:[0,0] op_sel_hi:[1,0]
  v_mfma_f32_16x16x32_f16 v[76:79], v[172:175], v[56:59], v[76:79]
  v_pk_mul_f16 v67, v42, v43 op_sel:[0,0] op_sel_hi:[1,0]
  s_waitcnt lgkmcnt(0)
  v_alignbit_b32 v48, v48, v48, v13
  v_mfma_f32_16x16x32_f16 v[76:79], v[176:179], v[60:63], v[76:79]
  v_mul_f16_sdwa v52, v40, v40 dst_sel:WORD_0 dst_unused:UNUSED_PAD src0_sel:WORD_0 src1_sel:WORD_1
  v_mul_f16_sdwa v53, v42, v42 dst_sel:WORD_0 dst_unused:UNUSED_PAD src0_sel:WORD_0 src1_sel:WORD_1
  v_mfma_f32_16x16x32_f16 v[76:79], v[180:183], v[64:67], v[76:79]
  v_mul_f16_sdwa v52, v41, v41 dst_sel:WORD_1 dst_unused:UNUSED_PRESERVE src0_sel:WORD_0 src1_sel:WORD_1
  v_mul_f16_sdwa v53, v43, v43 dst_sel:WORD_1 dst_unused:UNUSED_PRESERVE src0_sel:WORD_0 src1_sel:WORD_1
  v_smfmac_f32_16x16x64_f16 v[80:83], v[220:223], v[60:67], v16
  v_pk_mul_f16 v54, v40, v47 op_sel:[0,0] op_sel_hi:[1,0]
  v_pk_mul_f16 v55, v41, v47 op_sel:[0,0] op_sel_hi:[1,0]
  v_mfma_f32_16x16x32_f16 v[68:71], v[88:91], v[60:63], v[68:71]
  v_pk_mul_f16 v56, v42, v47 op_sel:[0,0] op_sel_hi:[1,0]
  v_pk_mul_f16 v57, v40, v44 op_sel:[0,0] op_sel_hi:[1,1]
  v_mfma_f32_16x16x32_f16 v[68:71], v[92:95], v[64:67], v[68:71]
  v_pk_mul_f16 v58, v40, v44 op_sel:[0,1] op_sel_hi:[1,0]
  v_pk_mul_f16 v59, v40, v45 op_sel:[0,0] op_sel_hi:[1,1]
  v_mfma_f32_16x16x32_f16 v[72:75], v[132:135], v[60:63], v[72:75]
  v_pk_mul_f16 v60, v40, v45 op_sel:[0,1] op_sel_hi:[1,0]
  v_pk_mul_f16 v61, v40, v46 op_sel:[0,0] op_sel_hi:[1,1]
  v_mfma_f32_16x16x32_f16 v[72:75], v[136:139], v[64:67], v[72:75]
  v_pk_mul_f16 v62, v40, v46 op_sel:[0,1] op_sel_hi:[1,0]
  v_pk_mul_f16 v63, v41, v44 op_sel:[0,0] op_sel_hi:[1,1]
  v_mfma_f32_16x16x32_f16 v[72:75], v[140:143], v[52:55], v[72:75]
  v_pk_mul_f16 v64, v41, v44 op_sel:[0,1] op_sel_hi:[1,0]
  v_pk_mul_f16 v65, v41, v45 op_sel:[0,0] op_sel_hi:[1,1]
  v_mfma_f32_16x16x32_f16 v[72:75], v[144:147], v[56:59], v[72:75]
  v_pk_mul_f16 v66, v41, v45 op_sel:[0,1] op_sel_hi:[1,0]
  v_pk_mul_f16 v67, v41, v46 op_sel:[0,0] op_sel_hi:[1,1]
  v_smfmac_f32_16x16x64_f16 v[80:83], v[224:227], v[52:59], v16
  v_alignbit_b32 v49, v49, v49, v13
  v_alignbit_b32 v50, v50, v50, v13
  v_mfma_f32_16x16x32_f16 v[68:71], v[96:99], v[52:55], v[68:71]
  ds_read_u16_d16_hi v32, v7 offset:64
  ds_read_u16_d16_hi v33, v7 offset:192
  v_mfma_f32_16x16x32_f16 v[68:71], v[100:103], v[56:59], v[68:71]
  ds_read_u16_d16_hi v34, v7 offset:320
  ds_read_u16_d16_hi v35, v7 offset:448
  v_mfma_f32_16x16x32_f16 v[76:79], v[184:187], v[52:55], v[76:79]
  v_pk_mul_f16 v52, v41, v46 op_sel:[0,1] op_sel_hi:[1,0]
  v_pk_mul_f16 v53, v42, v44 op_sel:[0,0] op_sel_hi:[1,1]
  v_mfma_f32_16x16x32_f16 v[76:79], v[188:191], v[56:59], v[76:79]
  v_pk_mul_f16 v54, v42, v44 op_sel:[0,1] op_sel_hi:[1,0]
  v_pk_mul_f16 v55, v42, v45 op_sel:[0,0] op_sel_hi:[1,1]
  v_mfma_f32_16x16x32_f16 v[76:79], v[192:195], v[60:63], v[76:79]
  v_pk_mul_f16 v56, v42, v45 op_sel:[0,1] op_sel_hi:[1,0]
  v_pk_mul_f16 v57, v42, v46 op_sel:[0,0] op_sel_hi:[1,1]
  v_mfma_f32_16x16x32_f16 v[76:79], v[196:199], v[64:67], v[76:79]
  v_pk_mul_f16 v58, v42, v46 op_sel:[0,1] op_sel_hi:[1,0]
  v_pk_mul_f16 v59, v40, v48 op_sel:[0,0] op_sel_hi:[1,1]
  v_smfmac_f32_16x16x64_f16 v[80:83], v[228:231], v[60:67], v16
  ds_read_u16_d16_hi v36, v7 offset:576
  ds_read_u16_d16_hi v37, v7 offset:704
  v_mfma_f32_16x16x32_f16 v[68:71], v[104:107], v[60:63], v[68:71]
  ds_read_u16_d16_hi v38, v7 offset:832
  ds_read_u16_d16_hi v39, v7 offset:960
  v_mfma_f32_16x16x32_f16 v[68:71], v[108:111], v[64:67], v[68:71]
  v_and_b32 v15, 0x60006000, v15
  v_cmp_ne_u32 s[90:91], 0, v15
  v_mfma_f32_16x16x32_f16 v[72:75], v[148:151], v[60:63], v[72:75]
  v_pk_mul_f16 v60, v41, v49 op_sel:[0,0] op_sel_hi:[1,1]
  v_pk_mul_f16 v61, v42, v50 op_sel:[0,0] op_sel_hi:[1,1]
  v_mfma_f32_16x16x32_f16 v[72:75], v[152:155], v[64:67], v[72:75]
  v_pk_mul_f16 v62, v40, v49 op_sel:[0,0] op_sel_hi:[1,1]
  v_pk_mul_f16 v63, v40, v49 op_sel:[0,1] op_sel_hi:[1,0]
  v_mfma_f32_16x16x32_f16 v[72:75], v[156:159], v[52:55], v[72:75]
  v_pk_mul_f16 v64, v40, v50 op_sel:[0,0] op_sel_hi:[1,1]
  v_pk_mul_f16 v65, v40, v50 op_sel:[0,1] op_sel_hi:[1,0]
  v_mfma_f32_16x16x32_f16 v[72:75], v[160:163], v[56:59], v[72:75]
  v_pk_mul_f16 v66, v41, v50 op_sel:[0,0] op_sel_hi:[1,1]
  v_pk_mul_f16 v67, v41, v50 op_sel:[0,1] op_sel_hi:[1,0]
  v_smfmac_f32_16x16x64_f16 v[80:83], v[232:235], v[52:59], v16
  s_waitcnt lgkmcnt(0)
  v_cvt_pk_f16_f32 v43, v38, v39
  v_cvt_pk_f16_f32 v40, v32, v35
  v_mfma_f32_16x16x32_f16 v[68:71], v[112:115], v[52:55], v[68:71]
  v_cvt_pk_f16_f32 v41, v33, v36
  v_cvt_pk_f16_f32 v42, v34, v37
  v_mfma_f32_16x16x32_f16 v[68:71], v[116:119], v[56:59], v[68:71]
  ds_write_b128 v10, v[40:43]
  v_mfma_f32_16x16x32_f16 v[76:79], v[200:203], v[52:55], v[76:79]
  ds_read_b64_tr_b16 v[52:53], v8 offset:64
  ds_read_b64_tr_b16 v[54:55], v8 offset:576
  v_mfma_f32_16x16x32_f16 v[76:79], v[204:207], v[56:59], v[76:79]
  v_pk_mul_f16 v56, v40, v40 op_sel:[0,0] op_sel_hi:[1,1]
  v_pk_mul_f16 v57, v41, v41 op_sel:[0,0] op_sel_hi:[1,1]
  v_mfma_f32_16x16x32_f16 v[72:75], v[164:167], v[60:63], v[72:75]
  v_pk_mul_f16 v58, v42, v42 op_sel:[0,0] op_sel_hi:[1,1]
  v_pk_mul_f16 v59, v40, v41 op_sel:[0,0] op_sel_hi:[1,1]
  v_mfma_f32_16x16x32_f16 v[72:75], v[168:171], v[64:67], v[72:75]
  ds_read_b128 v[44:47], v11
  ds_read_b128 v[48:51], v12
  v_smfmac_f32_16x16x64_f16 v[80:83], v[236:239], v[60:67], v16
  v_mfma_f32_16x16x32_f16 v[68:71], v[120:123], v[60:63], v[68:71]
  v_mfma_f32_16x16x32_f16 v[68:71], v[124:127], v[64:67], v[68:71]
  v_mfma_f32_16x16x32_f16 v[76:79], v[208:211], v[60:63], v[76:79]
  s_nop 4
  v_add_f32 v22, v80, v81
  v_add_f32 v23, v82, v83
  v_mfma_f32_16x16x32_f16 v[76:79], v[212:215], v[64:67], v[76:79]
  v_pk_mul_f16 v60, v40, v41 op_sel:[0,1] op_sel_hi:[1,0]
  v_pk_mul_f16 v61, v40, v42 op_sel:[0,0] op_sel_hi:[1,1]
  s_cmp_eq_u32 s72, s96
  s_cbranch_scc1 L_htail
  v_mfma_f32_16x16x32_f16 v[80:83], v[216:219], v[56:59], 0
  v_fmac_f32 v14, v68, v72
  v_fmac_f32 v14, v69, v73
  v_fmac_f32 v14, v70, v74
  v_fmac_f32 v14, v71, v75
  s_waitcnt lgkmcnt(2)
  v_mfma_f32_16x16x32_bf16 v[72:75], v[240:243], v[52:55], 0
  v_pk_mul_f16 v62, v40, v42 op_sel:[0,1] op_sel_hi:[1,0]
  v_pk_mul_f16 v63, v41, v42 op_sel:[0,0] op_sel_hi:[1,1]
  v_mfma_f32_16x16x32_f16 v[72:75], v[128:131], v[56:59], v[72:75]
  v_fmac_f32 v14, v76, v77
  v_fmac_f32 v14, v22, v78
  v_mfma_f32_16x16x32_f16 v[68:71], v[84:87], v[56:59], 0
  v_fmac_f32 v14, v23, v79
  v_pk_mul_f16 v64, v41, v42 op_sel:[0,1] op_sel_hi:[1,0]
  v_mfma_f32_16x16x32_bf16 v[76:79], v[244:247], v[52:55], 0
  v_pk_mul_f16 v65, v40, v43 op_sel:[0,0] op_sel_hi:[1,0]
  v_pk_mul_f16 v66, v41, v43 op_sel:[0,0] op_sel_hi:[1,0]
  v_mfma_f32_16x16x32_f16 v[76:79], v[172:175], v[56:59], v[76:79]
  v_pk_mul_f16 v67, v42, v43 op_sel:[0,0] op_sel_hi:[1,0]
  s_waitcnt lgkmcnt(0)
  v_alignbit_b32 v48, v48, v48, v13
  v_mfma_f32_16x16x32_f16 v[76:79], v[176:179], v[60:63], v[76:79]
  v_mul_f16_sdwa v52, v40, v40 dst_sel:WORD_0 dst_unused:UNUSED_PAD src0_sel:WORD_0 src1_sel:WORD_1
  v_mul_f16_sdwa v53, v42, v42 dst_sel:WORD_0 dst_unused:UNUSED_PAD src0_sel:WORD_0 src1_sel:WORD_1
  v_mfma_f32_16x16x32_f16 v[76:79], v[180:183], v[64:67], v[76:79]
  v_mul_f16_sdwa v52, v41, v41 dst_sel:WORD_1 dst_unused:UNUSED_PRESERVE src0_sel:WORD_0 src1_sel:WORD_1
  v_mul_f16_sdwa v53, v43, v43 dst_sel:WORD_1 dst_unused:UNUSED_PRESERVE src0_sel:WORD_0 src1_sel:WORD_1
  v_smfmac_f32_16x16x64_f16 v[80:83], v[220:223], v[60:67], v16
  v_pk_mul_f16 v54, v40, v47 op_sel:[0,0] op_sel_hi:[1,0]
  v_pk_mul_f16 v55, v41, v47 op_sel:[0,0] op_sel_hi:[1,0]
  v_mfma_f32_16x16x32_f16 v[68:71], v[88:91], v[60:63], v[68:71]
  v_pk_mul_f16 v56, v42, v47 op_sel:[0,0] op_sel_hi:[1,0]
  v_pk_mul_f16 v57, v40, v44 op_sel:[0,0] op_sel_hi:[1,1]
  v_mfma_f32_16x16x32_f16 v[68:71], v[92:95], v[64:67], v[68:71]
  v_pk_mul_f16 v58, v40, v44 op_sel:[0,1] op_sel_hi:[1,0]
  v_pk_mul_f16 v59, v40, v45 op_sel:[0,0] op_sel_hi:[1,1]
  v_mfma_f32_16x16x32_f16 v[72:75], v[132:135], v[60:63], v[72:75]
  v_pk_mul_f16 v60, v40, v45 op_sel:[0,1] op_sel_hi:[1,0]
  v_pk_mul_f16 v61, v40, v46 op_sel:[0,0] op_sel_hi:[1,1]
  v_mfma_f32_16x16x32_f16 v[72:75], v[136:139], v[64:67], v[72:75]
  v_pk_mul_f16 v62, v40, v46 op_sel:[0,1] op_sel_hi:[1,0]
  v_pk_mul_f16 v63, v41, v44 op_sel:[0,0] op_sel_hi:[1,1]
  v_mfma_f32_16x16x32_f16 v[72:75], v[140:143], v[52:55], v[72:75]
  v_pk_mul_f16 v64, v41, v44 op_sel:[0,1] op_sel_hi:[1,0]
  v_pk_mul_f16 v65, v41, v45 op_sel:[0,0] op_sel_hi:[1,1]
  v_mfma_f32_16x16x32_f16 v[72:75], v[144:147], v[56:59], v[72:75]
  v_pk_mul_f16 v66, v41, v45 op_sel:[0,1] op_sel_hi:[1,0]
  v_pk_mul_f16 v67, v41, v46 op_sel:[0,0] op_sel_hi:[1,1]
  v_smfmac_f32_16x16x64_f16 v[80:83], v[224:227], v[52:59], v16
  v_alignbit_b32 v49, v49, v49, v13
  v_alignbit_b32 v50, v50, v50, v13
  v_mfma_f32_16x16x32_f16 v[68:71], v[96:99], v[52:55], v[68:71]
  ds_read_u16_d16_hi v32, v7 offset:96
  ds_read_u16_d16_hi v33, v7 offset:224
  v_mfma_f32_16x16x32_f16 v[68:71], v[100:103], v[56:59], v[68:71]
  ds_read_u16_d16_hi v34, v7 offset:352
  ds_read_u16_d16_hi v35, v7 offset:480
  s_cmp_lg_u32 s99, 8
  s_cbranch_scc1 L_hk
  s_waitcnt vmcnt(0)
  v_readfirstlane_b32 s81, v250
  s_mov_b32 s99, 0
  s_add_u32 s81, s81, 1
  s_cmp_ge_u32 s81, 36
  s_cbranch_scc1 L_hk
  s_add_u32 s72, s72, 1
  s_mov_b32 s26, 10240
  s_cmp_lt_u32 s81, 20
  s_cbranch_scc1 L_hkf
  s_add_u32 s81, s81, 20
  s_and_b32 s94, s81, 1
  s_lshr_b32 s81, s81, 1
  s_mov_b32 s96, 1
  s_lshl_b32 s94, s94, 6
  v_xor_b32 v18, s94, v18
  s_lshl_b32 s94, s94, 5
  s_add_u32 s26, s26, s94
L_hkf:
  s_add_u32 s81, s81, 484
  s_lshl_b32 s94, s81, 2
  s_add_u32 s26, s26, s94
  s_andn2_b32 s94, s98, 0x3fff
  s_add_u32 s26, s26, s94
  s_lshr_b32 s94, s94, 5
  s_add_u32 s94, s94, s81
  s_mul_i32 s94, s94, 104
L_hk:
  buffer_load_dwordx4 v[24:27], v17, s[28:31], s94 offen offset:0
  v_mfma_f32_16x16x32_f16 v[76:79], v[184:187], v[52:55], v[76:79]
  v_pk_mul_f16 v52, v41, v46 op_sel:[0,1] op_sel_hi:[1,0]
  v_pk_mul_f16 v53, v42, v44 op_sel:[0,0] op_sel_hi:[1,1]
  v_mfma_f32_16x16x32_f16 v[76:79], v[188:191], v[56:59], v[76:79]
  v_pk_mul_f16 v54, v42, v44 op_sel:[0,1] op_sel_hi:[1,0]
  v_pk_mul_f16 v55, v42, v45 op_sel:[0,0] op_sel_hi:[1,1]
  v_mfma_f32_16x16x32_f16 v[76:79], v[192:195], v[60:63], v[76:79]
  v_pk_mul_f16 v56, v42, v45 op_sel:[0,1] op_sel_hi:[1,0]
  v_pk_mul_f16 v57, v42, v46 op_sel:[0,0] op_sel_hi:[1,1]
  v_mfma_f32_16x16x32_f16 v[76:79], v[196:199], v[64:67], v[76:79]
  v_pk_mul_f16 v58, v42, v46 op_sel:[0,1] op_sel_hi:[1,0]
  v_pk_mul_f16 v59, v40, v48 op_sel:[0,0] op_sel_hi:[1,1]
  v_smfmac_f32_16x16x64_f16 v[80:83], v[228:231], v[60:67], v16
  ds_read_u16_d16_hi v36, v7 offset:608
  ds_read_u16_d16_hi v37, v7 offset:736
  v_mfma_f32_16x16x32_f16 v[68:71], v[104:107], v[60:63], v[68:71]
  ds_read_u16_d16_hi v38, v7 offset:864
  ds_read_u16_d16_hi v39, v7 offset:992
  v_mfma_f32_16x16x32_f16 v[68:71], v[108:111], v[64:67], v[68:71]
  v_mfma_f32_16x16x32_f16 v[72:75], v[148:151], v[60:63], v[72:75]
  v_pk_mul_f16 v60, v41, v49 op_sel:[0,0] op_sel_hi:[1,1]
  v_pk_mul_f16 v61, v42, v50 op_sel:[0,0] op_sel_hi:[1,1]
  v_mfma_f32_16x16x32_f16 v[72:75], v[152:155], v[64:67], v[72:75]
  v_pk_mul_f16 v62, v40, v49 op_sel:[0,0] op_sel_hi:[1,1]
  v_pk_mul_f16 v63, v40, v49 op_sel:[0,1] op_sel_hi:[1,0]
  v_mfma_f32_16x16x32_f16 v[72:75], v[156:159], v[52:55], v[72:75]
  v_pk_mul_f16 v64, v40, v50 op_sel:[0,0] op_sel_hi:[1,1]
  v_pk_mul_f16 v65, v40, v50 op_sel:[0,1] op_sel_hi:[1,0]
  s_cmp_lg_u32 s84, 0
  s_cbranch_scc1 L_pr110
  s_setprio 0
L_pr110:
  v_mfma_f32_16x16x32_f16 v[72:75], v[160:163], v[56:59], v[72:75]
  v_pk_mul_f16 v66, v41, v50 op_sel:[0,0] op_sel_hi:[1,1]
  v_pk_mul_f16 v67, v41, v50 op_sel:[0,1] op_sel_hi:[1,0]
  v_smfmac_f32_16x16x64_f16 v[80:83], v[232:235], v[52:59], v16
  s_waitcnt lgkmcnt(0)
  v_cvt_pk_f16_f32 v43, v38, v39
  v_cvt_pk_f16_f32 v40, v32, v35
  v_mfma_f32_16x16x32_f16 v[68:71], v[112:115], v[52:55], v[68:71]
  v_cvt_pk_f16_f32 v41, v33, v36
  v_cvt_pk_f16_f32 v42, v34, v37
  v_mfma_f32_16x16x32_f16 v[68:71], v[116:119], v[56:59], v[68:71]
  ds_write_b128 v10, v[40:43]
  v_mfma_f32_16x16x32_f16 v[76:79], v[200:203], v[52:55], v[76:79]
  ds_read_b64_tr_b16 v[52:53], v8 offset:96
  ds_read_b64_tr_b16 v[54:55], v8 offset:608
  v_mfma_f32_16x16x32_f16 v[76:79], v[204:207], v[56:59], v[76:79]
  v_pk_mul_f16 v56, v40, v40 op_sel:[0,0] op_sel_hi:[1,1]
  v_pk_mul_f16 v57, v41, v41 op_sel:[0,0] op_sel_hi:[1,1]
  v_mfma_f32_16x16x32_f16 v[72:75], v[164:167], v[60:63], v[72:75]
  v_pk_mul_f16 v58, v42, v42 op_sel:[0,0] op_sel_hi:[1,1]
  v_pk_mul_f16 v59, v40, v41 op_sel:[0,0] op_sel_hi:[1,1]
  v_mfma_f32_16x16x32_f16 v[72:75], v[168:171], v[64:67], v[72:75]
  ds_read_b128 v[44:47], v11
  ds_read_b128 v[48:51], v12
  v_smfmac_f32_16x16x64_f16 v[80:83], v[236:239], v[60:67], v16
  v_mfma_f32_16x16x32_f16 v[68:71], v[120:123], v[60:63], v[68:71]
  v_mfma_f32_16x16x32_f16 v[68:71], v[124:127], v[64:67], v[68:71]
  v_mfma_f32_16x16x32_f16 v[76:79], v[208:211], v[60:63], v[76:79]
  s_nop 4
  v_add_f32 v22, v80, v81
  v_add_f32 v23, v82, v83
  v_mfma_f32_16x16x32_f16 v[76:79], v[212:215], v[64:67], v[76:79]
  v_pk_mul_f16 v60, v40, v41 op_sel:[0,1] op_sel_hi:[1,0]
  v_pk_mul_f16 v61, v40, v42 op_sel:[0,0] op_sel_hi:[1,1]
  v_mfma_f32_16x16x32_f16 v[80:83], v[216:219], v[56:59], 0
  v_fmac_f32 v14, v68, v72
  v_fmac_f32 v14, v69, v73
  v_fmac_f32 v14, v70, v74
  v_fmac_f32 v14, v71, v75
  s_waitcnt lgkmcnt(2)
  v_mfma_f32_16x16x32_bf16 v[72:75], v[240:243], v[52:55], 0
  v_pk_mul_f16 v62, v40, v42 op_sel:[0,1] op_sel_hi:[1,0]
  v_pk_mul_f16 v63, v41, v42 op_sel:[0,0] op_sel_hi:[1,1]
  v_mfma_f32_16x16x32_f16 v[72:75], v[128:131], v[56:59], v[72:75]
  v_fmac_f32 v14, v76, v77
  v_fmac_f32 v14, v22, v78
  v_mfma_f32_16x16x32_f16 v[68:71], v[84:87], v[56:59], 0
  v_fmac_f32 v14, v23, v79
  v_pk_mul_f16 v64, v41, v42 op_sel:[0,1] op_sel_hi:[1,0]
  v_mfma_f32_16x16x32_bf16 v[76:79], v[244:247], v[52:55], 0
  v_pk_mul_f16 v65, v40, v43 op_sel:[0,0] op_sel_hi:[1,0]
  v_pk_mul_f16 v66, v41, v43 op_sel:[0,0] op_sel_hi:[1,0]
  v_mfma_f32_16x16x32_f16 v[76:79], v[172:175], v[56:59], v[76:79]
  v_pk_mul_f16 v67, v42, v43 op_sel:[0,0] op_sel_hi:[1,0]
  s_waitcnt lgkmcnt(0)
  v_alignbit_b32 v48, v48, v48, v13
  v_mfma_f32_16x16x32_f16 v[76:79], v[176:179], v[60:63], v[76:79]
  v_mul_f16_sdwa v52, v40, v40 dst_sel:WORD_0 dst_unused:UNUSED_PAD src0_sel:WORD_0 src1_sel:WORD_1
  v_mul_f16_sdwa v53, v42, v42 dst_sel:WORD_0 dst_unused:UNUSED_PAD src0_sel:WORD_0 src1_sel:WORD_1
  v_mfma_f32_16x16x32_f16 v[76:79], v[180:183], v[64:67], v[76:79]
  v_mul_f16_sdwa v52, v41, v41 dst_sel:WORD_1 dst_unused:UNUSED_PRESERVE src0_sel:WORD_0 src1_sel:WORD_1
  v_mul_f16_sdwa v53, v43, v43 dst_sel:WORD_1 dst_unused:UNUSED_PRESERVE src0_sel:WORD_0 src1_sel:WORD_1
  v_smfmac_f32_16x16x64_f16 v[80:83], v[220:223], v[60:67], v16
  v_pk_mul_f16 v54, v40, v47 op_sel:[0,0] op_sel_hi:[1,0]
  v_pk_mul_f16 v55, v41, v47 op_sel:[0,0] op_sel_hi:[1,0]
  v_mfma_f32_16x16x32_f16 v[68:71], v[88:91], v[60:63], v[68:71]
  v_pk_mul_f16 v56, v42, v47 op_sel:[0,0] op_sel_hi:[1,0]
  v_pk_mul_f16 v57, v40, v44 op_sel:[0,0] op_sel_hi:[1,1]
  v_mfma_f32_16x16x32_f16 v[68:71], v[92:95], v[64:67], v[68:71]
  v_add_u32 v7, s75, v7
  s_waitcnt vmcnt(1)
  v_pk_mul_f16 v58, v40, v44 op_sel:[0,1] op_sel_hi:[1,0]
  v_mfma_f32_16x16x32_f16 v[72:75], v[132:135], v[60:63], v[72:75]
  v_pk_mul_f16 v59, v40, v45 op_sel:[0,0] op_sel_hi:[1,1]
  v_pk_mul_f16 v60, v40, v45 op_sel:[0,1] op_sel_hi:[1,0]
  v_mfma_f32_16x16x32_f16 v[72:75], v[136:139], v[64:67], v[72:75]
  v_pk_mul_f16 v61, v40, v46 op_sel:[0,0] op_sel_hi:[1,1]
  v_pk_mul_f16 v62, v40, v46 op_sel:[0,1] op_sel_hi:[1,0]
  v_mfma_f32_16x16x32_f16 v[72:75], v[140:143], v[52:55], v[72:75]
  v_pk_mul_f16 v63, v41, v44 op_sel:[0,0] op_sel_hi:[1,1]
  v_pk_mul_f16 v64, v41, v44 op_sel:[0,1] op_sel_hi:[1,0]
  v_mfma_f32_16x16x32_f16 v[72:75], v[144:147], v[56:59], v[72:75]
  v_pk_mul_f16 v65, v41, v45 op_sel:[0,0] op_sel_hi:[1,1]
  v_pk_mul_f16 v66, v41, v45 op_sel:[0,1] op_sel_hi:[1,0]
  v_smfmac_f32_16x16x64_f16 v[80:83], v[224:227], v[52:59], v16
  v_pk_mul_f16 v67, v41, v46 op_sel:[0,0] op_sel_hi:[1,1]
  v_alignbit_b32 v49, v49, v49, v13
  v_mfma_f32_16x16x32_f16 v[68:71], v[96:99], v[52:55], v[68:71]
  v_alignbit_b32 v50, v50, v50, v13
  ds_read_u16_d16_hi v32, v7 offset:0
  v_mfma_f32_16x16x32_f16 v[68:71], v[100:103], v[56:59], v[68:71]
  ds_read_u16_d16_hi v33, v7 offset:128
  ds_read_u16_d16_hi v34, v7 offset:256
  v_mfma_f32_16x16x32_f16 v[76:79], v[184:187], v[52:55], v[76:79]
  v_pk_mul_f16 v52, v41, v46 op_sel:[0,1] op_sel_hi:[1,0]
  v_pk_mul_f16 v53, v42, v44 op_sel:[0,0] op_sel_hi:[1,1]
  v_mfma_f32_16x16x32_f16 v[76:79], v[188:191], v[56:59], v[76:79]
  v_pk_mul_f16 v54, v42, v44 op_sel:[0,1] op_sel_hi:[1,0]
  v_pk_mul_f16 v55, v42, v45 op_sel:[0,0] op_sel_hi:[1,1]
  v_mfma_f32_16x16x32_f16 v[76:79], v[192:195], v[60:63], v[76:79]
  v_pk_mul_f16 v56, v42, v45 op_sel:[0,1] op_sel_hi:[1,0]
  v_pk_mul_f16 v57, v42, v46 op_sel:[0,0] op_sel_hi:[1,1]
  v_mfma_f32_16x16x32_f16 v[76:79], v[196:199], v[64:67], v[76:79]
  v_pk_mul_f16 v58, v42, v46 op_sel:[0,1] op_sel_hi:[1,0]
  v_pk_mul_f16 v59, v40, v48 op_sel:[0,0] op_sel_hi:[1,1]
  v_smfmac_f32_16x16x64_f16 v[80:83], v[228:231], v[60:67], v16
  ds_read_u16_d16_hi v35, v7 offset:384
  ds_read_u16_d16_hi v36, v7 offset:512
  v_mfma_f32_16x16x32_f16 v[68:71], v[104:107], v[60:63], v[68:71]
  ds_read_u16_d16_hi v37, v7 offset:640
  ds_read_u16_d16_hi v38, v7 offset:768
  v_mfma_f32_16x16x32_f16 v[68:71], v[108:111], v[64:67], v[68:71]
  ds_read_u16_d16_hi v39, v7 offset:896
  s_add_u32 s81, s74, s75
  v_add_u32 v8, s81, v9
  v_mfma_f32_16x16x32_f16 v[72:75], v[148:151], v[60:63], v[72:75]
  v_pk_mul_f16 v60, v41, v49 op_sel:[0,0] op_sel_hi:[1,1]
  v_pk_mul_f16 v61, v42, v50 op_sel:[0,0] op_sel_hi:[1,1]
  v_mfma_f32_16x16x32_f16 v[72:75], v[152:155], v[64:67], v[72:75]
  v_pk_mul_f16 v62, v40, v49 op_sel:[0,0] op_sel_hi:[1,1]
  v_pk_mul_f16 v63, v40, v49 op_sel:[0,1] op_sel_hi:[1,0]
  v_mfma_f32_16x16x32_f16 v[72:75], v[156:159], v[52:55], v[72:75]
  v_pk_mul_f16 v64, v40, v50 op_sel:[0,0] op_sel_hi:[1,1]
  v_pk_mul_f16 v65, v40, v50 op_sel:[0,1] op_sel_hi:[1,0]
  v_mfma_f32_16x16x32_f16 v[72:75], v[160:163], v[56:59], v[72:75]
  v_pk_mul_f16 v66, v41, v50 op_sel:[0,0] op_sel_hi:[1,1]
  v_pk_mul_f16 v67, v41, v50 op_sel:[0,1] op_sel_hi:[1,0]
  v_smfmac_f32_16x16x64_f16 v[80:83], v[232:235], v[52:59], v16
  s_waitcnt lgkmcnt(0)
  v_cvt_pk_f16_f32 v43, v38, v39
  v_cvt_pk_f16_f32 v40, v32, v35
  v_mfma_f32_16x16x32_f16 v[68:71], v[112:115], v[52:55], v[68:71]
  v_cvt_pk_f16_f32 v41, v33, v36
  v_cvt_pk_f16_f32 v42, v34, v37
  v_mfma_f32_16x16x32_f16 v[68:71], v[116:119], v[56:59], v[68:71]
  ds_write_b128 v10, v[40:43]
  v_mfma_f32_16x16x32_f16 v[76:79], v[200:203], v[52:55], v[76:79]
  ds_read_b64_tr_b16 v[52:53], v8 offset:0
  ds_read_b64_tr_b16 v[54:55], v8 offset:512
  v_mfma_f32_16x16x32_f16 v[76:79], v[204:207], v[56:59], v[76:79]
  v_pk_mul_f16 v56, v40, v40 op_sel:[0,0] op_sel_hi:[1,1]
  v_pk_mul_f16 v57, v41, v41 op_sel:[0,0] op_sel_hi:[1,1]
  v_mfma_f32_16x16x32_f16 v[72:75], v[164:167], v[60:63], v[72:75]
  v_pk_mul_f16 v58, v42, v42 op_sel:[0,0] op_sel_hi:[1,1]
  v_pk_mul_f16 v59, v40, v41 op_sel:[0,0] op_sel_hi:[1,1]
  v_mfma_f32_16x16x32_f16 v[72:75], v[168:171], v[64:67], v[72:75]
  ds_read_b128 v[44:47], v11
  ds_read_b128 v[48:51], v12
  v_smfmac_f32_16x16x64_f16 v[80:83], v[236:239], v[60:67], v16
  v_mfma_f32_16x16x32_f16 v[68:71], v[120:123], v[60:63], v[68:71]
  v_mfma_f32_16x16x32_f16 v[68:71], v[124:127], v[64:67], v[68:71]
  v_mfma_f32_16x16x32_f16 v[76:79], v[208:211], v[60:63], v[76:79]
  s_nop 4
  v_add_f32 v22, v80, v81
  v_add_f32 v23, v82, v83
  v_mfma_f32_16x16x32_f16 v[76:79], v[212:215], v[64:67], v[76:79]
  v_pk_mul_f16 v60, v40, v41 op_sel:[0,1] op_sel_hi:[1,0]
  v_pk_mul_f16 v61, v40, v42 op_sel:[0,0] op_sel_hi:[1,1]
  s_cmp_lg_u32 s72, 1
  s_cbranch_scc1 L_cin_loop
  v_fmac_f32 v14, v68, v72
  v_fmac_f32 v14, v69, v73
  v_fmac_f32 v14, v70, v74
  v_fmac_f32 v14, v71, v75
  v_fmac_f32 v14, v76, v77
  v_fmac_f32 v14, v22, v78
  v_fmac_f32 v14, v23, v79
  s_nop 1
  v_add_f32_dpp v14, v14, v14 row_shr:1 row_mask:0xf bank_mask:0xf
  s_nop 1
  v_add_f32_dpp v14, v14, v14 row_shr:2 row_mask:0xf bank_mask:0xf
  s_nop 1
  v_add_f32_dpp v14, v14, v14 row_shr:4 row_mask:0xf bank_mask:0xf
  s_nop 1
  v_add_f32_dpp v14, v14, v14 row_shr:8 row_mask:0xf bank_mask:0xf
  s_nop 1
  v_add_f32_dpp v14, v14, v14 row_bcast:15 row_mask:0xa bank_mask:0xf
  s_nop 1
  v_add_f32_dpp v14, v14, v14 row_bcast:31 row_mask:0xc bank_mask:0xf
  s_branch L_blk
L_htail:
  v_fmac_f32 v14, v68, v72
  v_fmac_f32 v14, v69, v73
  v_fmac_f32 v14, v70, v74
  v_fmac_f32 v14, v71, v75
  v_fmac_f32 v14, v76, v77
  v_fmac_f32 v14, v22, v78
  v_fmac_f32 v14, v23, v79
  s_nop 1
  v_add_f32_dpp v14, v14, v14 row_shr:1 row_mask:0xf bank_mask:0xf
  s_nop 1
  v_add_f32_dpp v14, v14, v14 row_shr:2 row_mask:0xf bank_mask:0xf
  s_nop 1
  v_add_f32_dpp v14, v14, v14 row_shr:4 row_mask:0xf bank_mask:0xf
  s_nop 1
  v_add_f32_dpp v14, v14, v14 row_shr:8 row_mask:0xf bank_mask:0xf
  s_nop 1
  v_add_f32_dpp v14, v14, v14 row_bcast:15 row_mask:0xa bank_mask:0xf
  s_nop 1
  v_add_f32_dpp v14, v14, v14 row_bcast:31 row_mask:0xc bank_mask:0xf
  v_add_u32 v7, s75, v7
  s_branch L_blk
L_slow:
  v_subrev_u32 v7, s75, v7
L_slow2:
  v_lshlrev_b32 v22, 1, v0
  v_add_u32 v23, s74, v22
  s_mul_i32 s81, s3, 4224
  s_add_u32 s81, s81, 1024
  v_add_u32 v22, s81, v22
  v_add_u32 v8, s81, v9
L_csync10:
  ds_read_b32 v4, v2 offset:12
  s_waitcnt lgkmcnt(0)
  v_cmp_gt_u32 vcc, 8, v4
  s_cbranch_vccnz L_csync10
  ds_read_u16 v52, v23 offset:0
  ds_read_u16 v53, v23 offset:128
  ds_read_u16 v54, v23 offset:256
  ds_read_u16 v55, v23 offset:384
  ds_read_u16 v56, v23 offset:512
  ds_read_u16 v57, v23 offset:640
  ds_read_u16 v58, v23 offset:768
  ds_read_u16 v59, v23 offset:896
  ds_read_u16 v60, v23 offset:1056
  ds_read_u16 v61, v23 offset:1184
  ds_read_u16 v62, v23 offset:1312
  ds_read_u16 v63, v23 offset:1440
  ds_read_u16 v64, v23 offset:1568
  ds_read_u16 v65, v23 offset:1696
  ds_read_u16 v66, v23 offset:1824
  ds_read_u16 v67, v23 offset:1952
  ds_read_u16 v68, v23 offset:2112
  ds_read_u16 v69, v23 offset:2240
  ds_read_u16 v70, v23 offset:2368
  ds_read_u16 v71, v23 offset:2496
  ds_read_u16 v72, v23 offset:2624
  ds_read_u16 v73, v23 offset:2752
  ds_read_u16 v74, v23 offset:2880
  ds_read_u16 v75, v23 offset:3008
  ds_read_u16 v76, v23 offset:3168
  ds_read_u16 v77, v23 offset:3296
  ds_read_u16 v78, v23 offset:3424
  ds_read_u16 v79, v23 offset:3552
  ds_read_u16 v80, v23 offset:3680
  ds_read_u16 v81, v23 offset:3808
  ds_read_u16 v82, v23 offset:3936
  s_waitcnt lgkmcnt(14)
  v_lshlrev_b32 v52, 16, v52
  v_lshlrev_b32 v53, 16, v53
  v_lshlrev_b32 v54, 16, v54
  v_lshlrev_b32 v55, 16, v55
  v_lshlrev_b32 v56, 16, v56
  v_lshlrev_b32 v57, 16, v57
  v_lshlrev_b32 v58, 16, v58
  v_lshlrev_b32 v59, 16, v59
  v_lshlrev_b32 v60, 16, v60
  v_lshlrev_b32 v61, 16, v61
  v_lshlrev_b32 v62, 16, v62
  v_lshlrev_b32 v63, 16, v63
  v_lshlrev_b32 v64, 16, v64
  v_lshlrev_b32 v65, 16, v65
  v_lshlrev_b32 v66, 16, v66
  v_lshlrev_b32 v67, 16, v67
  v_lshlrev_b32 v68, 16, v68
  s_waitcnt lgkmcnt(13)
  v_lshlrev_b32 v69, 16, v69
  s_waitcnt lgkmcnt(12)
  v_lshlrev_b32 v70, 16, v70
  s_waitcnt lgkmcnt(11)
  v_lshlrev_b32 v71, 16, v71
  s_waitcnt lgkmcnt(10)
  v_lshlrev_b32 v72, 16, v72
  s_waitcnt lgkmcnt(9)
  v_lshlrev_b32 v73, 16, v73
  s_waitcnt lgkmcnt(8)
  v_lshlrev_b32 v74, 16, v74
  s_waitcnt lgkmcnt(7)
  v_lshlrev_b32 v75, 16, v75
  s_waitcnt lgkmcnt(6)
  v_lshlrev_b32 v76, 16, v76
  s_waitcnt lgkmcnt(5)
  v_lshlrev_b32 v77, 16, v77
  s_waitcnt lgkmcnt(4)
  v_lshlrev_b32 v78, 16, v78
  s_waitcnt lgkmcnt(3)
  v_lshlrev_b32 v79, 16, v79
  s_waitcnt lgkmcnt(2)
  v_lshlrev_b32 v80, 16, v80
  s_waitcnt lgkmcnt(1)
  v_lshlrev_b32 v81, 16, v81
  s_waitcnt lgkmcnt(0)
  v_lshlrev_b32 v82, 16, v82
  v_max3_f32 v14, abs(v52), abs(v53), abs(v54)
  v_max3_f32 v14, v14, abs(v55), abs(v56)
  v_max3_f32 v14, v14, abs(v57), abs(v58)
  v_max3_f32 v14, v14, abs(v59), abs(v60)
  v_max3_f32 v14, v14, abs(v61), abs(v62)
  v_max3_f32 v14, v14, abs(v63), abs(v64)
  v_max3_f32 v14, v14, abs(v65), abs(v66)
  v_max3_f32 v14, v14, abs(v67), abs(v68)
  v_max3_f32 v14, v14, abs(v69), abs(v70)
  v_max3_f32 v14, v14, abs(v71), abs(v72)
  v_max3_f32 v14, v14, abs(v73), abs(v74)
  v_max3_f32 v14, v14, abs(v75), abs(v76)
  v_max3_f32 v14, v14, abs(v77), abs(v78)
  v_max3_f32 v14, v14, abs(v79), abs(v80)
  v_max3_f32 v14, v14, abs(v81), abs(v82)
  s_nop 1
  v_max_u32_dpp v14, v14, v14 row_shr:1 row_mask:0xf bank_mask:0xf
  s_nop 1
  v_max_u32_dpp v14, v14, v14 row_shr:2 row_mask:0xf bank_mask:0xf
  s_nop 1
  v_max_u32_dpp v14, v14, v14 row_shr:4 row_mask:0xf bank_mask:0xf
  s_nop 1
  v_max_u32_dpp v14, v14, v14 row_shr:8 row_mask:0xf bank_mask:0xf
  s_nop 1
  v_max_u32_dpp v14, v14, v14 row_bcast:15 row_mask:0xa bank_mask:0xf
  s_nop 1
  v_max_u32_dpp v14, v14, v14 row_bcast:31 row_mask:0xc bank_mask:0xf
  s_nop 0
  v_readlane_b32 s81, v14, 63
  s_nop 0
  s_lshr_b32 s81, s81, 23
  s_sub_i32 s81, 134, s81
  s_cmp_le_u32 s81, 9
  s_cselect_b32 s97, 2, 3
  s_min_i32 s81, s81, 16
  s_lshl_b32 s49, s81, 2
  s_sub_i32 s49, s48, s49
  s_add_i32 s81, s81, 127
  s_lshl_b32 s81, s81, 23
  v_mov_b32 v83, s81
  v_mul_f32 v52, s81, v52
  v_mul_f32 v53, s81, v53
  v_mul_f32 v54, s81, v54
  v_mul_f32 v55, s81, v55
  v_mul_f32 v56, s81, v56
  v_mul_f32 v57, s81, v57
  v_mul_f32 v58, s81, v58
  v_mul_f32 v59, s81, v59
  v_mul_f32 v60, s81, v60
  v_mul_f32 v61, s81, v61
  v_mul_f32 v62, s81, v62
  v_mul_f32 v63, s81, v63
  v_mul_f32 v64, s81, v64
  v_mul_f32 v65, s81, v65
  v_mul_f32 v66, s81, v66
  v_mul_f32 v67, s81, v67
  v_mul_f32 v68, s81, v68
  v_mul_f32 v69, s81, v69
  v_mul_f32 v70, s81, v70
  v_mul_f32 v71, s81, v71
  v_mul_f32 v72, s81, v72
  v_mul_f32 v73, s81, v73
  v_mul_f32 v74, s81, v74
  v_mul_f32 v75, s81, v75
  v_mul_f32 v76, s81, v76
  v_mul_f32 v77, s81, v77
  v_mul_f32 v78, s81, v78
  v_mul_f32 v79, s81, v79
  v_mul_f32 v80, s81, v80
  v_mul_f32 v81, s81, v81
  v_mul_f32 v82, s81, v82
  ds_write_b16_d16_hi v23, v52 offset:0
  ds_write_b16_d16_hi v23, v53 offset:128
  ds_write_b16_d16_hi v23, v54 offset:256
  ds_write_b16_d16_hi v23, v55 offset:384
  ds_write_b16_d16_hi v23, v56 offset:512
  ds_write_b16_d16_hi v23, v57 offset:640
  ds_write_b16_d16_hi v23, v58 offset:768
  ds_write_b16_d16_hi v23, v59 offset:896
  ds_write_b16_d16_hi v23, v60 offset:1056
  ds_write_b16_d16_hi v23, v61 offset:1184
  ds_write_b16_d16_hi v23, v62 offset:1312
  ds_write_b16_d16_hi v23, v63 offset:1440
  ds_write_b16_d16_hi v23, v64 offset:1568
  ds_write_b16_d16_hi v23, v65 offset:1696
  ds_write_b16_d16_hi v23, v66 offset:1824
  ds_write_b16_d16_hi v23, v67 offset:1952
  ds_write_b16_d16_hi v23, v68 offset:2112
  ds_write_b16_d16_hi v23, v69 offset:2240
  ds_write_b16_d16_hi v23, v70 offset:2368
  ds_write_b16_d16_hi v23, v71 offset:2496
  ds_write_b16_d16_hi v23, v72 offset:2624
  ds_write_b16_d16_hi v23, v73 offset:2752
  ds_write_b16_d16_hi v23, v74 offset:2880
  ds_write_b16_d16_hi v23, v75 offset:3008
  ds_write_b16_d16_hi v23, v76 offset:3168
  ds_write_b16_d16_hi v23, v77 offset:3296
  ds_write_b16_d16_hi v23, v78 offset:3424
  ds_write_b16_d16_hi v23, v79 offset:3552
  ds_write_b16_d16_hi v23, v80 offset:3680
  ds_write_b16_d16_hi v23, v81 offset:3808
  ds_write_b16_d16_hi v23, v82 offset:3936
  v_mul_f32 v52, s81, v52
  v_mul_f32 v53, s81, v53
  v_mul_f32 v54, s81, v54
  v_mul_f32 v55, s81, v55
  v_mul_f32 v56, s81, v56
  v_mul_f32 v57, s81, v57
  v_mul_f32 v58, s81, v58
  v_mul_f32 v59, s81, v59
  v_mul_f32 v60, s81, v60
  v_mul_f32 v61, s81, v61
  v_mul_f32 v62, s81, v62
  v_mul_f32 v63, s81, v63
  v_mul_f32 v64, s81, v64
  v_mul_f32 v65, s81, v65
  v_mul_f32 v66, s81, v66
  v_mul_f32 v67, s81, v67
  v_mul_f32 v68, s81, v68
  v_mul_f32 v69, s81, v69
  v_mul_f32 v70, s81, v70
  v_mul_f32 v71, s81, v71
  v_mul_f32 v72, s81, v72
  v_mul_f32 v73, s81, v73
  v_mul_f32 v74, s81, v74
  v_mul_f32 v75, s81, v75
  v_mul_f32 v76, s81, v76
  v_mul_f32 v77, s81, v77
  v_mul_f32 v78, s81, v78
  v_mul_f32 v79, s81, v79
  v_mul_f32 v80, s81, v80
  v_mul_f32 v81, s81, v81
  v_mul_f32 v82, s81, v82
  v_mul_f32 v83, s81, v83
  ds_write_b16_d16_hi v22, v52 offset:0
  ds_write_b16_d16_hi v22, v53 offset:128
  ds_write_b16_d16_hi v22, v54 offset:256
  ds_write_b16_d16_hi v22, v55 offset:384
  ds_write_b16_d16_hi v22, v56 offset:512
  ds_write_b16_d16_hi v22, v57 offset:640
  ds_write_b16_d16_hi v22, v58 offset:768
  ds_write_b16_d16_hi v22, v59 offset:896
  ds_write_b16_d16_hi v22, v60 offset:1056
  ds_write_b16_d16_hi v22, v61 offset:1184
  ds_write_b16_d16_hi v22, v62 offset:1312
  ds_write_b16_d16_hi v22, v63 offset:1440
  ds_write_b16_d16_hi v22, v64 offset:1568
  ds_write_b16_d16_hi v22, v65 offset:1696
  ds_write_b16_d16_hi v22, v66 offset:1824
  ds_write_b16_d16_hi v22, v67 offset:1952
  ds_write_b16_d16_hi v22, v68 offset:2112
  ds_write_b16_d16_hi v22, v69 offset:2240
  ds_write_b16_d16_hi v22, v70 offset:2368
  ds_write_b16_d16_hi v22, v71 offset:2496
  ds_write_b16_d16_hi v22, v72 offset:2624
  ds_write_b16_d16_hi v22, v73 offset:2752
  ds_write_b16_d16_hi v22, v74 offset:2880
  ds_write_b16_d16_hi v22, v75 offset:3008
  ds_write_b16_d16_hi v22, v76 offset:3168
  ds_write_b16_d16_hi v22, v77 offset:3296
  ds_write_b16_d16_hi v22, v78 offset:3424
  ds_write_b16_d16_hi v22, v79 offset:3552
  ds_write_b16_d16_hi v22, v80 offset:3680
  ds_write_b16_d16_hi v22, v81 offset:3808
  ds_write_b16_d16_hi v22, v82 offset:3936
  ds_write_b16_d16_hi v22, v83 offset:4064
  s_mov_b32 s50, 0
  s_waitcnt lgkmcnt(0)
  s_branch L_prime
L_cin_done:
  s_endpgm
L_rem:
  s_lshr_b32 s84, s3, 2
  s_and_b32 s68, s2, 7
  s_lshl_b32 s68, s68, 3
  s_add_u32 s68, s68, s3
  s_mul_i32 s68, s68, 6656
  s_lshl_b32 s76, s3, 14
  v_lshlrev_b32 v248, 4, v0
  v_lshrrev_b32 v246, 4, v0
  v_lshrrev_b32 v247, 3, v0
  v_mul_u32_u24 v13, 3328, v247
  v_and_b32 v247, 2, v247
  s_and_b32 s69, s3, 1
  s_lshl_b32 s69, s69, 2
  v_or_b32 v247, s69, v247
  v_and_b32 v9, 7, v0
  v_xor_b32 v247, v247, v9
  v_lshl_add_u32 v13, v247, 4, v13
  s_mul_i32 s74, s3, 26624
  s_add_u32 s74, s74, 3200
  s_lshl_b32 s75, s3, 10
  s_add_u32 s75, s75, 131072
  s_waitcnt lgkmcnt(0)
  s_mov_b32 s28, s4
  s_and_b32 s29, s5, 0xffff
  s_mov_b32 s30, 425984
  s_mov_b32 s31, 0x20000
  s_add_u32 m0, s76, 8192
  s_nop 0
  buffer_load_dwordx4 v248, s[28:31], s68 offen lds
  s_add_u32 s68, s68, 1024
  s_add_u32 m0, s76, 9216
  s_nop 0
  buffer_load_dwordx4 v248, s[28:31], s68 offen lds
  s_add_u32 s68, s68, 1024
  s_add_u32 m0, s76, 10240
  s_nop 0
  buffer_load_dwordx4 v248, s[28:31], s68 offen lds
  s_add_u32 s68, s68, 1024
  s_add_u32 m0, s76, 11264
  s_nop 0
  buffer_load_dwordx4 v248, s[28:31], s68 offen lds
  s_add_u32 s68, s68, 1024
  s_add_u32 m0, s76, 12288
  s_nop 0
  buffer_load_dwordx4 v248, s[28:31], s68 offen lds
  s_add_u32 s68, s68, 1024
  s_add_u32 m0, s76, 13312
  s_nop 0
  buffer_load_dwordx4 v248, s[28:31], s68 offen lds
  s_add_u32 s68, s68, 1024
  s_add_u32 m0, s76, 14336
  s_nop 0
  buffer_load_dwordx4 v248, s[28:31], s68 offen lds
  s_add_u32 s68, s68, 1024
  s_mov_b32 s44, s12
  s_and_b32 s45, s13, 0xffff
  s_mov_b32 s46, 5537792
  s_mov_b32 s47, 0x20000
  s_add_u32 m0, s75, 0
  s_nop 0
  buffer_load_dwordx4 v13, s[44:47], s74 offen lds
  s_add_u32 s74, s74, 212992
  s_mov_b32 s60, s24
  s_and_b32 s61, s25, 0xffff
  s_mov_b32 s62, 268435456
  s_mov_b32 s63, 0x20000
  s_mov_b32 s64, s22
  s_and_b32 s65, s23, 0xffff
  s_mov_b32 s66, 256
  s_mov_b32 s67, 0x20000
  v_mov_b32 v64, -1
  v_mov_b32 v65, -1
  v_mov_b32 v66, -1
  v_mov_b32 v67, -1
  s_and_b32 s70, s2, 7
  s_lshl_b32 s68, s70, 3
  s_add_u32 s68, s68, s3
  s_lshl_b32 s68, s68, 11
  s_lshl_b32 s70, s70, 2
  buffer_store_dwordx4 v[64:67], v248, s[60:63], s68 offen sc1
  buffer_store_dwordx4 v[64:67], v248, s[60:63], s68 offen offset:1024 sc1
  s_mov_b32 s48, s14
  s_and_b32 s49, s15, 0xffff
  s_mov_b32 s50, 3328
  s_mov_b32 s51, 0x20000
  s_mov_b32 s52, s16
  s_and_b32 s53, s17, 0xffff
  s_mov_b32 s54, 3328
  s_mov_b32 s55, 0x20000
  s_mov_b32 s32, s6
  s_and_b32 s33, s7, 0xffff
  s_mov_b32 s34, 12800000
  s_mov_b32 s35, 0x20000
  v_xor_b32 v248, v9, v246
  v_lshlrev_b32 v14, 4, v248
  v_xor_b32 v15, 64, v14
  v_bfe_u32 v247, v0, 2, 2
  v_lshl_add_u32 v248, v246, 3, v247
  v_lshlrev_b32 v248, 7, v248
  v_and_b32 v247, 3, v0
  v_lshl_add_u32 v248, v247, 3, v248
  v_add_u32 v248, 131072, v248
  v_bfe_u32 v247, v0, 3, 2
  v_lshl_add_u32 v1, v247, 5, v248
  v_xor_b32 v2, 32, v1
  v_xor_b32 v7, 64, v1
  v_xor_b32 v8, 96, v1
  v_and_b32 v248, 15, v0
  v_lshlrev_b32 v248, 7, v248
  v_bfe_u32 v247, v0, 1, 3
  v_xor_b32 v247, v247, v246
  v_lshl_add_u32 v248, v247, 4, v248
  v_add_u32 v11, s76, v248
  v_xor_b32 v12, 64, v11
  v_lshrrev_b32 v247, 3, v0
  v_lshl_add_u32 v248, v9, 3, v247
  v_mul_u32_u24 v248, 104, v248
  v_add_u32 v248, s76, v248
  v_mov_b32 v240, 0xc0135761
  v_mov_b32 v241, 0xc0135761
  v_mov_b32 v242, 0xbdd2d3e8
  v_mov_b32 v243, 0xbdd2d3e8
  v_mov_b32 v244, 0x71800000
  v_mov_b32 v160, 0
  v_mov_b32 v161, 0
  v_mov_b32 v162, 0
  v_mov_b32 v163, 0
  v_mov_b32 v164, 0
  v_mov_b32 v165, 0
  v_mov_b32 v166, 0
  v_mov_b32 v167, 0
  v_mov_b32 v168, 0
  v_mov_b32 v169, 0
  v_mov_b32 v170, 0
  v_mov_b32 v171, 0
  v_mov_b32 v172, 0
  v_mov_b32 v173, 0
  v_mov_b32 v174, 0
  v_mov_b32 v175, 0
  v_mov_b32 v176, 0
  v_mov_b32 v177, 0
  v_mov_b32 v178, 0
  v_mov_b32 v179, 0
  v_mov_b32 v180, 0
  v_mov_b32 v181, 0
  v_mov_b32 v182, 0
  v_mov_b32 v183, 0
  v_mov_b32 v184, 0
  v_mov_b32 v185, 0
  v_mov_b32 v186, 0
  v_mov_b32 v187, 0
  v_mov_b32 v188, 0
  v_mov_b32 v189, 0
  v_mov_b32 v190, 0
  v_mov_b32 v191, 0
  v_mov_b32 v192, 0
  v_mov_b32 v193, 0
  v_mov_b32 v194, 0
  v_mov_b32 v195, 0
  v_mov_b32 v196, 0
  v_mov_b32 v197, 0
  v_mov_b32 v198, 0
  v_mov_b32 v199, 0
  v_mov_b32 v200, 0
  v_mov_b32 v201, 0
  v_mov_b32 v202, 0
  v_mov_b32 v203, 0
  v_mov_b32 v204, 0
  v_mov_b32 v205, 0
  v_mov_b32 v206, 0
  v_mov_b32 v207, 0
  v_mov_b32 v208, 0
  v_mov_b32 v209, 0
  v_mov_b32 v210, 0
  v_mov_b32 v211, 0
  v_mov_b32 v212, 0
  v_mov_b32 v213, 0
  v_mov_b32 v214, 0
  v_mov_b32 v215, 0
  v_mov_b32 v216, 0
  v_mov_b32 v217, 0
  v_mov_b32 v218, 0
  v_mov_b32 v219, 0
  v_mov_b32 v220, 0
  v_mov_b32 v221, 0
  v_mov_b32 v222, 0
  v_mov_b32 v223, 0
  s_waitcnt vmcnt(0)
  ds_read_b64 v[32:33], v248 offset:8192
  ds_read_b64 v[34:35], v248 offset:8200
  ds_read_b64 v[36:37], v248 offset:8208
  ds_read_b64 v[38:39], v248 offset:8216
  ds_read_b64 v[40:41], v248 offset:8224
  ds_read_b64 v[42:43], v248 offset:8232
  ds_read_b64 v[44:45], v248 offset:8240
  ds_read_b64 v[46:47], v248 offset:8248
  ds_read_b64 v[48:49], v248 offset:8256
  ds_read_b64 v[50:51], v248 offset:8264
  ds_read_b64 v[52:53], v248 offset:8272
  ds_read_b64 v[54:55], v248 offset:8280
  ds_read_b64 v[56:57], v248 offset:8288
  v_mov_b32 v24, 0
  v_mov_b32 v25, 0
  v_mov_b32 v26, 0
  v_mov_b32 v27, 0
  v_mov_b32 v28, 0
  v_mov_b32 v29, 0
  v_mov_b32 v30, 0
  v_mov_b32 v31, 0
  v_mov_b32 v58, 0x7f000000
  v_mov_b32 v59, 0x7f000000
  s_waitcnt lgkmcnt(12)
  v_lshlrev_b32 v32, 7, v32
  s_nop 1
  v_add_u32_dpp v24, v32, v14 row_newbcast:0 row_mask:0xf bank_mask:0x3
  v_add_u32_dpp v25, v32, v15 row_newbcast:1 row_mask:0xf bank_mask:0x3
  v_add_u32_dpp v26, v32, v14 row_newbcast:2 row_mask:0xf bank_mask:0x3
  v_add_u32_dpp v27, v32, v15 row_newbcast:3 row_mask:0xf bank_mask:0x3
  v_add_u32_dpp v24, v32, v14 row_newbcast:8 row_mask:0xf bank_mask:0xc
  v_add_u32_dpp v25, v32, v15 row_newbcast:9 row_mask:0xf bank_mask:0xc
  v_add_u32_dpp v26, v32, v14 row_newbcast:10 row_mask:0xf bank_mask:0xc
  v_add_u32_dpp v27, v32, v15 row_newbcast:11 row_mask:0xf bank_mask:0xc
  s_add_u32 m0, s76, 0
  s_nop 0
  buffer_load_dwordx4 v24, s[32:35], 0 offen lds
  s_add_u32 m0, s76, 1024
  s_nop 0
  buffer_load_dwordx4 v25, s[32:35], 0 offen lds
  s_add_u32 m0, s76, 2048
  s_nop 0
  buffer_load_dwordx4 v26, s[32:35], 0 offen lds
  s_add_u32 m0, s76, 3072
  s_nop 0
  buffer_load_dwordx4 v27, s[32:35], 0 offen lds
  v_add_u32_dpp v28, v32, v14 row_newbcast:4 row_mask:0xf bank_mask:0x3
  v_add_u32_dpp v29, v32, v15 row_newbcast:5 row_mask:0xf bank_mask:0x3
  v_add_u32_dpp v30, v32, v14 row_newbcast:6 row_mask:0xf bank_mask:0x3
  v_add_u32_dpp v31, v32, v15 row_newbcast:7 row_mask:0xf bank_mask:0x3
  v_add_u32_dpp v28, v32, v14 row_newbcast:12 row_mask:0xf bank_mask:0xc
  v_add_u32_dpp v29, v32, v15 row_newbcast:13 row_mask:0xf bank_mask:0xc
  v_add_u32_dpp v30, v32, v14 row_newbcast:14 row_mask:0xf bank_mask:0xc
  v_add_u32_dpp v31, v32, v15 row_newbcast:15 row_mask:0xf bank_mask:0xc
  s_add_u32 m0, s76, 4096
  s_nop 0
  buffer_load_dwordx4 v28, s[32:35], 0 offen lds
  s_add_u32 m0, s76, 5120
  s_nop 0
  buffer_load_dwordx4 v29, s[32:35], 0 offen lds
  s_add_u32 m0, s76, 6144
  s_nop 0
  buffer_load_dwordx4 v30, s[32:35], 0 offen lds
  s_add_u32 m0, s76, 7168
  s_nop 0
  buffer_load_dwordx4 v31, s[32:35], 0 offen lds
  s_add_u32 m0, s75, 8192
  s_nop 0
  buffer_load_dwordx4 v13, s[44:47], s74 offen lds
  s_add_u32 s74, s74, 212992
  s_waitcnt lgkmcnt(0)
  v_lshlrev_b32 v57, 7, v57
  v_lshlrev_b32 v56, 7, v56
  v_lshlrev_b32 v55, 7, v55
  v_lshlrev_b32 v54, 7, v54
  v_lshlrev_b32 v53, 7, v53
  v_lshlrev_b32 v52, 7, v52
  v_lshlrev_b32 v51, 7, v51
  v_lshlrev_b32 v50, 7, v50
  v_lshlrev_b32 v49, 7, v49
  v_lshlrev_b32 v48, 7, v48
  v_lshlrev_b32 v47, 7, v47
  v_lshlrev_b32 v46, 7, v46
  v_lshlrev_b32 v45, 7, v45
  v_lshlrev_b32 v44, 7, v44
  v_lshlrev_b32 v43, 7, v43
  v_lshlrev_b32 v42, 7, v42
  v_lshlrev_b32 v41, 7, v41
  v_lshlrev_b32 v40, 7, v40
  v_lshlrev_b32 v39, 7, v39
  v_lshlrev_b32 v38, 7, v38
  v_lshlrev_b32 v37, 7, v37
  v_lshlrev_b32 v36, 7, v36
  v_lshlrev_b32 v35, 7, v35
  v_lshlrev_b32 v34, 7, v34
  v_lshlrev_b32 v33, 7, v33
  s_nop 1
  v_add_u32_dpp v24, v33, v14 row_newbcast:0 row_mask:0xf bank_mask:0x3
  v_add_u32_dpp v25, v33, v15 row_newbcast:1 row_mask:0xf bank_mask:0x3
  v_add_u32_dpp v26, v33, v14 row_newbcast:2 row_mask:0xf bank_mask:0x3
  v_add_u32_dpp v27, v33, v15 row_newbcast:3 row_mask:0xf bank_mask:0x3
  v_add_u32_dpp v24, v33, v14 row_newbcast:8 row_mask:0xf bank_mask:0xc
  v_add_u32_dpp v25, v33, v15 row_newbcast:9 row_mask:0xf bank_mask:0xc
  v_add_u32_dpp v26, v33, v14 row_newbcast:10 row_mask:0xf bank_mask:0xc
  v_add_u32_dpp v27, v33, v15 row_newbcast:11 row_mask:0xf bank_mask:0xc
  s_add_u32 m0, s76, 8192
  s_nop 0
  buffer_load_dwordx4 v24, s[32:35], 0 offen lds
  s_add_u32 m0, s76, 9216
  s_nop 0
  buffer_load_dwordx4 v25, s[32:35], 0 offen lds
  s_add_u32 m0, s76, 10240
  s_nop 0
  buffer_load_dwordx4 v26, s[32:35], 0 offen lds
  s_add_u32 m0, s76, 11264
  s_nop 0
  buffer_load_dwordx4 v27, s[32:35], 0 offen lds
  v_add_u32_dpp v28, v33, v14 row_newbcast:4 row_mask:0xf bank_mask:0x3
  v_add_u32_dpp v29, v33, v15 row_newbcast:5 row_mask:0xf bank_mask:0x3
  v_add_u32_dpp v30, v33, v14 row_newbcast:6 row_mask:0xf bank_mask:0x3
  v_add_u32_dpp v31, v33, v15 row_newbcast:7 row_mask:0xf bank_mask:0x3
  v_add_u32_dpp v28, v33, v14 row_newbcast:12 row_mask:0xf bank_mask:0xc
  v_add_u32_dpp v29, v33, v15 row_newbcast:13 row_mask:0xf bank_mask:0xc
  v_add_u32_dpp v30, v33, v14 row_newbcast:14 row_mask:0xf bank_mask:0xc
  v_add_u32_dpp v31, v33, v15 row_newbcast:15 row_mask:0xf bank_mask:0xc
  s_add_u32 m0, s76, 12288
  s_nop 0
  buffer_load_dwordx4 v28, s[32:35], 0 offen lds
  s_add_u32 m0, s76, 13312
  s_nop 0
  buffer_load_dwordx4 v29, s[32:35], 0 offen lds
  s_add_u32 m0, s76, 14336
  s_nop 0
  buffer_load_dwordx4 v30, s[32:35], 0 offen lds
  s_add_u32 m0, s76, 15360
  s_nop 0
  buffer_load_dwordx4 v31, s[32:35], 0 offen lds
  s_add_u32 m0, s75, 16384
  s_nop 0
  buffer_load_dwordx4 v13, s[44:47], s74 offen lds
  s_add_u32 s74, s74, 212992
  v_lshlrev_b32 v248, 3, v246
  s_mov_b32 s73, 3
  v_mov_b32 v9, v34
  s_nop 1
  v_add_u32_dpp v24, v9, v14 row_newbcast:0 row_mask:0xf bank_mask:0x3
  v_add_u32_dpp v25, v9, v15 row_newbcast:1 row_mask:0xf bank_mask:0x3
  v_add_u32_dpp v26, v9, v14 row_newbcast:2 row_mask:0xf bank_mask:0x3
  v_add_u32_dpp v27, v9, v15 row_newbcast:3 row_mask:0xf bank_mask:0x3
  v_add_u32_dpp v24, v9, v14 row_newbcast:8 row_mask:0xf bank_mask:0xc
  v_add_u32_dpp v25, v9, v15 row_newbcast:9 row_mask:0xf bank_mask:0xc
  v_add_u32_dpp v26, v9, v14 row_newbcast:10 row_mask:0xf bank_mask:0xc
  v_add_u32_dpp v27, v9, v15 row_newbcast:11 row_mask:0xf bank_mask:0xc
  s_waitcnt vmcnt(14)
  s_barrier
  ds_read_b128 v[76:79], v12 offset:2048
  ds_read_b128 v[72:75], v11 offset:2048
  ds_read_b128 v[68:71], v12 offset:0
  ds_read_b128 v[64:67], v11 offset:0
  ds_read_b64_tr_b16 v[96:97], v1 offset:0
  ds_read_b64_tr_b16 v[98:99], v1 offset:512
  ds_read_b64_tr_b16 v[100:101], v1 offset:4096
  ds_read_b64_tr_b16 v[102:103], v1 offset:4608
  ds_read_b64_tr_b16 v[104:105], v2 offset:0
  ds_read_b64_tr_b16 v[106:107], v2 offset:512
  ds_read_b64_tr_b16 v[108:109], v2 offset:4096
  ds_read_b64_tr_b16 v[110:111], v2 offset:4608
  ds_read_b64_tr_b16 v[112:113], v7 offset:0
  ds_read_b64_tr_b16 v[114:115], v7 offset:512
  ds_read_b64_tr_b16 v[116:117], v7 offset:4096
  ds_read_b64_tr_b16 v[118:119], v7 offset:4608
  ds_read_b64_tr_b16 v[120:121], v8 offset:0
  ds_read_b64_tr_b16 v[122:123], v8 offset:512
  ds_read_b64_tr_b16 v[124:125], v8 offset:4096
  ds_read_b64_tr_b16 v[126:127], v8 offset:4608
  s_cmp_lg_u32 s3, 7
  s_cbranch_scc1 L_rem_loop
  s_mov_b64 exec, 1
  buffer_store_dword v240, v14, s[64:67], s70 offen offset:128 sc1
  s_mov_b64 exec, -1
L_rem_loop:
  s_waitcnt vmcnt(9)
  s_barrier
  s_waitcnt lgkmcnt(8)
  v_mfma_f32_16x16x32_bf16 v[160:163], v[96:99], v[64:67], v[160:163]
  ds_read_b128 v[92:95], v12 offset:6144
  ds_read_b128 v[88:91], v11 offset:6144
  s_waitcnt lgkmcnt(14)
  v_mfma_f32_16x16x32_bf16 v[160:163], v[100:103], v[68:71], v[160:163]
  ds_read_b128 v[84:87], v12 offset:4096
  s_add_u32 m0, s76, 0
  s_nop 0
  buffer_load_dwordx4 v24, s[32:35], 0 offen lds
  v_mfma_f32_16x16x32_bf16 v[164:167], v[96:99], v[72:75], v[164:167]
  ds_read_b128 v[80:83], v11 offset:4096
  v_mfma_f32_16x16x32_bf16 v[164:167], v[100:103], v[76:79], v[164:167]
  ds_read_b64_tr_b16 v[128:129], v1 offset:8192
  s_waitcnt lgkmcnt(14)
  v_mfma_f32_16x16x32_bf16 v[176:179], v[104:107], v[64:67], v[176:179]
  ds_read_b64_tr_b16 v[130:131], v1 offset:8704
  s_add_u32 m0, s76, 1024
  s_nop 0
  buffer_load_dwordx4 v25, s[32:35], 0 offen lds
  s_waitcnt lgkmcnt(14)
  v_mfma_f32_16x16x32_bf16 v[176:179], v[108:111], v[68:71], v[176:179]
  ds_read_b64_tr_b16 v[132:133], v1 offset:12288
  v_mfma_f32_16x16x32_bf16 v[180:183], v[104:107], v[72:75], v[180:183]
  ds_read_b64_tr_b16 v[134:135], v1 offset:12800
  v_mfma_f32_16x16x32_bf16 v[180:183], v[108:111], v[76:79], v[180:183]
  ds_read_b64_tr_b16 v[136:137], v2 offset:8192
  s_waitcnt lgkmcnt(14)
  v_mfma_f32_16x16x32_bf16 v[192:195], v[112:115], v[64:67], v[192:195]
  ds_read_b64_tr_b16 v[138:139], v2 offset:8704
  s_add_u32 m0, s76, 2048
  s_nop 0
  buffer_load_dwordx4 v26, s[32:35], 0 offen lds
  s_waitcnt lgkmcnt(14)
  v_mfma_f32_16x16x32_bf16 v[192:195], v[116:119], v[68:71], v[192:195]
  ds_read_b64_tr_b16 v[140:141], v2 offset:12288
  v_mfma_f32_16x16x32_bf16 v[196:199], v[112:115], v[72:75], v[196:199]
  ds_read_b64_tr_b16 v[142:143], v2 offset:12800
  v_mfma_f32_16x16x32_bf16 v[196:199], v[116:119], v[76:79], v[196:199]
  v_add_u32_dpp v28, v9, v14 row_newbcast:4 row_mask:0xf bank_mask:0x3
  v_add_u32_dpp v29, v9, v15 row_newbcast:5 row_mask:0xf bank_mask:0x3
  s_waitcnt lgkmcnt(14)
  v_mfma_f32_16x16x32_bf16 v[208:211], v[120:123], v[64:67], v[208:211]
  s_add_u32 m0, s76, 3072
  s_nop 0
  buffer_load_dwordx4 v27, s[32:35], 0 offen lds
  v_add_u32_dpp v30, v9, v14 row_newbcast:6 row_mask:0xf bank_mask:0x3
  v_add_u32_dpp v31, v9, v15 row_newbcast:7 row_mask:0xf bank_mask:0x3
  s_waitcnt lgkmcnt(12)
  v_mfma_f32_16x16x32_bf16 v[208:211], v[124:127], v[68:71], v[208:211]
  v_add_u32_dpp v28, v9, v14 row_newbcast:12 row_mask:0xf bank_mask:0xc
  v_mfma_f32_16x16x32_bf16 v[212:215], v[120:123], v[72:75], v[212:215]
  v_add_u32_dpp v29, v9, v15 row_newbcast:13 row_mask:0xf bank_mask:0xc
  v_add_u32_dpp v30, v9, v14 row_newbcast:14 row_mask:0xf bank_mask:0xc
  v_mfma_f32_16x16x32_bf16 v[212:215], v[124:127], v[76:79], v[212:215]
  v_add_u32_dpp v31, v9, v15 row_newbcast:15 row_mask:0xf bank_mask:0xc
  s_waitcnt vmcnt(9)
  s_waitcnt lgkmcnt(8)
  v_mfma_f32_16x16x32_bf16 v[168:171], v[96:99], v[80:83], v[168:171]
  ds_read_b128 v[76:79], v12 offset:10240
  ds_read_b128 v[72:75], v11 offset:10240
  v_mfma_f32_16x16x32_bf16 v[168:171], v[100:103], v[84:87], v[168:171]
  ds_read_b128 v[68:71], v12 offset:8192
  s_add_u32 m0, s76, 4096
  s_nop 0
  buffer_load_dwordx4 v28, s[32:35], 0 offen lds
  v_mfma_f32_16x16x32_bf16 v[172:175], v[96:99], v[88:91], v[172:175]
  ds_read_b128 v[64:67], v11 offset:8192
  v_mfma_f32_16x16x32_bf16 v[172:175], v[100:103], v[92:95], v[172:175]
  ds_read_b64_tr_b16 v[144:145], v7 offset:8192
  v_mfma_f32_16x16x32_bf16 v[184:187], v[104:107], v[80:83], v[184:187]
  ds_read_b64_tr_b16 v[146:147], v7 offset:8704
  s_add_u32 m0, s76, 5120
  s_nop 0
  buffer_load_dwordx4 v29, s[32:35], 0 offen lds
  v_mfma_f32_16x16x32_bf16 v[184:187], v[108:111], v[84:87], v[184:187]
  ds_read_b64_tr_b16 v[148:149], v7 offset:12288
  v_mfma_f32_16x16x32_bf16 v[188:191], v[104:107], v[88:91], v[188:191]
  ds_read_b64_tr_b16 v[150:151], v7 offset:12800
  v_mfma_f32_16x16x32_bf16 v[188:191], v[108:111], v[92:95], v[188:191]
  ds_read_b64_tr_b16 v[152:153], v8 offset:8192
  s_add_u32 m0, s76, 6144
  s_nop 0
  buffer_load_dwordx4 v30, s[32:35], 0 offen lds
  v_mfma_f32_16x16x32_bf16 v[200:203], v[112:115], v[80:83], v[200:203]
  ds_read_b64_tr_b16 v[154:155], v8 offset:8704
  v_mfma_f32_16x16x32_bf16 v[200:203], v[116:119], v[84:87], v[200:203]
  ds_read_b64_tr_b16 v[156:157], v8 offset:12288
  v_mfma_f32_16x16x32_bf16 v[204:207], v[112:115], v[88:91], v[204:207]
  ds_read_b64_tr_b16 v[158:159], v8 offset:12800
  s_add_u32 m0, s76, 7168
  s_nop 0
  buffer_load_dwordx4 v31, s[32:35], 0 offen lds
  v_mfma_f32_16x16x32_bf16 v[204:207], v[116:119], v[92:95], v[204:207]
  s_set_gpr_idx_on s73, gpr_idx(SRC0)
  s_nop 0
  v_mov_b32 v9, v32
  s_set_gpr_idx_off
  s_add_u32 s73, s73, 1
  v_add_u32_dpp v24, v9, v14 row_newbcast:0 row_mask:0xf bank_mask:0x3
  v_mfma_f32_16x16x32_bf16 v[216:219], v[120:123], v[80:83], v[216:219]
  v_add_u32_dpp v25, v9, v15 row_newbcast:1 row_mask:0xf bank_mask:0x3
  v_add_u32_dpp v26, v9, v14 row_newbcast:2 row_mask:0xf bank_mask:0x3
  v_mfma_f32_16x16x32_bf16 v[216:219], v[124:127], v[84:87], v[216:219]
  s_xor_b32 s75, s75, 16384
  s_add_u32 m0, s75, 8192
  s_nop 0
  buffer_load_dwordx4 v13, s[44:47], s74 offen lds
  s_add_u32 s74, s74, 212992
  s_xor_b32 s75, s75, 16384
  v_add_u32_dpp v27, v9, v15 row_newbcast:3 row_mask:0xf bank_mask:0x3
  v_add_u32_dpp v24, v9, v14 row_newbcast:8 row_mask:0xf bank_mask:0xc
  v_mfma_f32_16x16x32_bf16 v[220:223], v[120:123], v[88:91], v[220:223]
  v_add_u32_dpp v25, v9, v15 row_newbcast:9 row_mask:0xf bank_mask:0xc
  v_add_u32_dpp v26, v9, v14 row_newbcast:10 row_mask:0xf bank_mask:0xc
  v_mfma_f32_16x16x32_bf16 v[220:223], v[124:127], v[92:95], v[220:223]
  v_add_u32_dpp v27, v9, v15 row_newbcast:11 row_mask:0xf bank_mask:0xc
  s_waitcnt vmcnt(9)
  s_barrier
  v_xor_b32 v1, 16384, v1
  v_xor_b32 v2, 16384, v2
  v_xor_b32 v7, 16384, v7
  v_xor_b32 v8, 16384, v8
  s_waitcnt lgkmcnt(8)
  v_mfma_f32_16x16x32_bf16 v[160:163], v[128:131], v[64:67], v[160:163]
  ds_read_b128 v[92:95], v12 offset:14336
  ds_read_b128 v[88:91], v11 offset:14336
  v_mfma_f32_16x16x32_bf16 v[160:163], v[132:135], v[68:71], v[160:163]
  ds_read_b128 v[84:87], v12 offset:12288
  s_add_u32 m0, s76, 8192
  s_nop 0
  buffer_load_dwordx4 v24, s[32:35], 0 offen lds
  v_mfma_f32_16x16x32_bf16 v[164:167], v[128:131], v[72:75], v[164:167]
  ds_read_b128 v[80:83], v11 offset:12288
  v_mfma_f32_16x16x32_bf16 v[164:167], v[132:135], v[76:79], v[164:167]
  ds_read_b64_tr_b16 v[96:97], v1 offset:0
  v_mfma_f32_16x16x32_bf16 v[176:179], v[136:139], v[64:67], v[176:179]
  ds_read_b64_tr_b16 v[98:99], v1 offset:512
  s_add_u32 m0, s76, 9216
  s_nop 0
  buffer_load_dwordx4 v25, s[32:35], 0 offen lds
  v_mfma_f32_16x16x32_bf16 v[176:179], v[140:143], v[68:71], v[176:179]
  ds_read_b64_tr_b16 v[100:101], v1 offset:4096
  v_mfma_f32_16x16x32_bf16 v[180:183], v[136:139], v[72:75], v[180:183]
  ds_read_b64_tr_b16 v[102:103], v1 offset:4608
  v_mfma_f32_16x16x32_bf16 v[180:183], v[140:143], v[76:79], v[180:183]
  ds_read_b64_tr_b16 v[104:105], v2 offset:0
  s_waitcnt lgkmcnt(14)
  v_mfma_f32_16x16x32_bf16 v[192:195], v[144:147], v[64:67], v[192:195]
  ds_read_b64_tr_b16 v[106:107], v2 offset:512
  s_add_u32 m0, s76, 10240
  s_nop 0
  buffer_load_dwordx4 v26, s[32:35], 0 offen lds
  s_waitcnt lgkmcnt(14)
  v_mfma_f32_16x16x32_bf16 v[192:195], v[148:151], v[68:71], v[192:195]
  ds_read_b64_tr_b16 v[108:109], v2 offset:4096
  v_mfma_f32_16x16x32_bf16 v[196:199], v[144:147], v[72:75], v[196:199]
  ds_read_b64_tr_b16 v[110:111], v2 offset:4608
  v_mfma_f32_16x16x32_bf16 v[196:199], v[148:151], v[76:79], v[196:199]
  v_add_u32_dpp v28, v9, v14 row_newbcast:4 row_mask:0xf bank_mask:0x3
  v_add_u32_dpp v29, v9, v15 row_newbcast:5 row_mask:0xf bank_mask:0x3
  s_waitcnt lgkmcnt(14)
  v_mfma_f32_16x16x32_bf16 v[208:211], v[152:155], v[64:67], v[208:211]
  s_add_u32 m0, s76, 11264
  s_nop 0
  buffer_load_dwordx4 v27, s[32:35], 0 offen lds
  v_add_u32_dpp v30, v9, v14 row_newbcast:6 row_mask:0xf bank_mask:0x3
  v_add_u32_dpp v31, v9, v15 row_newbcast:7 row_mask:0xf bank_mask:0x3
  s_waitcnt lgkmcnt(12)
  v_mfma_f32_16x16x32_bf16 v[208:211], v[156:159], v[68:71], v[208:211]
  v_add_u32_dpp v28, v9, v14 row_newbcast:12 row_mask:0xf bank_mask:0xc
  v_mfma_f32_16x16x32_bf16 v[212:215], v[152:155], v[72:75], v[212:215]
  v_add_u32_dpp v29, v9, v15 row_newbcast:13 row_mask:0xf bank_mask:0xc
  v_add_u32_dpp v30, v9, v14 row_newbcast:14 row_mask:0xf bank_mask:0xc
  v_mfma_f32_16x16x32_bf16 v[212:215], v[156:159], v[76:79], v[212:215]
  v_add_u32_dpp v31, v9, v15 row_newbcast:15 row_mask:0xf bank_mask:0xc
  s_waitcnt vmcnt(9)
  s_waitcnt lgkmcnt(8)
  v_mfma_f32_16x16x32_bf16 v[168:171], v[128:131], v[80:83], v[168:171]
  ds_read_b128 v[76:79], v12 offset:2048
  ds_read_b128 v[72:75], v11 offset:2048
  v_mfma_f32_16x16x32_bf16 v[168:171], v[132:135], v[84:87], v[168:171]
  ds_read_b128 v[68:71], v12 offset:0
  s_add_u32 m0, s76, 12288
  s_nop 0
  buffer_load_dwordx4 v28, s[32:35], 0 offen lds
  v_mfma_f32_16x16x32_bf16 v[172:175], v[128:131], v[88:91], v[172:175]
  ds_read_b128 v[64:67], v11 offset:0
  v_mfma_f32_16x16x32_bf16 v[172:175], v[132:135], v[92:95], v[172:175]
  ds_read_b64_tr_b16 v[112:113], v7 offset:0
  v_mfma_f32_16x16x32_bf16 v[184:187], v[136:139], v[80:83], v[184:187]
  ds_read_b64_tr_b16 v[114:115], v7 offset:512
  s_add_u32 m0, s76, 13312
  s_nop 0
  buffer_load_dwordx4 v29, s[32:35], 0 offen lds
  v_mfma_f32_16x16x32_bf16 v[184:187], v[140:143], v[84:87], v[184:187]
  ds_read_b64_tr_b16 v[116:117], v7 offset:4096
  v_mfma_f32_16x16x32_bf16 v[188:191], v[136:139], v[88:91], v[188:191]
  ds_read_b64_tr_b16 v[118:119], v7 offset:4608
  v_mfma_f32_16x16x32_bf16 v[188:191], v[140:143], v[92:95], v[188:191]
  ds_read_b64_tr_b16 v[120:121], v8 offset:0
  s_add_u32 m0, s76, 14336
  s_nop 0
  buffer_load_dwordx4 v30, s[32:35], 0 offen lds
  v_mfma_f32_16x16x32_bf16 v[200:203], v[144:147], v[80:83], v[200:203]
  ds_read_b64_tr_b16 v[122:123], v8 offset:512
  v_mfma_f32_16x16x32_bf16 v[200:203], v[148:151], v[84:87], v[200:203]
  ds_read_b64_tr_b16 v[124:125], v8 offset:4096
  v_mfma_f32_16x16x32_bf16 v[204:207], v[144:147], v[88:91], v[204:207]
  ds_read_b64_tr_b16 v[126:127], v8 offset:4608
  s_add_u32 m0, s76, 15360
  s_nop 0
  buffer_load_dwordx4 v31, s[32:35], 0 offen lds
  v_mfma_f32_16x16x32_bf16 v[204:207], v[148:151], v[92:95], v[204:207]
  s_set_gpr_idx_on s73, gpr_idx(SRC0)
  s_nop 0
  v_mov_b32 v9, v32
  s_set_gpr_idx_off
  s_add_u32 s73, s73, 1
  v_add_u32_dpp v24, v9, v14 row_newbcast:0 row_mask:0xf bank_mask:0x3
  v_mfma_f32_16x16x32_bf16 v[216:219], v[152:155], v[80:83], v[216:219]
  v_add_u32_dpp v25, v9, v15 row_newbcast:1 row_mask:0xf bank_mask:0x3
  v_add_u32_dpp v26, v9, v14 row_newbcast:2 row_mask:0xf bank_mask:0x3
  v_mfma_f32_16x16x32_bf16 v[216:219], v[156:159], v[84:87], v[216:219]
  s_add_u32 m0, s75, 0
  s_nop 0
  buffer_load_dwordx4 v13, s[44:47], s74 offen lds
  s_add_u32 s74, s74, 212992
  s_xor_b32 s75, s75, 16384
  v_add_u32_dpp v27, v9, v15 row_newbcast:3 row_mask:0xf bank_mask:0x3
  v_add_u32_dpp v24, v9, v14 row_newbcast:8 row_mask:0xf bank_mask:0xc
  v_mfma_f32_16x16x32_bf16 v[220:223], v[152:155], v[88:91], v[220:223]
  v_add_u32_dpp v25, v9, v15 row_newbcast:9 row_mask:0xf bank_mask:0xc
  v_add_u32_dpp v26, v9, v14 row_newbcast:10 row_mask:0xf bank_mask:0xc
  v_mfma_f32_16x16x32_bf16 v[220:223], v[156:159], v[92:95], v[220:223]
  v_add_u32_dpp v27, v9, v15 row_newbcast:11 row_mask:0xf bank_mask:0xc
  s_cmp_lt_u32 s73, 27
  s_cbranch_scc1 L_rem_loop
  s_waitcnt vmcnt(0)
  s_barrier
  s_waitcnt lgkmcnt(8)
  v_mfma_f32_16x16x32_bf16 v[160:163], v[96:99], v[64:67], v[160:163]
  ds_read_b128 v[92:95], v12 offset:6144
  ds_read_b128 v[88:91], v11 offset:6144
  v_mfma_f32_16x16x32_bf16 v[160:163], v[100:103], v[68:71], v[160:163]
  ds_read_b128 v[84:87], v12 offset:4096
  buffer_load_dwordx2 v[224:225], v248, s[48:51], 0 offen offset:3200
  v_mfma_f32_16x16x32_bf16 v[164:167], v[96:99], v[72:75], v[164:167]
  ds_read_b128 v[80:83], v11 offset:4096
  buffer_load_dwordx2 v[226:227], v248, s[48:51], 0 offen offset:3232
  v_mfma_f32_16x16x32_bf16 v[164:167], v[100:103], v[76:79], v[164:167]
  ds_read_b64_tr_b16 v[128:129], v1 offset:8192
  v_mfma_f32_16x16x32_bf16 v[176:179], v[104:107], v[64:67], v[176:179]
  ds_read_b64_tr_b16 v[130:131], v1 offset:8704
  buffer_load_dwordx2 v[228:229], v248, s[48:51], 0 offen offset:3264
  v_mfma_f32_16x16x32_bf16 v[176:179], v[108:111], v[68:71], v[176:179]
  ds_read_b64_tr_b16 v[132:133], v1 offset:12288
  v_mfma_f32_16x16x32_bf16 v[180:183], v[104:107], v[72:75], v[180:183]
  ds_read_b64_tr_b16 v[134:135], v1 offset:12800
  buffer_load_dwordx2 v[230:231], v248, s[48:51], 0 offen offset:3296
  v_mfma_f32_16x16x32_bf16 v[180:183], v[108:111], v[76:79], v[180:183]
  ds_read_b64_tr_b16 v[136:137], v2 offset:8192
  s_waitcnt lgkmcnt(14)
  v_mfma_f32_16x16x32_bf16 v[192:195], v[112:115], v[64:67], v[192:195]
  ds_read_b64_tr_b16 v[138:139], v2 offset:8704
  buffer_load_dwordx2 v[232:233], v248, s[52:55], 0 offen offset:3200
  s_waitcnt lgkmcnt(14)
  v_mfma_f32_16x16x32_bf16 v[192:195], v[116:119], v[68:71], v[192:195]
  ds_read_b64_tr_b16 v[140:141], v2 offset:12288
  v_mfma_f32_16x16x32_bf16 v[196:199], v[112:115], v[72:75], v[196:199]
  ds_read_b64_tr_b16 v[142:143], v2 offset:12800
  buffer_load_dwordx2 v[234:235], v248, s[52:55], 0 offen offset:3232
  v_mfma_f32_16x16x32_bf16 v[196:199], v[116:119], v[76:79], v[196:199]
  s_waitcnt lgkmcnt(14)
  v_mfma_f32_16x16x32_bf16 v[208:211], v[120:123], v[64:67], v[208:211]
  buffer_load_dwordx2 v[236:237], v248, s[52:55], 0 offen offset:3264
  s_waitcnt lgkmcnt(12)
  v_mfma_f32_16x16x32_bf16 v[208:211], v[124:127], v[68:71], v[208:211]
  v_mfma_f32_16x16x32_bf16 v[212:215], v[120:123], v[72:75], v[212:215]
  buffer_load_dwordx2 v[238:239], v248, s[52:55], 0 offen offset:3296
  v_mfma_f32_16x16x32_bf16 v[212:215], v[124:127], v[76:79], v[212:215]
  s_waitcnt lgkmcnt(8)
  v_mfma_f32_16x16x32_bf16 v[168:171], v[96:99], v[80:83], v[168:171]
  ds_read_b128 v[76:79], v12 offset:10240
  ds_read_b128 v[72:75], v11 offset:10240
  v_mfma_f32_16x16x32_bf16 v[168:171], v[100:103], v[84:87], v[168:171]
  ds_read_b128 v[68:71], v12 offset:8192
  v_mfma_f32_16x16x32_bf16 v[172:175], v[96:99], v[88:91], v[172:175]
  ds_read_b128 v[64:67], v11 offset:8192
  v_mfma_f32_16x16x32_bf16 v[172:175], v[100:103], v[92:95], v[172:175]
  ds_read_b64_tr_b16 v[144:145], v7 offset:8192
  v_mfma_f32_16x16x32_bf16 v[184:187], v[104:107], v[80:83], v[184:187]
  ds_read_b64_tr_b16 v[146:147], v7 offset:8704
  v_mfma_f32_16x16x32_bf16 v[184:187], v[108:111], v[84:87], v[184:187]
  ds_read_b64_tr_b16 v[148:149], v7 offset:12288
  v_mfma_f32_16x16x32_bf16 v[188:191], v[104:107], v[88:91], v[188:191]
  ds_read_b64_tr_b16 v[150:151], v7 offset:12800
  v_mfma_f32_16x16x32_bf16 v[188:191], v[108:111], v[92:95], v[188:191]
  ds_read_b64_tr_b16 v[152:153], v8 offset:8192
  v_mfma_f32_16x16x32_bf16 v[200:203], v[112:115], v[80:83], v[200:203]
  ds_read_b64_tr_b16 v[154:155], v8 offset:8704
  v_mfma_f32_16x16x32_bf16 v[200:203], v[116:119], v[84:87], v[200:203]
  ds_read_b64_tr_b16 v[156:157], v8 offset:12288
  v_mfma_f32_16x16x32_bf16 v[204:207], v[112:115], v[88:91], v[204:207]
  ds_read_b64_tr_b16 v[158:159], v8 offset:12800
  v_mfma_f32_16x16x32_bf16 v[204:207], v[116:119], v[92:95], v[204:207]
  v_mfma_f32_16x16x32_bf16 v[216:219], v[120:123], v[80:83], v[216:219]
  v_mfma_f32_16x16x32_bf16 v[216:219], v[124:127], v[84:87], v[216:219]
  v_mfma_f32_16x16x32_bf16 v[220:223], v[120:123], v[88:91], v[220:223]
  v_mfma_f32_16x16x32_bf16 v[220:223], v[124:127], v[92:95], v[220:223]
  s_waitcnt lgkmcnt(8)
  v_mfma_f32_16x16x32_bf16 v[160:163], v[128:131], v[64:67], v[160:163]
  ds_read_b128 v[92:95], v12 offset:14336
  v_mfma_f32_16x16x32_bf16 v[160:163], v[132:135], v[68:71], v[160:163]
  v_mfma_f32_16x16x32_bf16 v[164:167], v[128:131], v[72:75], v[164:167]
  ds_read_b128 v[88:91], v11 offset:14336
  v_mfma_f32_16x16x32_bf16 v[164:167], v[132:135], v[76:79], v[164:167]
  v_mfma_f32_16x16x32_bf16 v[176:179], v[136:139], v[64:67], v[176:179]
  v_mfma_f32_16x16x32_bf16 v[176:179], v[140:143], v[68:71], v[176:179]
  ds_read_b128 v[84:87], v12 offset:12288
  v_mfma_f32_16x16x32_bf16 v[180:183], v[136:139], v[72:75], v[180:183]
  v_mfma_f32_16x16x32_bf16 v[180:183], v[140:143], v[76:79], v[180:183]
  s_waitcnt lgkmcnt(9)
  v_mfma_f32_16x16x32_bf16 v[192:195], v[144:147], v[64:67], v[192:195]
  ds_read_b128 v[80:83], v11 offset:12288
  s_waitcnt lgkmcnt(8)
  v_mfma_f32_16x16x32_bf16 v[192:195], v[148:151], v[68:71], v[192:195]
  v_mfma_f32_16x16x32_bf16 v[196:199], v[144:147], v[72:75], v[196:199]
  v_mfma_f32_16x16x32_bf16 v[196:199], v[148:151], v[76:79], v[196:199]
  s_waitcnt lgkmcnt(6)
  v_mfma_f32_16x16x32_bf16 v[208:211], v[152:155], v[64:67], v[208:211]
  s_waitcnt lgkmcnt(4)
  v_mfma_f32_16x16x32_bf16 v[208:211], v[156:159], v[68:71], v[208:211]
  v_mfma_f32_16x16x32_bf16 v[212:215], v[152:155], v[72:75], v[212:215]
  v_mfma_f32_16x16x32_bf16 v[212:215], v[156:159], v[76:79], v[212:215]
  s_waitcnt lgkmcnt(0)
  v_mfma_f32_16x16x32_bf16 v[168:171], v[128:131], v[80:83], v[168:171]
  s_waitcnt vmcnt(7)
  v_lshlrev_b32 v112, 16, v224
  v_and_b32 v113, 0xffff0000, v224
  v_mfma_f32_16x16x32_bf16 v[168:171], v[132:135], v[84:87], v[168:171]
  s_waitcnt vmcnt(3)
  v_lshlrev_b32 v96, 16, v232
  v_and_b32 v97, 0xffff0000, v232
  v_mfma_f32_16x16x32_bf16 v[172:175], v[128:131], v[88:91], v[172:175]
  v_lshlrev_b32 v114, 16, v225
  v_and_b32 v115, 0xffff0000, v225
  v_mfma_f32_16x16x32_bf16 v[172:175], v[132:135], v[92:95], v[172:175]
  v_lshlrev_b32 v98, 16, v233
  v_and_b32 v99, 0xffff0000, v233
  v_mfma_f32_16x16x32_bf16 v[184:187], v[136:139], v[80:83], v[184:187]
  v_lshlrev_b32 v116, 16, v226
  v_and_b32 v117, 0xffff0000, v226
  v_mfma_f32_16x16x32_bf16 v[184:187], v[140:143], v[84:87], v[184:187]
  s_waitcnt vmcnt(2)
  v_lshlrev_b32 v100, 16, v234
  v_and_b32 v101, 0xffff0000, v234
  v_mfma_f32_16x16x32_bf16 v[188:191], v[136:139], v[88:91], v[188:191]
  v_lshlrev_b32 v118, 16, v227
  v_and_b32 v119, 0xffff0000, v227
  v_mfma_f32_16x16x32_bf16 v[188:191], v[140:143], v[92:95], v[188:191]
  v_lshlrev_b32 v102, 16, v235
  v_and_b32 v103, 0xffff0000, v235
  v_mfma_f32_16x16x32_bf16 v[200:203], v[144:147], v[80:83], v[200:203]
  v_lshlrev_b32 v120, 16, v228
  v_and_b32 v121, 0xffff0000, v228
  v_mfma_f32_16x16x32_bf16 v[200:203], v[148:151], v[84:87], v[200:203]
  s_waitcnt vmcnt(1)
  v_lshlrev_b32 v104, 16, v236
  v_and_b32 v105, 0xffff0000, v236
  v_mfma_f32_16x16x32_bf16 v[204:207], v[144:147], v[88:91], v[204:207]
  v_lshlrev_b32 v122, 16, v229
  v_and_b32 v123, 0xffff0000, v229
  v_mfma_f32_16x16x32_bf16 v[204:207], v[148:151], v[92:95], v[204:207]
  v_lshlrev_b32 v106, 16, v237
  v_and_b32 v107, 0xffff0000, v237
  v_mfma_f32_16x16x32_bf16 v[216:219], v[152:155], v[80:83], v[216:219]
  v_lshlrev_b32 v124, 16, v230
  v_and_b32 v125, 0xffff0000, v230
  v_mfma_f32_16x16x32_bf16 v[216:219], v[156:159], v[84:87], v[216:219]
  s_waitcnt vmcnt(0)
  v_lshlrev_b32 v108, 16, v238
  v_and_b32 v109, 0xffff0000, v238
  v_mfma_f32_16x16x32_bf16 v[220:223], v[152:155], v[88:91], v[220:223]
  v_lshlrev_b32 v126, 16, v231
  v_and_b32 v127, 0xffff0000, v231
  v_mfma_f32_16x16x32_bf16 v[220:223], v[156:159], v[92:95], v[220:223]
  v_lshlrev_b32 v110, 16, v239
  v_and_b32 v111, 0xffff0000, v239
  s_mov_b32 s60, s24
  s_and_b32 s61, s25, 0xffff
  s_mov_b32 s62, 268435456
  s_mov_b32 s63, 0x20000
  s_mov_b32 s64, s22
  s_and_b32 s65, s23, 0xffff
  s_mov_b32 s66, 256
  s_mov_b32 s67, 0x20000
  v_lshlrev_b32 v4, 2, v0
  s_mov_b64 exec, 0xff
  s_mov_b32 s81, 0x80000
  buffer_load_dword v255, v4, s[60:63], s81 offen
  buffer_load_dword v5, v4, s[64:67], 0 offen offset:128 sc1
  s_mov_b64 exec, -1
  v_mov_b32 v4, 0
  s_mov_b32 s56, s20
  s_and_b32 s57, s21, 0xffff
  s_mov_b32 s58, 8192
  s_mov_b32 s59, 0x20000
  s_load_dword s80, s[18:19], 0
  buffer_load_dword v255, v4, s[56:59], 0 offen
  s_and_b32 s70, s2, 7
  s_lshl_b32 s68, s70, 14
  s_lshl_b32 s69, s3, 8
  s_add_u32 s68, s68, s69
  s_add_u32 s69, s68, 4096
  s_add_u32 s71, s68, 8192
  s_lshl_b32 s70, s70, 3
  s_add_u32 s70, s70, s3
  s_lshl_b32 s70, s70, 7
  v_lshlrev_b32 v3, 2, v0
  v_lshlrev_b32 v2, 1, v0
  s_waitcnt lgkmcnt(0)
  s_lshl_b32 s80, s80, 16
  s_lshl_b32 s81, s3, 6
  v_add_u32 v1, s81, v0
  v_cmp_lt_u32 vcc, 503, v1
  v_add_u32 v1, 4096, v3
  v_mov_b32 v6, 0x7f000000
  v_cndmask_b32 v1, v6, v1, vcc
  v_rcp_f32 v96, v96
  v_rcp_f32 v97, v97
  v_rcp_f32 v98, v98
  v_rcp_f32 v99, v99
  v_rcp_f32 v100, v100
  v_rcp_f32 v101, v101
  v_rcp_f32 v102, v102
  v_rcp_f32 v103, v103
  v_rcp_f32 v104, v104
  v_rcp_f32 v105, v105
  v_rcp_f32 v106, v106
  v_rcp_f32 v107, v107
  v_rcp_f32 v108, v108
  v_rcp_f32 v109, v109
  v_rcp_f32 v110, v110
  v_rcp_f32 v111, v111
  v_med3_f32 v96, v96, -v244, v244
  v_med3_f32 v97, v97, -v244, v244
  v_med3_f32 v98, v98, -v244, v244
  v_med3_f32 v99, v99, -v244, v244
  v_med3_f32 v100, v100, -v244, v244
  v_med3_f32 v101, v101, -v244, v244
  v_med3_f32 v102, v102, -v244, v244
  v_med3_f32 v103, v103, -v244, v244
  v_med3_f32 v104, v104, -v244, v244
  v_med3_f32 v105, v105, -v244, v244
  v_med3_f32 v106, v106, -v244, v244
  v_med3_f32 v107, v107, -v244, v244
  v_med3_f32 v108, v108, -v244, v244
  v_med3_f32 v109, v109, -v244, v244
  v_med3_f32 v110, v110, -v244, v244
  v_med3_f32 v111, v111, -v244, v244
  v_pk_add_f32 v[160:161], v[160:161], v[112:113]
  v_pk_add_f32 v[162:163], v[162:163], v[114:115]
  v_pk_add_f32 v[164:165], v[164:165], v[112:113]
  v_pk_add_f32 v[166:167], v[166:167], v[114:115]
  v_pk_add_f32 v[168:169], v[168:169], v[112:113]
  v_pk_add_f32 v[170:171], v[170:171], v[114:115]
  v_pk_add_f32 v[172:173], v[172:173], v[112:113]
  v_pk_add_f32 v[174:175], v[174:175], v[114:115]
  v_pk_add_f32 v[176:177], v[176:177], v[116:117]
  v_pk_add_f32 v[178:179], v[178:179], v[118:119]
  v_pk_add_f32 v[180:181], v[180:181], v[116:117]
  v_pk_add_f32 v[182:183], v[182:183], v[118:119]
  v_pk_add_f32 v[184:185], v[184:185], v[116:117]
  v_pk_add_f32 v[186:187], v[186:187], v[118:119]
  v_pk_add_f32 v[188:189], v[188:189], v[116:117]
  v_pk_add_f32 v[190:191], v[190:191], v[118:119]
  v_pk_add_f32 v[192:193], v[192:193], v[120:121]
  v_pk_add_f32 v[194:195], v[194:195], v[122:123]
  v_pk_add_f32 v[196:197], v[196:197], v[120:121]
  v_pk_add_f32 v[198:199], v[198:199], v[122:123]
  v_pk_add_f32 v[200:201], v[200:201], v[120:121]
  v_pk_add_f32 v[202:203], v[202:203], v[122:123]
  v_pk_add_f32 v[204:205], v[204:205], v[120:121]
  v_pk_add_f32 v[206:207], v[206:207], v[122:123]
  v_pk_add_f32 v[208:209], v[208:209], v[124:125]
  v_pk_add_f32 v[210:211], v[210:211], v[126:127]
  v_pk_add_f32 v[212:213], v[212:213], v[124:125]
  v_pk_add_f32 v[214:215], v[214:215], v[126:127]
  v_pk_add_f32 v[216:217], v[216:217], v[124:125]
  v_pk_add_f32 v[218:219], v[218:219], v[126:127]
  v_pk_add_f32 v[220:221], v[220:221], v[124:125]
  v_pk_add_f32 v[222:223], v[222:223], v[126:127]
  v_pk_mul_f32 v[64:65], v[160:161], v[160:161]
  v_pk_mul_f32 v[68:69], v[164:165], v[164:165]
  v_pk_mul_f32 v[72:73], v[168:169], v[168:169]
  v_pk_mul_f32 v[76:77], v[172:173], v[172:173]
  v_pk_fma_f32 v[64:65], v[64:65], v[242:243], v[240:241]
  v_pk_fma_f32 v[68:69], v[68:69], v[242:243], v[240:241]
  v_pk_fma_f32 v[72:73], v[72:73], v[242:243], v[240:241]
  v_pk_fma_f32 v[76:77], v[76:77], v[242:243], v[240:241]
  v_pk_mul_f32 v[64:65], v[64:65], v[160:161]
  v_pk_mul_f32 v[68:69], v[68:69], v[164:165]
  v_pk_mul_f32 v[72:73], v[72:73], v[168:169]
  v_pk_mul_f32 v[76:77], v[76:77], v[172:173]
  v_exp_f32 v64, v64
  v_exp_f32 v65, v65
  v_exp_f32 v68, v68
  v_exp_f32 v69, v69
  v_exp_f32 v72, v72
  v_exp_f32 v73, v73
  v_exp_f32 v76, v76
  v_exp_f32 v77, v77
  v_pk_fma_f32 v[64:65], v[64:65], v[96:97], v[96:97]
  v_pk_fma_f32 v[68:69], v[68:69], v[96:97], v[96:97]
  v_pk_fma_f32 v[72:73], v[72:73], v[96:97], v[96:97]
  v_pk_fma_f32 v[76:77], v[76:77], v[96:97], v[96:97]
  v_rcp_f32 v64, v64
  v_rcp_f32 v65, v65
  v_rcp_f32 v68, v68
  v_rcp_f32 v69, v69
  v_rcp_f32 v72, v72
  v_rcp_f32 v73, v73
  v_rcp_f32 v76, v76
  v_rcp_f32 v77, v77
  v_pk_mul_f32 v[16:17], v[64:65], v[160:161]
  v_pk_mul_f32 v[18:19], v[68:69], v[164:165]
  v_pk_mul_f32 v[20:21], v[72:73], v[168:169]
  v_pk_mul_f32 v[22:23], v[76:77], v[172:173]
  v_pk_mul_f32 v[80:81], v[162:163], v[162:163]
  v_pk_mul_f32 v[84:85], v[166:167], v[166:167]
  v_pk_mul_f32 v[88:89], v[170:171], v[170:171]
  v_pk_mul_f32 v[92:93], v[174:175], v[174:175]
  v_pk_fma_f32 v[80:81], v[80:81], v[242:243], v[240:241]
  v_pk_fma_f32 v[84:85], v[84:85], v[242:243], v[240:241]
  v_pk_fma_f32 v[88:89], v[88:89], v[242:243], v[240:241]
  v_pk_fma_f32 v[92:93], v[92:93], v[242:243], v[240:241]
  v_pk_mul_f32 v[80:81], v[80:81], v[162:163]
  v_pk_mul_f32 v[84:85], v[84:85], v[166:167]
  v_pk_mul_f32 v[88:89], v[88:89], v[170:171]
  v_pk_mul_f32 v[92:93], v[92:93], v[174:175]
  v_exp_f32 v80, v80
  v_exp_f32 v81, v81
  v_exp_f32 v84, v84
  v_exp_f32 v85, v85
  v_exp_f32 v88, v88
  v_exp_f32 v89, v89
  v_exp_f32 v92, v92
  v_exp_f32 v93, v93
  v_pk_fma_f32 v[80:81], v[80:81], v[98:99], v[98:99]
  v_pk_fma_f32 v[84:85], v[84:85], v[98:99], v[98:99]
  v_pk_fma_f32 v[88:89], v[88:89], v[98:99], v[98:99]
  v_pk_fma_f32 v[92:93], v[92:93], v[98:99], v[98:99]
  v_rcp_f32 v80, v80
  v_rcp_f32 v81, v81
  v_rcp_f32 v84, v84
  v_rcp_f32 v85, v85
  v_rcp_f32 v88, v88
  v_rcp_f32 v89, v89
  v_rcp_f32 v92, v92
  v_rcp_f32 v93, v93
  v_pk_fma_f32 v[16:17], v[80:81], v[162:163], v[16:17]
  v_pk_fma_f32 v[18:19], v[84:85], v[166:167], v[18:19]
  v_pk_fma_f32 v[20:21], v[88:89], v[170:171], v[20:21]
  v_pk_fma_f32 v[22:23], v[92:93], v[174:175], v[22:23]
  v_pk_mul_f32 v[64:65], v[176:177], v[176:177]
  v_pk_mul_f32 v[68:69], v[180:181], v[180:181]
  v_pk_mul_f32 v[72:73], v[184:185], v[184:185]
  v_pk_mul_f32 v[76:77], v[188:189], v[188:189]
  v_pk_fma_f32 v[64:65], v[64:65], v[242:243], v[240:241]
  v_pk_fma_f32 v[68:69], v[68:69], v[242:243], v[240:241]
  v_pk_fma_f32 v[72:73], v[72:73], v[242:243], v[240:241]
  v_pk_fma_f32 v[76:77], v[76:77], v[242:243], v[240:241]
  v_pk_mul_f32 v[64:65], v[64:65], v[176:177]
  v_pk_mul_f32 v[68:69], v[68:69], v[180:181]
  v_pk_mul_f32 v[72:73], v[72:73], v[184:185]
  v_pk_mul_f32 v[76:77], v[76:77], v[188:189]
  v_exp_f32 v64, v64
  v_exp_f32 v65, v65
  v_exp_f32 v68, v68
  v_exp_f32 v69, v69
  v_exp_f32 v72, v72
  v_exp_f32 v73, v73
  v_exp_f32 v76, v76
  v_exp_f32 v77, v77
  v_pk_fma_f32 v[64:65], v[64:65], v[100:101], v[100:101]
  v_pk_fma_f32 v[68:69], v[68:69], v[100:101], v[100:101]
  v_pk_fma_f32 v[72:73], v[72:73], v[100:101], v[100:101]
  v_pk_fma_f32 v[76:77], v[76:77], v[100:101], v[100:101]
  v_rcp_f32 v64, v64
  v_rcp_f32 v65, v65
  v_rcp_f32 v68, v68
  v_rcp_f32 v69, v69
  v_rcp_f32 v72, v72
  v_rcp_f32 v73, v73
  v_rcp_f32 v76, v76
  v_rcp_f32 v77, v77
  v_pk_fma_f32 v[16:17], v[64:65], v[176:177], v[16:17]
  v_pk_fma_f32 v[18:19], v[68:69], v[180:181], v[18:19]
  v_pk_fma_f32 v[20:21], v[72:73], v[184:185], v[20:21]
  v_pk_fma_f32 v[22:23], v[76:77], v[188:189], v[22:23]
  v_pk_mul_f32 v[80:81], v[178:179], v[178:179]
  v_pk_mul_f32 v[84:85], v[182:183], v[182:183]
  v_pk_mul_f32 v[88:89], v[186:187], v[186:187]
  v_pk_mul_f32 v[92:93], v[190:191], v[190:191]
  v_pk_fma_f32 v[80:81], v[80:81], v[242:243], v[240:241]
  v_pk_fma_f32 v[84:85], v[84:85], v[242:243], v[240:241]
  v_pk_fma_f32 v[88:89], v[88:89], v[242:243], v[240:241]
  v_pk_fma_f32 v[92:93], v[92:93], v[242:243], v[240:241]
  v_pk_mul_f32 v[80:81], v[80:81], v[178:179]
  v_pk_mul_f32 v[84:85], v[84:85], v[182:183]
  v_pk_mul_f32 v[88:89], v[88:89], v[186:187]
  v_pk_mul_f32 v[92:93], v[92:93], v[190:191]
  v_exp_f32 v80, v80
  v_exp_f32 v81, v81
  v_exp_f32 v84, v84
  v_exp_f32 v85, v85
  v_exp_f32 v88, v88
  v_exp_f32 v89, v89
  v_exp_f32 v92, v92
  v_exp_f32 v93, v93
  v_pk_fma_f32 v[80:81], v[80:81], v[102:103], v[102:103]
  v_pk_fma_f32 v[84:85], v[84:85], v[102:103], v[102:103]
  v_pk_fma_f32 v[88:89], v[88:89], v[102:103], v[102:103]
  v_pk_fma_f32 v[92:93], v[92:93], v[102:103], v[102:103]
  v_rcp_f32 v80, v80
  v_rcp_f32 v81, v81
  v_rcp_f32 v84, v84
  v_rcp_f32 v85, v85
  v_rcp_f32 v88, v88
  v_rcp_f32 v89, v89
  v_rcp_f32 v92, v92
  v_rcp_f32 v93, v93
  v_pk_fma_f32 v[16:17], v[80:81], v[178:179], v[16:17]
  v_pk_fma_f32 v[18:19], v[84:85], v[182:183], v[18:19]
  v_pk_fma_f32 v[20:21], v[88:89], v[186:187], v[20:21]
  v_pk_fma_f32 v[22:23], v[92:93], v[190:191], v[22:23]
  v_pk_mul_f32 v[64:65], v[192:193], v[192:193]
  v_pk_mul_f32 v[68:69], v[196:197], v[196:197]
  v_pk_mul_f32 v[72:73], v[200:201], v[200:201]
  v_pk_mul_f32 v[76:77], v[204:205], v[204:205]
  v_pk_fma_f32 v[64:65], v[64:65], v[242:243], v[240:241]
  v_pk_fma_f32 v[68:69], v[68:69], v[242:243], v[240:241]
  v_pk_fma_f32 v[72:73], v[72:73], v[242:243], v[240:241]
  v_pk_fma_f32 v[76:77], v[76:77], v[242:243], v[240:241]
  v_pk_mul_f32 v[64:65], v[64:65], v[192:193]
  v_pk_mul_f32 v[68:69], v[68:69], v[196:197]
  v_pk_mul_f32 v[72:73], v[72:73], v[200:201]
  v_pk_mul_f32 v[76:77], v[76:77], v[204:205]
  v_exp_f32 v64, v64
  v_exp_f32 v65, v65
  v_exp_f32 v68, v68
  v_exp_f32 v69, v69
  v_exp_f32 v72, v72
  v_exp_f32 v73, v73
  v_exp_f32 v76, v76
  v_exp_f32 v77, v77
  v_pk_fma_f32 v[64:65], v[64:65], v[104:105], v[104:105]
  v_pk_fma_f32 v[68:69], v[68:69], v[104:105], v[104:105]
  v_pk_fma_f32 v[72:73], v[72:73], v[104:105], v[104:105]
  v_pk_fma_f32 v[76:77], v[76:77], v[104:105], v[104:105]
  v_rcp_f32 v64, v64
  v_rcp_f32 v65, v65
  v_rcp_f32 v68, v68
  v_rcp_f32 v69, v69
  v_rcp_f32 v72, v72
  v_rcp_f32 v73, v73
  v_rcp_f32 v76, v76
  v_rcp_f32 v77, v77
  v_pk_fma_f32 v[16:17], v[64:65], v[192:193], v[16:17]
  v_pk_fma_f32 v[18:19], v[68:69], v[196:197], v[18:19]
  v_pk_fma_f32 v[20:21], v[72:73], v[200:201], v[20:21]
  v_pk_fma_f32 v[22:23], v[76:77], v[204:205], v[22:23]
  v_pk_mul_f32 v[80:81], v[194:195], v[194:195]
  v_pk_mul_f32 v[84:85], v[198:199], v[198:199]
  v_pk_mul_f32 v[88:89], v[202:203], v[202:203]
  v_pk_mul_f32 v[92:93], v[206:207], v[206:207]
  v_pk_fma_f32 v[80:81], v[80:81], v[242:243], v[240:241]
  v_pk_fma_f32 v[84:85], v[84:85], v[242:243], v[240:241]
  v_pk_fma_f32 v[88:89], v[88:89], v[242:243], v[240:241]
  v_pk_fma_f32 v[92:93], v[92:93], v[242:243], v[240:241]
  v_pk_mul_f32 v[80:81], v[80:81], v[194:195]
  v_pk_mul_f32 v[84:85], v[84:85], v[198:199]
  v_pk_mul_f32 v[88:89], v[88:89], v[202:203]
  v_pk_mul_f32 v[92:93], v[92:93], v[206:207]
  v_exp_f32 v80, v80
  v_exp_f32 v81, v81
  v_exp_f32 v84, v84
  v_exp_f32 v85, v85
  v_exp_f32 v88, v88
  v_exp_f32 v89, v89
  v_exp_f32 v92, v92
  v_exp_f32 v93, v93
  v_pk_fma_f32 v[80:81], v[80:81], v[106:107], v[106:107]
  v_pk_fma_f32 v[84:85], v[84:85], v[106:107], v[106:107]
  v_pk_fma_f32 v[88:89], v[88:89], v[106:107], v[106:107]
  v_pk_fma_f32 v[92:93], v[92:93], v[106:107], v[106:107]
  v_rcp_f32 v80, v80
  v_rcp_f32 v81, v81
  v_rcp_f32 v84, v84
  v_rcp_f32 v85, v85
  v_rcp_f32 v88, v88
  v_rcp_f32 v89, v89
  v_rcp_f32 v92, v92
  v_rcp_f32 v93, v93
  v_pk_fma_f32 v[16:17], v[80:81], v[194:195], v[16:17]
  v_pk_fma_f32 v[18:19], v[84:85], v[198:199], v[18:19]
  v_pk_fma_f32 v[20:21], v[88:89], v[202:203], v[20:21]
  v_pk_fma_f32 v[22:23], v[92:93], v[206:207], v[22:23]
  v_pk_mul_f32 v[64:65], v[208:209], v[208:209]
  v_pk_mul_f32 v[68:69], v[212:213], v[212:213]
  v_pk_mul_f32 v[72:73], v[216:217], v[216:217]
  v_pk_mul_f32 v[76:77], v[220:221], v[220:221]
  v_pk_fma_f32 v[64:65], v[64:65], v[242:243], v[240:241]
  v_pk_fma_f32 v[68:69], v[68:69], v[242:243], v[240:241]
  v_pk_fma_f32 v[72:73], v[72:73], v[242:243], v[240:241]
  v_pk_fma_f32 v[76:77], v[76:77], v[242:243], v[240:241]
  v_pk_mul_f32 v[64:65], v[64:65], v[208:209]
  v_pk_mul_f32 v[68:69], v[68:69], v[212:213]
  v_pk_mul_f32 v[72:73], v[72:73], v[216:217]
  v_pk_mul_f32 v[76:77], v[76:77], v[220:221]
  v_exp_f32 v64, v64
  v_exp_f32 v65, v65
  v_exp_f32 v68, v68
  v_exp_f32 v69, v69
  v_exp_f32 v72, v72
  v_exp_f32 v73, v73
  v_exp_f32 v76, v76
  v_exp_f32 v77, v77
  v_pk_fma_f32 v[64:65], v[64:65], v[108:109], v[108:109]
  v_pk_fma_f32 v[68:69], v[68:69], v[108:109], v[108:109]
  v_pk_fma_f32 v[72:73], v[72:73], v[108:109], v[108:109]
  v_pk_fma_f32 v[76:77], v[76:77], v[108:109], v[108:109]
  v_rcp_f32 v64, v64
  v_rcp_f32 v65, v65
  v_rcp_f32 v68, v68
  v_rcp_f32 v69, v69
  v_rcp_f32 v72, v72
  v_rcp_f32 v73, v73
  v_rcp_f32 v76, v76
  v_rcp_f32 v77, v77
  v_pk_fma_f32 v[16:17], v[64:65], v[208:209], v[16:17]
  v_pk_fma_f32 v[18:19], v[68:69], v[212:213], v[18:19]
  v_pk_fma_f32 v[20:21], v[72:73], v[216:217], v[20:21]
  v_pk_fma_f32 v[22:23], v[76:77], v[220:221], v[22:23]
  v_pk_mul_f32 v[80:81], v[210:211], v[210:211]
  v_pk_mul_f32 v[84:85], v[214:215], v[214:215]
  v_pk_mul_f32 v[88:89], v[218:219], v[218:219]
  v_pk_mul_f32 v[92:93], v[222:223], v[222:223]
  v_pk_fma_f32 v[80:81], v[80:81], v[242:243], v[240:241]
  v_pk_fma_f32 v[84:85], v[84:85], v[242:243], v[240:241]
  v_pk_fma_f32 v[88:89], v[88:89], v[242:243], v[240:241]
  v_pk_fma_f32 v[92:93], v[92:93], v[242:243], v[240:241]
  v_pk_mul_f32 v[80:81], v[80:81], v[210:211]
  v_pk_mul_f32 v[84:85], v[84:85], v[214:215]
  v_pk_mul_f32 v[88:89], v[88:89], v[218:219]
  v_pk_mul_f32 v[92:93], v[92:93], v[222:223]
  v_exp_f32 v80, v80
  v_exp_f32 v81, v81
  v_exp_f32 v84, v84
  v_exp_f32 v85, v85
  v_exp_f32 v88, v88
  v_exp_f32 v89, v89
  v_exp_f32 v92, v92
  v_exp_f32 v93, v93
  v_pk_fma_f32 v[80:81], v[80:81], v[110:111], v[110:111]
  v_pk_fma_f32 v[84:85], v[84:85], v[110:111], v[110:111]
  v_pk_fma_f32 v[88:89], v[88:89], v[110:111], v[110:111]
  v_pk_fma_f32 v[92:93], v[92:93], v[110:111], v[110:111]
  v_rcp_f32 v80, v80
  v_rcp_f32 v81, v81
  v_rcp_f32 v84, v84
  v_rcp_f32 v85, v85
  v_rcp_f32 v88, v88
  v_rcp_f32 v89, v89
  v_rcp_f32 v92, v92
  v_rcp_f32 v93, v93
  v_pk_fma_f32 v[16:17], v[80:81], v[210:211], v[16:17]
  v_pk_fma_f32 v[18:19], v[84:85], v[214:215], v[18:19]
  v_pk_fma_f32 v[20:21], v[88:89], v[218:219], v[20:21]
  v_pk_fma_f32 v[22:23], v[92:93], v[222:223], v[22:23]
  v_add_f32 v16, v16, v17
  v_add_f32 v18, v18, v19
  v_add_f32 v20, v20, v21
  v_add_f32 v22, v22, v23
  s_nop 0
  v_permlane32_swap_b32 v16, v20
  v_permlane32_swap_b32 v18, v22
  v_add_f32 v16, v16, v20
  v_add_f32 v18, v18, v22
  s_nop 1
  v_permlane16_swap_b32 v16, v18
  v_add_f32 v16, v16, v18
  v_add_f32 v16, s80, v16
  s_waitcnt vmcnt(1)
  v_cmp_eq_u32 vcc, 0, v5
  s_nop 0
  s_and_b32 vcc_lo, vcc_lo, 0xff
  s_cbranch_scc0 L_rclr_ok
  s_mov_b32 s78, 0x40000
L_rclr:
  s_sub_u32 s78, s78, 1
  s_cbranch_scc1 L_rclr_ok
  v_lshlrev_b32 v5, 2, v0
  v_and_b32 v5, 31, v5
  buffer_load_dword v5, v5, s[64:67], 0 offen offset:128 sc1
  s_waitcnt vmcnt(0)
  v_cmp_eq_u32 vcc, 0, v5
  s_nop 0
  s_and_b32 vcc_lo, vcc_lo, 0xff
  s_cbranch_scc1 L_rclr
L_rclr_ok:
  s_mov_b32 s72, 0x40000
L_poll:
  s_sub_u32 s72, s72, 1
  s_cbranch_scc1 L_pollx
  buffer_load_dword v64, v3, s[60:63], s68 offen offset:0 sc1
  buffer_load_dword v65, v3, s[60:63], s68 offen offset:2048 sc1
  buffer_load_dword v66, v3, s[60:63], s69 offen offset:0 sc1
  buffer_load_dword v67, v3, s[60:63], s69 offen offset:2048 sc1
  buffer_load_dword v68, v3, s[60:63], s71 offen offset:0 sc1
  buffer_load_dword v69, v3, s[60:63], s71 offen offset:2048 sc1
  buffer_load_dword v70, v1, s[60:63], s71 offen sc1
  s_waitcnt vmcnt(4)
  v_max3_u32 v72, v64, v65, v66
  s_waitcnt vmcnt(1)
  v_max3_u32 v73, v67, v68, v69
  s_waitcnt vmcnt(0)
  v_max3_u32 v72, v72, v73, v70
  v_cmp_eq_u32 vcc, -1, v72
  s_cbranch_vccnz L_poll
L_pollx:
  v_add_f32 v64, v64, v65
  v_add_f32 v66, v66, v67
  v_add_f32 v68, v68, v69
  v_add_f32 v16, v16, v70
  v_add_f32 v64, v64, v66
  v_add_f32 v68, v68, v16
  v_add_f32 v64, v64, v68
  v_cvt_pk_bf16_f32 v64, v64, v64
  buffer_store_short v64, v2, s[56:59], s70 offen
  s_endpgm
L_end:
  s_endpgm
.section .rodata,"a"
.p2align 6
.amdhsa_kernel standalone__deep_cross_xdeepfm__recsys_kernel
  .amdhsa_next_free_vgpr 256
  .amdhsa_next_free_sgpr 102
  .amdhsa_accum_offset 256
  .amdhsa_group_segment_fixed_size 0
  .amdhsa_kernarg_size 88
  .amdhsa_user_sgpr_count 2
  .amdhsa_user_sgpr_kernarg_segment_ptr 1
  .amdhsa_system_sgpr_workgroup_id_x 1
  .amdhsa_float_denorm_mode_32 3
.end_amdhsa_kernel
```

```asm
; @launch grid=(256,1,1) block=(512,1,1) lds=163840
.amdgcn_target "amdgcn-amd-amdhsa--gfx950"
.text
.globl standalone__deep_cross_xdeepfm__recsys_kernel
.p2align 8
.type standalone__deep_cross_xdeepfm__recsys_kernel,@function
standalone__deep_cross_xdeepfm__recsys_kernel:
  s_cmp_ge_u32 s2, 256
  s_cbranch_scc1 L_end
  s_load_dwordx16 s[4:19], s[0:1], 0
  s_load_dwordx4 s[20:23], s[0:1], 64
  s_load_dwordx2 s[24:25], s[0:1], 80
  v_lshrrev_b32 v1, 6, v0
  s_getpc_b64 s[92:93]
L_pc:
  s_and_b32 s68, s2, 0xf8
  v_add_u32 v2, s68, v1
  v_lshlrev_b32 v2, 7, v2
  v_and_b32 v3, 1, v0
  v_lshl_add_u32 v2, v3, 15, v2
  v_min_u32 v2, L_end-L_pc, v2
  v_mov_b32 v3, s93
  v_add_co_u32 v2, vcc, s92, v2
  s_nop 1
  v_addc_co_u32 v3, vcc, 0, v3, vcc
  global_load_dword v255, v[2:3], off
  v_and_b32 v0, 63, v0
  v_readfirstlane_b32 s3, v1
  s_and_b32 s68, s2, 7
  s_lshl_b32 s68, s68, 2
  s_lshr_b32 s26, s2, 6
  s_add_u32 s26, s26, s68
  s_bfe_u32 s27, s2, 0x30003
  s_and_b32 s80, s2, 0xf8
  s_add_u32 s80, s80, s3
  s_lshl_b32 s80, s80, 21
  s_cmp_ge_u32 s27, 5
  s_cbranch_scc1 L_cin
  s_mul_i32 s77, s27, 640
  s_mul_i32 s70, s3, 7
  v_min_u32 v132, 6, v0
  v_add_u32 v132, s70, v132
  v_min_u32 v132, 51, v132
  v_lshrrev_b32 v130, 1, v132
  v_mul_u32_u24 v130, 96, v130
  v_lshl_add_u32 v132, v132, 2, v130
  s_mul_i32 s78, s27, 26
  s_min_u32 s78, s78, 102
  s_lshl_b32 s71, s26, 7
  s_add_u32 s78, s78, s71
  s_mul_i32 s78, s78, 104
  s_and_b32 s70, s26, 3
  s_lshl_b32 s70, s70, 3
  s_add_u32 s70, s70, s3
  s_mul_i32 s70, s70, 3328
  s_add_u32 s81, s70, s77
  v_min_u32 v124, 15, v0
  v_lshrrev_b32 v130, 3, v124
  s_mov_b32 s70, 106496
  v_mul_u32_u24 v130, s70, v130
  v_and_b32 v124, 7, v124
  v_min_u32 v124, 4, v124
  v_lshl_add_u32 v124, v124, 7, v130
  s_xor_b32 s70, s3, 4
  s_lshl_b32 s70, s70, 4
  s_add_u32 s70, s70, s71
  v_lshrrev_b32 v128, 3, v0
  v_add_u32 v128, s70, v128
  v_mul_u32_u24 v13, 104, v128
  s_waitcnt lgkmcnt(0)
  s_mov_b32 s28, s4
  s_and_b32 s29, s5, 0xffff
  s_mov_b32 s30, 425984
  s_mov_b32 s31, 0x20000
  buffer_load_dwordx3 v[120:122], v132, s[28:31], s78 offen
  buffer_load_dwordx2 v[112:113], v13, s[28:31], 0 offen offset:0
  buffer_load_dwordx2 v[116:117], v13, s[28:31], 0 offen offset:832
  s_mov_b32 s32, s6
  s_and_b32 s33, s7, 0xffff
  s_mov_b32 s34, 12800000
  s_mov_b32 s35, 0x20000
  v_mov_b32 v136, s80
  buffer_load_dword v255, v136, s[32:35], 0 offen
  v_lshlrev_b32 v37, 4, v0
  s_mov_b32 s48, s14
  s_and_b32 s49, s15, 0xffff
  s_mov_b32 s50, 3328
  s_mov_b32 s51, 0x20000
  s_mov_b32 s44, s12
  s_and_b32 s45, s13, 0xffff
  s_mov_b32 s46, 5537792
  s_mov_b32 s47, 0x20000
  buffer_load_dword v255, v124, s[44:47], s81 offen
  s_mov_b32 m0, 155648
  s_mov_b32 exec_hi, 0xff
  buffer_load_dwordx4 v37, s[48:51], s77 offen lds
  s_mov_b64 exec, -1
  s_lshr_b32 s68, s3, 2
  s_and_b32 s69, s3, 3
  s_mov_b32 s70, 1639
  s_and_b32 s78, s69, 1
  s_lshl_b32 s78, s78, 2
  s_mov_b32 s81, 3328
  v_mov_b32 v128, v0
  v_mul_u32_u24 v129, s70, v128
  v_lshrrev_b32 v129, 16, v129
  v_mul_u32_u24 v132, 40, v129
  v_sub_u32 v132, v128, v132
  v_and_b32 v131, 2, v129
  v_or_b32 v131, s78, v131
  v_xor_b32 v132, v132, v131
  v_mul_u32_u24 v129, s81, v129
  v_lshl_add_u32 v29, v132, 4, v129
  v_add_u32 v128, 64, v128
  v_mul_u32_u24 v129, s70, v128
  v_lshrrev_b32 v129, 16, v129
  v_mul_u32_u24 v132, 40, v129
  v_sub_u32 v132, v128, v132
  v_and_b32 v131, 2, v129
  v_or_b32 v131, s78, v131
  v_xor_b32 v132, v132, v131
  v_mul_u32_u24 v129, s81, v129
  v_lshl_add_u32 v30, v132, 4, v129
  v_subrev_u32 v30, 1024, v30
  v_add_u32 v128, 64, v128
  v_mul_u32_u24 v129, s70, v128
  v_lshrrev_b32 v129, 16, v129
  v_mul_u32_u24 v132, 40, v129
  v_sub_u32 v132, v128, v132
  v_and_b32 v131, 2, v129
  v_or_b32 v131, s78, v131
  v_xor_b32 v132, v132, v131
  v_mul_u32_u24 v129, s81, v129
  v_lshl_add_u32 v31, v132, 4, v129
  v_subrev_u32 v31, 2048, v31
  v_add_u32 v128, 64, v128
  v_mul_u32_u24 v129, s70, v128
  v_lshrrev_b32 v129, 16, v129
  v_mul_u32_u24 v132, 40, v129
  v_sub_u32 v132, v128, v132
  v_and_b32 v131, 2, v129
  v_or_b32 v131, s78, v131
  v_xor_b32 v132, v132, v131
  v_mul_u32_u24 v129, s81, v129
  v_lshl_add_u32 v32, v132, 4, v129
  v_subrev_u32 v32, 3072, v32
  v_add_u32 v128, 64, v128
  v_mul_u32_u24 v129, s70, v128
  v_lshrrev_b32 v129, 16, v129
  v_mul_u32_u24 v132, 40, v129
  v_sub_u32 v132, v128, v132
  v_and_b32 v131, 2, v129
  v_or_b32 v131, s78, v131
  v_xor_b32 v132, v132, v131
  v_mul_u32_u24 v129, s81, v129
  v_lshl_add_u32 v33, v132, 4, v129
  s_mul_i32 s70, s3, 26624
  s_add_u32 s74, s70, s77
  s_mul_i32 s75, s3, 5120
  s_add_u32 s75, s75, 32768
  s_lshl_b32 s71, s68, 14
  s_lshl_b32 s76, s69, 11
  s_add_u32 s76, s76, s71
  s_xor_b32 s76, s76, 16384
  v_and_b32 v132, 7, v0
  v_lshrrev_b32 v130, 4, v0
  v_xor_b32 v132, v132, v130
  v_lshlrev_b32 v14, 4, v132
  v_xor_b32 v15, 64, v14
  v_and_b32 v132, 15, v0
  v_lshlrev_b32 v132, 7, v132
  v_bfe_u32 v131, v0, 1, 3
  v_xor_b32 v131, v131, v130
  v_lshl_add_u32 v132, v131, 4, v132
  v_add_u32 v11, s71, v132
  v_xor_b32 v12, 64, v11
  s_mov_b32 s52, s16
  s_and_b32 s53, s17, 0xffff
  s_mov_b32 s54, 3328
  s_mov_b32 s55, 0x20000
  s_mul_i32 s71, s69, 5
  v_bfe_u32 v131, v0, 2, 2
  v_lshl_add_u32 v132, v130, 3, v131
  v_mul_u32_u24 v132, 640, v132
  v_and_b32 v131, 3, v0
  v_lshl_add_u32 v132, v131, 3, v132
  v_add_u32 v132, 32768, v132
  v_bfe_u32 v131, v0, 3, 2
  v_xor_b32 v128, s71, v131
  v_lshl_add_u32 v1, v128, 5, v132
  v_add_u32 v6, 61440, v1
  s_add_u32 s71, s71, 1
  v_xor_b32 v128, s71, v131
  v_lshl_add_u32 v2, v128, 5, v132
  v_add_u32 v7, 61440, v2
  s_add_u32 s71, s71, 1
  v_xor_b32 v128, s71, v131
  v_lshl_add_u32 v3, v128, 5, v132
  v_add_u32 v8, 61440, v3
  s_add_u32 s71, s71, 1
  v_xor_b32 v128, s71, v131
  v_lshl_add_u32 v4, v128, 5, v132
  v_add_u32 v9, 61440, v4
  s_add_u32 s71, s71, 1
  v_xor_b32 v128, s71, v131
  v_lshl_add_u32 v5, v128, 5, v132
  v_add_u32 v10, 61440, v5
  s_add_u32 s71, s71, 1
  s_mul_i32 s71, s69, 160
  s_add_u32 s71, s71, 155648
  v_lshlrev_b32 v132, 3, v130
  v_add_u32 v35, s71, v132
  s_lshl_b32 s70, s69, 1
  s_add_u32 s70, s70, s68
  s_lshl_b32 s70, s70, 8
  s_add_u32 s70, s70, 156928
  v_lshlrev_b32 v36, 2, v0
  v_add_u32 v36, s70, v36
  s_add_u32 m0, s75, 0
  s_nop 0
  buffer_load_dwordx4 v29, s[44:47], s74 offen offset:0 lds
  buffer_load_dwordx4 v30, s[44:47], s74 offen offset:1024 lds
  buffer_load_dwordx4 v31, s[44:47], s74 offen offset:2048 lds
  buffer_load_dwordx4 v32, s[44:47], s74 offen offset:3072 lds
  s_add_u32 m0, m0, 4096
  s_nop 0
  buffer_load_dwordx4 v33, s[44:47], s74 offen offset:0 lds
  s_add_u32 s74, s74, 212992
  s_waitcnt vmcnt(10)
  v_lshlrev_b32 v120, 7, v120
  s_barrier
  buffer_load_dword v255, v120, s[32:35], 0 offen
  s_waitcnt vmcnt(9)
  v_lshl_add_u32 v34, v116, 7, v15
  v_lshl_add_u32 v28, v112, 7, v14
  s_add_u32 m0, s76, 0
  s_nop 0
  buffer_load_dwordx4 v28, s[32:35], 0 offen lds
  s_add_u32 m0, m0, 1024
  s_nop 0
  buffer_load_dwordx4 v34, s[32:35], 0 offen lds
  v_lshlrev_b32 v122, 7, v122
  buffer_load_dword v255, v122, s[32:35], 0 offen
  s_barrier
  s_waitcnt vmcnt(9)
  ds_read_b64 v[220:221], v35 offset:0
  ds_read_b64 v[222:223], v35 offset:32
  ds_read_b64 v[224:225], v35 offset:64
  ds_read_b64 v[226:227], v35 offset:96
  ds_read_b64 v[228:229], v35 offset:128
  s_waitcnt lgkmcnt(4)
  v_lshlrev_b32 v140, 16, v220
  v_and_b32 v141, 0xffff0000, v220
  v_lshlrev_b32 v142, 16, v221
  v_and_b32 v143, 0xffff0000, v221
  s_waitcnt lgkmcnt(3)
  v_lshlrev_b32 v156, 16, v222
  v_and_b32 v157, 0xffff0000, v222
  v_lshlrev_b32 v158, 16, v223
  v_and_b32 v159, 0xffff0000, v223
  s_waitcnt lgkmcnt(2)
  v_lshlrev_b32 v172, 16, v224
  v_and_b32 v173, 0xffff0000, v224
  v_lshlrev_b32 v174, 16, v225
  v_and_b32 v175, 0xffff0000, v225
  s_waitcnt lgkmcnt(1)
  v_lshlrev_b32 v188, 16, v226
  v_and_b32 v189, 0xffff0000, v226
  v_lshlrev_b32 v190, 16, v227
  v_and_b32 v191, 0xffff0000, v227
  s_waitcnt lgkmcnt(0)
  v_lshlrev_b32 v204, 16, v228
  v_and_b32 v205, 0xffff0000, v228
  v_lshlrev_b32 v206, 16, v229
  v_and_b32 v207, 0xffff0000, v229
  v_mov_b64 v[144:145], v[140:141]
  v_mov_b64 v[146:147], v[142:143]
  v_mov_b64 v[148:149], v[140:141]
  v_mov_b64 v[150:151], v[142:143]
  v_mov_b64 v[152:153], v[140:141]
  v_mov_b64 v[154:155], v[142:143]
  v_mov_b64 v[160:161], v[156:157]
  v_mov_b64 v[162:163], v[158:159]
  v_mov_b64 v[164:165], v[156:157]
  v_mov_b64 v[166:167], v[158:159]
  v_mov_b64 v[168:169], v[156:157]
  v_mov_b64 v[170:171], v[158:159]
  v_mov_b64 v[176:177], v[172:173]
  v_mov_b64 v[178:179], v[174:175]
  v_mov_b64 v[180:181], v[172:173]
  v_mov_b64 v[182:183], v[174:175]
  v_mov_b64 v[184:185], v[172:173]
  v_mov_b64 v[186:187], v[174:175]
  v_mov_b64 v[192:193], v[188:189]
  v_mov_b64 v[194:195], v[190:191]
  v_mov_b64 v[196:197], v[188:189]
  v_mov_b64 v[198:199], v[190:191]
  v_mov_b64 v[200:201], v[188:189]
  v_mov_b64 v[202:203], v[190:191]
  v_mov_b64 v[208:209], v[204:205]
  v_mov_b64 v[210:211], v[206:207]
  v_mov_b64 v[212:213], v[204:205]
  v_mov_b64 v[214:215], v[206:207]
  v_mov_b64 v[216:217], v[204:205]
  v_mov_b64 v[218:219], v[206:207]
  s_lshl_b32 s73, s68, 2
  s_add_u32 s73, s73, 4
  buffer_load_dwordx3 v[16:18], v13, s[28:31], s73 offen offset:0
  buffer_load_dwordx3 v[20:22], v13, s[28:31], s73 offen offset:832
  s_add_u32 s73, s73, 12
  s_mov_b32 s72, 0
  s_cmp_lg_u32 s68, 0
  s_cbranch_scc1 L_dnn_h1
L_dnn_h0:
  s_add_u32 m0, s75, 40960
  s_nop 0
  buffer_load_dwordx4 v29, s[44:47], s74 offen offset:0 lds
  buffer_load_dwordx4 v30, s[44:47], s74 offen offset:1024 lds
  buffer_load_dwordx4 v31, s[44:47], s74 offen offset:2048 lds
  buffer_load_dwordx4 v32, s[44:47], s74 offen offset:3072 lds
  s_add_u32 m0, m0, 4096
  s_nop 0
  buffer_load_dwordx4 v33, s[44:47], s74 offen offset:0 lds
  s_add_u32 s74, s74, 212992
  s_waitcnt vmcnt(11) lgkmcnt(0)
  s_barrier
  buffer_load_dwordx3 v[24:26], v13, s[28:31], s73 offen offset:0
  buffer_load_dwordx3 v[240:242], v13, s[28:31], s73 offen offset:832
  s_add_u32 s73, s73, 12
L_dnn_loop0:
  ds_read_b64_tr_b16 v[40:41], v1 offset:0
  s_add_u32 m0, s75, 81920
  s_nop 0
  buffer_load_dwordx4 v29, s[44:47], s74 offen offset:0 lds
  ds_read_b64_tr_b16 v[42:43], v1 offset:2560
  ds_read_b64_tr_b16 v[44:45], v1 offset:20480
  ds_read_b64_tr_b16 v[46:47], v1 offset:23040
  ds_read_b64_tr_b16 v[48:49], v2 offset:0
  buffer_load_dwordx4 v30, s[44:47], s74 offen offset:1024 lds
  ds_read_b64_tr_b16 v[50:51], v2 offset:2560
  ds_read_b64_tr_b16 v[52:53], v2 offset:20480
  ds_read_b64_tr_b16 v[54:55], v2 offset:23040
  ds_read_b64_tr_b16 v[56:57], v3 offset:0
  buffer_load_dwordx4 v31, s[44:47], s74 offen offset:2048 lds
  ds_read_b64_tr_b16 v[58:59], v3 offset:2560
  ds_read_b64_tr_b16 v[60:61], v3 offset:20480
  ds_read_b64_tr_b16 v[62:63], v3 offset:23040
  ds_read_b64_tr_b16 v[64:65], v4 offset:0
  buffer_load_dwordx4 v32, s[44:47], s74 offen offset:3072 lds
  ds_read_b64_tr_b16 v[66:67], v4 offset:2560
  ds_read_b64_tr_b16 v[68:69], v4 offset:20480
  ds_read_b64_tr_b16 v[70:71], v4 offset:23040
  ds_read_b128 v[80:83], v11 offset:0
  s_add_u32 m0, m0, 4096
  s_nop 0
  buffer_load_dwordx4 v33, s[44:47], s74 offen offset:0 lds
  s_add_u32 s74, s74, 212992
  ds_read_b128 v[84:87], v12 offset:0
  ds_read_b128 v[88:91], v11 offset:2048
  ds_read_b128 v[92:95], v12 offset:2048
  ds_read_b128 v[96:99], v11 offset:4096
  s_waitcnt vmcnt(12)
  v_lshl_add_u32 v34, v20, 7, v15
  v_lshl_add_u32 v28, v16, 7, v14
  s_add_u32 m0, s76, 8192
  s_nop 0
  buffer_load_dwordx4 v28, s[32:35], 0 offen lds
  ds_read_b128 v[100:103], v12 offset:4096
  ds_read_b128 v[104:107], v11 offset:6144
  ds_read_b128 v[108:111], v12 offset:6144
  ds_read_b64_tr_b16 v[72:73], v5 offset:0
  s_add_u32 m0, m0, 1024
  s_nop 0
  buffer_load_dwordx4 v34, s[32:35], 0 offen lds
  ds_read_b64_tr_b16 v[74:75], v5 offset:2560
  ds_read_b64_tr_b16 v[76:77], v5 offset:20480
  ds_read_b64_tr_b16 v[78:79], v5 offset:23040
  s_waitcnt vmcnt(9) lgkmcnt(0)
  s_barrier
  s_setprio 0
  v_mfma_f32_16x16x32_bf16 v[140:143], v[40:43], v[80:83], v[140:143]
  v_mfma_f32_16x16x32_bf16 v[140:143], v[44:47], v[84:87], v[140:143]
  v_mfma_f32_16x16x32_bf16 v[144:147], v[40:43], v[88:91], v[144:147]
  v_mfma_f32_16x16x32_bf16 v[144:147], v[44:47], v[92:95], v[144:147]
  v_mfma_f32_16x16x32_bf16 v[148:151], v[40:43], v[96:99], v[148:151]
  v_mfma_f32_16x16x32_bf16 v[148:151], v[44:47], v[100:103], v[148:151]
  v_mfma_f32_16x16x32_bf16 v[152:155], v[40:43], v[104:107], v[152:155]
  v_mfma_f32_16x16x32_bf16 v[152:155], v[44:47], v[108:111], v[152:155]
  v_mfma_f32_16x16x32_bf16 v[168:171], v[48:51], v[104:107], v[168:171]
  v_mfma_f32_16x16x32_bf16 v[168:171], v[52:55], v[108:111], v[168:171]
  v_mfma_f32_16x16x32_bf16 v[164:167], v[48:51], v[96:99], v[164:167]
  v_mfma_f32_16x16x32_bf16 v[164:167], v[52:55], v[100:103], v[164:167]
  v_mfma_f32_16x16x32_bf16 v[160:163], v[48:51], v[88:91], v[160:163]
  v_mfma_f32_16x16x32_bf16 v[160:163], v[52:55], v[92:95], v[160:163]
  v_mfma_f32_16x16x32_bf16 v[156:159], v[48:51], v[80:83], v[156:159]
  v_mfma_f32_16x16x32_bf16 v[156:159], v[52:55], v[84:87], v[156:159]
  v_mfma_f32_16x16x32_bf16 v[172:175], v[56:59], v[80:83], v[172:175]
  v_mfma_f32_16x16x32_bf16 v[172:175], v[60:63], v[84:87], v[172:175]
  v_mfma_f32_16x16x32_bf16 v[176:179], v[56:59], v[88:91], v[176:179]
  v_mfma_f32_16x16x32_bf16 v[176:179], v[60:63], v[92:95], v[176:179]
  v_mfma_f32_16x16x32_bf16 v[180:183], v[56:59], v[96:99], v[180:183]
  v_mfma_f32_16x16x32_bf16 v[180:183], v[60:63], v[100:103], v[180:183]
  v_mfma_f32_16x16x32_bf16 v[184:187], v[56:59], v[104:107], v[184:187]
  v_mfma_f32_16x16x32_bf16 v[184:187], v[60:63], v[108:111], v[184:187]
  v_mfma_f32_16x16x32_bf16 v[200:203], v[64:67], v[104:107], v[200:203]
  v_mfma_f32_16x16x32_bf16 v[200:203], v[68:71], v[108:111], v[200:203]
  v_mfma_f32_16x16x32_bf16 v[196:199], v[64:67], v[96:99], v[196:199]
  v_mfma_f32_16x16x32_bf16 v[196:199], v[68:71], v[100:103], v[196:199]
  v_mfma_f32_16x16x32_bf16 v[192:195], v[64:67], v[88:91], v[192:195]
  v_mfma_f32_16x16x32_bf16 v[192:195], v[68:71], v[92:95], v[192:195]
  v_mfma_f32_16x16x32_bf16 v[188:191], v[64:67], v[80:83], v[188:191]
  v_mfma_f32_16x16x32_bf16 v[188:191], v[68:71], v[84:87], v[188:191]
  v_mfma_f32_16x16x32_bf16 v[204:207], v[72:75], v[80:83], v[204:207]
  v_mfma_f32_16x16x32_bf16 v[204:207], v[76:79], v[84:87], v[204:207]
  v_mfma_f32_16x16x32_bf16 v[208:211], v[72:75], v[88:91], v[208:211]
  v_mfma_f32_16x16x32_bf16 v[208:211], v[76:79], v[92:95], v[208:211]
  v_mfma_f32_16x16x32_bf16 v[212:215], v[72:75], v[96:99], v[212:215]
  v_mfma_f32_16x16x32_bf16 v[212:215], v[76:79], v[100:103], v[212:215]
  v_mfma_f32_16x16x32_bf16 v[216:219], v[72:75], v[104:107], v[216:219]
  s_setprio 2
  s_waitcnt vmcnt(9)
  s_barrier
  v_mfma_f32_16x16x32_bf16 v[216:219], v[76:79], v[108:111], v[216:219]
  ds_read_b64_tr_b16 v[40:41], v1 offset:40960
  s_add_u32 m0, s75, 0
  s_nop 0
  buffer_load_dwordx4 v29, s[44:47], s74 offen offset:0 lds
  ds_read_b64_tr_b16 v[42:43], v1 offset:43520
  ds_read_b64_tr_b16 v[44:45], v6 offset:0
  ds_read_b64_tr_b16 v[46:47], v6 offset:2560
  ds_read_b64_tr_b16 v[48:49], v2 offset:40960
  buffer_load_dwordx4 v30, s[44:47], s74 offen offset:1024 lds
  ds_read_b64_tr_b16 v[50:51], v2 offset:43520
  ds_read_b64_tr_b16 v[52:53], v7 offset:0
  ds_read_b64_tr_b16 v[54:55], v7 offset:2560
  ds_read_b64_tr_b16 v[56:57], v3 offset:40960
  buffer_load_dwordx4 v31, s[44:47], s74 offen offset:2048 lds
  ds_read_b64_tr_b16 v[58:59], v3 offset:43520
  ds_read_b64_tr_b16 v[60:61], v8 offset:0
  ds_read_b64_tr_b16 v[62:63], v8 offset:2560
  ds_read_b64_tr_b16 v[64:65], v4 offset:40960
  buffer_load_dwordx4 v32, s[44:47], s74 offen offset:3072 lds
  ds_read_b64_tr_b16 v[66:67], v4 offset:43520
  ds_read_b64_tr_b16 v[68:69], v9 offset:0
  ds_read_b64_tr_b16 v[70:71], v9 offset:2560
  ds_read_b128 v[80:83], v11 offset:8192
  s_add_u32 m0, m0, 4096
  s_nop 0
  buffer_load_dwordx4 v33, s[44:47], s74 offen offset:0 lds
  s_add_u32 s74, s74, 212992
  ds_read_b128 v[84:87], v12 offset:8192
  ds_read_b128 v[88:91], v11 offset:10240
  ds_read_b128 v[92:95], v12 offset:10240
  ds_read_b128 v[96:99], v11 offset:12288
  v_lshl_add_u32 v34, v21, 7, v15
  v_lshl_add_u32 v28, v17, 7, v14
  s_add_u32 m0, s76, 0
  s_nop 0
  buffer_load_dwordx4 v28, s[32:35], 0 offen lds
  ds_read_b128 v[100:103], v12 offset:12288
  ds_read_b128 v[104:107], v11 offset:14336
  ds_read_b128 v[108:111], v12 offset:14336
  ds_read_b64_tr_b16 v[72:73], v5 offset:40960
  s_add_u32 m0, m0, 1024
  s_nop 0
  buffer_load_dwordx4 v34, s[32:35], 0 offen lds
  ds_read_b64_tr_b16 v[74:75], v5 offset:43520
  ds_read_b64_tr_b16 v[76:77], v10 offset:0
  ds_read_b64_tr_b16 v[78:79], v10 offset:2560
  s_waitcnt vmcnt(7) lgkmcnt(0)
  s_barrier
  s_setprio 0
  v_mfma_f32_16x16x32_bf16 v[140:143], v[40:43], v[80:83], v[140:143]
  v_mfma_f32_16x16x32_bf16 v[140:143], v[44:47], v[84:87], v[140:143]
  v_mfma_f32_16x16x32_bf16 v[144:147], v[40:43], v[88:91], v[144:147]
  v_mfma_f32_16x16x32_bf16 v[144:147], v[44:47], v[92:95], v[144:147]
  v_mfma_f32_16x16x32_bf16 v[148:151], v[40:43], v[96:99], v[148:151]
  v_mfma_f32_16x16x32_bf16 v[148:151], v[44:47], v[100:103], v[148:151]
  v_mfma_f32_16x16x32_bf16 v[152:155], v[40:43], v[104:107], v[152:155]
  v_mfma_f32_16x16x32_bf16 v[152:155], v[44:47], v[108:111], v[152:155]
  v_mfma_f32_16x16x32_bf16 v[168:171], v[48:51], v[104:107], v[168:171]
  v_mfma_f32_16x16x32_bf16 v[168:171], v[52:55], v[108:111], v[168:171]
  v_mfma_f32_16x16x32_bf16 v[164:167], v[48:51], v[96:99], v[164:167]
  v_mfma_f32_16x16x32_bf16 v[164:167], v[52:55], v[100:103], v[164:167]
  v_mfma_f32_16x16x32_bf16 v[160:163], v[48:51], v[88:91], v[160:163]
  v_mfma_f32_16x16x32_bf16 v[160:163], v[52:55], v[92:95], v[160:163]
  v_mfma_f32_16x16x32_bf16 v[156:159], v[48:51], v[80:83], v[156:159]
  v_mfma_f32_16x16x32_bf16 v[156:159], v[52:55], v[84:87], v[156:159]
  v_mfma_f32_16x16x32_bf16 v[172:175], v[56:59], v[80:83], v[172:175]
  v_mfma_f32_16x16x32_bf16 v[172:175], v[60:63], v[84:87], v[172:175]
  v_mfma_f32_16x16x32_bf16 v[176:179], v[56:59], v[88:91], v[176:179]
  v_mfma_f32_16x16x32_bf16 v[176:179], v[60:63], v[92:95], v[176:179]
  v_mfma_f32_16x16x32_bf16 v[180:183], v[56:59], v[96:99], v[180:183]
  v_mfma_f32_16x16x32_bf16 v[180:183], v[60:63], v[100:103], v[180:183]
  v_mfma_f32_16x16x32_bf16 v[184:187], v[56:59], v[104:107], v[184:187]
  v_mfma_f32_16x16x32_bf16 v[184:187], v[60:63], v[108:111], v[184:187]
  v_mfma_f32_16x16x32_bf16 v[200:203], v[64:67], v[104:107], v[200:203]
  v_mfma_f32_16x16x32_bf16 v[200:203], v[68:71], v[108:111], v[200:203]
  v_mfma_f32_16x16x32_bf16 v[196:199], v[64:67], v[96:99], v[196:199]
  v_mfma_f32_16x16x32_bf16 v[196:199], v[68:71], v[100:103], v[196:199]
  v_mfma_f32_16x16x32_bf16 v[192:195], v[64:67], v[88:91], v[192:195]
  v_mfma_f32_16x16x32_bf16 v[192:195], v[68:71], v[92:95], v[192:195]
  v_mfma_f32_16x16x32_bf16 v[188:191], v[64:67], v[80:83], v[188:191]
  v_mfma_f32_16x16x32_bf16 v[188:191], v[68:71], v[84:87], v[188:191]
  v_mfma_f32_16x16x32_bf16 v[204:207], v[72:75], v[80:83], v[204:207]
  v_mfma_f32_16x16x32_bf16 v[204:207], v[76:79], v[84:87], v[204:207]
  v_mfma_f32_16x16x32_bf16 v[208:211], v[72:75], v[88:91], v[208:211]
  v_mfma_f32_16x16x32_bf16 v[208:211], v[76:79], v[92:95], v[208:211]
  v_mfma_f32_16x16x32_bf16 v[212:215], v[72:75], v[96:99], v[212:215]
  v_mfma_f32_16x16x32_bf16 v[212:215], v[76:79], v[100:103], v[212:215]
  v_mfma_f32_16x16x32_bf16 v[216:219], v[72:75], v[104:107], v[216:219]
  s_setprio 2
  s_barrier
  v_mfma_f32_16x16x32_bf16 v[216:219], v[76:79], v[108:111], v[216:219]
  ds_read_b64_tr_b16 v[40:41], v6 offset:20480
  s_add_u32 m0, s75, 40960
  s_nop 0
  buffer_load_dwordx4 v29, s[44:47], s74 offen offset:0 lds
  ds_read_b64_tr_b16 v[42:43], v6 offset:23040
  ds_read_b64_tr_b16 v[44:45], v6 offset:40960
  ds_read_b64_tr_b16 v[46:47], v6 offset:43520
  ds_read_b64_tr_b16 v[48:49], v7 offset:20480
  buffer_load_dwordx4 v30, s[44:47], s74 offen offset:1024 lds
  ds_read_b64_tr_b16 v[50:51], v7 offset:23040
  ds_read_b64_tr_b16 v[52:53], v7 offset:40960
  ds_read_b64_tr_b16 v[54:55], v7 offset:43520
  ds_read_b64_tr_b16 v[56:57], v8 offset:20480
  buffer_load_dwordx4 v31, s[44:47], s74 offen offset:2048 lds
  ds_read_b64_tr_b16 v[58:59], v8 offset:23040
  ds_read_b64_tr_b16 v[60:61], v8 offset:40960
  ds_read_b64_tr_b16 v[62:63], v8 offset:43520
  ds_read_b64_tr_b16 v[64:65], v9 offset:20480
  buffer_load_dwordx4 v32, s[44:47], s74 offen offset:3072 lds
  ds_read_b64_tr_b16 v[66:67], v9 offset:23040
  ds_read_b64_tr_b16 v[68:69], v9 offset:40960
  ds_read_b64_tr_b16 v[70:71], v9 offset:43520
  ds_read_b128 v[80:83], v11 offset:0
  s_add_u32 m0, m0, 4096
  s_nop 0
  buffer_load_dwordx4 v33, s[44:47], s74 offen offset:0 lds
  s_add_u32 s74, s74, 212992
  ds_read_b128 v[84:87], v12 offset:0
  ds_read_b128 v[88:91], v11 offset:2048
  ds_read_b128 v[92:95], v12 offset:2048
  ds_read_b128 v[96:99], v11 offset:4096
  v_lshl_add_u32 v34, v22, 7, v15
  v_lshl_add_u32 v28, v18, 7, v14
  s_add_u32 m0, s76, 8192
  s_nop 0
  buffer_load_dwordx4 v28, s[32:35], 0 offen lds
  ds_read_b128 v[100:103], v12 offset:4096
  ds_read_b128 v[104:107], v11 offset:6144
  ds_read_b128 v[108:111], v12 offset:6144
  ds_read_b64_tr_b16 v[72:73], v10 offset:20480
  s_add_u32 m0, m0, 1024
  s_nop 0
  buffer_load_dwordx4 v34, s[32:35], 0 offen lds
  ds_read_b64_tr_b16 v[74:75], v10 offset:23040
  ds_read_b64_tr_b16 v[76:77], v10 offset:40960
  ds_read_b64_tr_b16 v[78:79], v10 offset:43520
  buffer_load_dwordx3 v[16:18], v13, s[28:31], s73 offen offset:0
  buffer_load_dwordx3 v[20:22], v13, s[28:31], s73 offen offset:832
  s_add_u32 s73, s73, 12
  s_waitcnt vmcnt(9) lgkmcnt(0)
  s_barrier
  s_setprio 0
  v_mfma_f32_16x16x32_bf16 v[140:143], v[40:43], v[80:83], v[140:143]
  v_mfma_f32_16x16x32_bf16 v[140:143], v[44:47], v[84:87], v[140:143]
  v_mfma_f32_16x16x32_bf16 v[144:147], v[40:43], v[88:91], v[144:147]
  v_mfma_f32_16x16x32_bf16 v[144:147], v[44:47], v[92:95], v[144:147]
  v_mfma_f32_16x16x32_bf16 v[148:151], v[40:43], v[96:99], v[148:151]
  v_mfma_f32_16x16x32_bf16 v[148:151], v[44:47], v[100:103], v[148:151]
  v_mfma_f32_16x16x32_bf16 v[152:155], v[40:43], v[104:107], v[152:155]
  v_mfma_f32_16x16x32_bf16 v[152:155], v[44:47], v[108:111], v[152:155]
  v_mfma_f32_16x16x32_bf16 v[168:171], v[48:51], v[104:107], v[168:171]
  v_mfma_f32_16x16x32_bf16 v[168:171], v[52:55], v[108:111], v[168:171]
  v_mfma_f32_16x16x32_bf16 v[164:167], v[48:51], v[96:99], v[164:167]
  v_mfma_f32_16x16x32_bf16 v[164:167], v[52:55], v[100:103], v[164:167]
  v_mfma_f32_16x16x32_bf16 v[160:163], v[48:51], v[88:91], v[160:163]
  v_mfma_f32_16x16x32_bf16 v[160:163], v[52:55], v[92:95], v[160:163]
  v_mfma_f32_16x16x32_bf16 v[156:159], v[48:51], v[80:83], v[156:159]
  v_mfma_f32_16x16x32_bf16 v[156:159], v[52:55], v[84:87], v[156:159]
  v_mfma_f32_16x16x32_bf16 v[172:175], v[56:59], v[80:83], v[172:175]
  v_mfma_f32_16x16x32_bf16 v[172:175], v[60:63], v[84:87], v[172:175]
  v_mfma_f32_16x16x32_bf16 v[176:179], v[56:59], v[88:91], v[176:179]
  v_mfma_f32_16x16x32_bf16 v[176:179], v[60:63], v[92:95], v[176:179]
  v_mfma_f32_16x16x32_bf16 v[180:183], v[56:59], v[96:99], v[180:183]
  v_mfma_f32_16x16x32_bf16 v[180:183], v[60:63], v[100:103], v[180:183]
  v_mfma_f32_16x16x32_bf16 v[184:187], v[56:59], v[104:107], v[184:187]
  v_mfma_f32_16x16x32_bf16 v[184:187], v[60:63], v[108:111], v[184:187]
  v_mfma_f32_16x16x32_bf16 v[200:203], v[64:67], v[104:107], v[200:203]
  v_mfma_f32_16x16x32_bf16 v[200:203], v[68:71], v[108:111], v[200:203]
  v_mfma_f32_16x16x32_bf16 v[196:199], v[64:67], v[96:99], v[196:199]
  v_mfma_f32_16x16x32_bf16 v[196:199], v[68:71], v[100:103], v[196:199]
  v_mfma_f32_16x16x32_bf16 v[192:195], v[64:67], v[88:91], v[192:195]
  v_mfma_f32_16x16x32_bf16 v[192:195], v[68:71], v[92:95], v[192:195]
  v_mfma_f32_16x16x32_bf16 v[188:191], v[64:67], v[80:83], v[188:191]
  v_mfma_f32_16x16x32_bf16 v[188:191], v[68:71], v[84:87], v[188:191]
  v_mfma_f32_16x16x32_bf16 v[204:207], v[72:75], v[80:83], v[204:207]
  v_mfma_f32_16x16x32_bf16 v[204:207], v[76:79], v[84:87], v[204:207]
  v_mfma_f32_16x16x32_bf16 v[208:211], v[72:75], v[88:91], v[208:211]
  v_mfma_f32_16x16x32_bf16 v[208:211], v[76:79], v[92:95], v[208:211]
  v_mfma_f32_16x16x32_bf16 v[212:215], v[72:75], v[96:99], v[212:215]
  v_mfma_f32_16x16x32_bf16 v[212:215], v[76:79], v[100:103], v[212:215]
  v_mfma_f32_16x16x32_bf16 v[216:219], v[72:75], v[104:107], v[216:219]
  s_setprio 2
  s_barrier
  v_mfma_f32_16x16x32_bf16 v[216:219], v[76:79], v[108:111], v[216:219]
  ds_read_b64_tr_b16 v[40:41], v1 offset:0
  s_add_u32 m0, s75, 81920
  s_nop 0
  buffer_load_dwordx4 v29, s[44:47], s74 offen offset:0 lds
  ds_read_b64_tr_b16 v[42:43], v1 offset:2560
  ds_read_b64_tr_b16 v[44:45], v1 offset:20480
  ds_read_b64_tr_b16 v[46:47], v1 offset:23040
  ds_read_b64_tr_b16 v[48:49], v2 offset:0
  buffer_load_dwordx4 v30, s[44:47], s74 offen offset:1024 lds
  ds_read_b64_tr_b16 v[50:51], v2 offset:2560
  ds_read_b64_tr_b16 v[52:53], v2 offset:20480
  ds_read_b64_tr_b16 v[54:55], v2 offset:23040
  ds_read_b64_tr_b16 v[56:57], v3 offset:0
  buffer_load_dwordx4 v31, s[44:47], s74 offen offset:2048 lds
  ds_read_b64_tr_b16 v[58:59], v3 offset:2560
  ds_read_b64_tr_b16 v[60:61], v3 offset:20480
  ds_read_b64_tr_b16 v[62:63], v3 offset:23040
  ds_read_b64_tr_b16 v[64:65], v4 offset:0
  buffer_load_dwordx4 v32, s[44:47], s74 offen offset:3072 lds
  ds_read_b64_tr_b16 v[66:67], v4 offset:2560
  ds_read_b64_tr_b16 v[68:69], v4 offset:20480
  ds_read_b64_tr_b16 v[70:71], v4 offset:23040
  ds_read_b128 v[80:83], v11 offset:8192
  s_add_u32 m0, m0, 4096
  s_nop 0
  buffer_load_dwordx4 v33, s[44:47], s74 offen offset:0 lds
  s_add_u32 s74, s74, 212992
  ds_read_b128 v[84:87], v12 offset:8192
  ds_read_b128 v[88:91], v11 offset:10240
  ds_read_b128 v[92:95], v12 offset:10240
  ds_read_b128 v[96:99], v11 offset:12288
  v_lshl_add_u32 v34, v240, 7, v15
  v_lshl_add_u32 v28, v24, 7, v14
  s_add_u32 m0, s76, 0
  s_nop 0
  buffer_load_dwordx4 v28, s[32:35], 0 offen lds
  ds_read_b128 v[100:103], v12 offset:12288
  ds_read_b128 v[104:107], v11 offset:14336
  ds_read_b128 v[108:111], v12 offset:14336
  ds_read_b64_tr_b16 v[72:73], v5 offset:0
  s_add_u32 m0, m0, 1024
  s_nop 0
  buffer_load_dwordx4 v34, s[32:35], 0 offen lds
  ds_read_b64_tr_b16 v[74:75], v5 offset:2560
  ds_read_b64_tr_b16 v[76:77], v5 offset:20480
  ds_read_b64_tr_b16 v[78:79], v5 offset:23040
  s_waitcnt vmcnt(9) lgkmcnt(0)
  s_barrier
  s_setprio 0
  v_mfma_f32_16x16x32_bf16 v[140:143], v[40:43], v[80:83], v[140:143]
  v_mfma_f32_16x16x32_bf16 v[140:143], v[44:47], v[84:87], v[140:143]
  v_mfma_f32_16x16x32_bf16 v[144:147], v[40:43], v[88:91], v[144:147]
  v_mfma_f32_16x16x32_bf16 v[144:147], v[44:47], v[92:95], v[144:147]
  v_mfma_f32_16x16x32_bf16 v[148:151], v[40:43], v[96:99], v[148:151]
  v_mfma_f32_16x16x32_bf16 v[148:151], v[44:47], v[100:103], v[148:151]
  v_mfma_f32_16x16x32_bf16 v[152:155], v[40:43], v[104:107], v[152:155]
  v_mfma_f32_16x16x32_bf16 v[152:155], v[44:47], v[108:111], v[152:155]
  v_mfma_f32_16x16x32_bf16 v[168:171], v[48:51], v[104:107], v[168:171]
  v_mfma_f32_16x16x32_bf16 v[168:171], v[52:55], v[108:111], v[168:171]
  v_mfma_f32_16x16x32_bf16 v[164:167], v[48:51], v[96:99], v[164:167]
  v_mfma_f32_16x16x32_bf16 v[164:167], v[52:55], v[100:103], v[164:167]
  v_mfma_f32_16x16x32_bf16 v[160:163], v[48:51], v[88:91], v[160:163]
  v_mfma_f32_16x16x32_bf16 v[160:163], v[52:55], v[92:95], v[160:163]
  v_mfma_f32_16x16x32_bf16 v[156:159], v[48:51], v[80:83], v[156:159]
  v_mfma_f32_16x16x32_bf16 v[156:159], v[52:55], v[84:87], v[156:159]
  v_mfma_f32_16x16x32_bf16 v[172:175], v[56:59], v[80:83], v[172:175]
  v_mfma_f32_16x16x32_bf16 v[172:175], v[60:63], v[84:87], v[172:175]
  v_mfma_f32_16x16x32_bf16 v[176:179], v[56:59], v[88:91], v[176:179]
  v_mfma_f32_16x16x32_bf16 v[176:179], v[60:63], v[92:95], v[176:179]
  v_mfma_f32_16x16x32_bf16 v[180:183], v[56:59], v[96:99], v[180:183]
  v_mfma_f32_16x16x32_bf16 v[180:183], v[60:63], v[100:103], v[180:183]
  v_mfma_f32_16x16x32_bf16 v[184:187], v[56:59], v[104:107], v[184:187]
  v_mfma_f32_16x16x32_bf16 v[184:187], v[60:63], v[108:111], v[184:187]
  v_mfma_f32_16x16x32_bf16 v[200:203], v[64:67], v[104:107], v[200:203]
  v_mfma_f32_16x16x32_bf16 v[200:203], v[68:71], v[108:111], v[200:203]
  v_mfma_f32_16x16x32_bf16 v[196:199], v[64:67], v[96:99], v[196:199]
  v_mfma_f32_16x16x32_bf16 v[196:199], v[68:71], v[100:103], v[196:199]
  v_mfma_f32_16x16x32_bf16 v[192:195], v[64:67], v[88:91], v[192:195]
  v_mfma_f32_16x16x32_bf16 v[192:195], v[68:71], v[92:95], v[192:195]
  v_mfma_f32_16x16x32_bf16 v[188:191], v[64:67], v[80:83], v[188:191]
  v_mfma_f32_16x16x32_bf16 v[188:191], v[68:71], v[84:87], v[188:191]
  v_mfma_f32_16x16x32_bf16 v[204:207], v[72:75], v[80:83], v[204:207]
  v_mfma_f32_16x16x32_bf16 v[204:207], v[76:79], v[84:87], v[204:207]
  v_mfma_f32_16x16x32_bf16 v[208:211], v[72:75], v[88:91], v[208:211]
  v_mfma_f32_16x16x32_bf16 v[208:211], v[76:79], v[92:95], v[208:211]
  v_mfma_f32_16x16x32_bf16 v[212:215], v[72:75], v[96:99], v[212:215]
  v_mfma_f32_16x16x32_bf16 v[212:215], v[76:79], v[100:103], v[212:215]
  v_mfma_f32_16x16x32_bf16 v[216:219], v[72:75], v[104:107], v[216:219]
  s_setprio 2
  s_barrier
  v_mfma_f32_16x16x32_bf16 v[216:219], v[76:79], v[108:111], v[216:219]
  ds_read_b64_tr_b16 v[40:41], v1 offset:40960
  s_add_u32 m0, s75, 0
  s_nop 0
  buffer_load_dwordx4 v29, s[44:47], s74 offen offset:0 lds
  ds_read_b64_tr_b16 v[42:43], v1 offset:43520
  ds_read_b64_tr_b16 v[44:45], v6 offset:0
  ds_read_b64_tr_b16 v[46:47], v6 offset:2560
  ds_read_b64_tr_b16 v[48:49], v2 offset:40960
  buffer_load_dwordx4 v30, s[44:47], s74 offen offset:1024 lds
  ds_read_b64_tr_b16 v[50:51], v2 offset:43520
  ds_read_b64_tr_b16 v[52:53], v7 offset:0
  ds_read_b64_tr_b16 v[54:55], v7 offset:2560
  ds_read_b64_tr_b16 v[56:57], v3 offset:40960
  buffer_load_dwordx4 v31, s[44:47], s74 offen offset:2048 lds
  ds_read_b64_tr_b16 v[58:59], v3 offset:43520
  ds_read_b64_tr_b16 v[60:61], v8 offset:0
  ds_read_b64_tr_b16 v[62:63], v8 offset:2560
  ds_read_b64_tr_b16 v[64:65], v4 offset:40960
  buffer_load_dwordx4 v32, s[44:47], s74 offen offset:3072 lds
  ds_read_b64_tr_b16 v[66:67], v4 offset:43520
  ds_read_b64_tr_b16 v[68:69], v9 offset:0
  ds_read_b64_tr_b16 v[70:71], v9 offset:2560
  ds_read_b128 v[80:83], v11 offset:0
  s_add_u32 m0, m0, 4096
  s_nop 0
  buffer_load_dwordx4 v33, s[44:47], s74 offen offset:0 lds
  s_add_u32 s74, s74, 212992
  ds_read_b128 v[84:87], v12 offset:0
  ds_read_b128 v[88:91], v11 offset:2048
  ds_read_b128 v[92:95], v12 offset:2048
  ds_read_b128 v[96:99], v11 offset:4096
  v_lshl_add_u32 v34, v241, 7, v15
  v_lshl_add_u32 v28, v25, 7, v14
  s_add_u32 m0, s76, 8192
  s_nop 0
  buffer_load_dwordx4 v28, s[32:35], 0 offen lds
  ds_read_b128 v[100:103], v12 offset:4096
  ds_read_b128 v[104:107], v11 offset:6144
  ds_read_b128 v[108:111], v12 offset:6144
  ds_read_b64_tr_b16 v[72:73], v5 offset:40960
  s_add_u32 m0, m0, 1024
  s_nop 0
  buffer_load_dwordx4 v34, s[32:35], 0 offen lds
  ds_read_b64_tr_b16 v[74:75], v5 offset:43520
  ds_read_b64_tr_b16 v[76:77], v10 offset:0
  ds_read_b64_tr_b16 v[78:79], v10 offset:2560
  s_waitcnt vmcnt(7) lgkmcnt(0)
  s_barrier
  s_setprio 0
  v_mfma_f32_16x16x32_bf16 v[140:143], v[40:43], v[80:83], v[140:143]
  v_mfma_f32_16x16x32_bf16 v[140:143], v[44:47], v[84:87], v[140:143]
  v_mfma_f32_16x16x32_bf16 v[144:147], v[40:43], v[88:91], v[144:147]
  v_mfma_f32_16x16x32_bf16 v[144:147], v[44:47], v[92:95], v[144:147]
  v_mfma_f32_16x16x32_bf16 v[148:151], v[40:43], v[96:99], v[148:151]
  v_mfma_f32_16x16x32_bf16 v[148:151], v[44:47], v[100:103], v[148:151]
  v_mfma_f32_16x16x32_bf16 v[152:155], v[40:43], v[104:107], v[152:155]
  v_mfma_f32_16x16x32_bf16 v[152:155], v[44:47], v[108:111], v[152:155]
  v_mfma_f32_16x16x32_bf16 v[168:171], v[48:51], v[104:107], v[168:171]
  v_mfma_f32_16x16x32_bf16 v[168:171], v[52:55], v[108:111], v[168:171]
  v_mfma_f32_16x16x32_bf16 v[164:167], v[48:51], v[96:99], v[164:167]
  v_mfma_f32_16x16x32_bf16 v[164:167], v[52:55], v[100:103], v[164:167]
  v_mfma_f32_16x16x32_bf16 v[160:163], v[48:51], v[88:91], v[160:163]
  v_mfma_f32_16x16x32_bf16 v[160:163], v[52:55], v[92:95], v[160:163]
  v_mfma_f32_16x16x32_bf16 v[156:159], v[48:51], v[80:83], v[156:159]
  v_mfma_f32_16x16x32_bf16 v[156:159], v[52:55], v[84:87], v[156:159]
  v_mfma_f32_16x16x32_bf16 v[172:175], v[56:59], v[80:83], v[172:175]
  v_mfma_f32_16x16x32_bf16 v[172:175], v[60:63], v[84:87], v[172:175]
  v_mfma_f32_16x16x32_bf16 v[176:179], v[56:59], v[88:91], v[176:179]
  v_mfma_f32_16x16x32_bf16 v[176:179], v[60:63], v[92:95], v[176:179]
  v_mfma_f32_16x16x32_bf16 v[180:183], v[56:59], v[96:99], v[180:183]
  v_mfma_f32_16x16x32_bf16 v[180:183], v[60:63], v[100:103], v[180:183]
  v_mfma_f32_16x16x32_bf16 v[184:187], v[56:59], v[104:107], v[184:187]
  v_mfma_f32_16x16x32_bf16 v[184:187], v[60:63], v[108:111], v[184:187]
  v_mfma_f32_16x16x32_bf16 v[200:203], v[64:67], v[104:107], v[200:203]
  v_mfma_f32_16x16x32_bf16 v[200:203], v[68:71], v[108:111], v[200:203]
  v_mfma_f32_16x16x32_bf16 v[196:199], v[64:67], v[96:99], v[196:199]
  v_mfma_f32_16x16x32_bf16 v[196:199], v[68:71], v[100:103], v[196:199]
  v_mfma_f32_16x16x32_bf16 v[192:195], v[64:67], v[88:91], v[192:195]
  v_mfma_f32_16x16x32_bf16 v[192:195], v[68:71], v[92:95], v[192:195]
  v_mfma_f32_16x16x32_bf16 v[188:191], v[64:67], v[80:83], v[188:191]
  v_mfma_f32_16x16x32_bf16 v[188:191], v[68:71], v[84:87], v[188:191]
  v_mfma_f32_16x16x32_bf16 v[204:207], v[72:75], v[80:83], v[204:207]
  v_mfma_f32_16x16x32_bf16 v[204:207], v[76:79], v[84:87], v[204:207]
  v_mfma_f32_16x16x32_bf16 v[208:211], v[72:75], v[88:91], v[208:211]
  v_mfma_f32_16x16x32_bf16 v[208:211], v[76:79], v[92:95], v[208:211]
  v_mfma_f32_16x16x32_bf16 v[212:215], v[72:75], v[96:99], v[212:215]
  v_mfma_f32_16x16x32_bf16 v[212:215], v[76:79], v[100:103], v[212:215]
  v_mfma_f32_16x16x32_bf16 v[216:219], v[72:75], v[104:107], v[216:219]
  s_setprio 2
  s_barrier
  v_mfma_f32_16x16x32_bf16 v[216:219], v[76:79], v[108:111], v[216:219]
  ds_read_b64_tr_b16 v[40:41], v6 offset:20480
  s_add_u32 m0, s75, 40960
  s_nop 0
  buffer_load_dwordx4 v29, s[44:47], s74 offen offset:0 lds
  ds_read_b64_tr_b16 v[42:43], v6 offset:23040
  ds_read_b64_tr_b16 v[44:45], v6 offset:40960
  ds_read_b64_tr_b16 v[46:47], v6 offset:43520
  ds_read_b64_tr_b16 v[48:49], v7 offset:20480
  buffer_load_dwordx4 v30, s[44:47], s74 offen offset:1024 lds
  ds_read_b64_tr_b16 v[50:51], v7 offset:23040
  ds_read_b64_tr_b16 v[52:53], v7 offset:40960
  ds_read_b64_tr_b16 v[54:55], v7 offset:43520
  ds_read_b64_tr_b16 v[56:57], v8 offset:20480
  buffer_load_dwordx4 v31, s[44:47], s74 offen offset:2048 lds
  ds_read_b64_tr_b16 v[58:59], v8 offset:23040
  ds_read_b64_tr_b16 v[60:61], v8 offset:40960
  ds_read_b64_tr_b16 v[62:63], v8 offset:43520
  ds_read_b64_tr_b16 v[64:65], v9 offset:20480
  buffer_load_dwordx4 v32, s[44:47], s74 offen offset:3072 lds
  ds_read_b64_tr_b16 v[66:67], v9 offset:23040
  ds_read_b64_tr_b16 v[68:69], v9 offset:40960
  ds_read_b64_tr_b16 v[70:71], v9 offset:43520
  ds_read_b128 v[80:83], v11 offset:8192
  s_add_u32 m0, m0, 4096
  s_nop 0
  buffer_load_dwordx4 v33, s[44:47], s74 offen offset:0 lds
  s_add_u32 s74, s74, 212992
  ds_read_b128 v[84:87], v12 offset:8192
  ds_read_b128 v[88:91], v11 offset:10240
  ds_read_b128 v[92:95], v12 offset:10240
  ds_read_b128 v[96:99], v11 offset:12288
  v_lshl_add_u32 v34, v242, 7, v15
  v_lshl_add_u32 v28, v26, 7, v14
  s_add_u32 m0, s76, 0
  s_nop 0
  buffer_load_dwordx4 v28, s[32:35], 0 offen lds
  ds_read_b128 v[100:103], v12 offset:12288
  ds_read_b128 v[104:107], v11 offset:14336
  ds_read_b128 v[108:111], v12 offset:14336
  ds_read_b64_tr_b16 v[72:73], v10 offset:20480
  s_add_u32 m0, m0, 1024
  s_nop 0
  buffer_load_dwordx4 v34, s[32:35], 0 offen lds
  ds_read_b64_tr_b16 v[74:75], v10 offset:23040
  ds_read_b64_tr_b16 v[76:77], v10 offset:40960
  ds_read_b64_tr_b16 v[78:79], v10 offset:43520
  buffer_load_dwordx3 v[24:26], v13, s[28:31], s73 offen offset:0
  buffer_load_dwordx3 v[240:242], v13, s[28:31], s73 offen offset:832
  s_add_u32 s73, s73, 12
  s_waitcnt vmcnt(9) lgkmcnt(0)
  s_barrier
  s_setprio 0
  v_mfma_f32_16x16x32_bf16 v[140:143], v[40:43], v[80:83], v[140:143]
  s_add_u32 s72, s72, 1
  v_mfma_f32_16x16x32_bf16 v[140:143], v[44:47], v[84:87], v[140:143]
  v_mfma_f32_16x16x32_bf16 v[144:147], v[40:43], v[88:91], v[144:147]
  v_mfma_f32_16x16x32_bf16 v[144:147], v[44:47], v[92:95], v[144:147]
  v_mfma_f32_16x16x32_bf16 v[148:151], v[40:43], v[96:99], v[148:151]
  v_mfma_f32_16x16x32_bf16 v[148:151], v[44:47], v[100:103], v[148:151]
  v_mfma_f32_16x16x32_bf16 v[152:155], v[40:43], v[104:107], v[152:155]
  v_mfma_f32_16x16x32_bf16 v[152:155], v[44:47], v[108:111], v[152:155]
  v_mfma_f32_16x16x32_bf16 v[168:171], v[48:51], v[104:107], v[168:171]
  v_mfma_f32_16x16x32_bf16 v[168:171], v[52:55], v[108:111], v[168:171]
  v_mfma_f32_16x16x32_bf16 v[164:167], v[48:51], v[96:99], v[164:167]
  v_mfma_f32_16x16x32_bf16 v[164:167], v[52:55], v[100:103], v[164:167]
  v_mfma_f32_16x16x32_bf16 v[160:163], v[48:51], v[88:91], v[160:163]
  v_mfma_f32_16x16x32_bf16 v[160:163], v[52:55], v[92:95], v[160:163]
  v_mfma_f32_16x16x32_bf16 v[156:159], v[48:51], v[80:83], v[156:159]
  v_mfma_f32_16x16x32_bf16 v[156:159], v[52:55], v[84:87], v[156:159]
  v_mfma_f32_16x16x32_bf16 v[172:175], v[56:59], v[80:83], v[172:175]
  v_mfma_f32_16x16x32_bf16 v[172:175], v[60:63], v[84:87], v[172:175]
  v_mfma_f32_16x16x32_bf16 v[176:179], v[56:59], v[88:91], v[176:179]
  v_mfma_f32_16x16x32_bf16 v[176:179], v[60:63], v[92:95], v[176:179]
  s_cmp_lt_u32 s72, 4
  v_mfma_f32_16x16x32_bf16 v[180:183], v[56:59], v[96:99], v[180:183]
  v_mfma_f32_16x16x32_bf16 v[180:183], v[60:63], v[100:103], v[180:183]
  v_mfma_f32_16x16x32_bf16 v[184:187], v[56:59], v[104:107], v[184:187]
  v_mfma_f32_16x16x32_bf16 v[184:187], v[60:63], v[108:111], v[184:187]
  v_mfma_f32_16x16x32_bf16 v[200:203], v[64:67], v[104:107], v[200:203]
  v_mfma_f32_16x16x32_bf16 v[200:203], v[68:71], v[108:111], v[200:203]
  v_mfma_f32_16x16x32_bf16 v[196:199], v[64:67], v[96:99], v[196:199]
  v_mfma_f32_16x16x32_bf16 v[196:199], v[68:71], v[100:103], v[196:199]
  v_mfma_f32_16x16x32_bf16 v[192:195], v[64:67], v[88:91], v[192:195]
  v_mfma_f32_16x16x32_bf16 v[192:195], v[68:71], v[92:95], v[192:195]
  v_mfma_f32_16x16x32_bf16 v[188:191], v[64:67], v[80:83], v[188:191]
  v_mfma_f32_16x16x32_bf16 v[188:191], v[68:71], v[84:87], v[188:191]
  v_mfma_f32_16x16x32_bf16 v[204:207], v[72:75], v[80:83], v[204:207]
  v_mfma_f32_16x16x32_bf16 v[204:207], v[76:79], v[84:87], v[204:207]
  v_mfma_f32_16x16x32_bf16 v[208:211], v[72:75], v[88:91], v[208:211]
  v_mfma_f32_16x16x32_bf16 v[208:211], v[76:79], v[92:95], v[208:211]
  v_mfma_f32_16x16x32_bf16 v[212:215], v[72:75], v[96:99], v[212:215]
  v_mfma_f32_16x16x32_bf16 v[212:215], v[76:79], v[100:103], v[212:215]
  v_mfma_f32_16x16x32_bf16 v[216:219], v[72:75], v[104:107], v[216:219]
  s_setprio 2
  s_barrier
  v_mfma_f32_16x16x32_bf16 v[216:219], v[76:79], v[108:111], v[216:219]
  s_cbranch_scc1 L_dnn_loop0
  ds_read_b64_tr_b16 v[40:41], v1 offset:0
  v_lshl_add_u32 v34, v20, 7, v15
  v_lshl_add_u32 v28, v16, 7, v14
  s_add_u32 m0, s76, 8192
  s_nop 0
  buffer_load_dwordx4 v28, s[32:35], 0 offen lds
  ds_read_b64_tr_b16 v[42:43], v1 offset:2560
  ds_read_b64_tr_b16 v[44:45], v1 offset:20480
  ds_read_b64_tr_b16 v[46:47], v1 offset:23040
  ds_read_b64_tr_b16 v[48:49], v2 offset:0
  ds_read_b64_tr_b16 v[50:51], v2 offset:2560
  ds_read_b64_tr_b16 v[52:53], v2 offset:20480
  ds_read_b64_tr_b16 v[54:55], v2 offset:23040
  ds_read_b64_tr_b16 v[56:57], v3 offset:0
  ds_read_b64_tr_b16 v[58:59], v3 offset:2560
  ds_read_b64_tr_b16 v[60:61], v3 offset:20480
  ds_read_b64_tr_b16 v[62:63], v3 offset:23040
  ds_read_b64_tr_b16 v[64:65], v4 offset:0
  ds_read_b64_tr_b16 v[66:67], v4 offset:2560
  ds_read_b64_tr_b16 v[68:69], v4 offset:20480
  ds_read_b64_tr_b16 v[70:71], v4 offset:23040
  ds_read_b128 v[80:83], v11 offset:0
  s_add_u32 m0, m0, 1024
  s_nop 0
  buffer_load_dwordx4 v34, s[32:35], 0 offen lds
  ds_read_b128 v[84:87], v12 offset:0
  ds_read_b128 v[88:91], v11 offset:2048
  ds_read_b128 v[92:95], v12 offset:2048
  ds_read_b128 v[96:99], v11 offset:4096
  ds_read_b128 v[100:103], v12 offset:4096
  ds_read_b128 v[104:107], v11 offset:6144
  ds_read_b128 v[108:111], v12 offset:6144
  ds_read_b64_tr_b16 v[72:73], v5 offset:0
  ds_read_b64_tr_b16 v[74:75], v5 offset:2560
  ds_read_b64_tr_b16 v[76:77], v5 offset:20480
  ds_read_b64_tr_b16 v[78:79], v5 offset:23040
  ds_read_b64 v[220:221], v35 offset:640
  ds_read_b64 v[222:223], v35 offset:672
  ds_read_b64 v[224:225], v35 offset:704
  ds_read_b64 v[226:227], v35 offset:736
  ds_read_b64 v[228:229], v35 offset:768
  s_mov_b32 s60, s24
  s_and_b32 s61, s25, 0xffff
  s_mov_b32 s62, 268435456
  s_mov_b32 s63, 0x20000
  s_mov_b32 s64, s22
  s_and_b32 s65, s23, 0xffff
  s_mov_b32 s66, 256
  s_mov_b32 s67, 0x20000
  v_lshlrev_b32 v28, 2, v0
  s_mov_b64 exec, 0xff
  s_mov_b32 s81, 0x80000
  buffer_load_dword v255, v28, s[60:63], s81 offen
  buffer_load_dword v37, v28, s[64:67], 0 offen offset:128 sc1
  s_mov_b64 exec, -1
  v_mov_b32 v28, 0
  s_waitcnt vmcnt(6) lgkmcnt(0)
  s_barrier
  s_setprio 0
  v_mfma_f32_16x16x32_bf16 v[140:143], v[40:43], v[80:83], v[140:143]
  v_mov_b32 v232, 0xc0135761
  v_mov_b32 v233, 0xc0135761
  v_mfma_f32_16x16x32_bf16 v[140:143], v[44:47], v[84:87], v[140:143]
  v_mov_b32 v234, 0xbdd2d3e8
  v_mfma_f32_16x16x32_bf16 v[144:147], v[40:43], v[88:91], v[144:147]
  v_mov_b32 v235, 0xbdd2d3e8
  v_mfma_f32_16x16x32_bf16 v[144:147], v[44:47], v[92:95], v[144:147]
  v_mov_b32 v236, 0x71800000
  v_mfma_f32_16x16x32_bf16 v[148:151], v[40:43], v[96:99], v[148:151]
  v_lshlrev_b32 v112, 16, v220
  v_mfma_f32_16x16x32_bf16 v[148:151], v[44:47], v[100:103], v[148:151]
  v_and_b32 v113, 0xffff0000, v220
  v_mfma_f32_16x16x32_bf16 v[152:155], v[40:43], v[104:107], v[152:155]
  v_lshlrev_b32 v114, 16, v221
  v_mfma_f32_16x16x32_bf16 v[152:155], v[44:47], v[108:111], v[152:155]
  v_and_b32 v115, 0xffff0000, v221
  v_mfma_f32_16x16x32_bf16 v[168:171], v[48:51], v[104:107], v[168:171]
  v_lshlrev_b32 v116, 16, v222
  v_mfma_f32_16x16x32_bf16 v[168:171], v[52:55], v[108:111], v[168:171]
  v_and_b32 v117, 0xffff0000, v222
  v_mfma_f32_16x16x32_bf16 v[164:167], v[48:51], v[96:99], v[164:167]
  v_lshlrev_b32 v118, 16, v223
  v_mfma_f32_16x16x32_bf16 v[164:167], v[52:55], v[100:103], v[164:167]
  v_and_b32 v119, 0xffff0000, v223
  v_mfma_f32_16x16x32_bf16 v[160:163], v[48:51], v[88:91], v[160:163]
  v_lshlrev_b32 v120, 16, v224
  v_mfma_f32_16x16x32_bf16 v[160:163], v[52:55], v[92:95], v[160:163]
  v_and_b32 v121, 0xffff0000, v224
  v_mfma_f32_16x16x32_bf16 v[156:159], v[48:51], v[80:83], v[156:159]
  v_lshlrev_b32 v122, 16, v225
  v_mfma_f32_16x16x32_bf16 v[156:159], v[52:55], v[84:87], v[156:159]
  v_and_b32 v123, 0xffff0000, v225
  v_mfma_f32_16x16x32_bf16 v[172:175], v[56:59], v[80:83], v[172:175]
  v_lshlrev_b32 v124, 16, v226
  v_mfma_f32_16x16x32_bf16 v[172:175], v[60:63], v[84:87], v[172:175]
  v_and_b32 v125, 0xffff0000, v226
  v_mfma_f32_16x16x32_bf16 v[176:179], v[56:59], v[88:91], v[176:179]
  v_lshlrev_b32 v126, 16, v227
  v_mfma_f32_16x16x32_bf16 v[176:179], v[60:63], v[92:95], v[176:179]
  v_and_b32 v127, 0xffff0000, v227
  v_mfma_f32_16x16x32_bf16 v[180:183], v[56:59], v[96:99], v[180:183]
  v_lshlrev_b32 v128, 16, v228
  v_mfma_f32_16x16x32_bf16 v[180:183], v[60:63], v[100:103], v[180:183]
  v_and_b32 v129, 0xffff0000, v228
  v_mfma_f32_16x16x32_bf16 v[184:187], v[56:59], v[104:107], v[184:187]
  v_lshlrev_b32 v130, 16, v229
  v_mfma_f32_16x16x32_bf16 v[184:187], v[60:63], v[108:111], v[184:187]
  v_and_b32 v131, 0xffff0000, v229
  v_mfma_f32_16x16x32_bf16 v[200:203], v[64:67], v[104:107], v[200:203]
  v_rcp_f32 v112, v112
  v_mfma_f32_16x16x32_bf16 v[200:203], v[68:71], v[108:111], v[200:203]
  v_rcp_f32 v113, v113
  v_mfma_f32_16x16x32_bf16 v[196:199], v[64:67], v[96:99], v[196:199]
  v_rcp_f32 v114, v114
  v_mfma_f32_16x16x32_bf16 v[196:199], v[68:71], v[100:103], v[196:199]
  v_rcp_f32 v115, v115
  v_mfma_f32_16x16x32_bf16 v[192:195], v[64:67], v[88:91], v[192:195]
  v_rcp_f32 v116, v116
  v_mfma_f32_16x16x32_bf16 v[192:195], v[68:71], v[92:95], v[192:195]
  v_rcp_f32 v117, v117
  v_mfma_f32_16x16x32_bf16 v[188:191], v[64:67], v[80:83], v[188:191]
  v_rcp_f32 v118, v118
  v_mfma_f32_16x16x32_bf16 v[188:191], v[68:71], v[84:87], v[188:191]
  v_rcp_f32 v119, v119
  v_mfma_f32_16x16x32_bf16 v[204:207], v[72:75], v[80:83], v[204:207]
  v_rcp_f32 v120, v120
  v_mfma_f32_16x16x32_bf16 v[204:207], v[76:79], v[84:87], v[204:207]
  v_rcp_f32 v121, v121
  v_mfma_f32_16x16x32_bf16 v[208:211], v[72:75], v[88:91], v[208:211]
  v_rcp_f32 v122, v122
  v_mfma_f32_16x16x32_bf16 v[208:211], v[76:79], v[92:95], v[208:211]
  v_rcp_f32 v123, v123
  v_mfma_f32_16x16x32_bf16 v[212:215], v[72:75], v[96:99], v[212:215]
  v_rcp_f32 v124, v124
  v_mfma_f32_16x16x32_bf16 v[212:215], v[76:79], v[100:103], v[212:215]
  v_rcp_f32 v125, v125
  v_mfma_f32_16x16x32_bf16 v[216:219], v[72:75], v[104:107], v[216:219]
  s_setprio 2
  s_barrier
  v_mfma_f32_16x16x32_bf16 v[216:219], v[76:79], v[108:111], v[216:219]
  ds_read_b64_tr_b16 v[40:41], v1 offset:40960
  ds_read_b64_tr_b16 v[42:43], v1 offset:43520
  ds_read_b64_tr_b16 v[44:45], v6 offset:0
  ds_read_b64_tr_b16 v[46:47], v6 offset:2560
  ds_read_b64_tr_b16 v[48:49], v2 offset:40960
  ds_read_b64_tr_b16 v[50:51], v2 offset:43520
  ds_read_b64_tr_b16 v[52:53], v7 offset:0
  ds_read_b64_tr_b16 v[54:55], v7 offset:2560
  ds_read_b64_tr_b16 v[56:57], v3 offset:40960
  ds_read_b64_tr_b16 v[58:59], v3 offset:43520
  ds_read_b64_tr_b16 v[60:61], v8 offset:0
  ds_read_b64_tr_b16 v[62:63], v8 offset:2560
  ds_read_b64_tr_b16 v[64:65], v4 offset:40960
  ds_read_b64_tr_b16 v[66:67], v4 offset:43520
  ds_read_b64_tr_b16 v[68:69], v9 offset:0
  ds_read_b64_tr_b16 v[70:71], v9 offset:2560
  ds_read_b128 v[80:83], v11 offset:8192
  ds_read_b128 v[84:87], v12 offset:8192
  ds_read_b128 v[88:91], v11 offset:10240
  ds_read_b128 v[92:95], v12 offset:10240
  ds_read_b128 v[96:99], v11 offset:12288
  ds_read_b128 v[100:103], v12 offset:12288
  ds_read_b128 v[104:107], v11 offset:14336
  ds_read_b128 v[108:111], v12 offset:14336
  ds_read_b64_tr_b16 v[72:73], v5 offset:40960
  ds_read_b64_tr_b16 v[74:75], v5 offset:43520
  ds_read_b64_tr_b16 v[76:77], v10 offset:0
  ds_read_b64_tr_b16 v[78:79], v10 offset:2560
  s_waitcnt vmcnt(2) lgkmcnt(0)
  s_barrier
  s_setprio 0
  v_mfma_f32_16x16x32_bf16 v[140:143], v[40:43], v[80:83], v[140:143]
  v_rcp_f32 v126, v126
  v_mfma_f32_16x16x32_bf16 v[140:143], v[44:47], v[84:87], v[140:143]
  v_rcp_f32 v127, v127
  v_mfma_f32_16x16x32_bf16 v[144:147], v[40:43], v[88:91], v[144:147]
  v_rcp_f32 v128, v128
  v_mfma_f32_16x16x32_bf16 v[144:147], v[44:47], v[92:95], v[144:147]
  v_mfma_f32_16x16x32_bf16 v[148:151], v[40:43], v[96:99], v[148:151]
  v_rcp_f32 v129, v129
  v_mfma_f32_16x16x32_bf16 v[148:151], v[44:47], v[100:103], v[148:151]
  v_rcp_f32 v130, v130
  v_mfma_f32_16x16x32_bf16 v[152:155], v[40:43], v[104:107], v[152:155]
  v_mfma_f32_16x16x32_bf16 v[152:155], v[44:47], v[108:111], v[152:155]
  v_rcp_f32 v131, v131
  v_mfma_f32_16x16x32_bf16 v[168:171], v[48:51], v[104:107], v[168:171]
  v_med3_f32 v112, v112, -v236, v236
  v_mfma_f32_16x16x32_bf16 v[168:171], v[52:55], v[108:111], v[168:171]
  v_mfma_f32_16x16x32_bf16 v[164:167], v[48:51], v[96:99], v[164:167]
  v_med3_f32 v113, v113, -v236, v236
  v_mfma_f32_16x16x32_bf16 v[164:167], v[52:55], v[100:103], v[164:167]
  v_med3_f32 v114, v114, -v236, v236
  v_mfma_f32_16x16x32_bf16 v[160:163], v[48:51], v[88:91], v[160:163]
  v_mfma_f32_16x16x32_bf16 v[160:163], v[52:55], v[92:95], v[160:163]
  v_med3_f32 v115, v115, -v236, v236
  v_mfma_f32_16x16x32_bf16 v[156:159], v[48:51], v[80:83], v[156:159]
  v_med3_f32 v116, v116, -v236, v236
  v_mfma_f32_16x16x32_bf16 v[156:159], v[52:55], v[84:87], v[156:159]
  v_mfma_f32_16x16x32_bf16 v[172:175], v[56:59], v[80:83], v[172:175]
  v_med3_f32 v117, v117, -v236, v236
  v_mfma_f32_16x16x32_bf16 v[172:175], v[60:63], v[84:87], v[172:175]
  v_med3_f32 v118, v118, -v236, v236
  v_mfma_f32_16x16x32_bf16 v[176:179], v[56:59], v[88:91], v[176:179]
  v_mfma_f32_16x16x32_bf16 v[176:179], v[60:63], v[92:95], v[176:179]
  v_med3_f32 v119, v119, -v236, v236
  v_mfma_f32_16x16x32_bf16 v[180:183], v[56:59], v[96:99], v[180:183]
  v_med3_f32 v120, v120, -v236, v236
  v_mfma_f32_16x16x32_bf16 v[180:183], v[60:63], v[100:103], v[180:183]
  v_med3_f32 v121, v121, -v236, v236
  v_mfma_f32_16x16x32_bf16 v[184:187], v[56:59], v[104:107], v[184:187]
  v_mfma_f32_16x16x32_bf16 v[184:187], v[60:63], v[108:111], v[184:187]
  v_med3_f32 v122, v122, -v236, v236
  v_mfma_f32_16x16x32_bf16 v[200:203], v[64:67], v[104:107], v[200:203]
  v_med3_f32 v123, v123, -v236, v236
  v_mfma_f32_16x16x32_bf16 v[200:203], v[68:71], v[108:111], v[200:203]
  v_mfma_f32_16x16x32_bf16 v[196:199], v[64:67], v[96:99], v[196:199]
  v_med3_f32 v124, v124, -v236, v236
  v_mfma_f32_16x16x32_bf16 v[196:199], v[68:71], v[100:103], v[196:199]
  v_med3_f32 v125, v125, -v236, v236
  v_mfma_f32_16x16x32_bf16 v[192:195], v[64:67], v[88:91], v[192:195]
  v_mfma_f32_16x16x32_bf16 v[192:195], v[68:71], v[92:95], v[192:195]
  v_med3_f32 v126, v126, -v236, v236
  v_mfma_f32_16x16x32_bf16 v[188:191], v[64:67], v[80:83], v[188:191]
  v_med3_f32 v127, v127, -v236, v236
  v_mfma_f32_16x16x32_bf16 v[188:191], v[68:71], v[84:87], v[188:191]
  v_mfma_f32_16x16x32_bf16 v[204:207], v[72:75], v[80:83], v[204:207]
  v_med3_f32 v128, v128, -v236, v236
  v_mfma_f32_16x16x32_bf16 v[204:207], v[76:79], v[84:87], v[204:207]
  v_med3_f32 v129, v129, -v236, v236
  v_mfma_f32_16x16x32_bf16 v[208:211], v[72:75], v[88:91], v[208:211]
  v_mfma_f32_16x16x32_bf16 v[208:211], v[76:79], v[92:95], v[208:211]
  v_med3_f32 v130, v130, -v236, v236
  v_mfma_f32_16x16x32_bf16 v[212:215], v[72:75], v[96:99], v[212:215]
  v_med3_f32 v131, v131, -v236, v236
  v_mfma_f32_16x16x32_bf16 v[212:215], v[76:79], v[100:103], v[212:215]
  v_mfma_f32_16x16x32_bf16 v[216:219], v[72:75], v[104:107], v[216:219]
  s_setprio 2
  s_barrier
  v_mfma_f32_16x16x32_bf16 v[216:219], v[76:79], v[108:111], v[216:219]
  s_setprio 0
  s_branch L_epi
L_dnn_h1:
  v_lshl_add_u32 v34, v117, 7, v15
  v_lshl_add_u32 v28, v113, 7, v14
  s_add_u32 m0, s76, 8192
  s_nop 0
  buffer_load_dwordx4 v28, s[32:35], 0 offen lds
  s_add_u32 m0, m0, 1024
  s_nop 0
  buffer_load_dwordx4 v34, s[32:35], 0 offen lds
  s_add_u32 m0, s75, 40960
  s_nop 0
  buffer_load_dwordx4 v29, s[44:47], s74 offen offset:0 lds
  buffer_load_dwordx4 v30, s[44:47], s74 offen offset:1024 lds
  buffer_load_dwordx4 v31, s[44:47], s74 offen offset:2048 lds
  buffer_load_dwordx4 v32, s[44:47], s74 offen offset:3072 lds
  s_add_u32 m0, m0, 4096
  s_nop 0
  buffer_load_dwordx4 v33, s[44:47], s74 offen offset:0 lds
  s_add_u32 s74, s74, 212992
  s_waitcnt vmcnt(13)
  s_waitcnt vmcnt(10) lgkmcnt(0)
  s_barrier
  buffer_load_dwordx3 v[24:26], v13, s[28:31], s73 offen offset:0
  buffer_load_dwordx3 v[240:242], v13, s[28:31], s73 offen offset:832
  s_add_u32 s73, s73, 12
  s_barrier
L_dnn_loop1:
  ds_read_b64_tr_b16 v[40:41], v1 offset:0
  s_add_u32 m0, s75, 81920
  s_nop 0
  buffer_load_dwordx4 v29, s[44:47], s74 offen offset:0 lds
  ds_read_b64_tr_b16 v[42:43], v1 offset:2560
  ds_read_b64_tr_b16 v[44:45], v1 offset:20480
  ds_read_b64_tr_b16 v[46:47], v1 offset:23040
  ds_read_b64_tr_b16 v[48:49], v2 offset:0
  buffer_load_dwordx4 v30, s[44:47], s74 offen offset:1024 lds
  ds_read_b64_tr_b16 v[50:51], v2 offset:2560
  ds_read_b64_tr_b16 v[52:53], v2 offset:20480
  ds_read_b64_tr_b16 v[54:55], v2 offset:23040
  ds_read_b64_tr_b16 v[56:57], v3 offset:0
  buffer_load_dwordx4 v31, s[44:47], s74 offen offset:2048 lds
  ds_read_b64_tr_b16 v[58:59], v3 offset:2560
  ds_read_b64_tr_b16 v[60:61], v3 offset:20480
  ds_read_b64_tr_b16 v[62:63], v3 offset:23040
  ds_read_b64_tr_b16 v[64:65], v4 offset:0
  buffer_load_dwordx4 v32, s[44:47], s74 offen offset:3072 lds
  ds_read_b64_tr_b16 v[66:67], v4 offset:2560
  ds_read_b64_tr_b16 v[68:69], v4 offset:20480
  ds_read_b64_tr_b16 v[70:71], v4 offset:23040
  ds_read_b128 v[80:83], v11 offset:0
  s_add_u32 m0, m0, 4096
  s_nop 0
  buffer_load_dwordx4 v33, s[44:47], s74 offen offset:0 lds
  s_add_u32 s74, s74, 212992
  ds_read_b128 v[84:87], v12 offset:0
  ds_read_b128 v[88:91], v11 offset:2048
  ds_read_b128 v[92:95], v12 offset:2048
  ds_read_b128 v[96:99], v11 offset:4096
  s_waitcnt vmcnt(14)
  v_lshl_add_u32 v34, v20, 7, v15
  v_lshl_add_u32 v28, v16, 7, v14
  s_add_u32 m0, s76, 0
  s_nop 0
  buffer_load_dwordx4 v28, s[32:35], 0 offen lds
  ds_read_b128 v[100:103], v12 offset:4096
  ds_read_b128 v[104:107], v11 offset:6144
  ds_read_b128 v[108:111], v12 offset:6144
  ds_read_b64_tr_b16 v[72:73], v5 offset:0
  s_add_u32 m0, m0, 1024
  s_nop 0
  buffer_load_dwordx4 v34, s[32:35], 0 offen lds
  ds_read_b64_tr_b16 v[74:75], v5 offset:2560
  ds_read_b64_tr_b16 v[76:77], v5 offset:20480
  ds_read_b64_tr_b16 v[78:79], v5 offset:23040
  s_waitcnt vmcnt(9) lgkmcnt(0)
  s_waitcnt vmcnt(9)
  s_barrier
  s_setprio 0
  v_mfma_f32_16x16x32_bf16 v[140:143], v[40:43], v[80:83], v[140:143]
  v_mfma_f32_16x16x32_bf16 v[140:143], v[44:47], v[84:87], v[140:143]
  v_mfma_f32_16x16x32_bf16 v[144:147], v[40:43], v[88:91], v[144:147]
  v_mfma_f32_16x16x32_bf16 v[144:147], v[44:47], v[92:95], v[144:147]
  v_mfma_f32_16x16x32_bf16 v[148:151], v[40:43], v[96:99], v[148:151]
  v_mfma_f32_16x16x32_bf16 v[148:151], v[44:47], v[100:103], v[148:151]
  v_mfma_f32_16x16x32_bf16 v[152:155], v[40:43], v[104:107], v[152:155]
  v_mfma_f32_16x16x32_bf16 v[152:155], v[44:47], v[108:111], v[152:155]
  v_mfma_f32_16x16x32_bf16 v[168:171], v[48:51], v[104:107], v[168:171]
  v_mfma_f32_16x16x32_bf16 v[168:171], v[52:55], v[108:111], v[168:171]
  v_mfma_f32_16x16x32_bf16 v[164:167], v[48:51], v[96:99], v[164:167]
  v_mfma_f32_16x16x32_bf16 v[164:167], v[52:55], v[100:103], v[164:167]
  v_mfma_f32_16x16x32_bf16 v[160:163], v[48:51], v[88:91], v[160:163]
  v_mfma_f32_16x16x32_bf16 v[160:163], v[52:55], v[92:95], v[160:163]
  v_mfma_f32_16x16x32_bf16 v[156:159], v[48:51], v[80:83], v[156:159]
  v_mfma_f32_16x16x32_bf16 v[156:159], v[52:55], v[84:87], v[156:159]
  v_mfma_f32_16x16x32_bf16 v[172:175], v[56:59], v[80:83], v[172:175]
  v_mfma_f32_16x16x32_bf16 v[172:175], v[60:63], v[84:87], v[172:175]
  v_mfma_f32_16x16x32_bf16 v[176:179], v[56:59], v[88:91], v[176:179]
  v_mfma_f32_16x16x32_bf16 v[176:179], v[60:63], v[92:95], v[176:179]
  v_mfma_f32_16x16x32_bf16 v[180:183], v[56:59], v[96:99], v[180:183]
  v_mfma_f32_16x16x32_bf16 v[180:183], v[60:63], v[100:103], v[180:183]
  v_mfma_f32_16x16x32_bf16 v[184:187], v[56:59], v[104:107], v[184:187]
  v_mfma_f32_16x16x32_bf16 v[184:187], v[60:63], v[108:111], v[184:187]
  v_mfma_f32_16x16x32_bf16 v[200:203], v[64:67], v[104:107], v[200:203]
  v_mfma_f32_16x16x32_bf16 v[200:203], v[68:71], v[108:111], v[200:203]
  v_mfma_f32_16x16x32_bf16 v[196:199], v[64:67], v[96:99], v[196:199]
  v_mfma_f32_16x16x32_bf16 v[196:199], v[68:71], v[100:103], v[196:199]
  v_mfma_f32_16x16x32_bf16 v[192:195], v[64:67], v[88:91], v[192:195]
  v_mfma_f32_16x16x32_bf16 v[192:195], v[68:71], v[92:95], v[192:195]
  v_mfma_f32_16x16x32_bf16 v[188:191], v[64:67], v[80:83], v[188:191]
  v_mfma_f32_16x16x32_bf16 v[188:191], v[68:71], v[84:87], v[188:191]
  v_mfma_f32_16x16x32_bf16 v[204:207], v[72:75], v[80:83], v[204:207]
  v_mfma_f32_16x16x32_bf16 v[204:207], v[76:79], v[84:87], v[204:207]
  v_mfma_f32_16x16x32_bf16 v[208:211], v[72:75], v[88:91], v[208:211]
  v_mfma_f32_16x16x32_bf16 v[208:211], v[76:79], v[92:95], v[208:211]
  v_mfma_f32_16x16x32_bf16 v[212:215], v[72:75], v[96:99], v[212:215]
  v_mfma_f32_16x16x32_bf16 v[212:215], v[76:79], v[100:103], v[212:215]
  v_mfma_f32_16x16x32_bf16 v[216:219], v[72:75], v[104:107], v[216:219]
  s_setprio 2
  s_barrier
  v_mfma_f32_16x16x32_bf16 v[216:219], v[76:79], v[108:111], v[216:219]
  ds_read_b64_tr_b16 v[40:41], v1 offset:40960
  s_add_u32 m0, s75, 0
  s_nop 0
  buffer_load_dwordx4 v29, s[44:47], s74 offen offset:0 lds
  ds_read_b64_tr_b16 v[42:43], v1 offset:43520
  ds_read_b64_tr_b16 v[44:45], v6 offset:0
  ds_read_b64_tr_b16 v[46:47], v6 offset:2560
  ds_read_b64_tr_b16 v[48:49], v2 offset:40960
  buffer_load_dwordx4 v30, s[44:47], s74 offen offset:1024 lds
  ds_read_b64_tr_b16 v[50:51], v2 offset:43520
  ds_read_b64_tr_b16 v[52:53], v7 offset:0
  ds_read_b64_tr_b16 v[54:55], v7 offset:2560
  ds_read_b64_tr_b16 v[56:57], v3 offset:40960
  buffer_load_dwordx4 v31, s[44:47], s74 offen offset:2048 lds
  ds_read_b64_tr_b16 v[58:59], v3 offset:43520
  ds_read_b64_tr_b16 v[60:61], v8 offset:0
  ds_read_b64_tr_b16 v[62:63], v8 offset:2560
  ds_read_b64_tr_b16 v[64:65], v4 offset:40960
  buffer_load_dwordx4 v32, s[44:47], s74 offen offset:3072 lds
  ds_read_b64_tr_b16 v[66:67], v4 offset:43520
  ds_read_b64_tr_b16 v[68:69], v9 offset:0
  ds_read_b64_tr_b16 v[70:71], v9 offset:2560
  ds_read_b128 v[80:83], v11 offset:8192
  s_add_u32 m0, m0, 4096
  s_nop 0
  buffer_load_dwordx4 v33, s[44:47], s74 offen offset:0 lds
  s_add_u32 s74, s74, 212992
  ds_read_b128 v[84:87], v12 offset:8192
  ds_read_b128 v[88:91], v11 offset:10240
  ds_read_b128 v[92:95], v12 offset:10240
  ds_read_b128 v[96:99], v11 offset:12288
  v_lshl_add_u32 v34, v21, 7, v15
  v_lshl_add_u32 v28, v17, 7, v14
  s_add_u32 m0, s76, 8192
  s_nop 0
  buffer_load_dwordx4 v28, s[32:35], 0 offen lds
  ds_read_b128 v[100:103], v12 offset:12288
  ds_read_b128 v[104:107], v11 offset:14336
  ds_read_b128 v[108:111], v12 offset:14336
  ds_read_b64_tr_b16 v[72:73], v5 offset:40960
  s_add_u32 m0, m0, 1024
  s_nop 0
  buffer_load_dwordx4 v34, s[32:35], 0 offen lds
  ds_read_b64_tr_b16 v[74:75], v5 offset:43520
  ds_read_b64_tr_b16 v[76:77], v10 offset:0
  ds_read_b64_tr_b16 v[78:79], v10 offset:2560
  s_waitcnt vmcnt(7) lgkmcnt(0)
  s_barrier
  s_setprio 0
  v_mfma_f32_16x16x32_bf16 v[140:143], v[40:43], v[80:83], v[140:143]
  v_mfma_f32_16x16x32_bf16 v[140:143], v[44:47], v[84:87], v[140:143]
  v_mfma_f32_16x16x32_bf16 v[144:147], v[40:43], v[88:91], v[144:147]
  v_mfma_f32_16x16x32_bf16 v[144:147], v[44:47], v[92:95], v[144:147]
  v_mfma_f32_16x16x32_bf16 v[148:151], v[40:43], v[96:99], v[148:151]
  v_mfma_f32_16x16x32_bf16 v[148:151], v[44:47], v[100:103], v[148:151]
  v_mfma_f32_16x16x32_bf16 v[152:155], v[40:43], v[104:107], v[152:155]
  v_mfma_f32_16x16x32_bf16 v[152:155], v[44:47], v[108:111], v[152:155]
  v_mfma_f32_16x16x32_bf16 v[168:171], v[48:51], v[104:107], v[168:171]
  v_mfma_f32_16x16x32_bf16 v[168:171], v[52:55], v[108:111], v[168:171]
  v_mfma_f32_16x16x32_bf16 v[164:167], v[48:51], v[96:99], v[164:167]
  v_mfma_f32_16x16x32_bf16 v[164:167], v[52:55], v[100:103], v[164:167]
  v_mfma_f32_16x16x32_bf16 v[160:163], v[48:51], v[88:91], v[160:163]
  v_mfma_f32_16x16x32_bf16 v[160:163], v[52:55], v[92:95], v[160:163]
  v_mfma_f32_16x16x32_bf16 v[156:159], v[48:51], v[80:83], v[156:159]
  v_mfma_f32_16x16x32_bf16 v[156:159], v[52:55], v[84:87], v[156:159]
  v_mfma_f32_16x16x32_bf16 v[172:175], v[56:59], v[80:83], v[172:175]
  v_mfma_f32_16x16x32_bf16 v[172:175], v[60:63], v[84:87], v[172:175]
  v_mfma_f32_16x16x32_bf16 v[176:179], v[56:59], v[88:91], v[176:179]
  v_mfma_f32_16x16x32_bf16 v[176:179], v[60:63], v[92:95], v[176:179]
  v_mfma_f32_16x16x32_bf16 v[180:183], v[56:59], v[96:99], v[180:183]
  v_mfma_f32_16x16x32_bf16 v[180:183], v[60:63], v[100:103], v[180:183]
  v_mfma_f32_16x16x32_bf16 v[184:187], v[56:59], v[104:107], v[184:187]
  v_mfma_f32_16x16x32_bf16 v[184:187], v[60:63], v[108:111], v[184:187]
  v_mfma_f32_16x16x32_bf16 v[200:203], v[64:67], v[104:107], v[200:203]
  v_mfma_f32_16x16x32_bf16 v[200:203], v[68:71], v[108:111], v[200:203]
  v_mfma_f32_16x16x32_bf16 v[196:199], v[64:67], v[96:99], v[196:199]
  v_mfma_f32_16x16x32_bf16 v[196:199], v[68:71], v[100:103], v[196:199]
  v_mfma_f32_16x16x32_bf16 v[192:195], v[64:67], v[88:91], v[192:195]
  v_mfma_f32_16x16x32_bf16 v[192:195], v[68:71], v[92:95], v[192:195]
  v_mfma_f32_16x16x32_bf16 v[188:191], v[64:67], v[80:83], v[188:191]
  v_mfma_f32_16x16x32_bf16 v[188:191], v[68:71], v[84:87], v[188:191]
  v_mfma_f32_16x16x32_bf16 v[204:207], v[72:75], v[80:83], v[204:207]
  v_mfma_f32_16x16x32_bf16 v[204:207], v[76:79], v[84:87], v[204:207]
  v_mfma_f32_16x16x32_bf16 v[208:211], v[72:75], v[88:91], v[208:211]
  v_mfma_f32_16x16x32_bf16 v[208:211], v[76:79], v[92:95], v[208:211]
  v_mfma_f32_16x16x32_bf16 v[212:215], v[72:75], v[96:99], v[212:215]
  v_mfma_f32_16x16x32_bf16 v[212:215], v[76:79], v[100:103], v[212:215]
  v_mfma_f32_16x16x32_bf16 v[216:219], v[72:75], v[104:107], v[216:219]
  s_setprio 2
  s_barrier
  v_mfma_f32_16x16x32_bf16 v[216:219], v[76:79], v[108:111], v[216:219]
  ds_read_b64_tr_b16 v[40:41], v6 offset:20480
  s_add_u32 m0, s75, 40960
  s_nop 0
  buffer_load_dwordx4 v29, s[44:47], s74 offen offset:0 lds
  ds_read_b64_tr_b16 v[42:43], v6 offset:23040
  ds_read_b64_tr_b16 v[44:45], v6 offset:40960
  ds_read_b64_tr_b16 v[46:47], v6 offset:43520
  ds_read_b64_tr_b16 v[48:49], v7 offset:20480
  buffer_load_dwordx4 v30, s[44:47], s74 offen offset:1024 lds
  ds_read_b64_tr_b16 v[50:51], v7 offset:23040
  ds_read_b64_tr_b16 v[52:53], v7 offset:40960
  ds_read_b64_tr_b16 v[54:55], v7 offset:43520
  ds_read_b64_tr_b16 v[56:57], v8 offset:20480
  buffer_load_dwordx4 v31, s[44:47], s74 offen offset:2048 lds
  ds_read_b64_tr_b16 v[58:59], v8 offset:23040
  ds_read_b64_tr_b16 v[60:61], v8 offset:40960
  ds_read_b64_tr_b16 v[62:63], v8 offset:43520
  ds_read_b64_tr_b16 v[64:65], v9 offset:20480
  buffer_load_dwordx4 v32, s[44:47], s74 offen offset:3072 lds
  ds_read_b64_tr_b16 v[66:67], v9 offset:23040
  ds_read_b64_tr_b16 v[68:69], v9 offset:40960
  ds_read_b64_tr_b16 v[70:71], v9 offset:43520
  ds_read_b128 v[80:83], v11 offset:0
  s_add_u32 m0, m0, 4096
  s_nop 0
  buffer_load_dwordx4 v33, s[44:47], s74 offen offset:0 lds
  s_add_u32 s74, s74, 212992
  ds_read_b128 v[84:87], v12 offset:0
  ds_read_b128 v[88:91], v11 offset:2048
  ds_read_b128 v[92:95], v12 offset:2048
  ds_read_b128 v[96:99], v11 offset:4096
  v_lshl_add_u32 v34, v22, 7, v15
  v_lshl_add_u32 v28, v18, 7, v14
  s_add_u32 m0, s76, 0
  s_nop 0
  buffer_load_dwordx4 v28, s[32:35], 0 offen lds
  ds_read_b128 v[100:103], v12 offset:4096
  ds_read_b128 v[104:107], v11 offset:6144
  ds_read_b128 v[108:111], v12 offset:6144
  ds_read_b64_tr_b16 v[72:73], v10 offset:20480
  s_add_u32 m0, m0, 1024
  s_nop 0
  buffer_load_dwordx4 v34, s[32:35], 0 offen lds
  ds_read_b64_tr_b16 v[74:75], v10 offset:23040
  ds_read_b64_tr_b16 v[76:77], v10 offset:40960
  ds_read_b64_tr_b16 v[78:79], v10 offset:43520
  buffer_load_dwordx3 v[16:18], v13, s[28:31], s73 offen offset:0
  buffer_load_dwordx3 v[20:22], v13, s[28:31], s73 offen offset:832
  s_add_u32 s73, s73, 12
  s_waitcnt vmcnt(9) lgkmcnt(0)
  s_barrier
  s_setprio 0
  v_mfma_f32_16x16x32_bf16 v[140:143], v[40:43], v[80:83], v[140:143]
  v_mfma_f32_16x16x32_bf16 v[140:143], v[44:47], v[84:87], v[140:143]
  v_mfma_f32_16x16x32_bf16 v[144:147], v[40:43], v[88:91], v[144:147]
  v_mfma_f32_16x16x32_bf16 v[144:147], v[44:47], v[92:95], v[144:147]
  v_mfma_f32_16x16x32_bf16 v[148:151], v[40:43], v[96:99], v[148:151]
  v_mfma_f32_16x16x32_bf16 v[148:151], v[44:47], v[100:103], v[148:151]
  v_mfma_f32_16x16x32_bf16 v[152:155], v[40:43], v[104:107], v[152:155]
  v_mfma_f32_16x16x32_bf16 v[152:155], v[44:47], v[108:111], v[152:155]
  v_mfma_f32_16x16x32_bf16 v[168:171], v[48:51], v[104:107], v[168:171]
  v_mfma_f32_16x16x32_bf16 v[168:171], v[52:55], v[108:111], v[168:171]
  v_mfma_f32_16x16x32_bf16 v[164:167], v[48:51], v[96:99], v[164:167]
  v_mfma_f32_16x16x32_bf16 v[164:167], v[52:55], v[100:103], v[164:167]
  v_mfma_f32_16x16x32_bf16 v[160:163], v[48:51], v[88:91], v[160:163]
  v_mfma_f32_16x16x32_bf16 v[160:163], v[52:55], v[92:95], v[160:163]
  v_mfma_f32_16x16x32_bf16 v[156:159], v[48:51], v[80:83], v[156:159]
  v_mfma_f32_16x16x32_bf16 v[156:159], v[52:55], v[84:87], v[156:159]
  v_mfma_f32_16x16x32_bf16 v[172:175], v[56:59], v[80:83], v[172:175]
  v_mfma_f32_16x16x32_bf16 v[172:175], v[60:63], v[84:87], v[172:175]
  v_mfma_f32_16x16x32_bf16 v[176:179], v[56:59], v[88:91], v[176:179]
  v_mfma_f32_16x16x32_bf16 v[176:179], v[60:63], v[92:95], v[176:179]
  v_mfma_f32_16x16x32_bf16 v[180:183], v[56:59], v[96:99], v[180:183]
  v_mfma_f32_16x16x32_bf16 v[180:183], v[60:63], v[100:103], v[180:183]
  v_mfma_f32_16x16x32_bf16 v[184:187], v[56:59], v[104:107], v[184:187]
  v_mfma_f32_16x16x32_bf16 v[184:187], v[60:63], v[108:111], v[184:187]
  v_mfma_f32_16x16x32_bf16 v[200:203], v[64:67], v[104:107], v[200:203]
  v_mfma_f32_16x16x32_bf16 v[200:203], v[68:71], v[108:111], v[200:203]
  v_mfma_f32_16x16x32_bf16 v[196:199], v[64:67], v[96:99], v[196:199]
  v_mfma_f32_16x16x32_bf16 v[196:199], v[68:71], v[100:103], v[196:199]
  v_mfma_f32_16x16x32_bf16 v[192:195], v[64:67], v[88:91], v[192:195]
  v_mfma_f32_16x16x32_bf16 v[192:195], v[68:71], v[92:95], v[192:195]
  v_mfma_f32_16x16x32_bf16 v[188:191], v[64:67], v[80:83], v[188:191]
  v_mfma_f32_16x16x32_bf16 v[188:191], v[68:71], v[84:87], v[188:191]
  v_mfma_f32_16x16x32_bf16 v[204:207], v[72:75], v[80:83], v[204:207]
  v_mfma_f32_16x16x32_bf16 v[204:207], v[76:79], v[84:87], v[204:207]
  v_mfma_f32_16x16x32_bf16 v[208:211], v[72:75], v[88:91], v[208:211]
  v_mfma_f32_16x16x32_bf16 v[208:211], v[76:79], v[92:95], v[208:211]
  v_mfma_f32_16x16x32_bf16 v[212:215], v[72:75], v[96:99], v[212:215]
  v_mfma_f32_16x16x32_bf16 v[212:215], v[76:79], v[100:103], v[212:215]
  v_mfma_f32_16x16x32_bf16 v[216:219], v[72:75], v[104:107], v[216:219]
  s_setprio 2
  s_barrier
  v_mfma_f32_16x16x32_bf16 v[216:219], v[76:79], v[108:111], v[216:219]
  ds_read_b64_tr_b16 v[40:41], v1 offset:0
  s_add_u32 m0, s75, 81920
  s_nop 0
  buffer_load_dwordx4 v29, s[44:47], s74 offen offset:0 lds
  ds_read_b64_tr_b16 v[42:43], v1 offset:2560
  ds_read_b64_tr_b16 v[44:45], v1 offset:20480
  ds_read_b64_tr_b16 v[46:47], v1 offset:23040
  ds_read_b64_tr_b16 v[48:49], v2 offset:0
  buffer_load_dwordx4 v30, s[44:47], s74 offen offset:1024 lds
  ds_read_b64_tr_b16 v[50:51], v2 offset:2560
  ds_read_b64_tr_b16 v[52:53], v2 offset:20480
  ds_read_b64_tr_b16 v[54:55], v2 offset:23040
  ds_read_b64_tr_b16 v[56:57], v3 offset:0
  buffer_load_dwordx4 v31, s[44:47], s74 offen offset:2048 lds
  ds_read_b64_tr_b16 v[58:59], v3 offset:2560
  ds_read_b64_tr_b16 v[60:61], v3 offset:20480
  ds_read_b64_tr_b16 v[62:63], v3 offset:23040
  ds_read_b64_tr_b16 v[64:65], v4 offset:0
  buffer_load_dwordx4 v32, s[44:47], s74 offen offset:3072 lds
  ds_read_b64_tr_b16 v[66:67], v4 offset:2560
  ds_read_b64_tr_b16 v[68:69], v4 offset:20480
  ds_read_b64_tr_b16 v[70:71], v4 offset:23040
  ds_read_b128 v[80:83], v11 offset:8192
  s_add_u32 m0, m0, 4096
  s_nop 0
  buffer_load_dwordx4 v33, s[44:47], s74 offen offset:0 lds
  s_add_u32 s74, s74, 212992
  ds_read_b128 v[84:87], v12 offset:8192
  ds_read_b128 v[88:91], v11 offset:10240
  ds_read_b128 v[92:95], v12 offset:10240
  ds_read_b128 v[96:99], v11 offset:12288
  v_lshl_add_u32 v34, v240, 7, v15
  v_lshl_add_u32 v28, v24, 7, v14
  s_add_u32 m0, s76, 8192
  s_nop 0
  buffer_load_dwordx4 v28, s[32:35], 0 offen lds
  ds_read_b128 v[100:103], v12 offset:12288
  ds_read_b128 v[104:107], v11 offset:14336
  ds_read_b128 v[108:111], v12 offset:14336
  ds_read_b64_tr_b16 v[72:73], v5 offset:0
  s_add_u32 m0, m0, 1024
  s_nop 0
  buffer_load_dwordx4 v34, s[32:35], 0 offen lds
  ds_read_b64_tr_b16 v[74:75], v5 offset:2560
  ds_read_b64_tr_b16 v[76:77], v5 offset:20480
  ds_read_b64_tr_b16 v[78:79], v5 offset:23040
  s_waitcnt vmcnt(9) lgkmcnt(0)
  s_barrier
  s_setprio 0
  v_mfma_f32_16x16x32_bf16 v[140:143], v[40:43], v[80:83], v[140:143]
  v_mfma_f32_16x16x32_bf16 v[140:143], v[44:47], v[84:87], v[140:143]
  v_mfma_f32_16x16x32_bf16 v[144:147], v[40:43], v[88:91], v[144:147]
  v_mfma_f32_16x16x32_bf16 v[144:147], v[44:47], v[92:95], v[144:147]
  v_mfma_f32_16x16x32_bf16 v[148:151], v[40:43], v[96:99], v[148:151]
  v_mfma_f32_16x16x32_bf16 v[148:151], v[44:47], v[100:103], v[148:151]
  v_mfma_f32_16x16x32_bf16 v[152:155], v[40:43], v[104:107], v[152:155]
  v_mfma_f32_16x16x32_bf16 v[152:155], v[44:47], v[108:111], v[152:155]
  v_mfma_f32_16x16x32_bf16 v[168:171], v[48:51], v[104:107], v[168:171]
  v_mfma_f32_16x16x32_bf16 v[168:171], v[52:55], v[108:111], v[168:171]
  v_mfma_f32_16x16x32_bf16 v[164:167], v[48:51], v[96:99], v[164:167]
  v_mfma_f32_16x16x32_bf16 v[164:167], v[52:55], v[100:103], v[164:167]
  v_mfma_f32_16x16x32_bf16 v[160:163], v[48:51], v[88:91], v[160:163]
  v_mfma_f32_16x16x32_bf16 v[160:163], v[52:55], v[92:95], v[160:163]
  v_mfma_f32_16x16x32_bf16 v[156:159], v[48:51], v[80:83], v[156:159]
  v_mfma_f32_16x16x32_bf16 v[156:159], v[52:55], v[84:87], v[156:159]
  v_mfma_f32_16x16x32_bf16 v[172:175], v[56:59], v[80:83], v[172:175]
  v_mfma_f32_16x16x32_bf16 v[172:175], v[60:63], v[84:87], v[172:175]
  v_mfma_f32_16x16x32_bf16 v[176:179], v[56:59], v[88:91], v[176:179]
  v_mfma_f32_16x16x32_bf16 v[176:179], v[60:63], v[92:95], v[176:179]
  v_mfma_f32_16x16x32_bf16 v[180:183], v[56:59], v[96:99], v[180:183]
  v_mfma_f32_16x16x32_bf16 v[180:183], v[60:63], v[100:103], v[180:183]
  v_mfma_f32_16x16x32_bf16 v[184:187], v[56:59], v[104:107], v[184:187]
  v_mfma_f32_16x16x32_bf16 v[184:187], v[60:63], v[108:111], v[184:187]
  v_mfma_f32_16x16x32_bf16 v[200:203], v[64:67], v[104:107], v[200:203]
  v_mfma_f32_16x16x32_bf16 v[200:203], v[68:71], v[108:111], v[200:203]
  v_mfma_f32_16x16x32_bf16 v[196:199], v[64:67], v[96:99], v[196:199]
  v_mfma_f32_16x16x32_bf16 v[196:199], v[68:71], v[100:103], v[196:199]
  v_mfma_f32_16x16x32_bf16 v[192:195], v[64:67], v[88:91], v[192:195]
  v_mfma_f32_16x16x32_bf16 v[192:195], v[68:71], v[92:95], v[192:195]
  v_mfma_f32_16x16x32_bf16 v[188:191], v[64:67], v[80:83], v[188:191]
  v_mfma_f32_16x16x32_bf16 v[188:191], v[68:71], v[84:87], v[188:191]
  v_mfma_f32_16x16x32_bf16 v[204:207], v[72:75], v[80:83], v[204:207]
  v_mfma_f32_16x16x32_bf16 v[204:207], v[76:79], v[84:87], v[204:207]
  v_mfma_f32_16x16x32_bf16 v[208:211], v[72:75], v[88:91], v[208:211]
  v_mfma_f32_16x16x32_bf16 v[208:211], v[76:79], v[92:95], v[208:211]
  v_mfma_f32_16x16x32_bf16 v[212:215], v[72:75], v[96:99], v[212:215]
  v_mfma_f32_16x16x32_bf16 v[212:215], v[76:79], v[100:103], v[212:215]
  v_mfma_f32_16x16x32_bf16 v[216:219], v[72:75], v[104:107], v[216:219]
  s_setprio 2
  s_barrier
  v_mfma_f32_16x16x32_bf16 v[216:219], v[76:79], v[108:111], v[216:219]
  ds_read_b64_tr_b16 v[40:41], v1 offset:40960
  s_add_u32 m0, s75, 0
  s_nop 0
  buffer_load_dwordx4 v29, s[44:47], s74 offen offset:0 lds
  ds_read_b64_tr_b16 v[42:43], v1 offset:43520
  ds_read_b64_tr_b16 v[44:45], v6 offset:0
  ds_read_b64_tr_b16 v[46:47], v6 offset:2560
  ds_read_b64_tr_b16 v[48:49], v2 offset:40960
  buffer_load_dwordx4 v30, s[44:47], s74 offen offset:1024 lds
  ds_read_b64_tr_b16 v[50:51], v2 offset:43520
  ds_read_b64_tr_b16 v[52:53], v7 offset:0
  ds_read_b64_tr_b16 v[54:55], v7 offset:2560
  ds_read_b64_tr_b16 v[56:57], v3 offset:40960
  buffer_load_dwordx4 v31, s[44:47], s74 offen offset:2048 lds
  ds_read_b64_tr_b16 v[58:59], v3 offset:43520
  ds_read_b64_tr_b16 v[60:61], v8 offset:0
  ds_read_b64_tr_b16 v[62:63], v8 offset:2560
  ds_read_b64_tr_b16 v[64:65], v4 offset:40960
  buffer_load_dwordx4 v32, s[44:47], s74 offen offset:3072 lds
  ds_read_b64_tr_b16 v[66:67], v4 offset:43520
  ds_read_b64_tr_b16 v[68:69], v9 offset:0
  ds_read_b64_tr_b16 v[70:71], v9 offset:2560
  ds_read_b128 v[80:83], v11 offset:0
  s_add_u32 m0, m0, 4096
  s_nop 0
  buffer_load_dwordx4 v33, s[44:47], s74 offen offset:0 lds
  s_add_u32 s74, s74, 212992
  ds_read_b128 v[84:87], v12 offset:0
  ds_read_b128 v[88:91], v11 offset:2048
  ds_read_b128 v[92:95], v12 offset:2048
  ds_read_b128 v[96:99], v11 offset:4096
  v_lshl_add_u32 v34, v241, 7, v15
  v_lshl_add_u32 v28, v25, 7, v14
  s_add_u32 m0, s76, 0
  s_nop 0
  buffer_load_dwordx4 v28, s[32:35], 0 offen lds
  ds_read_b128 v[100:103], v12 offset:4096
  ds_read_b128 v[104:107], v11 offset:6144
  ds_read_b128 v[108:111], v12 offset:6144
  ds_read_b64_tr_b16 v[72:73], v5 offset:40960
  s_add_u32 m0, m0, 1024
  s_nop 0
  buffer_load_dwordx4 v34, s[32:35], 0 offen lds
  ds_read_b64_tr_b16 v[74:75], v5 offset:43520
  ds_read_b64_tr_b16 v[76:77], v10 offset:0
  ds_read_b64_tr_b16 v[78:79], v10 offset:2560
  s_mov_b32 m0, 156288
  s_mov_b32 exec_hi, 0xff
  buffer_load_dwordx4 v37, s[52:55], s77 offen lds
  s_mov_b64 exec, -1
  s_waitcnt vmcnt(8) lgkmcnt(0)
  s_barrier
  s_setprio 0
  v_mfma_f32_16x16x32_bf16 v[140:143], v[40:43], v[80:83], v[140:143]
  v_mfma_f32_16x16x32_bf16 v[140:143], v[44:47], v[84:87], v[140:143]
  v_mfma_f32_16x16x32_bf16 v[144:147], v[40:43], v[88:91], v[144:147]
  v_mfma_f32_16x16x32_bf16 v[144:147], v[44:47], v[92:95], v[144:147]
  v_mfma_f32_16x16x32_bf16 v[148:151], v[40:43], v[96:99], v[148:151]
  v_mfma_f32_16x16x32_bf16 v[148:151], v[44:47], v[100:103], v[148:151]
  v_mfma_f32_16x16x32_bf16 v[152:155], v[40:43], v[104:107], v[152:155]
  v_mfma_f32_16x16x32_bf16 v[152:155], v[44:47], v[108:111], v[152:155]
  v_mfma_f32_16x16x32_bf16 v[168:171], v[48:51], v[104:107], v[168:171]
  v_mfma_f32_16x16x32_bf16 v[168:171], v[52:55], v[108:111], v[168:171]
  v_mfma_f32_16x16x32_bf16 v[164:167], v[48:51], v[96:99], v[164:167]
  v_mfma_f32_16x16x32_bf16 v[164:167], v[52:55], v[100:103], v[164:167]
  v_mfma_f32_16x16x32_bf16 v[160:163], v[48:51], v[88:91], v[160:163]
  v_mfma_f32_16x16x32_bf16 v[160:163], v[52:55], v[92:95], v[160:163]
  v_mfma_f32_16x16x32_bf16 v[156:159], v[48:51], v[80:83], v[156:159]
  v_mfma_f32_16x16x32_bf16 v[156:159], v[52:55], v[84:87], v[156:159]
  v_mfma_f32_16x16x32_bf16 v[172:175], v[56:59], v[80:83], v[172:175]
  v_mfma_f32_16x16x32_bf16 v[172:175], v[60:63], v[84:87], v[172:175]
  v_mfma_f32_16x16x32_bf16 v[176:179], v[56:59], v[88:91], v[176:179]
  v_mfma_f32_16x16x32_bf16 v[176:179], v[60:63], v[92:95], v[176:179]
  v_mfma_f32_16x16x32_bf16 v[180:183], v[56:59], v[96:99], v[180:183]
  v_mfma_f32_16x16x32_bf16 v[180:183], v[60:63], v[100:103], v[180:183]
  v_mfma_f32_16x16x32_bf16 v[184:187], v[56:59], v[104:107], v[184:187]
  v_mfma_f32_16x16x32_bf16 v[184:187], v[60:63], v[108:111], v[184:187]
  v_mfma_f32_16x16x32_bf16 v[200:203], v[64:67], v[104:107], v[200:203]
  v_mfma_f32_16x16x32_bf16 v[200:203], v[68:71], v[108:111], v[200:203]
  v_mfma_f32_16x16x32_bf16 v[196:199], v[64:67], v[96:99], v[196:199]
  v_mfma_f32_16x16x32_bf16 v[196:199], v[68:71], v[100:103], v[196:199]
  v_mfma_f32_16x16x32_bf16 v[192:195], v[64:67], v[88:91], v[192:195]
  v_mfma_f32_16x16x32_bf16 v[192:195], v[68:71], v[92:95], v[192:195]
  v_mfma_f32_16x16x32_bf16 v[188:191], v[64:67], v[80:83], v[188:191]
  v_mfma_f32_16x16x32_bf16 v[188:191], v[68:71], v[84:87], v[188:191]
  v_mfma_f32_16x16x32_bf16 v[204:207], v[72:75], v[80:83], v[204:207]
  v_mfma_f32_16x16x32_bf16 v[204:207], v[76:79], v[84:87], v[204:207]
  v_mfma_f32_16x16x32_bf16 v[208:211], v[72:75], v[88:91], v[208:211]
  v_mfma_f32_16x16x32_bf16 v[208:211], v[76:79], v[92:95], v[208:211]
  v_mfma_f32_16x16x32_bf16 v[212:215], v[72:75], v[96:99], v[212:215]
  v_mfma_f32_16x16x32_bf16 v[212:215], v[76:79], v[100:103], v[212:215]
  v_mfma_f32_16x16x32_bf16 v[216:219], v[72:75], v[104:107], v[216:219]
  s_setprio 2
  s_barrier
  v_mfma_f32_16x16x32_bf16 v[216:219], v[76:79], v[108:111], v[216:219]
  ds_read_b64_tr_b16 v[40:41], v6 offset:20480
  s_add_u32 m0, s75, 40960
  s_nop 0
  buffer_load_dwordx4 v29, s[44:47], s74 offen offset:0 lds
  ds_read_b64_tr_b16 v[42:43], v6 offset:23040
  ds_read_b64_tr_b16 v[44:45], v6 offset:40960
  ds_read_b64_tr_b16 v[46:47], v6 offset:43520
  ds_read_b64_tr_b16 v[48:49], v7 offset:20480
  buffer_load_dwordx4 v30, s[44:47], s74 offen offset:1024 lds
  ds_read_b64_tr_b16 v[50:51], v7 offset:23040
  ds_read_b64_tr_b16 v[52:53], v7 offset:40960
  ds_read_b64_tr_b16 v[54:55], v7 offset:43520
  ds_read_b64_tr_b16 v[56:57], v8 offset:20480
  buffer_load_dwordx4 v31, s[44:47], s74 offen offset:2048 lds
  ds_read_b64_tr_b16 v[58:59], v8 offset:23040
  ds_read_b64_tr_b16 v[60:61], v8 offset:40960
  ds_read_b64_tr_b16 v[62:63], v8 offset:43520
  ds_read_b64_tr_b16 v[64:65], v9 offset:20480
  buffer_load_dwordx4 v32, s[44:47], s74 offen offset:3072 lds
  ds_read_b64_tr_b16 v[66:67], v9 offset:23040
  ds_read_b64_tr_b16 v[68:69], v9 offset:40960
  ds_read_b64_tr_b16 v[70:71], v9 offset:43520
  ds_read_b128 v[80:83], v11 offset:8192
  s_add_u32 m0, m0, 4096
  s_nop 0
  buffer_load_dwordx4 v33, s[44:47], s74 offen offset:0 lds
  s_add_u32 s74, s74, 212992
  ds_read_b128 v[84:87], v12 offset:8192
  ds_read_b128 v[88:91], v11 offset:10240
  ds_read_b128 v[92:95], v12 offset:10240
  ds_read_b128 v[96:99], v11 offset:12288
  v_lshl_add_u32 v34, v242, 7, v15
  v_lshl_add_u32 v28, v26, 7, v14
  s_add_u32 m0, s76, 8192
  s_nop 0
  buffer_load_dwordx4 v28, s[32:35], 0 offen lds
  ds_read_b128 v[100:103], v12 offset:12288
  ds_read_b128 v[104:107], v11 offset:14336
  ds_read_b128 v[108:111], v12 offset:14336
  ds_read_b64_tr_b16 v[72:73], v10 offset:20480
  s_add_u32 m0, m0, 1024
  s_nop 0
  buffer_load_dwordx4 v34, s[32:35], 0 offen lds
  ds_read_b64_tr_b16 v[74:75], v10 offset:23040
  ds_read_b64_tr_b16 v[76:77], v10 offset:40960
  ds_read_b64_tr_b16 v[78:79], v10 offset:43520
  buffer_load_dwordx3 v[24:26], v13, s[28:31], s73 offen offset:0
  buffer_load_dwordx3 v[240:242], v13, s[28:31], s73 offen offset:832
  s_add_u32 s73, s73, 12
  s_waitcnt vmcnt(10) lgkmcnt(0)
  s_barrier
  s_setprio 0
  v_mfma_f32_16x16x32_bf16 v[140:143], v[40:43], v[80:83], v[140:143]
  s_add_u32 s72, s72, 1
  v_mfma_f32_16x16x32_bf16 v[140:143], v[44:47], v[84:87], v[140:143]
  v_mfma_f32_16x16x32_bf16 v[144:147], v[40:43], v[88:91], v[144:147]
  v_mfma_f32_16x16x32_bf16 v[144:147], v[44:47], v[92:95], v[144:147]
  v_mfma_f32_16x16x32_bf16 v[148:151], v[40:43], v[96:99], v[148:151]
  v_mfma_f32_16x16x32_bf16 v[148:151], v[44:47], v[100:103], v[148:151]
  v_mfma_f32_16x16x32_bf16 v[152:155], v[40:43], v[104:107], v[152:155]
  v_mfma_f32_16x16x32_bf16 v[152:155], v[44:47], v[108:111], v[152:155]
  v_mfma_f32_16x16x32_bf16 v[168:171], v[48:51], v[104:107], v[168:171]
  v_mfma_f32_16x16x32_bf16 v[168:171], v[52:55], v[108:111], v[168:171]
  v_mfma_f32_16x16x32_bf16 v[164:167], v[48:51], v[96:99], v[164:167]
  v_mfma_f32_16x16x32_bf16 v[164:167], v[52:55], v[100:103], v[164:167]
  v_mfma_f32_16x16x32_bf16 v[160:163], v[48:51], v[88:91], v[160:163]
  v_mfma_f32_16x16x32_bf16 v[160:163], v[52:55], v[92:95], v[160:163]
  v_mfma_f32_16x16x32_bf16 v[156:159], v[48:51], v[80:83], v[156:159]
  v_mfma_f32_16x16x32_bf16 v[156:159], v[52:55], v[84:87], v[156:159]
  v_mfma_f32_16x16x32_bf16 v[172:175], v[56:59], v[80:83], v[172:175]
  v_mfma_f32_16x16x32_bf16 v[172:175], v[60:63], v[84:87], v[172:175]
  v_mfma_f32_16x16x32_bf16 v[176:179], v[56:59], v[88:91], v[176:179]
  v_mfma_f32_16x16x32_bf16 v[176:179], v[60:63], v[92:95], v[176:179]
  s_cmp_lt_u32 s72, 4
  v_mfma_f32_16x16x32_bf16 v[180:183], v[56:59], v[96:99], v[180:183]
  v_mfma_f32_16x16x32_bf16 v[180:183], v[60:63], v[100:103], v[180:183]
  v_mfma_f32_16x16x32_bf16 v[184:187], v[56:59], v[104:107], v[184:187]
  v_mfma_f32_16x16x32_bf16 v[184:187], v[60:63], v[108:111], v[184:187]
  v_mfma_f32_16x16x32_bf16 v[200:203], v[64:67], v[104:107], v[200:203]
  v_mfma_f32_16x16x32_bf16 v[200:203], v[68:71], v[108:111], v[200:203]
  v_mfma_f32_16x16x32_bf16 v[196:199], v[64:67], v[96:99], v[196:199]
  v_mfma_f32_16x16x32_bf16 v[196:199], v[68:71], v[100:103], v[196:199]
  v_mfma_f32_16x16x32_bf16 v[192:195], v[64:67], v[88:91], v[192:195]
  v_mfma_f32_16x16x32_bf16 v[192:195], v[68:71], v[92:95], v[192:195]
  v_mfma_f32_16x16x32_bf16 v[188:191], v[64:67], v[80:83], v[188:191]
  v_mfma_f32_16x16x32_bf16 v[188:191], v[68:71], v[84:87], v[188:191]
  v_mfma_f32_16x16x32_bf16 v[204:207], v[72:75], v[80:83], v[204:207]
  v_mfma_f32_16x16x32_bf16 v[204:207], v[76:79], v[84:87], v[204:207]
  v_mfma_f32_16x16x32_bf16 v[208:211], v[72:75], v[88:91], v[208:211]
  v_mfma_f32_16x16x32_bf16 v[208:211], v[76:79], v[92:95], v[208:211]
  v_mfma_f32_16x16x32_bf16 v[212:215], v[72:75], v[96:99], v[212:215]
  v_mfma_f32_16x16x32_bf16 v[212:215], v[76:79], v[100:103], v[212:215]
  v_mfma_f32_16x16x32_bf16 v[216:219], v[72:75], v[104:107], v[216:219]
  s_setprio 2
  s_barrier
  v_mfma_f32_16x16x32_bf16 v[216:219], v[76:79], v[108:111], v[216:219]
  s_cbranch_scc1 L_dnn_loop1
  ds_read_b64_tr_b16 v[40:41], v1 offset:0
  ds_read_b64_tr_b16 v[42:43], v1 offset:2560
  ds_read_b64_tr_b16 v[44:45], v1 offset:20480
  ds_read_b64_tr_b16 v[46:47], v1 offset:23040
  ds_read_b64_tr_b16 v[48:49], v2 offset:0
  ds_read_b64_tr_b16 v[50:51], v2 offset:2560
  ds_read_b64_tr_b16 v[52:53], v2 offset:20480
  ds_read_b64_tr_b16 v[54:55], v2 offset:23040
  ds_read_b64_tr_b16 v[56:57], v3 offset:0
  ds_read_b64_tr_b16 v[58:59], v3 offset:2560
  ds_read_b64_tr_b16 v[60:61], v3 offset:20480
  ds_read_b64_tr_b16 v[62:63], v3 offset:23040
  ds_read_b64_tr_b16 v[64:65], v4 offset:0
  ds_read_b64_tr_b16 v[66:67], v4 offset:2560
  ds_read_b64_tr_b16 v[68:69], v4 offset:20480
  ds_read_b64_tr_b16 v[70:71], v4 offset:23040
  ds_read_b128 v[80:83], v11 offset:0
  ds_read_b128 v[84:87], v12 offset:0
  ds_read_b128 v[88:91], v11 offset:2048
  ds_read_b128 v[92:95], v12 offset:2048
  ds_read_b128 v[96:99], v11 offset:4096
  ds_read_b128 v[100:103], v12 offset:4096
  ds_read_b128 v[104:107], v11 offset:6144
  ds_read_b128 v[108:111], v12 offset:6144
  ds_read_b64_tr_b16 v[72:73], v5 offset:0
  ds_read_b64_tr_b16 v[74:75], v5 offset:2560
  ds_read_b64_tr_b16 v[76:77], v5 offset:20480
  ds_read_b64_tr_b16 v[78:79], v5 offset:23040
  ds_read_b64 v[220:221], v35 offset:640
  ds_read_b64 v[222:223], v35 offset:672
  ds_read_b64 v[224:225], v35 offset:704
  ds_read_b64 v[226:227], v35 offset:736
  ds_read_b64 v[228:229], v35 offset:768
  s_waitcnt vmcnt(2) lgkmcnt(0)
  s_barrier
  s_setprio 0
  v_mfma_f32_16x16x32_bf16 v[140:143], v[40:43], v[80:83], v[140:143]
  v_mov_b32 v232, 0xc0135761
  v_mov_b32 v233, 0xc0135761
  v_mfma_f32_16x16x32_bf16 v[140:143], v[44:47], v[84:87], v[140:143]
  v_mov_b32 v234, 0xbdd2d3e8
  v_mfma_f32_16x16x32_bf16 v[144:147], v[40:43], v[88:91], v[144:147]
  v_mov_b32 v235, 0xbdd2d3e8
  v_mfma_f32_16x16x32_bf16 v[144:147], v[44:47], v[92:95], v[144:147]
  v_mov_b32 v236, 0x71800000
  v_mfma_f32_16x16x32_bf16 v[148:151], v[40:43], v[96:99], v[148:151]
  v_lshlrev_b32 v112, 16, v220
  v_mfma_f32_16x16x32_bf16 v[148:151], v[44:47], v[100:103], v[148:151]
  v_and_b32 v113, 0xffff0000, v220
  v_mfma_f32_16x16x32_bf16 v[152:155], v[40:43], v[104:107], v[152:155]
  v_lshlrev_b32 v114, 16, v221
  v_mfma_f32_16x16x32_bf16 v[152:155], v[44:47], v[108:111], v[152:155]
  v_and_b32 v115, 0xffff0000, v221
  v_mfma_f32_16x16x32_bf16 v[168:171], v[48:51], v[104:107], v[168:171]
  v_lshlrev_b32 v116, 16, v222
  v_mfma_f32_16x16x32_bf16 v[168:171], v[52:55], v[108:111], v[168:171]
  v_and_b32 v117, 0xffff0000, v222
  v_mfma_f32_16x16x32_bf16 v[164:167], v[48:51], v[96:99], v[164:167]
  v_lshlrev_b32 v118, 16, v223
  v_mfma_f32_16x16x32_bf16 v[164:167], v[52:55], v[100:103], v[164:167]
  v_and_b32 v119, 0xffff0000, v223
  v_mfma_f32_16x16x32_bf16 v[160:163], v[48:51], v[88:91], v[160:163]
  v_lshlrev_b32 v120, 16, v224
  v_mfma_f32_16x16x32_bf16 v[160:163], v[52:55], v[92:95], v[160:163]
  v_and_b32 v121, 0xffff0000, v224
  v_mfma_f32_16x16x32_bf16 v[156:159], v[48:51], v[80:83], v[156:159]
  v_lshlrev_b32 v122, 16, v225
  v_mfma_f32_16x16x32_bf16 v[156:159], v[52:55], v[84:87], v[156:159]
  v_and_b32 v123, 0xffff0000, v225
  v_mfma_f32_16x16x32_bf16 v[172:175], v[56:59], v[80:83], v[172:175]
  v_lshlrev_b32 v124, 16, v226
  v_mfma_f32_16x16x32_bf16 v[172:175], v[60:63], v[84:87], v[172:175]
  v_and_b32 v125, 0xffff0000, v226
  v_mfma_f32_16x16x32_bf16 v[176:179], v[56:59], v[88:91], v[176:179]
  v_lshlrev_b32 v126, 16, v227
  v_mfma_f32_16x16x32_bf16 v[176:179], v[60:63], v[92:95], v[176:179]
  v_and_b32 v127, 0xffff0000, v227
  v_mfma_f32_16x16x32_bf16 v[180:183], v[56:59], v[96:99], v[180:183]
  v_lshlrev_b32 v128, 16, v228
  v_mfma_f32_16x16x32_bf16 v[180:183], v[60:63], v[100:103], v[180:183]
  v_and_b32 v129, 0xffff0000, v228
  v_mfma_f32_16x16x32_bf16 v[184:187], v[56:59], v[104:107], v[184:187]
  v_lshlrev_b32 v130, 16, v229
  v_mfma_f32_16x16x32_bf16 v[184:187], v[60:63], v[108:111], v[184:187]
  v_and_b32 v131, 0xffff0000, v229
  v_mfma_f32_16x16x32_bf16 v[200:203], v[64:67], v[104:107], v[200:203]
  v_rcp_f32 v112, v112
  v_mfma_f32_16x16x32_bf16 v[200:203], v[68:71], v[108:111], v[200:203]
  v_rcp_f32 v113, v113
  v_mfma_f32_16x16x32_bf16 v[196:199], v[64:67], v[96:99], v[196:199]
  v_rcp_f32 v114, v114
  v_mfma_f32_16x16x32_bf16 v[196:199], v[68:71], v[100:103], v[196:199]
  v_rcp_f32 v115, v115
  v_mfma_f32_16x16x32_bf16 v[192:195], v[64:67], v[88:91], v[192:195]
  v_rcp_f32 v116, v116
  v_mfma_f32_16x16x32_bf16 v[192:195], v[68:71], v[92:95], v[192:195]
  v_rcp_f32 v117, v117
  v_mfma_f32_16x16x32_bf16 v[188:191], v[64:67], v[80:83], v[188:191]
  v_rcp_f32 v118, v118
  v_mfma_f32_16x16x32_bf16 v[188:191], v[68:71], v[84:87], v[188:191]
  v_rcp_f32 v119, v119
  v_mfma_f32_16x16x32_bf16 v[204:207], v[72:75], v[80:83], v[204:207]
  v_rcp_f32 v120, v120
  v_mfma_f32_16x16x32_bf16 v[204:207], v[76:79], v[84:87], v[204:207]
  v_rcp_f32 v121, v121
  v_mfma_f32_16x16x32_bf16 v[208:211], v[72:75], v[88:91], v[208:211]
  v_rcp_f32 v122, v122
  v_mfma_f32_16x16x32_bf16 v[208:211], v[76:79], v[92:95], v[208:211]
  v_rcp_f32 v123, v123
  v_mfma_f32_16x16x32_bf16 v[212:215], v[72:75], v[96:99], v[212:215]
  v_rcp_f32 v124, v124
  v_mfma_f32_16x16x32_bf16 v[212:215], v[76:79], v[100:103], v[212:215]
  v_rcp_f32 v125, v125
  v_mfma_f32_16x16x32_bf16 v[216:219], v[72:75], v[104:107], v[216:219]
  s_setprio 2
  s_barrier
  v_mfma_f32_16x16x32_bf16 v[216:219], v[76:79], v[108:111], v[216:219]
  ds_read_b64_tr_b16 v[40:41], v1 offset:40960
  ds_read_b64_tr_b16 v[42:43], v1 offset:43520
  ds_read_b64_tr_b16 v[44:45], v6 offset:0
  ds_read_b64_tr_b16 v[46:47], v6 offset:2560
  ds_read_b64_tr_b16 v[48:49], v2 offset:40960
  ds_read_b64_tr_b16 v[50:51], v2 offset:43520
  ds_read_b64_tr_b16 v[52:53], v7 offset:0
  ds_read_b64_tr_b16 v[54:55], v7 offset:2560
  ds_read_b64_tr_b16 v[56:57], v3 offset:40960
  ds_read_b64_tr_b16 v[58:59], v3 offset:43520
  ds_read_b64_tr_b16 v[60:61], v8 offset:0
  ds_read_b64_tr_b16 v[62:63], v8 offset:2560
  ds_read_b64_tr_b16 v[64:65], v4 offset:40960
  ds_read_b64_tr_b16 v[66:67], v4 offset:43520
  ds_read_b64_tr_b16 v[68:69], v9 offset:0
  ds_read_b64_tr_b16 v[70:71], v9 offset:2560
  ds_read_b128 v[80:83], v11 offset:8192
  ds_read_b128 v[84:87], v12 offset:8192
  ds_read_b128 v[88:91], v11 offset:10240
  ds_read_b128 v[92:95], v12 offset:10240
  ds_read_b128 v[96:99], v11 offset:12288
  ds_read_b128 v[100:103], v12 offset:12288
  ds_read_b128 v[104:107], v11 offset:14336
  ds_read_b128 v[108:111], v12 offset:14336
  ds_read_b64_tr_b16 v[72:73], v5 offset:40960
  ds_read_b64_tr_b16 v[74:75], v5 offset:43520
  ds_read_b64_tr_b16 v[76:77], v10 offset:0
  ds_read_b64_tr_b16 v[78:79], v10 offset:2560
  s_waitcnt lgkmcnt(0)
  s_barrier
  v_mfma_f32_16x16x32_bf16 v[140:143], v[40:43], v[80:83], v[140:143]
  v_rcp_f32 v126, v126
  v_mfma_f32_16x16x32_bf16 v[140:143], v[44:47], v[84:87], v[140:143]
  v_rcp_f32 v127, v127
  v_mfma_f32_16x16x32_bf16 v[144:147], v[40:43], v[88:91], v[144:147]
  v_rcp_f32 v128, v128
  v_mfma_f32_16x16x32_bf16 v[144:147], v[44:47], v[92:95], v[144:147]
  v_mfma_f32_16x16x32_bf16 v[148:151], v[40:43], v[96:99], v[148:151]
  v_rcp_f32 v129, v129
  v_mfma_f32_16x16x32_bf16 v[148:151], v[44:47], v[100:103], v[148:151]
  v_rcp_f32 v130, v130
  v_mfma_f32_16x16x32_bf16 v[152:155], v[40:43], v[104:107], v[152:155]
  v_mfma_f32_16x16x32_bf16 v[152:155], v[44:47], v[108:111], v[152:155]
  v_rcp_f32 v131, v131
  v_mfma_f32_16x16x32_bf16 v[168:171], v[48:51], v[104:107], v[168:171]
  v_med3_f32 v112, v112, -v236, v236
  v_mfma_f32_16x16x32_bf16 v[168:171], v[52:55], v[108:111], v[168:171]
  v_mfma_f32_16x16x32_bf16 v[164:167], v[48:51], v[96:99], v[164:167]
  v_med3_f32 v113, v113, -v236, v236
  v_mfma_f32_16x16x32_bf16 v[164:167], v[52:55], v[100:103], v[164:167]
  v_med3_f32 v114, v114, -v236, v236
  v_mfma_f32_16x16x32_bf16 v[160:163], v[48:51], v[88:91], v[160:163]
  v_mfma_f32_16x16x32_bf16 v[160:163], v[52:55], v[92:95], v[160:163]
  v_med3_f32 v115, v115, -v236, v236
  v_mfma_f32_16x16x32_bf16 v[156:159], v[48:51], v[80:83], v[156:159]
  v_med3_f32 v116, v116, -v236, v236
  v_mfma_f32_16x16x32_bf16 v[156:159], v[52:55], v[84:87], v[156:159]
  v_mfma_f32_16x16x32_bf16 v[172:175], v[56:59], v[80:83], v[172:175]
  v_med3_f32 v117, v117, -v236, v236
  v_mfma_f32_16x16x32_bf16 v[172:175], v[60:63], v[84:87], v[172:175]
  v_med3_f32 v118, v118, -v236, v236
  v_mfma_f32_16x16x32_bf16 v[176:179], v[56:59], v[88:91], v[176:179]
  v_mfma_f32_16x16x32_bf16 v[176:179], v[60:63], v[92:95], v[176:179]
  v_med3_f32 v119, v119, -v236, v236
  v_mfma_f32_16x16x32_bf16 v[180:183], v[56:59], v[96:99], v[180:183]
  v_med3_f32 v120, v120, -v236, v236
  v_mfma_f32_16x16x32_bf16 v[180:183], v[60:63], v[100:103], v[180:183]
  v_med3_f32 v121, v121, -v236, v236
  v_mfma_f32_16x16x32_bf16 v[184:187], v[56:59], v[104:107], v[184:187]
  v_mfma_f32_16x16x32_bf16 v[184:187], v[60:63], v[108:111], v[184:187]
  v_med3_f32 v122, v122, -v236, v236
  v_mfma_f32_16x16x32_bf16 v[200:203], v[64:67], v[104:107], v[200:203]
  v_med3_f32 v123, v123, -v236, v236
  v_mfma_f32_16x16x32_bf16 v[200:203], v[68:71], v[108:111], v[200:203]
  v_mfma_f32_16x16x32_bf16 v[196:199], v[64:67], v[96:99], v[196:199]
  v_med3_f32 v124, v124, -v236, v236
  v_mfma_f32_16x16x32_bf16 v[196:199], v[68:71], v[100:103], v[196:199]
  v_med3_f32 v125, v125, -v236, v236
  v_mfma_f32_16x16x32_bf16 v[192:195], v[64:67], v[88:91], v[192:195]
  v_mfma_f32_16x16x32_bf16 v[192:195], v[68:71], v[92:95], v[192:195]
  v_med3_f32 v126, v126, -v236, v236
  v_mfma_f32_16x16x32_bf16 v[188:191], v[64:67], v[80:83], v[188:191]
  v_med3_f32 v127, v127, -v236, v236
  v_mfma_f32_16x16x32_bf16 v[188:191], v[68:71], v[84:87], v[188:191]
  v_mfma_f32_16x16x32_bf16 v[204:207], v[72:75], v[80:83], v[204:207]
  v_med3_f32 v128, v128, -v236, v236
  v_mfma_f32_16x16x32_bf16 v[204:207], v[76:79], v[84:87], v[204:207]
  v_med3_f32 v129, v129, -v236, v236
  v_mfma_f32_16x16x32_bf16 v[208:211], v[72:75], v[88:91], v[208:211]
  v_mfma_f32_16x16x32_bf16 v[208:211], v[76:79], v[92:95], v[208:211]
  v_med3_f32 v130, v130, -v236, v236
  v_mfma_f32_16x16x32_bf16 v[212:215], v[72:75], v[96:99], v[212:215]
  v_med3_f32 v131, v131, -v236, v236
  v_mfma_f32_16x16x32_bf16 v[212:215], v[76:79], v[100:103], v[212:215]
  v_mfma_f32_16x16x32_bf16 v[216:219], v[72:75], v[104:107], v[216:219]
  v_mfma_f32_16x16x32_bf16 v[216:219], v[76:79], v[108:111], v[216:219]
  s_setprio 0
  s_nop 0
L_epi:
  s_lshl_b32 s69, s27, 11
  s_and_b32 s71, s26, 3
  s_lshl_b32 s71, s71, 9
  s_add_u32 s69, s69, s71
  s_lshr_b32 s68, s26, 2
  s_lshl_b32 s68, s68, 14
  s_add_u32 s69, s69, s68
  v_lshlrev_b32 v3, 3, v0
  v_add_u32 v2, 156928, v3
  v_pk_mul_f32 v[40:41], v[140:141], v[140:141]
  v_pk_mul_f32 v[44:45], v[144:145], v[144:145]
  v_pk_mul_f32 v[48:49], v[148:149], v[148:149]
  v_pk_mul_f32 v[52:53], v[152:153], v[152:153]
  v_pk_fma_f32 v[40:41], v[40:41], v[234:235], v[232:233]
  v_pk_fma_f32 v[44:45], v[44:45], v[234:235], v[232:233]
  v_pk_fma_f32 v[48:49], v[48:49], v[234:235], v[232:233]
  v_pk_fma_f32 v[52:53], v[52:53], v[234:235], v[232:233]
  v_pk_mul_f32 v[40:41], v[40:41], v[140:141]
  v_pk_mul_f32 v[44:45], v[44:45], v[144:145]
  v_pk_mul_f32 v[48:49], v[48:49], v[148:149]
  v_pk_mul_f32 v[52:53], v[52:53], v[152:153]
  v_exp_f32 v40, v40
  v_exp_f32 v41, v41
  v_exp_f32 v44, v44
  v_exp_f32 v45, v45
  v_exp_f32 v48, v48
  v_exp_f32 v49, v49
  v_exp_f32 v52, v52
  v_exp_f32 v53, v53
  v_pk_fma_f32 v[40:41], v[40:41], v[112:113], v[112:113]
  v_pk_fma_f32 v[44:45], v[44:45], v[112:113], v[112:113]
  v_pk_fma_f32 v[48:49], v[48:49], v[112:113], v[112:113]
  v_pk_fma_f32 v[52:53], v[52:53], v[112:113], v[112:113]
  v_rcp_f32 v40, v40
  v_rcp_f32 v41, v41
  v_rcp_f32 v44, v44
  v_rcp_f32 v45, v45
  v_rcp_f32 v48, v48
  v_rcp_f32 v49, v49
  v_rcp_f32 v52, v52
  v_rcp_f32 v53, v53
  v_pk_mul_f32 v[16:17], v[40:41], v[140:141]
  v_pk_mul_f32 v[18:19], v[44:45], v[144:145]
  v_pk_mul_f32 v[20:21], v[48:49], v[148:149]
  v_pk_mul_f32 v[22:23], v[52:53], v[152:153]
  v_pk_mul_f32 v[56:57], v[142:143], v[142:143]
  v_pk_mul_f32 v[60:61], v[146:147], v[146:147]
  v_pk_mul_f32 v[64:65], v[150:151], v[150:151]
  v_pk_mul_f32 v[68:69], v[154:155], v[154:155]
  v_pk_fma_f32 v[56:57], v[56:57], v[234:235], v[232:233]
  v_pk_fma_f32 v[60:61], v[60:61], v[234:235], v[232:233]
  v_pk_fma_f32 v[64:65], v[64:65], v[234:235], v[232:233]
  v_pk_fma_f32 v[68:69], v[68:69], v[234:235], v[232:233]
  v_pk_mul_f32 v[56:57], v[56:57], v[142:143]
  v_pk_mul_f32 v[60:61], v[60:61], v[146:147]
  v_pk_mul_f32 v[64:65], v[64:65], v[150:151]
  v_pk_mul_f32 v[68:69], v[68:69], v[154:155]
  v_exp_f32 v56, v56
  v_exp_f32 v57, v57
  v_exp_f32 v60, v60
  v_exp_f32 v61, v61
  v_exp_f32 v64, v64
  v_exp_f32 v65, v65
  v_exp_f32 v68, v68
  v_exp_f32 v69, v69
  v_pk_fma_f32 v[56:57], v[56:57], v[114:115], v[114:115]
  v_pk_fma_f32 v[60:61], v[60:61], v[114:115], v[114:115]
  v_pk_fma_f32 v[64:65], v[64:65], v[114:115], v[114:115]
  v_pk_fma_f32 v[68:69], v[68:69], v[114:115], v[114:115]
  v_rcp_f32 v56, v56
  v_rcp_f32 v57, v57
  v_rcp_f32 v60, v60
  v_rcp_f32 v61, v61
  v_rcp_f32 v64, v64
  v_rcp_f32 v65, v65
  v_rcp_f32 v68, v68
  v_rcp_f32 v69, v69
  v_pk_fma_f32 v[16:17], v[56:57], v[142:143], v[16:17]
  v_pk_fma_f32 v[18:19], v[60:61], v[146:147], v[18:19]
  v_pk_fma_f32 v[20:21], v[64:65], v[150:151], v[20:21]
  v_pk_fma_f32 v[22:23], v[68:69], v[154:155], v[22:23]
  v_pk_mul_f32 v[40:41], v[156:157], v[156:157]
  v_pk_mul_f32 v[44:45], v[160:161], v[160:161]
  v_pk_mul_f32 v[48:49], v[164:165], v[164:165]
  v_pk_mul_f32 v[52:53], v[168:169], v[168:169]
  v_pk_fma_f32 v[40:41], v[40:41], v[234:235], v[232:233]
  v_pk_fma_f32 v[44:45], v[44:45], v[234:235], v[232:233]
  v_pk_fma_f32 v[48:49], v[48:49], v[234:235], v[232:233]
  v_pk_fma_f32 v[52:53], v[52:53], v[234:235], v[232:233]
  v_pk_mul_f32 v[40:41], v[40:41], v[156:157]
  v_pk_mul_f32 v[44:45], v[44:45], v[160:161]
  v_pk_mul_f32 v[48:49], v[48:49], v[164:165]
  v_pk_mul_f32 v[52:53], v[52:53], v[168:169]
  v_exp_f32 v40, v40
  v_exp_f32 v41, v41
  v_exp_f32 v44, v44
  v_exp_f32 v45, v45
  v_exp_f32 v48, v48
  v_exp_f32 v49, v49
  v_exp_f32 v52, v52
  v_exp_f32 v53, v53
  v_pk_fma_f32 v[40:41], v[40:41], v[116:117], v[116:117]
  v_pk_fma_f32 v[44:45], v[44:45], v[116:117], v[116:117]
  v_pk_fma_f32 v[48:49], v[48:49], v[116:117], v[116:117]
  v_pk_fma_f32 v[52:53], v[52:53], v[116:117], v[116:117]
  v_rcp_f32 v40, v40
  v_rcp_f32 v41, v41
  v_rcp_f32 v44, v44
  v_rcp_f32 v45, v45
  v_rcp_f32 v48, v48
  v_rcp_f32 v49, v49
  v_rcp_f32 v52, v52
  v_rcp_f32 v53, v53
  v_pk_fma_f32 v[16:17], v[40:41], v[156:157], v[16:17]
  v_pk_fma_f32 v[18:19], v[44:45], v[160:161], v[18:19]
  v_pk_fma_f32 v[20:21], v[48:49], v[164:165], v[20:21]
  v_pk_fma_f32 v[22:23], v[52:53], v[168:169], v[22:23]
  v_pk_mul_f32 v[56:57], v[158:159], v[158:159]
  v_pk_mul_f32 v[60:61], v[162:163], v[162:163]
  v_pk_mul_f32 v[64:65], v[166:167], v[166:167]
  v_pk_mul_f32 v[68:69], v[170:171], v[170:171]
  v_pk_fma_f32 v[56:57], v[56:57], v[234:235], v[232:233]
  v_pk_fma_f32 v[60:61], v[60:61], v[234:235], v[232:233]
  v_pk_fma_f32 v[64:65], v[64:65], v[234:235], v[232:233]
  v_pk_fma_f32 v[68:69], v[68:69], v[234:235], v[232:233]
  v_pk_mul_f32 v[56:57], v[56:57], v[158:159]
  v_pk_mul_f32 v[60:61], v[60:61], v[162:163]
  v_pk_mul_f32 v[64:65], v[64:65], v[166:167]
  v_pk_mul_f32 v[68:69], v[68:69], v[170:171]
  v_exp_f32 v56, v56
  v_exp_f32 v57, v57
  v_exp_f32 v60, v60
  v_exp_f32 v61, v61
  v_exp_f32 v64, v64
  v_exp_f32 v65, v65
  v_exp_f32 v68, v68
  v_exp_f32 v69, v69
  v_pk_fma_f32 v[56:57], v[56:57], v[118:119], v[118:119]
  v_pk_fma_f32 v[60:61], v[60:61], v[118:119], v[118:119]
  v_pk_fma_f32 v[64:65], v[64:65], v[118:119], v[118:119]
  v_pk_fma_f32 v[68:69], v[68:69], v[118:119], v[118:119]
  v_rcp_f32 v56, v56
  v_rcp_f32 v57, v57
  v_rcp_f32 v60, v60
  v_rcp_f32 v61, v61
  v_rcp_f32 v64, v64
  v_rcp_f32 v65, v65
  v_rcp_f32 v68, v68
  v_rcp_f32 v69, v69
  v_pk_fma_f32 v[16:17], v[56:57], v[158:159], v[16:17]
  v_pk_fma_f32 v[18:19], v[60:61], v[162:163], v[18:19]
  v_pk_fma_f32 v[20:21], v[64:65], v[166:167], v[20:21]
  v_pk_fma_f32 v[22:23], v[68:69], v[170:171], v[22:23]
  v_pk_mul_f32 v[40:41], v[172:173], v[172:173]
  v_pk_mul_f32 v[44:45], v[176:177], v[176:177]
  v_pk_mul_f32 v[48:49], v[180:181], v[180:181]
  v_pk_mul_f32 v[52:53], v[184:185], v[184:185]
  v_pk_fma_f32 v[40:41], v[40:41], v[234:235], v[232:233]
  v_pk_fma_f32 v[44:45], v[44:45], v[234:235], v[232:233]
  v_pk_fma_f32 v[48:49], v[48:49], v[234:235], v[232:233]
  v_pk_fma_f32 v[52:53], v[52:53], v[234:235], v[232:233]
  v_pk_mul_f32 v[40:41], v[40:41], v[172:173]
  v_pk_mul_f32 v[44:45], v[44:45], v[176:177]
  v_pk_mul_f32 v[48:49], v[48:49], v[180:181]
  v_pk_mul_f32 v[52:53], v[52:53], v[184:185]
  v_exp_f32 v40, v40
  v_exp_f32 v41, v41
  v_exp_f32 v44, v44
  v_exp_f32 v45, v45
  v_exp_f32 v48, v48
  v_exp_f32 v49, v49
  v_exp_f32 v52, v52
  v_exp_f32 v53, v53
  v_pk_fma_f32 v[40:41], v[40:41], v[120:121], v[120:121]
  v_pk_fma_f32 v[44:45], v[44:45], v[120:121], v[120:121]
  v_pk_fma_f32 v[48:49], v[48:49], v[120:121], v[120:121]
  v_pk_fma_f32 v[52:53], v[52:53], v[120:121], v[120:121]
  v_rcp_f32 v40, v40
  v_rcp_f32 v41, v41
  v_rcp_f32 v44, v44
  v_rcp_f32 v45, v45
  v_rcp_f32 v48, v48
  v_rcp_f32 v49, v49
  v_rcp_f32 v52, v52
  v_rcp_f32 v53, v53
  v_pk_fma_f32 v[16:17], v[40:41], v[172:173], v[16:17]
  v_pk_fma_f32 v[18:19], v[44:45], v[176:177], v[18:19]
  v_pk_fma_f32 v[20:21], v[48:49], v[180:181], v[20:21]
  v_pk_fma_f32 v[22:23], v[52:53], v[184:185], v[22:23]
  v_pk_mul_f32 v[56:57], v[174:175], v[174:175]
  v_pk_mul_f32 v[60:61], v[178:179], v[178:179]
  v_pk_mul_f32 v[64:65], v[182:183], v[182:183]
  v_pk_mul_f32 v[68:69], v[186:187], v[186:187]
  v_pk_fma_f32 v[56:57], v[56:57], v[234:235], v[232:233]
  v_pk_fma_f32 v[60:61], v[60:61], v[234:235], v[232:233]
  v_pk_fma_f32 v[64:65], v[64:65], v[234:235], v[232:233]
  v_pk_fma_f32 v[68:69], v[68:69], v[234:235], v[232:233]
  v_pk_mul_f32 v[56:57], v[56:57], v[174:175]
  v_pk_mul_f32 v[60:61], v[60:61], v[178:179]
  v_pk_mul_f32 v[64:65], v[64:65], v[182:183]
  v_pk_mul_f32 v[68:69], v[68:69], v[186:187]
  v_exp_f32 v56, v56
  v_exp_f32 v57, v57
  v_exp_f32 v60, v60
  v_exp_f32 v61, v61
  v_exp_f32 v64, v64
  v_exp_f32 v65, v65
  v_exp_f32 v68, v68
  v_exp_f32 v69, v69
  v_pk_fma_f32 v[56:57], v[56:57], v[122:123], v[122:123]
  v_pk_fma_f32 v[60:61], v[60:61], v[122:123], v[122:123]
  v_pk_fma_f32 v[64:65], v[64:65], v[122:123], v[122:123]
  v_pk_fma_f32 v[68:69], v[68:69], v[122:123], v[122:123]
  v_rcp_f32 v56, v56
  v_rcp_f32 v57, v57
  v_rcp_f32 v60, v60
  v_rcp_f32 v61, v61
  v_rcp_f32 v64, v64
  v_rcp_f32 v65, v65
  v_rcp_f32 v68, v68
  v_rcp_f32 v69, v69
  v_pk_fma_f32 v[16:17], v[56:57], v[174:175], v[16:17]
  v_pk_fma_f32 v[18:19], v[60:61], v[178:179], v[18:19]
  v_pk_fma_f32 v[20:21], v[64:65], v[182:183], v[20:21]
  v_pk_fma_f32 v[22:23], v[68:69], v[186:187], v[22:23]
  v_pk_mul_f32 v[40:41], v[188:189], v[188:189]
  v_pk_mul_f32 v[44:45], v[192:193], v[192:193]
  v_pk_mul_f32 v[48:49], v[196:197], v[196:197]
  v_pk_mul_f32 v[52:53], v[200:201], v[200:201]
  v_pk_fma_f32 v[40:41], v[40:41], v[234:235], v[232:233]
  v_pk_fma_f32 v[44:45], v[44:45], v[234:235], v[232:233]
  v_pk_fma_f32 v[48:49], v[48:49], v[234:235], v[232:233]
  v_pk_fma_f32 v[52:53], v[52:53], v[234:235], v[232:233]
  v_pk_mul_f32 v[40:41], v[40:41], v[188:189]
  v_pk_mul_f32 v[44:45], v[44:45], v[192:193]
  v_pk_mul_f32 v[48:49], v[48:49], v[196:197]
  v_pk_mul_f32 v[52:53], v[52:53], v[200:201]
  v_exp_f32 v40, v40
  v_exp_f32 v41, v41
  v_exp_f32 v44, v44
  v_exp_f32 v45, v45
  v_exp_f32 v48, v48
  v_exp_f32 v49, v49
  v_exp_f32 v52, v52
  v_exp_f32 v53, v53
  v_pk_fma_f32 v[40:41], v[40:41], v[124:125], v[124:125]
  v_pk_fma_f32 v[44:45], v[44:45], v[124:125], v[124:125]
  v_pk_fma_f32 v[48:49], v[48:49], v[124:125], v[124:125]
  v_pk_fma_f32 v[52:53], v[52:53], v[124:125], v[124:125]
  v_rcp_f32 v40, v40
  v_rcp_f32 v41, v41
  v_rcp_f32 v44, v44
  v_rcp_f32 v45, v45
  v_rcp_f32 v48, v48
  v_rcp_f32 v49, v49
  v_rcp_f32 v52, v52
  v_rcp_f32 v53, v53
  v_pk_fma_f32 v[16:17], v[40:41], v[188:189], v[16:17]
  v_pk_fma_f32 v[18:19], v[44:45], v[192:193], v[18:19]
  v_pk_fma_f32 v[20:21], v[48:49], v[196:197], v[20:21]
  v_pk_fma_f32 v[22:23], v[52:53], v[200:201], v[22:23]
  v_pk_mul_f32 v[56:57], v[190:191], v[190:191]
  v_pk_mul_f32 v[60:61], v[194:195], v[194:195]
  v_pk_mul_f32 v[64:65], v[198:199], v[198:199]
  v_pk_mul_f32 v[68:69], v[202:203], v[202:203]
  v_pk_fma_f32 v[56:57], v[56:57], v[234:235], v[232:233]
  v_pk_fma_f32 v[60:61], v[60:61], v[234:235], v[232:233]
  v_pk_fma_f32 v[64:65], v[64:65], v[234:235], v[232:233]
  v_pk_fma_f32 v[68:69], v[68:69], v[234:235], v[232:233]
  v_pk_mul_f32 v[56:57], v[56:57], v[190:191]
  v_pk_mul_f32 v[60:61], v[60:61], v[194:195]
  v_pk_mul_f32 v[64:65], v[64:65], v[198:199]
  v_pk_mul_f32 v[68:69], v[68:69], v[202:203]
  v_exp_f32 v56, v56
  v_exp_f32 v57, v57
  v_exp_f32 v60, v60
  v_exp_f32 v61, v61
  v_exp_f32 v64, v64
  v_exp_f32 v65, v65
  v_exp_f32 v68, v68
  v_exp_f32 v69, v69
  v_pk_fma_f32 v[56:57], v[56:57], v[126:127], v[126:127]
  v_pk_fma_f32 v[60:61], v[60:61], v[126:127], v[126:127]
  v_pk_fma_f32 v[64:65], v[64:65], v[126:127], v[126:127]
  v_pk_fma_f32 v[68:69], v[68:69], v[126:127], v[126:127]
  v_rcp_f32 v56, v56
  v_rcp_f32 v57, v57
  v_rcp_f32 v60, v60
  v_rcp_f32 v61, v61
  v_rcp_f32 v64, v64
  v_rcp_f32 v65, v65
  v_rcp_f32 v68, v68
  v_rcp_f32 v69, v69
  v_pk_fma_f32 v[16:17], v[56:57], v[190:191], v[16:17]
  v_pk_fma_f32 v[18:19], v[60:61], v[194:195], v[18:19]
  v_pk_fma_f32 v[20:21], v[64:65], v[198:199], v[20:21]
  v_pk_fma_f32 v[22:23], v[68:69], v[202:203], v[22:23]
  v_pk_mul_f32 v[40:41], v[204:205], v[204:205]
  v_pk_mul_f32 v[44:45], v[208:209], v[208:209]
  v_pk_mul_f32 v[48:49], v[212:213], v[212:213]
  v_pk_mul_f32 v[52:53], v[216:217], v[216:217]
  v_pk_fma_f32 v[40:41], v[40:41], v[234:235], v[232:233]
  v_pk_fma_f32 v[44:45], v[44:45], v[234:235], v[232:233]
  v_pk_fma_f32 v[48:49], v[48:49], v[234:235], v[232:233]
  v_pk_fma_f32 v[52:53], v[52:53], v[234:235], v[232:233]
  v_pk_mul_f32 v[40:41], v[40:41], v[204:205]
  v_pk_mul_f32 v[44:45], v[44:45], v[208:209]
  v_pk_mul_f32 v[48:49], v[48:49], v[212:213]
  v_pk_mul_f32 v[52:53], v[52:53], v[216:217]
  v_exp_f32 v40, v40
  v_exp_f32 v41, v41
  v_exp_f32 v44, v44
  v_exp_f32 v45, v45
  v_exp_f32 v48, v48
  v_exp_f32 v49, v49
  v_exp_f32 v52, v52
  v_exp_f32 v53, v53
  v_pk_fma_f32 v[40:41], v[40:41], v[128:129], v[128:129]
  v_pk_fma_f32 v[44:45], v[44:45], v[128:129], v[128:129]
  v_pk_fma_f32 v[48:49], v[48:49], v[128:129], v[128:129]
  v_pk_fma_f32 v[52:53], v[52:53], v[128:129], v[128:129]
  v_rcp_f32 v40, v40
  v_rcp_f32 v41, v41
  v_rcp_f32 v44, v44
  v_rcp_f32 v45, v45
  v_rcp_f32 v48, v48
  v_rcp_f32 v49, v49
  v_rcp_f32 v52, v52
  v_rcp_f32 v53, v53
  v_pk_fma_f32 v[16:17], v[40:41], v[204:205], v[16:17]
  v_pk_fma_f32 v[18:19], v[44:45], v[208:209], v[18:19]
  v_pk_fma_f32 v[20:21], v[48:49], v[212:213], v[20:21]
  v_pk_fma_f32 v[22:23], v[52:53], v[216:217], v[22:23]
  v_pk_mul_f32 v[56:57], v[206:207], v[206:207]
  v_pk_mul_f32 v[60:61], v[210:211], v[210:211]
  v_pk_mul_f32 v[64:65], v[214:215], v[214:215]
  v_pk_mul_f32 v[68:69], v[218:219], v[218:219]
  v_pk_fma_f32 v[56:57], v[56:57], v[234:235], v[232:233]
  v_pk_fma_f32 v[60:61], v[60:61], v[234:235], v[232:233]
  v_pk_fma_f32 v[64:65], v[64:65], v[234:235], v[232:233]
  v_pk_fma_f32 v[68:69], v[68:69], v[234:235], v[232:233]
  v_pk_mul_f32 v[56:57], v[56:57], v[206:207]
  v_pk_mul_f32 v[60:61], v[60:61], v[210:211]
  v_pk_mul_f32 v[64:65], v[64:65], v[214:215]
  v_pk_mul_f32 v[68:69], v[68:69], v[218:219]
  v_exp_f32 v56, v56
  v_exp_f32 v57, v57
  v_exp_f32 v60, v60
  v_exp_f32 v61, v61
  v_exp_f32 v64, v64
  v_exp_f32 v65, v65
  v_exp_f32 v68, v68
  v_exp_f32 v69, v69
  v_pk_fma_f32 v[56:57], v[56:57], v[130:131], v[130:131]
  v_pk_fma_f32 v[60:61], v[60:61], v[130:131], v[130:131]
  v_pk_fma_f32 v[64:65], v[64:65], v[130:131], v[130:131]
  v_pk_fma_f32 v[68:69], v[68:69], v[130:131], v[130:131]
  v_rcp_f32 v56, v56
  v_rcp_f32 v57, v57
  v_rcp_f32 v60, v60
  v_rcp_f32 v61, v61
  v_rcp_f32 v64, v64
  v_rcp_f32 v65, v65
  v_rcp_f32 v68, v68
  v_rcp_f32 v69, v69
  v_pk_fma_f32 v[16:17], v[56:57], v[206:207], v[16:17]
  v_pk_fma_f32 v[18:19], v[60:61], v[210:211], v[18:19]
  v_pk_fma_f32 v[20:21], v[64:65], v[214:215], v[20:21]
  v_pk_fma_f32 v[22:23], v[68:69], v[218:219], v[22:23]
  v_add_f32 v16, v16, v17
  v_add_f32 v18, v18, v19
  v_add_f32 v20, v20, v21
  v_add_f32 v22, v22, v23
  s_nop 0
  v_permlane32_swap_b32 v16, v20
  v_permlane32_swap_b32 v18, v22
  v_add_f32 v16, v16, v20
  v_add_f32 v18, v18, v22
  s_nop 1
  v_permlane16_swap_b32 v16, v18
  v_add_f32 v16, v16, v18
  ds_write_b32 v36, v16
  s_waitcnt lgkmcnt(0)
  s_cmp_eq_u32 s3, 0
  s_cbranch_scc1 L_dpub
  s_barrier
  s_endpgm
L_dpub:
  s_mov_b32 s60, s24
  s_and_b32 s61, s25, 0xffff
  s_mov_b32 s62, 268435456
  s_mov_b32 s63, 0x20000
  s_mov_b32 s64, s22
  s_and_b32 s65, s23, 0xffff
  s_mov_b32 s66, 256
  s_mov_b32 s67, 0x20000
  s_waitcnt vmcnt(0)
  v_cmp_eq_u32 vcc, 0, v37
  s_nop 0
  s_and_b32 vcc_lo, vcc_lo, 0xff
  s_cbranch_scc0 L_dclr_ok
  s_mov_b32 s78, 0x40000
L_dclr:
  s_sub_u32 s78, s78, 1
  s_cbranch_scc1 L_dclr_ok
  v_lshlrev_b32 v37, 2, v0
  v_and_b32 v37, 31, v37
  buffer_load_dword v37, v37, s[64:67], 0 offen offset:128 sc1
  s_waitcnt vmcnt(0)
  v_cmp_eq_u32 vcc, 0, v37
  s_nop 0
  s_and_b32 vcc_lo, vcc_lo, 0xff
  s_cbranch_scc1 L_dclr
L_dclr_ok:
  s_barrier
  ds_read_b64 v[64:65], v2 offset:0
  ds_read_b64 v[66:67], v2 offset:512
  ds_read_b64 v[68:69], v2 offset:1024
  ds_read_b64 v[70:71], v2 offset:1536
  s_waitcnt lgkmcnt(2)
  v_pk_add_f32 v[64:65], v[64:65], v[66:67]
  s_waitcnt lgkmcnt(0)
  v_pk_add_f32 v[68:69], v[68:69], v[70:71]
  v_pk_add_f32 v[64:65], v[64:65], v[68:69]
  v_and_b32 v64, -2, v64
  v_and_b32 v65, -2, v65
  buffer_store_dwordx2 v[64:65], v3, s[60:63], s69 offen sc1
  s_endpgm
L_cin:
  s_and_b32 s68, s26, 3
  s_mul_i32 s68, s68, 3
  s_add_u32 s27, s68, s27
  s_sub_u32 s27, s27, 6
  s_cbranch_scc1 L_rem
  s_and_b32 s79, s3, 3
  s_lshr_b32 s84, s3, 2
  s_lshl_b32 s100, s27, 3
  s_add_u32 s100, s100, s3
  s_mul_i32 s68, s100, 1280
  v_min_u32 v40, 9, v0
  v_lshlrev_b32 v40, 7, v40
  v_lshlrev_b32 v48, 4, v0
  s_lshl_b32 s95, s79, 10
  s_cmp_eq_u32 s79, 2
  s_cselect_b64 s[82:83], 0x1fffff, -1
  s_cmp_eq_u32 s79, 3
  s_cselect_b32 s96, 0, 32768
  s_add_u32 s96, s96, s95
  s_mul_i32 s69, s27, 2979
  s_lshr_b32 s69, s69, 6
  s_mul_i32 s98, s27, 44
  s_and_b32 s70, s2, 7
  s_add_u32 s85, s98, s3
  s_lshl_b32 s85, s85, 2
  s_lshl_b32 s98, s70, 14
  s_add_u32 s85, s85, s98
  s_add_u32 s85, s85, 10240
  s_mul_i32 s98, s27, 44
  s_lshl_b32 s77, s70, 9
  s_add_u32 s94, s77, s98
  s_add_u32 s77, s77, s69
  s_add_u32 s94, s94, s3
  s_mul_i32 s94, s94, 104
  s_lshl_b32 s98, s27, 2
  s_add_u32 s98, s98, s3
  s_add_u32 s98, s98, s70
  s_and_b32 s98, s98, 7
  s_mul_i32 s98, s98, 16640
  s_add_u32 s98, s98, 12288
  s_sub_u32 s72, 6, s84
  s_lshl_b32 s99, s84, 1
  s_mov_b32 s26, -1
  v_lshrrev_b32 v43, 3, v0
  v_min_u32 v43, 6, v43
  v_lshlrev_b32 v17, 4, v43
  s_mul_i32 s70, s70, 88
  s_add_u32 s70, s100, s70
  s_mov_b32 s71, 704
  v_mov_b32 v44, s70
  v_mad_u32_u24 v19, v0, s71, v44
  s_mul_i32 s70, s100, 104
  s_sub_u32 s70, s70, 313
  v_min_u32 v44, 16, v0
  v_mul_u32_u24 v45, 26, v44
  v_add_u32 v45, s70, v45
  v_cmp_lt_u32 vcc, 12, v44
  s_nop 1
  v_cndmask_b32 v19, v19, v45, vcc
  v_lshlrev_b32 v19, 7, v19
  s_mov_b32 s101, 212992
  v_mov_b32 v2, 110464
  v_lshlrev_b32 v1, 20, v0
  v_add_u32 v1, 110464, v1
  v_and_b32 v44, 7, v0
  v_lshlrev_b32 v18, 4, v44
  v_and_b32 v44, 15, v0
  v_lshl_add_u32 v44, v44, 2, v2
  v_mov_b32 v3, 0
  ds_write_b32 v44, v3
  v_lshrrev_b32 v41, 5, v0
  v_and_b32 v42, 31, v0
  s_waitcnt lgkmcnt(0)
  v_mov_b32 v3, 1
  s_mov_b32 s32, s6
  s_and_b32 s33, s7, 0xffff
  s_mov_b32 s34, 12800000
  s_mov_b32 s35, 0x20000
  v_mov_b32 v45, s80
  buffer_load_dword v255, v45, s[32:35], 0 offen
  s_mov_b32 s36, s8
  s_and_b32 s37, s9, 0xffff
  s_mov_b32 s38, 105456
  s_mov_b32 s39, 0x20000
  buffer_load_dword v255, v40, s[36:39], s68 offen
  s_mov_b32 s44, s12
  s_and_b32 s45, s13, 0xffff
  s_mov_b32 s46, 5537792
  s_mov_b32 s47, 0x20000
  s_barrier
  s_mov_b64 exec, 131071
  buffer_load_dword v255, v19, s[44:47], s101 offen
  s_mov_b64 exec, -1
  s_add_u32 s101, s101, 1171456
  s_mov_b32 s28, s4
  s_and_b32 s29, s5, 0xffff
  s_mov_b32 s30, 425984
  s_mov_b32 s31, 0x20000
  s_cmp_lg_u32 s84, 0
  s_cbranch_scc1 L_g1a
  s_mov_b32 s40, s10
  s_and_b32 s41, s11, 0xffff
  s_mov_b32 s42, 156
  s_mov_b32 s43, 0x20000
  s_mov_b32 m0, 110272
  s_mov_b64 exec, 0x7ff
  buffer_load_dwordx4 v48, s[40:43], 0 offen lds
  s_mov_b64 exec, -1
  s_add_u32 m0, s95, 71552
  s_add_u32 s81, s95, 70304
  buffer_load_dwordx4 v48, s[36:39], s81 offen lds
  s_add_u32 m0, s95, 75648
  s_add_u32 s81, s95, 74400
  buffer_load_dwordx4 v48, s[36:39], s81 offen lds
  s_add_u32 m0, s95, 79744
  s_add_u32 s81, s95, 78496
  buffer_load_dwordx4 v48, s[36:39], s81 offen lds
  s_add_u32 m0, s95, 83840
  s_add_u32 s81, s95, 82592
  buffer_load_dwordx4 v48, s[36:39], s81 offen lds
  s_add_u32 m0, s95, 87936
  s_add_u32 s81, s95, 86688
  buffer_load_dwordx4 v48, s[36:39], s81 offen lds
  s_add_u32 m0, s95, 92032
  s_add_u32 s81, s95, 90784
  buffer_load_dwordx4 v48, s[36:39], s81 offen lds
  s_add_u32 m0, s95, 96128
  s_add_u32 s81, s95, 94880
  buffer_load_dwordx4 v48, s[36:39], s81 offen lds
  s_add_u32 m0, s95, 100224
  s_add_u32 s81, s95, 98976
  buffer_load_dwordx4 v48, s[36:39], s81 offen lds
  s_add_u32 m0, s96, 71552
  s_add_u32 s81, s96, 70304
  s_mov_b64 exec, s[82:83]
  buffer_load_dwordx4 v48, s[36:39], s81 offen lds
  s_mov_b64 exec, -1
  s_add_u32 m0, s95, 36288
  s_add_u32 s81, s95, 35152
  buffer_load_dwordx4 v48, s[36:39], s81 offen lds
  s_add_u32 m0, s95, 40384
  s_add_u32 s81, s95, 39248
  buffer_load_dwordx4 v48, s[36:39], s81 offen lds
  s_add_u32 m0, s95, 44480
  s_add_u32 s81, s95, 43344
  buffer_load_dwordx4 v48, s[36:39], s81 offen lds
  s_add_u32 m0, s95, 48576
  s_add_u32 s81, s95, 47440
  buffer_load_dwordx4 v48, s[36:39], s81 offen lds
  s_branch L_addrc
L_g1a:
  s_setprio 1
  v_bfe_u32 v43, v0, 2, 2
  v_lshl_add_u32 v43, v41, 3, v43
  v_bfe_u32 v44, v0, 4, 1
  v_lshlrev_b32 v44, 5, v44
  v_and_b32 v45, 3, v0
  v_lshl_add_u32 v44, v45, 3, v44
  v_lshl_add_u32 v240, v43, 6, v44
  v_add_u32 v240, 106816, v240
  s_lshl_b32 s68, s79, 6
  s_add_u32 s68, s68, 36288
  v_add_u32 v44, s68, v44
  v_mul_u32_u24 v45, 1352, v43
  v_add_u32 v241, v44, v45
  v_add_u32 v45, 16, v43
  v_min_u32 v45, 25, v45
  v_mul_u32_u24 v45, 1352, v45
  v_add_u32 v242, v44, v45
  v_add_u32 v45, 20, v43
  v_min_u32 v45, 25, v45
  v_mul_u32_u24 v45, 1352, v45
  v_add_u32 v243, v44, v45
  s_lshl_b32 s68, s79, 5
  v_add_u32 v246, s68, v42
  v_mul_u32_u24 v43, 52, v246
  v_lshl_add_u32 v43, v41, 3, v43
  v_add_u32 v244, 71552, v43
  v_lshlrev_b32 v43, 1, v246
  v_add_u32 v245, 108864, v43
  v_mov_b32 v216, 0
  v_mov_b32 v217, 0
  v_lshlrev_b32 v43, 3, v0
  v_add_u32 v44, 106816, v43
  s_lshl_b32 s68, s79, 9
  v_add_u32 v44, s68, v44
  ds_write_b64 v44, v[216:217]
  v_lshl_add_u32 v43, v41, 7, v246
  s_mov_b32 s69, 2521
  s_mov_b32 s70, 106816
  v_mul_u32_u24 v44, s69, v43
  v_lshrrev_b32 v44, 16, v44
  v_mad_u32_u24 v44, v44, 12, s70
  v_lshl_add_u32 v68, v43, 1, v44
  v_add_u32 v43, 256, v43
  v_mul_u32_u24 v44, s69, v43
  v_lshrrev_b32 v44, 16, v44
  v_mad_u32_u24 v44, v44, 12, s70
  v_lshl_add_u32 v69, v43, 1, v44
  v_add_u32 v43, 256, v43
  v_mul_u32_u24 v44, s69, v43
  v_lshrrev_b32 v44, 16, v44
  v_mad_u32_u24 v44, v44, 12, s70
  v_lshl_add_u32 v70, v43, 1, v44
  v_mov_b32 v44, 676
  v_cmp_gt_u32 s[92:93], v44, v43
  v_add_u32 v43, 0, v246
  v_mul_u32_u24 v44, s69, v43
  v_lshrrev_b32 v44, 16, v44
  v_lshl_add_u32 v44, v44, 2, v244
  v_add_u32 v72, 0, v44
  v_add_u32 v43, 128, v246
  v_mul_u32_u24 v44, s69, v43
  v_lshrrev_b32 v44, 16, v44
  v_lshl_add_u32 v44, v44, 2, v244
  v_add_u32 v73, 6656, v44
  v_add_u32 v43, 256, v246
  v_mul_u32_u24 v44, s69, v43
  v_lshrrev_b32 v44, 16, v44
  v_lshl_add_u32 v44, v44, 2, v244
  v_add_u32 v74, 13312, v44
  v_add_u32 v43, 384, v246
  v_mul_u32_u24 v44, s69, v43
  v_lshrrev_b32 v44, 16, v44
  v_lshl_add_u32 v44, v44, 2, v244
  v_add_u32 v75, 19968, v44
  v_add_u32 v43, 512, v246
  v_mul_u32_u24 v44, s69, v43
  v_lshrrev_b32 v44, 16, v44
  v_lshl_add_u32 v44, v44, 2, v244
  v_add_u32 v76, 26624, v44
  v_add_u32 v43, 640, v246
  v_mul_u32_u24 v44, s69, v43
  v_lshrrev_b32 v44, 16, v44
  v_lshl_add_u32 v44, v44, 2, v244
  v_add_u32 v77, 33280, v44
  v_lshlrev_b32 v78, 4, v41
  v_add_u32 v78, 110376, v78
  v_lshlrev_b32 v79, 1, v0
  v_add_u32 v79, 110272, v79
  v_lshlrev_b32 v80, 6, v0
  v_add_u32 v80, 106868, v80
L_addrc:
  s_and_b32 s70, s3, 1
  s_lshl_b32 s70, s70, 1
  v_add_u32 v46, s70, v41
  v_min_u32 v43, 25, v42
  s_mul_i32 s68, s84, 4
  s_add_u32 s68, s68, 1352
  s_mul_i32 s69, s84, 70528
  s_add_u32 s69, s69, 1024
  v_mul_u32_u24 v44, s68, v43
  v_add_u32 v44, s69, v44
  v_lshlrev_b32 v247, 2, v43
  v_add_u32 v247, 70528, v247
  v_mul_u32_u24 v65, 52, v43
  v_lshl_add_u32 v65, v46, 1, v65
  v_add_u32 v65, 108864, v65
  v_lshlrev_b32 v67, 1, v43
  v_add_u32 v67, 110272, v67
  v_mad_u32_u24 v60, v46, 52, v44
  v_lshl_add_u32 v61, v46, 1, v44
  v_lshl_add_u32 v49, v46, 1, v60
  v_lshlrev_b32 v43, 3, v46
  s_mov_b32 s68, 0x01000100
  v_bfe_i32 v45, s68, v43, 8
  v_lshl_add_u32 v50, v45, 1, v60
  v_mad_i32_i24 v51, v45, 52, v61
  s_mov_b32 s68, 0xff00ff00
  v_bfe_i32 v45, s68, v43, 8
  v_lshl_add_u32 v52, v45, 1, v60
  v_mad_i32_i24 v53, v45, 52, v61
  s_mov_b32 s68, 0xff020100
  v_bfe_i32 v45, s68, v43, 8
  v_lshl_add_u32 v54, v45, 1, v60
  v_mad_i32_i24 v55, v45, 52, v61
  s_mov_b32 s68, 0x0b0a0100
  v_bfe_i32 v45, s68, v43, 8
  v_lshl_add_u32 v56, v45, 1, v60
  v_mad_i32_i24 v57, v45, 52, v61
  s_mov_b32 s68, 0xf3f20100
  v_bfe_i32 v45, s68, v43, 8
  v_lshl_add_u32 v58, v45, 1, v60
  v_mad_i32_i24 v59, v45, 52, v61
  s_mov_b32 s68, 0x00023600
  v_bfe_u32 v45, s68, v43, 8
  v_add_u32 v60, v45, v44
  v_add_u32 v61, 52, v44
  v_mov_b32 v47, 1048576
  v_cmp_eq_u32 vcc, 3, v46
  s_nop 1
  v_cndmask_b32 v60, v60, v47, vcc
  v_cndmask_b32 v67, v47, v67, vcc
  v_cmp_eq_u32 vcc, 2, v46
  s_nop 1
  v_cndmask_b32 v61, v47, v61, vcc
  v_cmp_gt_u32 vcc, 2, v46
  s_nop 1
  v_cndmask_b32 v64, v47, v65, vcc
  s_lshr_b32 s69, s79, 1
  s_mul_i32 s69, s69, 6144
  s_mul_i32 s68, s84, 6144
  v_lshlrev_b32 v45, 8, v46
  v_lshl_add_u32 v43, v42, 4, v45
  v_add_u32 v63, 1024, v43
  v_add_u32 v66, 36288, v43
  v_bfe_u32 v43, v0, 2, 2
  v_lshl_add_u32 v45, v43, 4, v45
  v_and_b32 v43, 3, v0
  v_lshl_add_u32 v44, v43, 6, v45
  v_add_u32 v44, 12288, v44
  v_cmp_lt_u32 vcc, 15, v42
  s_nop 1
  v_cndmask_b32 v63, v63, v44, vcc
  v_add_u32 v44, 16, v44
  v_cndmask_b32 v66, v66, v44, vcc
  v_lshl_add_u32 v44, v43, 5, v45
  v_add_u32 v44, 24560, v44
  v_cmp_lt_u32 vcc, 19, v42
  s_nop 1
  v_cndmask_b32 v63, v63, v44, vcc
  v_add_u32 v63, s69, v63
  v_add_u32 v66, s68, v66
  v_cmp_lt_u32 vcc, 25, v42
  s_nop 1
  v_cndmask_b32 v63, v63, v47, vcc
  v_cndmask_b32 v66, v66, v47, vcc
  v_mov_b32 v62, 0
  s_mul_i32 s74, s3, 4224
  s_add_u32 s74, s74, 111040
  s_mov_b32 s75, -39488
  v_add_u32 v28, 1024, v48
  v_and_b32 v43, 11, v0
  v_cmp_eq_u32 vcc, 11, v43
  s_nop 1
  v_cndmask_b32 v31, v28, v47, vcc
  v_and_b32 v43, 3, v0
  v_cmp_eq_u32 vcc, 0, v43
  s_nop 1
  v_cndmask_b32 v30, v31, v47, vcc
  v_lshrrev_b32 v46, 4, v0
  v_bfe_u32 v43, v0, 1, 3
  v_lshlrev_b32 v45, 4, v43
  v_add_u32 v45, 24576, v45
  v_and_b32 v43, 10, v0
  v_cmp_eq_u32 vcc, 10, v43
  s_nop 1
  v_cndmask_b32 v45, v45, v47, vcc
  v_and_b32 v44, 1, v0
  v_lshl_add_u32 v29, v46, 9, v45
  v_lshl_add_u32 v29, v44, 2, v29
  v_add_u32 v29, 1024, v29
  v_lshl_add_u32 v22, v46, 8, v45
  v_lshl_add_u32 v22, v44, 20, v22
  v_and_b32 v47, 15, v0
  s_mov_b32 s68, 1056
  v_lshlrev_b32 v43, 1, v47
  v_add_u32 v43, s74, v43
  v_mad_u32_u24 v7, v46, s68, v43
  s_lshl_b32 s68, s3, 10
  s_add_u32 s68, s68, 144832
  v_add_u32 v10, s68, v48
  v_add_u32 v43, 256, v48
  v_and_b32 v43, 1023, v43
  v_add_u32 v11, s68, v43
  v_xor_b32 v43, 512, v48
  v_add_u32 v12, s68, v43
  v_lshlrev_b32 v13, 4, v41
  v_mov_b32 v32, 0
  v_mov_b32 v33, 0
  v_mov_b32 v34, 0
  v_mov_b32 v35, 0
  v_mov_b32 v36, 0
  v_mov_b32 v37, 0
  v_mov_b32 v38, 0
  v_mov_b32 v39, 0
  v_mov_b32 v216, 0
  v_mov_b32 v217, 0
  v_mov_b32 v218, 0
  v_mov_b32 v219, 0
  v_mov_b32 v220, 0
  v_mov_b32 v221, 0
  v_mov_b32 v222, 0
  v_mov_b32 v223, 0
  v_mov_b32 v224, 0
  v_mov_b32 v225, 0
  v_mov_b32 v226, 0
  v_mov_b32 v227, 0
  v_mov_b32 v228, 0
  v_mov_b32 v229, 0
  v_mov_b32 v230, 0
  v_mov_b32 v231, 0
  v_mov_b32 v232, 0
  v_mov_b32 v233, 0
  v_mov_b32 v234, 0
  v_mov_b32 v235, 0
  v_mov_b32 v236, 0
  v_mov_b32 v237, 0
  v_mov_b32 v238, 0
  v_mov_b32 v239, 0
  v_mul_u32_u24 v44, 1056, v46
  v_bfe_u32 v45, v0, 2, 2
  v_lshl_add_u32 v44, v45, 7, v44
  v_and_b32 v45, 3, v0
  v_lshl_add_u32 v9, v45, 3, v44
  v_add_u32 v8, s74, v9
  v_and_b32 v45, 1, v0
  s_mov_b32 s68, 0xaaaaaaaa
  v_mul_lo_u32 v16, s68, v45
  v_or_b32 v16, 0x44444444, v16
  v_lshlrev_b32 v15, 1, v0
  v_add_u32 v15, s74, v15
  v_mov_b32 v14, 0x3f80
  ds_write_b16 v15, v14 offset:4064
  v_add_u32 v15, s75, v15
  s_mul_i32 s71, s3, 6
  s_add_u32 s77, s77, s71
  s_mul_i32 s77, s77, 104
  s_add_u32 s73, s77, 80
  s_add_u32 s77, s77, 16
  s_mov_b32 s71, 10923
  v_min_u32 v43, 35, v0
  v_mul_u32_u24 v44, s71, v43
  v_lshrrev_b32 v44, 16, v44
  v_mul_u32_u24 v44, 80, v44
  v_lshl_add_u32 v20, v43, 2, v44
  s_cmp_eq_u32 s84, 0
  s_cbranch_scc1 L_g0pf
  s_waitcnt lgkmcnt(0)
  ds_add_u32 v1, v3 offset:0
  s_sub_u32 s94, s94, 416
  buffer_load_dwordx4 v[204:207], v17, s[28:31], s94 offen offset:0
  s_add_u32 s94, s94, 416
  buffer_load_dwordx4 v[24:27], v17, s[28:31], s94 offen offset:0
  s_add_u32 s94, s94, 832
  s_sub_u32 s68, s77, 2496
  buffer_load_dword v208, v20, s[28:31], s68 offen
  buffer_load_dword v209, v20, s[28:31], s77 offen
  s_add_u32 s77, s77, 24
  buffer_load_dword v21, v20, s[28:31], s77 offen
  s_cmp_eq_u32 s77, s73
  s_cselect_b32 s73, 0x7000000, s73
  s_cselect_b32 s77, 0x7000000, s77
  s_add_u32 s77, s77, 24
  s_min_u32 s77, s77, s73
L_csync1:
  ds_read_b32 v4, v2 offset:0
  s_waitcnt lgkmcnt(0)
  v_cmp_gt_u32 vcc, 8, v4
  s_cbranch_vccnz L_csync1
  ds_read_b64 v[132:133], v78 offset:0
  ds_read_b64 v[134:135], v78 offset:8
  ds_read_b64 v[136:137], v78 offset:32
  ds_read_b64 v[138:139], v78 offset:40
  ds_read_u16 v45, v79 offset:52
  ds_read_b64_tr_b16 v[84:85], v241 offset:35264
  ds_read_b64_tr_b16 v[86:87], v241 offset:40672
  ds_read_b64_tr_b16 v[88:89], v242 offset:35264
  ds_read_b64_tr_b16 v[90:91], v243 offset:35264
  ds_read_b64_tr_b16 v[92:93], v241 offset:35520
  ds_read_b64_tr_b16 v[94:95], v241 offset:40928
  ds_read_b64_tr_b16 v[96:97], v242 offset:35520
  ds_read_b64_tr_b16 v[98:99], v243 offset:35520
  ds_read_b64_tr_b16 v[100:101], v241 offset:35776
  ds_read_b64_tr_b16 v[102:103], v241 offset:41184
  ds_read_b64_tr_b16 v[104:105], v242 offset:35776
  ds_read_b64_tr_b16 v[106:107], v243 offset:35776
  ds_read_b64_tr_b16 v[108:109], v241 offset:36032
  ds_read_b64_tr_b16 v[110:111], v241 offset:41440
  ds_read_b64_tr_b16 v[112:113], v242 offset:36032
  ds_read_b64_tr_b16 v[114:115], v243 offset:36032
  s_waitcnt lgkmcnt(14)
  v_mfma_f32_32x32x16_bf16 v[140:155], v[132:135], v[84:87], 0
  s_waitcnt lgkmcnt(12)
  v_mfma_f32_32x32x16_bf16 v[140:155], v[136:139], v[88:91], v[140:155]
  ds_read_b64_tr_b16 v[116:117], v241 offset:36288
  ds_read_b64_tr_b16 v[118:119], v241 offset:41696
  ds_read_b64_tr_b16 v[120:121], v242 offset:36288
  ds_read_b64_tr_b16 v[122:123], v243 offset:36288
  s_waitcnt lgkmcnt(14)
  v_mfma_f32_32x32x16_bf16 v[156:171], v[132:135], v[92:95], 0
  s_waitcnt lgkmcnt(12)
  v_mfma_f32_32x32x16_bf16 v[156:171], v[136:139], v[96:99], v[156:171]
  ds_read_b64_tr_b16 v[124:125], v241 offset:36544
  ds_read_b64_tr_b16 v[126:127], v241 offset:41952
  ds_read_b64_tr_b16 v[128:129], v242 offset:36544
  ds_read_b64_tr_b16 v[130:131], v243 offset:36544
  s_waitcnt lgkmcnt(14)
  v_mfma_f32_32x32x16_bf16 v[172:187], v[132:135], v[100:103], 0
  s_waitcnt lgkmcnt(12)
  v_mfma_f32_32x32x16_bf16 v[172:187], v[136:139], v[104:107], v[172:187]
  v_cvt_pk_bf16_f32 v81, v140, 0
  s_waitcnt lgkmcnt(10)
  v_mfma_f32_32x32x16_bf16 v[188:203], v[132:135], v[108:111], 0
  s_waitcnt lgkmcnt(8)
  v_mfma_f32_32x32x16_bf16 v[188:203], v[136:139], v[112:115], v[188:203]
  s_mov_b32 exec_lo, 0
  v_cvt_pk_bf16_f32 v81, v156, 0
  s_mov_b32 exec_lo, -1
  ds_write_b16 v68, v81
  s_waitcnt lgkmcnt(7)
  v_mfma_f32_32x32x16_bf16 v[140:155], v[132:135], v[116:119], 0
  s_waitcnt lgkmcnt(5)
  v_mfma_f32_32x32x16_bf16 v[140:155], v[136:139], v[120:123], v[140:155]
  v_cvt_pk_bf16_f32 v82, v172, 0
  s_waitcnt lgkmcnt(3)
  v_mfma_f32_32x32x16_bf16 v[156:171], v[132:135], v[124:127], 0
  s_waitcnt lgkmcnt(1)
  v_mfma_f32_32x32x16_bf16 v[156:171], v[136:139], v[128:131], v[156:171]
  s_mov_b32 exec_lo, 0
  v_cvt_pk_bf16_f32 v82, v188, 0
  s_mov_b32 exec_lo, -1
  ds_write_b16 v69, v82
  s_nop 2
  v_cvt_pk_bf16_f32 v83, v140, 0
  s_mov_b32 exec_lo, 0
  s_nop 2
  v_cvt_pk_bf16_f32 v83, v156, 0
  s_mov_b64 exec, s[92:93]
  ds_write_b16 v70, v83
  s_mov_b64 exec, 0x3ffffff
  ds_write_b16 v80, v45
  s_mov_b64 exec, -1
  s_waitcnt lgkmcnt(0)
  ds_add_u32 v1, v3 offset:32
  s_mov_b64 exec, 131071
  buffer_load_dword v255, v19, s[44:47], s101 offen
  s_mov_b64 exec, -1
  s_add_u32 s101, s101, 1171456
  v_cmp_gt_u32 s[92:93], 36, v246
  s_waitcnt vmcnt(3)
  v_lshlrev_b32 v208, 7, v208
  buffer_load_dword v255, v208, s[32:35], 0 offen
  s_waitcnt vmcnt(3)
  v_lshlrev_b32 v209, 7, v209
  buffer_load_dword v255, v209, s[32:35], 0 offen
L_csync2:
  ds_read_b32 v4, v2 offset:4
  s_waitcnt lgkmcnt(0)
  v_cmp_gt_u32 vcc, 4, v4
  s_cbranch_vccnz L_csync2
  ds_read_b64_tr_b16 v[84:85], v241 offset:0
  ds_read_b64_tr_b16 v[86:87], v241 offset:5408
  ds_read_b64_tr_b16 v[88:89], v242 offset:0
  ds_read_b64_tr_b16 v[90:91], v243 offset:0
  ds_read_b64_tr_b16 v[92:93], v241 offset:256
  ds_read_b64_tr_b16 v[94:95], v241 offset:5664
  ds_read_b64_tr_b16 v[96:97], v242 offset:256
  ds_read_b64_tr_b16 v[98:99], v243 offset:256
  ds_read_b64_tr_b16 v[100:101], v241 offset:512
  ds_read_b64_tr_b16 v[102:103], v241 offset:5920
  ds_read_b64_tr_b16 v[104:105], v242 offset:512
  ds_read_b64_tr_b16 v[106:107], v243 offset:512
  ds_read_b64_tr_b16 v[108:109], v241 offset:768
  ds_read_b64_tr_b16 v[110:111], v241 offset:6176
  ds_read_b64_tr_b16 v[112:113], v242 offset:768
  ds_read_b64_tr_b16 v[114:115], v243 offset:768
  ds_read_b64_tr_b16 v[116:117], v241 offset:1024
  ds_read_b64_tr_b16 v[118:119], v241 offset:6432
  ds_read_b64_tr_b16 v[120:121], v242 offset:1024
  ds_read_b64_tr_b16 v[122:123], v243 offset:1024
  ds_read_b64_tr_b16 v[124:125], v241 offset:1280
  ds_read_b64_tr_b16 v[126:127], v241 offset:6688
  ds_read_b64_tr_b16 v[128:129], v242 offset:1280
  ds_read_b64_tr_b16 v[130:131], v243 offset:1280
L_csync3:
  ds_read_b32 v4, v2 offset:32
  s_waitcnt lgkmcnt(0)
  v_cmp_gt_u32 vcc, 4, v4
  s_cbranch_vccnz L_csync3
  s_setprio 1
  ds_read_b64_tr_b16 v[132:133], v240 offset:0
  ds_read_b64_tr_b16 v[134:135], v240 offset:256
  ds_read_b64_tr_b16 v[136:137], v240 offset:1024
  ds_read_b64_tr_b16 v[138:139], v240 offset:1280
  s_waitcnt lgkmcnt(2)
  v_mfma_f32_32x32x16_bf16 v[140:155], v[132:135], v[84:87], 0
  s_waitcnt lgkmcnt(0)
  v_mfma_f32_32x32x16_bf16 v[140:155], v[136:139], v[88:91], v[140:155]
  v_mfma_f32_32x32x16_bf16 v[156:171], v[132:135], v[92:95], 0
  v_mfma_f32_32x32x16_bf16 v[156:171], v[136:139], v[96:99], v[156:171]
  v_mfma_f32_32x32x16_bf16 v[172:187], v[132:135], v[100:103], 0
  v_mfma_f32_32x32x16_bf16 v[172:187], v[136:139], v[104:107], v[172:187]
  s_nop 7
  v_cvt_pk_bf16_f32 v84, v140, v141
  v_cvt_pk_bf16_f32 v85, v142, v143
  v_cvt_pk_bf16_f32 v86, v144, v145
  v_cvt_pk_bf16_f32 v87, v146, v147
  v_cvt_pk_bf16_f32 v88, v148, v149
  v_cvt_pk_bf16_f32 v89, v150, v151
  v_cvt_pk_bf16_f32 v90, v152, v153
  v_cvt_pk_bf16_f32 v91, v154, v155
  ds_write2_b32 v72, v84, v85 offset0:0 offset1:1
  v_max3_f32 v62, v62, abs(v140), abs(v141)
  v_max3_f32 v62, v62, abs(v142), abs(v143)
  v_max3_f32 v62, v62, abs(v144), abs(v145)
  ds_write2_b32 v72, v86, v87 offset0:4 offset1:5
  v_max3_f32 v62, v62, abs(v146), abs(v147)
  v_max3_f32 v62, v62, abs(v148), abs(v149)
  ds_write2_b32 v72, v88, v89 offset0:8 offset1:9
  v_max3_f32 v62, v62, abs(v150), abs(v151)
  v_max3_f32 v62, v62, abs(v152), abs(v153)
  v_mfma_f32_32x32x16_bf16 v[188:203], v[132:135], v[108:111], 0
  v_mfma_f32_32x32x16_bf16 v[188:203], v[136:139], v[112:115], v[188:203]
  v_cvt_pk_bf16_f32 v92, v156, v157
  v_cvt_pk_bf16_f32 v93, v158, v159
  v_cvt_pk_bf16_f32 v94, v160, v161
  v_cvt_pk_bf16_f32 v95, v162, v163
  v_cvt_pk_bf16_f32 v96, v164, v165
  v_cvt_pk_bf16_f32 v97, v166, v167
  v_cvt_pk_bf16_f32 v98, v168, v169
  v_cvt_pk_bf16_f32 v99, v170, v171
  ds_write2_b32 v73, v92, v93 offset0:0 offset1:1
  v_max3_f32 v62, v62, abs(v156), abs(v157)
  v_max3_f32 v62, v62, abs(v158), abs(v159)
  v_max3_f32 v62, v62, abs(v160), abs(v161)
  ds_write2_b32 v73, v94, v95 offset0:4 offset1:5
  v_max3_f32 v62, v62, abs(v162), abs(v163)
  v_max3_f32 v62, v62, abs(v164), abs(v165)
  ds_write2_b32 v73, v96, v97 offset0:8 offset1:9
  v_max3_f32 v62, v62, abs(v166), abs(v167)
  v_max3_f32 v62, v62, abs(v168), abs(v169)
  v_mfma_f32_32x32x16_bf16 v[140:155], v[132:135], v[116:119], 0
  v_mfma_f32_32x32x16_bf16 v[140:155], v[136:139], v[120:123], v[140:155]
  v_cvt_pk_bf16_f32 v100, v172, v173
  v_cvt_pk_bf16_f32 v101, v174, v175
  v_cvt_pk_bf16_f32 v102, v176, v177
  v_cvt_pk_bf16_f32 v103, v178, v179
  v_cvt_pk_bf16_f32 v104, v180, v181
  v_cvt_pk_bf16_f32 v105, v182, v183
  v_cvt_pk_bf16_f32 v106, v184, v185
  v_cvt_pk_bf16_f32 v107, v186, v187
  ds_write2_b32 v74, v100, v101 offset0:0 offset1:1
  v_max3_f32 v62, v62, abs(v172), abs(v173)
  v_max3_f32 v62, v62, abs(v174), abs(v175)
  v_max3_f32 v62, v62, abs(v176), abs(v177)
  ds_write2_b32 v74, v102, v103 offset0:4 offset1:5
  v_max3_f32 v62, v62, abs(v178), abs(v179)
  v_max3_f32 v62, v62, abs(v180), abs(v181)
  ds_write2_b32 v74, v104, v105 offset0:8 offset1:9
  v_max3_f32 v62, v62, abs(v182), abs(v183)
  v_max3_f32 v62, v62, abs(v184), abs(v185)
  v_mfma_f32_32x32x16_bf16 v[156:171], v[132:135], v[124:127], 0
  v_mfma_f32_32x32x16_bf16 v[156:171], v[136:139], v[128:131], v[156:171]
  v_cvt_pk_bf16_f32 v108, v188, v189
  v_cvt_pk_bf16_f32 v109, v190, v191
  v_cvt_pk_bf16_f32 v110, v192, v193
  v_cvt_pk_bf16_f32 v111, v194, v195
  v_cvt_pk_bf16_f32 v112, v196, v197
  v_cvt_pk_bf16_f32 v113, v198, v199
  v_cvt_pk_bf16_f32 v114, v200, v201
  v_cvt_pk_bf16_f32 v115, v202, v203
  ds_write2_b32 v75, v108, v109 offset0:0 offset1:1
  v_max3_f32 v62, v62, abs(v188), abs(v189)
  v_max3_f32 v62, v62, abs(v190), abs(v191)
  v_max3_f32 v62, v62, abs(v192), abs(v193)
  ds_write2_b32 v75, v110, v111 offset0:4 offset1:5
  v_max3_f32 v62, v62, abs(v194), abs(v195)
  v_max3_f32 v62, v62, abs(v196), abs(v197)
  ds_write2_b32 v75, v112, v113 offset0:8 offset1:9
  v_max3_f32 v62, v62, abs(v198), abs(v199)
  v_max3_f32 v62, v62, abs(v200), abs(v201)
  v_cvt_pk_bf16_f32 v116, v140, v141
  v_cvt_pk_bf16_f32 v117, v142, v143
  v_cvt_pk_bf16_f32 v118, v144, v145
  v_cvt_pk_bf16_f32 v119, v146, v147
  v_cvt_pk_bf16_f32 v120, v148, v149
  v_cvt_pk_bf16_f32 v121, v150, v151
  v_cvt_pk_bf16_f32 v122, v152, v153
  v_cvt_pk_bf16_f32 v123, v154, v155
  ds_write2_b32 v76, v116, v117 offset0:0 offset1:1
  v_max3_f32 v62, v62, abs(v140), abs(v141)
  v_max3_f32 v62, v62, abs(v142), abs(v143)
  v_max3_f32 v62, v62, abs(v144), abs(v145)
  ds_write2_b32 v76, v118, v119 offset0:4 offset1:5
  v_max3_f32 v62, v62, abs(v146), abs(v147)
  v_max3_f32 v62, v62, abs(v148), abs(v149)
  ds_write2_b32 v76, v120, v121 offset0:8 offset1:9
  v_max3_f32 v62, v62, abs(v150), abs(v151)
  v_max3_f32 v62, v62, abs(v152), abs(v153)
  v_cvt_pk_bf16_f32 v124, v156, v157
  v_cvt_pk_bf16_f32 v125, v158, v159
  v_cvt_pk_bf16_f32 v126, v160, v161
  v_cvt_pk_bf16_f32 v127, v162, v163
  v_cvt_pk_bf16_f32 v128, v164, v165
  v_cvt_pk_bf16_f32 v129, v166, v167
  v_cvt_pk_bf16_f32 v130, v168, v169
  v_cvt_pk_bf16_f32 v131, v170, v171
  s_mov_b64 exec, s[92:93]
  ds_write2_b32 v77, v124, v125 offset0:0 offset1:1
  v_max3_f32 v62, v62, abs(v156), abs(v157)
  v_max3_f32 v62, v62, abs(v158), abs(v159)
  v_max3_f32 v62, v62, abs(v160), abs(v161)
  ds_write2_b32 v77, v126, v127 offset0:4 offset1:5
  v_max3_f32 v62, v62, abs(v162), abs(v163)
  v_max3_f32 v62, v62, abs(v164), abs(v165)
  ds_write2_b32 v77, v128, v129 offset0:8 offset1:9
  v_max3_f32 v62, v62, abs(v166), abs(v167)
  v_max3_f32 v62, v62, abs(v168), abs(v169)
  s_mov_b32 exec_hi, 0
  ds_write_b32 v77, v130 offset:48
  ds_write_b16 v245, v131 offset:1280
  s_mov_b32 exec_lo, -1
  ds_write_b32 v76, v122 offset:48
  ds_write_b16 v245, v123 offset:1024
  ds_write_b32 v75, v114 offset:48
  ds_write_b16 v245, v115 offset:768
  ds_write_b32 v74, v106 offset:48
  ds_write_b16 v245, v107 offset:512
  ds_write_b32 v73, v98 offset:48
  ds_write_b16 v245, v99 offset:256
  ds_write_b32 v72, v90 offset:48
  ds_write_b16 v245, v91 offset:0
  s_mov_b64 exec, -1
  v_max_u32_dpp v62, v62, v62 row_shr:1 row_mask:0xf bank_mask:0xf
  s_nop 1
  v_max_u32_dpp v62, v62, v62 row_shr:2 row_mask:0xf bank_mask:0xf
  s_nop 1
  v_max_u32_dpp v62, v62, v62 row_shr:4 row_mask:0xf bank_mask:0xf
  s_nop 1
  v_max_u32_dpp v62, v62, v62 row_shr:8 row_mask:0xf bank_mask:0xf
  s_nop 1
  v_max_u32_dpp v62, v62, v62 row_bcast:15 row_mask:0xa bank_mask:0xf
  s_nop 1
  v_max_u32_dpp v62, v62, v62 row_bcast:31 row_mask:0xc bank_mask:0xf
  s_nop 0
  v_readlane_b32 s68, v62, 63
  s_nop 1
  v_mov_b32 v62, s68
  ds_max_u32 v1, v62 offset:28
  ds_add_u32 v1, v3 offset:24
  s_setprio 0
  v_lshl_add_u32 v24, v24, 7, v18
  v_lshl_add_u32 v25, v25, 7, v18
  s_mov_b32 exec_hi, 0x0000ffff
  v_lshl_add_u32 v26, v26, 7, v18
  v_lshl_add_u32 v27, v27, 7, v18
  s_mov_b32 exec_lo, 0
  s_mov_b32 exec_hi, 0xffff0000
  v_mov_b32 v27, v25
  v_mov_b32 v26, v25
  s_mov_b32 exec_hi, 0x00ff0000
  v_mov_b32 v26, v24
  s_mov_b64 exec, -1
  s_add_u32 m0, s74, 0
  s_nop 0
  buffer_load_dwordx4 v24, s[32:35], 0 offen lds
  s_add_u32 m0, s74, 1056
  s_nop 0
  buffer_load_dwordx4 v25, s[32:35], 0 offen lds
  s_add_u32 m0, s74, 2112
  s_nop 0
  buffer_load_dwordx4 v26, s[32:35], 0 offen lds
  s_add_u32 m0, s74, 3168
  s_mov_b32 exec_hi, 0x00ffffff
  buffer_load_dwordx4 v27, s[32:35], 0 offen lds
  s_mov_b32 exec_hi, -1
  v_lshl_add_u32 v204, v204, 7, v18
  v_lshl_add_u32 v205, v205, 7, v18
  s_mov_b32 exec_hi, 0x0000ffff
  v_lshl_add_u32 v206, v206, 7, v18
  v_lshl_add_u32 v207, v207, 7, v18
  s_mov_b32 exec_lo, 0
  s_mov_b32 exec_hi, 0xffff0000
  v_mov_b32 v207, v205
  v_mov_b32 v206, v205
  s_mov_b32 exec_hi, 0x00ff0000
  v_mov_b32 v206, v204
  s_mov_b64 exec, -1
  s_add_u32 m0, s74, -16896
  s_nop 0
  buffer_load_dwordx4 v204, s[32:35], 0 offen lds
  s_add_u32 m0, s74, -15840
  s_nop 0
  buffer_load_dwordx4 v205, s[32:35], 0 offen lds
  s_add_u32 m0, s74, -14784
  s_nop 0
  buffer_load_dwordx4 v206, s[32:35], 0 offen lds
  s_add_u32 m0, s74, -13728
  s_mov_b32 exec_hi, 0x00ffffff
  buffer_load_dwordx4 v207, s[32:35], 0 offen lds
  s_mov_b32 exec_hi, -1
  buffer_load_dwordx4 v[24:27], v17, s[28:31], s94 offen offset:0
  s_add_u32 s94, s94, 832
  s_branch L_uph
L_g0pf:
  s_waitcnt vmcnt(4) lgkmcnt(0)
  ds_add_u32 v1, v3 offset:0
  s_add_u32 m0, s95, 52672
  s_add_u32 s81, s95, 51536
  buffer_load_dwordx4 v48, s[36:39], s81 offen lds
  s_add_u32 m0, s95, 56768
  s_add_u32 s81, s95, 55632
  buffer_load_dwordx4 v48, s[36:39], s81 offen lds
  s_add_u32 m0, s95, 60864
  s_add_u32 s81, s95, 59728
  buffer_load_dwordx4 v48, s[36:39], s81 offen lds
  s_add_u32 m0, s95, 64960
  s_add_u32 s81, s95, 63824
  buffer_load_dwordx4 v48, s[36:39], s81 offen lds
  s_add_u32 m0, s96, 36288
  s_add_u32 s81, s96, 35152
  s_mov_b64 exec, s[82:83]
  buffer_load_dwordx4 v48, s[36:39], s81 offen lds
  s_mov_b64 exec, -1
  s_add_u32 m0, s95, 1024
  s_add_u32 s81, s95, 0
  buffer_load_dwordx4 v48, s[36:39], s81 offen lds
  s_add_u32 m0, s95, 5120
  s_add_u32 s81, s95, 4096
  buffer_load_dwordx4 v48, s[36:39], s81 offen lds
  s_add_u32 m0, s95, 9216
  s_add_u32 s81, s95, 8192
  buffer_load_dwordx4 v48, s[36:39], s81 offen lds
  s_add_u32 m0, s95, 13312
  s_add_u32 s81, s95, 12288
  buffer_load_dwordx4 v48, s[36:39], s81 offen lds
  s_waitcnt vmcnt(4) lgkmcnt(0)
  ds_add_u32 v1, v3 offset:4
  s_add_u32 m0, s95, 17408
  s_add_u32 s81, s95, 16384
  buffer_load_dwordx4 v48, s[36:39], s81 offen lds
  s_add_u32 m0, s95, 21504
  s_add_u32 s81, s95, 20480
  buffer_load_dwordx4 v48, s[36:39], s81 offen lds
  s_add_u32 m0, s95, 25600
  s_add_u32 s81, s95, 24576
  buffer_load_dwordx4 v48, s[36:39], s81 offen lds
  s_add_u32 m0, s95, 29696
  s_add_u32 s81, s95, 28672
  buffer_load_dwordx4 v48, s[36:39], s81 offen lds
  s_add_u32 m0, s96, 1024
  s_add_u32 s81, s96, 0
  s_mov_b64 exec, s[82:83]
  buffer_load_dwordx4 v48, s[36:39], s81 offen lds
  s_mov_b64 exec, -1
  s_add_u32 s94, s94, 832
  s_add_u32 s77, s77, 24
  buffer_load_dwordx4 v[24:27], v17, s[28:31], s94 offen offset:0
  s_add_u32 s94, s94, 832
  buffer_load_dword v21, v20, s[28:31], s77 offen
  s_cmp_eq_u32 s77, s73
  s_cselect_b32 s73, 0x7000000, s73
  s_cselect_b32 s77, 0x7000000, s77
  s_add_u32 s77, s77, 24
  s_min_u32 s77, s77, s73
  s_mov_b64 exec, 131071
  buffer_load_dword v255, v19, s[44:47], s101 offen
  s_mov_b64 exec, -1
  s_add_u32 s101, s101, 1171456
  s_waitcnt vmcnt(3) lgkmcnt(0)
  ds_add_u32 v1, v3 offset:8
  s_mov_b32 s97, 0
L_csync4:
  ds_read_b32 v4, v2 offset:8
  s_waitcnt lgkmcnt(0)
  v_cmp_gt_u32 vcc, 4, v4
  s_cbranch_vccnz L_csync4
  s_cmp_ge_u32 s79, 2
  s_cbranch_scc1 L_chunk2
L_chunk0:
  ds_read_u16_d16_hi v216, v49 offset:0
  ds_read_u16_d16_hi v218, v49 offset:648
  ds_read_u16_d16_hi v220, v49 offset:216
  ds_read_u16_d16_hi v222, v49 offset:864
  ds_read_u16_d16_hi v224, v49 offset:432
  ds_read_u16_d16_hi v226, v49 offset:1080
  ds_read_u16_d16_hi v228, v49 offset:8
  ds_read_u16_d16_hi v229, v49 offset:208
  ds_read_u16_d16_hi v230, v49 offset:656
  ds_read_u16_d16_hi v231, v49 offset:856
  s_waitcnt lgkmcnt(8)
  v_mov_b32 v85, v218
  v_mov_b32 v84, v216
  v_max3_f32 v62, v62, abs(v84), abs(v85)
  ds_read_u16_d16_hi v232, v49 offset:32
  ds_read_u16_d16_hi v233, v49 offset:832
  ds_read_u16_d16_hi v234, v49 offset:632
  ds_read_u16_d16_hi v235, v49 offset:232
  s_waitcnt lgkmcnt(10)
  v_mov_b32 v87, v222
  v_mov_b32 v86, v220
  v_max3_f32 v62, v62, abs(v86), abs(v87)
  ds_read_u16_d16_hi v236, v49 offset:16
  ds_read_u16_d16_hi v237, v49 offset:416
  ds_read_u16_d16_hi v238, v49 offset:664
  ds_read_u16_d16_hi v239, v49 offset:1064
  s_waitcnt lgkmcnt(12)
  v_mov_b32 v89, v226
  v_mov_b32 v88, v224
  v_max3_f32 v62, v62, abs(v88), abs(v89)
  ds_read_u16_d16_hi v216, v49 offset:40
  ds_read_u16_d16_hi v217, v49 offset:1040
  ds_read_u16_d16_hi v218, v49 offset:640
  ds_read_u16_d16_hi v219, v49 offset:440
  s_waitcnt lgkmcnt(12)
  v_add_f32 v91, v230, v231
  v_add_f32 v90, v228, v229
  v_max3_f32 v62, v62, abs(v90), abs(v91)
  ds_read_u16_d16_hi v220, v49 offset:224
  ds_read_u16_d16_hi v221, v49 offset:424
  ds_read_u16_d16_hi v222, v49 offset:872
  ds_read_u16_d16_hi v223, v49 offset:1072
  s_waitcnt lgkmcnt(12)
  v_add_f32 v93, v234, v235
  v_add_f32 v92, v232, v233
  v_max3_f32 v62, v62, abs(v92), abs(v93)
  ds_read_u16_d16_hi v224, v49 offset:248
  ds_read_u16_d16_hi v225, v49 offset:1048
  ds_read_u16_d16_hi v226, v49 offset:848
  ds_read_u16_d16_hi v227, v49 offset:448
  s_waitcnt lgkmcnt(12)
  v_add_f32 v95, v238, v239
  v_add_f32 v94, v236, v237
  v_max3_f32 v62, v62, abs(v94), abs(v95)
  ds_read_u16_d16_hi v228, v50 offset:48
  ds_read_u16_d16_hi v229, v51 offset:1248
  ds_read_u16_d16_hi v230, v50 offset:672
  ds_read_u16_d16_hi v231, v51 offset:1272
  s_waitcnt lgkmcnt(12)
  v_add_f32 v97, v218, v219
  v_add_f32 v96, v216, v217
  v_max3_f32 v62, v62, abs(v96), abs(v97)
  ds_read_u16_d16_hi v232, v50 offset:256
  ds_read_u16_d16_hi v233, v51 offset:1256
  ds_read_u16_d16_hi v234, v50 offset:880
  ds_read_u16_d16_hi v235, v51 offset:1280
  s_waitcnt lgkmcnt(12)
  v_add_f32 v99, v222, v223
  v_add_f32 v98, v220, v221
  v_max3_f32 v62, v62, abs(v98), abs(v99)
  ds_read_u16_d16_hi v236, v50 offset:464
  ds_read_u16_d16_hi v237, v51 offset:1264
  ds_read_u16_d16_hi v238, v50 offset:1088
  ds_read_u16_d16_hi v239, v51 offset:1288
  s_waitcnt lgkmcnt(12)
  v_add_f32 v101, v226, v227
  v_add_f32 v100, v224, v225
  v_max3_f32 v62, v62, abs(v100), abs(v101)
  s_waitcnt lgkmcnt(8)
  v_add_f32 v103, v230, v231
  v_add_f32 v102, v228, v229
  v_max3_f32 v62, v62, abs(v102), abs(v103)
  s_waitcnt lgkmcnt(4)
  v_add_f32 v105, v234, v235
  v_add_f32 v104, v232, v233
  v_max3_f32 v62, v62, abs(v104), abs(v105)
  s_waitcnt lgkmcnt(0)
  v_add_f32 v107, v238, v239
  v_add_f32 v106, v236, v237
  v_max3_f32 v62, v62, abs(v106), abs(v107)
  s_cmp_lg_u32 s97, 0
  s_cbranch_scc1 L_uconv0
L_chunk1:
  ds_read_u16_d16_hi v216, v49 offset:24
  ds_read_u16_d16_hi v217, v49 offset:624
  ds_read_u16_d16_hi v218, v49 offset:240
  ds_read_u16_d16_hi v219, v49 offset:840
  ds_read_u16_d16_hi v220, v49 offset:456
  ds_read_u16_d16_hi v221, v49 offset:1056
  ds_read_u16_d16_hi v222, v60 offset:1296
  ds_read_u16_d16_hi v223, v61 offset:1296
  ds_read_u16_d16_hi v224, v52 offset:50
  ds_read_u16_d16_hi v225, v53 offset:1300
  ds_read_u16_d16_hi v226, v52 offset:674
  ds_read_u16_d16_hi v227, v53 offset:1324
  ds_read_u16_d16_hi v228, v52 offset:258
  ds_read_u16_d16_hi v229, v53 offset:1308
  ds_read_u16_d16_hi v230, v52 offset:882
  ds_read_u16_d16_hi v231, v53 offset:1332
  s_waitcnt lgkmcnt(12)
  v_add_f32 v109, v218, v219
  v_add_f32 v108, v216, v217
  v_max3_f32 v62, v62, abs(v108), abs(v109)
  ds_read_u16_d16_hi v232, v52 offset:466
  ds_read_u16_d16_hi v233, v53 offset:1316
  ds_read_u16_d16_hi v234, v52 offset:1090
  ds_read_u16_d16_hi v235, v53 offset:1340
  s_waitcnt lgkmcnt(12)
  v_add_f32 v111, v222, v223
  v_add_f32 v110, v220, v221
  v_max3_f32 v62, v62, abs(v110), abs(v111)
  ds_read_u16_d16_hi v236, v54 offset:2
  ds_read_u16_d16_hi v237, v55 offset:52
  ds_read_u16_d16_hi v238, v54 offset:650
  ds_read_u16_d16_hi v239, v55 offset:700
  s_waitcnt lgkmcnt(12)
  v_add_f32 v113, v226, v227
  v_add_f32 v112, v224, v225
  v_max3_f32 v62, v62, abs(v112), abs(v113)
  ds_read_u16_d16_hi v216, v54 offset:26
  ds_read_u16_d16_hi v217, v55 offset:676
  ds_read_u16_d16_hi v218, v54 offset:626
  ds_read_u16_d16_hi v219, v55 offset:76
  s_waitcnt lgkmcnt(12)
  v_add_f32 v115, v230, v231
  v_add_f32 v114, v228, v229
  v_max3_f32 v62, v62, abs(v114), abs(v115)
  ds_read_u16_d16_hi v220, v54 offset:10
  ds_read_u16_d16_hi v221, v55 offset:260
  ds_read_u16_d16_hi v222, v54 offset:658
  ds_read_u16_d16_hi v223, v55 offset:908
  s_waitcnt lgkmcnt(12)
  v_add_f32 v117, v234, v235
  v_add_f32 v116, v232, v233
  v_max3_f32 v62, v62, abs(v116), abs(v117)
  ds_read_u16_d16_hi v224, v54 offset:34
  ds_read_u16_d16_hi v225, v55 offset:884
  ds_read_u16_d16_hi v226, v54 offset:634
  ds_read_u16_d16_hi v227, v55 offset:284
  s_waitcnt lgkmcnt(12)
  v_add_f32 v119, v238, v239
  v_add_f32 v118, v236, v237
  v_max3_f32 v62, v62, abs(v118), abs(v119)
  ds_read_u16_d16_hi v228, v54 offset:18
  ds_read_u16_d16_hi v229, v55 offset:468
  ds_read_u16_d16_hi v230, v54 offset:666
  ds_read_u16_d16_hi v231, v55 offset:1116
  s_waitcnt lgkmcnt(12)
  v_add_f32 v121, v218, v219
  v_add_f32 v120, v216, v217
  v_max3_f32 v62, v62, abs(v120), abs(v121)
  ds_read_u16_d16_hi v232, v54 offset:42
  ds_read_u16_d16_hi v233, v55 offset:1092
  ds_read_u16_d16_hi v234, v54 offset:642
  ds_read_u16_d16_hi v235, v55 offset:492
  s_waitcnt lgkmcnt(12)
  v_add_f32 v123, v222, v223
  v_add_f32 v122, v220, v221
  v_max3_f32 v62, v62, abs(v122), abs(v123)
  ds_read_u16_d16_hi v236, v54 offset:210
  ds_read_u16_d16_hi v237, v55 offset:60
  ds_read_u16_d16_hi v238, v54 offset:858
  ds_read_u16_d16_hi v239, v55 offset:708
  s_waitcnt lgkmcnt(12)
  v_add_f32 v125, v226, v227
  v_add_f32 v124, v224, v225
  v_max3_f32 v62, v62, abs(v124), abs(v125)
  s_waitcnt lgkmcnt(8)
  v_add_f32 v127, v230, v231
  v_add_f32 v126, v228, v229
  v_max3_f32 v62, v62, abs(v126), abs(v127)
  s_waitcnt lgkmcnt(4)
  v_add_f32 v129, v234, v235
  v_add_f32 v128, v232, v233
  v_max3_f32 v62, v62, abs(v128), abs(v129)
  s_waitcnt lgkmcnt(0)
  v_add_f32 v131, v238, v239
  v_add_f32 v130, v236, v237
  v_max3_f32 v62, v62, abs(v130), abs(v131)
  s_cmp_lg_u32 s97, 0
  s_cbranch_scc1 L_uconv1
  s_branch L_w1conv
L_chunk2:
  ds_read_u16_d16_hi v216, v54 offset:234
  ds_read_u16_d16_hi v217, v55 offset:684
  ds_read_u16_d16_hi v218, v54 offset:834
  ds_read_u16_d16_hi v219, v55 offset:84
  ds_read_u16_d16_hi v220, v54 offset:218
  ds_read_u16_d16_hi v221, v55 offset:268
  ds_read_u16_d16_hi v222, v54 offset:866
  ds_read_u16_d16_hi v223, v55 offset:916
  ds_read_u16_d16_hi v224, v54 offset:242
  ds_read_u16_d16_hi v225, v55 offset:892
  ds_read_u16_d16_hi v226, v54 offset:842
  ds_read_u16_d16_hi v227, v55 offset:292
  ds_read_u16_d16_hi v228, v54 offset:226
  ds_read_u16_d16_hi v229, v55 offset:476
  ds_read_u16_d16_hi v230, v54 offset:874
  ds_read_u16_d16_hi v231, v55 offset:1124
  s_waitcnt lgkmcnt(12)
  v_add_f32 v85, v218, v219
  v_add_f32 v84, v216, v217
  v_max3_f32 v62, v62, abs(v84), abs(v85)
  ds_read_u16_d16_hi v232, v54 offset:250
  ds_read_u16_d16_hi v233, v55 offset:1100
  ds_read_u16_d16_hi v234, v54 offset:850
  ds_read_u16_d16_hi v235, v55 offset:500
  s_waitcnt lgkmcnt(12)
  v_add_f32 v87, v222, v223
  v_add_f32 v86, v220, v221
  v_max3_f32 v62, v62, abs(v86), abs(v87)
  ds_read_u16_d16_hi v236, v54 offset:418
  ds_read_u16_d16_hi v237, v55 offset:68
  ds_read_u16_d16_hi v238, v54 offset:1066
  ds_read_u16_d16_hi v239, v55 offset:716
  s_waitcnt lgkmcnt(12)
  v_add_f32 v89, v226, v227
  v_add_f32 v88, v224, v225
  v_max3_f32 v62, v62, abs(v88), abs(v89)
  ds_read_u16_d16_hi v216, v54 offset:442
  ds_read_u16_d16_hi v217, v55 offset:692
  ds_read_u16_d16_hi v218, v54 offset:1042
  ds_read_u16_d16_hi v219, v55 offset:92
  s_waitcnt lgkmcnt(12)
  v_add_f32 v91, v230, v231
  v_add_f32 v90, v228, v229
  v_max3_f32 v62, v62, abs(v90), abs(v91)
  ds_read_u16_d16_hi v220, v54 offset:426
  ds_read_u16_d16_hi v221, v55 offset:276
  ds_read_u16_d16_hi v222, v54 offset:1074
  ds_read_u16_d16_hi v223, v55 offset:924
  s_waitcnt lgkmcnt(12)
  v_add_f32 v93, v234, v235
  v_add_f32 v92, v232, v233
  v_max3_f32 v62, v62, abs(v92), abs(v93)
  ds_read_u16_d16_hi v224, v54 offset:450
  ds_read_u16_d16_hi v225, v55 offset:900
  ds_read_u16_d16_hi v226, v54 offset:1050
  ds_read_u16_d16_hi v227, v55 offset:300
  s_waitcnt lgkmcnt(12)
  v_add_f32 v95, v238, v239
  v_add_f32 v94, v236, v237
  v_max3_f32 v62, v62, abs(v94), abs(v95)
  ds_read_u16_d16_hi v228, v54 offset:434
  ds_read_u16_d16_hi v229, v55 offset:484
  ds_read_u16_d16_hi v230, v54 offset:1082
  ds_read_u16_d16_hi v231, v55 offset:1132
  s_waitcnt lgkmcnt(12)
  v_add_f32 v97, v218, v219
  v_add_f32 v96, v216, v217
  v_max3_f32 v62, v62, abs(v96), abs(v97)
  ds_read_u16_d16_hi v232, v54 offset:458
  ds_read_u16_d16_hi v233, v55 offset:1108
  ds_read_u16_d16_hi v234, v54 offset:1058
  ds_read_u16_d16_hi v235, v55 offset:508
  s_waitcnt lgkmcnt(12)
  v_add_f32 v99, v222, v223
  v_add_f32 v98, v220, v221
  v_max3_f32 v62, v62, abs(v98), abs(v99)
  ds_read_u16_d16_hi v236, v56 offset:4
  ds_read_u16_d16_hi v237, v57 offset:104
  ds_read_u16_d16_hi v238, v58 offset:652
  ds_read_u16_d16_hi v239, v59 offset:752
  s_waitcnt lgkmcnt(12)
  v_add_f32 v101, v226, v227
  v_add_f32 v100, v224, v225
  v_max3_f32 v62, v62, abs(v100), abs(v101)
  s_waitcnt lgkmcnt(8)
  v_add_f32 v103, v230, v231
  v_add_f32 v102, v228, v229
  v_max3_f32 v62, v62, abs(v102), abs(v103)
  s_waitcnt lgkmcnt(4)
  v_add_f32 v105, v234, v235
  v_add_f32 v104, v232, v233
  v_max3_f32 v62, v62, abs(v104), abs(v105)
  s_waitcnt lgkmcnt(0)
  v_add_f32 v107, v238, v239
  v_add_f32 v106, v236, v237
  v_max3_f32 v62, v62, abs(v106), abs(v107)
  s_cmp_lg_u32 s97, 0
  s_cbranch_scc1 L_uconv0
L_chunk3:
  ds_read_u16_d16_hi v216, v56 offset:220
  ds_read_u16_d16_hi v217, v57 offset:320
  ds_read_u16_d16_hi v218, v58 offset:868
  ds_read_u16_d16_hi v219, v59 offset:968
  ds_read_u16_d16_hi v220, v56 offset:436
  ds_read_u16_d16_hi v221, v57 offset:536
  ds_read_u16_d16_hi v222, v58 offset:1084
  ds_read_u16_d16_hi v223, v59 offset:1184
  ds_read_u16_d16_hi v224, v56 offset:12
  ds_read_u16_d16_hi v225, v57 offset:312
  ds_read_u16_d16_hi v226, v58 offset:660
  ds_read_u16_d16_hi v227, v59 offset:960
  ds_read_u16_d16_hi v228, v58 offset:36
  ds_read_u16_d16_hi v229, v59 offset:936
  ds_read_u16_d16_hi v230, v56 offset:636
  ds_read_u16_d16_hi v231, v57 offset:336
  s_waitcnt lgkmcnt(12)
  v_add_f32 v109, v218, v219
  v_add_f32 v108, v216, v217
  v_max3_f32 v62, v62, abs(v108), abs(v109)
  ds_read_u16_d16_hi v232, v56 offset:20
  ds_read_u16_d16_hi v233, v57 offset:520
  ds_read_u16_d16_hi v234, v58 offset:668
  ds_read_u16_d16_hi v235, v59 offset:1168
  s_waitcnt lgkmcnt(12)
  v_add_f32 v111, v222, v223
  v_add_f32 v110, v220, v221
  v_max3_f32 v62, v62, abs(v110), abs(v111)
  ds_read_u16_d16_hi v236, v58 offset:44
  ds_read_u16_d16_hi v237, v59 offset:1144
  ds_read_u16_d16_hi v238, v56 offset:644
  ds_read_u16_d16_hi v239, v57 offset:544
  s_waitcnt lgkmcnt(12)
  v_add_f32 v113, v226, v227
  v_add_f32 v112, v224, v225
  v_max3_f32 v62, v62, abs(v112), abs(v113)
  ds_read_u16_d16_hi v216, v56 offset:228
  ds_read_u16_d16_hi v217, v57 offset:528
  ds_read_u16_d16_hi v218, v58 offset:876
  ds_read_u16_d16_hi v219, v59 offset:1176
  s_waitcnt lgkmcnt(12)
  v_add_f32 v115, v230, v231
  v_add_f32 v114, v228, v229
  v_max3_f32 v62, v62, abs(v114), abs(v115)
  ds_read_u16_d16_hi v220, v58 offset:252
  ds_read_u16_d16_hi v221, v59 offset:1152
  ds_read_u16_d16_hi v222, v56 offset:852
  ds_read_u16_d16_hi v223, v57 offset:552
  s_waitcnt lgkmcnt(12)
  v_add_f32 v117, v234, v235
  v_add_f32 v116, v232, v233
  v_max3_f32 v62, v62, abs(v116), abs(v117)
  ds_read_u16_d16_hi v224, v65 offset:0
  ds_read_u16_d16_hi v225, v65 offset:8
  ds_read_u16_d16_hi v226, v65 offset:16
  ds_read_u16_d16_hi v227, v65 offset:24
  ds_read_u16_d16_hi v228, v65 offset:32
  ds_read_u16_d16_hi v229, v65 offset:40
  ds_read_u16_d16_hi v230, v64 offset:48
  ds_read_u16_d16_hi v231, v67
  s_waitcnt lgkmcnt(14)
  v_add_f32 v119, v238, v239
  v_add_f32 v118, v236, v237
  v_max3_f32 v62, v62, abs(v118), abs(v119)
  s_waitcnt lgkmcnt(12)
  v_add_f32 v121, v218, v219
  v_add_f32 v120, v216, v217
  v_max3_f32 v62, v62, abs(v120), abs(v121)
  s_waitcnt lgkmcnt(8)
  v_add_f32 v123, v222, v223
  v_add_f32 v122, v220, v221
  v_max3_f32 v62, v62, abs(v122), abs(v123)
  s_cmp_lg_u32 s97, 0
  s_cbranch_scc1 L_uconv1
L_w1conv:
  v_max_u32_dpp v62, v62, v62 row_shr:1 row_mask:0xf bank_mask:0xf
  s_nop 1
  v_max_u32_dpp v62, v62, v62 row_shr:2 row_mask:0xf bank_mask:0xf
  s_nop 1
  v_max_u32_dpp v62, v62, v62 row_shr:4 row_mask:0xf bank_mask:0xf
  s_nop 1
  v_max_u32_dpp v62, v62, v62 row_shr:8 row_mask:0xf bank_mask:0xf
  s_nop 1
  v_max_u32_dpp v62, v62, v62 row_bcast:15 row_mask:0xa bank_mask:0xf
  s_nop 1
  v_max_u32_dpp v62, v62, v62 row_bcast:31 row_mask:0xc bank_mask:0xf
  s_nop 0
  v_readlane_b32 s68, v62, 63
  s_nop 1
  v_mov_b32 v62, s68
  ds_max_u32 v1, v62 offset:20
  ds_add_u32 v1, v3 offset:16
  v_add_u32 v49, v49, v247
  v_add_u32 v50, v50, v247
  v_add_u32 v51, v51, v247
  v_add_u32 v52, v52, v247
  v_add_u32 v53, v53, v247
  v_add_u32 v54, v54, v247
  v_add_u32 v55, v55, v247
  v_add_u32 v56, v56, v247
  v_add_u32 v57, v57, v247
  v_add_u32 v58, v58, v247
  v_add_u32 v59, v59, v247
  v_add_u32 v60, v60, v247
  v_add_u32 v61, v61, v247
L_csync5:
  ds_read_b64 v[40:41], v2 offset:16
  s_waitcnt lgkmcnt(0)
  v_cmp_gt_u32 vcc, 4, v40
  s_cbranch_vccnz L_csync5
  v_readfirstlane_b32 s70, v41
  s_nop 0
  s_lshr_b32 s70, s70, 23
  s_sub_i32 s70, 141, s70
  s_min_i32 s70, s70, 40
  s_add_i32 s51, s70, 127
  s_lshl_b32 s51, s51, 23
  v_fma_mixlo_f16 v132, v84, s51, 0
  v_fma_mixlo_f16 v133, v86, s51, 0
  v_fma_mixlo_f16 v134, v88, s51, 0
  v_fma_mixlo_f16 v135, v90, s51, 0
  v_fma_mixhi_f16 v132, v85, s51, 0
  v_fma_mixhi_f16 v133, v87, s51, 0
  v_fma_mixhi_f16 v134, v89, s51, 0
  v_fma_mixhi_f16 v135, v91, s51, 0
  v_fma_mixlo_f16 v136, v92, s51, 0
  v_fma_mixlo_f16 v137, v94, s51, 0
  v_fma_mixlo_f16 v138, v96, s51, 0
  v_fma_mixlo_f16 v139, v98, s51, 0
  v_fma_mixhi_f16 v136, v93, s51, 0
  v_fma_mixhi_f16 v137, v95, s51, 0
  v_fma_mixhi_f16 v138, v97, s51, 0
  v_fma_mixhi_f16 v139, v99, s51, 0
  ds_write_b128 v63, v[132:135] offset:0
  v_fma_mixlo_f16 v140, v100, s51, 0
  v_fma_mixlo_f16 v141, v102, s51, 0
  v_fma_mixlo_f16 v142, v104, s51, 0
  v_fma_mixlo_f16 v143, v106, s51, 0
  v_fma_mixhi_f16 v140, v101, s51, 0
  v_fma_mixhi_f16 v141, v103, s51, 0
  v_fma_mixhi_f16 v142, v105, s51, 0
  v_fma_mixhi_f16 v143, v107, s51, 0
  ds_write_b128 v63, v[136:139] offset:1024
  v_fma_mixlo_f16 v144, v108, s51, 0
  v_fma_mixlo_f16 v145, v110, s51, 0
  v_fma_mixlo_f16 v146, v112, s51, 0
  v_fma_mixlo_f16 v147, v114, s51, 0
  v_fma_mixhi_f16 v144, v109, s51, 0
  v_fma_mixhi_f16 v145, v111, s51, 0
  v_fma_mixhi_f16 v146, v113, s51, 0
  v_fma_mixhi_f16 v147, v115, s51, 0
  ds_write_b128 v63, v[140:143] offset:2048
  v_fma_mixlo_f16 v148, v116, s51, 0
  v_fma_mixlo_f16 v149, v118, s51, 0
  v_fma_mixlo_f16 v150, v120, s51, 0
  v_fma_mixlo_f16 v151, v122, s51, 0
  v_fma_mixhi_f16 v148, v117, s51, 0
  v_fma_mixhi_f16 v149, v119, s51, 0
  v_fma_mixhi_f16 v150, v121, s51, 0
  v_fma_mixhi_f16 v151, v123, s51, 0
  ds_write_b128 v63, v[144:147] offset:3072
  ds_write_b128 v63, v[148:151] offset:4096
  s_cmp_ge_u32 s79, 2
  s_cbranch_scc1 L_w1x
  v_fma_mixlo_f16 v152, v124, s51, 0
  v_fma_mixlo_f16 v153, v126, s51, 0
  v_fma_mixlo_f16 v154, v128, s51, 0
  v_fma_mixlo_f16 v155, v130, s51, 0
  v_fma_mixhi_f16 v152, v125, s51, 0
  v_fma_mixhi_f16 v153, v127, s51, 0
  v_fma_mixhi_f16 v154, v129, s51, 0
  v_fma_mixhi_f16 v155, v131, s51, 0
  ds_write_b128 v63, v[152:155] offset:5120
L_w1x:
L_uph:
L_csync6:
  ds_read_b64 v[40:41], v2 offset:24
  s_waitcnt lgkmcnt(0)
  v_cmp_gt_u32 vcc, 4, v40
  s_cbranch_vccnz L_csync6
  v_readfirstlane_b32 s71, v41
  s_nop 0
  s_lshr_b32 s71, s71, 23
  s_sub_i32 s71, 140, s71
  s_min_i32 s71, s71, 40
  s_add_i32 s51, s71, 127
  s_lshl_b32 s51, s51, 23
  s_mov_b32 s97, 1
  s_lshr_b32 s69, s3, 1
  s_cmp_eq_u32 s69, 0
  s_cbranch_scc1 L_chunk0
  s_cmp_eq_u32 s69, 1
  s_cbranch_scc1 L_chunk1
  s_cmp_eq_u32 s69, 2
  s_cbranch_scc1 L_chunk2
  s_branch L_chunk3
L_uconv0:
  v_fma_mixlo_f16 v132, v84, s51, 0
  v_fma_mixlo_f16 v133, v86, s51, 0
  v_fma_mixlo_f16 v134, v88, s51, 0
  v_fma_mixlo_f16 v135, v90, s51, 0
  v_fma_mixhi_f16 v132, v85, s51, 0
  v_fma_mixhi_f16 v133, v87, s51, 0
  v_fma_mixhi_f16 v134, v89, s51, 0
  v_fma_mixhi_f16 v135, v91, s51, 0
L_csync7:
  ds_read_b64 v[40:41], v2 offset:16
  s_waitcnt lgkmcnt(0)
  v_cmp_gt_u32 vcc, 4, v40
  s_cbranch_vccnz L_csync7
  v_readfirstlane_b32 s70, v41
  s_nop 0
  s_lshr_b32 s70, s70, 23
  s_sub_i32 s70, 141, s70
  s_min_i32 s70, s70, 40
  ds_write_b128 v66, v[132:135] offset:0
  v_fma_mixlo_f16 v136, v92, s51, 0
  v_fma_mixlo_f16 v137, v94, s51, 0
  v_fma_mixlo_f16 v138, v96, s51, 0
  v_fma_mixlo_f16 v139, v98, s51, 0
  v_fma_mixhi_f16 v136, v93, s51, 0
  v_fma_mixhi_f16 v137, v95, s51, 0
  v_fma_mixhi_f16 v138, v97, s51, 0
  v_fma_mixhi_f16 v139, v99, s51, 0
  ds_write_b128 v66, v[136:139] offset:1024
  v_fma_mixlo_f16 v140, v100, s51, 0
  v_fma_mixlo_f16 v141, v102, s51, 0
  v_fma_mixlo_f16 v142, v104, s51, 0
  v_fma_mixlo_f16 v143, v106, s51, 0
  v_fma_mixhi_f16 v140, v101, s51, 0
  v_fma_mixhi_f16 v141, v103, s51, 0
  v_fma_mixhi_f16 v142, v105, s51, 0
  v_fma_mixhi_f16 v143, v107, s51, 0
  ds_write_b128 v66, v[140:143] offset:2048
  s_branch L_built
L_uconv1:
  v_fma_mixlo_f16 v144, v108, s51, 0
  v_fma_mixlo_f16 v145, v110, s51, 0
  v_fma_mixlo_f16 v146, v112, s51, 0
  v_fma_mixlo_f16 v147, v114, s51, 0
  v_fma_mixhi_f16 v144, v109, s51, 0
  v_fma_mixhi_f16 v145, v111, s51, 0
  v_fma_mixhi_f16 v146, v113, s51, 0
  v_fma_mixhi_f16 v147, v115, s51, 0
L_csync8:
  ds_read_b64 v[40:41], v2 offset:16
  s_waitcnt lgkmcnt(0)
  v_cmp_gt_u32 vcc, 4, v40
  s_cbranch_vccnz L_csync8
  v_readfirstlane_b32 s70, v41
  s_nop 0
  s_lshr_b32 s70, s70, 23
  s_sub_i32 s70, 141, s70
  s_min_i32 s70, s70, 40
  ds_write_b128 v66, v[144:147] offset:3072
  v_fma_mixlo_f16 v148, v116, s51, 0
  v_fma_mixlo_f16 v149, v118, s51, 0
  v_fma_mixlo_f16 v150, v120, s51, 0
  v_fma_mixlo_f16 v151, v122, s51, 0
  v_fma_mixhi_f16 v148, v117, s51, 0
  v_fma_mixhi_f16 v149, v119, s51, 0
  v_fma_mixhi_f16 v150, v121, s51, 0
  v_fma_mixhi_f16 v151, v123, s51, 0
  ds_write_b128 v66, v[148:151] offset:4096
  s_cmp_lg_u32 s84, 0
  s_cbranch_scc1 L_ulin
  v_fma_mixlo_f16 v152, v124, s51, 0
  v_fma_mixlo_f16 v153, v126, s51, 0
  v_fma_mixlo_f16 v154, v128, s51, 0
  v_fma_mixlo_f16 v155, v130, s51, 0
  v_fma_mixhi_f16 v152, v125, s51, 0
  v_fma_mixhi_f16 v153, v127, s51, 0
  v_fma_mixhi_f16 v154, v129, s51, 0
  v_fma_mixhi_f16 v155, v131, s51, 0
  ds_write_b128 v66, v[152:155] offset:5120
  s_branch L_built
L_ulin:
  v_mul_f32 v224, s51, v224
  v_mul_f32 v225, s51, v225
  v_mul_f32 v226, s51, v226
  v_mul_f32 v227, s51, v227
  v_mul_f32 v228, s51, v228
  v_mul_f32 v229, s51, v229
  v_mul_f32 v230, s51, v230
  v_mul_f32 v231, s51, v231
  v_cvt_pk_bf16_f32 v152, v224, v225
  v_cvt_pk_bf16_f32 v153, v226, v227
  v_cvt_pk_bf16_f32 v154, v228, v229
  v_cvt_pk_bf16_f32 v155, v230, v231
  ds_write_b128 v66, v[152:155] offset:5120
L_built:
  s_waitcnt vmcnt(1)
  v_mov_b32 v4, s84
  ds_add_u32 v1, v4 offset:36
  s_mov_b32 s60, s24
  s_and_b32 s61, s25, 0xffff
  s_mov_b32 s62, 268435456
  s_mov_b32 s63, 0x20000
  s_mov_b32 s64, s22
  s_and_b32 s65, s23, 0xffff
  s_mov_b32 s66, 256
  s_mov_b32 s67, 0x20000
  v_lshlrev_b32 v251, 2, v0
  s_mov_b64 exec, 0xff
  s_mov_b32 s81, 0x80000
  buffer_load_dword v255, v251, s[60:63], s81 offen
  buffer_load_dword v250, v251, s[64:67], 0 offen offset:128 sc1
  s_mov_b64 exec, -1
  v_mov_b32 v251, 0
  s_add_i32 s48, s70, s71
L_csync9:
  ds_read_b32 v4, v2 offset:36
  s_waitcnt lgkmcnt(0)
  v_cmp_gt_u32 vcc, 4, v4
  s_cbranch_vccnz L_csync9
  ds_read_u16_d16_hi v32, v7 offset:0
  ds_read_u16_d16_hi v33, v7 offset:128
  ds_read_u16_d16_hi v34, v7 offset:256
  ds_read_u16_d16_hi v35, v7 offset:384
  ds_read_u16_d16_hi v36, v7 offset:512
  ds_read_u16_d16_hi v37, v7 offset:640
  ds_read_u16_d16_hi v38, v7 offset:768
  ds_read_u16_d16_hi v39, v7 offset:896
  s_waitcnt lgkmcnt(0)
  v_cvt_pk_f16_f32 v43, v38, v39
  v_cvt_pk_f16_f32 v40, v32, v35
  v_cvt_pk_f16_f32 v41, v33, v36
  v_cvt_pk_f16_f32 v42, v34, v37
  ds_write_b128 v10, v[40:43]
  ds_read_b128 v[44:47], v11
  ds_read_b128 v[48:51], v12
  ds_read_b64_tr_b16 v[52:53], v8 offset:0
  ds_read_b64_tr_b16 v[54:55], v8 offset:512
  v_pk_mul_f16 v56, v40, v40 op_sel:[0,0] op_sel_hi:[1,1]
  v_pk_mul_f16 v57, v41, v41 op_sel:[0,0] op_sel_hi:[1,1]
  v_pk_mul_f16 v58, v42, v42 op_sel:[0,0] op_sel_hi:[1,1]
  v_pk_mul_f16 v59, v40, v41 op_sel:[0,0] op_sel_hi:[1,1]
  ds_read_u16_d16_hi v32, v7 offset:32
  ds_read_u16_d16_hi v33, v7 offset:160
  s_waitcnt vmcnt(3)
  v_lshlrev_b32 v21, 7, v21
  buffer_load_dword v255, v21, s[32:35], 0 offen
  s_mov_b64 exec, 131071
  buffer_load_dword v255, v19, s[44:47], s101 offen
  s_mov_b64 exec, -1
  s_add_u32 s101, s101, 1171456
  s_waitcnt lgkmcnt(0)
  s_barrier
  s_setprio 1
  ds_read_b128 v[240:243], v28 offset:46528
  ds_read_b128 v[128:131], v28 offset:35264
  ds_read_b128 v[84:87], v28 offset:0
  ds_read_b128 v[216:219], v22
  ds_read_b128 v[244:247], v30 offset:22528
  ds_read_b128 v[172:175], v31 offset:11264
  ds_read_b128 v[176:179], v31 offset:12288
  ds_read_b128 v[180:183], v31 offset:13312
  ds_read2_b32 v[220:221], v29 offset0:0 offset1:2
  ds_read2_b32 v[222:223], v29 offset0:64 offset1:66
  v_add_u32 v29, 2048, v29
  ds_read_b128 v[88:91], v28 offset:1024
  s_cmp_lg_u32 s84, 0
  s_cbranch_scc1 L_prf
  s_setprio 2
L_prf:
  s_waitcnt lgkmcnt(10)
  v_mfma_f32_16x16x32_bf16 v[72:75], v[240:243], v[52:55], 0
  ds_read_b128 v[92:95], v28 offset:2048
  s_waitcnt lgkmcnt(10)
  v_mfma_f32_16x16x32_f16 v[72:75], v[128:131], v[56:59], v[72:75]
  ds_read_b128 v[132:135], v28 offset:36288
  s_waitcnt lgkmcnt(10)
  v_mfma_f32_16x16x32_f16 v[68:71], v[84:87], v[56:59], 0
  ds_read_b128 v[136:139], v28 offset:37312
  v_pk_mul_f16 v60, v40, v41 op_sel:[0,1] op_sel_hi:[1,0]
  s_waitcnt lgkmcnt(10)
  v_mfma_f32_16x16x32_f16 v[80:83], v[216:219], v[56:59], 0
  ds_read_b128 v[140:143], v28 offset:38336
  v_pk_mul_f16 v61, v40, v42 op_sel:[0,0] op_sel_hi:[1,1]
  v_pk_mul_f16 v62, v40, v42 op_sel:[0,1] op_sel_hi:[1,0]
  s_waitcnt lgkmcnt(10)
  v_mfma_f32_16x16x32_bf16 v[76:79], v[244:247], v[52:55], 0
  ds_read_b128 v[144:147], v28 offset:39360
  v_pk_mul_f16 v63, v41, v42 op_sel:[0,0] op_sel_hi:[1,1]
  v_pk_mul_f16 v64, v41, v42 op_sel:[0,1] op_sel_hi:[1,0]
  s_waitcnt lgkmcnt(10)
  v_mfma_f32_16x16x32_f16 v[76:79], v[172:175], v[56:59], v[76:79]
  ds_read2_b32 v[224:225], v29 offset0:0 offset1:2
  ds_read2_b32 v[226:227], v29 offset0:64 offset1:66
  v_add_u32 v29, 2048, v29
  v_pk_mul_f16 v65, v40, v43 op_sel:[0,0] op_sel_hi:[1,0]
  v_pk_mul_f16 v66, v41, v43 op_sel:[0,0] op_sel_hi:[1,0]
  v_pk_mul_f16 v67, v42, v43 op_sel:[0,0] op_sel_hi:[1,0]
  s_waitcnt lgkmcnt(11)
  v_mfma_f32_16x16x32_f16 v[76:79], v[176:179], v[60:63], v[76:79]
  ds_read_b128 v[184:187], v31 offset:14336
  v_alignbit_b32 v48, v48, v48, v13
  s_waitcnt lgkmcnt(11)
  v_mfma_f32_16x16x32_f16 v[76:79], v[180:183], v[64:67], v[76:79]
  ds_read_b128 v[188:191], v31 offset:15360
  v_mul_f16_sdwa v52, v40, v40 dst_sel:WORD_0 dst_unused:UNUSED_PAD src0_sel:WORD_0 src1_sel:WORD_1
  v_mul_f16_sdwa v53, v42, v42 dst_sel:WORD_0 dst_unused:UNUSED_PAD src0_sel:WORD_0 src1_sel:WORD_1
  s_waitcnt lgkmcnt(10)
  v_smfmac_f32_16x16x64_f16 v[80:83], v[220:223], v[60:67], v16
  ds_read_b128 v[96:99], v28 offset:3072
  v_alignbit_b32 v49, v49, v49, v13
  s_waitcnt lgkmcnt(10)
  v_mfma_f32_16x16x32_f16 v[68:71], v[88:91], v[60:63], v[68:71]
  ds_read_b128 v[100:103], v28 offset:4096
  v_mul_f16_sdwa v52, v41, v41 dst_sel:WORD_1 dst_unused:UNUSED_PRESERVE src0_sel:WORD_0 src1_sel:WORD_1
  v_mul_f16_sdwa v53, v43, v43 dst_sel:WORD_1 dst_unused:UNUSED_PRESERVE src0_sel:WORD_0 src1_sel:WORD_1
  s_waitcnt lgkmcnt(10)
  v_mfma_f32_16x16x32_f16 v[68:71], v[92:95], v[64:67], v[68:71]
  ds_read_b128 v[104:107], v28 offset:5120
  v_pk_mul_f16 v54, v40, v47 op_sel:[0,0] op_sel_hi:[1,0]
  s_waitcnt lgkmcnt(10)
  v_mfma_f32_16x16x32_f16 v[72:75], v[132:135], v[60:63], v[72:75]
  ds_read_b128 v[108:111], v28 offset:6144
  v_pk_mul_f16 v55, v41, v47 op_sel:[0,0] op_sel_hi:[1,0]
  v_pk_mul_f16 v56, v42, v47 op_sel:[0,0] op_sel_hi:[1,0]
  s_waitcnt lgkmcnt(10)
  v_mfma_f32_16x16x32_f16 v[72:75], v[136:139], v[64:67], v[72:75]
  ds_read2_b32 v[228:229], v29 offset0:0 offset1:2
  ds_read2_b32 v[230:231], v29 offset0:64 offset1:66
  v_add_u32 v29, 2048, v29
  v_pk_mul_f16 v57, v40, v44 op_sel:[0,0] op_sel_hi:[1,1]
  v_pk_mul_f16 v58, v40, v44 op_sel:[0,1] op_sel_hi:[1,0]
  v_pk_mul_f16 v59, v40, v45 op_sel:[0,0] op_sel_hi:[1,1]
  s_waitcnt lgkmcnt(11)
  v_mfma_f32_16x16x32_f16 v[72:75], v[140:143], v[52:55], v[72:75]
  ds_read_b128 v[148:151], v28 offset:40384
  v_pk_mul_f16 v60, v40, v45 op_sel:[0,1] op_sel_hi:[1,0]
  s_waitcnt lgkmcnt(11)
  v_mfma_f32_16x16x32_f16 v[72:75], v[144:147], v[56:59], v[72:75]
  ds_read_b128 v[152:155], v28 offset:41408
  v_pk_mul_f16 v61, v40, v46 op_sel:[0,0] op_sel_hi:[1,1]
  v_pk_mul_f16 v62, v40, v46 op_sel:[0,1] op_sel_hi:[1,0]
  s_waitcnt lgkmcnt(10)
  v_smfmac_f32_16x16x64_f16 v[80:83], v[224:227], v[52:59], v16
  ds_read_b128 v[192:195], v31 offset:16384
  v_pk_mul_f16 v63, v41, v44 op_sel:[0,0] op_sel_hi:[1,1]
  s_waitcnt lgkmcnt(10)
  v_mfma_f32_16x16x32_f16 v[76:79], v[184:187], v[52:55], v[76:79]
  ds_read_b128 v[196:199], v31 offset:17408
  v_pk_mul_f16 v64, v41, v44 op_sel:[0,1] op_sel_hi:[1,0]
  v_pk_mul_f16 v65, v41, v45 op_sel:[0,0] op_sel_hi:[1,1]
  s_waitcnt lgkmcnt(10)
  v_mfma_f32_16x16x32_f16 v[76:79], v[188:191], v[56:59], v[76:79]
  ds_read_b128 v[200:203], v31 offset:18432
  v_pk_mul_f16 v66, v41, v45 op_sel:[0,1] op_sel_hi:[1,0]
  s_waitcnt lgkmcnt(10)
  v_mfma_f32_16x16x32_f16 v[68:71], v[96:99], v[52:55], v[68:71]
  ds_read_b128 v[204:207], v31 offset:19456
  v_pk_mul_f16 v67, v41, v46 op_sel:[0,0] op_sel_hi:[1,1]
  ds_write_b16 v15, v14 offset:4064
  s_waitcnt vmcnt(2)
  v_cmp_eq_u32 vcc, 0, v250
  s_nop 0
  s_and_b32 vcc_lo, vcc_lo, 0xff
  s_cbranch_scc0 L_cclr_ok
  s_mov_b32 s78, 0x40000
L_cclr:
  s_sub_u32 s78, s78, 1
  s_cbranch_scc1 L_cclr_ok
  v_lshlrev_b32 v250, 2, v0
  v_and_b32 v250, 31, v250
  buffer_load_dword v250, v250, s[64:67], 0 offen offset:128 sc1
  s_waitcnt vmcnt(0)
  v_cmp_eq_u32 vcc, 0, v250
  s_nop 0
  s_and_b32 vcc_lo, vcc_lo, 0xff
  s_cbranch_scc1 L_cclr
L_cclr_ok:
  v_lshl_add_u32 v24, v24, 7, v18
  v_lshl_add_u32 v25, v25, 7, v18
  s_mov_b32 exec_hi, 0x0000ffff
  v_lshl_add_u32 v26, v26, 7, v18
  v_lshl_add_u32 v27, v27, 7, v18
  s_mov_b32 exec_lo, 0
  s_mov_b32 exec_hi, 0xffff0000
  v_mov_b32 v27, v25
  v_mov_b32 v26, v25
  s_mov_b32 exec_hi, 0x00ff0000
  v_mov_b32 v26, v24
  s_mov_b64 exec, -1
  s_add_u32 m0, s74, -39488
  s_nop 0
  buffer_load_dwordx4 v24, s[32:35], 0 offen lds
  s_add_u32 m0, s74, -38432
  s_nop 0
  buffer_load_dwordx4 v25, s[32:35], 0 offen lds
  s_add_u32 m0, s74, -37376
  s_nop 0
  buffer_load_dwordx4 v26, s[32:35], 0 offen lds
  s_add_u32 m0, s74, -36320
  s_mov_b32 exec_hi, 0x00ffffff
  buffer_load_dwordx4 v27, s[32:35], 0 offen lds
  s_mov_b32 exec_hi, -1
  s_mov_b64 exec, 131071
  buffer_load_dword v255, v19, s[44:47], s101 offen
  s_mov_b64 exec, -1
  s_add_u32 s101, s101, 1171456
  s_sub_i32 s48, 0, s48
  s_mov_b32 s49, s48
  s_mov_b32 s97, 1
  s_mov_b32 s50, 1
  s_mov_b32 s96, 0
  s_cmp_lg_u32 s3, 7
  s_cbranch_scc1 L_nw0
  s_mov_b32 s52, s16
  s_and_b32 s53, s17, 0xffff
  s_mov_b32 s54, 3328
  s_mov_b32 s55, 0x20000
  v_lshlrev_b32 v22, 7, v0
  buffer_load_dword v255, v22, s[52:55], 0 offen
L_nw0:
  v_alignbit_b32 v50, v50, v50, v13
  s_waitcnt lgkmcnt(11)
  v_mfma_f32_16x16x32_f16 v[68:71], v[100:103], v[56:59], v[68:71]
  ds_read2_b32 v[232:233], v29 offset0:0 offset1:2
  ds_read2_b32 v[234:235], v29 offset0:64 offset1:66
  v_add_u32 v29, 2048, v29
  v_pk_mul_f16 v52, v41, v46 op_sel:[0,1] op_sel_hi:[1,0]
  v_pk_mul_f16 v53, v42, v44 op_sel:[0,0] op_sel_hi:[1,1]
  s_waitcnt lgkmcnt(12)
  v_mfma_f32_16x16x32_f16 v[68:71], v[104:107], v[60:63], v[68:71]
  ds_read_b128 v[156:159], v28 offset:42432
  v_pk_mul_f16 v54, v42, v44 op_sel:[0,1] op_sel_hi:[1,0]
  v_pk_mul_f16 v55, v42, v45 op_sel:[0,0] op_sel_hi:[1,1]
  s_waitcnt lgkmcnt(12)
  v_mfma_f32_16x16x32_f16 v[68:71], v[108:111], v[64:67], v[68:71]
  ds_read_b128 v[160:163], v28 offset:43456
  v_pk_mul_f16 v56, v42, v45 op_sel:[0,1] op_sel_hi:[1,0]
  v_pk_mul_f16 v57, v42, v46 op_sel:[0,0] op_sel_hi:[1,1]
  s_waitcnt lgkmcnt(11)
  v_smfmac_f32_16x16x64_f16 v[80:83], v[228:231], v[60:67], v16
  ds_read_b128 v[112:115], v28 offset:7168
  v_pk_mul_f16 v58, v42, v46 op_sel:[0,1] op_sel_hi:[1,0]
  v_pk_mul_f16 v59, v40, v48 op_sel:[0,0] op_sel_hi:[1,1]
  s_waitcnt lgkmcnt(11)
  v_mfma_f32_16x16x32_f16 v[72:75], v[148:151], v[60:63], v[72:75]
  ds_read_b128 v[116:119], v28 offset:8192
  ds_read_u16_d16_hi v34, v7 offset:288
  ds_read_u16_d16_hi v35, v7 offset:416
  s_waitcnt lgkmcnt(13)
  v_mfma_f32_16x16x32_f16 v[72:75], v[152:155], v[64:67], v[72:75]
  ds_read_b128 v[120:123], v28 offset:9216
  ds_read_u16_d16_hi v36, v7 offset:544
  ds_read_u16_d16_hi v37, v7 offset:672
  s_waitcnt lgkmcnt(14)
  v_mfma_f32_16x16x32_f16 v[76:79], v[192:195], v[60:63], v[76:79]
  ds_read_b128 v[124:127], v28 offset:10240
  ds_read_u16_d16_hi v38, v7 offset:800
  ds_read_u16_d16_hi v39, v7 offset:928
  v_mfma_f32_16x16x32_f16 v[76:79], v[196:199], v[64:67], v[76:79]
  ds_read_b128 v[164:167], v28 offset:44480
  v_pk_mul_f16 v60, v41, v49 op_sel:[0,0] op_sel_hi:[1,1]
  v_pk_mul_f16 v61, v42, v50 op_sel:[0,0] op_sel_hi:[1,1]
  s_waitcnt lgkmcnt(14)
  v_mfma_f32_16x16x32_f16 v[76:79], v[200:203], v[52:55], v[76:79]
  ds_read_b128 v[168:171], v28 offset:45504
  v_pk_mul_f16 v62, v40, v49 op_sel:[0,0] op_sel_hi:[1,1]
  v_pk_mul_f16 v63, v40, v49 op_sel:[0,1] op_sel_hi:[1,0]
  v_mfma_f32_16x16x32_f16 v[76:79], v[204:207], v[56:59], v[76:79]
  ds_read2_b32 v[236:237], v29 offset0:0 offset1:2
  ds_read2_b32 v[238:239], v29 offset0:64 offset1:66
  v_add_u32 v29, 2048, v29
  v_pk_mul_f16 v64, v40, v50 op_sel:[0,0] op_sel_hi:[1,1]
  v_pk_mul_f16 v65, v40, v50 op_sel:[0,1] op_sel_hi:[1,0]
  s_waitcnt lgkmcnt(14)
  v_smfmac_f32_16x16x64_f16 v[80:83], v[232:235], v[52:59], v16
  ds_read_b128 v[208:211], v31 offset:20480
  v_pk_mul_f16 v66, v41, v50 op_sel:[0,0] op_sel_hi:[1,1]
  v_pk_mul_f16 v67, v41, v50 op_sel:[0,1] op_sel_hi:[1,0]
  v_mfma_f32_16x16x32_f16 v[72:75], v[156:159], v[52:55], v[72:75]
  ds_read_b128 v[212:215], v31 offset:21504
  s_waitcnt lgkmcnt(6)
  v_cvt_pk_f16_f32 v43, v38, v39
  v_mfma_f32_16x16x32_f16 v[72:75], v[160:163], v[56:59], v[72:75]
  v_cvt_pk_f16_f32 v40, v32, v35
  v_cvt_pk_f16_f32 v41, v33, v36
  v_mfma_f32_16x16x32_f16 v[68:71], v[112:115], v[52:55], v[68:71]
  v_cvt_pk_f16_f32 v42, v34, v37
  v_mfma_f32_16x16x32_f16 v[68:71], v[116:119], v[56:59], v[68:71]
  ds_write_b128 v10, v[40:43]
  v_mfma_f32_16x16x32_f16 v[68:71], v[120:123], v[60:63], v[68:71]
  v_mfma_f32_16x16x32_f16 v[68:71], v[124:127], v[64:67], v[68:71]
  ds_read_b128 v[44:47], v11
  ds_read_b128 v[48:51], v12
  s_waitcnt lgkmcnt(8)
  v_mfma_f32_16x16x32_f16 v[72:75], v[164:167], v[60:63], v[72:75]
  ds_read_b64_tr_b16 v[52:53], v8 offset:32
  ds_read_b64_tr_b16 v[54:55], v8 offset:544
  s_waitcnt lgkmcnt(9)
  v_mfma_f32_16x16x32_f16 v[72:75], v[168:171], v[64:67], v[72:75]
  v_pk_mul_f16 v56, v40, v40 op_sel:[0,0] op_sel_hi:[1,1]
  v_pk_mul_f16 v57, v41, v41 op_sel:[0,0] op_sel_hi:[1,1]
  s_waitcnt lgkmcnt(7)
  v_smfmac_f32_16x16x64_f16 v[80:83], v[236:239], v[60:67], v16
  v_pk_mul_f16 v58, v42, v42 op_sel:[0,0] op_sel_hi:[1,1]
  v_pk_mul_f16 v59, v40, v41 op_sel:[0,0] op_sel_hi:[1,1]
  s_waitcnt lgkmcnt(6)
  v_mfma_f32_16x16x32_f16 v[76:79], v[208:211], v[60:63], v[76:79]
  v_mul_f32 v14, v68, v72
  v_fmac_f32 v14, v69, v73
  s_waitcnt lgkmcnt(5)
  v_mfma_f32_16x16x32_f16 v[76:79], v[212:215], v[64:67], v[76:79]
  v_fmac_f32 v14, v70, v74
  v_fmac_f32 v14, v71, v75
  ds_add_u32 v1, v3 offset:12
  s_branch L_grp1
L_prime:
  v_mov_b32 v68, 0
  v_mov_b32 v69, 0
  v_mov_b32 v70, 0
  v_mov_b32 v71, 0
  v_mov_b32 v72, 0
  v_mov_b32 v73, 0
  v_mov_b32 v74, 0
  v_mov_b32 v75, 0
  v_mov_b32 v76, 0
  v_mov_b32 v77, 0
  v_mov_b32 v78, 0
  v_mov_b32 v79, 0
  v_mov_b32 v80, 0
  v_mov_b32 v81, 0
  v_mov_b32 v82, 0
  v_mov_b32 v83, 0
  v_mov_b32 v22, 0
  v_mov_b32 v23, 0
  ds_read_u16_d16_hi v32, v7 offset:0
  ds_read_u16_d16_hi v33, v7 offset:128
  ds_read_u16_d16_hi v34, v7 offset:256
  ds_read_u16_d16_hi v35, v7 offset:384
  ds_read_u16_d16_hi v36, v7 offset:512
  ds_read_u16_d16_hi v37, v7 offset:640
  ds_read_u16_d16_hi v38, v7 offset:768
  ds_read_u16_d16_hi v39, v7 offset:896
  s_waitcnt lgkmcnt(0)
  v_cvt_pk_f16_f32 v43, v38, v39
  v_cvt_pk_f16_f32 v40, v32, v35
  v_cvt_pk_f16_f32 v41, v33, v36
  v_cvt_pk_f16_f32 v42, v34, v37
  ds_write_b128 v10, v[40:43]
  ds_read_b128 v[44:47], v11
  ds_read_b128 v[48:51], v12
  ds_read_b64_tr_b16 v[52:53], v8 offset:0
  ds_read_b64_tr_b16 v[54:55], v8 offset:512
  v_pk_mul_f16 v56, v40, v40 op_sel:[0,0] op_sel_hi:[1,1]
  v_pk_mul_f16 v57, v41, v41 op_sel:[0,0] op_sel_hi:[1,1]
  v_pk_mul_f16 v58, v42, v42 op_sel:[0,0] op_sel_hi:[1,1]
  v_pk_mul_f16 v59, v40, v41 op_sel:[0,0] op_sel_hi:[1,1]
  ds_read_u16_d16_hi v32, v7 offset:32
  ds_read_u16_d16_hi v33, v7 offset:160
L_cin_loop:
  s_cmp_lg_u32 s84, 0
  s_cbranch_scc1 L_pr0
  s_setprio 2
L_pr0:
  s_waitcnt lgkmcnt(2)
  v_mfma_f32_16x16x32_bf16 v[72:75], v[240:243], v[52:55], 0
  v_add_f32 v22, v80, v81
  v_add_f32 v23, v82, v83
  v_mfma_f32_16x16x32_f16 v[72:75], v[128:131], v[56:59], v[72:75]
  v_fmac_f32 v14, v76, v77
  v_fmac_f32 v14, v22, v78
  v_mfma_f32_16x16x32_f16 v[68:71], v[84:87], v[56:59], 0
  v_fmac_f32 v14, v23, v79
  v_pk_mul_f16 v60, v40, v41 op_sel:[0,1] op_sel_hi:[1,0]
  v_mfma_f32_16x16x32_f16 v[80:83], v[216:219], v[56:59], 0
  v_pk_mul_f16 v61, v40, v42 op_sel:[0,0] op_sel_hi:[1,1]
  v_pk_mul_f16 v62, v40, v42 op_sel:[0,1] op_sel_hi:[1,0]
  v_mfma_f32_16x16x32_bf16 v[76:79], v[244:247], v[52:55], 0
  v_pk_mul_f16 v63, v41, v42 op_sel:[0,0] op_sel_hi:[1,1]
  v_pk_mul_f16 v64, v41, v42 op_sel:[0,1] op_sel_hi:[1,0]
  v_mfma_f32_16x16x32_f16 v[76:79], v[172:175], v[56:59], v[76:79]
  v_pk_mul_f16 v65, v40, v43 op_sel:[0,0] op_sel_hi:[1,0]
  v_pk_mul_f16 v66, v41, v43 op_sel:[0,0] op_sel_hi:[1,0]
  v_pk_mul_f16 v67, v42, v43 op_sel:[0,0] op_sel_hi:[1,0]
  v_mfma_f32_16x16x32_f16 v[76:79], v[176:179], v[60:63], v[76:79]
  v_add_f32_dpp v14, v14, v14 row_shr:1 row_mask:0xf bank_mask:0xf
  v_alignbit_b32 v48, v48, v48, v13
  v_mfma_f32_16x16x32_f16 v[76:79], v[180:183], v[64:67], v[76:79]
  v_mul_f16_sdwa v52, v40, v40 dst_sel:WORD_0 dst_unused:UNUSED_PAD src0_sel:WORD_0 src1_sel:WORD_1
  v_mul_f16_sdwa v53, v42, v42 dst_sel:WORD_0 dst_unused:UNUSED_PAD src0_sel:WORD_0 src1_sel:WORD_1
  v_smfmac_f32_16x16x64_f16 v[80:83], v[220:223], v[60:67], v16
  v_add_f32_dpp v14, v14, v14 row_shr:2 row_mask:0xf bank_mask:0xf
  v_alignbit_b32 v49, v49, v49, v13
  v_mfma_f32_16x16x32_f16 v[68:71], v[88:91], v[60:63], v[68:71]
  v_mul_f16_sdwa v52, v41, v41 dst_sel:WORD_1 dst_unused:UNUSED_PRESERVE src0_sel:WORD_0 src1_sel:WORD_1
  v_mul_f16_sdwa v53, v43, v43 dst_sel:WORD_1 dst_unused:UNUSED_PRESERVE src0_sel:WORD_0 src1_sel:WORD_1
  v_mfma_f32_16x16x32_f16 v[68:71], v[92:95], v[64:67], v[68:71]
  v_add_f32_dpp v14, v14, v14 row_shr:4 row_mask:0xf bank_mask:0xf
  v_pk_mul_f16 v54, v40, v47 op_sel:[0,0] op_sel_hi:[1,0]
  v_mfma_f32_16x16x32_f16 v[72:75], v[132:135], v[60:63], v[72:75]
  v_pk_mul_f16 v55, v41, v47 op_sel:[0,0] op_sel_hi:[1,0]
  v_pk_mul_f16 v56, v42, v47 op_sel:[0,0] op_sel_hi:[1,0]
  v_mfma_f32_16x16x32_f16 v[72:75], v[136:139], v[64:67], v[72:75]
  v_pk_mul_f16 v57, v40, v44 op_sel:[0,0] op_sel_hi:[1,1]
  v_pk_mul_f16 v58, v40, v44 op_sel:[0,1] op_sel_hi:[1,0]
  v_pk_mul_f16 v59, v40, v45 op_sel:[0,0] op_sel_hi:[1,1]
  v_mfma_f32_16x16x32_f16 v[72:75], v[140:143], v[52:55], v[72:75]
  v_add_f32_dpp v14, v14, v14 row_shr:8 row_mask:0xf bank_mask:0xf
  v_pk_mul_f16 v60, v40, v45 op_sel:[0,1] op_sel_hi:[1,0]
  v_mfma_f32_16x16x32_f16 v[72:75], v[144:147], v[56:59], v[72:75]
  v_pk_mul_f16 v61, v40, v46 op_sel:[0,0] op_sel_hi:[1,1]
  v_pk_mul_f16 v62, v40, v46 op_sel:[0,1] op_sel_hi:[1,0]
  v_smfmac_f32_16x16x64_f16 v[80:83], v[224:227], v[52:59], v16
  v_add_f32_dpp v14, v14, v14 row_bcast:15 row_mask:0xa bank_mask:0xf
  v_pk_mul_f16 v63, v41, v44 op_sel:[0,0] op_sel_hi:[1,1]
  v_mfma_f32_16x16x32_f16 v[76:79], v[184:187], v[52:55], v[76:79]
  v_pk_mul_f16 v64, v41, v44 op_sel:[0,1] op_sel_hi:[1,0]
  v_pk_mul_f16 v65, v41, v45 op_sel:[0,0] op_sel_hi:[1,1]
  v_mfma_f32_16x16x32_f16 v[76:79], v[188:191], v[56:59], v[76:79]
  v_add_f32_dpp v14, v14, v14 row_bcast:31 row_mask:0xc bank_mask:0xf
  v_pk_mul_f16 v66, v41, v45 op_sel:[0,1] op_sel_hi:[1,0]
  v_mfma_f32_16x16x32_f16 v[68:71], v[96:99], v[52:55], v[68:71]
  v_pk_mul_f16 v67, v41, v46 op_sel:[0,0] op_sel_hi:[1,1]
  s_waitcnt vmcnt(0)
  s_cmp_le_u32 s72, 3
  s_cbranch_scc1 L_blk
  s_mov_b64 exec, 131071
  buffer_load_dword v255, v19, s[44:47], s101 offen
  s_mov_b64 exec, -1
  s_add_u32 s101, s101, 1171456
L_blk:
  s_cmp_eq_u32 s50, 0
  s_cbranch_scc1 L_blkend
  v_readlane_b32 s81, v14, 63
  v_ldexp_f32 v14, v14, s49
  v_and_b32 v14, -2, v14
  s_cmp_ge_u32 s50, 2
  s_cbranch_scc1 L_good
  s_cmp_eq_u64 s[90:91], 0
  s_cbranch_scc1 L_slow
  s_bfe_u32 s81, s81, 0x80017
  s_cmp_eq_u32 s81, 255
  s_cbranch_scc1 L_slow
L_good:
  s_mov_b32 exec_lo, 0
  s_mov_b32 exec_hi, 0x80000000
  buffer_store_dword v14, v251, s[60:63], s85 offen sc1
  s_mov_b64 exec, -1
  s_add_u32 s85, s85, 32
  s_sub_u32 s72, s72, 1
  s_cmp_eq_u32 s72, 0
  s_cbranch_scc1 L_cin_done
  s_cmp_eq_u32 s72, 1
  s_cbranch_scc1 L_lastnext
  v_lshl_add_u32 v24, v24, 7, v18
  v_lshl_add_u32 v25, v25, 7, v18
  s_mov_b32 exec_hi, 0x0000ffff
  v_lshl_add_u32 v26, v26, 7, v18
  v_lshl_add_u32 v27, v27, 7, v18
  s_mov_b32 exec_lo, 0
  s_mov_b32 exec_hi, 0xffff0000
  v_mov_b32 v27, v25
  v_mov_b32 v26, v25
  s_mov_b32 exec_hi, 0x00ff0000
  v_mov_b32 v26, v24
  s_mov_b64 exec, -1
  s_add_u32 m0, s74, 0
  s_nop 0
  buffer_load_dwordx4 v24, s[32:35], 0 offen lds
  s_add_u32 m0, s74, 1056
  s_nop 0
  buffer_load_dwordx4 v25, s[32:35], 0 offen lds
  s_add_u32 m0, s74, 2112
  s_nop 0
  buffer_load_dwordx4 v26, s[32:35], 0 offen lds
  s_add_u32 m0, s74, 3168
  s_mov_b32 exec_hi, 0x00ffffff
  buffer_load_dwordx4 v27, s[32:35], 0 offen lds
  s_mov_b32 exec_hi, -1
  s_add_u32 s94, s94, 832
  s_cmp_lg_u32 s72, s99
  s_cbranch_scc1 L_nodma
  v_mov_b32 v250, 1
  s_mov_b64 exec, 1
  buffer_atomic_add v250, v251, s[60:63], s98 offen sc0
  s_mov_b64 exec, -1
  s_mov_b32 s99, 8
  s_branch L_nodma
L_lastnext:
  s_cmp_lt_i32 s26, 0
  s_cselect_b32 s85, s85, s26
L_nodma:
  s_add_u32 s74, s74, s75
  s_sub_u32 s75, 0, s75
  s_mov_b32 s49, s48
  s_mov_b32 s97, 1
  s_cmp_eq_u32 s50, 3
  s_cbranch_scc1 L_slow2
L_blkend:
  s_mov_b32 s50, s97
  v_alignbit_b32 v50, v50, v50, v13
  v_mfma_f32_16x16x32_f16 v[68:71], v[100:103], v[56:59], v[68:71]
  v_pk_mul_f16 v52, v41, v46 op_sel:[0,1] op_sel_hi:[1,0]
  v_pk_mul_f16 v53, v42, v44 op_sel:[0,0] op_sel_hi:[1,1]
  v_mfma_f32_16x16x32_f16 v[68:71], v[104:107], v[60:63], v[68:71]
  v_pk_mul_f16 v54, v42, v44 op_sel:[0,1] op_sel_hi:[1,0]
  v_pk_mul_f16 v55, v42, v45 op_sel:[0,0] op_sel_hi:[1,1]
  v_mfma_f32_16x16x32_f16 v[68:71], v[108:111], v[64:67], v[68:71]
  v_pk_mul_f16 v56, v42, v45 op_sel:[0,1] op_sel_hi:[1,0]
  v_pk_mul_f16 v57, v42, v46 op_sel:[0,0] op_sel_hi:[1,1]
  v_smfmac_f32_16x16x64_f16 v[80:83], v[228:231], v[60:67], v16
  v_pk_mul_f16 v58, v42, v46 op_sel:[0,1] op_sel_hi:[1,0]
  v_pk_mul_f16 v59, v40, v48 op_sel:[0,0] op_sel_hi:[1,1]
  v_mfma_f32_16x16x32_f16 v[72:75], v[148:151], v[60:63], v[72:75]
  ds_read_u16_d16_hi v34, v7 offset:288
  ds_read_u16_d16_hi v35, v7 offset:416
  v_mfma_f32_16x16x32_f16 v[72:75], v[152:155], v[64:67], v[72:75]
  ds_read_u16_d16_hi v36, v7 offset:544
  ds_read_u16_d16_hi v37, v7 offset:672
  v_mfma_f32_16x16x32_f16 v[76:79], v[192:195], v[60:63], v[76:79]
  ds_read_u16_d16_hi v38, v7 offset:800
  ds_read_u16_d16_hi v39, v7 offset:928
  v_mfma_f32_16x16x32_f16 v[76:79], v[196:199], v[64:67], v[76:79]
  v_pk_mul_f16 v60, v41, v49 op_sel:[0,0] op_sel_hi:[1,1]
  v_pk_mul_f16 v61, v42, v50 op_sel:[0,0] op_sel_hi:[1,1]
  v_mfma_f32_16x16x32_f16 v[76:79], v[200:203], v[52:55], v[76:79]
  v_pk_mul_f16 v62, v40, v49 op_sel:[0,0] op_sel_hi:[1,1]
  v_pk_mul_f16 v63, v40, v49 op_sel:[0,1] op_sel_hi:[1,0]
  v_mfma_f32_16x16x32_f16 v[76:79], v[204:207], v[56:59], v[76:79]
  v_pk_mul_f16 v64, v40, v50 op_sel:[0,0] op_sel_hi:[1,1]
  v_pk_mul_f16 v65, v40, v50 op_sel:[0,1] op_sel_hi:[1,0]
  v_smfmac_f32_16x16x64_f16 v[80:83], v[232:235], v[52:59], v16
  v_pk_mul_f16 v66, v41, v50 op_sel:[0,0] op_sel_hi:[1,1]
  v_pk_mul_f16 v67, v41, v50 op_sel:[0,1] op_sel_hi:[1,0]
  v_mfma_f32_16x16x32_f16 v[72:75], v[156:159], v[52:55], v[72:75]
  s_waitcnt lgkmcnt(0)
  v_cvt_pk_f16_f32 v43, v38, v39
  v_mfma_f32_16x16x32_f16 v[72:75], v[160:163], v[56:59], v[72:75]
  v_cvt_pk_f16_f32 v40, v32, v35
  v_cvt_pk_f16_f32 v41, v33, v36
  v_mfma_f32_16x16x32_f16 v[68:71], v[112:115], v[52:55], v[68:71]
  v_cvt_pk_f16_f32 v42, v34, v37
  v_mfma_f32_16x16x32_f16 v[68:71], v[116:119], v[56:59], v[68:71]
  ds_write_b128 v10, v[40:43]
  v_mfma_f32_16x16x32_f16 v[68:71], v[120:123], v[60:63], v[68:71]
  v_mfma_f32_16x16x32_f16 v[68:71], v[124:127], v[64:67], v[68:71]
  ds_read_b128 v[44:47], v11
  ds_read_b128 v[48:51], v12
  v_mfma_f32_16x16x32_f16 v[72:75], v[164:167], v[60:63], v[72:75]
  ds_read_b64_tr_b16 v[52:53], v8 offset:32
  ds_read_b64_tr_b16 v[54:55], v8 offset:544
  v_mfma_f32_16x16x32_f16 v[72:75], v[168:171], v[64:67], v[72:75]
  v_pk_mul_f16 v56, v40, v40 op_sel:[0,0] op_sel_hi:[1,1]
  v_pk_mul_f16 v57, v41, v41 op_sel:[0,0] op_sel_hi:[1,1]
  v_smfmac_f32_16x16x64_f16 v[80:83], v[236:239], v[60:67], v16
  v_pk_mul_f16 v58, v42, v42 op_sel:[0,0] op_sel_hi:[1,1]
  v_pk_mul_f16 v59, v40, v41 op_sel:[0,0] op_sel_hi:[1,1]
  v_mfma_f32_16x16x32_f16 v[76:79], v[208:211], v[60:63], v[76:79]
  s_nop 1
  v_mul_f32 v14, v68, v72
  v_fmac_f32 v14, v69, v73
  v_mfma_f32_16x16x32_f16 v[76:79], v[212:215], v[64:67], v[76:79]
  v_fmac_f32 v14, v70, v74
  v_fmac_f32 v14, v71, v75
L_grp1:
  s_waitcnt lgkmcnt(0)
  v_mfma_f32_16x16x32_bf16 v[72:75], v[240:243], v[52:55], 0
  v_add_f32 v22, v80, v81
  v_add_f32 v23, v82, v83
  v_mfma_f32_16x16x32_f16 v[72:75], v[128:131], v[56:59], v[72:75]
  s_nop 0
  v_fmac_f32 v14, v76, v77
  v_fmac_f32 v14, v22, v78
  v_mfma_f32_16x16x32_f16 v[68:71], v[84:87], v[56:59], 0
  v_fmac_f32 v14, v23, v79
  v_pk_mul_f16 v60, v40, v41 op_sel:[0,1] op_sel_hi:[1,0]
  v_mfma_f32_16x16x32_f16 v[80:83], v[216:219], v[56:59], 0
  v_pk_mul_f16 v61, v40, v42 op_sel:[0,0] op_sel_hi:[1,1]
  v_pk_mul_f16 v62, v40, v42 op_sel:[0,1] op_sel_hi:[1,0]
  v_mfma_f32_16x16x32_bf16 v[76:79], v[244:247], v[52:55], 0
  v_pk_mul_f16 v63, v41, v42 op_sel:[0,0] op_sel_hi:[1,1]
  v_pk_mul_f16 v64, v41, v42 op_sel:[0,1] op_sel_hi:[1,0]
  v_mfma_f32_16x16x32_f16 v[76:79], v[172:175], v[56:59], v[76:79]
  v_pk_mul_f16 v65, v40, v43 op_sel:[0,0] op_sel_hi:[1,0]
  v_pk_mul_f16 v66, v41, v43 op_sel:[0,0] op_sel_hi:[1,0]
  v_pk_mul_f16 v67, v42, v43 op_sel:[0,0] op_sel_hi:[1,0]
  v_mfma_f32_16x16x32_f16 v[76:79], v[176:179], v[60:63], v[76:79]
  v_or3_b32 v15, v56, v57, v58
  v_alignbit_b32 v48, v48, v48, v13
  v_mfma_f32_16x16x32_f16 v[76:79], v[180:183], v[64:67], v[76:79]
  v_mul_f16_sdwa v52, v40, v40 dst_sel:WORD_0 dst_unused:UNUSED_PAD src0_sel:WORD_0 src1_sel:WORD_1
  v_mul_f16_sdwa v53, v42, v42 dst_sel:WORD_0 dst_unused:UNUSED_PAD src0_sel:WORD_0 src1_sel:WORD_1
  v_smfmac_f32_16x16x64_f16 v[80:83], v[220:223], v[60:67], v16
  v_mul_f16_sdwa v52, v41, v41 dst_sel:WORD_1 dst_unused:UNUSED_PRESERVE src0_sel:WORD_0 src1_sel:WORD_1
  v_mul_f16_sdwa v53, v43, v43 dst_sel:WORD_1 dst_unused:UNUSED_PRESERVE src0_sel:WORD_0 src1_sel:WORD_1
  v_mfma_f32_16x16x32_f16 v[68:71], v[88:91], v[60:63], v[68:71]
  v_pk_mul_f16 v54, v40, v47 op_sel:[0,0] op_sel_hi:[1,0]
  v_pk_mul_f16 v55, v41, v47 op_sel:[0,0] op_sel_hi:[1,0]
  v_mfma_f32_16x16x32_f16 v[68:71], v[92:95], v[64:67], v[68:71]
  v_pk_mul_f16 v56, v42, v47 op_sel:[0,0] op_sel_hi:[1,0]
  v_pk_mul_f16 v57, v40, v44 op_sel:[0,0] op_sel_hi:[1,1]
  v_mfma_f32_16x16x32_f16 v[72:75], v[132:135], v[60:63], v[72:75]
  v_pk_mul_f16 v58, v40, v44 op_sel:[0,1] op_sel_hi:[1,0]
  v_pk_mul_f16 v59, v40, v45 op_sel:[0,0] op_sel_hi:[1,1]
  v_mfma_f32_16x16x32_f16 v[72:75], v[136:139], v[64:67], v[72:75]
  v_pk_mul_f16 v60, v40, v45 op_sel:[0,1] op_sel_hi:[1,0]
  v_pk_mul_f16 v61, v40, v46 op_sel:[0,0] op_sel_hi:[1,1]
  v_mfma_f32_16x16x32_f16 v[72:75], v[140:143], v[52:55], v[72:75]
  v_pk_mul_f16 v62, v40, v46 op_sel:[0,1] op_sel_hi:[1,0]
  v_pk_mul_f16 v63, v41, v44 op_sel:[0,0] op_sel_hi:[1,1]
  v_mfma_f32_16x16x32_f16 v[72:75], v[144:147], v[56:59], v[72:75]
  v_pk_mul_f16 v64, v41, v44 op_sel:[0,1] op_sel_hi:[1,0]
  v_pk_mul_f16 v65, v41, v45 op_sel:[0,0] op_sel_hi:[1,1]
  v_smfmac_f32_16x16x64_f16 v[80:83], v[224:227], v[52:59], v16
  v_pk_mul_f16 v66, v41, v45 op_sel:[0,1] op_sel_hi:[1,0]
  v_pk_mul_f16 v67, v41, v46 op_sel:[0,0] op_sel_hi:[1,1]
  v_mfma_f32_16x16x32_f16 v[76:79], v[184:187], v[52:55], v[76:79]
  v_alignbit_b32 v49, v49, v49, v13
  v_alignbit_b32 v50, v50, v50, v13
  v_mfma_f32_16x16x32_f16 v[76:79], v[188:191], v[56:59], v[76:79]
  ds_read_u16_d16_hi v32, v7 offset:64
  ds_read_u16_d16_hi v33, v7 offset:192
  v_mfma_f32_16x16x32_f16 v[68:71], v[96:99], v[52:55], v[68:71]
  v_pk_mul_f16 v52, v41, v46 op_sel:[0,1] op_sel_hi:[1,0]
  v_pk_mul_f16 v53, v42, v44 op_sel:[0,0] op_sel_hi:[1,1]
  v_mfma_f32_16x16x32_f16 v[68:71], v[100:103], v[56:59], v[68:71]
  v_pk_mul_f16 v54, v42, v44 op_sel:[0,1] op_sel_hi:[1,0]
  v_pk_mul_f16 v55, v42, v45 op_sel:[0,0] op_sel_hi:[1,1]
  v_mfma_f32_16x16x32_f16 v[68:71], v[104:107], v[60:63], v[68:71]
  v_pk_mul_f16 v56, v42, v45 op_sel:[0,1] op_sel_hi:[1,0]
  v_pk_mul_f16 v57, v42, v46 op_sel:[0,0] op_sel_hi:[1,1]
  v_mfma_f32_16x16x32_f16 v[68:71], v[108:111], v[64:67], v[68:71]
  v_pk_mul_f16 v58, v42, v46 op_sel:[0,1] op_sel_hi:[1,0]
  v_pk_mul_f16 v59, v40, v48 op_sel:[0,0] op_sel_hi:[1,1]
  v_smfmac_f32_16x16x64_f16 v[80:83], v[228:231], v[60:67], v16
  ds_read_u16_d16_hi v34, v7 offset:320
  ds_read_u16_d16_hi v35, v7 offset:448
  v_mfma_f32_16x16x32_f16 v[72:75], v[148:151], v[60:63], v[72:75]
  ds_read_u16_d16_hi v36, v7 offset:576
  ds_read_u16_d16_hi v37, v7 offset:704
  v_mfma_f32_16x16x32_f16 v[72:75], v[152:155], v[64:67], v[72:75]
  ds_read_u16_d16_hi v38, v7 offset:832
  ds_read_u16_d16_hi v39, v7 offset:960
  v_mfma_f32_16x16x32_f16 v[76:79], v[192:195], v[60:63], v[76:79]
  v_and_b32 v15, 0x60006000, v15
  v_cmp_ne_u32 s[90:91], 0, v15
  v_mfma_f32_16x16x32_f16 v[76:79], v[196:199], v[64:67], v[76:79]
  v_pk_mul_f16 v60, v41, v49 op_sel:[0,0] op_sel_hi:[1,1]
  v_pk_mul_f16 v61, v42, v50 op_sel:[0,0] op_sel_hi:[1,1]
  v_mfma_f32_16x16x32_f16 v[76:79], v[200:203], v[52:55], v[76:79]
  v_pk_mul_f16 v62, v40, v49 op_sel:[0,0] op_sel_hi:[1,1]
  v_pk_mul_f16 v63, v40, v49 op_sel:[0,1] op_sel_hi:[1,0]
  v_mfma_f32_16x16x32_f16 v[76:79], v[204:207], v[56:59], v[76:79]
  v_pk_mul_f16 v64, v40, v50 op_sel:[0,0] op_sel_hi:[1,1]
  v_pk_mul_f16 v65, v40, v50 op_sel:[0,1] op_sel_hi:[1,0]
  v_smfmac_f32_16x16x64_f16 v[80:83], v[232:235], v[52:59], v16
  v_pk_mul_f16 v66, v41, v50 op_sel:[0,0] op_sel_hi:[1,1]
  v_pk_mul_f16 v67, v41, v50 op_sel:[0,1] op_sel_hi:[1,0]
  v_mfma_f32_16x16x32_f16 v[72:75], v[156:159], v[52:55], v[72:75]
  s_waitcnt lgkmcnt(0)
  v_cvt_pk_f16_f32 v43, v38, v39
  v_mfma_f32_16x16x32_f16 v[72:75], v[160:163], v[56:59], v[72:75]
  v_cvt_pk_f16_f32 v40, v32, v35
  v_cvt_pk_f16_f32 v41, v33, v36
  v_mfma_f32_16x16x32_f16 v[68:71], v[112:115], v[52:55], v[68:71]
  v_cvt_pk_f16_f32 v42, v34, v37
  v_mfma_f32_16x16x32_f16 v[68:71], v[116:119], v[56:59], v[68:71]
  ds_write_b128 v10, v[40:43]
  v_mfma_f32_16x16x32_f16 v[68:71], v[120:123], v[60:63], v[68:71]
  v_mfma_f32_16x16x32_f16 v[68:71], v[124:127], v[64:67], v[68:71]
  ds_read_b128 v[44:47], v11
  ds_read_b128 v[48:51], v12
  v_mfma_f32_16x16x32_f16 v[72:75], v[164:167], v[60:63], v[72:75]
  ds_read_b64_tr_b16 v[52:53], v8 offset:64
  ds_read_b64_tr_b16 v[54:55], v8 offset:576
  v_mfma_f32_16x16x32_f16 v[72:75], v[168:171], v[64:67], v[72:75]
  v_pk_mul_f16 v56, v40, v40 op_sel:[0,0] op_sel_hi:[1,1]
  v_pk_mul_f16 v57, v41, v41 op_sel:[0,0] op_sel_hi:[1,1]
  v_smfmac_f32_16x16x64_f16 v[80:83], v[236:239], v[60:67], v16
  v_pk_mul_f16 v58, v42, v42 op_sel:[0,0] op_sel_hi:[1,1]
  v_pk_mul_f16 v59, v40, v41 op_sel:[0,0] op_sel_hi:[1,1]
  v_mfma_f32_16x16x32_f16 v[76:79], v[208:211], v[60:63], v[76:79]
  s_nop 1
  v_fmac_f32 v14, v68, v72
  v_fmac_f32 v14, v69, v73
  v_mfma_f32_16x16x32_f16 v[76:79], v[212:215], v[64:67], v[76:79]
  v_fmac_f32 v14, v70, v74
  v_fmac_f32 v14, v71, v75
  s_cmp_eq_u32 s72, s96
  s_cbranch_scc1 L_htail
  s_waitcnt lgkmcnt(0)
  v_mfma_f32_16x16x32_bf16 v[72:75], v[240:243], v[52:55], 0
  v_add_f32 v22, v80, v81
  v_add_f32 v23, v82, v83
  v_mfma_f32_16x16x32_f16 v[72:75], v[128:131], v[56:59], v[72:75]
  v_fmac_f32 v14, v76, v77
  v_fmac_f32 v14, v22, v78
  v_mfma_f32_16x16x32_f16 v[68:71], v[84:87], v[56:59], 0
  v_fmac_f32 v14, v23, v79
  v_pk_mul_f16 v60, v40, v41 op_sel:[0,1] op_sel_hi:[1,0]
  v_mfma_f32_16x16x32_f16 v[80:83], v[216:219], v[56:59], 0
  v_pk_mul_f16 v61, v40, v42 op_sel:[0,0] op_sel_hi:[1,1]
  v_pk_mul_f16 v62, v40, v42 op_sel:[0,1] op_sel_hi:[1,0]
  v_mfma_f32_16x16x32_bf16 v[76:79], v[244:247], v[52:55], 0
  v_pk_mul_f16 v63, v41, v42 op_sel:[0,0] op_sel_hi:[1,1]
  v_pk_mul_f16 v64, v41, v42 op_sel:[0,1] op_sel_hi:[1,0]
  v_mfma_f32_16x16x32_f16 v[76:79], v[172:175], v[56:59], v[76:79]
  v_pk_mul_f16 v65, v40, v43 op_sel:[0,0] op_sel_hi:[1,0]
  v_pk_mul_f16 v66, v41, v43 op_sel:[0,0] op_sel_hi:[1,0]
  v_pk_mul_f16 v67, v42, v43 op_sel:[0,0] op_sel_hi:[1,0]
  v_mfma_f32_16x16x32_f16 v[76:79], v[176:179], v[60:63], v[76:79]
  v_mul_f16_sdwa v52, v40, v40 dst_sel:WORD_0 dst_unused:UNUSED_PAD src0_sel:WORD_0 src1_sel:WORD_1
  v_mul_f16_sdwa v53, v42, v42 dst_sel:WORD_0 dst_unused:UNUSED_PAD src0_sel:WORD_0 src1_sel:WORD_1
  v_mfma_f32_16x16x32_f16 v[76:79], v[180:183], v[64:67], v[76:79]
  v_mul_f16_sdwa v52, v41, v41 dst_sel:WORD_1 dst_unused:UNUSED_PRESERVE src0_sel:WORD_0 src1_sel:WORD_1
  v_mul_f16_sdwa v53, v43, v43 dst_sel:WORD_1 dst_unused:UNUSED_PRESERVE src0_sel:WORD_0 src1_sel:WORD_1
  v_smfmac_f32_16x16x64_f16 v[80:83], v[220:223], v[60:67], v16
  v_pk_mul_f16 v54, v40, v47 op_sel:[0,0] op_sel_hi:[1,0]
  v_pk_mul_f16 v55, v41, v47 op_sel:[0,0] op_sel_hi:[1,0]
  v_mfma_f32_16x16x32_f16 v[68:71], v[88:91], v[60:63], v[68:71]
  v_pk_mul_f16 v56, v42, v47 op_sel:[0,0] op_sel_hi:[1,0]
  v_pk_mul_f16 v57, v40, v44 op_sel:[0,0] op_sel_hi:[1,1]
  v_mfma_f32_16x16x32_f16 v[68:71], v[92:95], v[64:67], v[68:71]
  v_pk_mul_f16 v58, v40, v44 op_sel:[0,1] op_sel_hi:[1,0]
  v_pk_mul_f16 v59, v40, v45 op_sel:[0,0] op_sel_hi:[1,1]
  v_mfma_f32_16x16x32_f16 v[72:75], v[132:135], v[60:63], v[72:75]
  v_pk_mul_f16 v60, v40, v45 op_sel:[0,1] op_sel_hi:[1,0]
  v_pk_mul_f16 v61, v40, v46 op_sel:[0,0] op_sel_hi:[1,1]
  v_mfma_f32_16x16x32_f16 v[72:75], v[136:139], v[64:67], v[72:75]
  v_pk_mul_f16 v62, v40, v46 op_sel:[0,1] op_sel_hi:[1,0]
  v_pk_mul_f16 v63, v41, v44 op_sel:[0,0] op_sel_hi:[1,1]
  v_mfma_f32_16x16x32_f16 v[72:75], v[140:143], v[52:55], v[72:75]
  v_pk_mul_f16 v64, v41, v44 op_sel:[0,1] op_sel_hi:[1,0]
  v_pk_mul_f16 v65, v41, v45 op_sel:[0,0] op_sel_hi:[1,1]
  v_mfma_f32_16x16x32_f16 v[72:75], v[144:147], v[56:59], v[72:75]
  v_pk_mul_f16 v66, v41, v45 op_sel:[0,1] op_sel_hi:[1,0]
  v_pk_mul_f16 v67, v41, v46 op_sel:[0,0] op_sel_hi:[1,1]
  v_smfmac_f32_16x16x64_f16 v[80:83], v[224:227], v[52:59], v16
  v_alignbit_b32 v48, v48, v48, v13
  v_alignbit_b32 v49, v49, v49, v13
  v_mfma_f32_16x16x32_f16 v[76:79], v[184:187], v[52:55], v[76:79]
  v_alignbit_b32 v50, v50, v50, v13
  ds_read_u16_d16_hi v32, v7 offset:96
  v_mfma_f32_16x16x32_f16 v[76:79], v[188:191], v[56:59], v[76:79]
  ds_read_u16_d16_hi v33, v7 offset:224
  ds_read_u16_d16_hi v34, v7 offset:352
  s_cmp_lg_u32 s99, 8
  s_cbranch_scc1 L_hk
  s_waitcnt vmcnt(0)
  v_readfirstlane_b32 s81, v250
  s_mov_b32 s99, 0
  s_add_u32 s81, s81, 1
  s_cmp_ge_u32 s81, 36
  s_cbranch_scc1 L_hk
  s_add_u32 s72, s72, 1
  s_mov_b32 s26, 10240
  s_cmp_lt_u32 s81, 20
  s_cbranch_scc1 L_hkf
  s_add_u32 s81, s81, 20
  s_and_b32 s94, s81, 1
  s_lshr_b32 s81, s81, 1
  s_mov_b32 s96, 1
  s_lshl_b32 s94, s94, 6
  v_xor_b32 v18, s94, v18
  s_lshl_b32 s94, s94, 5
  s_add_u32 s26, s26, s94
L_hkf:
  s_add_u32 s81, s81, 484
  s_lshl_b32 s94, s81, 2
  s_add_u32 s26, s26, s94
  s_andn2_b32 s94, s98, 0x3fff
  s_add_u32 s26, s26, s94
  s_lshr_b32 s94, s94, 5
  s_add_u32 s94, s94, s81
  s_mul_i32 s94, s94, 104
L_hk:
  buffer_load_dwordx4 v[24:27], v17, s[28:31], s94 offen offset:0
  v_mfma_f32_16x16x32_f16 v[68:71], v[96:99], v[52:55], v[68:71]
  v_pk_mul_f16 v52, v41, v46 op_sel:[0,1] op_sel_hi:[1,0]
  v_pk_mul_f16 v53, v42, v44 op_sel:[0,0] op_sel_hi:[1,1]
  v_mfma_f32_16x16x32_f16 v[68:71], v[100:103], v[56:59], v[68:71]
  v_pk_mul_f16 v54, v42, v44 op_sel:[0,1] op_sel_hi:[1,0]
  v_pk_mul_f16 v55, v42, v45 op_sel:[0,0] op_sel_hi:[1,1]
  v_mfma_f32_16x16x32_f16 v[68:71], v[104:107], v[60:63], v[68:71]
  v_pk_mul_f16 v56, v42, v45 op_sel:[0,1] op_sel_hi:[1,0]
  v_pk_mul_f16 v57, v42, v46 op_sel:[0,0] op_sel_hi:[1,1]
  v_mfma_f32_16x16x32_f16 v[68:71], v[108:111], v[64:67], v[68:71]
  v_pk_mul_f16 v58, v42, v46 op_sel:[0,1] op_sel_hi:[1,0]
  v_pk_mul_f16 v59, v40, v48 op_sel:[0,0] op_sel_hi:[1,1]
  v_smfmac_f32_16x16x64_f16 v[80:83], v[228:231], v[60:67], v16
  ds_read_u16_d16_hi v35, v7 offset:480
  ds_read_u16_d16_hi v36, v7 offset:608
  v_mfma_f32_16x16x32_f16 v[72:75], v[148:151], v[60:63], v[72:75]
  ds_read_u16_d16_hi v37, v7 offset:736
  ds_read_u16_d16_hi v38, v7 offset:864
  v_mfma_f32_16x16x32_f16 v[72:75], v[152:155], v[64:67], v[72:75]
  ds_read_u16_d16_hi v39, v7 offset:992
  v_mfma_f32_16x16x32_f16 v[76:79], v[192:195], v[60:63], v[76:79]
  v_pk_mul_f16 v60, v41, v49 op_sel:[0,0] op_sel_hi:[1,1]
  v_pk_mul_f16 v61, v42, v50 op_sel:[0,0] op_sel_hi:[1,1]
  v_mfma_f32_16x16x32_f16 v[76:79], v[196:199], v[64:67], v[76:79]
  v_pk_mul_f16 v62, v40, v49 op_sel:[0,0] op_sel_hi:[1,1]
  v_pk_mul_f16 v63, v40, v49 op_sel:[0,1] op_sel_hi:[1,0]
  v_mfma_f32_16x16x32_f16 v[76:79], v[200:203], v[52:55], v[76:79]
  v_pk_mul_f16 v64, v40, v50 op_sel:[0,0] op_sel_hi:[1,1]
  v_pk_mul_f16 v65, v40, v50 op_sel:[0,1] op_sel_hi:[1,0]
  s_cmp_lg_u32 s84, 0
  s_cbranch_scc1 L_pr110
  s_setprio 0
L_pr110:
  v_mfma_f32_16x16x32_f16 v[76:79], v[204:207], v[56:59], v[76:79]
  v_pk_mul_f16 v66, v41, v50 op_sel:[0,0] op_sel_hi:[1,1]
  v_pk_mul_f16 v67, v41, v50 op_sel:[0,1] op_sel_hi:[1,0]
  v_smfmac_f32_16x16x64_f16 v[80:83], v[232:235], v[52:59], v16
  s_waitcnt lgkmcnt(0)
  v_cvt_pk_f16_f32 v43, v38, v39
  v_mfma_f32_16x16x32_f16 v[72:75], v[156:159], v[52:55], v[72:75]
  v_cvt_pk_f16_f32 v40, v32, v35
  v_cvt_pk_f16_f32 v41, v33, v36
  v_mfma_f32_16x16x32_f16 v[72:75], v[160:163], v[56:59], v[72:75]
  v_cvt_pk_f16_f32 v42, v34, v37
  v_mfma_f32_16x16x32_f16 v[68:71], v[112:115], v[52:55], v[68:71]
  ds_write_b128 v10, v[40:43]
  v_mfma_f32_16x16x32_f16 v[68:71], v[116:119], v[56:59], v[68:71]
  v_add_u32 v7, s75, v7
  s_waitcnt vmcnt(1)
  v_mfma_f32_16x16x32_f16 v[68:71], v[120:123], v[60:63], v[68:71]
  ds_read_b128 v[44:47], v11
  ds_read_b128 v[48:51], v12
  v_mfma_f32_16x16x32_f16 v[68:71], v[124:127], v[64:67], v[68:71]
  ds_read_b64_tr_b16 v[52:53], v8 offset:96
  ds_read_b64_tr_b16 v[54:55], v8 offset:608
  v_mfma_f32_16x16x32_f16 v[72:75], v[164:167], v[60:63], v[72:75]
  v_pk_mul_f16 v56, v40, v40 op_sel:[0,0] op_sel_hi:[1,1]
  v_pk_mul_f16 v57, v41, v41 op_sel:[0,0] op_sel_hi:[1,1]
  v_mfma_f32_16x16x32_f16 v[72:75], v[168:171], v[64:67], v[72:75]
  v_pk_mul_f16 v58, v42, v42 op_sel:[0,0] op_sel_hi:[1,1]
  v_pk_mul_f16 v59, v40, v41 op_sel:[0,0] op_sel_hi:[1,1]
  v_smfmac_f32_16x16x64_f16 v[80:83], v[236:239], v[60:67], v16
  ds_read_u16_d16_hi v32, v7 offset:0
  ds_read_u16_d16_hi v33, v7 offset:128
  v_mfma_f32_16x16x32_f16 v[76:79], v[208:211], v[60:63], v[76:79]
  s_nop 1
  v_fmac_f32 v14, v68, v72
  v_fmac_f32 v14, v69, v73
  v_mfma_f32_16x16x32_f16 v[76:79], v[212:215], v[64:67], v[76:79]
  v_fmac_f32 v14, v70, v74
  v_fmac_f32 v14, v71, v75
  s_waitcnt lgkmcnt(2)
  v_mfma_f32_16x16x32_bf16 v[72:75], v[240:243], v[52:55], 0
  v_add_f32 v22, v80, v81
  v_add_f32 v23, v82, v83
  v_mfma_f32_16x16x32_f16 v[72:75], v[128:131], v[56:59], v[72:75]
  s_nop 0
  v_fmac_f32 v14, v76, v77
  v_fmac_f32 v14, v22, v78
  v_mfma_f32_16x16x32_f16 v[68:71], v[84:87], v[56:59], 0
  v_fmac_f32 v14, v23, v79
  v_pk_mul_f16 v60, v40, v41 op_sel:[0,1] op_sel_hi:[1,0]
  v_mfma_f32_16x16x32_f16 v[80:83], v[216:219], v[56:59], 0
  v_pk_mul_f16 v61, v40, v42 op_sel:[0,0] op_sel_hi:[1,1]
  v_pk_mul_f16 v62, v40, v42 op_sel:[0,1] op_sel_hi:[1,0]
  v_mfma_f32_16x16x32_bf16 v[76:79], v[244:247], v[52:55], 0
  v_pk_mul_f16 v63, v41, v42 op_sel:[0,0] op_sel_hi:[1,1]
  v_pk_mul_f16 v64, v41, v42 op_sel:[0,1] op_sel_hi:[1,0]
  v_mfma_f32_16x16x32_f16 v[76:79], v[172:175], v[56:59], v[76:79]
  v_pk_mul_f16 v65, v40, v43 op_sel:[0,0] op_sel_hi:[1,0]
  v_pk_mul_f16 v66, v41, v43 op_sel:[0,0] op_sel_hi:[1,0]
  v_pk_mul_f16 v67, v42, v43 op_sel:[0,0] op_sel_hi:[1,0]
  v_mfma_f32_16x16x32_f16 v[76:79], v[176:179], v[60:63], v[76:79]
  v_mul_f16_sdwa v52, v40, v40 dst_sel:WORD_0 dst_unused:UNUSED_PAD src0_sel:WORD_0 src1_sel:WORD_1
  v_mul_f16_sdwa v53, v42, v42 dst_sel:WORD_0 dst_unused:UNUSED_PAD src0_sel:WORD_0 src1_sel:WORD_1
  v_mfma_f32_16x16x32_f16 v[76:79], v[180:183], v[64:67], v[76:79]
  v_mul_f16_sdwa v52, v41, v41 dst_sel:WORD_1 dst_unused:UNUSED_PRESERVE src0_sel:WORD_0 src1_sel:WORD_1
  v_mul_f16_sdwa v53, v43, v43 dst_sel:WORD_1 dst_unused:UNUSED_PRESERVE src0_sel:WORD_0 src1_sel:WORD_1
  v_smfmac_f32_16x16x64_f16 v[80:83], v[220:223], v[60:67], v16
  v_pk_mul_f16 v54, v40, v47 op_sel:[0,0] op_sel_hi:[1,0]
  v_pk_mul_f16 v55, v41, v47 op_sel:[0,0] op_sel_hi:[1,0]
  v_mfma_f32_16x16x32_f16 v[68:71], v[88:91], v[60:63], v[68:71]
  v_pk_mul_f16 v56, v42, v47 op_sel:[0,0] op_sel_hi:[1,0]
  v_pk_mul_f16 v57, v40, v44 op_sel:[0,0] op_sel_hi:[1,1]
  v_mfma_f32_16x16x32_f16 v[68:71], v[92:95], v[64:67], v[68:71]
  v_pk_mul_f16 v58, v40, v44 op_sel:[0,1] op_sel_hi:[1,0]
  v_pk_mul_f16 v59, v40, v45 op_sel:[0,0] op_sel_hi:[1,1]
  v_mfma_f32_16x16x32_f16 v[72:75], v[132:135], v[60:63], v[72:75]
  v_pk_mul_f16 v60, v40, v45 op_sel:[0,1] op_sel_hi:[1,0]
  v_pk_mul_f16 v61, v40, v46 op_sel:[0,0] op_sel_hi:[1,1]
  v_mfma_f32_16x16x32_f16 v[72:75], v[136:139], v[64:67], v[72:75]
  v_pk_mul_f16 v62, v40, v46 op_sel:[0,1] op_sel_hi:[1,0]
  v_pk_mul_f16 v63, v41, v44 op_sel:[0,0] op_sel_hi:[1,1]
  v_mfma_f32_16x16x32_f16 v[72:75], v[140:143], v[52:55], v[72:75]
  v_pk_mul_f16 v64, v41, v44 op_sel:[0,1] op_sel_hi:[1,0]
  v_pk_mul_f16 v65, v41, v45 op_sel:[0,0] op_sel_hi:[1,1]
  v_mfma_f32_16x16x32_f16 v[72:75], v[144:147], v[56:59], v[72:75]
  v_pk_mul_f16 v66, v41, v45 op_sel:[0,1] op_sel_hi:[1,0]
  v_pk_mul_f16 v67, v41, v46 op_sel:[0,0] op_sel_hi:[1,1]
  v_smfmac_f32_16x16x64_f16 v[80:83], v[224:227], v[52:59], v16
  v_alignbit_b32 v48, v48, v48, v13
  v_alignbit_b32 v49, v49, v49, v13
  v_mfma_f32_16x16x32_f16 v[76:79], v[184:187], v[52:55], v[76:79]
  v_alignbit_b32 v50, v50, v50, v13
  ds_read_u16_d16_hi v34, v7 offset:256
  v_mfma_f32_16x16x32_f16 v[76:79], v[188:191], v[56:59], v[76:79]
  ds_read_u16_d16_hi v35, v7 offset:384
  ds_read_u16_d16_hi v36, v7 offset:512
  v_mfma_f32_16x16x32_f16 v[68:71], v[96:99], v[52:55], v[68:71]
  v_pk_mul_f16 v52, v41, v46 op_sel:[0,1] op_sel_hi:[1,0]
  v_pk_mul_f16 v53, v42, v44 op_sel:[0,0] op_sel_hi:[1,1]
  v_mfma_f32_16x16x32_f16 v[68:71], v[100:103], v[56:59], v[68:71]
  v_pk_mul_f16 v54, v42, v44 op_sel:[0,1] op_sel_hi:[1,0]
  v_pk_mul_f16 v55, v42, v45 op_sel:[0,0] op_sel_hi:[1,1]
  v_mfma_f32_16x16x32_f16 v[68:71], v[104:107], v[60:63], v[68:71]
  v_pk_mul_f16 v56, v42, v45 op_sel:[0,1] op_sel_hi:[1,0]
  v_pk_mul_f16 v57, v42, v46 op_sel:[0,0] op_sel_hi:[1,1]
  v_mfma_f32_16x16x32_f16 v[68:71], v[108:111], v[64:67], v[68:71]
  v_pk_mul_f16 v58, v42, v46 op_sel:[0,1] op_sel_hi:[1,0]
  v_pk_mul_f16 v59, v40, v48 op_sel:[0,0] op_sel_hi:[1,1]
  v_smfmac_f32_16x16x64_f16 v[80:83], v[228:231], v[60:67], v16
  ds_read_u16_d16_hi v37, v7 offset:640
  ds_read_u16_d16_hi v38, v7 offset:768
  v_mfma_f32_16x16x32_f16 v[72:75], v[148:151], v[60:63], v[72:75]
  ds_read_u16_d16_hi v39, v7 offset:896
  s_add_u32 s81, s74, s75
  v_add_u32 v8, s81, v9
  v_mfma_f32_16x16x32_f16 v[72:75], v[152:155], v[64:67], v[72:75]
  v_mfma_f32_16x16x32_f16 v[76:79], v[192:195], v[60:63], v[76:79]
  v_pk_mul_f16 v60, v41, v49 op_sel:[0,0] op_sel_hi:[1,1]
  v_pk_mul_f16 v61, v42, v50 op_sel:[0,0] op_sel_hi:[1,1]
  v_mfma_f32_16x16x32_f16 v[76:79], v[196:199], v[64:67], v[76:79]
  v_pk_mul_f16 v62, v40, v49 op_sel:[0,0] op_sel_hi:[1,1]
  v_pk_mul_f16 v63, v40, v49 op_sel:[0,1] op_sel_hi:[1,0]
  v_mfma_f32_16x16x32_f16 v[76:79], v[200:203], v[52:55], v[76:79]
  v_pk_mul_f16 v64, v40, v50 op_sel:[0,0] op_sel_hi:[1,1]
  v_pk_mul_f16 v65, v40, v50 op_sel:[0,1] op_sel_hi:[1,0]
  v_mfma_f32_16x16x32_f16 v[76:79], v[204:207], v[56:59], v[76:79]
  v_pk_mul_f16 v66, v41, v50 op_sel:[0,0] op_sel_hi:[1,1]
  v_pk_mul_f16 v67, v41, v50 op_sel:[0,1] op_sel_hi:[1,0]
  v_smfmac_f32_16x16x64_f16 v[80:83], v[232:235], v[52:59], v16
  s_waitcnt lgkmcnt(0)
  v_cvt_pk_f16_f32 v43, v38, v39
  v_mfma_f32_16x16x32_f16 v[72:75], v[156:159], v[52:55], v[72:75]
  v_cvt_pk_f16_f32 v40, v32, v35
  v_cvt_pk_f16_f32 v41, v33, v36
  v_mfma_f32_16x16x32_f16 v[72:75], v[160:163], v[56:59], v[72:75]
  v_cvt_pk_f16_f32 v42, v34, v37
  v_mfma_f32_16x16x32_f16 v[68:71], v[112:115], v[52:55], v[68:71]
  ds_write_b128 v10, v[40:43]
  v_mfma_f32_16x16x32_f16 v[68:71], v[116:119], v[56:59], v[68:71]
  v_mfma_f32_16x16x32_f16 v[68:71], v[120:123], v[60:63], v[68:71]
  ds_read_b128 v[44:47], v11
  ds_read_b128 v[48:51], v12
  v_mfma_f32_16x16x32_f16 v[68:71], v[124:127], v[64:67], v[68:71]
  ds_read_b64_tr_b16 v[52:53], v8 offset:0
  ds_read_b64_tr_b16 v[54:55], v8 offset:512
  v_mfma_f32_16x16x32_f16 v[72:75], v[164:167], v[60:63], v[72:75]
  v_pk_mul_f16 v56, v40, v40 op_sel:[0,0] op_sel_hi:[1,1]
  v_pk_mul_f16 v57, v41, v41 op_sel:[0,0] op_sel_hi:[1,1]
  v_mfma_f32_16x16x32_f16 v[72:75], v[168:171], v[64:67], v[72:75]
  v_pk_mul_f16 v58, v42, v42 op_sel:[0,0] op_sel_hi:[1,1]
  v_pk_mul_f16 v59, v40, v41 op_sel:[0,0] op_sel_hi:[1,1]
  v_smfmac_f32_16x16x64_f16 v[80:83], v[236:239], v[60:67], v16
  ds_read_u16_d16_hi v32, v7 offset:32
  ds_read_u16_d16_hi v33, v7 offset:160
  v_mfma_f32_16x16x32_f16 v[76:79], v[208:211], v[60:63], v[76:79]
  s_nop 1
  v_fmac_f32 v14, v68, v72
  v_fmac_f32 v14, v69, v73
  v_mfma_f32_16x16x32_f16 v[76:79], v[212:215], v[64:67], v[76:79]
  v_fmac_f32 v14, v70, v74
  v_fmac_f32 v14, v71, v75
  s_cmp_lg_u32 s72, 1
  s_cbranch_scc1 L_cin_loop
  v_add_f32 v22, v80, v81
  v_add_f32 v23, v82, v83
  s_nop 1
  v_fmac_f32 v14, v76, v77
  v_fmac_f32 v14, v22, v78
  v_fmac_f32 v14, v23, v79
  s_nop 1
  v_add_f32_dpp v14, v14, v14 row_shr:1 row_mask:0xf bank_mask:0xf
  s_nop 1
  v_add_f32_dpp v14, v14, v14 row_shr:2 row_mask:0xf bank_mask:0xf
  s_nop 1
  v_add_f32_dpp v14, v14, v14 row_shr:4 row_mask:0xf bank_mask:0xf
  s_nop 1
  v_add_f32_dpp v14, v14, v14 row_shr:8 row_mask:0xf bank_mask:0xf
  s_nop 1
  v_add_f32_dpp v14, v14, v14 row_bcast:15 row_mask:0xa bank_mask:0xf
  s_nop 1
  v_add_f32_dpp v14, v14, v14 row_bcast:31 row_mask:0xc bank_mask:0xf
  s_branch L_blk
L_htail:
  v_add_f32 v22, v80, v81
  v_add_f32 v23, v82, v83
  s_nop 1
  v_fmac_f32 v14, v76, v77
  v_fmac_f32 v14, v22, v78
  v_fmac_f32 v14, v23, v79
  s_nop 1
  v_add_f32_dpp v14, v14, v14 row_shr:1 row_mask:0xf bank_mask:0xf
  s_nop 1
  v_add_f32_dpp v14, v14, v14 row_shr:2 row_mask:0xf bank_mask:0xf
  s_nop 1
  v_add_f32_dpp v14, v14, v14 row_shr:4 row_mask:0xf bank_mask:0xf
  s_nop 1
  v_add_f32_dpp v14, v14, v14 row_shr:8 row_mask:0xf bank_mask:0xf
  s_nop 1
  v_add_f32_dpp v14, v14, v14 row_bcast:15 row_mask:0xa bank_mask:0xf
  s_nop 1
  v_add_f32_dpp v14, v14, v14 row_bcast:31 row_mask:0xc bank_mask:0xf
  v_add_u32 v7, s75, v7
  s_branch L_blk
L_slow:
  v_subrev_u32 v7, s75, v7
L_slow2:
  v_lshlrev_b32 v22, 1, v0
  v_add_u32 v23, s74, v22
  s_mul_i32 s81, s3, 4224
  s_add_u32 s81, s81, 1024
  v_add_u32 v22, s81, v22
  v_add_u32 v8, s81, v9
L_csync10:
  ds_read_b32 v4, v2 offset:12
  s_waitcnt lgkmcnt(0)
  v_cmp_gt_u32 vcc, 8, v4
  s_cbranch_vccnz L_csync10
  ds_read_u16 v52, v23 offset:0
  ds_read_u16 v53, v23 offset:128
  ds_read_u16 v54, v23 offset:256
  ds_read_u16 v55, v23 offset:384
  ds_read_u16 v56, v23 offset:512
  ds_read_u16 v57, v23 offset:640
  ds_read_u16 v58, v23 offset:768
  ds_read_u16 v59, v23 offset:896
  ds_read_u16 v60, v23 offset:1056
  ds_read_u16 v61, v23 offset:1184
  ds_read_u16 v62, v23 offset:1312
  ds_read_u16 v63, v23 offset:1440
  ds_read_u16 v64, v23 offset:1568
  ds_read_u16 v65, v23 offset:1696
  ds_read_u16 v66, v23 offset:1824
  ds_read_u16 v67, v23 offset:1952
  ds_read_u16 v68, v23 offset:2112
  ds_read_u16 v69, v23 offset:2240
  ds_read_u16 v70, v23 offset:2368
  ds_read_u16 v71, v23 offset:2496
  ds_read_u16 v72, v23 offset:2624
  ds_read_u16 v73, v23 offset:2752
  ds_read_u16 v74, v23 offset:2880
  ds_read_u16 v75, v23 offset:3008
  ds_read_u16 v76, v23 offset:3168
  ds_read_u16 v77, v23 offset:3296
  ds_read_u16 v78, v23 offset:3424
  ds_read_u16 v79, v23 offset:3552
  ds_read_u16 v80, v23 offset:3680
  ds_read_u16 v81, v23 offset:3808
  ds_read_u16 v82, v23 offset:3936
  s_waitcnt lgkmcnt(14)
  v_lshlrev_b32 v52, 16, v52
  v_lshlrev_b32 v53, 16, v53
  v_lshlrev_b32 v54, 16, v54
  v_lshlrev_b32 v55, 16, v55
  v_lshlrev_b32 v56, 16, v56
  v_lshlrev_b32 v57, 16, v57
  v_lshlrev_b32 v58, 16, v58
  v_lshlrev_b32 v59, 16, v59
  v_lshlrev_b32 v60, 16, v60
  v_lshlrev_b32 v61, 16, v61
  v_lshlrev_b32 v62, 16, v62
  v_lshlrev_b32 v63, 16, v63
  v_lshlrev_b32 v64, 16, v64
  v_lshlrev_b32 v65, 16, v65
  v_lshlrev_b32 v66, 16, v66
  v_lshlrev_b32 v67, 16, v67
  v_lshlrev_b32 v68, 16, v68
  s_waitcnt lgkmcnt(13)
  v_lshlrev_b32 v69, 16, v69
  s_waitcnt lgkmcnt(12)
  v_lshlrev_b32 v70, 16, v70
  s_waitcnt lgkmcnt(11)
  v_lshlrev_b32 v71, 16, v71
  s_waitcnt lgkmcnt(10)
  v_lshlrev_b32 v72, 16, v72
  s_waitcnt lgkmcnt(9)
  v_lshlrev_b32 v73, 16, v73
  s_waitcnt lgkmcnt(8)
  v_lshlrev_b32 v74, 16, v74
  s_waitcnt lgkmcnt(7)
  v_lshlrev_b32 v75, 16, v75
  s_waitcnt lgkmcnt(6)
  v_lshlrev_b32 v76, 16, v76
  s_waitcnt lgkmcnt(5)
  v_lshlrev_b32 v77, 16, v77
  s_waitcnt lgkmcnt(4)
  v_lshlrev_b32 v78, 16, v78
  s_waitcnt lgkmcnt(3)
  v_lshlrev_b32 v79, 16, v79
  s_waitcnt lgkmcnt(2)
  v_lshlrev_b32 v80, 16, v80
  s_waitcnt lgkmcnt(1)
  v_lshlrev_b32 v81, 16, v81
  s_waitcnt lgkmcnt(0)
  v_lshlrev_b32 v82, 16, v82
  v_max3_f32 v14, abs(v52), abs(v53), abs(v54)
  v_max3_f32 v14, v14, abs(v55), abs(v56)
  v_max3_f32 v14, v14, abs(v57), abs(v58)
  v_max3_f32 v14, v14, abs(v59), abs(v60)
  v_max3_f32 v14, v14, abs(v61), abs(v62)
  v_max3_f32 v14, v14, abs(v63), abs(v64)
  v_max3_f32 v14, v14, abs(v65), abs(v66)
  v_max3_f32 v14, v14, abs(v67), abs(v68)
  v_max3_f32 v14, v14, abs(v69), abs(v70)
  v_max3_f32 v14, v14, abs(v71), abs(v72)
  v_max3_f32 v14, v14, abs(v73), abs(v74)
  v_max3_f32 v14, v14, abs(v75), abs(v76)
  v_max3_f32 v14, v14, abs(v77), abs(v78)
  v_max3_f32 v14, v14, abs(v79), abs(v80)
  v_max3_f32 v14, v14, abs(v81), abs(v82)
  s_nop 1
  v_max_u32_dpp v14, v14, v14 row_shr:1 row_mask:0xf bank_mask:0xf
  s_nop 1
  v_max_u32_dpp v14, v14, v14 row_shr:2 row_mask:0xf bank_mask:0xf
  s_nop 1
  v_max_u32_dpp v14, v14, v14 row_shr:4 row_mask:0xf bank_mask:0xf
  s_nop 1
  v_max_u32_dpp v14, v14, v14 row_shr:8 row_mask:0xf bank_mask:0xf
  s_nop 1
  v_max_u32_dpp v14, v14, v14 row_bcast:15 row_mask:0xa bank_mask:0xf
  s_nop 1
  v_max_u32_dpp v14, v14, v14 row_bcast:31 row_mask:0xc bank_mask:0xf
  s_nop 0
  v_readlane_b32 s81, v14, 63
  s_nop 0
  s_lshr_b32 s81, s81, 23
  s_sub_i32 s81, 134, s81
  s_cmp_le_u32 s81, 9
  s_cselect_b32 s97, 2, 3
  s_min_i32 s81, s81, 16
  s_lshl_b32 s49, s81, 2
  s_sub_i32 s49, s48, s49
  s_add_i32 s81, s81, 127
  s_lshl_b32 s81, s81, 23
  v_mov_b32 v83, s81
  v_mul_f32 v52, s81, v52
  v_mul_f32 v53, s81, v53
  v_mul_f32 v54, s81, v54
  v_mul_f32 v55, s81, v55
  v_mul_f32 v56, s81, v56
  v_mul_f32 v57, s81, v57
  v_mul_f32 v58, s81, v58
  v_mul_f32 v59, s81, v59
  v_mul_f32 v60, s81, v60
  v_mul_f32 v61, s81, v61
  v_mul_f32 v62, s81, v62
  v_mul_f32 v63, s81, v63
  v_mul_f32 v64, s81, v64
  v_mul_f32 v65, s81, v65
  v_mul_f32 v66, s81, v66
  v_mul_f32 v67, s81, v67
  v_mul_f32 v68, s81, v68
  v_mul_f32 v69, s81, v69
  v_mul_f32 v70, s81, v70
  v_mul_f32 v71, s81, v71
  v_mul_f32 v72, s81, v72
  v_mul_f32 v73, s81, v73
  v_mul_f32 v74, s81, v74
  v_mul_f32 v75, s81, v75
  v_mul_f32 v76, s81, v76
  v_mul_f32 v77, s81, v77
  v_mul_f32 v78, s81, v78
  v_mul_f32 v79, s81, v79
  v_mul_f32 v80, s81, v80
  v_mul_f32 v81, s81, v81
  v_mul_f32 v82, s81, v82
  ds_write_b16_d16_hi v23, v52 offset:0
  ds_write_b16_d16_hi v23, v53 offset:128
  ds_write_b16_d16_hi v23, v54 offset:256
  ds_write_b16_d16_hi v23, v55 offset:384
  ds_write_b16_d16_hi v23, v56 offset:512
  ds_write_b16_d16_hi v23, v57 offset:640
  ds_write_b16_d16_hi v23, v58 offset:768
  ds_write_b16_d16_hi v23, v59 offset:896
  ds_write_b16_d16_hi v23, v60 offset:1056
  ds_write_b16_d16_hi v23, v61 offset:1184
  ds_write_b16_d16_hi v23, v62 offset:1312
  ds_write_b16_d16_hi v23, v63 offset:1440
  ds_write_b16_d16_hi v23, v64 offset:1568
  ds_write_b16_d16_hi v23, v65 offset:1696
  ds_write_b16_d16_hi v23, v66 offset:1824
  ds_write_b16_d16_hi v23, v67 offset:1952
  ds_write_b16_d16_hi v23, v68 offset:2112
  ds_write_b16_d16_hi v23, v69 offset:2240
  ds_write_b16_d16_hi v23, v70 offset:2368
  ds_write_b16_d16_hi v23, v71 offset:2496
  ds_write_b16_d16_hi v23, v72 offset:2624
  ds_write_b16_d16_hi v23, v73 offset:2752
  ds_write_b16_d16_hi v23, v74 offset:2880
  ds_write_b16_d16_hi v23, v75 offset:3008
  ds_write_b16_d16_hi v23, v76 offset:3168
  ds_write_b16_d16_hi v23, v77 offset:3296
  ds_write_b16_d16_hi v23, v78 offset:3424
  ds_write_b16_d16_hi v23, v79 offset:3552
  ds_write_b16_d16_hi v23, v80 offset:3680
  ds_write_b16_d16_hi v23, v81 offset:3808
  ds_write_b16_d16_hi v23, v82 offset:3936
  v_mul_f32 v52, s81, v52
  v_mul_f32 v53, s81, v53
  v_mul_f32 v54, s81, v54
  v_mul_f32 v55, s81, v55
  v_mul_f32 v56, s81, v56
  v_mul_f32 v57, s81, v57
  v_mul_f32 v58, s81, v58
  v_mul_f32 v59, s81, v59
  v_mul_f32 v60, s81, v60
  v_mul_f32 v61, s81, v61
  v_mul_f32 v62, s81, v62
  v_mul_f32 v63, s81, v63
  v_mul_f32 v64, s81, v64
  v_mul_f32 v65, s81, v65
  v_mul_f32 v66, s81, v66
  v_mul_f32 v67, s81, v67
  v_mul_f32 v68, s81, v68
  v_mul_f32 v69, s81, v69
  v_mul_f32 v70, s81, v70
  v_mul_f32 v71, s81, v71
  v_mul_f32 v72, s81, v72
  v_mul_f32 v73, s81, v73
  v_mul_f32 v74, s81, v74
  v_mul_f32 v75, s81, v75
  v_mul_f32 v76, s81, v76
  v_mul_f32 v77, s81, v77
  v_mul_f32 v78, s81, v78
  v_mul_f32 v79, s81, v79
  v_mul_f32 v80, s81, v80
  v_mul_f32 v81, s81, v81
  v_mul_f32 v82, s81, v82
  v_mul_f32 v83, s81, v83
  ds_write_b16_d16_hi v22, v52 offset:0
  ds_write_b16_d16_hi v22, v53 offset:128
  ds_write_b16_d16_hi v22, v54 offset:256
  ds_write_b16_d16_hi v22, v55 offset:384
  ds_write_b16_d16_hi v22, v56 offset:512
  ds_write_b16_d16_hi v22, v57 offset:640
  ds_write_b16_d16_hi v22, v58 offset:768
  ds_write_b16_d16_hi v22, v59 offset:896
  ds_write_b16_d16_hi v22, v60 offset:1056
  ds_write_b16_d16_hi v22, v61 offset:1184
  ds_write_b16_d16_hi v22, v62 offset:1312
  ds_write_b16_d16_hi v22, v63 offset:1440
  ds_write_b16_d16_hi v22, v64 offset:1568
  ds_write_b16_d16_hi v22, v65 offset:1696
  ds_write_b16_d16_hi v22, v66 offset:1824
  ds_write_b16_d16_hi v22, v67 offset:1952
  ds_write_b16_d16_hi v22, v68 offset:2112
  ds_write_b16_d16_hi v22, v69 offset:2240
  ds_write_b16_d16_hi v22, v70 offset:2368
  ds_write_b16_d16_hi v22, v71 offset:2496
  ds_write_b16_d16_hi v22, v72 offset:2624
  ds_write_b16_d16_hi v22, v73 offset:2752
  ds_write_b16_d16_hi v22, v74 offset:2880
  ds_write_b16_d16_hi v22, v75 offset:3008
  ds_write_b16_d16_hi v22, v76 offset:3168
  ds_write_b16_d16_hi v22, v77 offset:3296
  ds_write_b16_d16_hi v22, v78 offset:3424
  ds_write_b16_d16_hi v22, v79 offset:3552
  ds_write_b16_d16_hi v22, v80 offset:3680
  ds_write_b16_d16_hi v22, v81 offset:3808
  ds_write_b16_d16_hi v22, v82 offset:3936
  ds_write_b16_d16_hi v22, v83 offset:4064
  s_mov_b32 s50, 0
  s_waitcnt lgkmcnt(0)
  s_branch L_prime
L_cin_done:
  s_endpgm
L_rem:
  s_lshr_b32 s84, s3, 2
  s_and_b32 s68, s2, 7
  s_lshl_b32 s68, s68, 3
  s_add_u32 s68, s68, s3
  s_mul_i32 s68, s68, 6656
  s_lshl_b32 s76, s3, 14
  v_lshlrev_b32 v248, 4, v0
  v_lshrrev_b32 v246, 4, v0
  v_lshrrev_b32 v247, 3, v0
  v_mul_u32_u24 v13, 3328, v247
  v_and_b32 v247, 2, v247
  s_and_b32 s69, s3, 1
  s_lshl_b32 s69, s69, 2
  v_or_b32 v247, s69, v247
  v_and_b32 v9, 7, v0
  v_xor_b32 v247, v247, v9
  v_lshl_add_u32 v13, v247, 4, v13
  s_mul_i32 s74, s3, 26624
  s_add_u32 s74, s74, 3200
  s_lshl_b32 s75, s3, 10
  s_add_u32 s75, s75, 131072
  s_waitcnt lgkmcnt(0)
  s_mov_b32 s28, s4
  s_and_b32 s29, s5, 0xffff
  s_mov_b32 s30, 425984
  s_mov_b32 s31, 0x20000
  s_add_u32 m0, s76, 8192
  s_nop 0
  buffer_load_dwordx4 v248, s[28:31], s68 offen lds
  s_add_u32 s68, s68, 1024
  s_add_u32 m0, s76, 9216
  s_nop 0
  buffer_load_dwordx4 v248, s[28:31], s68 offen lds
  s_add_u32 s68, s68, 1024
  s_add_u32 m0, s76, 10240
  s_nop 0
  buffer_load_dwordx4 v248, s[28:31], s68 offen lds
  s_add_u32 s68, s68, 1024
  s_add_u32 m0, s76, 11264
  s_nop 0
  buffer_load_dwordx4 v248, s[28:31], s68 offen lds
  s_add_u32 s68, s68, 1024
  s_add_u32 m0, s76, 12288
  s_nop 0
  buffer_load_dwordx4 v248, s[28:31], s68 offen lds
  s_add_u32 s68, s68, 1024
  s_add_u32 m0, s76, 13312
  s_nop 0
  buffer_load_dwordx4 v248, s[28:31], s68 offen lds
  s_add_u32 s68, s68, 1024
  s_add_u32 m0, s76, 14336
  s_nop 0
  buffer_load_dwordx4 v248, s[28:31], s68 offen lds
  s_add_u32 s68, s68, 1024
  s_mov_b32 s44, s12
  s_and_b32 s45, s13, 0xffff
  s_mov_b32 s46, 5537792
  s_mov_b32 s47, 0x20000
  s_add_u32 m0, s75, 0
  s_nop 0
  buffer_load_dwordx4 v13, s[44:47], s74 offen lds
  s_add_u32 s74, s74, 212992
  s_mov_b32 s60, s24
  s_and_b32 s61, s25, 0xffff
  s_mov_b32 s62, 268435456
  s_mov_b32 s63, 0x20000
  s_mov_b32 s64, s22
  s_and_b32 s65, s23, 0xffff
  s_mov_b32 s66, 256
  s_mov_b32 s67, 0x20000
  v_mov_b32 v64, -1
  v_mov_b32 v65, -1
  v_mov_b32 v66, -1
  v_mov_b32 v67, -1
  s_and_b32 s70, s2, 7
  s_lshl_b32 s68, s70, 3
  s_add_u32 s68, s68, s3
  s_lshl_b32 s68, s68, 11
  s_lshl_b32 s70, s70, 2
  buffer_store_dwordx4 v[64:67], v248, s[60:63], s68 offen sc1
  buffer_store_dwordx4 v[64:67], v248, s[60:63], s68 offen offset:1024 sc1
  s_mov_b32 s48, s14
  s_and_b32 s49, s15, 0xffff
  s_mov_b32 s50, 3328
  s_mov_b32 s51, 0x20000
  s_mov_b32 s52, s16
  s_and_b32 s53, s17, 0xffff
  s_mov_b32 s54, 3328
  s_mov_b32 s55, 0x20000
  s_mov_b32 s32, s6
  s_and_b32 s33, s7, 0xffff
  s_mov_b32 s34, 12800000
  s_mov_b32 s35, 0x20000
  v_xor_b32 v248, v9, v246
  v_lshlrev_b32 v14, 4, v248
  v_xor_b32 v15, 64, v14
  v_bfe_u32 v247, v0, 2, 2
  v_lshl_add_u32 v248, v246, 3, v247
  v_lshlrev_b32 v248, 7, v248
  v_and_b32 v247, 3, v0
  v_lshl_add_u32 v248, v247, 3, v248
  v_add_u32 v248, 131072, v248
  v_bfe_u32 v247, v0, 3, 2
  v_lshl_add_u32 v1, v247, 5, v248
  v_xor_b32 v2, 32, v1
  v_xor_b32 v7, 64, v1
  v_xor_b32 v8, 96, v1
  v_and_b32 v248, 15, v0
  v_lshlrev_b32 v248, 7, v248
  v_bfe_u32 v247, v0, 1, 3
  v_xor_b32 v247, v247, v246
  v_lshl_add_u32 v248, v247, 4, v248
  v_add_u32 v11, s76, v248
  v_xor_b32 v12, 64, v11
  v_lshrrev_b32 v247, 3, v0
  v_lshl_add_u32 v248, v9, 3, v247
  v_mul_u32_u24 v248, 104, v248
  v_add_u32 v248, s76, v248
  v_mov_b32 v240, 0xc0135761
  v_mov_b32 v241, 0xc0135761
  v_mov_b32 v242, 0xbdd2d3e8
  v_mov_b32 v243, 0xbdd2d3e8
  v_mov_b32 v244, 0x71800000
  v_mov_b32 v160, 0
  v_mov_b32 v161, 0
  v_mov_b32 v162, 0
  v_mov_b32 v163, 0
  v_mov_b32 v164, 0
  v_mov_b32 v165, 0
  v_mov_b32 v166, 0
  v_mov_b32 v167, 0
  v_mov_b32 v168, 0
  v_mov_b32 v169, 0
  v_mov_b32 v170, 0
  v_mov_b32 v171, 0
  v_mov_b32 v172, 0
  v_mov_b32 v173, 0
  v_mov_b32 v174, 0
  v_mov_b32 v175, 0
  v_mov_b32 v176, 0
  v_mov_b32 v177, 0
  v_mov_b32 v178, 0
  v_mov_b32 v179, 0
  v_mov_b32 v180, 0
  v_mov_b32 v181, 0
  v_mov_b32 v182, 0
  v_mov_b32 v183, 0
  v_mov_b32 v184, 0
  v_mov_b32 v185, 0
  v_mov_b32 v186, 0
  v_mov_b32 v187, 0
  v_mov_b32 v188, 0
  v_mov_b32 v189, 0
  v_mov_b32 v190, 0
  v_mov_b32 v191, 0
  v_mov_b32 v192, 0
  v_mov_b32 v193, 0
  v_mov_b32 v194, 0
  v_mov_b32 v195, 0
  v_mov_b32 v196, 0
  v_mov_b32 v197, 0
  v_mov_b32 v198, 0
  v_mov_b32 v199, 0
  v_mov_b32 v200, 0
  v_mov_b32 v201, 0
  v_mov_b32 v202, 0
  v_mov_b32 v203, 0
  v_mov_b32 v204, 0
  v_mov_b32 v205, 0
  v_mov_b32 v206, 0
  v_mov_b32 v207, 0
  v_mov_b32 v208, 0
  v_mov_b32 v209, 0
  v_mov_b32 v210, 0
  v_mov_b32 v211, 0
  v_mov_b32 v212, 0
  v_mov_b32 v213, 0
  v_mov_b32 v214, 0
  v_mov_b32 v215, 0
  v_mov_b32 v216, 0
  v_mov_b32 v217, 0
  v_mov_b32 v218, 0
  v_mov_b32 v219, 0
  v_mov_b32 v220, 0
  v_mov_b32 v221, 0
  v_mov_b32 v222, 0
  v_mov_b32 v223, 0
  s_waitcnt vmcnt(0)
  ds_read_b64 v[32:33], v248 offset:8192
  ds_read_b64 v[34:35], v248 offset:8200
  ds_read_b64 v[36:37], v248 offset:8208
  ds_read_b64 v[38:39], v248 offset:8216
  ds_read_b64 v[40:41], v248 offset:8224
  ds_read_b64 v[42:43], v248 offset:8232
  ds_read_b64 v[44:45], v248 offset:8240
  ds_read_b64 v[46:47], v248 offset:8248
  ds_read_b64 v[48:49], v248 offset:8256
  ds_read_b64 v[50:51], v248 offset:8264
  ds_read_b64 v[52:53], v248 offset:8272
  ds_read_b64 v[54:55], v248 offset:8280
  ds_read_b64 v[56:57], v248 offset:8288
  v_mov_b32 v24, 0
  v_mov_b32 v25, 0
  v_mov_b32 v26, 0
  v_mov_b32 v27, 0
  v_mov_b32 v28, 0
  v_mov_b32 v29, 0
  v_mov_b32 v30, 0
  v_mov_b32 v31, 0
  v_mov_b32 v58, 0x7f000000
  v_mov_b32 v59, 0x7f000000
  s_waitcnt lgkmcnt(12)
  v_lshlrev_b32 v32, 7, v32
  s_nop 1
  v_add_u32_dpp v24, v32, v14 row_newbcast:0 row_mask:0xf bank_mask:0x3
  v_add_u32_dpp v25, v32, v15 row_newbcast:1 row_mask:0xf bank_mask:0x3
  v_add_u32_dpp v26, v32, v14 row_newbcast:2 row_mask:0xf bank_mask:0x3
  v_add_u32_dpp v27, v32, v15 row_newbcast:3 row_mask:0xf bank_mask:0x3
  v_add_u32_dpp v24, v32, v14 row_newbcast:8 row_mask:0xf bank_mask:0xc
  v_add_u32_dpp v25, v32, v15 row_newbcast:9 row_mask:0xf bank_mask:0xc
  v_add_u32_dpp v26, v32, v14 row_newbcast:10 row_mask:0xf bank_mask:0xc
  v_add_u32_dpp v27, v32, v15 row_newbcast:11 row_mask:0xf bank_mask:0xc
  s_add_u32 m0, s76, 0
  s_nop 0
  buffer_load_dwordx4 v24, s[32:35], 0 offen lds
  s_add_u32 m0, s76, 1024
  s_nop 0
  buffer_load_dwordx4 v25, s[32:35], 0 offen lds
  s_add_u32 m0, s76, 2048
  s_nop 0
  buffer_load_dwordx4 v26, s[32:35], 0 offen lds
  s_add_u32 m0, s76, 3072
  s_nop 0
  buffer_load_dwordx4 v27, s[32:35], 0 offen lds
  v_add_u32_dpp v28, v32, v14 row_newbcast:4 row_mask:0xf bank_mask:0x3
  v_add_u32_dpp v29, v32, v15 row_newbcast:5 row_mask:0xf bank_mask:0x3
  v_add_u32_dpp v30, v32, v14 row_newbcast:6 row_mask:0xf bank_mask:0x3
  v_add_u32_dpp v31, v32, v15 row_newbcast:7 row_mask:0xf bank_mask:0x3
  v_add_u32_dpp v28, v32, v14 row_newbcast:12 row_mask:0xf bank_mask:0xc
  v_add_u32_dpp v29, v32, v15 row_newbcast:13 row_mask:0xf bank_mask:0xc
  v_add_u32_dpp v30, v32, v14 row_newbcast:14 row_mask:0xf bank_mask:0xc
  v_add_u32_dpp v31, v32, v15 row_newbcast:15 row_mask:0xf bank_mask:0xc
  s_add_u32 m0, s76, 4096
  s_nop 0
  buffer_load_dwordx4 v28, s[32:35], 0 offen lds
  s_add_u32 m0, s76, 5120
  s_nop 0
  buffer_load_dwordx4 v29, s[32:35], 0 offen lds
  s_add_u32 m0, s76, 6144
  s_nop 0
  buffer_load_dwordx4 v30, s[32:35], 0 offen lds
  s_add_u32 m0, s76, 7168
  s_nop 0
  buffer_load_dwordx4 v31, s[32:35], 0 offen lds
  s_add_u32 m0, s75, 8192
  s_nop 0
  buffer_load_dwordx4 v13, s[44:47], s74 offen lds
  s_add_u32 s74, s74, 212992
  s_waitcnt lgkmcnt(0)
  v_lshlrev_b32 v57, 7, v57
  v_lshlrev_b32 v56, 7, v56
  v_lshlrev_b32 v55, 7, v55
  v_lshlrev_b32 v54, 7, v54
  v_lshlrev_b32 v53, 7, v53
  v_lshlrev_b32 v52, 7, v52
  v_lshlrev_b32 v51, 7, v51
  v_lshlrev_b32 v50, 7, v50
  v_lshlrev_b32 v49, 7, v49
  v_lshlrev_b32 v48, 7, v48
  v_lshlrev_b32 v47, 7, v47
  v_lshlrev_b32 v46, 7, v46
  v_lshlrev_b32 v45, 7, v45
  v_lshlrev_b32 v44, 7, v44
  v_lshlrev_b32 v43, 7, v43
  v_lshlrev_b32 v42, 7, v42
  v_lshlrev_b32 v41, 7, v41
  v_lshlrev_b32 v40, 7, v40
  v_lshlrev_b32 v39, 7, v39
  v_lshlrev_b32 v38, 7, v38
  v_lshlrev_b32 v37, 7, v37
  v_lshlrev_b32 v36, 7, v36
  v_lshlrev_b32 v35, 7, v35
  v_lshlrev_b32 v34, 7, v34
  v_lshlrev_b32 v33, 7, v33
  s_nop 1
  v_add_u32_dpp v24, v33, v14 row_newbcast:0 row_mask:0xf bank_mask:0x3
  v_add_u32_dpp v25, v33, v15 row_newbcast:1 row_mask:0xf bank_mask:0x3
  v_add_u32_dpp v26, v33, v14 row_newbcast:2 row_mask:0xf bank_mask:0x3
  v_add_u32_dpp v27, v33, v15 row_newbcast:3 row_mask:0xf bank_mask:0x3
  v_add_u32_dpp v24, v33, v14 row_newbcast:8 row_mask:0xf bank_mask:0xc
  v_add_u32_dpp v25, v33, v15 row_newbcast:9 row_mask:0xf bank_mask:0xc
  v_add_u32_dpp v26, v33, v14 row_newbcast:10 row_mask:0xf bank_mask:0xc
  v_add_u32_dpp v27, v33, v15 row_newbcast:11 row_mask:0xf bank_mask:0xc
  s_add_u32 m0, s76, 8192
  s_nop 0
  buffer_load_dwordx4 v24, s[32:35], 0 offen lds
  s_add_u32 m0, s76, 9216
  s_nop 0
  buffer_load_dwordx4 v25, s[32:35], 0 offen lds
  s_add_u32 m0, s76, 10240
  s_nop 0
  buffer_load_dwordx4 v26, s[32:35], 0 offen lds
  s_add_u32 m0, s76, 11264
  s_nop 0
  buffer_load_dwordx4 v27, s[32:35], 0 offen lds
  v_add_u32_dpp v28, v33, v14 row_newbcast:4 row_mask:0xf bank_mask:0x3
  v_add_u32_dpp v29, v33, v15 row_newbcast:5 row_mask:0xf bank_mask:0x3
  v_add_u32_dpp v30, v33, v14 row_newbcast:6 row_mask:0xf bank_mask:0x3
  v_add_u32_dpp v31, v33, v15 row_newbcast:7 row_mask:0xf bank_mask:0x3
  v_add_u32_dpp v28, v33, v14 row_newbcast:12 row_mask:0xf bank_mask:0xc
  v_add_u32_dpp v29, v33, v15 row_newbcast:13 row_mask:0xf bank_mask:0xc
  v_add_u32_dpp v30, v33, v14 row_newbcast:14 row_mask:0xf bank_mask:0xc
  v_add_u32_dpp v31, v33, v15 row_newbcast:15 row_mask:0xf bank_mask:0xc
  s_add_u32 m0, s76, 12288
  s_nop 0
  buffer_load_dwordx4 v28, s[32:35], 0 offen lds
  s_add_u32 m0, s76, 13312
  s_nop 0
  buffer_load_dwordx4 v29, s[32:35], 0 offen lds
  s_add_u32 m0, s76, 14336
  s_nop 0
  buffer_load_dwordx4 v30, s[32:35], 0 offen lds
  s_add_u32 m0, s76, 15360
  s_nop 0
  buffer_load_dwordx4 v31, s[32:35], 0 offen lds
  s_add_u32 m0, s75, 16384
  s_nop 0
  buffer_load_dwordx4 v13, s[44:47], s74 offen lds
  s_add_u32 s74, s74, 212992
  v_lshlrev_b32 v248, 3, v246
  s_mov_b32 s73, 3
  v_mov_b32 v9, v34
  s_nop 1
  v_add_u32_dpp v24, v9, v14 row_newbcast:0 row_mask:0xf bank_mask:0x3
  v_add_u32_dpp v25, v9, v15 row_newbcast:1 row_mask:0xf bank_mask:0x3
  v_add_u32_dpp v26, v9, v14 row_newbcast:2 row_mask:0xf bank_mask:0x3
  v_add_u32_dpp v27, v9, v15 row_newbcast:3 row_mask:0xf bank_mask:0x3
  v_add_u32_dpp v24, v9, v14 row_newbcast:8 row_mask:0xf bank_mask:0xc
  v_add_u32_dpp v25, v9, v15 row_newbcast:9 row_mask:0xf bank_mask:0xc
  v_add_u32_dpp v26, v9, v14 row_newbcast:10 row_mask:0xf bank_mask:0xc
  v_add_u32_dpp v27, v9, v15 row_newbcast:11 row_mask:0xf bank_mask:0xc
  s_waitcnt vmcnt(14)
  s_barrier
  ds_read_b128 v[76:79], v12 offset:2048
  ds_read_b128 v[72:75], v11 offset:2048
  ds_read_b128 v[68:71], v12 offset:0
  ds_read_b128 v[64:67], v11 offset:0
  ds_read_b64_tr_b16 v[96:97], v1 offset:0
  ds_read_b64_tr_b16 v[98:99], v1 offset:512
  ds_read_b64_tr_b16 v[100:101], v1 offset:4096
  ds_read_b64_tr_b16 v[102:103], v1 offset:4608
  ds_read_b64_tr_b16 v[104:105], v2 offset:0
  ds_read_b64_tr_b16 v[106:107], v2 offset:512
  ds_read_b64_tr_b16 v[108:109], v2 offset:4096
  ds_read_b64_tr_b16 v[110:111], v2 offset:4608
  ds_read_b64_tr_b16 v[112:113], v7 offset:0
  ds_read_b64_tr_b16 v[114:115], v7 offset:512
  ds_read_b64_tr_b16 v[116:117], v7 offset:4096
  ds_read_b64_tr_b16 v[118:119], v7 offset:4608
  ds_read_b64_tr_b16 v[120:121], v8 offset:0
  ds_read_b64_tr_b16 v[122:123], v8 offset:512
  ds_read_b64_tr_b16 v[124:125], v8 offset:4096
  ds_read_b64_tr_b16 v[126:127], v8 offset:4608
  s_cmp_lg_u32 s3, 7
  s_cbranch_scc1 L_rem_loop
  s_mov_b64 exec, 1
  buffer_store_dword v240, v14, s[64:67], s70 offen offset:128 sc1
  s_mov_b64 exec, -1
L_rem_loop:
  s_waitcnt vmcnt(9)
  s_barrier
  s_waitcnt lgkmcnt(8)
  v_mfma_f32_16x16x32_bf16 v[160:163], v[96:99], v[64:67], v[160:163]
  ds_read_b128 v[92:95], v12 offset:6144
  ds_read_b128 v[88:91], v11 offset:6144
  s_waitcnt lgkmcnt(14)
  v_mfma_f32_16x16x32_bf16 v[160:163], v[100:103], v[68:71], v[160:163]
  ds_read_b128 v[84:87], v12 offset:4096
  s_add_u32 m0, s76, 0
  s_nop 0
  buffer_load_dwordx4 v24, s[32:35], 0 offen lds
  v_mfma_f32_16x16x32_bf16 v[164:167], v[96:99], v[72:75], v[164:167]
  ds_read_b128 v[80:83], v11 offset:4096
  v_mfma_f32_16x16x32_bf16 v[164:167], v[100:103], v[76:79], v[164:167]
  ds_read_b64_tr_b16 v[128:129], v1 offset:8192
  s_waitcnt lgkmcnt(14)
  v_mfma_f32_16x16x32_bf16 v[176:179], v[104:107], v[64:67], v[176:179]
  ds_read_b64_tr_b16 v[130:131], v1 offset:8704
  s_add_u32 m0, s76, 1024
  s_nop 0
  buffer_load_dwordx4 v25, s[32:35], 0 offen lds
  s_waitcnt lgkmcnt(14)
  v_mfma_f32_16x16x32_bf16 v[176:179], v[108:111], v[68:71], v[176:179]
  ds_read_b64_tr_b16 v[132:133], v1 offset:12288
  v_mfma_f32_16x16x32_bf16 v[180:183], v[104:107], v[72:75], v[180:183]
  ds_read_b64_tr_b16 v[134:135], v1 offset:12800
  v_mfma_f32_16x16x32_bf16 v[180:183], v[108:111], v[76:79], v[180:183]
  ds_read_b64_tr_b16 v[136:137], v2 offset:8192
  s_waitcnt lgkmcnt(14)
  v_mfma_f32_16x16x32_bf16 v[192:195], v[112:115], v[64:67], v[192:195]
  ds_read_b64_tr_b16 v[138:139], v2 offset:8704
  s_add_u32 m0, s76, 2048
  s_nop 0
  buffer_load_dwordx4 v26, s[32:35], 0 offen lds
  s_waitcnt lgkmcnt(14)
  v_mfma_f32_16x16x32_bf16 v[192:195], v[116:119], v[68:71], v[192:195]
  ds_read_b64_tr_b16 v[140:141], v2 offset:12288
  v_mfma_f32_16x16x32_bf16 v[196:199], v[112:115], v[72:75], v[196:199]
  ds_read_b64_tr_b16 v[142:143], v2 offset:12800
  v_mfma_f32_16x16x32_bf16 v[196:199], v[116:119], v[76:79], v[196:199]
  v_add_u32_dpp v28, v9, v14 row_newbcast:4 row_mask:0xf bank_mask:0x3
  v_add_u32_dpp v29, v9, v15 row_newbcast:5 row_mask:0xf bank_mask:0x3
  s_waitcnt lgkmcnt(14)
  v_mfma_f32_16x16x32_bf16 v[208:211], v[120:123], v[64:67], v[208:211]
  s_add_u32 m0, s76, 3072
  s_nop 0
  buffer_load_dwordx4 v27, s[32:35], 0 offen lds
  v_add_u32_dpp v30, v9, v14 row_newbcast:6 row_mask:0xf bank_mask:0x3
  v_add_u32_dpp v31, v9, v15 row_newbcast:7 row_mask:0xf bank_mask:0x3
  s_waitcnt lgkmcnt(12)
  v_mfma_f32_16x16x32_bf16 v[208:211], v[124:127], v[68:71], v[208:211]
  v_add_u32_dpp v28, v9, v14 row_newbcast:12 row_mask:0xf bank_mask:0xc
  v_mfma_f32_16x16x32_bf16 v[212:215], v[120:123], v[72:75], v[212:215]
  v_add_u32_dpp v29, v9, v15 row_newbcast:13 row_mask:0xf bank_mask:0xc
  v_add_u32_dpp v30, v9, v14 row_newbcast:14 row_mask:0xf bank_mask:0xc
  v_mfma_f32_16x16x32_bf16 v[212:215], v[124:127], v[76:79], v[212:215]
  v_add_u32_dpp v31, v9, v15 row_newbcast:15 row_mask:0xf bank_mask:0xc
  s_waitcnt vmcnt(9)
  s_waitcnt lgkmcnt(8)
  v_mfma_f32_16x16x32_bf16 v[168:171], v[96:99], v[80:83], v[168:171]
  ds_read_b128 v[76:79], v12 offset:10240
  ds_read_b128 v[72:75], v11 offset:10240
  v_mfma_f32_16x16x32_bf16 v[168:171], v[100:103], v[84:87], v[168:171]
  ds_read_b128 v[68:71], v12 offset:8192
  s_add_u32 m0, s76, 4096
  s_nop 0
  buffer_load_dwordx4 v28, s[32:35], 0 offen lds
  v_mfma_f32_16x16x32_bf16 v[172:175], v[96:99], v[88:91], v[172:175]
  ds_read_b128 v[64:67], v11 offset:8192
  v_mfma_f32_16x16x32_bf16 v[172:175], v[100:103], v[92:95], v[172:175]
  ds_read_b64_tr_b16 v[144:145], v7 offset:8192
  v_mfma_f32_16x16x32_bf16 v[184:187], v[104:107], v[80:83], v[184:187]
  ds_read_b64_tr_b16 v[146:147], v7 offset:8704
  s_add_u32 m0, s76, 5120
  s_nop 0
  buffer_load_dwordx4 v29, s[32:35], 0 offen lds
  v_mfma_f32_16x16x32_bf16 v[184:187], v[108:111], v[84:87], v[184:187]
  ds_read_b64_tr_b16 v[148:149], v7 offset:12288
  v_mfma_f32_16x16x32_bf16 v[188:191], v[104:107], v[88:91], v[188:191]
  ds_read_b64_tr_b16 v[150:151], v7 offset:12800
  v_mfma_f32_16x16x32_bf16 v[188:191], v[108:111], v[92:95], v[188:191]
  ds_read_b64_tr_b16 v[152:153], v8 offset:8192
  s_add_u32 m0, s76, 6144
  s_nop 0
  buffer_load_dwordx4 v30, s[32:35], 0 offen lds
  v_mfma_f32_16x16x32_bf16 v[200:203], v[112:115], v[80:83], v[200:203]
  ds_read_b64_tr_b16 v[154:155], v8 offset:8704
  v_mfma_f32_16x16x32_bf16 v[200:203], v[116:119], v[84:87], v[200:203]
  ds_read_b64_tr_b16 v[156:157], v8 offset:12288
  v_mfma_f32_16x16x32_bf16 v[204:207], v[112:115], v[88:91], v[204:207]
  ds_read_b64_tr_b16 v[158:159], v8 offset:12800
  s_add_u32 m0, s76, 7168
  s_nop 0
  buffer_load_dwordx4 v31, s[32:35], 0 offen lds
  v_mfma_f32_16x16x32_bf16 v[204:207], v[116:119], v[92:95], v[204:207]
  s_set_gpr_idx_on s73, gpr_idx(SRC0)
  s_nop 0
  v_mov_b32 v9, v32
  s_set_gpr_idx_off
  s_add_u32 s73, s73, 1
  v_add_u32_dpp v24, v9, v14 row_newbcast:0 row_mask:0xf bank_mask:0x3
  v_mfma_f32_16x16x32_bf16 v[216:219], v[120:123], v[80:83], v[216:219]
  v_add_u32_dpp v25, v9, v15 row_newbcast:1 row_mask:0xf bank_mask:0x3
  v_add_u32_dpp v26, v9, v14 row_newbcast:2 row_mask:0xf bank_mask:0x3
  v_mfma_f32_16x16x32_bf16 v[216:219], v[124:127], v[84:87], v[216:219]
  s_xor_b32 s75, s75, 16384
  s_add_u32 m0, s75, 8192
  s_nop 0
  buffer_load_dwordx4 v13, s[44:47], s74 offen lds
  s_add_u32 s74, s74, 212992
  s_xor_b32 s75, s75, 16384
  v_add_u32_dpp v27, v9, v15 row_newbcast:3 row_mask:0xf bank_mask:0x3
  v_add_u32_dpp v24, v9, v14 row_newbcast:8 row_mask:0xf bank_mask:0xc
  v_mfma_f32_16x16x32_bf16 v[220:223], v[120:123], v[88:91], v[220:223]
  v_add_u32_dpp v25, v9, v15 row_newbcast:9 row_mask:0xf bank_mask:0xc
  v_add_u32_dpp v26, v9, v14 row_newbcast:10 row_mask:0xf bank_mask:0xc
  v_mfma_f32_16x16x32_bf16 v[220:223], v[124:127], v[92:95], v[220:223]
  v_add_u32_dpp v27, v9, v15 row_newbcast:11 row_mask:0xf bank_mask:0xc
  s_waitcnt vmcnt(9)
  s_barrier
  v_xor_b32 v1, 16384, v1
  v_xor_b32 v2, 16384, v2
  v_xor_b32 v7, 16384, v7
  v_xor_b32 v8, 16384, v8
  s_waitcnt lgkmcnt(8)
  v_mfma_f32_16x16x32_bf16 v[160:163], v[128:131], v[64:67], v[160:163]
  ds_read_b128 v[92:95], v12 offset:14336
  ds_read_b128 v[88:91], v11 offset:14336
  v_mfma_f32_16x16x32_bf16 v[160:163], v[132:135], v[68:71], v[160:163]
  ds_read_b128 v[84:87], v12 offset:12288
  s_add_u32 m0, s76, 8192
  s_nop 0
  buffer_load_dwordx4 v24, s[32:35], 0 offen lds
  v_mfma_f32_16x16x32_bf16 v[164:167], v[128:131], v[72:75], v[164:167]
  ds_read_b128 v[80:83], v11 offset:12288
  v_mfma_f32_16x16x32_bf16 v[164:167], v[132:135], v[76:79], v[164:167]
  ds_read_b64_tr_b16 v[96:97], v1 offset:0
  v_mfma_f32_16x16x32_bf16 v[176:179], v[136:139], v[64:67], v[176:179]
  ds_read_b64_tr_b16 v[98:99], v1 offset:512
  s_add_u32 m0, s76, 9216
  s_nop 0
  buffer_load_dwordx4 v25, s[32:35], 0 offen lds
  v_mfma_f32_16x16x32_bf16 v[176:179], v[140:143], v[68:71], v[176:179]
  ds_read_b64_tr_b16 v[100:101], v1 offset:4096
  v_mfma_f32_16x16x32_bf16 v[180:183], v[136:139], v[72:75], v[180:183]
  ds_read_b64_tr_b16 v[102:103], v1 offset:4608
  v_mfma_f32_16x16x32_bf16 v[180:183], v[140:143], v[76:79], v[180:183]
  ds_read_b64_tr_b16 v[104:105], v2 offset:0
  s_waitcnt lgkmcnt(14)
  v_mfma_f32_16x16x32_bf16 v[192:195], v[144:147], v[64:67], v[192:195]
  ds_read_b64_tr_b16 v[106:107], v2 offset:512
  s_add_u32 m0, s76, 10240
  s_nop 0
  buffer_load_dwordx4 v26, s[32:35], 0 offen lds
  s_waitcnt lgkmcnt(14)
  v_mfma_f32_16x16x32_bf16 v[192:195], v[148:151], v[68:71], v[192:195]
  ds_read_b64_tr_b16 v[108:109], v2 offset:4096
  v_mfma_f32_16x16x32_bf16 v[196:199], v[144:147], v[72:75], v[196:199]
  ds_read_b64_tr_b16 v[110:111], v2 offset:4608
  v_mfma_f32_16x16x32_bf16 v[196:199], v[148:151], v[76:79], v[196:199]
  v_add_u32_dpp v28, v9, v14 row_newbcast:4 row_mask:0xf bank_mask:0x3
  v_add_u32_dpp v29, v9, v15 row_newbcast:5 row_mask:0xf bank_mask:0x3
  s_waitcnt lgkmcnt(14)
  v_mfma_f32_16x16x32_bf16 v[208:211], v[152:155], v[64:67], v[208:211]
  s_add_u32 m0, s76, 11264
  s_nop 0
  buffer_load_dwordx4 v27, s[32:35], 0 offen lds
  v_add_u32_dpp v30, v9, v14 row_newbcast:6 row_mask:0xf bank_mask:0x3
  v_add_u32_dpp v31, v9, v15 row_newbcast:7 row_mask:0xf bank_mask:0x3
  s_waitcnt lgkmcnt(12)
  v_mfma_f32_16x16x32_bf16 v[208:211], v[156:159], v[68:71], v[208:211]
  v_add_u32_dpp v28, v9, v14 row_newbcast:12 row_mask:0xf bank_mask:0xc
  v_mfma_f32_16x16x32_bf16 v[212:215], v[152:155], v[72:75], v[212:215]
  v_add_u32_dpp v29, v9, v15 row_newbcast:13 row_mask:0xf bank_mask:0xc
  v_add_u32_dpp v30, v9, v14 row_newbcast:14 row_mask:0xf bank_mask:0xc
  v_mfma_f32_16x16x32_bf16 v[212:215], v[156:159], v[76:79], v[212:215]
  v_add_u32_dpp v31, v9, v15 row_newbcast:15 row_mask:0xf bank_mask:0xc
  s_waitcnt vmcnt(9)
  s_waitcnt lgkmcnt(8)
  v_mfma_f32_16x16x32_bf16 v[168:171], v[128:131], v[80:83], v[168:171]
  ds_read_b128 v[76:79], v12 offset:2048
  ds_read_b128 v[72:75], v11 offset:2048
  v_mfma_f32_16x16x32_bf16 v[168:171], v[132:135], v[84:87], v[168:171]
  ds_read_b128 v[68:71], v12 offset:0
  s_add_u32 m0, s76, 12288
  s_nop 0
  buffer_load_dwordx4 v28, s[32:35], 0 offen lds
  v_mfma_f32_16x16x32_bf16 v[172:175], v[128:131], v[88:91], v[172:175]
  ds_read_b128 v[64:67], v11 offset:0
  v_mfma_f32_16x16x32_bf16 v[172:175], v[132:135], v[92:95], v[172:175]
  ds_read_b64_tr_b16 v[112:113], v7 offset:0
  v_mfma_f32_16x16x32_bf16 v[184:187], v[136:139], v[80:83], v[184:187]
  ds_read_b64_tr_b16 v[114:115], v7 offset:512
  s_add_u32 m0, s76, 13312
  s_nop 0
  buffer_load_dwordx4 v29, s[32:35], 0 offen lds
  v_mfma_f32_16x16x32_bf16 v[184:187], v[140:143], v[84:87], v[184:187]
  ds_read_b64_tr_b16 v[116:117], v7 offset:4096
  v_mfma_f32_16x16x32_bf16 v[188:191], v[136:139], v[88:91], v[188:191]
  ds_read_b64_tr_b16 v[118:119], v7 offset:4608
  v_mfma_f32_16x16x32_bf16 v[188:191], v[140:143], v[92:95], v[188:191]
  ds_read_b64_tr_b16 v[120:121], v8 offset:0
  s_add_u32 m0, s76, 14336
  s_nop 0
  buffer_load_dwordx4 v30, s[32:35], 0 offen lds
  v_mfma_f32_16x16x32_bf16 v[200:203], v[144:147], v[80:83], v[200:203]
  ds_read_b64_tr_b16 v[122:123], v8 offset:512
  v_mfma_f32_16x16x32_bf16 v[200:203], v[148:151], v[84:87], v[200:203]
  ds_read_b64_tr_b16 v[124:125], v8 offset:4096
  v_mfma_f32_16x16x32_bf16 v[204:207], v[144:147], v[88:91], v[204:207]
  ds_read_b64_tr_b16 v[126:127], v8 offset:4608
  s_add_u32 m0, s76, 15360
  s_nop 0
  buffer_load_dwordx4 v31, s[32:35], 0 offen lds
  v_mfma_f32_16x16x32_bf16 v[204:207], v[148:151], v[92:95], v[204:207]
  s_set_gpr_idx_on s73, gpr_idx(SRC0)
  s_nop 0
  v_mov_b32 v9, v32
  s_set_gpr_idx_off
  s_add_u32 s73, s73, 1
  v_add_u32_dpp v24, v9, v14 row_newbcast:0 row_mask:0xf bank_mask:0x3
  v_mfma_f32_16x16x32_bf16 v[216:219], v[152:155], v[80:83], v[216:219]
  v_add_u32_dpp v25, v9, v15 row_newbcast:1 row_mask:0xf bank_mask:0x3
  v_add_u32_dpp v26, v9, v14 row_newbcast:2 row_mask:0xf bank_mask:0x3
  v_mfma_f32_16x16x32_bf16 v[216:219], v[156:159], v[84:87], v[216:219]
  s_add_u32 m0, s75, 0
  s_nop 0
  buffer_load_dwordx4 v13, s[44:47], s74 offen lds
  s_add_u32 s74, s74, 212992
  s_xor_b32 s75, s75, 16384
  v_add_u32_dpp v27, v9, v15 row_newbcast:3 row_mask:0xf bank_mask:0x3
  v_add_u32_dpp v24, v9, v14 row_newbcast:8 row_mask:0xf bank_mask:0xc
  v_mfma_f32_16x16x32_bf16 v[220:223], v[152:155], v[88:91], v[220:223]
  v_add_u32_dpp v25, v9, v15 row_newbcast:9 row_mask:0xf bank_mask:0xc
  v_add_u32_dpp v26, v9, v14 row_newbcast:10 row_mask:0xf bank_mask:0xc
  v_mfma_f32_16x16x32_bf16 v[220:223], v[156:159], v[92:95], v[220:223]
  v_add_u32_dpp v27, v9, v15 row_newbcast:11 row_mask:0xf bank_mask:0xc
  s_cmp_lt_u32 s73, 27
  s_cbranch_scc1 L_rem_loop
  s_waitcnt vmcnt(0)
  s_barrier
  s_waitcnt lgkmcnt(8)
  v_mfma_f32_16x16x32_bf16 v[160:163], v[96:99], v[64:67], v[160:163]
  ds_read_b128 v[92:95], v12 offset:6144
  ds_read_b128 v[88:91], v11 offset:6144
  v_mfma_f32_16x16x32_bf16 v[160:163], v[100:103], v[68:71], v[160:163]
  ds_read_b128 v[84:87], v12 offset:4096
  buffer_load_dwordx2 v[224:225], v248, s[48:51], 0 offen offset:3200
  v_mfma_f32_16x16x32_bf16 v[164:167], v[96:99], v[72:75], v[164:167]
  ds_read_b128 v[80:83], v11 offset:4096
  buffer_load_dwordx2 v[226:227], v248, s[48:51], 0 offen offset:3232
  v_mfma_f32_16x16x32_bf16 v[164:167], v[100:103], v[76:79], v[164:167]
  ds_read_b64_tr_b16 v[128:129], v1 offset:8192
  v_mfma_f32_16x16x32_bf16 v[176:179], v[104:107], v[64:67], v[176:179]
  ds_read_b64_tr_b16 v[130:131], v1 offset:8704
  buffer_load_dwordx2 v[228:229], v248, s[48:51], 0 offen offset:3264
  v_mfma_f32_16x16x32_bf16 v[176:179], v[108:111], v[68:71], v[176:179]
  ds_read_b64_tr_b16 v[132:133], v1 offset:12288
  v_mfma_f32_16x16x32_bf16 v[180:183], v[104:107], v[72:75], v[180:183]
  ds_read_b64_tr_b16 v[134:135], v1 offset:12800
  buffer_load_dwordx2 v[230:231], v248, s[48:51], 0 offen offset:3296
  v_mfma_f32_16x16x32_bf16 v[180:183], v[108:111], v[76:79], v[180:183]
  ds_read_b64_tr_b16 v[136:137], v2 offset:8192
  s_waitcnt lgkmcnt(14)
  v_mfma_f32_16x16x32_bf16 v[192:195], v[112:115], v[64:67], v[192:195]
  ds_read_b64_tr_b16 v[138:139], v2 offset:8704
  buffer_load_dwordx2 v[232:233], v248, s[52:55], 0 offen offset:3200
  s_waitcnt lgkmcnt(14)
  v_mfma_f32_16x16x32_bf16 v[192:195], v[116:119], v[68:71], v[192:195]
  ds_read_b64_tr_b16 v[140:141], v2 offset:12288
  v_mfma_f32_16x16x32_bf16 v[196:199], v[112:115], v[72:75], v[196:199]
  ds_read_b64_tr_b16 v[142:143], v2 offset:12800
  buffer_load_dwordx2 v[234:235], v248, s[52:55], 0 offen offset:3232
  v_mfma_f32_16x16x32_bf16 v[196:199], v[116:119], v[76:79], v[196:199]
  s_waitcnt lgkmcnt(14)
  v_mfma_f32_16x16x32_bf16 v[208:211], v[120:123], v[64:67], v[208:211]
  buffer_load_dwordx2 v[236:237], v248, s[52:55], 0 offen offset:3264
  s_waitcnt lgkmcnt(12)
  v_mfma_f32_16x16x32_bf16 v[208:211], v[124:127], v[68:71], v[208:211]
  v_mfma_f32_16x16x32_bf16 v[212:215], v[120:123], v[72:75], v[212:215]
  buffer_load_dwordx2 v[238:239], v248, s[52:55], 0 offen offset:3296
  v_mfma_f32_16x16x32_bf16 v[212:215], v[124:127], v[76:79], v[212:215]
  s_waitcnt lgkmcnt(8)
  v_mfma_f32_16x16x32_bf16 v[168:171], v[96:99], v[80:83], v[168:171]
  ds_read_b128 v[76:79], v12 offset:10240
  ds_read_b128 v[72:75], v11 offset:10240
  v_mfma_f32_16x16x32_bf16 v[168:171], v[100:103], v[84:87], v[168:171]
  ds_read_b128 v[68:71], v12 offset:8192
  v_mfma_f32_16x16x32_bf16 v[172:175], v[96:99], v[88:91], v[172:175]
  ds_read_b128 v[64:67], v11 offset:8192
  v_mfma_f32_16x16x32_bf16 v[172:175], v[100:103], v[92:95], v[172:175]
  ds_read_b64_tr_b16 v[144:145], v7 offset:8192
  v_mfma_f32_16x16x32_bf16 v[184:187], v[104:107], v[80:83], v[184:187]
  ds_read_b64_tr_b16 v[146:147], v7 offset:8704
  v_mfma_f32_16x16x32_bf16 v[184:187], v[108:111], v[84:87], v[184:187]
  ds_read_b64_tr_b16 v[148:149], v7 offset:12288
  v_mfma_f32_16x16x32_bf16 v[188:191], v[104:107], v[88:91], v[188:191]
  ds_read_b64_tr_b16 v[150:151], v7 offset:12800
  v_mfma_f32_16x16x32_bf16 v[188:191], v[108:111], v[92:95], v[188:191]
  ds_read_b64_tr_b16 v[152:153], v8 offset:8192
  v_mfma_f32_16x16x32_bf16 v[200:203], v[112:115], v[80:83], v[200:203]
  ds_read_b64_tr_b16 v[154:155], v8 offset:8704
  v_mfma_f32_16x16x32_bf16 v[200:203], v[116:119], v[84:87], v[200:203]
  ds_read_b64_tr_b16 v[156:157], v8 offset:12288
  v_mfma_f32_16x16x32_bf16 v[204:207], v[112:115], v[88:91], v[204:207]
  ds_read_b64_tr_b16 v[158:159], v8 offset:12800
  v_mfma_f32_16x16x32_bf16 v[204:207], v[116:119], v[92:95], v[204:207]
  v_mfma_f32_16x16x32_bf16 v[216:219], v[120:123], v[80:83], v[216:219]
  v_mfma_f32_16x16x32_bf16 v[216:219], v[124:127], v[84:87], v[216:219]
  v_mfma_f32_16x16x32_bf16 v[220:223], v[120:123], v[88:91], v[220:223]
  v_mfma_f32_16x16x32_bf16 v[220:223], v[124:127], v[92:95], v[220:223]
  s_waitcnt lgkmcnt(8)
  v_mfma_f32_16x16x32_bf16 v[160:163], v[128:131], v[64:67], v[160:163]
  ds_read_b128 v[92:95], v12 offset:14336
  v_mfma_f32_16x16x32_bf16 v[160:163], v[132:135], v[68:71], v[160:163]
  v_mfma_f32_16x16x32_bf16 v[164:167], v[128:131], v[72:75], v[164:167]
  ds_read_b128 v[88:91], v11 offset:14336
  v_mfma_f32_16x16x32_bf16 v[164:167], v[132:135], v[76:79], v[164:167]
  v_mfma_f32_16x16x32_bf16 v[176:179], v[136:139], v[64:67], v[176:179]
  v_mfma_f32_16x16x32_bf16 v[176:179], v[140:143], v[68:71], v[176:179]
  ds_read_b128 v[84:87], v12 offset:12288
  v_mfma_f32_16x16x32_bf16 v[180:183], v[136:139], v[72:75], v[180:183]
  v_mfma_f32_16x16x32_bf16 v[180:183], v[140:143], v[76:79], v[180:183]
  s_waitcnt lgkmcnt(9)
  v_mfma_f32_16x16x32_bf16 v[192:195], v[144:147], v[64:67], v[192:195]
  ds_read_b128 v[80:83], v11 offset:12288
  s_waitcnt lgkmcnt(8)
  v_mfma_f32_16x16x32_bf16 v[192:195], v[148:151], v[68:71], v[192:195]
  v_mfma_f32_16x16x32_bf16 v[196:199], v[144:147], v[72:75], v[196:199]
  v_mfma_f32_16x16x32_bf16 v[196:199], v[148:151], v[76:79], v[196:199]
  s_waitcnt lgkmcnt(6)
  v_mfma_f32_16x16x32_bf16 v[208:211], v[152:155], v[64:67], v[208:211]
  s_waitcnt lgkmcnt(4)
  v_mfma_f32_16x16x32_bf16 v[208:211], v[156:159], v[68:71], v[208:211]
  v_mfma_f32_16x16x32_bf16 v[212:215], v[152:155], v[72:75], v[212:215]
  v_mfma_f32_16x16x32_bf16 v[212:215], v[156:159], v[76:79], v[212:215]
  s_waitcnt lgkmcnt(0)
  v_mfma_f32_16x16x32_bf16 v[168:171], v[128:131], v[80:83], v[168:171]
  s_waitcnt vmcnt(7)
  v_lshlrev_b32 v112, 16, v224
  v_and_b32 v113, 0xffff0000, v224
  v_mfma_f32_16x16x32_bf16 v[168:171], v[132:135], v[84:87], v[168:171]
  s_waitcnt vmcnt(3)
  v_lshlrev_b32 v96, 16, v232
  v_and_b32 v97, 0xffff0000, v232
  v_mfma_f32_16x16x32_bf16 v[172:175], v[128:131], v[88:91], v[172:175]
  v_lshlrev_b32 v114, 16, v225
  v_and_b32 v115, 0xffff0000, v225
  v_mfma_f32_16x16x32_bf16 v[172:175], v[132:135], v[92:95], v[172:175]
  v_lshlrev_b32 v98, 16, v233
  v_and_b32 v99, 0xffff0000, v233
  v_mfma_f32_16x16x32_bf16 v[184:187], v[136:139], v[80:83], v[184:187]
  v_lshlrev_b32 v116, 16, v226
  v_and_b32 v117, 0xffff0000, v226
  v_mfma_f32_16x16x32_bf16 v[184:187], v[140:143], v[84:87], v[184:187]
  s_waitcnt vmcnt(2)
  v_lshlrev_b32 v100, 16, v234
  v_and_b32 v101, 0xffff0000, v234
  v_mfma_f32_16x16x32_bf16 v[188:191], v[136:139], v[88:91], v[188:191]
  v_lshlrev_b32 v118, 16, v227
  v_and_b32 v119, 0xffff0000, v227
  v_mfma_f32_16x16x32_bf16 v[188:191], v[140:143], v[92:95], v[188:191]
  v_lshlrev_b32 v102, 16, v235
  v_and_b32 v103, 0xffff0000, v235
  v_mfma_f32_16x16x32_bf16 v[200:203], v[144:147], v[80:83], v[200:203]
  v_lshlrev_b32 v120, 16, v228
  v_and_b32 v121, 0xffff0000, v228
  v_mfma_f32_16x16x32_bf16 v[200:203], v[148:151], v[84:87], v[200:203]
  s_waitcnt vmcnt(1)
  v_lshlrev_b32 v104, 16, v236
  v_and_b32 v105, 0xffff0000, v236
  v_mfma_f32_16x16x32_bf16 v[204:207], v[144:147], v[88:91], v[204:207]
  v_lshlrev_b32 v122, 16, v229
  v_and_b32 v123, 0xffff0000, v229
  v_mfma_f32_16x16x32_bf16 v[204:207], v[148:151], v[92:95], v[204:207]
  v_lshlrev_b32 v106, 16, v237
  v_and_b32 v107, 0xffff0000, v237
  v_mfma_f32_16x16x32_bf16 v[216:219], v[152:155], v[80:83], v[216:219]
  v_lshlrev_b32 v124, 16, v230
  v_and_b32 v125, 0xffff0000, v230
  v_mfma_f32_16x16x32_bf16 v[216:219], v[156:159], v[84:87], v[216:219]
  s_waitcnt vmcnt(0)
  v_lshlrev_b32 v108, 16, v238
  v_and_b32 v109, 0xffff0000, v238
  v_mfma_f32_16x16x32_bf16 v[220:223], v[152:155], v[88:91], v[220:223]
  v_lshlrev_b32 v126, 16, v231
  v_and_b32 v127, 0xffff0000, v231
  v_mfma_f32_16x16x32_bf16 v[220:223], v[156:159], v[92:95], v[220:223]
  v_lshlrev_b32 v110, 16, v239
  v_and_b32 v111, 0xffff0000, v239
  s_mov_b32 s60, s24
  s_and_b32 s61, s25, 0xffff
  s_mov_b32 s62, 268435456
  s_mov_b32 s63, 0x20000
  s_mov_b32 s64, s22
  s_and_b32 s65, s23, 0xffff
  s_mov_b32 s66, 256
  s_mov_b32 s67, 0x20000
  v_lshlrev_b32 v4, 2, v0
  s_mov_b64 exec, 0xff
  s_mov_b32 s81, 0x80000
  buffer_load_dword v255, v4, s[60:63], s81 offen
  buffer_load_dword v5, v4, s[64:67], 0 offen offset:128 sc1
  s_mov_b64 exec, -1
  v_mov_b32 v4, 0
  s_mov_b32 s56, s20
  s_and_b32 s57, s21, 0xffff
  s_mov_b32 s58, 8192
  s_mov_b32 s59, 0x20000
  s_load_dword s80, s[18:19], 0
  buffer_load_dword v255, v4, s[56:59], 0 offen
  s_and_b32 s70, s2, 7
  s_lshl_b32 s68, s70, 14
  s_lshl_b32 s69, s3, 8
  s_add_u32 s68, s68, s69
  s_add_u32 s69, s68, 4096
  s_add_u32 s71, s68, 8192
  s_lshl_b32 s70, s70, 3
  s_add_u32 s70, s70, s3
  s_lshl_b32 s70, s70, 7
  v_lshlrev_b32 v3, 2, v0
  v_lshlrev_b32 v2, 1, v0
  s_waitcnt lgkmcnt(0)
  s_lshl_b32 s80, s80, 16
  s_lshl_b32 s81, s3, 6
  v_add_u32 v1, s81, v0
  v_cmp_lt_u32 vcc, 503, v1
  v_add_u32 v1, 4096, v3
  v_mov_b32 v6, 0x7f000000
  v_cndmask_b32 v1, v6, v1, vcc
  v_rcp_f32 v96, v96
  v_rcp_f32 v97, v97
  v_rcp_f32 v98, v98
  v_rcp_f32 v99, v99
  v_rcp_f32 v100, v100
  v_rcp_f32 v101, v101
  v_rcp_f32 v102, v102
  v_rcp_f32 v103, v103
  v_rcp_f32 v104, v104
  v_rcp_f32 v105, v105
  v_rcp_f32 v106, v106
  v_rcp_f32 v107, v107
  v_rcp_f32 v108, v108
  v_rcp_f32 v109, v109
  v_rcp_f32 v110, v110
  v_rcp_f32 v111, v111
  v_med3_f32 v96, v96, -v244, v244
  v_med3_f32 v97, v97, -v244, v244
  v_med3_f32 v98, v98, -v244, v244
  v_med3_f32 v99, v99, -v244, v244
  v_med3_f32 v100, v100, -v244, v244
  v_med3_f32 v101, v101, -v244, v244
  v_med3_f32 v102, v102, -v244, v244
  v_med3_f32 v103, v103, -v244, v244
  v_med3_f32 v104, v104, -v244, v244
  v_med3_f32 v105, v105, -v244, v244
  v_med3_f32 v106, v106, -v244, v244
  v_med3_f32 v107, v107, -v244, v244
  v_med3_f32 v108, v108, -v244, v244
  v_med3_f32 v109, v109, -v244, v244
  v_med3_f32 v110, v110, -v244, v244
  v_med3_f32 v111, v111, -v244, v244
  v_pk_add_f32 v[160:161], v[160:161], v[112:113]
  v_pk_add_f32 v[162:163], v[162:163], v[114:115]
  v_pk_add_f32 v[164:165], v[164:165], v[112:113]
  v_pk_add_f32 v[166:167], v[166:167], v[114:115]
  v_pk_add_f32 v[168:169], v[168:169], v[112:113]
  v_pk_add_f32 v[170:171], v[170:171], v[114:115]
  v_pk_add_f32 v[172:173], v[172:173], v[112:113]
  v_pk_add_f32 v[174:175], v[174:175], v[114:115]
  v_pk_add_f32 v[176:177], v[176:177], v[116:117]
  v_pk_add_f32 v[178:179], v[178:179], v[118:119]
  v_pk_add_f32 v[180:181], v[180:181], v[116:117]
  v_pk_add_f32 v[182:183], v[182:183], v[118:119]
  v_pk_add_f32 v[184:185], v[184:185], v[116:117]
  v_pk_add_f32 v[186:187], v[186:187], v[118:119]
  v_pk_add_f32 v[188:189], v[188:189], v[116:117]
  v_pk_add_f32 v[190:191], v[190:191], v[118:119]
  v_pk_add_f32 v[192:193], v[192:193], v[120:121]
  v_pk_add_f32 v[194:195], v[194:195], v[122:123]
  v_pk_add_f32 v[196:197], v[196:197], v[120:121]
  v_pk_add_f32 v[198:199], v[198:199], v[122:123]
  v_pk_add_f32 v[200:201], v[200:201], v[120:121]
  v_pk_add_f32 v[202:203], v[202:203], v[122:123]
  v_pk_add_f32 v[204:205], v[204:205], v[120:121]
  v_pk_add_f32 v[206:207], v[206:207], v[122:123]
  v_pk_add_f32 v[208:209], v[208:209], v[124:125]
  v_pk_add_f32 v[210:211], v[210:211], v[126:127]
  v_pk_add_f32 v[212:213], v[212:213], v[124:125]
  v_pk_add_f32 v[214:215], v[214:215], v[126:127]
  v_pk_add_f32 v[216:217], v[216:217], v[124:125]
  v_pk_add_f32 v[218:219], v[218:219], v[126:127]
  v_pk_add_f32 v[220:221], v[220:221], v[124:125]
  v_pk_add_f32 v[222:223], v[222:223], v[126:127]
  v_pk_mul_f32 v[64:65], v[160:161], v[160:161]
  v_pk_mul_f32 v[68:69], v[164:165], v[164:165]
  v_pk_mul_f32 v[72:73], v[168:169], v[168:169]
  v_pk_mul_f32 v[76:77], v[172:173], v[172:173]
  v_pk_fma_f32 v[64:65], v[64:65], v[242:243], v[240:241]
  v_pk_fma_f32 v[68:69], v[68:69], v[242:243], v[240:241]
  v_pk_fma_f32 v[72:73], v[72:73], v[242:243], v[240:241]
  v_pk_fma_f32 v[76:77], v[76:77], v[242:243], v[240:241]
  v_pk_mul_f32 v[64:65], v[64:65], v[160:161]
  v_pk_mul_f32 v[68:69], v[68:69], v[164:165]
  v_pk_mul_f32 v[72:73], v[72:73], v[168:169]
  v_pk_mul_f32 v[76:77], v[76:77], v[172:173]
  v_exp_f32 v64, v64
  v_exp_f32 v65, v65
  v_exp_f32 v68, v68
  v_exp_f32 v69, v69
  v_exp_f32 v72, v72
  v_exp_f32 v73, v73
  v_exp_f32 v76, v76
  v_exp_f32 v77, v77
  v_pk_fma_f32 v[64:65], v[64:65], v[96:97], v[96:97]
  v_pk_fma_f32 v[68:69], v[68:69], v[96:97], v[96:97]
  v_pk_fma_f32 v[72:73], v[72:73], v[96:97], v[96:97]
  v_pk_fma_f32 v[76:77], v[76:77], v[96:97], v[96:97]
  v_rcp_f32 v64, v64
  v_rcp_f32 v65, v65
  v_rcp_f32 v68, v68
  v_rcp_f32 v69, v69
  v_rcp_f32 v72, v72
  v_rcp_f32 v73, v73
  v_rcp_f32 v76, v76
  v_rcp_f32 v77, v77
  v_pk_mul_f32 v[16:17], v[64:65], v[160:161]
  v_pk_mul_f32 v[18:19], v[68:69], v[164:165]
  v_pk_mul_f32 v[20:21], v[72:73], v[168:169]
  v_pk_mul_f32 v[22:23], v[76:77], v[172:173]
  v_pk_mul_f32 v[80:81], v[162:163], v[162:163]
  v_pk_mul_f32 v[84:85], v[166:167], v[166:167]
  v_pk_mul_f32 v[88:89], v[170:171], v[170:171]
  v_pk_mul_f32 v[92:93], v[174:175], v[174:175]
  v_pk_fma_f32 v[80:81], v[80:81], v[242:243], v[240:241]
  v_pk_fma_f32 v[84:85], v[84:85], v[242:243], v[240:241]
  v_pk_fma_f32 v[88:89], v[88:89], v[242:243], v[240:241]
  v_pk_fma_f32 v[92:93], v[92:93], v[242:243], v[240:241]
  v_pk_mul_f32 v[80:81], v[80:81], v[162:163]
  v_pk_mul_f32 v[84:85], v[84:85], v[166:167]
  v_pk_mul_f32 v[88:89], v[88:89], v[170:171]
  v_pk_mul_f32 v[92:93], v[92:93], v[174:175]
  v_exp_f32 v80, v80
  v_exp_f32 v81, v81
  v_exp_f32 v84, v84
  v_exp_f32 v85, v85
  v_exp_f32 v88, v88
  v_exp_f32 v89, v89
  v_exp_f32 v92, v92
  v_exp_f32 v93, v93
  v_pk_fma_f32 v[80:81], v[80:81], v[98:99], v[98:99]
  v_pk_fma_f32 v[84:85], v[84:85], v[98:99], v[98:99]
  v_pk_fma_f32 v[88:89], v[88:89], v[98:99], v[98:99]
  v_pk_fma_f32 v[92:93], v[92:93], v[98:99], v[98:99]
  v_rcp_f32 v80, v80
  v_rcp_f32 v81, v81
  v_rcp_f32 v84, v84
  v_rcp_f32 v85, v85
  v_rcp_f32 v88, v88
  v_rcp_f32 v89, v89
  v_rcp_f32 v92, v92
  v_rcp_f32 v93, v93
  v_pk_fma_f32 v[16:17], v[80:81], v[162:163], v[16:17]
  v_pk_fma_f32 v[18:19], v[84:85], v[166:167], v[18:19]
  v_pk_fma_f32 v[20:21], v[88:89], v[170:171], v[20:21]
  v_pk_fma_f32 v[22:23], v[92:93], v[174:175], v[22:23]
  v_pk_mul_f32 v[64:65], v[176:177], v[176:177]
  v_pk_mul_f32 v[68:69], v[180:181], v[180:181]
  v_pk_mul_f32 v[72:73], v[184:185], v[184:185]
  v_pk_mul_f32 v[76:77], v[188:189], v[188:189]
  v_pk_fma_f32 v[64:65], v[64:65], v[242:243], v[240:241]
  v_pk_fma_f32 v[68:69], v[68:69], v[242:243], v[240:241]
  v_pk_fma_f32 v[72:73], v[72:73], v[242:243], v[240:241]
  v_pk_fma_f32 v[76:77], v[76:77], v[242:243], v[240:241]
  v_pk_mul_f32 v[64:65], v[64:65], v[176:177]
  v_pk_mul_f32 v[68:69], v[68:69], v[180:181]
  v_pk_mul_f32 v[72:73], v[72:73], v[184:185]
  v_pk_mul_f32 v[76:77], v[76:77], v[188:189]
  v_exp_f32 v64, v64
  v_exp_f32 v65, v65
  v_exp_f32 v68, v68
  v_exp_f32 v69, v69
  v_exp_f32 v72, v72
  v_exp_f32 v73, v73
  v_exp_f32 v76, v76
  v_exp_f32 v77, v77
  v_pk_fma_f32 v[64:65], v[64:65], v[100:101], v[100:101]
  v_pk_fma_f32 v[68:69], v[68:69], v[100:101], v[100:101]
  v_pk_fma_f32 v[72:73], v[72:73], v[100:101], v[100:101]
  v_pk_fma_f32 v[76:77], v[76:77], v[100:101], v[100:101]
  v_rcp_f32 v64, v64
  v_rcp_f32 v65, v65
  v_rcp_f32 v68, v68
  v_rcp_f32 v69, v69
  v_rcp_f32 v72, v72
  v_rcp_f32 v73, v73
  v_rcp_f32 v76, v76
  v_rcp_f32 v77, v77
  v_pk_fma_f32 v[16:17], v[64:65], v[176:177], v[16:17]
  v_pk_fma_f32 v[18:19], v[68:69], v[180:181], v[18:19]
  v_pk_fma_f32 v[20:21], v[72:73], v[184:185], v[20:21]
  v_pk_fma_f32 v[22:23], v[76:77], v[188:189], v[22:23]
  v_pk_mul_f32 v[80:81], v[178:179], v[178:179]
  v_pk_mul_f32 v[84:85], v[182:183], v[182:183]
  v_pk_mul_f32 v[88:89], v[186:187], v[186:187]
  v_pk_mul_f32 v[92:93], v[190:191], v[190:191]
  v_pk_fma_f32 v[80:81], v[80:81], v[242:243], v[240:241]
  v_pk_fma_f32 v[84:85], v[84:85], v[242:243], v[240:241]
  v_pk_fma_f32 v[88:89], v[88:89], v[242:243], v[240:241]
  v_pk_fma_f32 v[92:93], v[92:93], v[242:243], v[240:241]
  v_pk_mul_f32 v[80:81], v[80:81], v[178:179]
  v_pk_mul_f32 v[84:85], v[84:85], v[182:183]
  v_pk_mul_f32 v[88:89], v[88:89], v[186:187]
  v_pk_mul_f32 v[92:93], v[92:93], v[190:191]
  v_exp_f32 v80, v80
  v_exp_f32 v81, v81
  v_exp_f32 v84, v84
  v_exp_f32 v85, v85
  v_exp_f32 v88, v88
  v_exp_f32 v89, v89
  v_exp_f32 v92, v92
  v_exp_f32 v93, v93
  v_pk_fma_f32 v[80:81], v[80:81], v[102:103], v[102:103]
  v_pk_fma_f32 v[84:85], v[84:85], v[102:103], v[102:103]
  v_pk_fma_f32 v[88:89], v[88:89], v[102:103], v[102:103]
  v_pk_fma_f32 v[92:93], v[92:93], v[102:103], v[102:103]
  v_rcp_f32 v80, v80
  v_rcp_f32 v81, v81
  v_rcp_f32 v84, v84
  v_rcp_f32 v85, v85
  v_rcp_f32 v88, v88
  v_rcp_f32 v89, v89
  v_rcp_f32 v92, v92
  v_rcp_f32 v93, v93
  v_pk_fma_f32 v[16:17], v[80:81], v[178:179], v[16:17]
  v_pk_fma_f32 v[18:19], v[84:85], v[182:183], v[18:19]
  v_pk_fma_f32 v[20:21], v[88:89], v[186:187], v[20:21]
  v_pk_fma_f32 v[22:23], v[92:93], v[190:191], v[22:23]
  v_pk_mul_f32 v[64:65], v[192:193], v[192:193]
  v_pk_mul_f32 v[68:69], v[196:197], v[196:197]
  v_pk_mul_f32 v[72:73], v[200:201], v[200:201]
  v_pk_mul_f32 v[76:77], v[204:205], v[204:205]
  v_pk_fma_f32 v[64:65], v[64:65], v[242:243], v[240:241]
  v_pk_fma_f32 v[68:69], v[68:69], v[242:243], v[240:241]
  v_pk_fma_f32 v[72:73], v[72:73], v[242:243], v[240:241]
  v_pk_fma_f32 v[76:77], v[76:77], v[242:243], v[240:241]
  v_pk_mul_f32 v[64:65], v[64:65], v[192:193]
  v_pk_mul_f32 v[68:69], v[68:69], v[196:197]
  v_pk_mul_f32 v[72:73], v[72:73], v[200:201]
  v_pk_mul_f32 v[76:77], v[76:77], v[204:205]
  v_exp_f32 v64, v64
  v_exp_f32 v65, v65
  v_exp_f32 v68, v68
  v_exp_f32 v69, v69
  v_exp_f32 v72, v72
  v_exp_f32 v73, v73
  v_exp_f32 v76, v76
  v_exp_f32 v77, v77
  v_pk_fma_f32 v[64:65], v[64:65], v[104:105], v[104:105]
  v_pk_fma_f32 v[68:69], v[68:69], v[104:105], v[104:105]
  v_pk_fma_f32 v[72:73], v[72:73], v[104:105], v[104:105]
  v_pk_fma_f32 v[76:77], v[76:77], v[104:105], v[104:105]
  v_rcp_f32 v64, v64
  v_rcp_f32 v65, v65
  v_rcp_f32 v68, v68
  v_rcp_f32 v69, v69
  v_rcp_f32 v72, v72
  v_rcp_f32 v73, v73
  v_rcp_f32 v76, v76
  v_rcp_f32 v77, v77
  v_pk_fma_f32 v[16:17], v[64:65], v[192:193], v[16:17]
  v_pk_fma_f32 v[18:19], v[68:69], v[196:197], v[18:19]
  v_pk_fma_f32 v[20:21], v[72:73], v[200:201], v[20:21]
  v_pk_fma_f32 v[22:23], v[76:77], v[204:205], v[22:23]
  v_pk_mul_f32 v[80:81], v[194:195], v[194:195]
  v_pk_mul_f32 v[84:85], v[198:199], v[198:199]
  v_pk_mul_f32 v[88:89], v[202:203], v[202:203]
  v_pk_mul_f32 v[92:93], v[206:207], v[206:207]
  v_pk_fma_f32 v[80:81], v[80:81], v[242:243], v[240:241]
  v_pk_fma_f32 v[84:85], v[84:85], v[242:243], v[240:241]
  v_pk_fma_f32 v[88:89], v[88:89], v[242:243], v[240:241]
  v_pk_fma_f32 v[92:93], v[92:93], v[242:243], v[240:241]
  v_pk_mul_f32 v[80:81], v[80:81], v[194:195]
  v_pk_mul_f32 v[84:85], v[84:85], v[198:199]
  v_pk_mul_f32 v[88:89], v[88:89], v[202:203]
  v_pk_mul_f32 v[92:93], v[92:93], v[206:207]
  v_exp_f32 v80, v80
  v_exp_f32 v81, v81
  v_exp_f32 v84, v84
  v_exp_f32 v85, v85
  v_exp_f32 v88, v88
  v_exp_f32 v89, v89
  v_exp_f32 v92, v92
  v_exp_f32 v93, v93
  v_pk_fma_f32 v[80:81], v[80:81], v[106:107], v[106:107]
  v_pk_fma_f32 v[84:85], v[84:85], v[106:107], v[106:107]
  v_pk_fma_f32 v[88:89], v[88:89], v[106:107], v[106:107]
  v_pk_fma_f32 v[92:93], v[92:93], v[106:107], v[106:107]
  v_rcp_f32 v80, v80
  v_rcp_f32 v81, v81
  v_rcp_f32 v84, v84
  v_rcp_f32 v85, v85
  v_rcp_f32 v88, v88
  v_rcp_f32 v89, v89
  v_rcp_f32 v92, v92
  v_rcp_f32 v93, v93
  v_pk_fma_f32 v[16:17], v[80:81], v[194:195], v[16:17]
  v_pk_fma_f32 v[18:19], v[84:85], v[198:199], v[18:19]
  v_pk_fma_f32 v[20:21], v[88:89], v[202:203], v[20:21]
  v_pk_fma_f32 v[22:23], v[92:93], v[206:207], v[22:23]
  v_pk_mul_f32 v[64:65], v[208:209], v[208:209]
  v_pk_mul_f32 v[68:69], v[212:213], v[212:213]
  v_pk_mul_f32 v[72:73], v[216:217], v[216:217]
  v_pk_mul_f32 v[76:77], v[220:221], v[220:221]
  v_pk_fma_f32 v[64:65], v[64:65], v[242:243], v[240:241]
  v_pk_fma_f32 v[68:69], v[68:69], v[242:243], v[240:241]
  v_pk_fma_f32 v[72:73], v[72:73], v[242:243], v[240:241]
  v_pk_fma_f32 v[76:77], v[76:77], v[242:243], v[240:241]
  v_pk_mul_f32 v[64:65], v[64:65], v[208:209]
  v_pk_mul_f32 v[68:69], v[68:69], v[212:213]
  v_pk_mul_f32 v[72:73], v[72:73], v[216:217]
  v_pk_mul_f32 v[76:77], v[76:77], v[220:221]
  v_exp_f32 v64, v64
  v_exp_f32 v65, v65
  v_exp_f32 v68, v68
  v_exp_f32 v69, v69
  v_exp_f32 v72, v72
  v_exp_f32 v73, v73
  v_exp_f32 v76, v76
  v_exp_f32 v77, v77
  v_pk_fma_f32 v[64:65], v[64:65], v[108:109], v[108:109]
  v_pk_fma_f32 v[68:69], v[68:69], v[108:109], v[108:109]
  v_pk_fma_f32 v[72:73], v[72:73], v[108:109], v[108:109]
  v_pk_fma_f32 v[76:77], v[76:77], v[108:109], v[108:109]
  v_rcp_f32 v64, v64
  v_rcp_f32 v65, v65
  v_rcp_f32 v68, v68
  v_rcp_f32 v69, v69
  v_rcp_f32 v72, v72
  v_rcp_f32 v73, v73
  v_rcp_f32 v76, v76
  v_rcp_f32 v77, v77
  v_pk_fma_f32 v[16:17], v[64:65], v[208:209], v[16:17]
  v_pk_fma_f32 v[18:19], v[68:69], v[212:213], v[18:19]
  v_pk_fma_f32 v[20:21], v[72:73], v[216:217], v[20:21]
  v_pk_fma_f32 v[22:23], v[76:77], v[220:221], v[22:23]
  v_pk_mul_f32 v[80:81], v[210:211], v[210:211]
  v_pk_mul_f32 v[84:85], v[214:215], v[214:215]
  v_pk_mul_f32 v[88:89], v[218:219], v[218:219]
  v_pk_mul_f32 v[92:93], v[222:223], v[222:223]
  v_pk_fma_f32 v[80:81], v[80:81], v[242:243], v[240:241]
  v_pk_fma_f32 v[84:85], v[84:85], v[242:243], v[240:241]
  v_pk_fma_f32 v[88:89], v[88:89], v[242:243], v[240:241]
  v_pk_fma_f32 v[92:93], v[92:93], v[242:243], v[240:241]
  v_pk_mul_f32 v[80:81], v[80:81], v[210:211]
  v_pk_mul_f32 v[84:85], v[84:85], v[214:215]
  v_pk_mul_f32 v[88:89], v[88:89], v[218:219]
  v_pk_mul_f32 v[92:93], v[92:93], v[222:223]
  v_exp_f32 v80, v80
  v_exp_f32 v81, v81
  v_exp_f32 v84, v84
  v_exp_f32 v85, v85
  v_exp_f32 v88, v88
  v_exp_f32 v89, v89
  v_exp_f32 v92, v92
  v_exp_f32 v93, v93
  v_pk_fma_f32 v[80:81], v[80:81], v[110:111], v[110:111]
  v_pk_fma_f32 v[84:85], v[84:85], v[110:111], v[110:111]
  v_pk_fma_f32 v[88:89], v[88:89], v[110:111], v[110:111]
  v_pk_fma_f32 v[92:93], v[92:93], v[110:111], v[110:111]
  v_rcp_f32 v80, v80
  v_rcp_f32 v81, v81
  v_rcp_f32 v84, v84
  v_rcp_f32 v85, v85
  v_rcp_f32 v88, v88
  v_rcp_f32 v89, v89
  v_rcp_f32 v92, v92
  v_rcp_f32 v93, v93
  v_pk_fma_f32 v[16:17], v[80:81], v[210:211], v[16:17]
  v_pk_fma_f32 v[18:19], v[84:85], v[214:215], v[18:19]
  v_pk_fma_f32 v[20:21], v[88:89], v[218:219], v[20:21]
  v_pk_fma_f32 v[22:23], v[92:93], v[222:223], v[22:23]
  v_add_f32 v16, v16, v17
  v_add_f32 v18, v18, v19
  v_add_f32 v20, v20, v21
  v_add_f32 v22, v22, v23
  s_nop 0
  v_permlane32_swap_b32 v16, v20
  v_permlane32_swap_b32 v18, v22
  v_add_f32 v16, v16, v20
  v_add_f32 v18, v18, v22
  s_nop 1
  v_permlane16_swap_b32 v16, v18
  v_add_f32 v16, v16, v18
  v_add_f32 v16, s80, v16
  s_waitcnt vmcnt(1)
  v_cmp_eq_u32 vcc, 0, v5
  s_nop 0
  s_and_b32 vcc_lo, vcc_lo, 0xff
  s_cbranch_scc0 L_rclr_ok
  s_mov_b32 s78, 0x40000
L_rclr:
  s_sub_u32 s78, s78, 1
  s_cbranch_scc1 L_rclr_ok
  v_lshlrev_b32 v5, 2, v0
  v_and_b32 v5, 31, v5
  buffer_load_dword v5, v5, s[64:67], 0 offen offset:128 sc1
  s_waitcnt vmcnt(0)
  v_cmp_eq_u32 vcc, 0, v5
  s_nop 0
  s_and_b32 vcc_lo, vcc_lo, 0xff
  s_cbranch_scc1 L_rclr
L_rclr_ok:
  s_mov_b32 s72, 0x40000
L_poll:
  s_sub_u32 s72, s72, 1
  s_cbranch_scc1 L_pollx
  buffer_load_dword v64, v3, s[60:63], s68 offen offset:0 sc1
  buffer_load_dword v65, v3, s[60:63], s68 offen offset:2048 sc1
  buffer_load_dword v66, v3, s[60:63], s69 offen offset:0 sc1
  buffer_load_dword v67, v3, s[60:63], s69 offen offset:2048 sc1
  buffer_load_dword v68, v3, s[60:63], s71 offen offset:0 sc1
  buffer_load_dword v69, v3, s[60:63], s71 offen offset:2048 sc1
  buffer_load_dword v70, v1, s[60:63], s71 offen sc1
  s_waitcnt vmcnt(4)
  v_max3_u32 v72, v64, v65, v66
  s_waitcnt vmcnt(1)
  v_max3_u32 v73, v67, v68, v69
  s_waitcnt vmcnt(0)
  v_max3_u32 v72, v72, v73, v70
  v_cmp_eq_u32 vcc, -1, v72
  s_cbranch_vccnz L_poll
L_pollx:
  v_add_f32 v64, v64, v65
  v_add_f32 v66, v66, v67
  v_add_f32 v68, v68, v69
  v_add_f32 v16, v16, v70
  v_add_f32 v64, v64, v66
  v_add_f32 v68, v68, v16
  v_add_f32 v64, v64, v68
  v_cvt_pk_bf16_f32 v64, v64, v64
  buffer_store_short v64, v2, s[56:59], s70 offen
  s_endpgm
L_end:
  s_endpgm
.section .rodata,"a"
.p2align 6
.amdhsa_kernel standalone__deep_cross_xdeepfm__recsys_kernel
  .amdhsa_next_free_vgpr 256
  .amdhsa_next_free_sgpr 102
  .amdhsa_accum_offset 256
  .amdhsa_group_segment_fixed_size 0
  .amdhsa_kernarg_size 88
  .amdhsa_user_sgpr_count 2
  .amdhsa_user_sgpr_kernarg_segment_ptr 1
  .amdhsa_system_sgpr_workgroup_id_x 1
  .amdhsa_float_denorm_mode_32 3
.end_amdhsa_kernel
```

```asm
; @launch grid=(256,1,1) block=(512,1,1) lds=163840
.amdgcn_target "amdgcn-amd-amdhsa--gfx950"
.text
.globl standalone__deep_cross_xdeepfm__recsys_kernel
.p2align 8
.type standalone__deep_cross_xdeepfm__recsys_kernel,@function
standalone__deep_cross_xdeepfm__recsys_kernel:
  s_cmp_ge_u32 s2, 256
  s_cbranch_scc1 L_end
  s_load_dwordx16 s[4:19], s[0:1], 0
  s_load_dwordx4 s[20:23], s[0:1], 64
  s_load_dwordx2 s[24:25], s[0:1], 80
  v_lshrrev_b32 v1, 6, v0
  s_getpc_b64 s[92:93]
L_pc:
  s_and_b32 s68, s2, 0xf8
  v_add_u32 v2, s68, v1
  v_lshlrev_b32 v2, 7, v2
  v_and_b32 v3, 1, v0
  v_lshl_add_u32 v2, v3, 15, v2
  v_min_u32 v2, L_end-L_pc, v2
  v_mov_b32 v3, s93
  v_add_co_u32 v2, vcc, s92, v2
  s_nop 1
  v_addc_co_u32 v3, vcc, 0, v3, vcc
  global_load_dword v255, v[2:3], off
  v_and_b32 v0, 63, v0
  v_readfirstlane_b32 s3, v1
  s_and_b32 s68, s2, 7
  s_lshl_b32 s68, s68, 2
  s_lshr_b32 s26, s2, 6
  s_add_u32 s26, s26, s68
  s_bfe_u32 s27, s2, 0x30003
  s_and_b32 s80, s2, 0xf8
  s_add_u32 s80, s80, s3
  s_lshl_b32 s80, s80, 21
  s_cmp_ge_u32 s27, 5
  s_cbranch_scc1 L_cin
  s_mul_i32 s77, s27, 640
  s_mul_i32 s70, s3, 7
  v_min_u32 v64, 6, v0
  v_add_u32 v64, s70, v64
  v_min_u32 v64, 51, v64
  v_lshrrev_b32 v62, 1, v64
  v_mul_u32_u24 v62, 96, v62
  v_lshl_add_u32 v64, v64, 2, v62
  s_mul_i32 s78, s27, 26
  s_min_u32 s78, s78, 102
  s_lshl_b32 s71, s26, 7
  s_add_u32 s78, s78, s71
  s_mul_i32 s78, s78, 104
  s_and_b32 s70, s26, 3
  s_lshl_b32 s70, s70, 3
  s_add_u32 s70, s70, s3
  s_mul_i32 s70, s70, 3328
  s_add_u32 s81, s70, s77
  v_min_u32 v56, 15, v0
  v_lshrrev_b32 v62, 3, v56
  s_mov_b32 s70, 106496
  v_mul_u32_u24 v62, s70, v62
  v_and_b32 v56, 7, v56
  v_min_u32 v56, 4, v56
  v_lshl_add_u32 v56, v56, 7, v62
  s_xor_b32 s70, s3, 4
  s_lshl_b32 s70, s70, 4
  s_add_u32 s70, s70, s71
  v_lshrrev_b32 v60, 3, v0
  v_add_u32 v60, s70, v60
  v_mul_u32_u24 v13, 104, v60
  s_waitcnt lgkmcnt(0)
  s_mov_b32 s28, s4
  s_and_b32 s29, s5, 0xffff
  s_mov_b32 s30, 425984
  s_mov_b32 s31, 0x20000
  buffer_load_dwordx3 v[52:54], v64, s[28:31], s78 offen
  buffer_load_dwordx2 v[44:45], v13, s[28:31], 0 offen offset:0
  buffer_load_dwordx2 v[48:49], v13, s[28:31], 0 offen offset:832
  s_mov_b32 s32, s6
  s_and_b32 s33, s7, 0xffff
  s_mov_b32 s34, 12800000
  s_mov_b32 s35, 0x20000
  v_mov_b32 v68, s80
  buffer_load_dword v255, v68, s[32:35], 0 offen
  v_lshlrev_b32 v37, 4, v0
  s_mov_b32 s48, s14
  s_and_b32 s49, s15, 0xffff
  s_mov_b32 s50, 3328
  s_mov_b32 s51, 0x20000
  s_mov_b32 s44, s12
  s_and_b32 s45, s13, 0xffff
  s_mov_b32 s46, 5537792
  s_mov_b32 s47, 0x20000
  buffer_load_dword v255, v56, s[44:47], s81 offen
  s_mov_b32 m0, 155648
  s_mov_b32 exec_hi, 0xff
  buffer_load_dwordx4 v37, s[48:51], s77 offen lds
  s_mov_b64 exec, -1
  s_lshr_b32 s68, s3, 2
  s_and_b32 s69, s3, 3
  s_mov_b32 s70, 1639
  s_and_b32 s78, s69, 1
  s_lshl_b32 s78, s78, 2
  s_mov_b32 s81, 3328
  v_mov_b32 v60, v0
  v_mul_u32_u24 v61, s70, v60
  v_lshrrev_b32 v61, 16, v61
  v_mul_u32_u24 v64, 40, v61
  v_sub_u32 v64, v60, v64
  v_and_b32 v63, 2, v61
  v_or_b32 v63, s78, v63
  v_xor_b32 v64, v64, v63
  v_mul_u32_u24 v61, s81, v61
  v_lshl_add_u32 v29, v64, 4, v61
  v_add_u32 v60, 64, v60
  v_mul_u32_u24 v61, s70, v60
  v_lshrrev_b32 v61, 16, v61
  v_mul_u32_u24 v64, 40, v61
  v_sub_u32 v64, v60, v64
  v_and_b32 v63, 2, v61
  v_or_b32 v63, s78, v63
  v_xor_b32 v64, v64, v63
  v_mul_u32_u24 v61, s81, v61
  v_lshl_add_u32 v30, v64, 4, v61
  v_subrev_u32 v30, 1024, v30
  v_add_u32 v60, 64, v60
  v_mul_u32_u24 v61, s70, v60
  v_lshrrev_b32 v61, 16, v61
  v_mul_u32_u24 v64, 40, v61
  v_sub_u32 v64, v60, v64
  v_and_b32 v63, 2, v61
  v_or_b32 v63, s78, v63
  v_xor_b32 v64, v64, v63
  v_mul_u32_u24 v61, s81, v61
  v_lshl_add_u32 v31, v64, 4, v61
  v_subrev_u32 v31, 2048, v31
  v_add_u32 v60, 64, v60
  v_mul_u32_u24 v61, s70, v60
  v_lshrrev_b32 v61, 16, v61
  v_mul_u32_u24 v64, 40, v61
  v_sub_u32 v64, v60, v64
  v_and_b32 v63, 2, v61
  v_or_b32 v63, s78, v63
  v_xor_b32 v64, v64, v63
  v_mul_u32_u24 v61, s81, v61
  v_lshl_add_u32 v32, v64, 4, v61
  v_subrev_u32 v32, 3072, v32
  v_add_u32 v60, 64, v60
  v_mul_u32_u24 v61, s70, v60
  v_lshrrev_b32 v61, 16, v61
  v_mul_u32_u24 v64, 40, v61
  v_sub_u32 v64, v60, v64
  v_and_b32 v63, 2, v61
  v_or_b32 v63, s78, v63
  v_xor_b32 v64, v64, v63
  v_mul_u32_u24 v61, s81, v61
  v_lshl_add_u32 v33, v64, 4, v61
  s_mul_i32 s70, s3, 26624
  s_add_u32 s74, s70, s77
  s_mul_i32 s75, s3, 5120
  s_add_u32 s75, s75, 32768
  s_lshl_b32 s71, s68, 14
  s_lshl_b32 s76, s69, 11
  s_add_u32 s76, s76, s71
  s_xor_b32 s76, s76, 16384
  v_and_b32 v64, 7, v0
  v_lshrrev_b32 v62, 4, v0
  v_xor_b32 v64, v64, v62
  v_lshlrev_b32 v14, 4, v64
  v_xor_b32 v15, 64, v14
  v_and_b32 v64, 15, v0
  v_lshlrev_b32 v64, 7, v64
  v_bfe_u32 v63, v0, 1, 3
  v_xor_b32 v63, v63, v62
  v_lshl_add_u32 v64, v63, 4, v64
  v_add_u32 v11, s71, v64
  v_xor_b32 v12, 64, v11
  s_mov_b32 s52, s16
  s_and_b32 s53, s17, 0xffff
  s_mov_b32 s54, 3328
  s_mov_b32 s55, 0x20000
  s_mul_i32 s71, s69, 5
  v_bfe_u32 v63, v0, 2, 2
  v_lshl_add_u32 v64, v62, 3, v63
  v_mul_u32_u24 v64, 640, v64
  v_and_b32 v63, 3, v0
  v_lshl_add_u32 v64, v63, 3, v64
  v_add_u32 v64, 32768, v64
  v_bfe_u32 v63, v0, 3, 2
  v_xor_b32 v60, s71, v63
  v_lshl_add_u32 v1, v60, 5, v64
  v_add_u32 v6, 61440, v1
  s_add_u32 s71, s71, 1
  v_xor_b32 v60, s71, v63
  v_lshl_add_u32 v2, v60, 5, v64
  v_add_u32 v7, 61440, v2
  s_add_u32 s71, s71, 1
  v_xor_b32 v60, s71, v63
  v_lshl_add_u32 v3, v60, 5, v64
  v_add_u32 v8, 61440, v3
  s_add_u32 s71, s71, 1
  v_xor_b32 v60, s71, v63
  v_lshl_add_u32 v4, v60, 5, v64
  v_add_u32 v9, 61440, v4
  s_add_u32 s71, s71, 1
  v_xor_b32 v60, s71, v63
  v_lshl_add_u32 v5, v60, 5, v64
  v_add_u32 v10, 61440, v5
  s_add_u32 s71, s71, 1
  s_mul_i32 s71, s69, 160
  s_add_u32 s71, s71, 155648
  v_lshlrev_b32 v64, 3, v62
  v_add_u32 v35, s71, v64
  s_lshl_b32 s70, s69, 1
  s_add_u32 s70, s70, s68
  s_lshl_b32 s70, s70, 8
  s_add_u32 s70, s70, 156928
  v_lshlrev_b32 v36, 2, v0
  v_add_u32 v36, s70, v36
  s_add_u32 m0, s75, 0
  s_nop 0
  buffer_load_dwordx4 v29, s[44:47], s74 offen offset:0 lds
  buffer_load_dwordx4 v30, s[44:47], s74 offen offset:1024 lds
  buffer_load_dwordx4 v31, s[44:47], s74 offen offset:2048 lds
  buffer_load_dwordx4 v32, s[44:47], s74 offen offset:3072 lds
  s_add_u32 m0, m0, 4096
  s_nop 0
  buffer_load_dwordx4 v33, s[44:47], s74 offen offset:0 lds
  s_add_u32 s74, s74, 212992
  s_waitcnt vmcnt(10)
  v_lshlrev_b32 v52, 7, v52
  s_barrier
  buffer_load_dword v255, v52, s[32:35], 0 offen
  s_waitcnt vmcnt(9)
  v_lshl_add_u32 v34, v48, 7, v15
  v_lshl_add_u32 v28, v44, 7, v14
  s_add_u32 m0, s76, 0
  s_nop 0
  buffer_load_dwordx4 v28, s[32:35], 0 offen lds
  s_add_u32 m0, m0, 1024
  s_nop 0
  buffer_load_dwordx4 v34, s[32:35], 0 offen lds
  v_lshlrev_b32 v54, 7, v54
  buffer_load_dword v255, v54, s[32:35], 0 offen
  s_barrier
  s_waitcnt vmcnt(9)
  ds_read_b64 v[220:221], v35 offset:0
  ds_read_b64 v[222:223], v35 offset:32
  ds_read_b64 v[224:225], v35 offset:64
  ds_read_b64 v[226:227], v35 offset:96
  ds_read_b64 v[228:229], v35 offset:128
  s_waitcnt lgkmcnt(4)
  v_lshlrev_b32 v140, 16, v220
  v_and_b32 v141, 0xffff0000, v220
  v_lshlrev_b32 v142, 16, v221
  v_and_b32 v143, 0xffff0000, v221
  s_waitcnt lgkmcnt(3)
  v_lshlrev_b32 v156, 16, v222
  v_and_b32 v157, 0xffff0000, v222
  v_lshlrev_b32 v158, 16, v223
  v_and_b32 v159, 0xffff0000, v223
  s_waitcnt lgkmcnt(2)
  v_lshlrev_b32 v172, 16, v224
  v_and_b32 v173, 0xffff0000, v224
  v_lshlrev_b32 v174, 16, v225
  v_and_b32 v175, 0xffff0000, v225
  s_waitcnt lgkmcnt(1)
  v_lshlrev_b32 v188, 16, v226
  v_and_b32 v189, 0xffff0000, v226
  v_lshlrev_b32 v190, 16, v227
  v_and_b32 v191, 0xffff0000, v227
  s_waitcnt lgkmcnt(0)
  v_lshlrev_b32 v204, 16, v228
  v_and_b32 v205, 0xffff0000, v228
  v_lshlrev_b32 v206, 16, v229
  v_and_b32 v207, 0xffff0000, v229
  v_mov_b64 v[144:145], v[140:141]
  v_mov_b64 v[146:147], v[142:143]
  v_mov_b64 v[148:149], v[140:141]
  v_mov_b64 v[150:151], v[142:143]
  v_mov_b64 v[152:153], v[140:141]
  v_mov_b64 v[154:155], v[142:143]
  v_mov_b64 v[160:161], v[156:157]
  v_mov_b64 v[162:163], v[158:159]
  v_mov_b64 v[164:165], v[156:157]
  v_mov_b64 v[166:167], v[158:159]
  v_mov_b64 v[168:169], v[156:157]
  v_mov_b64 v[170:171], v[158:159]
  v_mov_b64 v[176:177], v[172:173]
  v_mov_b64 v[178:179], v[174:175]
  v_mov_b64 v[180:181], v[172:173]
  v_mov_b64 v[182:183], v[174:175]
  v_mov_b64 v[184:185], v[172:173]
  v_mov_b64 v[186:187], v[174:175]
  v_mov_b64 v[192:193], v[188:189]
  v_mov_b64 v[194:195], v[190:191]
  v_mov_b64 v[196:197], v[188:189]
  v_mov_b64 v[198:199], v[190:191]
  v_mov_b64 v[200:201], v[188:189]
  v_mov_b64 v[202:203], v[190:191]
  v_mov_b64 v[208:209], v[204:205]
  v_mov_b64 v[210:211], v[206:207]
  v_mov_b64 v[212:213], v[204:205]
  v_mov_b64 v[214:215], v[206:207]
  v_mov_b64 v[216:217], v[204:205]
  v_mov_b64 v[218:219], v[206:207]
  s_lshl_b32 s73, s68, 2
  s_add_u32 s73, s73, 4
  buffer_load_dwordx3 v[16:18], v13, s[28:31], s73 offen offset:0
  buffer_load_dwordx3 v[20:22], v13, s[28:31], s73 offen offset:832
  s_add_u32 s73, s73, 12
  s_mov_b32 s72, 0
  s_cmp_lg_u32 s68, 0
  s_cbranch_scc1 L_dnn_h1
L_dnn_h0:
  s_add_u32 m0, s75, 40960
  s_nop 0
  buffer_load_dwordx4 v29, s[44:47], s74 offen offset:0 lds
  buffer_load_dwordx4 v30, s[44:47], s74 offen offset:1024 lds
  buffer_load_dwordx4 v31, s[44:47], s74 offen offset:2048 lds
  buffer_load_dwordx4 v32, s[44:47], s74 offen offset:3072 lds
  s_add_u32 m0, m0, 4096
  s_nop 0
  buffer_load_dwordx4 v33, s[44:47], s74 offen offset:0 lds
  s_add_u32 s74, s74, 212992
  s_waitcnt vmcnt(11) lgkmcnt(0)
  s_barrier
  buffer_load_dwordx3 v[24:26], v13, s[28:31], s73 offen offset:0
  buffer_load_dwordx3 v[240:242], v13, s[28:31], s73 offen offset:832
  s_add_u32 s73, s73, 12
L_dnn_loop0:
  ds_read_b64_tr_b16 v[40:41], v1 offset:0
  s_add_u32 m0, s75, 81920
  s_nop 0
  buffer_load_dwordx4 v29, s[44:47], s74 offen offset:0 lds
  ds_read_b64_tr_b16 v[42:43], v1 offset:2560
  ds_read_b64_tr_b16 v[44:45], v1 offset:20480
  ds_read_b64_tr_b16 v[46:47], v1 offset:23040
  ds_read_b64_tr_b16 v[48:49], v2 offset:0
  buffer_load_dwordx4 v30, s[44:47], s74 offen offset:1024 lds
  ds_read_b64_tr_b16 v[50:51], v2 offset:2560
  ds_read_b64_tr_b16 v[52:53], v2 offset:20480
  ds_read_b64_tr_b16 v[54:55], v2 offset:23040
  ds_read_b64_tr_b16 v[56:57], v3 offset:0
  buffer_load_dwordx4 v31, s[44:47], s74 offen offset:2048 lds
  ds_read_b64_tr_b16 v[58:59], v3 offset:2560
  ds_read_b64_tr_b16 v[60:61], v3 offset:20480
  ds_read_b64_tr_b16 v[62:63], v3 offset:23040
  ds_read_b64_tr_b16 v[64:65], v4 offset:0
  buffer_load_dwordx4 v32, s[44:47], s74 offen offset:3072 lds
  ds_read_b64_tr_b16 v[66:67], v4 offset:2560
  ds_read_b64_tr_b16 v[68:69], v4 offset:20480
  ds_read_b64_tr_b16 v[70:71], v4 offset:23040
  ds_read_b128 v[80:83], v11 offset:0
  s_add_u32 m0, m0, 4096
  s_nop 0
  buffer_load_dwordx4 v33, s[44:47], s74 offen offset:0 lds
  s_add_u32 s74, s74, 212992
  ds_read_b128 v[84:87], v12 offset:0
  ds_read_b128 v[88:91], v11 offset:2048
  ds_read_b128 v[92:95], v12 offset:2048
  ds_read_b128 v[96:99], v11 offset:4096
  s_waitcnt vmcnt(12)
  v_lshl_add_u32 v34, v20, 7, v15
  v_lshl_add_u32 v28, v16, 7, v14
  s_add_u32 m0, s76, 8192
  s_nop 0
  buffer_load_dwordx4 v28, s[32:35], 0 offen lds
  ds_read_b128 v[100:103], v12 offset:4096
  ds_read_b128 v[104:107], v11 offset:6144
  ds_read_b128 v[108:111], v12 offset:6144
  ds_read_b64_tr_b16 v[72:73], v5 offset:0
  s_add_u32 m0, m0, 1024
  s_nop 0
  buffer_load_dwordx4 v34, s[32:35], 0 offen lds
  ds_read_b64_tr_b16 v[74:75], v5 offset:2560
  ds_read_b64_tr_b16 v[76:77], v5 offset:20480
  ds_read_b64_tr_b16 v[78:79], v5 offset:23040
  s_waitcnt vmcnt(9) lgkmcnt(0)
  s_barrier
  s_setprio 0
  v_mfma_f32_16x16x32_bf16 v[140:143], v[40:43], v[80:83], v[140:143]
  v_mfma_f32_16x16x32_bf16 v[140:143], v[44:47], v[84:87], v[140:143]
  v_mfma_f32_16x16x32_bf16 v[144:147], v[40:43], v[88:91], v[144:147]
  v_mfma_f32_16x16x32_bf16 v[144:147], v[44:47], v[92:95], v[144:147]
  v_mfma_f32_16x16x32_bf16 v[148:151], v[40:43], v[96:99], v[148:151]
  v_mfma_f32_16x16x32_bf16 v[148:151], v[44:47], v[100:103], v[148:151]
  v_mfma_f32_16x16x32_bf16 v[152:155], v[40:43], v[104:107], v[152:155]
  v_mfma_f32_16x16x32_bf16 v[152:155], v[44:47], v[108:111], v[152:155]
  v_mfma_f32_16x16x32_bf16 v[168:171], v[48:51], v[104:107], v[168:171]
  v_mfma_f32_16x16x32_bf16 v[168:171], v[52:55], v[108:111], v[168:171]
  v_mfma_f32_16x16x32_bf16 v[164:167], v[48:51], v[96:99], v[164:167]
  v_mfma_f32_16x16x32_bf16 v[164:167], v[52:55], v[100:103], v[164:167]
  v_mfma_f32_16x16x32_bf16 v[160:163], v[48:51], v[88:91], v[160:163]
  v_mfma_f32_16x16x32_bf16 v[160:163], v[52:55], v[92:95], v[160:163]
  v_mfma_f32_16x16x32_bf16 v[156:159], v[48:51], v[80:83], v[156:159]
  v_mfma_f32_16x16x32_bf16 v[156:159], v[52:55], v[84:87], v[156:159]
  v_mfma_f32_16x16x32_bf16 v[172:175], v[56:59], v[80:83], v[172:175]
  v_mfma_f32_16x16x32_bf16 v[172:175], v[60:63], v[84:87], v[172:175]
  v_mfma_f32_16x16x32_bf16 v[176:179], v[56:59], v[88:91], v[176:179]
  v_mfma_f32_16x16x32_bf16 v[176:179], v[60:63], v[92:95], v[176:179]
  v_mfma_f32_16x16x32_bf16 v[180:183], v[56:59], v[96:99], v[180:183]
  v_mfma_f32_16x16x32_bf16 v[180:183], v[60:63], v[100:103], v[180:183]
  v_mfma_f32_16x16x32_bf16 v[184:187], v[56:59], v[104:107], v[184:187]
  v_mfma_f32_16x16x32_bf16 v[184:187], v[60:63], v[108:111], v[184:187]
  v_mfma_f32_16x16x32_bf16 v[200:203], v[64:67], v[104:107], v[200:203]
  v_mfma_f32_16x16x32_bf16 v[200:203], v[68:71], v[108:111], v[200:203]
  v_mfma_f32_16x16x32_bf16 v[196:199], v[64:67], v[96:99], v[196:199]
  v_mfma_f32_16x16x32_bf16 v[196:199], v[68:71], v[100:103], v[196:199]
  v_mfma_f32_16x16x32_bf16 v[192:195], v[64:67], v[88:91], v[192:195]
  v_mfma_f32_16x16x32_bf16 v[192:195], v[68:71], v[92:95], v[192:195]
  v_mfma_f32_16x16x32_bf16 v[188:191], v[64:67], v[80:83], v[188:191]
  v_mfma_f32_16x16x32_bf16 v[188:191], v[68:71], v[84:87], v[188:191]
  v_mfma_f32_16x16x32_bf16 v[204:207], v[72:75], v[80:83], v[204:207]
  v_mfma_f32_16x16x32_bf16 v[204:207], v[76:79], v[84:87], v[204:207]
  v_mfma_f32_16x16x32_bf16 v[208:211], v[72:75], v[88:91], v[208:211]
  v_mfma_f32_16x16x32_bf16 v[208:211], v[76:79], v[92:95], v[208:211]
  v_mfma_f32_16x16x32_bf16 v[212:215], v[72:75], v[96:99], v[212:215]
  v_mfma_f32_16x16x32_bf16 v[212:215], v[76:79], v[100:103], v[212:215]
  v_mfma_f32_16x16x32_bf16 v[216:219], v[72:75], v[104:107], v[216:219]
  s_setprio 2
  s_waitcnt vmcnt(9)
  s_barrier
  v_mfma_f32_16x16x32_bf16 v[216:219], v[76:79], v[108:111], v[216:219]
  ds_read_b64_tr_b16 v[40:41], v1 offset:40960
  s_add_u32 m0, s75, 0
  s_nop 0
  buffer_load_dwordx4 v29, s[44:47], s74 offen offset:0 lds
  ds_read_b64_tr_b16 v[42:43], v1 offset:43520
  ds_read_b64_tr_b16 v[44:45], v6 offset:0
  ds_read_b64_tr_b16 v[46:47], v6 offset:2560
  ds_read_b64_tr_b16 v[48:49], v2 offset:40960
  buffer_load_dwordx4 v30, s[44:47], s74 offen offset:1024 lds
  ds_read_b64_tr_b16 v[50:51], v2 offset:43520
  ds_read_b64_tr_b16 v[52:53], v7 offset:0
  ds_read_b64_tr_b16 v[54:55], v7 offset:2560
  ds_read_b64_tr_b16 v[56:57], v3 offset:40960
  buffer_load_dwordx4 v31, s[44:47], s74 offen offset:2048 lds
  ds_read_b64_tr_b16 v[58:59], v3 offset:43520
  ds_read_b64_tr_b16 v[60:61], v8 offset:0
  ds_read_b64_tr_b16 v[62:63], v8 offset:2560
  ds_read_b64_tr_b16 v[64:65], v4 offset:40960
  buffer_load_dwordx4 v32, s[44:47], s74 offen offset:3072 lds
  ds_read_b64_tr_b16 v[66:67], v4 offset:43520
  ds_read_b64_tr_b16 v[68:69], v9 offset:0
  ds_read_b64_tr_b16 v[70:71], v9 offset:2560
  ds_read_b128 v[80:83], v11 offset:8192
  s_add_u32 m0, m0, 4096
  s_nop 0
  buffer_load_dwordx4 v33, s[44:47], s74 offen offset:0 lds
  s_add_u32 s74, s74, 212992
  ds_read_b128 v[84:87], v12 offset:8192
  ds_read_b128 v[88:91], v11 offset:10240
  ds_read_b128 v[92:95], v12 offset:10240
  ds_read_b128 v[96:99], v11 offset:12288
  v_lshl_add_u32 v34, v21, 7, v15
  v_lshl_add_u32 v28, v17, 7, v14
  s_add_u32 m0, s76, 0
  s_nop 0
  buffer_load_dwordx4 v28, s[32:35], 0 offen lds
  ds_read_b128 v[100:103], v12 offset:12288
  ds_read_b128 v[104:107], v11 offset:14336
  ds_read_b128 v[108:111], v12 offset:14336
  ds_read_b64_tr_b16 v[72:73], v5 offset:40960
  s_add_u32 m0, m0, 1024
  s_nop 0
  buffer_load_dwordx4 v34, s[32:35], 0 offen lds
  ds_read_b64_tr_b16 v[74:75], v5 offset:43520
  ds_read_b64_tr_b16 v[76:77], v10 offset:0
  ds_read_b64_tr_b16 v[78:79], v10 offset:2560
  s_waitcnt vmcnt(7) lgkmcnt(0)
  s_barrier
  s_setprio 0
  v_mfma_f32_16x16x32_bf16 v[140:143], v[40:43], v[80:83], v[140:143]
  v_mfma_f32_16x16x32_bf16 v[140:143], v[44:47], v[84:87], v[140:143]
  v_mfma_f32_16x16x32_bf16 v[144:147], v[40:43], v[88:91], v[144:147]
  v_mfma_f32_16x16x32_bf16 v[144:147], v[44:47], v[92:95], v[144:147]
  v_mfma_f32_16x16x32_bf16 v[148:151], v[40:43], v[96:99], v[148:151]
  v_mfma_f32_16x16x32_bf16 v[148:151], v[44:47], v[100:103], v[148:151]
  v_mfma_f32_16x16x32_bf16 v[152:155], v[40:43], v[104:107], v[152:155]
  v_mfma_f32_16x16x32_bf16 v[152:155], v[44:47], v[108:111], v[152:155]
  v_mfma_f32_16x16x32_bf16 v[168:171], v[48:51], v[104:107], v[168:171]
  v_mfma_f32_16x16x32_bf16 v[168:171], v[52:55], v[108:111], v[168:171]
  v_mfma_f32_16x16x32_bf16 v[164:167], v[48:51], v[96:99], v[164:167]
  v_mfma_f32_16x16x32_bf16 v[164:167], v[52:55], v[100:103], v[164:167]
  v_mfma_f32_16x16x32_bf16 v[160:163], v[48:51], v[88:91], v[160:163]
  v_mfma_f32_16x16x32_bf16 v[160:163], v[52:55], v[92:95], v[160:163]
  v_mfma_f32_16x16x32_bf16 v[156:159], v[48:51], v[80:83], v[156:159]
  v_mfma_f32_16x16x32_bf16 v[156:159], v[52:55], v[84:87], v[156:159]
  v_mfma_f32_16x16x32_bf16 v[172:175], v[56:59], v[80:83], v[172:175]
  v_mfma_f32_16x16x32_bf16 v[172:175], v[60:63], v[84:87], v[172:175]
  v_mfma_f32_16x16x32_bf16 v[176:179], v[56:59], v[88:91], v[176:179]
  v_mfma_f32_16x16x32_bf16 v[176:179], v[60:63], v[92:95], v[176:179]
  v_mfma_f32_16x16x32_bf16 v[180:183], v[56:59], v[96:99], v[180:183]
  v_mfma_f32_16x16x32_bf16 v[180:183], v[60:63], v[100:103], v[180:183]
  v_mfma_f32_16x16x32_bf16 v[184:187], v[56:59], v[104:107], v[184:187]
  v_mfma_f32_16x16x32_bf16 v[184:187], v[60:63], v[108:111], v[184:187]
  v_mfma_f32_16x16x32_bf16 v[200:203], v[64:67], v[104:107], v[200:203]
  v_mfma_f32_16x16x32_bf16 v[200:203], v[68:71], v[108:111], v[200:203]
  v_mfma_f32_16x16x32_bf16 v[196:199], v[64:67], v[96:99], v[196:199]
  v_mfma_f32_16x16x32_bf16 v[196:199], v[68:71], v[100:103], v[196:199]
  v_mfma_f32_16x16x32_bf16 v[192:195], v[64:67], v[88:91], v[192:195]
  v_mfma_f32_16x16x32_bf16 v[192:195], v[68:71], v[92:95], v[192:195]
  v_mfma_f32_16x16x32_bf16 v[188:191], v[64:67], v[80:83], v[188:191]
  v_mfma_f32_16x16x32_bf16 v[188:191], v[68:71], v[84:87], v[188:191]
  v_mfma_f32_16x16x32_bf16 v[204:207], v[72:75], v[80:83], v[204:207]
  v_mfma_f32_16x16x32_bf16 v[204:207], v[76:79], v[84:87], v[204:207]
  v_mfma_f32_16x16x32_bf16 v[208:211], v[72:75], v[88:91], v[208:211]
  v_mfma_f32_16x16x32_bf16 v[208:211], v[76:79], v[92:95], v[208:211]
  v_mfma_f32_16x16x32_bf16 v[212:215], v[72:75], v[96:99], v[212:215]
  v_mfma_f32_16x16x32_bf16 v[212:215], v[76:79], v[100:103], v[212:215]
  v_mfma_f32_16x16x32_bf16 v[216:219], v[72:75], v[104:107], v[216:219]
  s_setprio 2
  s_barrier
  v_mfma_f32_16x16x32_bf16 v[216:219], v[76:79], v[108:111], v[216:219]
  ds_read_b64_tr_b16 v[40:41], v6 offset:20480
  s_add_u32 m0, s75, 40960
  s_nop 0
  buffer_load_dwordx4 v29, s[44:47], s74 offen offset:0 lds
  ds_read_b64_tr_b16 v[42:43], v6 offset:23040
  ds_read_b64_tr_b16 v[44:45], v6 offset:40960
  ds_read_b64_tr_b16 v[46:47], v6 offset:43520
  ds_read_b64_tr_b16 v[48:49], v7 offset:20480
  buffer_load_dwordx4 v30, s[44:47], s74 offen offset:1024 lds
  ds_read_b64_tr_b16 v[50:51], v7 offset:23040
  ds_read_b64_tr_b16 v[52:53], v7 offset:40960
  ds_read_b64_tr_b16 v[54:55], v7 offset:43520
  ds_read_b64_tr_b16 v[56:57], v8 offset:20480
  buffer_load_dwordx4 v31, s[44:47], s74 offen offset:2048 lds
  ds_read_b64_tr_b16 v[58:59], v8 offset:23040
  ds_read_b64_tr_b16 v[60:61], v8 offset:40960
  ds_read_b64_tr_b16 v[62:63], v8 offset:43520
  ds_read_b64_tr_b16 v[64:65], v9 offset:20480
  buffer_load_dwordx4 v32, s[44:47], s74 offen offset:3072 lds
  ds_read_b64_tr_b16 v[66:67], v9 offset:23040
  ds_read_b64_tr_b16 v[68:69], v9 offset:40960
  ds_read_b64_tr_b16 v[70:71], v9 offset:43520
  ds_read_b128 v[80:83], v11 offset:0
  s_add_u32 m0, m0, 4096
  s_nop 0
  buffer_load_dwordx4 v33, s[44:47], s74 offen offset:0 lds
  s_add_u32 s74, s74, 212992
  ds_read_b128 v[84:87], v12 offset:0
  ds_read_b128 v[88:91], v11 offset:2048
  ds_read_b128 v[92:95], v12 offset:2048
  ds_read_b128 v[96:99], v11 offset:4096
  v_lshl_add_u32 v34, v22, 7, v15
  v_lshl_add_u32 v28, v18, 7, v14
  s_add_u32 m0, s76, 8192
  s_nop 0
  buffer_load_dwordx4 v28, s[32:35], 0 offen lds
  ds_read_b128 v[100:103], v12 offset:4096
  ds_read_b128 v[104:107], v11 offset:6144
  ds_read_b128 v[108:111], v12 offset:6144
  ds_read_b64_tr_b16 v[72:73], v10 offset:20480
  s_add_u32 m0, m0, 1024
  s_nop 0
  buffer_load_dwordx4 v34, s[32:35], 0 offen lds
  ds_read_b64_tr_b16 v[74:75], v10 offset:23040
  ds_read_b64_tr_b16 v[76:77], v10 offset:40960
  ds_read_b64_tr_b16 v[78:79], v10 offset:43520
  buffer_load_dwordx3 v[16:18], v13, s[28:31], s73 offen offset:0
  buffer_load_dwordx3 v[20:22], v13, s[28:31], s73 offen offset:832
  s_add_u32 s73, s73, 12
  s_waitcnt vmcnt(9) lgkmcnt(0)
  s_barrier
  s_setprio 0
  v_mfma_f32_16x16x32_bf16 v[140:143], v[40:43], v[80:83], v[140:143]
  v_mfma_f32_16x16x32_bf16 v[140:143], v[44:47], v[84:87], v[140:143]
  v_mfma_f32_16x16x32_bf16 v[144:147], v[40:43], v[88:91], v[144:147]
  v_mfma_f32_16x16x32_bf16 v[144:147], v[44:47], v[92:95], v[144:147]
  v_mfma_f32_16x16x32_bf16 v[148:151], v[40:43], v[96:99], v[148:151]
  v_mfma_f32_16x16x32_bf16 v[148:151], v[44:47], v[100:103], v[148:151]
  v_mfma_f32_16x16x32_bf16 v[152:155], v[40:43], v[104:107], v[152:155]
  v_mfma_f32_16x16x32_bf16 v[152:155], v[44:47], v[108:111], v[152:155]
  v_mfma_f32_16x16x32_bf16 v[168:171], v[48:51], v[104:107], v[168:171]
  v_mfma_f32_16x16x32_bf16 v[168:171], v[52:55], v[108:111], v[168:171]
  v_mfma_f32_16x16x32_bf16 v[164:167], v[48:51], v[96:99], v[164:167]
  v_mfma_f32_16x16x32_bf16 v[164:167], v[52:55], v[100:103], v[164:167]
  v_mfma_f32_16x16x32_bf16 v[160:163], v[48:51], v[88:91], v[160:163]
  v_mfma_f32_16x16x32_bf16 v[160:163], v[52:55], v[92:95], v[160:163]
  v_mfma_f32_16x16x32_bf16 v[156:159], v[48:51], v[80:83], v[156:159]
  v_mfma_f32_16x16x32_bf16 v[156:159], v[52:55], v[84:87], v[156:159]
  v_mfma_f32_16x16x32_bf16 v[172:175], v[56:59], v[80:83], v[172:175]
  v_mfma_f32_16x16x32_bf16 v[172:175], v[60:63], v[84:87], v[172:175]
  v_mfma_f32_16x16x32_bf16 v[176:179], v[56:59], v[88:91], v[176:179]
  v_mfma_f32_16x16x32_bf16 v[176:179], v[60:63], v[92:95], v[176:179]
  v_mfma_f32_16x16x32_bf16 v[180:183], v[56:59], v[96:99], v[180:183]
  v_mfma_f32_16x16x32_bf16 v[180:183], v[60:63], v[100:103], v[180:183]
  v_mfma_f32_16x16x32_bf16 v[184:187], v[56:59], v[104:107], v[184:187]
  v_mfma_f32_16x16x32_bf16 v[184:187], v[60:63], v[108:111], v[184:187]
  v_mfma_f32_16x16x32_bf16 v[200:203], v[64:67], v[104:107], v[200:203]
  v_mfma_f32_16x16x32_bf16 v[200:203], v[68:71], v[108:111], v[200:203]
  v_mfma_f32_16x16x32_bf16 v[196:199], v[64:67], v[96:99], v[196:199]
  v_mfma_f32_16x16x32_bf16 v[196:199], v[68:71], v[100:103], v[196:199]
  v_mfma_f32_16x16x32_bf16 v[192:195], v[64:67], v[88:91], v[192:195]
  v_mfma_f32_16x16x32_bf16 v[192:195], v[68:71], v[92:95], v[192:195]
  v_mfma_f32_16x16x32_bf16 v[188:191], v[64:67], v[80:83], v[188:191]
  v_mfma_f32_16x16x32_bf16 v[188:191], v[68:71], v[84:87], v[188:191]
  v_mfma_f32_16x16x32_bf16 v[204:207], v[72:75], v[80:83], v[204:207]
  v_mfma_f32_16x16x32_bf16 v[204:207], v[76:79], v[84:87], v[204:207]
  v_mfma_f32_16x16x32_bf16 v[208:211], v[72:75], v[88:91], v[208:211]
  v_mfma_f32_16x16x32_bf16 v[208:211], v[76:79], v[92:95], v[208:211]
  v_mfma_f32_16x16x32_bf16 v[212:215], v[72:75], v[96:99], v[212:215]
  v_mfma_f32_16x16x32_bf16 v[212:215], v[76:79], v[100:103], v[212:215]
  v_mfma_f32_16x16x32_bf16 v[216:219], v[72:75], v[104:107], v[216:219]
  s_setprio 2
  s_barrier
  v_mfma_f32_16x16x32_bf16 v[216:219], v[76:79], v[108:111], v[216:219]
  ds_read_b64_tr_b16 v[40:41], v1 offset:0
  s_add_u32 m0, s75, 81920
  s_nop 0
  buffer_load_dwordx4 v29, s[44:47], s74 offen offset:0 lds
  ds_read_b64_tr_b16 v[42:43], v1 offset:2560
  ds_read_b64_tr_b16 v[44:45], v1 offset:20480
  ds_read_b64_tr_b16 v[46:47], v1 offset:23040
  ds_read_b64_tr_b16 v[48:49], v2 offset:0
  buffer_load_dwordx4 v30, s[44:47], s74 offen offset:1024 lds
  ds_read_b64_tr_b16 v[50:51], v2 offset:2560
  ds_read_b64_tr_b16 v[52:53], v2 offset:20480
  ds_read_b64_tr_b16 v[54:55], v2 offset:23040
  ds_read_b64_tr_b16 v[56:57], v3 offset:0
  buffer_load_dwordx4 v31, s[44:47], s74 offen offset:2048 lds
  ds_read_b64_tr_b16 v[58:59], v3 offset:2560
  ds_read_b64_tr_b16 v[60:61], v3 offset:20480
  ds_read_b64_tr_b16 v[62:63], v3 offset:23040
  ds_read_b64_tr_b16 v[64:65], v4 offset:0
  buffer_load_dwordx4 v32, s[44:47], s74 offen offset:3072 lds
  ds_read_b64_tr_b16 v[66:67], v4 offset:2560
  ds_read_b64_tr_b16 v[68:69], v4 offset:20480
  ds_read_b64_tr_b16 v[70:71], v4 offset:23040
  ds_read_b128 v[80:83], v11 offset:8192
  s_add_u32 m0, m0, 4096
  s_nop 0
  buffer_load_dwordx4 v33, s[44:47], s74 offen offset:0 lds
  s_add_u32 s74, s74, 212992
  ds_read_b128 v[84:87], v12 offset:8192
  ds_read_b128 v[88:91], v11 offset:10240
  ds_read_b128 v[92:95], v12 offset:10240
  ds_read_b128 v[96:99], v11 offset:12288
  v_lshl_add_u32 v34, v240, 7, v15
  v_lshl_add_u32 v28, v24, 7, v14
  s_add_u32 m0, s76, 0
  s_nop 0
  buffer_load_dwordx4 v28, s[32:35], 0 offen lds
  ds_read_b128 v[100:103], v12 offset:12288
  ds_read_b128 v[104:107], v11 offset:14336
  ds_read_b128 v[108:111], v12 offset:14336
  ds_read_b64_tr_b16 v[72:73], v5 offset:0
  s_add_u32 m0, m0, 1024
  s_nop 0
  buffer_load_dwordx4 v34, s[32:35], 0 offen lds
  ds_read_b64_tr_b16 v[74:75], v5 offset:2560
  ds_read_b64_tr_b16 v[76:77], v5 offset:20480
  ds_read_b64_tr_b16 v[78:79], v5 offset:23040
  s_waitcnt vmcnt(9) lgkmcnt(0)
  s_barrier
  s_setprio 0
  v_mfma_f32_16x16x32_bf16 v[140:143], v[40:43], v[80:83], v[140:143]
  v_mfma_f32_16x16x32_bf16 v[140:143], v[44:47], v[84:87], v[140:143]
  v_mfma_f32_16x16x32_bf16 v[144:147], v[40:43], v[88:91], v[144:147]
  v_mfma_f32_16x16x32_bf16 v[144:147], v[44:47], v[92:95], v[144:147]
  v_mfma_f32_16x16x32_bf16 v[148:151], v[40:43], v[96:99], v[148:151]
  v_mfma_f32_16x16x32_bf16 v[148:151], v[44:47], v[100:103], v[148:151]
  v_mfma_f32_16x16x32_bf16 v[152:155], v[40:43], v[104:107], v[152:155]
  v_mfma_f32_16x16x32_bf16 v[152:155], v[44:47], v[108:111], v[152:155]
  v_mfma_f32_16x16x32_bf16 v[168:171], v[48:51], v[104:107], v[168:171]
  v_mfma_f32_16x16x32_bf16 v[168:171], v[52:55], v[108:111], v[168:171]
  v_mfma_f32_16x16x32_bf16 v[164:167], v[48:51], v[96:99], v[164:167]
  v_mfma_f32_16x16x32_bf16 v[164:167], v[52:55], v[100:103], v[164:167]
  v_mfma_f32_16x16x32_bf16 v[160:163], v[48:51], v[88:91], v[160:163]
  v_mfma_f32_16x16x32_bf16 v[160:163], v[52:55], v[92:95], v[160:163]
  v_mfma_f32_16x16x32_bf16 v[156:159], v[48:51], v[80:83], v[156:159]
  v_mfma_f32_16x16x32_bf16 v[156:159], v[52:55], v[84:87], v[156:159]
  v_mfma_f32_16x16x32_bf16 v[172:175], v[56:59], v[80:83], v[172:175]
  v_mfma_f32_16x16x32_bf16 v[172:175], v[60:63], v[84:87], v[172:175]
  v_mfma_f32_16x16x32_bf16 v[176:179], v[56:59], v[88:91], v[176:179]
  v_mfma_f32_16x16x32_bf16 v[176:179], v[60:63], v[92:95], v[176:179]
  v_mfma_f32_16x16x32_bf16 v[180:183], v[56:59], v[96:99], v[180:183]
  v_mfma_f32_16x16x32_bf16 v[180:183], v[60:63], v[100:103], v[180:183]
  v_mfma_f32_16x16x32_bf16 v[184:187], v[56:59], v[104:107], v[184:187]
  v_mfma_f32_16x16x32_bf16 v[184:187], v[60:63], v[108:111], v[184:187]
  v_mfma_f32_16x16x32_bf16 v[200:203], v[64:67], v[104:107], v[200:203]
  v_mfma_f32_16x16x32_bf16 v[200:203], v[68:71], v[108:111], v[200:203]
  v_mfma_f32_16x16x32_bf16 v[196:199], v[64:67], v[96:99], v[196:199]
  v_mfma_f32_16x16x32_bf16 v[196:199], v[68:71], v[100:103], v[196:199]
  v_mfma_f32_16x16x32_bf16 v[192:195], v[64:67], v[88:91], v[192:195]
  v_mfma_f32_16x16x32_bf16 v[192:195], v[68:71], v[92:95], v[192:195]
  v_mfma_f32_16x16x32_bf16 v[188:191], v[64:67], v[80:83], v[188:191]
  v_mfma_f32_16x16x32_bf16 v[188:191], v[68:71], v[84:87], v[188:191]
  v_mfma_f32_16x16x32_bf16 v[204:207], v[72:75], v[80:83], v[204:207]
  v_mfma_f32_16x16x32_bf16 v[204:207], v[76:79], v[84:87], v[204:207]
  v_mfma_f32_16x16x32_bf16 v[208:211], v[72:75], v[88:91], v[208:211]
  v_mfma_f32_16x16x32_bf16 v[208:211], v[76:79], v[92:95], v[208:211]
  v_mfma_f32_16x16x32_bf16 v[212:215], v[72:75], v[96:99], v[212:215]
  v_mfma_f32_16x16x32_bf16 v[212:215], v[76:79], v[100:103], v[212:215]
  v_mfma_f32_16x16x32_bf16 v[216:219], v[72:75], v[104:107], v[216:219]
  s_setprio 2
  s_barrier
  v_mfma_f32_16x16x32_bf16 v[216:219], v[76:79], v[108:111], v[216:219]
  ds_read_b64_tr_b16 v[40:41], v1 offset:40960
  s_add_u32 m0, s75, 0
  s_nop 0
  buffer_load_dwordx4 v29, s[44:47], s74 offen offset:0 lds
  ds_read_b64_tr_b16 v[42:43], v1 offset:43520
  ds_read_b64_tr_b16 v[44:45], v6 offset:0
  ds_read_b64_tr_b16 v[46:47], v6 offset:2560
  ds_read_b64_tr_b16 v[48:49], v2 offset:40960
  buffer_load_dwordx4 v30, s[44:47], s74 offen offset:1024 lds
  ds_read_b64_tr_b16 v[50:51], v2 offset:43520
  ds_read_b64_tr_b16 v[52:53], v7 offset:0
  ds_read_b64_tr_b16 v[54:55], v7 offset:2560
  ds_read_b64_tr_b16 v[56:57], v3 offset:40960
  buffer_load_dwordx4 v31, s[44:47], s74 offen offset:2048 lds
  ds_read_b64_tr_b16 v[58:59], v3 offset:43520
  ds_read_b64_tr_b16 v[60:61], v8 offset:0
  ds_read_b64_tr_b16 v[62:63], v8 offset:2560
  ds_read_b64_tr_b16 v[64:65], v4 offset:40960
  buffer_load_dwordx4 v32, s[44:47], s74 offen offset:3072 lds
  ds_read_b64_tr_b16 v[66:67], v4 offset:43520
  ds_read_b64_tr_b16 v[68:69], v9 offset:0
  ds_read_b64_tr_b16 v[70:71], v9 offset:2560
  ds_read_b128 v[80:83], v11 offset:0
  s_add_u32 m0, m0, 4096
  s_nop 0
  buffer_load_dwordx4 v33, s[44:47], s74 offen offset:0 lds
  s_add_u32 s74, s74, 212992
  ds_read_b128 v[84:87], v12 offset:0
  ds_read_b128 v[88:91], v11 offset:2048
  ds_read_b128 v[92:95], v12 offset:2048
  ds_read_b128 v[96:99], v11 offset:4096
  v_lshl_add_u32 v34, v241, 7, v15
  v_lshl_add_u32 v28, v25, 7, v14
  s_add_u32 m0, s76, 8192
  s_nop 0
  buffer_load_dwordx4 v28, s[32:35], 0 offen lds
  ds_read_b128 v[100:103], v12 offset:4096
  ds_read_b128 v[104:107], v11 offset:6144
  ds_read_b128 v[108:111], v12 offset:6144
  ds_read_b64_tr_b16 v[72:73], v5 offset:40960
  s_add_u32 m0, m0, 1024
  s_nop 0
  buffer_load_dwordx4 v34, s[32:35], 0 offen lds
  ds_read_b64_tr_b16 v[74:75], v5 offset:43520
  ds_read_b64_tr_b16 v[76:77], v10 offset:0
  ds_read_b64_tr_b16 v[78:79], v10 offset:2560
  s_waitcnt vmcnt(7) lgkmcnt(0)
  s_barrier
  s_setprio 0
  v_mfma_f32_16x16x32_bf16 v[140:143], v[40:43], v[80:83], v[140:143]
  v_mfma_f32_16x16x32_bf16 v[140:143], v[44:47], v[84:87], v[140:143]
  v_mfma_f32_16x16x32_bf16 v[144:147], v[40:43], v[88:91], v[144:147]
  v_mfma_f32_16x16x32_bf16 v[144:147], v[44:47], v[92:95], v[144:147]
  v_mfma_f32_16x16x32_bf16 v[148:151], v[40:43], v[96:99], v[148:151]
  v_mfma_f32_16x16x32_bf16 v[148:151], v[44:47], v[100:103], v[148:151]
  v_mfma_f32_16x16x32_bf16 v[152:155], v[40:43], v[104:107], v[152:155]
  v_mfma_f32_16x16x32_bf16 v[152:155], v[44:47], v[108:111], v[152:155]
  v_mfma_f32_16x16x32_bf16 v[168:171], v[48:51], v[104:107], v[168:171]
  v_mfma_f32_16x16x32_bf16 v[168:171], v[52:55], v[108:111], v[168:171]
  v_mfma_f32_16x16x32_bf16 v[164:167], v[48:51], v[96:99], v[164:167]
  v_mfma_f32_16x16x32_bf16 v[164:167], v[52:55], v[100:103], v[164:167]
  v_mfma_f32_16x16x32_bf16 v[160:163], v[48:51], v[88:91], v[160:163]
  v_mfma_f32_16x16x32_bf16 v[160:163], v[52:55], v[92:95], v[160:163]
  v_mfma_f32_16x16x32_bf16 v[156:159], v[48:51], v[80:83], v[156:159]
  v_mfma_f32_16x16x32_bf16 v[156:159], v[52:55], v[84:87], v[156:159]
  v_mfma_f32_16x16x32_bf16 v[172:175], v[56:59], v[80:83], v[172:175]
  v_mfma_f32_16x16x32_bf16 v[172:175], v[60:63], v[84:87], v[172:175]
  v_mfma_f32_16x16x32_bf16 v[176:179], v[56:59], v[88:91], v[176:179]
  v_mfma_f32_16x16x32_bf16 v[176:179], v[60:63], v[92:95], v[176:179]
  v_mfma_f32_16x16x32_bf16 v[180:183], v[56:59], v[96:99], v[180:183]
  v_mfma_f32_16x16x32_bf16 v[180:183], v[60:63], v[100:103], v[180:183]
  v_mfma_f32_16x16x32_bf16 v[184:187], v[56:59], v[104:107], v[184:187]
  v_mfma_f32_16x16x32_bf16 v[184:187], v[60:63], v[108:111], v[184:187]
  v_mfma_f32_16x16x32_bf16 v[200:203], v[64:67], v[104:107], v[200:203]
  v_mfma_f32_16x16x32_bf16 v[200:203], v[68:71], v[108:111], v[200:203]
  v_mfma_f32_16x16x32_bf16 v[196:199], v[64:67], v[96:99], v[196:199]
  v_mfma_f32_16x16x32_bf16 v[196:199], v[68:71], v[100:103], v[196:199]
  v_mfma_f32_16x16x32_bf16 v[192:195], v[64:67], v[88:91], v[192:195]
  v_mfma_f32_16x16x32_bf16 v[192:195], v[68:71], v[92:95], v[192:195]
  v_mfma_f32_16x16x32_bf16 v[188:191], v[64:67], v[80:83], v[188:191]
  v_mfma_f32_16x16x32_bf16 v[188:191], v[68:71], v[84:87], v[188:191]
  v_mfma_f32_16x16x32_bf16 v[204:207], v[72:75], v[80:83], v[204:207]
  v_mfma_f32_16x16x32_bf16 v[204:207], v[76:79], v[84:87], v[204:207]
  v_mfma_f32_16x16x32_bf16 v[208:211], v[72:75], v[88:91], v[208:211]
  v_mfma_f32_16x16x32_bf16 v[208:211], v[76:79], v[92:95], v[208:211]
  v_mfma_f32_16x16x32_bf16 v[212:215], v[72:75], v[96:99], v[212:215]
  v_mfma_f32_16x16x32_bf16 v[212:215], v[76:79], v[100:103], v[212:215]
  v_mfma_f32_16x16x32_bf16 v[216:219], v[72:75], v[104:107], v[216:219]
  s_setprio 2
  s_barrier
  v_mfma_f32_16x16x32_bf16 v[216:219], v[76:79], v[108:111], v[216:219]
  ds_read_b64_tr_b16 v[40:41], v6 offset:20480
  s_add_u32 m0, s75, 40960
  s_nop 0
  buffer_load_dwordx4 v29, s[44:47], s74 offen offset:0 lds
  ds_read_b64_tr_b16 v[42:43], v6 offset:23040
  ds_read_b64_tr_b16 v[44:45], v6 offset:40960
  ds_read_b64_tr_b16 v[46:47], v6 offset:43520
  ds_read_b64_tr_b16 v[48:49], v7 offset:20480
  buffer_load_dwordx4 v30, s[44:47], s74 offen offset:1024 lds
  ds_read_b64_tr_b16 v[50:51], v7 offset:23040
  ds_read_b64_tr_b16 v[52:53], v7 offset:40960
  ds_read_b64_tr_b16 v[54:55], v7 offset:43520
  ds_read_b64_tr_b16 v[56:57], v8 offset:20480
  buffer_load_dwordx4 v31, s[44:47], s74 offen offset:2048 lds
  ds_read_b64_tr_b16 v[58:59], v8 offset:23040
  ds_read_b64_tr_b16 v[60:61], v8 offset:40960
  ds_read_b64_tr_b16 v[62:63], v8 offset:43520
  ds_read_b64_tr_b16 v[64:65], v9 offset:20480
  buffer_load_dwordx4 v32, s[44:47], s74 offen offset:3072 lds
  ds_read_b64_tr_b16 v[66:67], v9 offset:23040
  ds_read_b64_tr_b16 v[68:69], v9 offset:40960
  ds_read_b64_tr_b16 v[70:71], v9 offset:43520
  ds_read_b128 v[80:83], v11 offset:8192
  s_add_u32 m0, m0, 4096
  s_nop 0
  buffer_load_dwordx4 v33, s[44:47], s74 offen offset:0 lds
  s_add_u32 s74, s74, 212992
  ds_read_b128 v[84:87], v12 offset:8192
  ds_read_b128 v[88:91], v11 offset:10240
  ds_read_b128 v[92:95], v12 offset:10240
  ds_read_b128 v[96:99], v11 offset:12288
  v_lshl_add_u32 v34, v242, 7, v15
  v_lshl_add_u32 v28, v26, 7, v14
  s_add_u32 m0, s76, 0
  s_nop 0
  buffer_load_dwordx4 v28, s[32:35], 0 offen lds
  ds_read_b128 v[100:103], v12 offset:12288
  ds_read_b128 v[104:107], v11 offset:14336
  ds_read_b128 v[108:111], v12 offset:14336
  ds_read_b64_tr_b16 v[72:73], v10 offset:20480
  s_add_u32 m0, m0, 1024
  s_nop 0
  buffer_load_dwordx4 v34, s[32:35], 0 offen lds
  ds_read_b64_tr_b16 v[74:75], v10 offset:23040
  ds_read_b64_tr_b16 v[76:77], v10 offset:40960
  ds_read_b64_tr_b16 v[78:79], v10 offset:43520
  buffer_load_dwordx3 v[24:26], v13, s[28:31], s73 offen offset:0
  buffer_load_dwordx3 v[240:242], v13, s[28:31], s73 offen offset:832
  s_add_u32 s73, s73, 12
  s_waitcnt vmcnt(9) lgkmcnt(0)
  s_barrier
  s_setprio 0
  v_mfma_f32_16x16x32_bf16 v[140:143], v[40:43], v[80:83], v[140:143]
  s_add_u32 s72, s72, 1
  v_mfma_f32_16x16x32_bf16 v[140:143], v[44:47], v[84:87], v[140:143]
  v_mfma_f32_16x16x32_bf16 v[144:147], v[40:43], v[88:91], v[144:147]
  v_mfma_f32_16x16x32_bf16 v[144:147], v[44:47], v[92:95], v[144:147]
  v_mfma_f32_16x16x32_bf16 v[148:151], v[40:43], v[96:99], v[148:151]
  v_mfma_f32_16x16x32_bf16 v[148:151], v[44:47], v[100:103], v[148:151]
  v_mfma_f32_16x16x32_bf16 v[152:155], v[40:43], v[104:107], v[152:155]
  v_mfma_f32_16x16x32_bf16 v[152:155], v[44:47], v[108:111], v[152:155]
  v_mfma_f32_16x16x32_bf16 v[168:171], v[48:51], v[104:107], v[168:171]
  v_mfma_f32_16x16x32_bf16 v[168:171], v[52:55], v[108:111], v[168:171]
  v_mfma_f32_16x16x32_bf16 v[164:167], v[48:51], v[96:99], v[164:167]
  v_mfma_f32_16x16x32_bf16 v[164:167], v[52:55], v[100:103], v[164:167]
  v_mfma_f32_16x16x32_bf16 v[160:163], v[48:51], v[88:91], v[160:163]
  v_mfma_f32_16x16x32_bf16 v[160:163], v[52:55], v[92:95], v[160:163]
  v_mfma_f32_16x16x32_bf16 v[156:159], v[48:51], v[80:83], v[156:159]
  v_mfma_f32_16x16x32_bf16 v[156:159], v[52:55], v[84:87], v[156:159]
  v_mfma_f32_16x16x32_bf16 v[172:175], v[56:59], v[80:83], v[172:175]
  v_mfma_f32_16x16x32_bf16 v[172:175], v[60:63], v[84:87], v[172:175]
  v_mfma_f32_16x16x32_bf16 v[176:179], v[56:59], v[88:91], v[176:179]
  v_mfma_f32_16x16x32_bf16 v[176:179], v[60:63], v[92:95], v[176:179]
  s_cmp_lt_u32 s72, 4
  v_mfma_f32_16x16x32_bf16 v[180:183], v[56:59], v[96:99], v[180:183]
  v_mfma_f32_16x16x32_bf16 v[180:183], v[60:63], v[100:103], v[180:183]
  v_mfma_f32_16x16x32_bf16 v[184:187], v[56:59], v[104:107], v[184:187]
  v_mfma_f32_16x16x32_bf16 v[184:187], v[60:63], v[108:111], v[184:187]
  v_mfma_f32_16x16x32_bf16 v[200:203], v[64:67], v[104:107], v[200:203]
  v_mfma_f32_16x16x32_bf16 v[200:203], v[68:71], v[108:111], v[200:203]
  v_mfma_f32_16x16x32_bf16 v[196:199], v[64:67], v[96:99], v[196:199]
  v_mfma_f32_16x16x32_bf16 v[196:199], v[68:71], v[100:103], v[196:199]
  v_mfma_f32_16x16x32_bf16 v[192:195], v[64:67], v[88:91], v[192:195]
  v_mfma_f32_16x16x32_bf16 v[192:195], v[68:71], v[92:95], v[192:195]
  v_mfma_f32_16x16x32_bf16 v[188:191], v[64:67], v[80:83], v[188:191]
  v_mfma_f32_16x16x32_bf16 v[188:191], v[68:71], v[84:87], v[188:191]
  v_mfma_f32_16x16x32_bf16 v[204:207], v[72:75], v[80:83], v[204:207]
  v_mfma_f32_16x16x32_bf16 v[204:207], v[76:79], v[84:87], v[204:207]
  v_mfma_f32_16x16x32_bf16 v[208:211], v[72:75], v[88:91], v[208:211]
  v_mfma_f32_16x16x32_bf16 v[208:211], v[76:79], v[92:95], v[208:211]
  v_mfma_f32_16x16x32_bf16 v[212:215], v[72:75], v[96:99], v[212:215]
  v_mfma_f32_16x16x32_bf16 v[212:215], v[76:79], v[100:103], v[212:215]
  v_mfma_f32_16x16x32_bf16 v[216:219], v[72:75], v[104:107], v[216:219]
  s_setprio 2
  s_barrier
  v_mfma_f32_16x16x32_bf16 v[216:219], v[76:79], v[108:111], v[216:219]
  s_cbranch_scc1 L_dnn_loop0
  ds_read_b64_tr_b16 v[40:41], v1 offset:0
  v_lshl_add_u32 v34, v20, 7, v15
  v_lshl_add_u32 v28, v16, 7, v14
  s_add_u32 m0, s76, 8192
  s_nop 0
  buffer_load_dwordx4 v28, s[32:35], 0 offen lds
  ds_read_b64_tr_b16 v[42:43], v1 offset:2560
  ds_read_b64_tr_b16 v[44:45], v1 offset:20480
  ds_read_b64_tr_b16 v[46:47], v1 offset:23040
  ds_read_b64_tr_b16 v[48:49], v2 offset:0
  ds_read_b64_tr_b16 v[50:51], v2 offset:2560
  ds_read_b64_tr_b16 v[52:53], v2 offset:20480
  ds_read_b64_tr_b16 v[54:55], v2 offset:23040
  ds_read_b64_tr_b16 v[56:57], v3 offset:0
  ds_read_b64_tr_b16 v[58:59], v3 offset:2560
  ds_read_b64_tr_b16 v[60:61], v3 offset:20480
  ds_read_b64_tr_b16 v[62:63], v3 offset:23040
  ds_read_b64_tr_b16 v[64:65], v4 offset:0
  ds_read_b64_tr_b16 v[66:67], v4 offset:2560
  ds_read_b64_tr_b16 v[68:69], v4 offset:20480
  ds_read_b64_tr_b16 v[70:71], v4 offset:23040
  ds_read_b128 v[80:83], v11 offset:0
  s_add_u32 m0, m0, 1024
  s_nop 0
  buffer_load_dwordx4 v34, s[32:35], 0 offen lds
  ds_read_b128 v[84:87], v12 offset:0
  ds_read_b128 v[88:91], v11 offset:2048
  ds_read_b128 v[92:95], v12 offset:2048
  ds_read_b128 v[96:99], v11 offset:4096
  ds_read_b128 v[100:103], v12 offset:4096
  ds_read_b128 v[104:107], v11 offset:6144
  ds_read_b128 v[108:111], v12 offset:6144
  ds_read_b64_tr_b16 v[72:73], v5 offset:0
  ds_read_b64_tr_b16 v[74:75], v5 offset:2560
  ds_read_b64_tr_b16 v[76:77], v5 offset:20480
  ds_read_b64_tr_b16 v[78:79], v5 offset:23040
  ds_read_b64 v[220:221], v35 offset:640
  ds_read_b64 v[222:223], v35 offset:672
  ds_read_b64 v[224:225], v35 offset:704
  ds_read_b64 v[226:227], v35 offset:736
  ds_read_b64 v[228:229], v35 offset:768
  s_mov_b32 s60, s24
  s_and_b32 s61, s25, 0xffff
  s_mov_b32 s62, 268435456
  s_mov_b32 s63, 0x20000
  s_mov_b32 s64, s22
  s_and_b32 s65, s23, 0xffff
  s_mov_b32 s66, 256
  s_mov_b32 s67, 0x20000
  v_lshlrev_b32 v28, 2, v0
  s_mov_b64 exec, 0xff
  s_mov_b32 s81, 0x80000
  buffer_load_dword v255, v28, s[60:63], s81 offen
  buffer_load_dword v37, v28, s[64:67], 0 offen offset:128 sc1
  s_mov_b64 exec, -1
  v_mov_b32 v28, 0
  s_waitcnt vmcnt(6) lgkmcnt(0)
  s_barrier
  s_setprio 0
  v_mfma_f32_16x16x32_bf16 v[140:143], v[40:43], v[80:83], v[140:143]
  v_mov_b32 v232, 0xc0135761
  v_mov_b32 v233, 0xc0135761
  v_mfma_f32_16x16x32_bf16 v[140:143], v[44:47], v[84:87], v[140:143]
  v_mov_b32 v234, 0xbdd2d3e8
  v_mfma_f32_16x16x32_bf16 v[144:147], v[40:43], v[88:91], v[144:147]
  v_mov_b32 v235, 0xbdd2d3e8
  v_mfma_f32_16x16x32_bf16 v[144:147], v[44:47], v[92:95], v[144:147]
  v_mov_b32 v236, 0x71800000
  v_mfma_f32_16x16x32_bf16 v[148:151], v[40:43], v[96:99], v[148:151]
  v_lshlrev_b32 v112, 16, v220
  v_mfma_f32_16x16x32_bf16 v[148:151], v[44:47], v[100:103], v[148:151]
  v_and_b32 v113, 0xffff0000, v220
  v_mfma_f32_16x16x32_bf16 v[152:155], v[40:43], v[104:107], v[152:155]
  v_lshlrev_b32 v114, 16, v221
  v_mfma_f32_16x16x32_bf16 v[152:155], v[44:47], v[108:111], v[152:155]
  v_and_b32 v115, 0xffff0000, v221
  v_mfma_f32_16x16x32_bf16 v[168:171], v[48:51], v[104:107], v[168:171]
  v_lshlrev_b32 v116, 16, v222
  v_mfma_f32_16x16x32_bf16 v[168:171], v[52:55], v[108:111], v[168:171]
  v_and_b32 v117, 0xffff0000, v222
  v_mfma_f32_16x16x32_bf16 v[164:167], v[48:51], v[96:99], v[164:167]
  v_lshlrev_b32 v118, 16, v223
  v_mfma_f32_16x16x32_bf16 v[164:167], v[52:55], v[100:103], v[164:167]
  v_and_b32 v119, 0xffff0000, v223
  v_mfma_f32_16x16x32_bf16 v[160:163], v[48:51], v[88:91], v[160:163]
  v_lshlrev_b32 v120, 16, v224
  v_mfma_f32_16x16x32_bf16 v[160:163], v[52:55], v[92:95], v[160:163]
  v_and_b32 v121, 0xffff0000, v224
  v_mfma_f32_16x16x32_bf16 v[156:159], v[48:51], v[80:83], v[156:159]
  v_lshlrev_b32 v122, 16, v225
  v_mfma_f32_16x16x32_bf16 v[156:159], v[52:55], v[84:87], v[156:159]
  v_and_b32 v123, 0xffff0000, v225
  v_mfma_f32_16x16x32_bf16 v[172:175], v[56:59], v[80:83], v[172:175]
  v_lshlrev_b32 v124, 16, v226
  v_mfma_f32_16x16x32_bf16 v[172:175], v[60:63], v[84:87], v[172:175]
  v_and_b32 v125, 0xffff0000, v226
  v_mfma_f32_16x16x32_bf16 v[176:179], v[56:59], v[88:91], v[176:179]
  v_lshlrev_b32 v126, 16, v227
  v_mfma_f32_16x16x32_bf16 v[176:179], v[60:63], v[92:95], v[176:179]
  v_and_b32 v127, 0xffff0000, v227
  v_mfma_f32_16x16x32_bf16 v[180:183], v[56:59], v[96:99], v[180:183]
  v_lshlrev_b32 v128, 16, v228
  v_mfma_f32_16x16x32_bf16 v[180:183], v[60:63], v[100:103], v[180:183]
  v_and_b32 v129, 0xffff0000, v228
  v_mfma_f32_16x16x32_bf16 v[184:187], v[56:59], v[104:107], v[184:187]
  v_lshlrev_b32 v130, 16, v229
  v_mfma_f32_16x16x32_bf16 v[184:187], v[60:63], v[108:111], v[184:187]
  v_and_b32 v131, 0xffff0000, v229
  v_mfma_f32_16x16x32_bf16 v[200:203], v[64:67], v[104:107], v[200:203]
  v_rcp_f32 v112, v112
  v_mfma_f32_16x16x32_bf16 v[200:203], v[68:71], v[108:111], v[200:203]
  v_rcp_f32 v113, v113
  v_mfma_f32_16x16x32_bf16 v[196:199], v[64:67], v[96:99], v[196:199]
  v_rcp_f32 v114, v114
  v_mfma_f32_16x16x32_bf16 v[196:199], v[68:71], v[100:103], v[196:199]
  v_rcp_f32 v115, v115
  v_mfma_f32_16x16x32_bf16 v[192:195], v[64:67], v[88:91], v[192:195]
  v_rcp_f32 v116, v116
  v_mfma_f32_16x16x32_bf16 v[192:195], v[68:71], v[92:95], v[192:195]
  v_rcp_f32 v117, v117
  v_mfma_f32_16x16x32_bf16 v[188:191], v[64:67], v[80:83], v[188:191]
  v_rcp_f32 v118, v118
  v_mfma_f32_16x16x32_bf16 v[188:191], v[68:71], v[84:87], v[188:191]
  v_rcp_f32 v119, v119
  v_mfma_f32_16x16x32_bf16 v[204:207], v[72:75], v[80:83], v[204:207]
  v_rcp_f32 v120, v120
  v_mfma_f32_16x16x32_bf16 v[204:207], v[76:79], v[84:87], v[204:207]
  v_rcp_f32 v121, v121
  v_mfma_f32_16x16x32_bf16 v[208:211], v[72:75], v[88:91], v[208:211]
  v_rcp_f32 v122, v122
  v_mfma_f32_16x16x32_bf16 v[208:211], v[76:79], v[92:95], v[208:211]
  v_rcp_f32 v123, v123
  v_mfma_f32_16x16x32_bf16 v[212:215], v[72:75], v[96:99], v[212:215]
  v_rcp_f32 v124, v124
  v_mfma_f32_16x16x32_bf16 v[212:215], v[76:79], v[100:103], v[212:215]
  v_rcp_f32 v125, v125
  v_mfma_f32_16x16x32_bf16 v[216:219], v[72:75], v[104:107], v[216:219]
  s_setprio 2
  s_barrier
  v_mfma_f32_16x16x32_bf16 v[216:219], v[76:79], v[108:111], v[216:219]
  ds_read_b64_tr_b16 v[40:41], v1 offset:40960
  ds_read_b64_tr_b16 v[42:43], v1 offset:43520
  ds_read_b64_tr_b16 v[44:45], v6 offset:0
  ds_read_b64_tr_b16 v[46:47], v6 offset:2560
  ds_read_b64_tr_b16 v[48:49], v2 offset:40960
  ds_read_b64_tr_b16 v[50:51], v2 offset:43520
  ds_read_b64_tr_b16 v[52:53], v7 offset:0
  ds_read_b64_tr_b16 v[54:55], v7 offset:2560
  ds_read_b64_tr_b16 v[56:57], v3 offset:40960
  ds_read_b64_tr_b16 v[58:59], v3 offset:43520
  ds_read_b64_tr_b16 v[60:61], v8 offset:0
  ds_read_b64_tr_b16 v[62:63], v8 offset:2560
  ds_read_b64_tr_b16 v[64:65], v4 offset:40960
  ds_read_b64_tr_b16 v[66:67], v4 offset:43520
  ds_read_b64_tr_b16 v[68:69], v9 offset:0
  ds_read_b64_tr_b16 v[70:71], v9 offset:2560
  ds_read_b128 v[80:83], v11 offset:8192
  ds_read_b128 v[84:87], v12 offset:8192
  ds_read_b128 v[88:91], v11 offset:10240
  ds_read_b128 v[92:95], v12 offset:10240
  ds_read_b128 v[96:99], v11 offset:12288
  ds_read_b128 v[100:103], v12 offset:12288
  ds_read_b128 v[104:107], v11 offset:14336
  ds_read_b128 v[108:111], v12 offset:14336
  ds_read_b64_tr_b16 v[72:73], v5 offset:40960
  ds_read_b64_tr_b16 v[74:75], v5 offset:43520
  ds_read_b64_tr_b16 v[76:77], v10 offset:0
  ds_read_b64_tr_b16 v[78:79], v10 offset:2560
  s_waitcnt vmcnt(2) lgkmcnt(0)
  s_barrier
  s_setprio 0
  v_mfma_f32_16x16x32_bf16 v[140:143], v[40:43], v[80:83], v[140:143]
  v_rcp_f32 v126, v126
  v_mfma_f32_16x16x32_bf16 v[140:143], v[44:47], v[84:87], v[140:143]
  v_rcp_f32 v127, v127
  v_mfma_f32_16x16x32_bf16 v[144:147], v[40:43], v[88:91], v[144:147]
  v_rcp_f32 v128, v128
  v_mfma_f32_16x16x32_bf16 v[144:147], v[44:47], v[92:95], v[144:147]
  v_mfma_f32_16x16x32_bf16 v[148:151], v[40:43], v[96:99], v[148:151]
  v_rcp_f32 v129, v129
  v_mfma_f32_16x16x32_bf16 v[148:151], v[44:47], v[100:103], v[148:151]
  v_rcp_f32 v130, v130
  v_mfma_f32_16x16x32_bf16 v[152:155], v[40:43], v[104:107], v[152:155]
  v_mfma_f32_16x16x32_bf16 v[152:155], v[44:47], v[108:111], v[152:155]
  v_rcp_f32 v131, v131
  v_mfma_f32_16x16x32_bf16 v[168:171], v[48:51], v[104:107], v[168:171]
  v_med3_f32 v112, v112, -v236, v236
  v_mfma_f32_16x16x32_bf16 v[168:171], v[52:55], v[108:111], v[168:171]
  v_mfma_f32_16x16x32_bf16 v[164:167], v[48:51], v[96:99], v[164:167]
  v_med3_f32 v113, v113, -v236, v236
  v_mfma_f32_16x16x32_bf16 v[164:167], v[52:55], v[100:103], v[164:167]
  v_med3_f32 v114, v114, -v236, v236
  v_mfma_f32_16x16x32_bf16 v[160:163], v[48:51], v[88:91], v[160:163]
  v_mfma_f32_16x16x32_bf16 v[160:163], v[52:55], v[92:95], v[160:163]
  v_med3_f32 v115, v115, -v236, v236
  v_mfma_f32_16x16x32_bf16 v[156:159], v[48:51], v[80:83], v[156:159]
  v_med3_f32 v116, v116, -v236, v236
  v_mfma_f32_16x16x32_bf16 v[156:159], v[52:55], v[84:87], v[156:159]
  v_mfma_f32_16x16x32_bf16 v[172:175], v[56:59], v[80:83], v[172:175]
  v_med3_f32 v117, v117, -v236, v236
  v_mfma_f32_16x16x32_bf16 v[172:175], v[60:63], v[84:87], v[172:175]
  v_med3_f32 v118, v118, -v236, v236
  v_mfma_f32_16x16x32_bf16 v[176:179], v[56:59], v[88:91], v[176:179]
  v_mfma_f32_16x16x32_bf16 v[176:179], v[60:63], v[92:95], v[176:179]
  v_med3_f32 v119, v119, -v236, v236
  v_mfma_f32_16x16x32_bf16 v[180:183], v[56:59], v[96:99], v[180:183]
  v_med3_f32 v120, v120, -v236, v236
  v_mfma_f32_16x16x32_bf16 v[180:183], v[60:63], v[100:103], v[180:183]
  v_med3_f32 v121, v121, -v236, v236
  v_mfma_f32_16x16x32_bf16 v[184:187], v[56:59], v[104:107], v[184:187]
  v_mfma_f32_16x16x32_bf16 v[184:187], v[60:63], v[108:111], v[184:187]
  v_med3_f32 v122, v122, -v236, v236
  v_mfma_f32_16x16x32_bf16 v[200:203], v[64:67], v[104:107], v[200:203]
  v_med3_f32 v123, v123, -v236, v236
  v_mfma_f32_16x16x32_bf16 v[200:203], v[68:71], v[108:111], v[200:203]
  v_mfma_f32_16x16x32_bf16 v[196:199], v[64:67], v[96:99], v[196:199]
  v_med3_f32 v124, v124, -v236, v236
  v_mfma_f32_16x16x32_bf16 v[196:199], v[68:71], v[100:103], v[196:199]
  v_med3_f32 v125, v125, -v236, v236
  v_mfma_f32_16x16x32_bf16 v[192:195], v[64:67], v[88:91], v[192:195]
  v_mfma_f32_16x16x32_bf16 v[192:195], v[68:71], v[92:95], v[192:195]
  v_med3_f32 v126, v126, -v236, v236
  v_mfma_f32_16x16x32_bf16 v[188:191], v[64:67], v[80:83], v[188:191]
  v_med3_f32 v127, v127, -v236, v236
  v_mfma_f32_16x16x32_bf16 v[188:191], v[68:71], v[84:87], v[188:191]
  v_mfma_f32_16x16x32_bf16 v[204:207], v[72:75], v[80:83], v[204:207]
  v_med3_f32 v128, v128, -v236, v236
  v_mfma_f32_16x16x32_bf16 v[204:207], v[76:79], v[84:87], v[204:207]
  v_med3_f32 v129, v129, -v236, v236
  v_mfma_f32_16x16x32_bf16 v[208:211], v[72:75], v[88:91], v[208:211]
  v_mfma_f32_16x16x32_bf16 v[208:211], v[76:79], v[92:95], v[208:211]
  v_med3_f32 v130, v130, -v236, v236
  v_mfma_f32_16x16x32_bf16 v[212:215], v[72:75], v[96:99], v[212:215]
  v_med3_f32 v131, v131, -v236, v236
  v_mfma_f32_16x16x32_bf16 v[212:215], v[76:79], v[100:103], v[212:215]
  v_mfma_f32_16x16x32_bf16 v[216:219], v[72:75], v[104:107], v[216:219]
  s_setprio 2
  s_barrier
  v_mfma_f32_16x16x32_bf16 v[216:219], v[76:79], v[108:111], v[216:219]
  s_setprio 0
  s_branch L_epi
L_dnn_h1:
  v_lshl_add_u32 v34, v49, 7, v15
  v_lshl_add_u32 v28, v45, 7, v14
  s_add_u32 m0, s76, 8192
  s_nop 0
  buffer_load_dwordx4 v28, s[32:35], 0 offen lds
  s_add_u32 m0, m0, 1024
  s_nop 0
  buffer_load_dwordx4 v34, s[32:35], 0 offen lds
  s_add_u32 m0, s75, 40960
  s_nop 0
  buffer_load_dwordx4 v29, s[44:47], s74 offen offset:0 lds
  buffer_load_dwordx4 v30, s[44:47], s74 offen offset:1024 lds
  buffer_load_dwordx4 v31, s[44:47], s74 offen offset:2048 lds
  buffer_load_dwordx4 v32, s[44:47], s74 offen offset:3072 lds
  s_add_u32 m0, m0, 4096
  s_nop 0
  buffer_load_dwordx4 v33, s[44:47], s74 offen offset:0 lds
  s_add_u32 s74, s74, 212992
  s_waitcnt vmcnt(13)
  s_waitcnt vmcnt(10) lgkmcnt(0)
  s_barrier
  buffer_load_dwordx3 v[24:26], v13, s[28:31], s73 offen offset:0
  buffer_load_dwordx3 v[240:242], v13, s[28:31], s73 offen offset:832
  s_add_u32 s73, s73, 12
  s_barrier
L_dnn_loop1:
  ds_read_b64_tr_b16 v[40:41], v1 offset:0
  s_add_u32 m0, s75, 81920
  s_nop 0
  buffer_load_dwordx4 v29, s[44:47], s74 offen offset:0 lds
  ds_read_b64_tr_b16 v[42:43], v1 offset:2560
  ds_read_b64_tr_b16 v[44:45], v1 offset:20480
  ds_read_b64_tr_b16 v[46:47], v1 offset:23040
  ds_read_b64_tr_b16 v[48:49], v2 offset:0
  buffer_load_dwordx4 v30, s[44:47], s74 offen offset:1024 lds
  ds_read_b64_tr_b16 v[50:51], v2 offset:2560
  ds_read_b64_tr_b16 v[52:53], v2 offset:20480
  ds_read_b64_tr_b16 v[54:55], v2 offset:23040
  ds_read_b64_tr_b16 v[56:57], v3 offset:0
  buffer_load_dwordx4 v31, s[44:47], s74 offen offset:2048 lds
  ds_read_b64_tr_b16 v[58:59], v3 offset:2560
  ds_read_b64_tr_b16 v[60:61], v3 offset:20480
  ds_read_b64_tr_b16 v[62:63], v3 offset:23040
  ds_read_b64_tr_b16 v[64:65], v4 offset:0
  buffer_load_dwordx4 v32, s[44:47], s74 offen offset:3072 lds
  ds_read_b64_tr_b16 v[66:67], v4 offset:2560
  ds_read_b64_tr_b16 v[68:69], v4 offset:20480
  ds_read_b64_tr_b16 v[70:71], v4 offset:23040
  ds_read_b128 v[80:83], v11 offset:0
  s_add_u32 m0, m0, 4096
  s_nop 0
  buffer_load_dwordx4 v33, s[44:47], s74 offen offset:0 lds
  s_add_u32 s74, s74, 212992
  ds_read_b128 v[84:87], v12 offset:0
  ds_read_b128 v[88:91], v11 offset:2048
  ds_read_b128 v[92:95], v12 offset:2048
  ds_read_b128 v[96:99], v11 offset:4096
  s_waitcnt vmcnt(14)
  v_lshl_add_u32 v34, v20, 7, v15
  v_lshl_add_u32 v28, v16, 7, v14
  s_add_u32 m0, s76, 0
  s_nop 0
  buffer_load_dwordx4 v28, s[32:35], 0 offen lds
  ds_read_b128 v[100:103], v12 offset:4096
  ds_read_b128 v[104:107], v11 offset:6144
  ds_read_b128 v[108:111], v12 offset:6144
  ds_read_b64_tr_b16 v[72:73], v5 offset:0
  s_add_u32 m0, m0, 1024
  s_nop 0
  buffer_load_dwordx4 v34, s[32:35], 0 offen lds
  ds_read_b64_tr_b16 v[74:75], v5 offset:2560
  ds_read_b64_tr_b16 v[76:77], v5 offset:20480
  ds_read_b64_tr_b16 v[78:79], v5 offset:23040
  s_waitcnt vmcnt(9) lgkmcnt(0)
  s_waitcnt vmcnt(9)
  s_barrier
  s_setprio 0
  v_mfma_f32_16x16x32_bf16 v[140:143], v[40:43], v[80:83], v[140:143]
  v_mfma_f32_16x16x32_bf16 v[140:143], v[44:47], v[84:87], v[140:143]
  v_mfma_f32_16x16x32_bf16 v[144:147], v[40:43], v[88:91], v[144:147]
  v_mfma_f32_16x16x32_bf16 v[144:147], v[44:47], v[92:95], v[144:147]
  v_mfma_f32_16x16x32_bf16 v[148:151], v[40:43], v[96:99], v[148:151]
  v_mfma_f32_16x16x32_bf16 v[148:151], v[44:47], v[100:103], v[148:151]
  v_mfma_f32_16x16x32_bf16 v[152:155], v[40:43], v[104:107], v[152:155]
  v_mfma_f32_16x16x32_bf16 v[152:155], v[44:47], v[108:111], v[152:155]
  v_mfma_f32_16x16x32_bf16 v[168:171], v[48:51], v[104:107], v[168:171]
  v_mfma_f32_16x16x32_bf16 v[168:171], v[52:55], v[108:111], v[168:171]
  v_mfma_f32_16x16x32_bf16 v[164:167], v[48:51], v[96:99], v[164:167]
  v_mfma_f32_16x16x32_bf16 v[164:167], v[52:55], v[100:103], v[164:167]
  v_mfma_f32_16x16x32_bf16 v[160:163], v[48:51], v[88:91], v[160:163]
  v_mfma_f32_16x16x32_bf16 v[160:163], v[52:55], v[92:95], v[160:163]
  v_mfma_f32_16x16x32_bf16 v[156:159], v[48:51], v[80:83], v[156:159]
  v_mfma_f32_16x16x32_bf16 v[156:159], v[52:55], v[84:87], v[156:159]
  v_mfma_f32_16x16x32_bf16 v[172:175], v[56:59], v[80:83], v[172:175]
  v_mfma_f32_16x16x32_bf16 v[172:175], v[60:63], v[84:87], v[172:175]
  v_mfma_f32_16x16x32_bf16 v[176:179], v[56:59], v[88:91], v[176:179]
  v_mfma_f32_16x16x32_bf16 v[176:179], v[60:63], v[92:95], v[176:179]
  v_mfma_f32_16x16x32_bf16 v[180:183], v[56:59], v[96:99], v[180:183]
  v_mfma_f32_16x16x32_bf16 v[180:183], v[60:63], v[100:103], v[180:183]
  v_mfma_f32_16x16x32_bf16 v[184:187], v[56:59], v[104:107], v[184:187]
  v_mfma_f32_16x16x32_bf16 v[184:187], v[60:63], v[108:111], v[184:187]
  v_mfma_f32_16x16x32_bf16 v[200:203], v[64:67], v[104:107], v[200:203]
  v_mfma_f32_16x16x32_bf16 v[200:203], v[68:71], v[108:111], v[200:203]
  v_mfma_f32_16x16x32_bf16 v[196:199], v[64:67], v[96:99], v[196:199]
  v_mfma_f32_16x16x32_bf16 v[196:199], v[68:71], v[100:103], v[196:199]
  v_mfma_f32_16x16x32_bf16 v[192:195], v[64:67], v[88:91], v[192:195]
  v_mfma_f32_16x16x32_bf16 v[192:195], v[68:71], v[92:95], v[192:195]
  v_mfma_f32_16x16x32_bf16 v[188:191], v[64:67], v[80:83], v[188:191]
  v_mfma_f32_16x16x32_bf16 v[188:191], v[68:71], v[84:87], v[188:191]
  v_mfma_f32_16x16x32_bf16 v[204:207], v[72:75], v[80:83], v[204:207]
  v_mfma_f32_16x16x32_bf16 v[204:207], v[76:79], v[84:87], v[204:207]
  v_mfma_f32_16x16x32_bf16 v[208:211], v[72:75], v[88:91], v[208:211]
  v_mfma_f32_16x16x32_bf16 v[208:211], v[76:79], v[92:95], v[208:211]
  v_mfma_f32_16x16x32_bf16 v[212:215], v[72:75], v[96:99], v[212:215]
  v_mfma_f32_16x16x32_bf16 v[212:215], v[76:79], v[100:103], v[212:215]
  v_mfma_f32_16x16x32_bf16 v[216:219], v[72:75], v[104:107], v[216:219]
  s_setprio 2
  s_barrier
  v_mfma_f32_16x16x32_bf16 v[216:219], v[76:79], v[108:111], v[216:219]
  ds_read_b64_tr_b16 v[40:41], v1 offset:40960
  s_add_u32 m0, s75, 0
  s_nop 0
  buffer_load_dwordx4 v29, s[44:47], s74 offen offset:0 lds
  ds_read_b64_tr_b16 v[42:43], v1 offset:43520
  ds_read_b64_tr_b16 v[44:45], v6 offset:0
  ds_read_b64_tr_b16 v[46:47], v6 offset:2560
  ds_read_b64_tr_b16 v[48:49], v2 offset:40960
  buffer_load_dwordx4 v30, s[44:47], s74 offen offset:1024 lds
  ds_read_b64_tr_b16 v[50:51], v2 offset:43520
  ds_read_b64_tr_b16 v[52:53], v7 offset:0
  ds_read_b64_tr_b16 v[54:55], v7 offset:2560
  ds_read_b64_tr_b16 v[56:57], v3 offset:40960
  buffer_load_dwordx4 v31, s[44:47], s74 offen offset:2048 lds
  ds_read_b64_tr_b16 v[58:59], v3 offset:43520
  ds_read_b64_tr_b16 v[60:61], v8 offset:0
  ds_read_b64_tr_b16 v[62:63], v8 offset:2560
  ds_read_b64_tr_b16 v[64:65], v4 offset:40960
  buffer_load_dwordx4 v32, s[44:47], s74 offen offset:3072 lds
  ds_read_b64_tr_b16 v[66:67], v4 offset:43520
  ds_read_b64_tr_b16 v[68:69], v9 offset:0
  ds_read_b64_tr_b16 v[70:71], v9 offset:2560
  ds_read_b128 v[80:83], v11 offset:8192
  s_add_u32 m0, m0, 4096
  s_nop 0
  buffer_load_dwordx4 v33, s[44:47], s74 offen offset:0 lds
  s_add_u32 s74, s74, 212992
  ds_read_b128 v[84:87], v12 offset:8192
  ds_read_b128 v[88:91], v11 offset:10240
  ds_read_b128 v[92:95], v12 offset:10240
  ds_read_b128 v[96:99], v11 offset:12288
  v_lshl_add_u32 v34, v21, 7, v15
  v_lshl_add_u32 v28, v17, 7, v14
  s_add_u32 m0, s76, 8192
  s_nop 0
  buffer_load_dwordx4 v28, s[32:35], 0 offen lds
  ds_read_b128 v[100:103], v12 offset:12288
  ds_read_b128 v[104:107], v11 offset:14336
  ds_read_b128 v[108:111], v12 offset:14336
  ds_read_b64_tr_b16 v[72:73], v5 offset:40960
  s_add_u32 m0, m0, 1024
  s_nop 0
  buffer_load_dwordx4 v34, s[32:35], 0 offen lds
  ds_read_b64_tr_b16 v[74:75], v5 offset:43520
  ds_read_b64_tr_b16 v[76:77], v10 offset:0
  ds_read_b64_tr_b16 v[78:79], v10 offset:2560
  s_waitcnt vmcnt(7) lgkmcnt(0)
  s_barrier
  s_setprio 0
  v_mfma_f32_16x16x32_bf16 v[140:143], v[40:43], v[80:83], v[140:143]
  v_mfma_f32_16x16x32_bf16 v[140:143], v[44:47], v[84:87], v[140:143]
  v_mfma_f32_16x16x32_bf16 v[144:147], v[40:43], v[88:91], v[144:147]
  v_mfma_f32_16x16x32_bf16 v[144:147], v[44:47], v[92:95], v[144:147]
  v_mfma_f32_16x16x32_bf16 v[148:151], v[40:43], v[96:99], v[148:151]
  v_mfma_f32_16x16x32_bf16 v[148:151], v[44:47], v[100:103], v[148:151]
  v_mfma_f32_16x16x32_bf16 v[152:155], v[40:43], v[104:107], v[152:155]
  v_mfma_f32_16x16x32_bf16 v[152:155], v[44:47], v[108:111], v[152:155]
  v_mfma_f32_16x16x32_bf16 v[168:171], v[48:51], v[104:107], v[168:171]
  v_mfma_f32_16x16x32_bf16 v[168:171], v[52:55], v[108:111], v[168:171]
  v_mfma_f32_16x16x32_bf16 v[164:167], v[48:51], v[96:99], v[164:167]
  v_mfma_f32_16x16x32_bf16 v[164:167], v[52:55], v[100:103], v[164:167]
  v_mfma_f32_16x16x32_bf16 v[160:163], v[48:51], v[88:91], v[160:163]
  v_mfma_f32_16x16x32_bf16 v[160:163], v[52:55], v[92:95], v[160:163]
  v_mfma_f32_16x16x32_bf16 v[156:159], v[48:51], v[80:83], v[156:159]
  v_mfma_f32_16x16x32_bf16 v[156:159], v[52:55], v[84:87], v[156:159]
  v_mfma_f32_16x16x32_bf16 v[172:175], v[56:59], v[80:83], v[172:175]
  v_mfma_f32_16x16x32_bf16 v[172:175], v[60:63], v[84:87], v[172:175]
  v_mfma_f32_16x16x32_bf16 v[176:179], v[56:59], v[88:91], v[176:179]
  v_mfma_f32_16x16x32_bf16 v[176:179], v[60:63], v[92:95], v[176:179]
  v_mfma_f32_16x16x32_bf16 v[180:183], v[56:59], v[96:99], v[180:183]
  v_mfma_f32_16x16x32_bf16 v[180:183], v[60:63], v[100:103], v[180:183]
  v_mfma_f32_16x16x32_bf16 v[184:187], v[56:59], v[104:107], v[184:187]
  v_mfma_f32_16x16x32_bf16 v[184:187], v[60:63], v[108:111], v[184:187]
  v_mfma_f32_16x16x32_bf16 v[200:203], v[64:67], v[104:107], v[200:203]
  v_mfma_f32_16x16x32_bf16 v[200:203], v[68:71], v[108:111], v[200:203]
  v_mfma_f32_16x16x32_bf16 v[196:199], v[64:67], v[96:99], v[196:199]
  v_mfma_f32_16x16x32_bf16 v[196:199], v[68:71], v[100:103], v[196:199]
  v_mfma_f32_16x16x32_bf16 v[192:195], v[64:67], v[88:91], v[192:195]
  v_mfma_f32_16x16x32_bf16 v[192:195], v[68:71], v[92:95], v[192:195]
  v_mfma_f32_16x16x32_bf16 v[188:191], v[64:67], v[80:83], v[188:191]
  v_mfma_f32_16x16x32_bf16 v[188:191], v[68:71], v[84:87], v[188:191]
  v_mfma_f32_16x16x32_bf16 v[204:207], v[72:75], v[80:83], v[204:207]
  v_mfma_f32_16x16x32_bf16 v[204:207], v[76:79], v[84:87], v[204:207]
  v_mfma_f32_16x16x32_bf16 v[208:211], v[72:75], v[88:91], v[208:211]
  v_mfma_f32_16x16x32_bf16 v[208:211], v[76:79], v[92:95], v[208:211]
  v_mfma_f32_16x16x32_bf16 v[212:215], v[72:75], v[96:99], v[212:215]
  v_mfma_f32_16x16x32_bf16 v[212:215], v[76:79], v[100:103], v[212:215]
  v_mfma_f32_16x16x32_bf16 v[216:219], v[72:75], v[104:107], v[216:219]
  s_setprio 2
  s_barrier
  v_mfma_f32_16x16x32_bf16 v[216:219], v[76:79], v[108:111], v[216:219]
  ds_read_b64_tr_b16 v[40:41], v6 offset:20480
  s_add_u32 m0, s75, 40960
  s_nop 0
  buffer_load_dwordx4 v29, s[44:47], s74 offen offset:0 lds
  ds_read_b64_tr_b16 v[42:43], v6 offset:23040
  ds_read_b64_tr_b16 v[44:45], v6 offset:40960
  ds_read_b64_tr_b16 v[46:47], v6 offset:43520
  ds_read_b64_tr_b16 v[48:49], v7 offset:20480
  buffer_load_dwordx4 v30, s[44:47], s74 offen offset:1024 lds
  ds_read_b64_tr_b16 v[50:51], v7 offset:23040
  ds_read_b64_tr_b16 v[52:53], v7 offset:40960
  ds_read_b64_tr_b16 v[54:55], v7 offset:43520
  ds_read_b64_tr_b16 v[56:57], v8 offset:20480
  buffer_load_dwordx4 v31, s[44:47], s74 offen offset:2048 lds
  ds_read_b64_tr_b16 v[58:59], v8 offset:23040
  ds_read_b64_tr_b16 v[60:61], v8 offset:40960
  ds_read_b64_tr_b16 v[62:63], v8 offset:43520
  ds_read_b64_tr_b16 v[64:65], v9 offset:20480
  buffer_load_dwordx4 v32, s[44:47], s74 offen offset:3072 lds
  ds_read_b64_tr_b16 v[66:67], v9 offset:23040
  ds_read_b64_tr_b16 v[68:69], v9 offset:40960
  ds_read_b64_tr_b16 v[70:71], v9 offset:43520
  ds_read_b128 v[80:83], v11 offset:0
  s_add_u32 m0, m0, 4096
  s_nop 0
  buffer_load_dwordx4 v33, s[44:47], s74 offen offset:0 lds
  s_add_u32 s74, s74, 212992
  ds_read_b128 v[84:87], v12 offset:0
  ds_read_b128 v[88:91], v11 offset:2048
  ds_read_b128 v[92:95], v12 offset:2048
  ds_read_b128 v[96:99], v11 offset:4096
  v_lshl_add_u32 v34, v22, 7, v15
  v_lshl_add_u32 v28, v18, 7, v14
  s_add_u32 m0, s76, 0
  s_nop 0
  buffer_load_dwordx4 v28, s[32:35], 0 offen lds
  ds_read_b128 v[100:103], v12 offset:4096
  ds_read_b128 v[104:107], v11 offset:6144
  ds_read_b128 v[108:111], v12 offset:6144
  ds_read_b64_tr_b16 v[72:73], v10 offset:20480
  s_add_u32 m0, m0, 1024
  s_nop 0
  buffer_load_dwordx4 v34, s[32:35], 0 offen lds
  ds_read_b64_tr_b16 v[74:75], v10 offset:23040
  ds_read_b64_tr_b16 v[76:77], v10 offset:40960
  ds_read_b64_tr_b16 v[78:79], v10 offset:43520
  buffer_load_dwordx3 v[16:18], v13, s[28:31], s73 offen offset:0
  buffer_load_dwordx3 v[20:22], v13, s[28:31], s73 offen offset:832
  s_add_u32 s73, s73, 12
  s_waitcnt vmcnt(9) lgkmcnt(0)
  s_barrier
  s_setprio 0
  v_mfma_f32_16x16x32_bf16 v[140:143], v[40:43], v[80:83], v[140:143]
  v_mfma_f32_16x16x32_bf16 v[140:143], v[44:47], v[84:87], v[140:143]
  v_mfma_f32_16x16x32_bf16 v[144:147], v[40:43], v[88:91], v[144:147]
  v_mfma_f32_16x16x32_bf16 v[144:147], v[44:47], v[92:95], v[144:147]
  v_mfma_f32_16x16x32_bf16 v[148:151], v[40:43], v[96:99], v[148:151]
  v_mfma_f32_16x16x32_bf16 v[148:151], v[44:47], v[100:103], v[148:151]
  v_mfma_f32_16x16x32_bf16 v[152:155], v[40:43], v[104:107], v[152:155]
  v_mfma_f32_16x16x32_bf16 v[152:155], v[44:47], v[108:111], v[152:155]
  v_mfma_f32_16x16x32_bf16 v[168:171], v[48:51], v[104:107], v[168:171]
  v_mfma_f32_16x16x32_bf16 v[168:171], v[52:55], v[108:111], v[168:171]
  v_mfma_f32_16x16x32_bf16 v[164:167], v[48:51], v[96:99], v[164:167]
  v_mfma_f32_16x16x32_bf16 v[164:167], v[52:55], v[100:103], v[164:167]
  v_mfma_f32_16x16x32_bf16 v[160:163], v[48:51], v[88:91], v[160:163]
  v_mfma_f32_16x16x32_bf16 v[160:163], v[52:55], v[92:95], v[160:163]
  v_mfma_f32_16x16x32_bf16 v[156:159], v[48:51], v[80:83], v[156:159]
  v_mfma_f32_16x16x32_bf16 v[156:159], v[52:55], v[84:87], v[156:159]
  v_mfma_f32_16x16x32_bf16 v[172:175], v[56:59], v[80:83], v[172:175]
  v_mfma_f32_16x16x32_bf16 v[172:175], v[60:63], v[84:87], v[172:175]
  v_mfma_f32_16x16x32_bf16 v[176:179], v[56:59], v[88:91], v[176:179]
  v_mfma_f32_16x16x32_bf16 v[176:179], v[60:63], v[92:95], v[176:179]
  v_mfma_f32_16x16x32_bf16 v[180:183], v[56:59], v[96:99], v[180:183]
  v_mfma_f32_16x16x32_bf16 v[180:183], v[60:63], v[100:103], v[180:183]
  v_mfma_f32_16x16x32_bf16 v[184:187], v[56:59], v[104:107], v[184:187]
  v_mfma_f32_16x16x32_bf16 v[184:187], v[60:63], v[108:111], v[184:187]
  v_mfma_f32_16x16x32_bf16 v[200:203], v[64:67], v[104:107], v[200:203]
  v_mfma_f32_16x16x32_bf16 v[200:203], v[68:71], v[108:111], v[200:203]
  v_mfma_f32_16x16x32_bf16 v[196:199], v[64:67], v[96:99], v[196:199]
  v_mfma_f32_16x16x32_bf16 v[196:199], v[68:71], v[100:103], v[196:199]
  v_mfma_f32_16x16x32_bf16 v[192:195], v[64:67], v[88:91], v[192:195]
  v_mfma_f32_16x16x32_bf16 v[192:195], v[68:71], v[92:95], v[192:195]
  v_mfma_f32_16x16x32_bf16 v[188:191], v[64:67], v[80:83], v[188:191]
  v_mfma_f32_16x16x32_bf16 v[188:191], v[68:71], v[84:87], v[188:191]
  v_mfma_f32_16x16x32_bf16 v[204:207], v[72:75], v[80:83], v[204:207]
  v_mfma_f32_16x16x32_bf16 v[204:207], v[76:79], v[84:87], v[204:207]
  v_mfma_f32_16x16x32_bf16 v[208:211], v[72:75], v[88:91], v[208:211]
  v_mfma_f32_16x16x32_bf16 v[208:211], v[76:79], v[92:95], v[208:211]
  v_mfma_f32_16x16x32_bf16 v[212:215], v[72:75], v[96:99], v[212:215]
  v_mfma_f32_16x16x32_bf16 v[212:215], v[76:79], v[100:103], v[212:215]
  v_mfma_f32_16x16x32_bf16 v[216:219], v[72:75], v[104:107], v[216:219]
  s_setprio 2
  s_barrier
  v_mfma_f32_16x16x32_bf16 v[216:219], v[76:79], v[108:111], v[216:219]
  ds_read_b64_tr_b16 v[40:41], v1 offset:0
  s_add_u32 m0, s75, 81920
  s_nop 0
  buffer_load_dwordx4 v29, s[44:47], s74 offen offset:0 lds
  ds_read_b64_tr_b16 v[42:43], v1 offset:2560
  ds_read_b64_tr_b16 v[44:45], v1 offset:20480
  ds_read_b64_tr_b16 v[46:47], v1 offset:23040
  ds_read_b64_tr_b16 v[48:49], v2 offset:0
  buffer_load_dwordx4 v30, s[44:47], s74 offen offset:1024 lds
  ds_read_b64_tr_b16 v[50:51], v2 offset:2560
  ds_read_b64_tr_b16 v[52:53], v2 offset:20480
  ds_read_b64_tr_b16 v[54:55], v2 offset:23040
  ds_read_b64_tr_b16 v[56:57], v3 offset:0
  buffer_load_dwordx4 v31, s[44:47], s74 offen offset:2048 lds
  ds_read_b64_tr_b16 v[58:59], v3 offset:2560
  ds_read_b64_tr_b16 v[60:61], v3 offset:20480
  ds_read_b64_tr_b16 v[62:63], v3 offset:23040
  ds_read_b64_tr_b16 v[64:65], v4 offset:0
  buffer_load_dwordx4 v32, s[44:47], s74 offen offset:3072 lds
  ds_read_b64_tr_b16 v[66:67], v4 offset:2560
  ds_read_b64_tr_b16 v[68:69], v4 offset:20480
  ds_read_b64_tr_b16 v[70:71], v4 offset:23040
  ds_read_b128 v[80:83], v11 offset:8192
  s_add_u32 m0, m0, 4096
  s_nop 0
  buffer_load_dwordx4 v33, s[44:47], s74 offen offset:0 lds
  s_add_u32 s74, s74, 212992
  ds_read_b128 v[84:87], v12 offset:8192
  ds_read_b128 v[88:91], v11 offset:10240
  ds_read_b128 v[92:95], v12 offset:10240
  ds_read_b128 v[96:99], v11 offset:12288
  v_lshl_add_u32 v34, v240, 7, v15
  v_lshl_add_u32 v28, v24, 7, v14
  s_add_u32 m0, s76, 8192
  s_nop 0
  buffer_load_dwordx4 v28, s[32:35], 0 offen lds
  ds_read_b128 v[100:103], v12 offset:12288
  ds_read_b128 v[104:107], v11 offset:14336
  ds_read_b128 v[108:111], v12 offset:14336
  ds_read_b64_tr_b16 v[72:73], v5 offset:0
  s_add_u32 m0, m0, 1024
  s_nop 0
  buffer_load_dwordx4 v34, s[32:35], 0 offen lds
  ds_read_b64_tr_b16 v[74:75], v5 offset:2560
  ds_read_b64_tr_b16 v[76:77], v5 offset:20480
  ds_read_b64_tr_b16 v[78:79], v5 offset:23040
  s_waitcnt vmcnt(9) lgkmcnt(0)
  s_barrier
  s_setprio 0
  v_mfma_f32_16x16x32_bf16 v[140:143], v[40:43], v[80:83], v[140:143]
  v_mfma_f32_16x16x32_bf16 v[140:143], v[44:47], v[84:87], v[140:143]
  v_mfma_f32_16x16x32_bf16 v[144:147], v[40:43], v[88:91], v[144:147]
  v_mfma_f32_16x16x32_bf16 v[144:147], v[44:47], v[92:95], v[144:147]
  v_mfma_f32_16x16x32_bf16 v[148:151], v[40:43], v[96:99], v[148:151]
  v_mfma_f32_16x16x32_bf16 v[148:151], v[44:47], v[100:103], v[148:151]
  v_mfma_f32_16x16x32_bf16 v[152:155], v[40:43], v[104:107], v[152:155]
  v_mfma_f32_16x16x32_bf16 v[152:155], v[44:47], v[108:111], v[152:155]
  v_mfma_f32_16x16x32_bf16 v[168:171], v[48:51], v[104:107], v[168:171]
  v_mfma_f32_16x16x32_bf16 v[168:171], v[52:55], v[108:111], v[168:171]
  v_mfma_f32_16x16x32_bf16 v[164:167], v[48:51], v[96:99], v[164:167]
  v_mfma_f32_16x16x32_bf16 v[164:167], v[52:55], v[100:103], v[164:167]
  v_mfma_f32_16x16x32_bf16 v[160:163], v[48:51], v[88:91], v[160:163]
  v_mfma_f32_16x16x32_bf16 v[160:163], v[52:55], v[92:95], v[160:163]
  v_mfma_f32_16x16x32_bf16 v[156:159], v[48:51], v[80:83], v[156:159]
  v_mfma_f32_16x16x32_bf16 v[156:159], v[52:55], v[84:87], v[156:159]
  v_mfma_f32_16x16x32_bf16 v[172:175], v[56:59], v[80:83], v[172:175]
  v_mfma_f32_16x16x32_bf16 v[172:175], v[60:63], v[84:87], v[172:175]
  v_mfma_f32_16x16x32_bf16 v[176:179], v[56:59], v[88:91], v[176:179]
  v_mfma_f32_16x16x32_bf16 v[176:179], v[60:63], v[92:95], v[176:179]
  v_mfma_f32_16x16x32_bf16 v[180:183], v[56:59], v[96:99], v[180:183]
  v_mfma_f32_16x16x32_bf16 v[180:183], v[60:63], v[100:103], v[180:183]
  v_mfma_f32_16x16x32_bf16 v[184:187], v[56:59], v[104:107], v[184:187]
  v_mfma_f32_16x16x32_bf16 v[184:187], v[60:63], v[108:111], v[184:187]
  v_mfma_f32_16x16x32_bf16 v[200:203], v[64:67], v[104:107], v[200:203]
  v_mfma_f32_16x16x32_bf16 v[200:203], v[68:71], v[108:111], v[200:203]
  v_mfma_f32_16x16x32_bf16 v[196:199], v[64:67], v[96:99], v[196:199]
  v_mfma_f32_16x16x32_bf16 v[196:199], v[68:71], v[100:103], v[196:199]
  v_mfma_f32_16x16x32_bf16 v[192:195], v[64:67], v[88:91], v[192:195]
  v_mfma_f32_16x16x32_bf16 v[192:195], v[68:71], v[92:95], v[192:195]
  v_mfma_f32_16x16x32_bf16 v[188:191], v[64:67], v[80:83], v[188:191]
  v_mfma_f32_16x16x32_bf16 v[188:191], v[68:71], v[84:87], v[188:191]
  v_mfma_f32_16x16x32_bf16 v[204:207], v[72:75], v[80:83], v[204:207]
  v_mfma_f32_16x16x32_bf16 v[204:207], v[76:79], v[84:87], v[204:207]
  v_mfma_f32_16x16x32_bf16 v[208:211], v[72:75], v[88:91], v[208:211]
  v_mfma_f32_16x16x32_bf16 v[208:211], v[76:79], v[92:95], v[208:211]
  v_mfma_f32_16x16x32_bf16 v[212:215], v[72:75], v[96:99], v[212:215]
  v_mfma_f32_16x16x32_bf16 v[212:215], v[76:79], v[100:103], v[212:215]
  v_mfma_f32_16x16x32_bf16 v[216:219], v[72:75], v[104:107], v[216:219]
  s_setprio 2
  s_barrier
  v_mfma_f32_16x16x32_bf16 v[216:219], v[76:79], v[108:111], v[216:219]
  ds_read_b64_tr_b16 v[40:41], v1 offset:40960
  s_add_u32 m0, s75, 0
  s_nop 0
  buffer_load_dwordx4 v29, s[44:47], s74 offen offset:0 lds
  ds_read_b64_tr_b16 v[42:43], v1 offset:43520
  ds_read_b64_tr_b16 v[44:45], v6 offset:0
  ds_read_b64_tr_b16 v[46:47], v6 offset:2560
  ds_read_b64_tr_b16 v[48:49], v2 offset:40960
  buffer_load_dwordx4 v30, s[44:47], s74 offen offset:1024 lds
  ds_read_b64_tr_b16 v[50:51], v2 offset:43520
  ds_read_b64_tr_b16 v[52:53], v7 offset:0
  ds_read_b64_tr_b16 v[54:55], v7 offset:2560
  ds_read_b64_tr_b16 v[56:57], v3 offset:40960
  buffer_load_dwordx4 v31, s[44:47], s74 offen offset:2048 lds
  ds_read_b64_tr_b16 v[58:59], v3 offset:43520
  ds_read_b64_tr_b16 v[60:61], v8 offset:0
  ds_read_b64_tr_b16 v[62:63], v8 offset:2560
  ds_read_b64_tr_b16 v[64:65], v4 offset:40960
  buffer_load_dwordx4 v32, s[44:47], s74 offen offset:3072 lds
  ds_read_b64_tr_b16 v[66:67], v4 offset:43520
  ds_read_b64_tr_b16 v[68:69], v9 offset:0
  ds_read_b64_tr_b16 v[70:71], v9 offset:2560
  ds_read_b128 v[80:83], v11 offset:0
  s_add_u32 m0, m0, 4096
  s_nop 0
  buffer_load_dwordx4 v33, s[44:47], s74 offen offset:0 lds
  s_add_u32 s74, s74, 212992
  ds_read_b128 v[84:87], v12 offset:0
  ds_read_b128 v[88:91], v11 offset:2048
  ds_read_b128 v[92:95], v12 offset:2048
  ds_read_b128 v[96:99], v11 offset:4096
  v_lshl_add_u32 v34, v241, 7, v15
  v_lshl_add_u32 v28, v25, 7, v14
  s_add_u32 m0, s76, 0
  s_nop 0
  buffer_load_dwordx4 v28, s[32:35], 0 offen lds
  ds_read_b128 v[100:103], v12 offset:4096
  ds_read_b128 v[104:107], v11 offset:6144
  ds_read_b128 v[108:111], v12 offset:6144
  ds_read_b64_tr_b16 v[72:73], v5 offset:40960
  s_add_u32 m0, m0, 1024
  s_nop 0
  buffer_load_dwordx4 v34, s[32:35], 0 offen lds
  ds_read_b64_tr_b16 v[74:75], v5 offset:43520
  ds_read_b64_tr_b16 v[76:77], v10 offset:0
  ds_read_b64_tr_b16 v[78:79], v10 offset:2560
  s_mov_b32 m0, 156288
  s_mov_b32 exec_hi, 0xff
  buffer_load_dwordx4 v37, s[52:55], s77 offen lds
  s_mov_b64 exec, -1
  s_waitcnt vmcnt(8) lgkmcnt(0)
  s_barrier
  s_setprio 0
  v_mfma_f32_16x16x32_bf16 v[140:143], v[40:43], v[80:83], v[140:143]
  v_mfma_f32_16x16x32_bf16 v[140:143], v[44:47], v[84:87], v[140:143]
  v_mfma_f32_16x16x32_bf16 v[144:147], v[40:43], v[88:91], v[144:147]
  v_mfma_f32_16x16x32_bf16 v[144:147], v[44:47], v[92:95], v[144:147]
  v_mfma_f32_16x16x32_bf16 v[148:151], v[40:43], v[96:99], v[148:151]
  v_mfma_f32_16x16x32_bf16 v[148:151], v[44:47], v[100:103], v[148:151]
  v_mfma_f32_16x16x32_bf16 v[152:155], v[40:43], v[104:107], v[152:155]
  v_mfma_f32_16x16x32_bf16 v[152:155], v[44:47], v[108:111], v[152:155]
  v_mfma_f32_16x16x32_bf16 v[168:171], v[48:51], v[104:107], v[168:171]
  v_mfma_f32_16x16x32_bf16 v[168:171], v[52:55], v[108:111], v[168:171]
  v_mfma_f32_16x16x32_bf16 v[164:167], v[48:51], v[96:99], v[164:167]
  v_mfma_f32_16x16x32_bf16 v[164:167], v[52:55], v[100:103], v[164:167]
  v_mfma_f32_16x16x32_bf16 v[160:163], v[48:51], v[88:91], v[160:163]
  v_mfma_f32_16x16x32_bf16 v[160:163], v[52:55], v[92:95], v[160:163]
  v_mfma_f32_16x16x32_bf16 v[156:159], v[48:51], v[80:83], v[156:159]
  v_mfma_f32_16x16x32_bf16 v[156:159], v[52:55], v[84:87], v[156:159]
  v_mfma_f32_16x16x32_bf16 v[172:175], v[56:59], v[80:83], v[172:175]
  v_mfma_f32_16x16x32_bf16 v[172:175], v[60:63], v[84:87], v[172:175]
  v_mfma_f32_16x16x32_bf16 v[176:179], v[56:59], v[88:91], v[176:179]
  v_mfma_f32_16x16x32_bf16 v[176:179], v[60:63], v[92:95], v[176:179]
  v_mfma_f32_16x16x32_bf16 v[180:183], v[56:59], v[96:99], v[180:183]
  v_mfma_f32_16x16x32_bf16 v[180:183], v[60:63], v[100:103], v[180:183]
  v_mfma_f32_16x16x32_bf16 v[184:187], v[56:59], v[104:107], v[184:187]
  v_mfma_f32_16x16x32_bf16 v[184:187], v[60:63], v[108:111], v[184:187]
  v_mfma_f32_16x16x32_bf16 v[200:203], v[64:67], v[104:107], v[200:203]
  v_mfma_f32_16x16x32_bf16 v[200:203], v[68:71], v[108:111], v[200:203]
  v_mfma_f32_16x16x32_bf16 v[196:199], v[64:67], v[96:99], v[196:199]
  v_mfma_f32_16x16x32_bf16 v[196:199], v[68:71], v[100:103], v[196:199]
  v_mfma_f32_16x16x32_bf16 v[192:195], v[64:67], v[88:91], v[192:195]
  v_mfma_f32_16x16x32_bf16 v[192:195], v[68:71], v[92:95], v[192:195]
  v_mfma_f32_16x16x32_bf16 v[188:191], v[64:67], v[80:83], v[188:191]
  v_mfma_f32_16x16x32_bf16 v[188:191], v[68:71], v[84:87], v[188:191]
  v_mfma_f32_16x16x32_bf16 v[204:207], v[72:75], v[80:83], v[204:207]
  v_mfma_f32_16x16x32_bf16 v[204:207], v[76:79], v[84:87], v[204:207]
  v_mfma_f32_16x16x32_bf16 v[208:211], v[72:75], v[88:91], v[208:211]
  v_mfma_f32_16x16x32_bf16 v[208:211], v[76:79], v[92:95], v[208:211]
  v_mfma_f32_16x16x32_bf16 v[212:215], v[72:75], v[96:99], v[212:215]
  v_mfma_f32_16x16x32_bf16 v[212:215], v[76:79], v[100:103], v[212:215]
  v_mfma_f32_16x16x32_bf16 v[216:219], v[72:75], v[104:107], v[216:219]
  s_setprio 2
  s_barrier
  v_mfma_f32_16x16x32_bf16 v[216:219], v[76:79], v[108:111], v[216:219]
  ds_read_b64_tr_b16 v[40:41], v6 offset:20480
  s_add_u32 m0, s75, 40960
  s_nop 0
  buffer_load_dwordx4 v29, s[44:47], s74 offen offset:0 lds
  ds_read_b64_tr_b16 v[42:43], v6 offset:23040
  ds_read_b64_tr_b16 v[44:45], v6 offset:40960
  ds_read_b64_tr_b16 v[46:47], v6 offset:43520
  ds_read_b64_tr_b16 v[48:49], v7 offset:20480
  buffer_load_dwordx4 v30, s[44:47], s74 offen offset:1024 lds
  ds_read_b64_tr_b16 v[50:51], v7 offset:23040
  ds_read_b64_tr_b16 v[52:53], v7 offset:40960
  ds_read_b64_tr_b16 v[54:55], v7 offset:43520
  ds_read_b64_tr_b16 v[56:57], v8 offset:20480
  buffer_load_dwordx4 v31, s[44:47], s74 offen offset:2048 lds
  ds_read_b64_tr_b16 v[58:59], v8 offset:23040
  ds_read_b64_tr_b16 v[60:61], v8 offset:40960
  ds_read_b64_tr_b16 v[62:63], v8 offset:43520
  ds_read_b64_tr_b16 v[64:65], v9 offset:20480
  buffer_load_dwordx4 v32, s[44:47], s74 offen offset:3072 lds
  ds_read_b64_tr_b16 v[66:67], v9 offset:23040
  ds_read_b64_tr_b16 v[68:69], v9 offset:40960
  ds_read_b64_tr_b16 v[70:71], v9 offset:43520
  ds_read_b128 v[80:83], v11 offset:8192
  s_add_u32 m0, m0, 4096
  s_nop 0
  buffer_load_dwordx4 v33, s[44:47], s74 offen offset:0 lds
  s_add_u32 s74, s74, 212992
  ds_read_b128 v[84:87], v12 offset:8192
  ds_read_b128 v[88:91], v11 offset:10240
  ds_read_b128 v[92:95], v12 offset:10240
  ds_read_b128 v[96:99], v11 offset:12288
  v_lshl_add_u32 v34, v242, 7, v15
  v_lshl_add_u32 v28, v26, 7, v14
  s_add_u32 m0, s76, 8192
  s_nop 0
  buffer_load_dwordx4 v28, s[32:35], 0 offen lds
  ds_read_b128 v[100:103], v12 offset:12288
  ds_read_b128 v[104:107], v11 offset:14336
  ds_read_b128 v[108:111], v12 offset:14336
  ds_read_b64_tr_b16 v[72:73], v10 offset:20480
  s_add_u32 m0, m0, 1024
  s_nop 0
  buffer_load_dwordx4 v34, s[32:35], 0 offen lds
  ds_read_b64_tr_b16 v[74:75], v10 offset:23040
  ds_read_b64_tr_b16 v[76:77], v10 offset:40960
  ds_read_b64_tr_b16 v[78:79], v10 offset:43520
  buffer_load_dwordx3 v[24:26], v13, s[28:31], s73 offen offset:0
  buffer_load_dwordx3 v[240:242], v13, s[28:31], s73 offen offset:832
  s_add_u32 s73, s73, 12
  s_waitcnt vmcnt(10) lgkmcnt(0)
  s_barrier
  s_setprio 0
  v_mfma_f32_16x16x32_bf16 v[140:143], v[40:43], v[80:83], v[140:143]
  s_add_u32 s72, s72, 1
  v_mfma_f32_16x16x32_bf16 v[140:143], v[44:47], v[84:87], v[140:143]
  v_mfma_f32_16x16x32_bf16 v[144:147], v[40:43], v[88:91], v[144:147]
  v_mfma_f32_16x16x32_bf16 v[144:147], v[44:47], v[92:95], v[144:147]
  v_mfma_f32_16x16x32_bf16 v[148:151], v[40:43], v[96:99], v[148:151]
  v_mfma_f32_16x16x32_bf16 v[148:151], v[44:47], v[100:103], v[148:151]
  v_mfma_f32_16x16x32_bf16 v[152:155], v[40:43], v[104:107], v[152:155]
  v_mfma_f32_16x16x32_bf16 v[152:155], v[44:47], v[108:111], v[152:155]
  v_mfma_f32_16x16x32_bf16 v[168:171], v[48:51], v[104:107], v[168:171]
  v_mfma_f32_16x16x32_bf16 v[168:171], v[52:55], v[108:111], v[168:171]
  v_mfma_f32_16x16x32_bf16 v[164:167], v[48:51], v[96:99], v[164:167]
  v_mfma_f32_16x16x32_bf16 v[164:167], v[52:55], v[100:103], v[164:167]
  v_mfma_f32_16x16x32_bf16 v[160:163], v[48:51], v[88:91], v[160:163]
  v_mfma_f32_16x16x32_bf16 v[160:163], v[52:55], v[92:95], v[160:163]
  v_mfma_f32_16x16x32_bf16 v[156:159], v[48:51], v[80:83], v[156:159]
  v_mfma_f32_16x16x32_bf16 v[156:159], v[52:55], v[84:87], v[156:159]
  v_mfma_f32_16x16x32_bf16 v[172:175], v[56:59], v[80:83], v[172:175]
  v_mfma_f32_16x16x32_bf16 v[172:175], v[60:63], v[84:87], v[172:175]
  v_mfma_f32_16x16x32_bf16 v[176:179], v[56:59], v[88:91], v[176:179]
  v_mfma_f32_16x16x32_bf16 v[176:179], v[60:63], v[92:95], v[176:179]
  s_cmp_lt_u32 s72, 4
  v_mfma_f32_16x16x32_bf16 v[180:183], v[56:59], v[96:99], v[180:183]
  v_mfma_f32_16x16x32_bf16 v[180:183], v[60:63], v[100:103], v[180:183]
  v_mfma_f32_16x16x32_bf16 v[184:187], v[56:59], v[104:107], v[184:187]
  v_mfma_f32_16x16x32_bf16 v[184:187], v[60:63], v[108:111], v[184:187]
  v_mfma_f32_16x16x32_bf16 v[200:203], v[64:67], v[104:107], v[200:203]
  v_mfma_f32_16x16x32_bf16 v[200:203], v[68:71], v[108:111], v[200:203]
  v_mfma_f32_16x16x32_bf16 v[196:199], v[64:67], v[96:99], v[196:199]
  v_mfma_f32_16x16x32_bf16 v[196:199], v[68:71], v[100:103], v[196:199]
  v_mfma_f32_16x16x32_bf16 v[192:195], v[64:67], v[88:91], v[192:195]
  v_mfma_f32_16x16x32_bf16 v[192:195], v[68:71], v[92:95], v[192:195]
  v_mfma_f32_16x16x32_bf16 v[188:191], v[64:67], v[80:83], v[188:191]
  v_mfma_f32_16x16x32_bf16 v[188:191], v[68:71], v[84:87], v[188:191]
  v_mfma_f32_16x16x32_bf16 v[204:207], v[72:75], v[80:83], v[204:207]
  v_mfma_f32_16x16x32_bf16 v[204:207], v[76:79], v[84:87], v[204:207]
  v_mfma_f32_16x16x32_bf16 v[208:211], v[72:75], v[88:91], v[208:211]
  v_mfma_f32_16x16x32_bf16 v[208:211], v[76:79], v[92:95], v[208:211]
  v_mfma_f32_16x16x32_bf16 v[212:215], v[72:75], v[96:99], v[212:215]
  v_mfma_f32_16x16x32_bf16 v[212:215], v[76:79], v[100:103], v[212:215]
  v_mfma_f32_16x16x32_bf16 v[216:219], v[72:75], v[104:107], v[216:219]
  s_setprio 2
  s_barrier
  v_mfma_f32_16x16x32_bf16 v[216:219], v[76:79], v[108:111], v[216:219]
  s_cbranch_scc1 L_dnn_loop1
  ds_read_b64_tr_b16 v[40:41], v1 offset:0
  ds_read_b64_tr_b16 v[42:43], v1 offset:2560
  ds_read_b64_tr_b16 v[44:45], v1 offset:20480
  ds_read_b64_tr_b16 v[46:47], v1 offset:23040
  ds_read_b64_tr_b16 v[48:49], v2 offset:0
  ds_read_b64_tr_b16 v[50:51], v2 offset:2560
  ds_read_b64_tr_b16 v[52:53], v2 offset:20480
  ds_read_b64_tr_b16 v[54:55], v2 offset:23040
  ds_read_b64_tr_b16 v[56:57], v3 offset:0
  ds_read_b64_tr_b16 v[58:59], v3 offset:2560
  ds_read_b64_tr_b16 v[60:61], v3 offset:20480
  ds_read_b64_tr_b16 v[62:63], v3 offset:23040
  ds_read_b64_tr_b16 v[64:65], v4 offset:0
  ds_read_b64_tr_b16 v[66:67], v4 offset:2560
  ds_read_b64_tr_b16 v[68:69], v4 offset:20480
  ds_read_b64_tr_b16 v[70:71], v4 offset:23040
  ds_read_b128 v[80:83], v11 offset:0
  ds_read_b128 v[84:87], v12 offset:0
  ds_read_b128 v[88:91], v11 offset:2048
  ds_read_b128 v[92:95], v12 offset:2048
  ds_read_b128 v[96:99], v11 offset:4096
  ds_read_b128 v[100:103], v12 offset:4096
  ds_read_b128 v[104:107], v11 offset:6144
  ds_read_b128 v[108:111], v12 offset:6144
  ds_read_b64_tr_b16 v[72:73], v5 offset:0
  ds_read_b64_tr_b16 v[74:75], v5 offset:2560
  ds_read_b64_tr_b16 v[76:77], v5 offset:20480
  ds_read_b64_tr_b16 v[78:79], v5 offset:23040
  ds_read_b64 v[220:221], v35 offset:640
  ds_read_b64 v[222:223], v35 offset:672
  ds_read_b64 v[224:225], v35 offset:704
  ds_read_b64 v[226:227], v35 offset:736
  ds_read_b64 v[228:229], v35 offset:768
  s_waitcnt vmcnt(2) lgkmcnt(0)
  s_barrier
  s_setprio 0
  v_mfma_f32_16x16x32_bf16 v[140:143], v[40:43], v[80:83], v[140:143]
  v_mov_b32 v232, 0xc0135761
  v_mov_b32 v233, 0xc0135761
  v_mfma_f32_16x16x32_bf16 v[140:143], v[44:47], v[84:87], v[140:143]
  v_mov_b32 v234, 0xbdd2d3e8
  v_mfma_f32_16x16x32_bf16 v[144:147], v[40:43], v[88:91], v[144:147]
  v_mov_b32 v235, 0xbdd2d3e8
  v_mfma_f32_16x16x32_bf16 v[144:147], v[44:47], v[92:95], v[144:147]
  v_mov_b32 v236, 0x71800000
  v_mfma_f32_16x16x32_bf16 v[148:151], v[40:43], v[96:99], v[148:151]
  v_lshlrev_b32 v112, 16, v220
  v_mfma_f32_16x16x32_bf16 v[148:151], v[44:47], v[100:103], v[148:151]
  v_and_b32 v113, 0xffff0000, v220
  v_mfma_f32_16x16x32_bf16 v[152:155], v[40:43], v[104:107], v[152:155]
  v_lshlrev_b32 v114, 16, v221
  v_mfma_f32_16x16x32_bf16 v[152:155], v[44:47], v[108:111], v[152:155]
  v_and_b32 v115, 0xffff0000, v221
  v_mfma_f32_16x16x32_bf16 v[168:171], v[48:51], v[104:107], v[168:171]
  v_lshlrev_b32 v116, 16, v222
  v_mfma_f32_16x16x32_bf16 v[168:171], v[52:55], v[108:111], v[168:171]
  v_and_b32 v117, 0xffff0000, v222
  v_mfma_f32_16x16x32_bf16 v[164:167], v[48:51], v[96:99], v[164:167]
  v_lshlrev_b32 v118, 16, v223
  v_mfma_f32_16x16x32_bf16 v[164:167], v[52:55], v[100:103], v[164:167]
  v_and_b32 v119, 0xffff0000, v223
  v_mfma_f32_16x16x32_bf16 v[160:163], v[48:51], v[88:91], v[160:163]
  v_lshlrev_b32 v120, 16, v224
  v_mfma_f32_16x16x32_bf16 v[160:163], v[52:55], v[92:95], v[160:163]
  v_and_b32 v121, 0xffff0000, v224
  v_mfma_f32_16x16x32_bf16 v[156:159], v[48:51], v[80:83], v[156:159]
  v_lshlrev_b32 v122, 16, v225
  v_mfma_f32_16x16x32_bf16 v[156:159], v[52:55], v[84:87], v[156:159]
  v_and_b32 v123, 0xffff0000, v225
  v_mfma_f32_16x16x32_bf16 v[172:175], v[56:59], v[80:83], v[172:175]
  v_lshlrev_b32 v124, 16, v226
  v_mfma_f32_16x16x32_bf16 v[172:175], v[60:63], v[84:87], v[172:175]
  v_and_b32 v125, 0xffff0000, v226
  v_mfma_f32_16x16x32_bf16 v[176:179], v[56:59], v[88:91], v[176:179]
  v_lshlrev_b32 v126, 16, v227
  v_mfma_f32_16x16x32_bf16 v[176:179], v[60:63], v[92:95], v[176:179]
  v_and_b32 v127, 0xffff0000, v227
  v_mfma_f32_16x16x32_bf16 v[180:183], v[56:59], v[96:99], v[180:183]
  v_lshlrev_b32 v128, 16, v228
  v_mfma_f32_16x16x32_bf16 v[180:183], v[60:63], v[100:103], v[180:183]
  v_and_b32 v129, 0xffff0000, v228
  v_mfma_f32_16x16x32_bf16 v[184:187], v[56:59], v[104:107], v[184:187]
  v_lshlrev_b32 v130, 16, v229
  v_mfma_f32_16x16x32_bf16 v[184:187], v[60:63], v[108:111], v[184:187]
  v_and_b32 v131, 0xffff0000, v229
  v_mfma_f32_16x16x32_bf16 v[200:203], v[64:67], v[104:107], v[200:203]
  v_rcp_f32 v112, v112
  v_mfma_f32_16x16x32_bf16 v[200:203], v[68:71], v[108:111], v[200:203]
  v_rcp_f32 v113, v113
  v_mfma_f32_16x16x32_bf16 v[196:199], v[64:67], v[96:99], v[196:199]
  v_rcp_f32 v114, v114
  v_mfma_f32_16x16x32_bf16 v[196:199], v[68:71], v[100:103], v[196:199]
  v_rcp_f32 v115, v115
  v_mfma_f32_16x16x32_bf16 v[192:195], v[64:67], v[88:91], v[192:195]
  v_rcp_f32 v116, v116
  v_mfma_f32_16x16x32_bf16 v[192:195], v[68:71], v[92:95], v[192:195]
  v_rcp_f32 v117, v117
  v_mfma_f32_16x16x32_bf16 v[188:191], v[64:67], v[80:83], v[188:191]
  v_rcp_f32 v118, v118
  v_mfma_f32_16x16x32_bf16 v[188:191], v[68:71], v[84:87], v[188:191]
  v_rcp_f32 v119, v119
  v_mfma_f32_16x16x32_bf16 v[204:207], v[72:75], v[80:83], v[204:207]
  v_rcp_f32 v120, v120
  v_mfma_f32_16x16x32_bf16 v[204:207], v[76:79], v[84:87], v[204:207]
  v_rcp_f32 v121, v121
  v_mfma_f32_16x16x32_bf16 v[208:211], v[72:75], v[88:91], v[208:211]
  v_rcp_f32 v122, v122
  v_mfma_f32_16x16x32_bf16 v[208:211], v[76:79], v[92:95], v[208:211]
  v_rcp_f32 v123, v123
  v_mfma_f32_16x16x32_bf16 v[212:215], v[72:75], v[96:99], v[212:215]
  v_rcp_f32 v124, v124
  v_mfma_f32_16x16x32_bf16 v[212:215], v[76:79], v[100:103], v[212:215]
  v_rcp_f32 v125, v125
  v_mfma_f32_16x16x32_bf16 v[216:219], v[72:75], v[104:107], v[216:219]
  s_setprio 2
  s_barrier
  v_mfma_f32_16x16x32_bf16 v[216:219], v[76:79], v[108:111], v[216:219]
  ds_read_b64_tr_b16 v[40:41], v1 offset:40960
  ds_read_b64_tr_b16 v[42:43], v1 offset:43520
  ds_read_b64_tr_b16 v[44:45], v6 offset:0
  ds_read_b64_tr_b16 v[46:47], v6 offset:2560
  ds_read_b64_tr_b16 v[48:49], v2 offset:40960
  ds_read_b64_tr_b16 v[50:51], v2 offset:43520
  ds_read_b64_tr_b16 v[52:53], v7 offset:0
  ds_read_b64_tr_b16 v[54:55], v7 offset:2560
  ds_read_b64_tr_b16 v[56:57], v3 offset:40960
  ds_read_b64_tr_b16 v[58:59], v3 offset:43520
  ds_read_b64_tr_b16 v[60:61], v8 offset:0
  ds_read_b64_tr_b16 v[62:63], v8 offset:2560
  ds_read_b64_tr_b16 v[64:65], v4 offset:40960
  ds_read_b64_tr_b16 v[66:67], v4 offset:43520
  ds_read_b64_tr_b16 v[68:69], v9 offset:0
  ds_read_b64_tr_b16 v[70:71], v9 offset:2560
  ds_read_b128 v[80:83], v11 offset:8192
  ds_read_b128 v[84:87], v12 offset:8192
  ds_read_b128 v[88:91], v11 offset:10240
  ds_read_b128 v[92:95], v12 offset:10240
  ds_read_b128 v[96:99], v11 offset:12288
  ds_read_b128 v[100:103], v12 offset:12288
  ds_read_b128 v[104:107], v11 offset:14336
  ds_read_b128 v[108:111], v12 offset:14336
  ds_read_b64_tr_b16 v[72:73], v5 offset:40960
  ds_read_b64_tr_b16 v[74:75], v5 offset:43520
  ds_read_b64_tr_b16 v[76:77], v10 offset:0
  ds_read_b64_tr_b16 v[78:79], v10 offset:2560
  s_waitcnt lgkmcnt(0)
  s_barrier
  v_mfma_f32_16x16x32_bf16 v[140:143], v[40:43], v[80:83], v[140:143]
  v_rcp_f32 v126, v126
  v_mfma_f32_16x16x32_bf16 v[140:143], v[44:47], v[84:87], v[140:143]
  v_rcp_f32 v127, v127
  v_mfma_f32_16x16x32_bf16 v[144:147], v[40:43], v[88:91], v[144:147]
  v_rcp_f32 v128, v128
  v_mfma_f32_16x16x32_bf16 v[144:147], v[44:47], v[92:95], v[144:147]
  v_mfma_f32_16x16x32_bf16 v[148:151], v[40:43], v[96:99], v[148:151]
  v_rcp_f32 v129, v129
  v_mfma_f32_16x16x32_bf16 v[148:151], v[44:47], v[100:103], v[148:151]
  v_rcp_f32 v130, v130
  v_mfma_f32_16x16x32_bf16 v[152:155], v[40:43], v[104:107], v[152:155]
  v_mfma_f32_16x16x32_bf16 v[152:155], v[44:47], v[108:111], v[152:155]
  v_rcp_f32 v131, v131
  v_mfma_f32_16x16x32_bf16 v[168:171], v[48:51], v[104:107], v[168:171]
  v_med3_f32 v112, v112, -v236, v236
  v_mfma_f32_16x16x32_bf16 v[168:171], v[52:55], v[108:111], v[168:171]
  v_mfma_f32_16x16x32_bf16 v[164:167], v[48:51], v[96:99], v[164:167]
  v_med3_f32 v113, v113, -v236, v236
  v_mfma_f32_16x16x32_bf16 v[164:167], v[52:55], v[100:103], v[164:167]
  v_med3_f32 v114, v114, -v236, v236
  v_mfma_f32_16x16x32_bf16 v[160:163], v[48:51], v[88:91], v[160:163]
  v_mfma_f32_16x16x32_bf16 v[160:163], v[52:55], v[92:95], v[160:163]
  v_med3_f32 v115, v115, -v236, v236
  v_mfma_f32_16x16x32_bf16 v[156:159], v[48:51], v[80:83], v[156:159]
  v_med3_f32 v116, v116, -v236, v236
  v_mfma_f32_16x16x32_bf16 v[156:159], v[52:55], v[84:87], v[156:159]
  v_mfma_f32_16x16x32_bf16 v[172:175], v[56:59], v[80:83], v[172:175]
  v_med3_f32 v117, v117, -v236, v236
  v_mfma_f32_16x16x32_bf16 v[172:175], v[60:63], v[84:87], v[172:175]
  v_med3_f32 v118, v118, -v236, v236
  v_mfma_f32_16x16x32_bf16 v[176:179], v[56:59], v[88:91], v[176:179]
  v_mfma_f32_16x16x32_bf16 v[176:179], v[60:63], v[92:95], v[176:179]
  v_med3_f32 v119, v119, -v236, v236
  v_mfma_f32_16x16x32_bf16 v[180:183], v[56:59], v[96:99], v[180:183]
  v_med3_f32 v120, v120, -v236, v236
  v_mfma_f32_16x16x32_bf16 v[180:183], v[60:63], v[100:103], v[180:183]
  v_med3_f32 v121, v121, -v236, v236
  v_mfma_f32_16x16x32_bf16 v[184:187], v[56:59], v[104:107], v[184:187]
  v_mfma_f32_16x16x32_bf16 v[184:187], v[60:63], v[108:111], v[184:187]
  v_med3_f32 v122, v122, -v236, v236
  v_mfma_f32_16x16x32_bf16 v[200:203], v[64:67], v[104:107], v[200:203]
  v_med3_f32 v123, v123, -v236, v236
  v_mfma_f32_16x16x32_bf16 v[200:203], v[68:71], v[108:111], v[200:203]
  v_mfma_f32_16x16x32_bf16 v[196:199], v[64:67], v[96:99], v[196:199]
  v_med3_f32 v124, v124, -v236, v236
  v_mfma_f32_16x16x32_bf16 v[196:199], v[68:71], v[100:103], v[196:199]
  v_med3_f32 v125, v125, -v236, v236
  v_mfma_f32_16x16x32_bf16 v[192:195], v[64:67], v[88:91], v[192:195]
  v_mfma_f32_16x16x32_bf16 v[192:195], v[68:71], v[92:95], v[192:195]
  v_med3_f32 v126, v126, -v236, v236
  v_mfma_f32_16x16x32_bf16 v[188:191], v[64:67], v[80:83], v[188:191]
  v_med3_f32 v127, v127, -v236, v236
  v_mfma_f32_16x16x32_bf16 v[188:191], v[68:71], v[84:87], v[188:191]
  v_mfma_f32_16x16x32_bf16 v[204:207], v[72:75], v[80:83], v[204:207]
  v_med3_f32 v128, v128, -v236, v236
  v_mfma_f32_16x16x32_bf16 v[204:207], v[76:79], v[84:87], v[204:207]
  v_med3_f32 v129, v129, -v236, v236
  v_mfma_f32_16x16x32_bf16 v[208:211], v[72:75], v[88:91], v[208:211]
  v_mfma_f32_16x16x32_bf16 v[208:211], v[76:79], v[92:95], v[208:211]
  v_med3_f32 v130, v130, -v236, v236
  v_mfma_f32_16x16x32_bf16 v[212:215], v[72:75], v[96:99], v[212:215]
  v_med3_f32 v131, v131, -v236, v236
  v_mfma_f32_16x16x32_bf16 v[212:215], v[76:79], v[100:103], v[212:215]
  v_mfma_f32_16x16x32_bf16 v[216:219], v[72:75], v[104:107], v[216:219]
  v_mfma_f32_16x16x32_bf16 v[216:219], v[76:79], v[108:111], v[216:219]
  s_setprio 0
  s_nop 0
L_epi:
  s_lshl_b32 s69, s27, 11
  s_and_b32 s71, s26, 3
  s_lshl_b32 s71, s71, 9
  s_add_u32 s69, s69, s71
  s_lshr_b32 s68, s26, 2
  s_lshl_b32 s68, s68, 14
  s_add_u32 s69, s69, s68
  v_lshlrev_b32 v3, 3, v0
  v_add_u32 v2, 156928, v3
  v_pk_mul_f32 v[40:41], v[140:141], v[140:141]
  v_pk_mul_f32 v[44:45], v[144:145], v[144:145]
  v_pk_mul_f32 v[48:49], v[148:149], v[148:149]
  v_pk_mul_f32 v[52:53], v[152:153], v[152:153]
  v_pk_fma_f32 v[40:41], v[40:41], v[234:235], v[232:233]
  v_pk_fma_f32 v[44:45], v[44:45], v[234:235], v[232:233]
  v_pk_fma_f32 v[48:49], v[48:49], v[234:235], v[232:233]
  v_pk_fma_f32 v[52:53], v[52:53], v[234:235], v[232:233]
  v_pk_mul_f32 v[40:41], v[40:41], v[140:141]
  v_pk_mul_f32 v[44:45], v[44:45], v[144:145]
  v_pk_mul_f32 v[48:49], v[48:49], v[148:149]
  v_pk_mul_f32 v[52:53], v[52:53], v[152:153]
  v_exp_f32 v40, v40
  v_exp_f32 v41, v41
  v_exp_f32 v44, v44
  v_exp_f32 v45, v45
  v_exp_f32 v48, v48
  v_exp_f32 v49, v49
  v_exp_f32 v52, v52
  v_exp_f32 v53, v53
  v_pk_fma_f32 v[40:41], v[40:41], v[112:113], v[112:113]
  v_pk_fma_f32 v[44:45], v[44:45], v[112:113], v[112:113]
  v_pk_fma_f32 v[48:49], v[48:49], v[112:113], v[112:113]
  v_pk_fma_f32 v[52:53], v[52:53], v[112:113], v[112:113]
  v_rcp_f32 v40, v40
  v_rcp_f32 v41, v41
  v_rcp_f32 v44, v44
  v_rcp_f32 v45, v45
  v_rcp_f32 v48, v48
  v_rcp_f32 v49, v49
  v_rcp_f32 v52, v52
  v_rcp_f32 v53, v53
  v_pk_mul_f32 v[16:17], v[40:41], v[140:141]
  v_pk_mul_f32 v[18:19], v[44:45], v[144:145]
  v_pk_mul_f32 v[20:21], v[48:49], v[148:149]
  v_pk_mul_f32 v[22:23], v[52:53], v[152:153]
  v_pk_mul_f32 v[56:57], v[142:143], v[142:143]
  v_pk_mul_f32 v[60:61], v[146:147], v[146:147]
  v_pk_mul_f32 v[64:65], v[150:151], v[150:151]
  v_pk_mul_f32 v[68:69], v[154:155], v[154:155]
  v_pk_fma_f32 v[56:57], v[56:57], v[234:235], v[232:233]
  v_pk_fma_f32 v[60:61], v[60:61], v[234:235], v[232:233]
  v_pk_fma_f32 v[64:65], v[64:65], v[234:235], v[232:233]
  v_pk_fma_f32 v[68:69], v[68:69], v[234:235], v[232:233]
  v_pk_mul_f32 v[56:57], v[56:57], v[142:143]
  v_pk_mul_f32 v[60:61], v[60:61], v[146:147]
  v_pk_mul_f32 v[64:65], v[64:65], v[150:151]
  v_pk_mul_f32 v[68:69], v[68:69], v[154:155]
  v_exp_f32 v56, v56
  v_exp_f32 v57, v57
  v_exp_f32 v60, v60
  v_exp_f32 v61, v61
  v_exp_f32 v64, v64
  v_exp_f32 v65, v65
  v_exp_f32 v68, v68
  v_exp_f32 v69, v69
  v_pk_fma_f32 v[56:57], v[56:57], v[114:115], v[114:115]
  v_pk_fma_f32 v[60:61], v[60:61], v[114:115], v[114:115]
  v_pk_fma_f32 v[64:65], v[64:65], v[114:115], v[114:115]
  v_pk_fma_f32 v[68:69], v[68:69], v[114:115], v[114:115]
  v_rcp_f32 v56, v56
  v_rcp_f32 v57, v57
  v_rcp_f32 v60, v60
  v_rcp_f32 v61, v61
  v_rcp_f32 v64, v64
  v_rcp_f32 v65, v65
  v_rcp_f32 v68, v68
  v_rcp_f32 v69, v69
  v_pk_fma_f32 v[16:17], v[56:57], v[142:143], v[16:17]
  v_pk_fma_f32 v[18:19], v[60:61], v[146:147], v[18:19]
  v_pk_fma_f32 v[20:21], v[64:65], v[150:151], v[20:21]
  v_pk_fma_f32 v[22:23], v[68:69], v[154:155], v[22:23]
  v_pk_mul_f32 v[40:41], v[156:157], v[156:157]
  v_pk_mul_f32 v[44:45], v[160:161], v[160:161]
  v_pk_mul_f32 v[48:49], v[164:165], v[164:165]
  v_pk_mul_f32 v[52:53], v[168:169], v[168:169]
  v_pk_fma_f32 v[40:41], v[40:41], v[234:235], v[232:233]
  v_pk_fma_f32 v[44:45], v[44:45], v[234:235], v[232:233]
  v_pk_fma_f32 v[48:49], v[48:49], v[234:235], v[232:233]
  v_pk_fma_f32 v[52:53], v[52:53], v[234:235], v[232:233]
  v_pk_mul_f32 v[40:41], v[40:41], v[156:157]
  v_pk_mul_f32 v[44:45], v[44:45], v[160:161]
  v_pk_mul_f32 v[48:49], v[48:49], v[164:165]
  v_pk_mul_f32 v[52:53], v[52:53], v[168:169]
  v_exp_f32 v40, v40
  v_exp_f32 v41, v41
  v_exp_f32 v44, v44
  v_exp_f32 v45, v45
  v_exp_f32 v48, v48
  v_exp_f32 v49, v49
  v_exp_f32 v52, v52
  v_exp_f32 v53, v53
  v_pk_fma_f32 v[40:41], v[40:41], v[116:117], v[116:117]
  v_pk_fma_f32 v[44:45], v[44:45], v[116:117], v[116:117]
  v_pk_fma_f32 v[48:49], v[48:49], v[116:117], v[116:117]
  v_pk_fma_f32 v[52:53], v[52:53], v[116:117], v[116:117]
  v_rcp_f32 v40, v40
  v_rcp_f32 v41, v41
  v_rcp_f32 v44, v44
  v_rcp_f32 v45, v45
  v_rcp_f32 v48, v48
  v_rcp_f32 v49, v49
  v_rcp_f32 v52, v52
  v_rcp_f32 v53, v53
  v_pk_fma_f32 v[16:17], v[40:41], v[156:157], v[16:17]
  v_pk_fma_f32 v[18:19], v[44:45], v[160:161], v[18:19]
  v_pk_fma_f32 v[20:21], v[48:49], v[164:165], v[20:21]
  v_pk_fma_f32 v[22:23], v[52:53], v[168:169], v[22:23]
  v_pk_mul_f32 v[56:57], v[158:159], v[158:159]
  v_pk_mul_f32 v[60:61], v[162:163], v[162:163]
  v_pk_mul_f32 v[64:65], v[166:167], v[166:167]
  v_pk_mul_f32 v[68:69], v[170:171], v[170:171]
  v_pk_fma_f32 v[56:57], v[56:57], v[234:235], v[232:233]
  v_pk_fma_f32 v[60:61], v[60:61], v[234:235], v[232:233]
  v_pk_fma_f32 v[64:65], v[64:65], v[234:235], v[232:233]
  v_pk_fma_f32 v[68:69], v[68:69], v[234:235], v[232:233]
  v_pk_mul_f32 v[56:57], v[56:57], v[158:159]
  v_pk_mul_f32 v[60:61], v[60:61], v[162:163]
  v_pk_mul_f32 v[64:65], v[64:65], v[166:167]
  v_pk_mul_f32 v[68:69], v[68:69], v[170:171]
  v_exp_f32 v56, v56
  v_exp_f32 v57, v57
  v_exp_f32 v60, v60
  v_exp_f32 v61, v61
  v_exp_f32 v64, v64
  v_exp_f32 v65, v65
  v_exp_f32 v68, v68
  v_exp_f32 v69, v69
  v_pk_fma_f32 v[56:57], v[56:57], v[118:119], v[118:119]
  v_pk_fma_f32 v[60:61], v[60:61], v[118:119], v[118:119]
  v_pk_fma_f32 v[64:65], v[64:65], v[118:119], v[118:119]
  v_pk_fma_f32 v[68:69], v[68:69], v[118:119], v[118:119]
  v_rcp_f32 v56, v56
  v_rcp_f32 v57, v57
  v_rcp_f32 v60, v60
  v_rcp_f32 v61, v61
  v_rcp_f32 v64, v64
  v_rcp_f32 v65, v65
  v_rcp_f32 v68, v68
  v_rcp_f32 v69, v69
  v_pk_fma_f32 v[16:17], v[56:57], v[158:159], v[16:17]
  v_pk_fma_f32 v[18:19], v[60:61], v[162:163], v[18:19]
  v_pk_fma_f32 v[20:21], v[64:65], v[166:167], v[20:21]
  v_pk_fma_f32 v[22:23], v[68:69], v[170:171], v[22:23]
  v_pk_mul_f32 v[40:41], v[172:173], v[172:173]
  v_pk_mul_f32 v[44:45], v[176:177], v[176:177]
  v_pk_mul_f32 v[48:49], v[180:181], v[180:181]
  v_pk_mul_f32 v[52:53], v[184:185], v[184:185]
  v_pk_fma_f32 v[40:41], v[40:41], v[234:235], v[232:233]
  v_pk_fma_f32 v[44:45], v[44:45], v[234:235], v[232:233]
  v_pk_fma_f32 v[48:49], v[48:49], v[234:235], v[232:233]
  v_pk_fma_f32 v[52:53], v[52:53], v[234:235], v[232:233]
  v_pk_mul_f32 v[40:41], v[40:41], v[172:173]
  v_pk_mul_f32 v[44:45], v[44:45], v[176:177]
  v_pk_mul_f32 v[48:49], v[48:49], v[180:181]
  v_pk_mul_f32 v[52:53], v[52:53], v[184:185]
  v_exp_f32 v40, v40
  v_exp_f32 v41, v41
  v_exp_f32 v44, v44
  v_exp_f32 v45, v45
  v_exp_f32 v48, v48
  v_exp_f32 v49, v49
  v_exp_f32 v52, v52
  v_exp_f32 v53, v53
  v_pk_fma_f32 v[40:41], v[40:41], v[120:121], v[120:121]
  v_pk_fma_f32 v[44:45], v[44:45], v[120:121], v[120:121]
  v_pk_fma_f32 v[48:49], v[48:49], v[120:121], v[120:121]
  v_pk_fma_f32 v[52:53], v[52:53], v[120:121], v[120:121]
  v_rcp_f32 v40, v40
  v_rcp_f32 v41, v41
  v_rcp_f32 v44, v44
  v_rcp_f32 v45, v45
  v_rcp_f32 v48, v48
  v_rcp_f32 v49, v49
  v_rcp_f32 v52, v52
  v_rcp_f32 v53, v53
  v_pk_fma_f32 v[16:17], v[40:41], v[172:173], v[16:17]
  v_pk_fma_f32 v[18:19], v[44:45], v[176:177], v[18:19]
  v_pk_fma_f32 v[20:21], v[48:49], v[180:181], v[20:21]
  v_pk_fma_f32 v[22:23], v[52:53], v[184:185], v[22:23]
  v_pk_mul_f32 v[56:57], v[174:175], v[174:175]
  v_pk_mul_f32 v[60:61], v[178:179], v[178:179]
  v_pk_mul_f32 v[64:65], v[182:183], v[182:183]
  v_pk_mul_f32 v[68:69], v[186:187], v[186:187]
  v_pk_fma_f32 v[56:57], v[56:57], v[234:235], v[232:233]
  v_pk_fma_f32 v[60:61], v[60:61], v[234:235], v[232:233]
  v_pk_fma_f32 v[64:65], v[64:65], v[234:235], v[232:233]
  v_pk_fma_f32 v[68:69], v[68:69], v[234:235], v[232:233]
  v_pk_mul_f32 v[56:57], v[56:57], v[174:175]
  v_pk_mul_f32 v[60:61], v[60:61], v[178:179]
  v_pk_mul_f32 v[64:65], v[64:65], v[182:183]
  v_pk_mul_f32 v[68:69], v[68:69], v[186:187]
  v_exp_f32 v56, v56
  v_exp_f32 v57, v57
  v_exp_f32 v60, v60
  v_exp_f32 v61, v61
  v_exp_f32 v64, v64
  v_exp_f32 v65, v65
  v_exp_f32 v68, v68
  v_exp_f32 v69, v69
  v_pk_fma_f32 v[56:57], v[56:57], v[122:123], v[122:123]
  v_pk_fma_f32 v[60:61], v[60:61], v[122:123], v[122:123]
  v_pk_fma_f32 v[64:65], v[64:65], v[122:123], v[122:123]
  v_pk_fma_f32 v[68:69], v[68:69], v[122:123], v[122:123]
  v_rcp_f32 v56, v56
  v_rcp_f32 v57, v57
  v_rcp_f32 v60, v60
  v_rcp_f32 v61, v61
  v_rcp_f32 v64, v64
  v_rcp_f32 v65, v65
  v_rcp_f32 v68, v68
  v_rcp_f32 v69, v69
  v_pk_fma_f32 v[16:17], v[56:57], v[174:175], v[16:17]
  v_pk_fma_f32 v[18:19], v[60:61], v[178:179], v[18:19]
  v_pk_fma_f32 v[20:21], v[64:65], v[182:183], v[20:21]
  v_pk_fma_f32 v[22:23], v[68:69], v[186:187], v[22:23]
  v_pk_mul_f32 v[40:41], v[188:189], v[188:189]
  v_pk_mul_f32 v[44:45], v[192:193], v[192:193]
  v_pk_mul_f32 v[48:49], v[196:197], v[196:197]
  v_pk_mul_f32 v[52:53], v[200:201], v[200:201]
  v_pk_fma_f32 v[40:41], v[40:41], v[234:235], v[232:233]
  v_pk_fma_f32 v[44:45], v[44:45], v[234:235], v[232:233]
  v_pk_fma_f32 v[48:49], v[48:49], v[234:235], v[232:233]
  v_pk_fma_f32 v[52:53], v[52:53], v[234:235], v[232:233]
  v_pk_mul_f32 v[40:41], v[40:41], v[188:189]
  v_pk_mul_f32 v[44:45], v[44:45], v[192:193]
  v_pk_mul_f32 v[48:49], v[48:49], v[196:197]
  v_pk_mul_f32 v[52:53], v[52:53], v[200:201]
  v_exp_f32 v40, v40
  v_exp_f32 v41, v41
  v_exp_f32 v44, v44
  v_exp_f32 v45, v45
  v_exp_f32 v48, v48
  v_exp_f32 v49, v49
  v_exp_f32 v52, v52
  v_exp_f32 v53, v53
  v_pk_fma_f32 v[40:41], v[40:41], v[124:125], v[124:125]
  v_pk_fma_f32 v[44:45], v[44:45], v[124:125], v[124:125]
  v_pk_fma_f32 v[48:49], v[48:49], v[124:125], v[124:125]
  v_pk_fma_f32 v[52:53], v[52:53], v[124:125], v[124:125]
  v_rcp_f32 v40, v40
  v_rcp_f32 v41, v41
  v_rcp_f32 v44, v44
  v_rcp_f32 v45, v45
  v_rcp_f32 v48, v48
  v_rcp_f32 v49, v49
  v_rcp_f32 v52, v52
  v_rcp_f32 v53, v53
  v_pk_fma_f32 v[16:17], v[40:41], v[188:189], v[16:17]
  v_pk_fma_f32 v[18:19], v[44:45], v[192:193], v[18:19]
  v_pk_fma_f32 v[20:21], v[48:49], v[196:197], v[20:21]
  v_pk_fma_f32 v[22:23], v[52:53], v[200:201], v[22:23]
  v_pk_mul_f32 v[56:57], v[190:191], v[190:191]
  v_pk_mul_f32 v[60:61], v[194:195], v[194:195]
  v_pk_mul_f32 v[64:65], v[198:199], v[198:199]
  v_pk_mul_f32 v[68:69], v[202:203], v[202:203]
  v_pk_fma_f32 v[56:57], v[56:57], v[234:235], v[232:233]
  v_pk_fma_f32 v[60:61], v[60:61], v[234:235], v[232:233]
  v_pk_fma_f32 v[64:65], v[64:65], v[234:235], v[232:233]
  v_pk_fma_f32 v[68:69], v[68:69], v[234:235], v[232:233]
  v_pk_mul_f32 v[56:57], v[56:57], v[190:191]
  v_pk_mul_f32 v[60:61], v[60:61], v[194:195]
  v_pk_mul_f32 v[64:65], v[64:65], v[198:199]
  v_pk_mul_f32 v[68:69], v[68:69], v[202:203]
  v_exp_f32 v56, v56
  v_exp_f32 v57, v57
  v_exp_f32 v60, v60
  v_exp_f32 v61, v61
  v_exp_f32 v64, v64
  v_exp_f32 v65, v65
  v_exp_f32 v68, v68
  v_exp_f32 v69, v69
  v_pk_fma_f32 v[56:57], v[56:57], v[126:127], v[126:127]
  v_pk_fma_f32 v[60:61], v[60:61], v[126:127], v[126:127]
  v_pk_fma_f32 v[64:65], v[64:65], v[126:127], v[126:127]
  v_pk_fma_f32 v[68:69], v[68:69], v[126:127], v[126:127]
  v_rcp_f32 v56, v56
  v_rcp_f32 v57, v57
  v_rcp_f32 v60, v60
  v_rcp_f32 v61, v61
  v_rcp_f32 v64, v64
  v_rcp_f32 v65, v65
  v_rcp_f32 v68, v68
  v_rcp_f32 v69, v69
  v_pk_fma_f32 v[16:17], v[56:57], v[190:191], v[16:17]
  v_pk_fma_f32 v[18:19], v[60:61], v[194:195], v[18:19]
  v_pk_fma_f32 v[20:21], v[64:65], v[198:199], v[20:21]
  v_pk_fma_f32 v[22:23], v[68:69], v[202:203], v[22:23]
  v_pk_mul_f32 v[40:41], v[204:205], v[204:205]
  v_pk_mul_f32 v[44:45], v[208:209], v[208:209]
  v_pk_mul_f32 v[48:49], v[212:213], v[212:213]
  v_pk_mul_f32 v[52:53], v[216:217], v[216:217]
  v_pk_fma_f32 v[40:41], v[40:41], v[234:235], v[232:233]
  v_pk_fma_f32 v[44:45], v[44:45], v[234:235], v[232:233]
  v_pk_fma_f32 v[48:49], v[48:49], v[234:235], v[232:233]
  v_pk_fma_f32 v[52:53], v[52:53], v[234:235], v[232:233]
  v_pk_mul_f32 v[40:41], v[40:41], v[204:205]
  v_pk_mul_f32 v[44:45], v[44:45], v[208:209]
  v_pk_mul_f32 v[48:49], v[48:49], v[212:213]
  v_pk_mul_f32 v[52:53], v[52:53], v[216:217]
  v_exp_f32 v40, v40
  v_exp_f32 v41, v41
  v_exp_f32 v44, v44
  v_exp_f32 v45, v45
  v_exp_f32 v48, v48
  v_exp_f32 v49, v49
  v_exp_f32 v52, v52
  v_exp_f32 v53, v53
  v_pk_fma_f32 v[40:41], v[40:41], v[128:129], v[128:129]
  v_pk_fma_f32 v[44:45], v[44:45], v[128:129], v[128:129]
  v_pk_fma_f32 v[48:49], v[48:49], v[128:129], v[128:129]
  v_pk_fma_f32 v[52:53], v[52:53], v[128:129], v[128:129]
  v_rcp_f32 v40, v40
  v_rcp_f32 v41, v41
  v_rcp_f32 v44, v44
  v_rcp_f32 v45, v45
  v_rcp_f32 v48, v48
  v_rcp_f32 v49, v49
  v_rcp_f32 v52, v52
  v_rcp_f32 v53, v53
  v_pk_fma_f32 v[16:17], v[40:41], v[204:205], v[16:17]
  v_pk_fma_f32 v[18:19], v[44:45], v[208:209], v[18:19]
  v_pk_fma_f32 v[20:21], v[48:49], v[212:213], v[20:21]
  v_pk_fma_f32 v[22:23], v[52:53], v[216:217], v[22:23]
  v_pk_mul_f32 v[56:57], v[206:207], v[206:207]
  v_pk_mul_f32 v[60:61], v[210:211], v[210:211]
  v_pk_mul_f32 v[64:65], v[214:215], v[214:215]
  v_pk_mul_f32 v[68:69], v[218:219], v[218:219]
  v_pk_fma_f32 v[56:57], v[56:57], v[234:235], v[232:233]
  v_pk_fma_f32 v[60:61], v[60:61], v[234:235], v[232:233]
  v_pk_fma_f32 v[64:65], v[64:65], v[234:235], v[232:233]
  v_pk_fma_f32 v[68:69], v[68:69], v[234:235], v[232:233]
  v_pk_mul_f32 v[56:57], v[56:57], v[206:207]
  v_pk_mul_f32 v[60:61], v[60:61], v[210:211]
  v_pk_mul_f32 v[64:65], v[64:65], v[214:215]
  v_pk_mul_f32 v[68:69], v[68:69], v[218:219]
  v_exp_f32 v56, v56
  v_exp_f32 v57, v57
  v_exp_f32 v60, v60
  v_exp_f32 v61, v61
  v_exp_f32 v64, v64
  v_exp_f32 v65, v65
  v_exp_f32 v68, v68
  v_exp_f32 v69, v69
  v_pk_fma_f32 v[56:57], v[56:57], v[130:131], v[130:131]
  v_pk_fma_f32 v[60:61], v[60:61], v[130:131], v[130:131]
  v_pk_fma_f32 v[64:65], v[64:65], v[130:131], v[130:131]
  v_pk_fma_f32 v[68:69], v[68:69], v[130:131], v[130:131]
  v_rcp_f32 v56, v56
  v_rcp_f32 v57, v57
  v_rcp_f32 v60, v60
  v_rcp_f32 v61, v61
  v_rcp_f32 v64, v64
  v_rcp_f32 v65, v65
  v_rcp_f32 v68, v68
  v_rcp_f32 v69, v69
  v_pk_fma_f32 v[16:17], v[56:57], v[206:207], v[16:17]
  v_pk_fma_f32 v[18:19], v[60:61], v[210:211], v[18:19]
  v_pk_fma_f32 v[20:21], v[64:65], v[214:215], v[20:21]
  v_pk_fma_f32 v[22:23], v[68:69], v[218:219], v[22:23]
  v_add_f32 v16, v16, v17
  v_add_f32 v18, v18, v19
  v_add_f32 v20, v20, v21
  v_add_f32 v22, v22, v23
  s_nop 0
  v_permlane32_swap_b32 v16, v20
  v_permlane32_swap_b32 v18, v22
  v_add_f32 v16, v16, v20
  v_add_f32 v18, v18, v22
  s_nop 1
  v_permlane16_swap_b32 v16, v18
  v_add_f32 v16, v16, v18
  ds_write_b32 v36, v16
  s_waitcnt lgkmcnt(0)
  s_cmp_eq_u32 s3, 0
  s_cbranch_scc1 L_dpub
  s_barrier
  s_endpgm
L_dpub:
  s_mov_b32 s60, s24
  s_and_b32 s61, s25, 0xffff
  s_mov_b32 s62, 268435456
  s_mov_b32 s63, 0x20000
  s_mov_b32 s64, s22
  s_and_b32 s65, s23, 0xffff
  s_mov_b32 s66, 256
  s_mov_b32 s67, 0x20000
  s_and_b32 s81, s2, 7
  s_waitcnt vmcnt(0)
  v_cmp_eq_u32 vcc, 0, v37
  s_nop 0
  s_bitcmp1_b32 vcc_lo, s81
  s_cbranch_scc0 L_dclr_ok
  s_mov_b32 s78, 0x40000
L_dclr:
  s_sub_u32 s78, s78, 1
  s_cbranch_scc1 L_dclr_ok
  v_lshlrev_b32 v37, 2, v0
  v_and_b32 v37, 31, v37
  buffer_load_dword v37, v37, s[64:67], 0 offen offset:128 sc1
  s_waitcnt vmcnt(0)
  v_cmp_eq_u32 vcc, 0, v37
  s_nop 0
  s_bitcmp1_b32 vcc_lo, s81
  s_cbranch_scc1 L_dclr
L_dclr_ok:
  s_barrier
  ds_read_b64 v[64:65], v2 offset:0
  ds_read_b64 v[66:67], v2 offset:512
  ds_read_b64 v[68:69], v2 offset:1024
  ds_read_b64 v[70:71], v2 offset:1536
  s_waitcnt lgkmcnt(2)
  v_pk_add_f32 v[64:65], v[64:65], v[66:67]
  s_waitcnt lgkmcnt(0)
  v_pk_add_f32 v[68:69], v[68:69], v[70:71]
  v_pk_add_f32 v[64:65], v[64:65], v[68:69]
  v_and_b32 v64, -2, v64
  v_and_b32 v65, -2, v65
  buffer_store_dwordx2 v[64:65], v3, s[60:63], s69 offen sc1
  s_endpgm
L_cin:
  s_and_b32 s68, s26, 3
  s_mul_i32 s68, s68, 3
  s_add_u32 s27, s68, s27
  s_sub_u32 s27, s27, 6
  s_cbranch_scc1 L_rem
  s_and_b32 s79, s3, 3
  s_lshr_b32 s84, s3, 2
  s_lshl_b32 s100, s27, 3
  s_add_u32 s100, s100, s3
  s_mul_i32 s68, s100, 1280
  v_min_u32 v40, 9, v0
  v_lshlrev_b32 v40, 7, v40
  v_lshlrev_b32 v48, 4, v0
  s_lshl_b32 s95, s79, 10
  s_cmp_eq_u32 s79, 2
  s_cselect_b64 s[82:83], 0x3fffff, -1
  s_cmp_eq_u32 s79, 3
  s_cselect_b32 s96, 0, 32768
  s_add_u32 s96, s96, s95
  s_mul_i32 s69, s27, 2979
  s_lshr_b32 s69, s69, 6
  s_mul_i32 s98, s27, 44
  s_and_b32 s70, s2, 7
  s_add_u32 s85, s98, s3
  s_lshl_b32 s85, s85, 2
  s_lshl_b32 s98, s70, 14
  s_add_u32 s85, s85, s98
  s_add_u32 s85, s85, 10240
  s_mul_i32 s98, s27, 44
  s_lshl_b32 s77, s70, 9
  s_add_u32 s94, s77, s98
  s_add_u32 s77, s77, s69
  s_add_u32 s94, s94, s3
  s_mul_i32 s94, s94, 104
  s_lshl_b32 s98, s27, 2
  s_add_u32 s98, s98, s3
  s_add_u32 s98, s98, s70
  s_and_b32 s98, s98, 7
  s_mul_i32 s98, s98, 16640
  s_add_u32 s98, s98, 12288
  s_sub_u32 s72, 6, s84
  s_lshl_b32 s99, s84, 1
  s_mov_b32 s26, -1
  v_lshrrev_b32 v43, 3, v0
  v_min_u32 v43, 6, v43
  v_lshlrev_b32 v17, 4, v43
  s_mul_i32 s70, s70, 88
  s_add_u32 s70, s100, s70
  s_mov_b32 s71, 704
  v_mov_b32 v44, s70
  v_mad_u32_u24 v19, v0, s71, v44
  s_mul_i32 s70, s100, 104
  s_sub_u32 s70, s70, 313
  v_min_u32 v44, 16, v0
  v_mul_u32_u24 v45, 26, v44
  v_add_u32 v45, s70, v45
  v_cmp_lt_u32 vcc, 12, v44
  s_nop 1
  v_cndmask_b32 v19, v19, v45, vcc
  v_lshlrev_b32 v19, 7, v19
  s_mov_b32 s101, 212992
  v_mov_b32 v2, 110464
  v_lshlrev_b32 v1, 20, v0
  v_add_u32 v1, 110464, v1
  v_and_b32 v44, 7, v0
  v_lshlrev_b32 v18, 4, v44
  v_and_b32 v44, 15, v0
  v_lshl_add_u32 v44, v44, 2, v2
  v_mov_b32 v3, 0
  ds_write_b32 v44, v3
  v_lshrrev_b32 v41, 5, v0
  v_and_b32 v42, 31, v0
  s_waitcnt lgkmcnt(0)
  v_mov_b32 v3, 1
  s_mov_b32 s32, s6
  s_and_b32 s33, s7, 0xffff
  s_mov_b32 s34, 12800000
  s_mov_b32 s35, 0x20000
  v_mov_b32 v45, s80
  buffer_load_dword v255, v45, s[32:35], 0 offen
  s_mov_b32 s36, s8
  s_and_b32 s37, s9, 0xffff
  s_mov_b32 s38, 105456
  s_mov_b32 s39, 0x20000
  buffer_load_dword v255, v40, s[36:39], s68 offen
  s_mov_b32 s44, s12
  s_and_b32 s45, s13, 0xffff
  s_mov_b32 s46, 5537792
  s_mov_b32 s47, 0x20000
  s_barrier
  s_mov_b64 exec, 131071
  buffer_load_dword v255, v19, s[44:47], s101 offen
  s_mov_b64 exec, -1
  s_add_u32 s101, s101, 1171456
  s_mov_b32 s28, s4
  s_and_b32 s29, s5, 0xffff
  s_mov_b32 s30, 425984
  s_mov_b32 s31, 0x20000
  v_add_u32 v248, s95, v48
  v_cmp_gt_u32 vcc, 1152, v248
  s_nop 1
  v_cndmask_b32 v248, 0, 4, vcc
  v_add_u32 v248, v248, v48
  s_cmp_lg_u32 s84, 0
  s_cbranch_scc1 L_g1a
  s_mov_b32 s40, s10
  s_and_b32 s41, s11, 0xffff
  s_mov_b32 s42, 156
  s_mov_b32 s43, 0x20000
  s_mov_b32 m0, 110272
  s_mov_b64 exec, 0x7ff
  buffer_load_dwordx4 v48, s[40:43], 0 offen lds
  s_mov_b64 exec, -1
  s_add_u32 m0, s95, 71552
  s_add_u32 s81, s95, 70304
  buffer_load_dwordx4 v48, s[36:39], s81 offen lds
  s_add_u32 m0, s95, 75648
  s_add_u32 s81, s95, 74400
  buffer_load_dwordx4 v48, s[36:39], s81 offen lds
  s_add_u32 m0, s95, 79744
  s_add_u32 s81, s95, 78496
  buffer_load_dwordx4 v48, s[36:39], s81 offen lds
  s_add_u32 m0, s95, 83840
  s_add_u32 s81, s95, 82592
  buffer_load_dwordx4 v48, s[36:39], s81 offen lds
  s_add_u32 m0, s95, 87936
  s_add_u32 s81, s95, 86688
  buffer_load_dwordx4 v48, s[36:39], s81 offen lds
  s_add_u32 m0, s95, 92032
  s_add_u32 s81, s95, 90784
  buffer_load_dwordx4 v48, s[36:39], s81 offen lds
  s_add_u32 m0, s95, 96128
  s_add_u32 s81, s95, 94880
  buffer_load_dwordx4 v48, s[36:39], s81 offen lds
  s_add_u32 m0, s95, 100224
  s_add_u32 s81, s95, 98976
  buffer_load_dwordx4 v48, s[36:39], s81 offen lds
  s_add_u32 m0, s96, 71552
  s_add_u32 s81, s96, 70304
  s_mov_b64 exec, s[82:83]
  buffer_load_dwordx4 v48, s[36:39], s81 offen lds
  s_mov_b64 exec, -1
  s_add_u32 m0, s95, 36288
  s_add_u32 s81, s95, 35152
  buffer_load_dwordx4 v48, s[36:39], s81 offen lds
  s_add_u32 m0, s95, 40384
  s_add_u32 s81, s95, 39248
  buffer_load_dwordx4 v48, s[36:39], s81 offen lds
  s_add_u32 m0, s95, 44480
  s_add_u32 s81, s95, 43344
  buffer_load_dwordx4 v48, s[36:39], s81 offen lds
  s_add_u32 m0, s95, 48576
  s_add_u32 s81, s95, 47440
  buffer_load_dwordx4 v48, s[36:39], s81 offen lds
  s_branch L_addrc
L_g1a:
  s_setprio 1
  v_bfe_u32 v43, v0, 2, 2
  v_lshl_add_u32 v43, v41, 3, v43
  v_bfe_u32 v44, v0, 4, 1
  v_lshlrev_b32 v44, 5, v44
  v_and_b32 v45, 3, v0
  v_lshl_add_u32 v44, v45, 3, v44
  v_lshl_add_u32 v240, v43, 6, v44
  v_add_u32 v240, 106816, v240
  s_lshl_b32 s68, s79, 6
  s_add_u32 s68, s68, 36288
  v_add_u32 v44, s68, v44
  v_mul_u32_u24 v45, 1352, v43
  v_add_u32 v241, v44, v45
  v_add_u32 v45, 16, v43
  v_min_u32 v45, 25, v45
  v_mul_u32_u24 v45, 1352, v45
  v_add_u32 v242, v44, v45
  v_add_u32 v45, 20, v43
  v_min_u32 v45, 25, v45
  v_mul_u32_u24 v45, 1352, v45
  v_add_u32 v243, v44, v45
  s_lshl_b32 s68, s79, 5
  v_add_u32 v246, s68, v42
  v_mul_u32_u24 v43, 52, v246
  v_lshl_add_u32 v43, v41, 3, v43
  v_add_u32 v244, 71552, v43
  v_lshlrev_b32 v43, 1, v246
  v_add_u32 v245, 108864, v43
  v_mov_b32 v216, 0
  v_mov_b32 v217, 0
  v_lshlrev_b32 v43, 3, v0
  v_add_u32 v44, 106816, v43
  s_lshl_b32 s68, s79, 9
  v_add_u32 v44, s68, v44
  ds_write_b64 v44, v[216:217]
  v_lshl_add_u32 v43, v41, 7, v246
  s_mov_b32 s69, 2521
  s_mov_b32 s70, 106816
  v_mul_u32_u24 v44, s69, v43
  v_lshrrev_b32 v44, 16, v44
  v_mad_u32_u24 v44, v44, 12, s70
  v_lshl_add_u32 v68, v43, 1, v44
  v_add_u32 v43, 256, v43
  v_mul_u32_u24 v44, s69, v43
  v_lshrrev_b32 v44, 16, v44
  v_mad_u32_u24 v44, v44, 12, s70
  v_lshl_add_u32 v69, v43, 1, v44
  v_add_u32 v43, 256, v43
  v_mul_u32_u24 v44, s69, v43
  v_lshrrev_b32 v44, 16, v44
  v_mad_u32_u24 v44, v44, 12, s70
  v_lshl_add_u32 v70, v43, 1, v44
  v_mov_b32 v44, 676
  v_cmp_gt_u32 s[92:93], v44, v43
  v_add_u32 v43, 0, v246
  v_mul_u32_u24 v44, s69, v43
  v_lshrrev_b32 v44, 16, v44
  v_lshl_add_u32 v44, v44, 2, v244
  v_add_u32 v72, 0, v44
  v_add_u32 v43, 128, v246
  v_mul_u32_u24 v44, s69, v43
  v_lshrrev_b32 v44, 16, v44
  v_lshl_add_u32 v44, v44, 2, v244
  v_add_u32 v73, 6656, v44
  v_add_u32 v43, 256, v246
  v_mul_u32_u24 v44, s69, v43
  v_lshrrev_b32 v44, 16, v44
  v_lshl_add_u32 v44, v44, 2, v244
  v_add_u32 v74, 13312, v44
  v_add_u32 v43, 384, v246
  v_mul_u32_u24 v44, s69, v43
  v_lshrrev_b32 v44, 16, v44
  v_lshl_add_u32 v44, v44, 2, v244
  v_add_u32 v75, 19968, v44
  v_add_u32 v43, 512, v246
  v_mul_u32_u24 v44, s69, v43
  v_lshrrev_b32 v44, 16, v44
  v_lshl_add_u32 v44, v44, 2, v244
  v_add_u32 v76, 26624, v44
  v_add_u32 v43, 640, v246
  v_mul_u32_u24 v44, s69, v43
  v_lshrrev_b32 v44, 16, v44
  v_lshl_add_u32 v44, v44, 2, v244
  v_add_u32 v77, 33280, v44
  v_lshlrev_b32 v78, 4, v41
  v_add_u32 v78, 110376, v78
  v_lshlrev_b32 v79, 1, v0
  v_add_u32 v79, 110272, v79
  v_lshlrev_b32 v80, 6, v0
  v_add_u32 v80, 106868, v80
L_addrc:
  s_and_b32 s70, s3, 1
  s_lshl_b32 s70, s70, 1
  v_add_u32 v46, s70, v41
  v_min_u32 v43, 25, v42
  s_mul_i32 s68, s84, 4
  s_add_u32 s68, s68, 1352
  s_mul_i32 s69, s84, 70528
  s_add_u32 s69, s69, 1024
  v_mul_u32_u24 v44, s68, v43
  v_add_u32 v44, s69, v44
  v_lshlrev_b32 v247, 2, v43
  v_add_u32 v247, 70528, v247
  s_lshl_b32 s68, s84, 2
  s_xor_b32 s68, s68, 4
  v_lshrrev_b32 v45, 2, v43
  v_and_b32 v45, s68, v45
  v_add_u32 v44, v44, v45
  v_sub_u32 v247, v247, v45
  v_mul_u32_u24 v65, 52, v43
  v_lshl_add_u32 v65, v46, 1, v65
  v_add_u32 v65, 108864, v65
  v_lshlrev_b32 v67, 1, v43
  v_add_u32 v67, 110272, v67
  v_mad_u32_u24 v60, v46, 52, v44
  v_lshl_add_u32 v61, v46, 1, v44
  v_lshl_add_u32 v49, v46, 1, v60
  v_lshlrev_b32 v43, 3, v46
  s_mov_b32 s68, 0x01000100
  v_bfe_i32 v45, s68, v43, 8
  v_lshl_add_u32 v50, v45, 1, v60
  v_mad_i32_i24 v51, v45, 52, v61
  s_mov_b32 s68, 0xff00ff00
  v_bfe_i32 v45, s68, v43, 8
  v_lshl_add_u32 v52, v45, 1, v60
  v_mad_i32_i24 v53, v45, 52, v61
  s_mov_b32 s68, 0xff020100
  v_bfe_i32 v45, s68, v43, 8
  v_lshl_add_u32 v54, v45, 1, v60
  v_mad_i32_i24 v55, v45, 52, v61
  s_mov_b32 s68, 0x0b0a0100
  v_bfe_i32 v45, s68, v43, 8
  v_lshl_add_u32 v56, v45, 1, v60
  v_mad_i32_i24 v57, v45, 52, v61
  s_mov_b32 s68, 0xf3f20100
  v_bfe_i32 v45, s68, v43, 8
  v_lshl_add_u32 v58, v45, 1, v60
  v_mad_i32_i24 v59, v45, 52, v61
  s_mov_b32 s68, 0x00023600
  v_bfe_u32 v45, s68, v43, 8
  v_add_u32 v60, v45, v44
  v_add_u32 v61, 52, v44
  v_mov_b32 v47, 1048576
  v_cmp_eq_u32 vcc, 3, v46
  s_nop 1
  v_cndmask_b32 v60, v60, v47, vcc
  v_cndmask_b32 v67, v47, v67, vcc
  v_cmp_eq_u32 vcc, 2, v46
  s_nop 1
  v_cndmask_b32 v61, v47, v61, vcc
  v_cmp_gt_u32 vcc, 2, v46
  s_nop 1
  v_cndmask_b32 v64, v47, v65, vcc
  s_lshr_b32 s69, s79, 1
  s_mul_i32 s69, s69, 6144
  s_mul_i32 s68, s84, 6144
  v_lshlrev_b32 v45, 8, v46
  v_lshl_add_u32 v43, v42, 4, v45
  v_add_u32 v63, 1024, v43
  v_add_u32 v66, 36288, v43
  v_bfe_u32 v43, v0, 2, 2
  v_lshl_add_u32 v45, v43, 4, v45
  v_and_b32 v43, 3, v0
  v_lshl_add_u32 v44, v43, 6, v45
  v_add_u32 v44, 12288, v44
  v_cmp_lt_u32 vcc, 15, v42
  s_nop 1
  v_cndmask_b32 v63, v63, v44, vcc
  v_add_u32 v44, 16, v44
  v_cndmask_b32 v66, v66, v44, vcc
  v_lshl_add_u32 v44, v43, 5, v45
  v_add_u32 v44, 24560, v44
  v_cmp_lt_u32 vcc, 19, v42
  s_nop 1
  v_cndmask_b32 v63, v63, v44, vcc
  v_add_u32 v63, s69, v63
  v_add_u32 v66, s68, v66
  v_cmp_lt_u32 vcc, 25, v42
  s_nop 1
  v_cndmask_b32 v63, v63, v47, vcc
  v_cndmask_b32 v66, v66, v47, vcc
  v_mov_b32 v62, 0
  s_mul_i32 s74, s3, 4224
  s_add_u32 s74, s74, 111040
  s_mov_b32 s75, -39488
  v_add_u32 v28, 1024, v48
  v_and_b32 v43, 11, v0
  v_cmp_eq_u32 vcc, 11, v43
  s_nop 1
  v_cndmask_b32 v31, v28, v47, vcc
  v_and_b32 v43, 3, v0
  v_cmp_eq_u32 vcc, 0, v43
  s_nop 1
  v_cndmask_b32 v30, v31, v47, vcc
  v_lshrrev_b32 v46, 4, v0
  v_bfe_u32 v43, v0, 1, 3
  v_lshlrev_b32 v45, 4, v43
  v_add_u32 v45, 24576, v45
  v_and_b32 v43, 10, v0
  v_cmp_eq_u32 vcc, 10, v43
  s_nop 1
  v_cndmask_b32 v45, v45, v47, vcc
  v_and_b32 v44, 1, v0
  v_lshl_add_u32 v29, v46, 9, v45
  v_lshl_add_u32 v29, v44, 2, v29
  v_add_u32 v29, 1024, v29
  v_lshl_add_u32 v22, v46, 8, v45
  v_lshl_add_u32 v22, v44, 20, v22
  v_and_b32 v47, 15, v0
  s_mov_b32 s68, 1056
  v_lshlrev_b32 v43, 1, v47
  v_add_u32 v43, s74, v43
  v_mad_u32_u24 v7, v46, s68, v43
  s_lshl_b32 s68, s3, 10
  s_add_u32 s68, s68, 144832
  v_add_u32 v10, s68, v48
  v_add_u32 v43, 256, v48
  v_and_b32 v43, 1023, v43
  v_add_u32 v11, s68, v43
  v_xor_b32 v43, 512, v48
  v_add_u32 v12, s68, v43
  v_lshlrev_b32 v13, 4, v41
  v_mov_b32 v32, 0
  v_mov_b32 v33, 0
  v_mov_b32 v34, 0
  v_mov_b32 v35, 0
  v_mov_b32 v36, 0
  v_mov_b32 v37, 0
  v_mov_b32 v38, 0
  v_mov_b32 v39, 0
  v_mov_b32 v216, 0
  v_mov_b32 v217, 0
  v_mov_b32 v218, 0
  v_mov_b32 v219, 0
  v_mov_b32 v220, 0
  v_mov_b32 v221, 0
  v_mov_b32 v222, 0
  v_mov_b32 v223, 0
  v_mov_b32 v224, 0
  v_mov_b32 v225, 0
  v_mov_b32 v226, 0
  v_mov_b32 v227, 0
  v_mov_b32 v228, 0
  v_mov_b32 v229, 0
  v_mov_b32 v230, 0
  v_mov_b32 v231, 0
  v_mov_b32 v232, 0
  v_mov_b32 v233, 0
  v_mov_b32 v234, 0
  v_mov_b32 v235, 0
  v_mov_b32 v236, 0
  v_mov_b32 v237, 0
  v_mov_b32 v238, 0
  v_mov_b32 v239, 0
  v_mul_u32_u24 v44, 1056, v46
  v_bfe_u32 v45, v0, 2, 2
  v_lshl_add_u32 v44, v45, 7, v44
  v_and_b32 v45, 3, v0
  v_lshl_add_u32 v9, v45, 3, v44
  v_add_u32 v8, s74, v9
  v_and_b32 v45, 1, v0
  s_mov_b32 s68, 0xaaaaaaaa
  v_mul_lo_u32 v16, s68, v45
  v_or_b32 v16, 0x44444444, v16
  v_lshlrev_b32 v15, 1, v0
  v_add_u32 v15, s74, v15
  v_mov_b32 v14, 0x3f80
  ds_write_b16 v15, v14 offset:4064
  v_add_u32 v15, s75, v15
  s_mul_i32 s71, s3, 6
  s_add_u32 s77, s77, s71
  s_mul_i32 s77, s77, 104
  s_add_u32 s73, s77, 80
  s_add_u32 s77, s77, 16
  s_mov_b32 s71, 10923
  v_min_u32 v43, 35, v0
  v_mul_u32_u24 v44, s71, v43
  v_lshrrev_b32 v44, 16, v44
  v_mul_u32_u24 v44, 80, v44
  v_lshl_add_u32 v20, v43, 2, v44
  s_cmp_eq_u32 s84, 0
  s_cbranch_scc1 L_g0pf
  s_waitcnt lgkmcnt(0)
  ds_add_u32 v1, v3 offset:0
  s_sub_u32 s94, s94, 416
  buffer_load_dwordx4 v[204:207], v17, s[28:31], s94 offen offset:0
  s_add_u32 s94, s94, 416
  buffer_load_dwordx4 v[24:27], v17, s[28:31], s94 offen offset:0
  s_add_u32 s94, s94, 832
  s_sub_u32 s68, s77, 2496
  buffer_load_dword v208, v20, s[28:31], s68 offen
  buffer_load_dword v209, v20, s[28:31], s77 offen
  s_add_u32 s77, s77, 24
  buffer_load_dword v21, v20, s[28:31], s77 offen
  s_cmp_eq_u32 s77, s73
  s_cselect_b32 s73, 0x7000000, s73
  s_cselect_b32 s77, 0x7000000, s77
  s_add_u32 s77, s77, 24
  s_min_u32 s77, s77, s73
L_csync1:
  ds_read_b32 v4, v2 offset:0
  s_waitcnt lgkmcnt(0)
  v_cmp_gt_u32 vcc, 8, v4
  s_cbranch_vccnz L_csync1
  ds_read_b64 v[132:133], v78 offset:0
  ds_read_b64 v[134:135], v78 offset:8
  ds_read_b64 v[136:137], v78 offset:32
  ds_read_b64 v[138:139], v78 offset:40
  ds_read_u16 v45, v79 offset:52
  ds_read_b64_tr_b16 v[84:85], v241 offset:35264
  ds_read_b64_tr_b16 v[86:87], v241 offset:40672
  ds_read_b64_tr_b16 v[88:89], v242 offset:35264
  ds_read_b64_tr_b16 v[90:91], v243 offset:35264
  ds_read_b64_tr_b16 v[92:93], v241 offset:35520
  ds_read_b64_tr_b16 v[94:95], v241 offset:40928
  ds_read_b64_tr_b16 v[96:97], v242 offset:35520
  ds_read_b64_tr_b16 v[98:99], v243 offset:35520
  ds_read_b64_tr_b16 v[100:101], v241 offset:35776
  ds_read_b64_tr_b16 v[102:103], v241 offset:41184
  ds_read_b64_tr_b16 v[104:105], v242 offset:35776
  ds_read_b64_tr_b16 v[106:107], v243 offset:35776
  ds_read_b64_tr_b16 v[108:109], v241 offset:36032
  ds_read_b64_tr_b16 v[110:111], v241 offset:41440
  ds_read_b64_tr_b16 v[112:113], v242 offset:36032
  ds_read_b64_tr_b16 v[114:115], v243 offset:36032
  s_waitcnt lgkmcnt(14)
  v_mfma_f32_32x32x16_bf16 v[140:155], v[132:135], v[84:87], 0
  s_waitcnt lgkmcnt(12)
  v_mfma_f32_32x32x16_bf16 v[140:155], v[136:139], v[88:91], v[140:155]
  ds_read_b64_tr_b16 v[116:117], v241 offset:36288
  ds_read_b64_tr_b16 v[118:119], v241 offset:41696
  ds_read_b64_tr_b16 v[120:121], v242 offset:36288
  ds_read_b64_tr_b16 v[122:123], v243 offset:36288
  s_waitcnt lgkmcnt(14)
  v_mfma_f32_32x32x16_bf16 v[156:171], v[132:135], v[92:95], 0
  s_waitcnt lgkmcnt(12)
  v_mfma_f32_32x32x16_bf16 v[156:171], v[136:139], v[96:99], v[156:171]
  ds_read_b64_tr_b16 v[124:125], v241 offset:36544
  ds_read_b64_tr_b16 v[126:127], v241 offset:41952
  ds_read_b64_tr_b16 v[128:129], v242 offset:36544
  ds_read_b64_tr_b16 v[130:131], v243 offset:36544
  s_waitcnt lgkmcnt(14)
  v_mfma_f32_32x32x16_bf16 v[172:187], v[132:135], v[100:103], 0
  s_waitcnt lgkmcnt(12)
  v_mfma_f32_32x32x16_bf16 v[172:187], v[136:139], v[104:107], v[172:187]
  v_cvt_pk_bf16_f32 v81, v140, 0
  s_waitcnt lgkmcnt(10)
  v_mfma_f32_32x32x16_bf16 v[188:203], v[132:135], v[108:111], 0
  s_waitcnt lgkmcnt(8)
  v_mfma_f32_32x32x16_bf16 v[188:203], v[136:139], v[112:115], v[188:203]
  s_mov_b32 exec_lo, 0
  v_cvt_pk_bf16_f32 v81, v156, 0
  s_mov_b32 exec_lo, -1
  ds_write_b16 v68, v81
  s_waitcnt lgkmcnt(7)
  v_mfma_f32_32x32x16_bf16 v[140:155], v[132:135], v[116:119], 0
  s_waitcnt lgkmcnt(5)
  v_mfma_f32_32x32x16_bf16 v[140:155], v[136:139], v[120:123], v[140:155]
  v_cvt_pk_bf16_f32 v82, v172, 0
  s_waitcnt lgkmcnt(3)
  v_mfma_f32_32x32x16_bf16 v[156:171], v[132:135], v[124:127], 0
  s_waitcnt lgkmcnt(1)
  v_mfma_f32_32x32x16_bf16 v[156:171], v[136:139], v[128:131], v[156:171]
  s_mov_b32 exec_lo, 0
  v_cvt_pk_bf16_f32 v82, v188, 0
  s_mov_b32 exec_lo, -1
  ds_write_b16 v69, v82
  s_nop 2
  v_cvt_pk_bf16_f32 v83, v140, 0
  s_mov_b32 exec_lo, 0
  s_nop 2
  v_cvt_pk_bf16_f32 v83, v156, 0
  s_mov_b64 exec, s[92:93]
  ds_write_b16 v70, v83
  s_mov_b64 exec, 0x3ffffff
  ds_write_b16 v80, v45
  s_mov_b64 exec, -1
  s_waitcnt lgkmcnt(0)
  ds_add_u32 v1, v3 offset:32
  v_cmp_gt_u32 s[92:93], 36, v246
L_csync2:
  ds_read_b32 v4, v2 offset:4
  s_waitcnt lgkmcnt(0)
  v_cmp_gt_u32 vcc, 4, v4
  s_cbranch_vccnz L_csync2
  ds_read_b64_tr_b16 v[84:85], v241 offset:0
  ds_read_b64_tr_b16 v[86:87], v241 offset:5408
  ds_read_b64_tr_b16 v[88:89], v242 offset:0
  ds_read_b64_tr_b16 v[90:91], v243 offset:0
  ds_read_b64_tr_b16 v[92:93], v241 offset:256
  ds_read_b64_tr_b16 v[94:95], v241 offset:5664
  ds_read_b64_tr_b16 v[96:97], v242 offset:256
  ds_read_b64_tr_b16 v[98:99], v243 offset:256
  ds_read_b64_tr_b16 v[100:101], v241 offset:512
  ds_read_b64_tr_b16 v[102:103], v241 offset:5920
  ds_read_b64_tr_b16 v[104:105], v242 offset:512
  ds_read_b64_tr_b16 v[106:107], v243 offset:512
  ds_read_b64_tr_b16 v[108:109], v241 offset:768
  ds_read_b64_tr_b16 v[110:111], v241 offset:6176
  ds_read_b64_tr_b16 v[112:113], v242 offset:768
  ds_read_b64_tr_b16 v[114:115], v243 offset:768
  ds_read_b64_tr_b16 v[116:117], v241 offset:1024
  ds_read_b64_tr_b16 v[118:119], v241 offset:6432
  ds_read_b64_tr_b16 v[120:121], v242 offset:1024
  ds_read_b64_tr_b16 v[122:123], v243 offset:1024
  ds_read_b64_tr_b16 v[124:125], v241 offset:1280
  ds_read_b64_tr_b16 v[126:127], v241 offset:6688
  ds_read_b64_tr_b16 v[128:129], v242 offset:1280
  ds_read_b64_tr_b16 v[130:131], v243 offset:1280
L_csync3:
  ds_read_b32 v4, v2 offset:32
  s_waitcnt lgkmcnt(0)
  v_cmp_gt_u32 vcc, 4, v4
  s_cbranch_vccnz L_csync3
  s_setprio 0
  s_waitcnt vmcnt(2)
  v_lshlrev_b32 v208, 7, v208
  buffer_load_dword v255, v208, s[32:35], 0 offen
  s_waitcnt vmcnt(2)
  v_lshlrev_b32 v209, 7, v209
  buffer_load_dword v255, v209, s[32:35], 0 offen
  s_mov_b64 exec, 131071
  buffer_load_dword v255, v19, s[44:47], s101 offen
  s_mov_b64 exec, -1
  s_add_u32 s101, s101, 1171456
  ds_read_b64_tr_b16 v[132:133], v240 offset:0
  ds_read_b64_tr_b16 v[134:135], v240 offset:256
  ds_read_b64_tr_b16 v[136:137], v240 offset:1024
  ds_read_b64_tr_b16 v[138:139], v240 offset:1280
  s_waitcnt lgkmcnt(2)
  v_mfma_f32_32x32x16_bf16 v[140:155], v[132:135], v[84:87], 0
  s_waitcnt lgkmcnt(0)
  v_mfma_f32_32x32x16_bf16 v[140:155], v[136:139], v[88:91], v[140:155]
  v_mfma_f32_32x32x16_bf16 v[156:171], v[132:135], v[92:95], 0
  v_mfma_f32_32x32x16_bf16 v[156:171], v[136:139], v[96:99], v[156:171]
  v_mfma_f32_32x32x16_bf16 v[172:187], v[132:135], v[100:103], 0
  v_mfma_f32_32x32x16_bf16 v[172:187], v[136:139], v[104:107], v[172:187]
  s_nop 7
  v_cvt_pk_bf16_f32 v84, v140, v141
  v_cvt_pk_bf16_f32 v85, v142, v143
  v_cvt_pk_bf16_f32 v86, v144, v145
  v_cvt_pk_bf16_f32 v87, v146, v147
  v_cvt_pk_bf16_f32 v88, v148, v149
  v_cvt_pk_bf16_f32 v89, v150, v151
  v_cvt_pk_bf16_f32 v90, v152, v153
  v_cvt_pk_bf16_f32 v91, v154, v155
  ds_write2_b32 v72, v84, v85 offset0:0 offset1:1
  v_max3_f32 v62, v62, abs(v140), abs(v141)
  v_max3_f32 v62, v62, abs(v142), abs(v143)
  v_max3_f32 v62, v62, abs(v144), abs(v145)
  ds_write2_b32 v72, v86, v87 offset0:4 offset1:5
  v_max3_f32 v62, v62, abs(v146), abs(v147)
  v_max3_f32 v62, v62, abs(v148), abs(v149)
  ds_write2_b32 v72, v88, v89 offset0:8 offset1:9
  v_max3_f32 v62, v62, abs(v150), abs(v151)
  v_max3_f32 v62, v62, abs(v152), abs(v153)
  v_mfma_f32_32x32x16_bf16 v[188:203], v[132:135], v[108:111], 0
  v_mfma_f32_32x32x16_bf16 v[188:203], v[136:139], v[112:115], v[188:203]
  v_cvt_pk_bf16_f32 v92, v156, v157
  v_cvt_pk_bf16_f32 v93, v158, v159
  v_cvt_pk_bf16_f32 v94, v160, v161
  v_cvt_pk_bf16_f32 v95, v162, v163
  v_cvt_pk_bf16_f32 v96, v164, v165
  v_cvt_pk_bf16_f32 v97, v166, v167
  v_cvt_pk_bf16_f32 v98, v168, v169
  v_cvt_pk_bf16_f32 v99, v170, v171
  ds_write2_b32 v73, v92, v93 offset0:0 offset1:1
  v_max3_f32 v62, v62, abs(v156), abs(v157)
  v_max3_f32 v62, v62, abs(v158), abs(v159)
  v_max3_f32 v62, v62, abs(v160), abs(v161)
  ds_write2_b32 v73, v94, v95 offset0:4 offset1:5
  v_max3_f32 v62, v62, abs(v162), abs(v163)
  v_max3_f32 v62, v62, abs(v164), abs(v165)
  ds_write2_b32 v73, v96, v97 offset0:8 offset1:9
  v_max3_f32 v62, v62, abs(v166), abs(v167)
  v_max3_f32 v62, v62, abs(v168), abs(v169)
  v_mfma_f32_32x32x16_bf16 v[140:155], v[132:135], v[116:119], 0
  v_mfma_f32_32x32x16_bf16 v[140:155], v[136:139], v[120:123], v[140:155]
  v_cvt_pk_bf16_f32 v100, v172, v173
  v_cvt_pk_bf16_f32 v101, v174, v175
  v_cvt_pk_bf16_f32 v102, v176, v177
  v_cvt_pk_bf16_f32 v103, v178, v179
  v_cvt_pk_bf16_f32 v104, v180, v181
  v_cvt_pk_bf16_f32 v105, v182, v183
  v_cvt_pk_bf16_f32 v106, v184, v185
  v_cvt_pk_bf16_f32 v107, v186, v187
  ds_write2_b32 v74, v100, v101 offset0:0 offset1:1
  v_max3_f32 v62, v62, abs(v172), abs(v173)
  v_max3_f32 v62, v62, abs(v174), abs(v175)
  v_max3_f32 v62, v62, abs(v176), abs(v177)
  ds_write2_b32 v74, v102, v103 offset0:4 offset1:5
  v_max3_f32 v62, v62, abs(v178), abs(v179)
  v_max3_f32 v62, v62, abs(v180), abs(v181)
  ds_write2_b32 v74, v104, v105 offset0:8 offset1:9
  v_max3_f32 v62, v62, abs(v182), abs(v183)
  v_max3_f32 v62, v62, abs(v184), abs(v185)
  v_mfma_f32_32x32x16_bf16 v[156:171], v[132:135], v[124:127], 0
  v_mfma_f32_32x32x16_bf16 v[156:171], v[136:139], v[128:131], v[156:171]
  v_cvt_pk_bf16_f32 v108, v188, v189
  v_cvt_pk_bf16_f32 v109, v190, v191
  v_cvt_pk_bf16_f32 v110, v192, v193
  v_cvt_pk_bf16_f32 v111, v194, v195
  v_cvt_pk_bf16_f32 v112, v196, v197
  v_cvt_pk_bf16_f32 v113, v198, v199
  v_cvt_pk_bf16_f32 v114, v200, v201
  v_cvt_pk_bf16_f32 v115, v202, v203
  ds_write2_b32 v75, v108, v109 offset0:0 offset1:1
  v_max3_f32 v62, v62, abs(v188), abs(v189)
  v_max3_f32 v62, v62, abs(v190), abs(v191)
  v_max3_f32 v62, v62, abs(v192), abs(v193)
  ds_write2_b32 v75, v110, v111 offset0:4 offset1:5
  v_max3_f32 v62, v62, abs(v194), abs(v195)
  v_max3_f32 v62, v62, abs(v196), abs(v197)
  ds_write2_b32 v75, v112, v113 offset0:8 offset1:9
  v_max3_f32 v62, v62, abs(v198), abs(v199)
  v_max3_f32 v62, v62, abs(v200), abs(v201)
  v_cvt_pk_bf16_f32 v116, v140, v141
  v_cvt_pk_bf16_f32 v117, v142, v143
  v_cvt_pk_bf16_f32 v118, v144, v145
  v_cvt_pk_bf16_f32 v119, v146, v147
  v_cvt_pk_bf16_f32 v120, v148, v149
  v_cvt_pk_bf16_f32 v121, v150, v151
  v_cvt_pk_bf16_f32 v122, v152, v153
  v_cvt_pk_bf16_f32 v123, v154, v155
  ds_write2_b32 v76, v116, v117 offset0:0 offset1:1
  v_max3_f32 v62, v62, abs(v140), abs(v141)
  v_max3_f32 v62, v62, abs(v142), abs(v143)
  v_max3_f32 v62, v62, abs(v144), abs(v145)
  ds_write2_b32 v76, v118, v119 offset0:4 offset1:5
  v_max3_f32 v62, v62, abs(v146), abs(v147)
  v_max3_f32 v62, v62, abs(v148), abs(v149)
  ds_write2_b32 v76, v120, v121 offset0:8 offset1:9
  v_max3_f32 v62, v62, abs(v150), abs(v151)
  v_max3_f32 v62, v62, abs(v152), abs(v153)
  v_cvt_pk_bf16_f32 v124, v156, v157
  v_cvt_pk_bf16_f32 v125, v158, v159
  v_cvt_pk_bf16_f32 v126, v160, v161
  v_cvt_pk_bf16_f32 v127, v162, v163
  v_cvt_pk_bf16_f32 v128, v164, v165
  v_cvt_pk_bf16_f32 v129, v166, v167
  v_cvt_pk_bf16_f32 v130, v168, v169
  v_cvt_pk_bf16_f32 v131, v170, v171
  s_mov_b64 exec, s[92:93]
  ds_write2_b32 v77, v124, v125 offset0:0 offset1:1
  v_max3_f32 v62, v62, abs(v156), abs(v157)
  v_max3_f32 v62, v62, abs(v158), abs(v159)
  v_max3_f32 v62, v62, abs(v160), abs(v161)
  ds_write2_b32 v77, v126, v127 offset0:4 offset1:5
  v_max3_f32 v62, v62, abs(v162), abs(v163)
  v_max3_f32 v62, v62, abs(v164), abs(v165)
  ds_write2_b32 v77, v128, v129 offset0:8 offset1:9
  v_max3_f32 v62, v62, abs(v166), abs(v167)
  v_max3_f32 v62, v62, abs(v168), abs(v169)
  s_mov_b32 exec_hi, 0
  ds_write_b32 v77, v130 offset:48
  ds_write_b16 v245, v131 offset:1280
  s_mov_b32 exec_lo, -1
  ds_write_b32 v76, v122 offset:48
  ds_write_b16 v245, v123 offset:1024
  ds_write_b32 v75, v114 offset:48
  ds_write_b16 v245, v115 offset:768
  ds_write_b32 v74, v106 offset:48
  ds_write_b16 v245, v107 offset:512
  ds_write_b32 v73, v98 offset:48
  ds_write_b16 v245, v99 offset:256
  ds_write_b32 v72, v90 offset:48
  ds_write_b16 v245, v91 offset:0
  s_mov_b64 exec, -1
  v_max_u32_dpp v62, v62, v62 row_shr:1 row_mask:0xf bank_mask:0xf
  s_nop 1
  v_max_u32_dpp v62, v62, v62 row_shr:2 row_mask:0xf bank_mask:0xf
  s_nop 1
  v_max_u32_dpp v62, v62, v62 row_shr:4 row_mask:0xf bank_mask:0xf
  s_nop 1
  v_max_u32_dpp v62, v62, v62 row_shr:8 row_mask:0xf bank_mask:0xf
  s_nop 1
  v_max_u32_dpp v62, v62, v62 row_bcast:15 row_mask:0xa bank_mask:0xf
  s_nop 1
  v_max_u32_dpp v62, v62, v62 row_bcast:31 row_mask:0xc bank_mask:0xf
  s_nop 0
  v_readlane_b32 s68, v62, 63
  s_nop 1
  v_mov_b32 v62, s68
  ds_max_u32 v1, v62 offset:28
  ds_add_u32 v1, v3 offset:24
  s_setprio 0
  v_lshl_add_u32 v24, v24, 7, v18
  v_lshl_add_u32 v25, v25, 7, v18
  s_mov_b32 exec_hi, 0x0000ffff
  v_lshl_add_u32 v26, v26, 7, v18
  v_lshl_add_u32 v27, v27, 7, v18
  s_mov_b32 exec_lo, 0
  s_mov_b32 exec_hi, 0xffff0000
  v_mov_b32 v27, v25
  v_mov_b32 v26, v25
  s_mov_b32 exec_hi, 0x00ff0000
  v_mov_b32 v26, v24
  s_mov_b64 exec, -1
  s_add_u32 m0, s74, 0
  s_nop 0
  buffer_load_dwordx4 v24, s[32:35], 0 offen lds
  s_add_u32 m0, s74, 1056
  s_nop 0
  buffer_load_dwordx4 v25, s[32:35], 0 offen lds
  s_add_u32 m0, s74, 2112
  s_nop 0
  buffer_load_dwordx4 v26, s[32:35], 0 offen lds
  s_add_u32 m0, s74, 3168
  s_mov_b32 exec_hi, 0x00ffffff
  buffer_load_dwordx4 v27, s[32:35], 0 offen lds
  s_mov_b32 exec_hi, -1
  v_lshl_add_u32 v204, v204, 7, v18
  v_lshl_add_u32 v205, v205, 7, v18
  s_mov_b32 exec_hi, 0x0000ffff
  v_lshl_add_u32 v206, v206, 7, v18
  v_lshl_add_u32 v207, v207, 7, v18
  s_mov_b32 exec_lo, 0
  s_mov_b32 exec_hi, 0xffff0000
  v_mov_b32 v207, v205
  v_mov_b32 v206, v205
  s_mov_b32 exec_hi, 0x00ff0000
  v_mov_b32 v206, v204
  s_mov_b64 exec, -1
  s_add_u32 m0, s74, -16896
  s_nop 0
  buffer_load_dwordx4 v204, s[32:35], 0 offen lds
  s_add_u32 m0, s74, -15840
  s_nop 0
  buffer_load_dwordx4 v205, s[32:35], 0 offen lds
  s_add_u32 m0, s74, -14784
  s_nop 0
  buffer_load_dwordx4 v206, s[32:35], 0 offen lds
  s_add_u32 m0, s74, -13728
  s_mov_b32 exec_hi, 0x00ffffff
  buffer_load_dwordx4 v207, s[32:35], 0 offen lds
  s_mov_b32 exec_hi, -1
  buffer_load_dwordx4 v[24:27], v17, s[28:31], s94 offen offset:0
  s_add_u32 s94, s94, 832
  s_branch L_uph
L_g0pf:
  s_waitcnt vmcnt(4) lgkmcnt(0)
  ds_add_u32 v1, v3 offset:0
  s_add_u32 m0, s95, 52672
  s_add_u32 s81, s95, 51536
  buffer_load_dwordx4 v48, s[36:39], s81 offen lds
  s_add_u32 m0, s95, 56768
  s_add_u32 s81, s95, 55632
  buffer_load_dwordx4 v48, s[36:39], s81 offen lds
  s_add_u32 m0, s95, 60864
  s_add_u32 s81, s95, 59728
  buffer_load_dwordx4 v48, s[36:39], s81 offen lds
  s_add_u32 m0, s95, 64960
  s_add_u32 s81, s95, 63824
  buffer_load_dwordx4 v48, s[36:39], s81 offen lds
  s_add_u32 m0, s96, 36288
  s_add_u32 s81, s96, 35152
  s_mov_b64 exec, s[82:83]
  buffer_load_dwordx4 v48, s[36:39], s81 offen lds
  s_mov_b64 exec, -1
  s_add_u32 m0, s95, 1024
  s_add_u32 s81, s95, 0
  buffer_load_dwordx4 v48, s[36:39], s81 offen lds
  s_add_u32 m0, s95, 5120
  s_add_u32 s81, s95, 4096
  buffer_load_dwordx4 v48, s[36:39], s81 offen lds
  s_add_u32 m0, s95, 9216
  s_add_u32 s81, s95, 8192
  buffer_load_dwordx4 v48, s[36:39], s81 offen lds
  s_add_u32 m0, s95, 13312
  s_add_u32 s81, s95, 12288
  buffer_load_dwordx4 v48, s[36:39], s81 offen lds
  s_waitcnt vmcnt(4) lgkmcnt(0)
  ds_add_u32 v1, v3 offset:4
  s_add_u32 m0, s95, 17408
  s_add_u32 s81, s95, 16384
  buffer_load_dwordx4 v48, s[36:39], s81 offen lds
  s_add_u32 m0, s95, 21504
  s_add_u32 s81, s95, 20476
  buffer_load_dwordx4 v248, s[36:39], s81 offen lds
  s_add_u32 m0, s95, 25600
  s_add_u32 s81, s95, 24572
  buffer_load_dwordx4 v48, s[36:39], s81 offen lds
  s_add_u32 m0, s95, 29696
  s_add_u32 s81, s95, 28668
  buffer_load_dwordx4 v48, s[36:39], s81 offen lds
  s_add_u32 m0, s96, 1024
  s_lshr_b32 s81, s96, 13
  s_sub_u32 s81, s96, s81
  s_mov_b64 exec, s[82:83]
  buffer_load_dwordx4 v48, s[36:39], s81 offen lds
  s_mov_b64 exec, -1
  s_add_u32 s94, s94, 832
  s_add_u32 s77, s77, 24
  buffer_load_dwordx4 v[24:27], v17, s[28:31], s94 offen offset:0
  s_add_u32 s94, s94, 832
  buffer_load_dword v21, v20, s[28:31], s77 offen
  s_cmp_eq_u32 s77, s73
  s_cselect_b32 s73, 0x7000000, s73
  s_cselect_b32 s77, 0x7000000, s77
  s_add_u32 s77, s77, 24
  s_min_u32 s77, s77, s73
  s_mov_b64 exec, 131071
  buffer_load_dword v255, v19, s[44:47], s101 offen
  s_mov_b64 exec, -1
  s_add_u32 s101, s101, 1171456
  s_waitcnt vmcnt(3) lgkmcnt(0)
  ds_add_u32 v1, v3 offset:8
  s_mov_b32 s97, 0
L_csync4:
  ds_read_b32 v4, v2 offset:8
  s_waitcnt lgkmcnt(0)
  v_cmp_gt_u32 vcc, 4, v4
  s_cbranch_vccnz L_csync4
  s_cmp_ge_u32 s79, 2
  s_cbranch_scc1 L_chunk2
L_chunk0:
  ds_read_u16_d16_hi v216, v49 offset:0
  ds_read_u16_d16_hi v218, v49 offset:648
  ds_read_u16_d16_hi v220, v49 offset:216
  ds_read_u16_d16_hi v222, v49 offset:864
  ds_read_u16_d16_hi v224, v49 offset:432
  ds_read_u16_d16_hi v226, v49 offset:1080
  ds_read_u16_d16_hi v228, v49 offset:8
  ds_read_u16_d16_hi v229, v49 offset:208
  ds_read_u16_d16_hi v230, v49 offset:656
  ds_read_u16_d16_hi v231, v49 offset:856
  ds_read_u16_d16_hi v232, v49 offset:32
  ds_read_u16_d16_hi v233, v49 offset:832
  ds_read_u16_d16_hi v234, v49 offset:632
  ds_read_u16_d16_hi v235, v49 offset:232
  s_waitcnt lgkmcnt(12)
  v_mov_b32 v85, v218
  v_mov_b32 v84, v216
  v_max3_f32 v62, v62, abs(v84), abs(v85)
  ds_read_u16_d16_hi v236, v49 offset:16
  ds_read_u16_d16_hi v237, v49 offset:416
  ds_read_u16_d16_hi v238, v49 offset:664
  ds_read_u16_d16_hi v239, v49 offset:1064
  s_waitcnt lgkmcnt(14)
  v_mov_b32 v87, v222
  v_mov_b32 v86, v220
  v_max3_f32 v62, v62, abs(v86), abs(v87)
  ds_read_u16_d16_hi v216, v49 offset:40
  ds_read_u16_d16_hi v217, v49 offset:1040
  ds_read_u16_d16_hi v218, v49 offset:640
  ds_read_u16_d16_hi v219, v49 offset:440
  s_waitcnt lgkmcnt(14)
  v_mov_b32 v89, v226
  v_mov_b32 v88, v224
  v_max3_f32 v62, v62, abs(v88), abs(v89)
  ds_read_u16_d16_hi v220, v49 offset:224
  ds_read_u16_d16_hi v221, v49 offset:424
  ds_read_u16_d16_hi v222, v49 offset:872
  ds_read_u16_d16_hi v223, v49 offset:1072
  s_waitcnt lgkmcnt(14)
  v_add_f32 v91, v230, v231
  v_add_f32 v90, v228, v229
  v_max3_f32 v62, v62, abs(v90), abs(v91)
  ds_read_u16_d16_hi v224, v49 offset:248
  ds_read_u16_d16_hi v225, v49 offset:1048
  ds_read_u16_d16_hi v226, v49 offset:848
  ds_read_u16_d16_hi v227, v49 offset:448
  s_waitcnt lgkmcnt(14)
  v_add_f32 v93, v234, v235
  v_add_f32 v92, v232, v233
  v_max3_f32 v62, v62, abs(v92), abs(v93)
  ds_read_u16_d16_hi v228, v50 offset:48
  ds_read_u16_d16_hi v229, v51 offset:1248
  ds_read_u16_d16_hi v230, v50 offset:672
  ds_read_u16_d16_hi v231, v51 offset:1272
  s_waitcnt lgkmcnt(14)
  v_add_f32 v95, v238, v239
  v_add_f32 v94, v236, v237
  v_max3_f32 v62, v62, abs(v94), abs(v95)
  ds_read_u16_d16_hi v232, v50 offset:256
  ds_read_u16_d16_hi v233, v51 offset:1256
  ds_read_u16_d16_hi v234, v50 offset:880
  ds_read_u16_d16_hi v235, v51 offset:1280
  s_waitcnt lgkmcnt(14)
  v_add_f32 v97, v218, v219
  v_add_f32 v96, v216, v217
  v_max3_f32 v62, v62, abs(v96), abs(v97)
  ds_read_u16_d16_hi v236, v50 offset:464
  ds_read_u16_d16_hi v237, v51 offset:1264
  ds_read_u16_d16_hi v238, v50 offset:1088
  ds_read_u16_d16_hi v239, v51 offset:1288
  s_waitcnt lgkmcnt(14)
  v_add_f32 v99, v222, v223
  v_add_f32 v98, v220, v221
  v_max3_f32 v62, v62, abs(v98), abs(v99)
  s_waitcnt lgkmcnt(12)
  v_add_f32 v101, v226, v227
  v_add_f32 v100, v224, v225
  v_max3_f32 v62, v62, abs(v100), abs(v101)
  s_waitcnt lgkmcnt(8)
  v_add_f32 v103, v230, v231
  v_add_f32 v102, v228, v229
  v_max3_f32 v62, v62, abs(v102), abs(v103)
  s_waitcnt lgkmcnt(4)
  v_add_f32 v105, v234, v235
  v_add_f32 v104, v232, v233
  v_max3_f32 v62, v62, abs(v104), abs(v105)
  s_waitcnt lgkmcnt(0)
  v_add_f32 v107, v238, v239
  v_add_f32 v106, v236, v237
  v_max3_f32 v62, v62, abs(v106), abs(v107)
  s_cmp_lg_u32 s97, 0
  s_cbranch_scc1 L_uconv0
L_chunk1:
  ds_read_u16_d16_hi v216, v49 offset:24
  ds_read_u16_d16_hi v217, v49 offset:624
  ds_read_u16_d16_hi v218, v49 offset:240
  ds_read_u16_d16_hi v219, v49 offset:840
  ds_read_u16_d16_hi v220, v49 offset:456
  ds_read_u16_d16_hi v221, v49 offset:1056
  ds_read_u16_d16_hi v222, v60 offset:1296
  ds_read_u16_d16_hi v223, v61 offset:1296
  ds_read_u16_d16_hi v224, v52 offset:50
  ds_read_u16_d16_hi v225, v53 offset:1300
  ds_read_u16_d16_hi v226, v52 offset:674
  ds_read_u16_d16_hi v227, v53 offset:1324
  ds_read_u16_d16_hi v228, v52 offset:258
  ds_read_u16_d16_hi v229, v53 offset:1308
  ds_read_u16_d16_hi v230, v52 offset:882
  ds_read_u16_d16_hi v231, v53 offset:1332
  ds_read_u16_d16_hi v232, v52 offset:466
  ds_read_u16_d16_hi v233, v53 offset:1316
  ds_read_u16_d16_hi v234, v52 offset:1090
  ds_read_u16_d16_hi v235, v53 offset:1340
  s_waitcnt lgkmcnt(14)
  v_add_f32 v109, v218, v219
  v_add_f32 v108, v216, v217
  v_max3_f32 v62, v62, abs(v108), abs(v109)
  ds_read_u16_d16_hi v236, v54 offset:2
  ds_read_u16_d16_hi v237, v55 offset:52
  ds_read_u16_d16_hi v238, v54 offset:650
  ds_read_u16_d16_hi v239, v55 offset:700
  s_waitcnt lgkmcnt(14)
  v_add_f32 v111, v222, v223
  v_add_f32 v110, v220, v221
  v_max3_f32 v62, v62, abs(v110), abs(v111)
  ds_read_u16_d16_hi v216, v54 offset:26
  ds_read_u16_d16_hi v217, v55 offset:676
  ds_read_u16_d16_hi v218, v54 offset:626
  ds_read_u16_d16_hi v219, v55 offset:76
  s_waitcnt lgkmcnt(14)
  v_add_f32 v113, v226, v227
  v_add_f32 v112, v224, v225
  v_max3_f32 v62, v62, abs(v112), abs(v113)
  ds_read_u16_d16_hi v220, v54 offset:10
  ds_read_u16_d16_hi v221, v55 offset:260
  ds_read_u16_d16_hi v222, v54 offset:658
  ds_read_u16_d16_hi v223, v55 offset:908
  s_waitcnt lgkmcnt(14)
  v_add_f32 v115, v230, v231
  v_add_f32 v114, v228, v229
  v_max3_f32 v62, v62, abs(v114), abs(v115)
  ds_read_u16_d16_hi v224, v54 offset:34
  ds_read_u16_d16_hi v225, v55 offset:884
  ds_read_u16_d16_hi v226, v54 offset:634
  ds_read_u16_d16_hi v227, v55 offset:284
  s_waitcnt lgkmcnt(14)
  v_add_f32 v117, v234, v235
  v_add_f32 v116, v232, v233
  v_max3_f32 v62, v62, abs(v116), abs(v117)
  ds_read_u16_d16_hi v228, v54 offset:18
  ds_read_u16_d16_hi v229, v55 offset:468
  ds_read_u16_d16_hi v230, v54 offset:666
  ds_read_u16_d16_hi v231, v55 offset:1116
  s_waitcnt lgkmcnt(14)
  v_add_f32 v119, v238, v239
  v_add_f32 v118, v236, v237
  v_max3_f32 v62, v62, abs(v118), abs(v119)
  ds_read_u16_d16_hi v232, v54 offset:42
  ds_read_u16_d16_hi v233, v55 offset:1092
  ds_read_u16_d16_hi v234, v54 offset:642
  ds_read_u16_d16_hi v235, v55 offset:492
  s_waitcnt lgkmcnt(14)
  v_add_f32 v121, v218, v219
  v_add_f32 v120, v216, v217
  v_max3_f32 v62, v62, abs(v120), abs(v121)
  ds_read_u16_d16_hi v236, v54 offset:210
  ds_read_u16_d16_hi v237, v55 offset:60
  ds_read_u16_d16_hi v238, v54 offset:858
  ds_read_u16_d16_hi v239, v55 offset:708
  s_waitcnt lgkmcnt(14)
  v_add_f32 v123, v222, v223
  v_add_f32 v122, v220, v221
  v_max3_f32 v62, v62, abs(v122), abs(v123)
  s_waitcnt lgkmcnt(12)
  v_add_f32 v125, v226, v227
  v_add_f32 v124, v224, v225
  v_max3_f32 v62, v62, abs(v124), abs(v125)
  s_waitcnt lgkmcnt(8)
  v_add_f32 v127, v230, v231
  v_add_f32 v126, v228, v229
  v_max3_f32 v62, v62, abs(v126), abs(v127)
  s_waitcnt lgkmcnt(4)
  v_add_f32 v129, v234, v235
  v_add_f32 v128, v232, v233
  v_max3_f32 v62, v62, abs(v128), abs(v129)
  s_waitcnt lgkmcnt(0)
  v_add_f32 v131, v238, v239
  v_add_f32 v130, v236, v237
  v_max3_f32 v62, v62, abs(v130), abs(v131)
  s_cmp_lg_u32 s97, 0
  s_cbranch_scc1 L_uconv1
  s_branch L_w1conv
L_chunk2:
  ds_read_u16_d16_hi v216, v54 offset:234
  ds_read_u16_d16_hi v217, v55 offset:684
  ds_read_u16_d16_hi v218, v54 offset:834
  ds_read_u16_d16_hi v219, v55 offset:84
  ds_read_u16_d16_hi v220, v54 offset:218
  ds_read_u16_d16_hi v221, v55 offset:268
  ds_read_u16_d16_hi v222, v54 offset:866
  ds_read_u16_d16_hi v223, v55 offset:916
  ds_read_u16_d16_hi v224, v54 offset:242
  ds_read_u16_d16_hi v225, v55 offset:892
  ds_read_u16_d16_hi v226, v54 offset:842
  ds_read_u16_d16_hi v227, v55 offset:292
  ds_read_u16_d16_hi v228, v54 offset:226
  ds_read_u16_d16_hi v229, v55 offset:476
  ds_read_u16_d16_hi v230, v54 offset:874
  ds_read_u16_d16_hi v231, v55 offset:1124
  ds_read_u16_d16_hi v232, v54 offset:250
  ds_read_u16_d16_hi v233, v55 offset:1100
  ds_read_u16_d16_hi v234, v54 offset:850
  ds_read_u16_d16_hi v235, v55 offset:500
  s_waitcnt lgkmcnt(14)
  v_add_f32 v85, v218, v219
  v_add_f32 v84, v216, v217
  v_max3_f32 v62, v62, abs(v84), abs(v85)
  ds_read_u16_d16_hi v236, v54 offset:418
  ds_read_u16_d16_hi v237, v55 offset:68
  ds_read_u16_d16_hi v238, v54 offset:1066
  ds_read_u16_d16_hi v239, v55 offset:716
  s_waitcnt lgkmcnt(14)
  v_add_f32 v87, v222, v223
  v_add_f32 v86, v220, v221
  v_max3_f32 v62, v62, abs(v86), abs(v87)
  ds_read_u16_d16_hi v216, v54 offset:442
  ds_read_u16_d16_hi v217, v55 offset:692
  ds_read_u16_d16_hi v218, v54 offset:1042
  ds_read_u16_d16_hi v219, v55 offset:92
  s_waitcnt lgkmcnt(14)
  v_add_f32 v89, v226, v227
  v_add_f32 v88, v224, v225
  v_max3_f32 v62, v62, abs(v88), abs(v89)
  ds_read_u16_d16_hi v220, v54 offset:426
  ds_read_u16_d16_hi v221, v55 offset:276
  ds_read_u16_d16_hi v222, v54 offset:1074
  ds_read_u16_d16_hi v223, v55 offset:924
  s_waitcnt lgkmcnt(14)
  v_add_f32 v91, v230, v231
  v_add_f32 v90, v228, v229
  v_max3_f32 v62, v62, abs(v90), abs(v91)
  ds_read_u16_d16_hi v224, v54 offset:450
  ds_read_u16_d16_hi v225, v55 offset:900
  ds_read_u16_d16_hi v226, v54 offset:1050
  ds_read_u16_d16_hi v227, v55 offset:300
  s_waitcnt lgkmcnt(14)
  v_add_f32 v93, v234, v235
  v_add_f32 v92, v232, v233
  v_max3_f32 v62, v62, abs(v92), abs(v93)
  ds_read_u16_d16_hi v228, v54 offset:434
  ds_read_u16_d16_hi v229, v55 offset:484
  ds_read_u16_d16_hi v230, v54 offset:1082
  ds_read_u16_d16_hi v231, v55 offset:1132
  s_waitcnt lgkmcnt(14)
  v_add_f32 v95, v238, v239
  v_add_f32 v94, v236, v237
  v_max3_f32 v62, v62, abs(v94), abs(v95)
  ds_read_u16_d16_hi v232, v54 offset:458
  ds_read_u16_d16_hi v233, v55 offset:1108
  ds_read_u16_d16_hi v234, v54 offset:1058
  ds_read_u16_d16_hi v235, v55 offset:508
  s_waitcnt lgkmcnt(14)
  v_add_f32 v97, v218, v219
  v_add_f32 v96, v216, v217
  v_max3_f32 v62, v62, abs(v96), abs(v97)
  ds_read_u16_d16_hi v236, v56 offset:4
  ds_read_u16_d16_hi v237, v57 offset:104
  ds_read_u16_d16_hi v238, v58 offset:652
  ds_read_u16_d16_hi v239, v59 offset:752
  s_waitcnt lgkmcnt(14)
  v_add_f32 v99, v222, v223
  v_add_f32 v98, v220, v221
  v_max3_f32 v62, v62, abs(v98), abs(v99)
  s_waitcnt lgkmcnt(12)
  v_add_f32 v101, v226, v227
  v_add_f32 v100, v224, v225
  v_max3_f32 v62, v62, abs(v100), abs(v101)
  s_waitcnt lgkmcnt(8)
  v_add_f32 v103, v230, v231
  v_add_f32 v102, v228, v229
  v_max3_f32 v62, v62, abs(v102), abs(v103)
  s_waitcnt lgkmcnt(4)
  v_add_f32 v105, v234, v235
  v_add_f32 v104, v232, v233
  v_max3_f32 v62, v62, abs(v104), abs(v105)
  s_waitcnt lgkmcnt(0)
  v_add_f32 v107, v238, v239
  v_add_f32 v106, v236, v237
  v_max3_f32 v62, v62, abs(v106), abs(v107)
  s_cmp_lg_u32 s97, 0
  s_cbranch_scc1 L_uconv0
L_chunk3:
  ds_read_u16_d16_hi v216, v56 offset:220
  ds_read_u16_d16_hi v217, v57 offset:320
  ds_read_u16_d16_hi v218, v58 offset:868
  ds_read_u16_d16_hi v219, v59 offset:968
  ds_read_u16_d16_hi v220, v56 offset:436
  ds_read_u16_d16_hi v221, v57 offset:536
  ds_read_u16_d16_hi v222, v58 offset:1084
  ds_read_u16_d16_hi v223, v59 offset:1184
  ds_read_u16_d16_hi v224, v56 offset:12
  ds_read_u16_d16_hi v225, v57 offset:312
  ds_read_u16_d16_hi v226, v58 offset:660
  ds_read_u16_d16_hi v227, v59 offset:960
  ds_read_u16_d16_hi v228, v58 offset:36
  ds_read_u16_d16_hi v229, v59 offset:936
  ds_read_u16_d16_hi v230, v56 offset:636
  ds_read_u16_d16_hi v231, v57 offset:336
  ds_read_u16_d16_hi v232, v56 offset:20
  ds_read_u16_d16_hi v233, v57 offset:520
  ds_read_u16_d16_hi v234, v58 offset:668
  ds_read_u16_d16_hi v235, v59 offset:1168
  s_waitcnt lgkmcnt(14)
  v_add_f32 v109, v218, v219
  v_add_f32 v108, v216, v217
  v_max3_f32 v62, v62, abs(v108), abs(v109)
  ds_read_u16_d16_hi v236, v58 offset:44
  ds_read_u16_d16_hi v237, v59 offset:1144
  ds_read_u16_d16_hi v238, v56 offset:644
  ds_read_u16_d16_hi v239, v57 offset:544
  s_waitcnt lgkmcnt(14)
  v_add_f32 v111, v222, v223
  v_add_f32 v110, v220, v221
  v_max3_f32 v62, v62, abs(v110), abs(v111)
  ds_read_u16_d16_hi v216, v56 offset:228
  ds_read_u16_d16_hi v217, v57 offset:528
  ds_read_u16_d16_hi v218, v58 offset:876
  ds_read_u16_d16_hi v219, v59 offset:1176
  s_waitcnt lgkmcnt(14)
  v_add_f32 v113, v226, v227
  v_add_f32 v112, v224, v225
  v_max3_f32 v62, v62, abs(v112), abs(v113)
  ds_read_u16_d16_hi v220, v58 offset:252
  ds_read_u16_d16_hi v221, v59 offset:1152
  ds_read_u16_d16_hi v222, v56 offset:852
  ds_read_u16_d16_hi v223, v57 offset:552
  s_waitcnt lgkmcnt(14)
  v_add_f32 v115, v230, v231
  v_add_f32 v114, v228, v229
  v_max3_f32 v62, v62, abs(v114), abs(v115)
  ds_read_u16_d16_hi v224, v65 offset:0
  ds_read_u16_d16_hi v225, v65 offset:8
  ds_read_u16_d16_hi v226, v65 offset:16
  ds_read_u16_d16_hi v227, v65 offset:24
  ds_read_u16_d16_hi v228, v65 offset:32
  ds_read_u16_d16_hi v229, v65 offset:40
  ds_read_u16_d16_hi v230, v64 offset:48
  ds_read_u16_d16_hi v231, v67
  s_waitcnt lgkmcnt(14)
  v_add_f32 v117, v234, v235
  v_add_f32 v116, v232, v233
  v_max3_f32 v62, v62, abs(v116), abs(v117)
  v_add_f32 v119, v238, v239
  v_add_f32 v118, v236, v237
  v_max3_f32 v62, v62, abs(v118), abs(v119)
  s_waitcnt lgkmcnt(12)
  v_add_f32 v121, v218, v219
  v_add_f32 v120, v216, v217
  v_max3_f32 v62, v62, abs(v120), abs(v121)
  s_waitcnt lgkmcnt(8)
  v_add_f32 v123, v222, v223
  v_add_f32 v122, v220, v221
  v_max3_f32 v62, v62, abs(v122), abs(v123)
  s_cmp_lg_u32 s97, 0
  s_cbranch_scc1 L_uconv1
L_w1conv:
  v_max_u32_dpp v62, v62, v62 row_shr:1 row_mask:0xf bank_mask:0xf
  s_nop 1
  v_max_u32_dpp v62, v62, v62 row_shr:2 row_mask:0xf bank_mask:0xf
  s_nop 1
  v_max_u32_dpp v62, v62, v62 row_shr:4 row_mask:0xf bank_mask:0xf
  s_nop 1
  v_max_u32_dpp v62, v62, v62 row_shr:8 row_mask:0xf bank_mask:0xf
  s_nop 1
  v_max_u32_dpp v62, v62, v62 row_bcast:15 row_mask:0xa bank_mask:0xf
  s_nop 1
  v_max_u32_dpp v62, v62, v62 row_bcast:31 row_mask:0xc bank_mask:0xf
  s_nop 0
  v_readlane_b32 s68, v62, 63
  s_nop 1
  v_mov_b32 v62, s68
  ds_max_u32 v1, v62 offset:20
  ds_add_u32 v1, v3 offset:16
  v_add_u32 v49, v49, v247
  v_add_u32 v50, v50, v247
  v_add_u32 v51, v51, v247
  v_add_u32 v52, v52, v247
  v_add_u32 v53, v53, v247
  v_add_u32 v54, v54, v247
  v_add_u32 v55, v55, v247
  v_add_u32 v56, v56, v247
  v_add_u32 v57, v57, v247
  v_add_u32 v58, v58, v247
  v_add_u32 v59, v59, v247
  v_add_u32 v60, v60, v247
  v_add_u32 v61, v61, v247
L_csync5:
  ds_read_b64 v[40:41], v2 offset:16
  s_waitcnt lgkmcnt(0)
  v_cmp_gt_u32 vcc, 4, v40
  s_cbranch_vccnz L_csync5
  v_readfirstlane_b32 s70, v41
  s_nop 0
  s_lshr_b32 s70, s70, 23
  s_sub_i32 s70, 141, s70
  s_min_i32 s70, s70, 40
  s_add_i32 s51, s70, 127
  s_lshl_b32 s51, s51, 23
  v_fma_mixlo_f16 v132, v84, s51, 0
  v_fma_mixlo_f16 v133, v86, s51, 0
  v_fma_mixlo_f16 v134, v88, s51, 0
  v_fma_mixlo_f16 v135, v90, s51, 0
  v_fma_mixhi_f16 v132, v85, s51, 0
  v_fma_mixhi_f16 v133, v87, s51, 0
  v_fma_mixhi_f16 v134, v89, s51, 0
  v_fma_mixhi_f16 v135, v91, s51, 0
  v_fma_mixlo_f16 v136, v92, s51, 0
  v_fma_mixlo_f16 v137, v94, s51, 0
  v_fma_mixlo_f16 v138, v96, s51, 0
  v_fma_mixlo_f16 v139, v98, s51, 0
  v_fma_mixhi_f16 v136, v93, s51, 0
  v_fma_mixhi_f16 v137, v95, s51, 0
  v_fma_mixhi_f16 v138, v97, s51, 0
  v_fma_mixhi_f16 v139, v99, s51, 0
  ds_write_b128 v63, v[132:135] offset:0
  v_fma_mixlo_f16 v140, v100, s51, 0
  v_fma_mixlo_f16 v141, v102, s51, 0
  v_fma_mixlo_f16 v142, v104, s51, 0
  v_fma_mixlo_f16 v143, v106, s51, 0
  v_fma_mixhi_f16 v140, v101, s51, 0
  v_fma_mixhi_f16 v141, v103, s51, 0
  v_fma_mixhi_f16 v142, v105, s51, 0
  v_fma_mixhi_f16 v143, v107, s51, 0
  ds_write_b128 v63, v[136:139] offset:1024
  v_fma_mixlo_f16 v144, v108, s51, 0
  v_fma_mixlo_f16 v145, v110, s51, 0
  v_fma_mixlo_f16 v146, v112, s51, 0
  v_fma_mixlo_f16 v147, v114, s51, 0
  v_fma_mixhi_f16 v144, v109, s51, 0
  v_fma_mixhi_f16 v145, v111, s51, 0
  v_fma_mixhi_f16 v146, v113, s51, 0
  v_fma_mixhi_f16 v147, v115, s51, 0
  ds_write_b128 v63, v[140:143] offset:2048
  v_fma_mixlo_f16 v148, v116, s51, 0
  v_fma_mixlo_f16 v149, v118, s51, 0
  v_fma_mixlo_f16 v150, v120, s51, 0
  v_fma_mixlo_f16 v151, v122, s51, 0
  v_fma_mixhi_f16 v148, v117, s51, 0
  v_fma_mixhi_f16 v149, v119, s51, 0
  v_fma_mixhi_f16 v150, v121, s51, 0
  v_fma_mixhi_f16 v151, v123, s51, 0
  ds_write_b128 v63, v[144:147] offset:3072
  ds_write_b128 v63, v[148:151] offset:4096
  s_cmp_ge_u32 s79, 2
  s_cbranch_scc1 L_w1x
  v_fma_mixlo_f16 v152, v124, s51, 0
  v_fma_mixlo_f16 v153, v126, s51, 0
  v_fma_mixlo_f16 v154, v128, s51, 0
  v_fma_mixlo_f16 v155, v130, s51, 0
  v_fma_mixhi_f16 v152, v125, s51, 0
  v_fma_mixhi_f16 v153, v127, s51, 0
  v_fma_mixhi_f16 v154, v129, s51, 0
  v_fma_mixhi_f16 v155, v131, s51, 0
  ds_write_b128 v63, v[152:155] offset:5120
L_w1x:
L_uph:
L_csync6:
  ds_read_b64 v[40:41], v2 offset:24
  s_waitcnt lgkmcnt(0)
  v_cmp_gt_u32 vcc, 4, v40
  s_cbranch_vccnz L_csync6
  v_readfirstlane_b32 s71, v41
  s_nop 0
  s_lshr_b32 s71, s71, 23
  s_sub_i32 s71, 140, s71
  s_min_i32 s71, s71, 40
  s_add_i32 s51, s71, 127
  s_lshl_b32 s51, s51, 23
  s_mov_b32 s97, 1
  s_lshr_b32 s69, s3, 1
  s_cmp_eq_u32 s69, 0
  s_cbranch_scc1 L_chunk0
  s_cmp_eq_u32 s69, 1
  s_cbranch_scc1 L_chunk1
  s_cmp_eq_u32 s69, 2
  s_cbranch_scc1 L_chunk2
  s_branch L_chunk3
L_uconv0:
  v_fma_mixlo_f16 v132, v84, s51, 0
  v_fma_mixlo_f16 v133, v86, s51, 0
  v_fma_mixlo_f16 v134, v88, s51, 0
  v_fma_mixlo_f16 v135, v90, s51, 0
  v_fma_mixhi_f16 v132, v85, s51, 0
  v_fma_mixhi_f16 v133, v87, s51, 0
  v_fma_mixhi_f16 v134, v89, s51, 0
  v_fma_mixhi_f16 v135, v91, s51, 0
L_csync7:
  ds_read_b64 v[40:41], v2 offset:16
  s_waitcnt lgkmcnt(0)
  v_cmp_gt_u32 vcc, 4, v40
  s_cbranch_vccnz L_csync7
  v_readfirstlane_b32 s70, v41
  s_nop 0
  s_lshr_b32 s70, s70, 23
  s_sub_i32 s70, 141, s70
  s_min_i32 s70, s70, 40
  ds_write_b128 v66, v[132:135] offset:0
  v_fma_mixlo_f16 v136, v92, s51, 0
  v_fma_mixlo_f16 v137, v94, s51, 0
  v_fma_mixlo_f16 v138, v96, s51, 0
  v_fma_mixlo_f16 v139, v98, s51, 0
  v_fma_mixhi_f16 v136, v93, s51, 0
  v_fma_mixhi_f16 v137, v95, s51, 0
  v_fma_mixhi_f16 v138, v97, s51, 0
  v_fma_mixhi_f16 v139, v99, s51, 0
  ds_write_b128 v66, v[136:139] offset:1024
  v_fma_mixlo_f16 v140, v100, s51, 0
  v_fma_mixlo_f16 v141, v102, s51, 0
  v_fma_mixlo_f16 v142, v104, s51, 0
  v_fma_mixlo_f16 v143, v106, s51, 0
  v_fma_mixhi_f16 v140, v101, s51, 0
  v_fma_mixhi_f16 v141, v103, s51, 0
  v_fma_mixhi_f16 v142, v105, s51, 0
  v_fma_mixhi_f16 v143, v107, s51, 0
  ds_write_b128 v66, v[140:143] offset:2048
  s_branch L_built
L_uconv1:
  v_fma_mixlo_f16 v144, v108, s51, 0
  v_fma_mixlo_f16 v145, v110, s51, 0
  v_fma_mixlo_f16 v146, v112, s51, 0
  v_fma_mixlo_f16 v147, v114, s51, 0
  v_fma_mixhi_f16 v144, v109, s51, 0
  v_fma_mixhi_f16 v145, v111, s51, 0
  v_fma_mixhi_f16 v146, v113, s51, 0
  v_fma_mixhi_f16 v147, v115, s51, 0
L_csync8:
  ds_read_b64 v[40:41], v2 offset:16
  s_waitcnt lgkmcnt(0)
  v_cmp_gt_u32 vcc, 4, v40
  s_cbranch_vccnz L_csync8
  v_readfirstlane_b32 s70, v41
  s_nop 0
  s_lshr_b32 s70, s70, 23
  s_sub_i32 s70, 141, s70
  s_min_i32 s70, s70, 40
  ds_write_b128 v66, v[144:147] offset:3072
  v_fma_mixlo_f16 v148, v116, s51, 0
  v_fma_mixlo_f16 v149, v118, s51, 0
  v_fma_mixlo_f16 v150, v120, s51, 0
  v_fma_mixlo_f16 v151, v122, s51, 0
  v_fma_mixhi_f16 v148, v117, s51, 0
  v_fma_mixhi_f16 v149, v119, s51, 0
  v_fma_mixhi_f16 v150, v121, s51, 0
  v_fma_mixhi_f16 v151, v123, s51, 0
  ds_write_b128 v66, v[148:151] offset:4096
  s_cmp_lg_u32 s84, 0
  s_cbranch_scc1 L_ulin
  v_fma_mixlo_f16 v152, v124, s51, 0
  v_fma_mixlo_f16 v153, v126, s51, 0
  v_fma_mixlo_f16 v154, v128, s51, 0
  v_fma_mixlo_f16 v155, v130, s51, 0
  v_fma_mixhi_f16 v152, v125, s51, 0
  v_fma_mixhi_f16 v153, v127, s51, 0
  v_fma_mixhi_f16 v154, v129, s51, 0
  v_fma_mixhi_f16 v155, v131, s51, 0
  ds_write_b128 v66, v[152:155] offset:5120
  s_branch L_built
L_ulin:
  v_mul_f32 v224, s51, v224
  v_mul_f32 v225, s51, v225
  v_mul_f32 v226, s51, v226
  v_mul_f32 v227, s51, v227
  v_mul_f32 v228, s51, v228
  v_mul_f32 v229, s51, v229
  v_mul_f32 v230, s51, v230
  v_mul_f32 v231, s51, v231
  v_cvt_pk_bf16_f32 v152, v224, v225
  v_cvt_pk_bf16_f32 v153, v226, v227
  v_cvt_pk_bf16_f32 v154, v228, v229
  v_cvt_pk_bf16_f32 v155, v230, v231
  ds_write_b128 v66, v[152:155] offset:5120
L_built:
  s_waitcnt vmcnt(1)
  v_mov_b32 v4, s84
  ds_add_u32 v1, v4 offset:36
  s_mov_b32 s60, s24
  s_and_b32 s61, s25, 0xffff
  s_mov_b32 s62, 268435456
  s_mov_b32 s63, 0x20000
  s_mov_b32 s64, s22
  s_and_b32 s65, s23, 0xffff
  s_mov_b32 s66, 256
  s_mov_b32 s67, 0x20000
  v_lshlrev_b32 v251, 2, v0
  s_mov_b64 exec, 0xff
  s_mov_b32 s81, 0x80000
  buffer_load_dword v255, v251, s[60:63], s81 offen
  buffer_load_dword v249, v251, s[64:67], 0 offen offset:128 sc1
  s_mov_b64 exec, -1
  v_mov_b32 v251, 0
  s_add_i32 s48, s70, s71
L_csync9:
  ds_read_b32 v4, v2 offset:36
  s_waitcnt lgkmcnt(0)
  v_cmp_gt_u32 vcc, 4, v4
  s_cbranch_vccnz L_csync9
  ds_read_u16_d16_hi v32, v7 offset:0
  ds_read_u16_d16_hi v33, v7 offset:128
  ds_read_u16_d16_hi v34, v7 offset:256
  ds_read_u16_d16_hi v35, v7 offset:384
  ds_read_u16_d16_hi v36, v7 offset:512
  ds_read_u16_d16_hi v37, v7 offset:640
  ds_read_u16_d16_hi v38, v7 offset:768
  ds_read_u16_d16_hi v39, v7 offset:896
  s_waitcnt lgkmcnt(0)
  v_cvt_pk_f16_f32 v43, v38, v39
  v_cvt_pk_f16_f32 v40, v32, v35
  v_cvt_pk_f16_f32 v41, v33, v36
  v_cvt_pk_f16_f32 v42, v34, v37
  ds_write_b128 v10, v[40:43]
  ds_read_b128 v[44:47], v11
  ds_read_b128 v[48:51], v12
  ds_read_b64_tr_b16 v[52:53], v8 offset:0
  ds_read_b64_tr_b16 v[54:55], v8 offset:512
  v_pk_mul_f16 v56, v40, v40 op_sel:[0,0] op_sel_hi:[1,1]
  v_pk_mul_f16 v57, v41, v41 op_sel:[0,0] op_sel_hi:[1,1]
  v_pk_mul_f16 v58, v42, v42 op_sel:[0,0] op_sel_hi:[1,1]
  v_pk_mul_f16 v59, v40, v41 op_sel:[0,0] op_sel_hi:[1,1]
  ds_read_u16_d16_hi v32, v7 offset:32
  ds_read_u16_d16_hi v33, v7 offset:160
  s_waitcnt vmcnt(3)
  v_lshlrev_b32 v21, 7, v21
  buffer_load_dword v255, v21, s[32:35], 0 offen
  s_mov_b64 exec, 131071
  buffer_load_dword v255, v19, s[44:47], s101 offen
  s_mov_b64 exec, -1
  s_add_u32 s101, s101, 1171456
  s_waitcnt lgkmcnt(0)
  s_barrier
  s_setprio 1
  ds_read_b128 v[240:243], v28 offset:46528
  ds_read_b128 v[128:131], v28 offset:35264
  ds_read_b128 v[84:87], v28 offset:0
  ds_read_b128 v[216:219], v22
  ds_read_b128 v[244:247], v30 offset:22528
  ds_read_b128 v[172:175], v31 offset:11264
  ds_read_b128 v[176:179], v31 offset:12288
  ds_read_b128 v[180:183], v31 offset:13312
  ds_read2_b32 v[220:221], v29 offset0:0 offset1:2
  ds_read2_b32 v[222:223], v29 offset0:64 offset1:66
  v_add_u32 v29, 2048, v29
  ds_read_b128 v[88:91], v28 offset:1024
  ds_read_b128 v[92:95], v28 offset:2048
  ds_read_b128 v[132:135], v28 offset:36288
  ds_read_b128 v[136:139], v28 offset:37312
  ds_read_b128 v[140:143], v28 offset:38336
  ds_read_b128 v[144:147], v28 offset:39360
  ds_read2_b32 v[224:225], v29 offset0:0 offset1:2
  ds_read2_b32 v[226:227], v29 offset0:64 offset1:66
  v_add_u32 v29, 2048, v29
  s_cmp_lg_u32 s84, 0
  s_cbranch_scc1 L_prf
  s_setprio 2
L_prf:
  s_waitcnt lgkmcnt(14)
  v_mfma_f32_16x16x32_bf16 v[72:75], v[240:243], v[52:55], 0
  ds_read_b128 v[184:187], v31 offset:14336
  v_mfma_f32_16x16x32_f16 v[72:75], v[128:131], v[56:59], v[72:75]
  ds_read_b128 v[188:191], v31 offset:15360
  v_mfma_f32_16x16x32_f16 v[68:71], v[84:87], v[56:59], 0
  ds_read_b128 v[96:99], v28 offset:3072
  v_pk_mul_f16 v60, v40, v41 op_sel:[0,1] op_sel_hi:[1,0]
  v_mfma_f32_16x16x32_f16 v[80:83], v[216:219], v[56:59], 0
  ds_read_b128 v[100:103], v28 offset:4096
  v_pk_mul_f16 v61, v40, v42 op_sel:[0,0] op_sel_hi:[1,1]
  v_pk_mul_f16 v62, v40, v42 op_sel:[0,1] op_sel_hi:[1,0]
  s_waitcnt lgkmcnt(14)
  v_mfma_f32_16x16x32_bf16 v[76:79], v[244:247], v[52:55], 0
  ds_read_b128 v[104:107], v28 offset:5120
  v_pk_mul_f16 v63, v41, v42 op_sel:[0,0] op_sel_hi:[1,1]
  v_pk_mul_f16 v64, v41, v42 op_sel:[0,1] op_sel_hi:[1,0]
  v_mfma_f32_16x16x32_f16 v[76:79], v[172:175], v[56:59], v[76:79]
  ds_read_b128 v[108:111], v28 offset:6144
  v_pk_mul_f16 v65, v40, v43 op_sel:[0,0] op_sel_hi:[1,0]
  v_pk_mul_f16 v66, v41, v43 op_sel:[0,0] op_sel_hi:[1,0]
  v_pk_mul_f16 v67, v42, v43 op_sel:[0,0] op_sel_hi:[1,0]
  v_mfma_f32_16x16x32_f16 v[76:79], v[176:179], v[60:63], v[76:79]
  ds_read2_b32 v[228:229], v29 offset0:0 offset1:2
  ds_read2_b32 v[230:231], v29 offset0:64 offset1:66
  v_add_u32 v29, 2048, v29
  v_alignbit_b32 v48, v48, v48, v13
  v_mfma_f32_16x16x32_f16 v[76:79], v[180:183], v[64:67], v[76:79]
  ds_read_b128 v[148:151], v28 offset:40384
  v_mul_f16_sdwa v52, v40, v40 dst_sel:WORD_0 dst_unused:UNUSED_PAD src0_sel:WORD_0 src1_sel:WORD_1
  v_mul_f16_sdwa v53, v42, v42 dst_sel:WORD_0 dst_unused:UNUSED_PAD src0_sel:WORD_0 src1_sel:WORD_1
  s_waitcnt lgkmcnt(14)
  v_smfmac_f32_16x16x64_f16 v[80:83], v[220:223], v[60:67], v16
  ds_read_b128 v[152:155], v28 offset:41408
  v_alignbit_b32 v49, v49, v49, v13
  v_mfma_f32_16x16x32_f16 v[68:71], v[88:91], v[60:63], v[68:71]
  ds_read_b128 v[192:195], v31 offset:16384
  v_mul_f16_sdwa v52, v41, v41 dst_sel:WORD_1 dst_unused:UNUSED_PRESERVE src0_sel:WORD_0 src1_sel:WORD_1
  v_mul_f16_sdwa v53, v43, v43 dst_sel:WORD_1 dst_unused:UNUSED_PRESERVE src0_sel:WORD_0 src1_sel:WORD_1
  v_mfma_f32_16x16x32_f16 v[68:71], v[92:95], v[64:67], v[68:71]
  ds_read_b128 v[196:199], v31 offset:17408
  v_pk_mul_f16 v54, v40, v47 op_sel:[0,0] op_sel_hi:[1,0]
  v_mfma_f32_16x16x32_f16 v[72:75], v[132:135], v[60:63], v[72:75]
  ds_read_b128 v[200:203], v31 offset:18432
  v_pk_mul_f16 v55, v41, v47 op_sel:[0,0] op_sel_hi:[1,0]
  v_pk_mul_f16 v56, v42, v47 op_sel:[0,0] op_sel_hi:[1,0]
  s_waitcnt lgkmcnt(14)
  v_mfma_f32_16x16x32_f16 v[72:75], v[136:139], v[64:67], v[72:75]
  ds_read_b128 v[204:207], v31 offset:19456
  v_pk_mul_f16 v57, v40, v44 op_sel:[0,0] op_sel_hi:[1,1]
  v_pk_mul_f16 v58, v40, v44 op_sel:[0,1] op_sel_hi:[1,0]
  v_pk_mul_f16 v59, v40, v45 op_sel:[0,0] op_sel_hi:[1,1]
  v_mfma_f32_16x16x32_f16 v[72:75], v[140:143], v[52:55], v[72:75]
  ds_read2_b32 v[232:233], v29 offset0:0 offset1:2
  ds_read2_b32 v[234:235], v29 offset0:64 offset1:66
  v_add_u32 v29, 2048, v29
  v_pk_mul_f16 v60, v40, v45 op_sel:[0,1] op_sel_hi:[1,0]
  v_mfma_f32_16x16x32_f16 v[72:75], v[144:147], v[56:59], v[72:75]
  ds_read_b128 v[156:159], v28 offset:42432
  v_pk_mul_f16 v61, v40, v46 op_sel:[0,0] op_sel_hi:[1,1]
  v_pk_mul_f16 v62, v40, v46 op_sel:[0,1] op_sel_hi:[1,0]
  s_waitcnt lgkmcnt(14)
  v_smfmac_f32_16x16x64_f16 v[80:83], v[224:227], v[52:59], v16
  ds_read_b128 v[160:163], v28 offset:43456
  v_pk_mul_f16 v63, v41, v44 op_sel:[0,0] op_sel_hi:[1,1]
  v_mfma_f32_16x16x32_f16 v[76:79], v[184:187], v[52:55], v[76:79]
  ds_read_b128 v[112:115], v28 offset:7168
  v_pk_mul_f16 v64, v41, v44 op_sel:[0,1] op_sel_hi:[1,0]
  v_pk_mul_f16 v65, v41, v45 op_sel:[0,0] op_sel_hi:[1,1]
  v_mfma_f32_16x16x32_f16 v[76:79], v[188:191], v[56:59], v[76:79]
  ds_read_b128 v[116:119], v28 offset:8192
  v_pk_mul_f16 v66, v41, v45 op_sel:[0,1] op_sel_hi:[1,0]
  v_mfma_f32_16x16x32_f16 v[68:71], v[96:99], v[52:55], v[68:71]
  ds_read_b128 v[120:123], v28 offset:9216
  v_pk_mul_f16 v67, v41, v46 op_sel:[0,0] op_sel_hi:[1,1]
  ds_write_b16 v15, v14 offset:4064
  s_and_b32 s81, s2, 7
  s_waitcnt vmcnt(2)
  v_cmp_eq_u32 vcc, 0, v249
  s_nop 0
  s_bitcmp1_b32 vcc_lo, s81
  s_cbranch_scc0 L_cclr_ok
  s_mov_b32 s78, 0x40000
L_cclr:
  s_sub_u32 s78, s78, 1
  s_cbranch_scc1 L_cclr_ok
  v_lshlrev_b32 v249, 2, v0
  v_and_b32 v249, 31, v249
  buffer_load_dword v249, v249, s[64:67], 0 offen offset:128 sc1
  s_waitcnt vmcnt(0)
  v_cmp_eq_u32 vcc, 0, v249
  s_nop 0
  s_bitcmp1_b32 vcc_lo, s81
  s_cbranch_scc1 L_cclr
L_cclr_ok:
  v_lshl_add_u32 v24, v24, 7, v18
  v_lshl_add_u32 v25, v25, 7, v18
  s_mov_b32 exec_hi, 0x0000ffff
  v_lshl_add_u32 v26, v26, 7, v18
  v_lshl_add_u32 v27, v27, 7, v18
  s_mov_b32 exec_lo, 0
  s_mov_b32 exec_hi, 0xffff0000
  v_mov_b32 v27, v25
  v_mov_b32 v26, v25
  s_mov_b32 exec_hi, 0x00ff0000
  v_mov_b32 v26, v24
  s_mov_b64 exec, -1
  s_add_u32 m0, s74, -39488
  s_nop 0
  buffer_load_dwordx4 v24, s[32:35], 0 offen lds
  s_add_u32 m0, s74, -38432
  s_nop 0
  buffer_load_dwordx4 v25, s[32:35], 0 offen lds
  s_add_u32 m0, s74, -37376
  s_nop 0
  buffer_load_dwordx4 v26, s[32:35], 0 offen lds
  s_add_u32 m0, s74, -36320
  s_mov_b32 exec_hi, 0x00ffffff
  buffer_load_dwordx4 v27, s[32:35], 0 offen lds
  s_mov_b32 exec_hi, -1
  s_mov_b64 exec, 131071
  buffer_load_dword v255, v19, s[44:47], s101 offen
  s_mov_b64 exec, -1
  s_add_u32 s101, s101, 1171456
  s_sub_i32 s48, 0, s48
  s_mov_b32 s49, s48
  s_mov_b32 s97, 1
  s_mov_b32 s50, 1
  s_mov_b32 s96, 0
  s_cmp_lg_u32 s3, 7
  s_cbranch_scc1 L_nw0
  s_mov_b32 s52, s16
  s_and_b32 s53, s17, 0xffff
  s_mov_b32 s54, 3328
  s_mov_b32 s55, 0x20000
  v_lshlrev_b32 v22, 7, v0
  buffer_load_dword v255, v22, s[52:55], 0 offen
L_nw0:
  v_alignbit_b32 v50, v50, v50, v13
  s_waitcnt lgkmcnt(14)
  v_mfma_f32_16x16x32_f16 v[68:71], v[100:103], v[56:59], v[68:71]
  ds_read_b128 v[124:127], v28 offset:10240
  v_pk_mul_f16 v52, v41, v46 op_sel:[0,1] op_sel_hi:[1,0]
  v_pk_mul_f16 v53, v42, v44 op_sel:[0,0] op_sel_hi:[1,1]
  v_mfma_f32_16x16x32_f16 v[68:71], v[104:107], v[60:63], v[68:71]
  ds_read_b128 v[164:167], v28 offset:44480
  v_pk_mul_f16 v54, v42, v44 op_sel:[0,1] op_sel_hi:[1,0]
  v_pk_mul_f16 v55, v42, v45 op_sel:[0,0] op_sel_hi:[1,1]
  v_mfma_f32_16x16x32_f16 v[68:71], v[108:111], v[64:67], v[68:71]
  ds_read_b128 v[168:171], v28 offset:45504
  v_pk_mul_f16 v56, v42, v45 op_sel:[0,1] op_sel_hi:[1,0]
  v_pk_mul_f16 v57, v42, v46 op_sel:[0,0] op_sel_hi:[1,1]
  v_smfmac_f32_16x16x64_f16 v[80:83], v[228:231], v[60:67], v16
  ds_read2_b32 v[236:237], v29 offset0:0 offset1:2
  ds_read2_b32 v[238:239], v29 offset0:64 offset1:66
  v_add_u32 v29, 2048, v29
  v_pk_mul_f16 v58, v42, v46 op_sel:[0,1] op_sel_hi:[1,0]
  v_pk_mul_f16 v59, v40, v48 op_sel:[0,0] op_sel_hi:[1,1]
  s_waitcnt lgkmcnt(14)
  v_mfma_f32_16x16x32_f16 v[72:75], v[148:151], v[60:63], v[72:75]
  ds_read_b128 v[208:211], v31 offset:20480
  ds_read_u16_d16_hi v34, v7 offset:288
  ds_read_u16_d16_hi v35, v7 offset:416
  v_mfma_f32_16x16x32_f16 v[72:75], v[152:155], v[64:67], v[72:75]
  ds_read_b128 v[212:215], v31 offset:21504
  ds_read_u16_d16_hi v36, v7 offset:544
  ds_read_u16_d16_hi v37, v7 offset:672
  v_mfma_f32_16x16x32_f16 v[76:79], v[192:195], v[60:63], v[76:79]
  ds_read_u16_d16_hi v38, v7 offset:800
  ds_read_u16_d16_hi v39, v7 offset:928
  v_mfma_f32_16x16x32_f16 v[76:79], v[196:199], v[64:67], v[76:79]
  v_pk_mul_f16 v60, v41, v49 op_sel:[0,0] op_sel_hi:[1,1]
  v_pk_mul_f16 v61, v42, v50 op_sel:[0,0] op_sel_hi:[1,1]
  v_mfma_f32_16x16x32_f16 v[76:79], v[200:203], v[52:55], v[76:79]
  v_pk_mul_f16 v62, v40, v49 op_sel:[0,0] op_sel_hi:[1,1]
  v_pk_mul_f16 v63, v40, v49 op_sel:[0,1] op_sel_hi:[1,0]
  s_waitcnt lgkmcnt(14)
  v_mfma_f32_16x16x32_f16 v[76:79], v[204:207], v[56:59], v[76:79]
  v_pk_mul_f16 v64, v40, v50 op_sel:[0,0] op_sel_hi:[1,1]
  v_pk_mul_f16 v65, v40, v50 op_sel:[0,1] op_sel_hi:[1,0]
  v_smfmac_f32_16x16x64_f16 v[80:83], v[232:235], v[52:59], v16
  v_pk_mul_f16 v66, v41, v50 op_sel:[0,0] op_sel_hi:[1,1]
  v_pk_mul_f16 v67, v41, v50 op_sel:[0,1] op_sel_hi:[1,0]
  v_mfma_f32_16x16x32_f16 v[72:75], v[156:159], v[52:55], v[72:75]
  s_waitcnt lgkmcnt(0)
  v_cvt_pk_f16_f32 v43, v38, v39
  v_mfma_f32_16x16x32_f16 v[72:75], v[160:163], v[56:59], v[72:75]
  v_cvt_pk_f16_f32 v40, v32, v35
  v_cvt_pk_f16_f32 v41, v33, v36
  v_mfma_f32_16x16x32_f16 v[68:71], v[112:115], v[52:55], v[68:71]
  v_cvt_pk_f16_f32 v42, v34, v37
  v_mfma_f32_16x16x32_f16 v[68:71], v[116:119], v[56:59], v[68:71]
  ds_write_b128 v10, v[40:43]
  v_mfma_f32_16x16x32_f16 v[68:71], v[120:123], v[60:63], v[68:71]
  v_mfma_f32_16x16x32_f16 v[68:71], v[124:127], v[64:67], v[68:71]
  ds_read_b128 v[44:47], v11
  ds_read_b128 v[48:51], v12
  v_mfma_f32_16x16x32_f16 v[72:75], v[164:167], v[60:63], v[72:75]
  ds_read_b64_tr_b16 v[52:53], v8 offset:32
  ds_read_b64_tr_b16 v[54:55], v8 offset:544
  v_mfma_f32_16x16x32_f16 v[72:75], v[168:171], v[64:67], v[72:75]
  v_pk_mul_f16 v56, v40, v40 op_sel:[0,0] op_sel_hi:[1,1]
  v_pk_mul_f16 v57, v41, v41 op_sel:[0,0] op_sel_hi:[1,1]
  v_smfmac_f32_16x16x64_f16 v[80:83], v[236:239], v[60:67], v16
  v_pk_mul_f16 v58, v42, v42 op_sel:[0,0] op_sel_hi:[1,1]
  v_pk_mul_f16 v59, v40, v41 op_sel:[0,0] op_sel_hi:[1,1]
  v_mfma_f32_16x16x32_f16 v[76:79], v[208:211], v[60:63], v[76:79]
  s_nop 1
  v_mul_f32 v14, v68, v72
  v_fmac_f32 v14, v69, v73
  v_mfma_f32_16x16x32_f16 v[76:79], v[212:215], v[64:67], v[76:79]
  v_fmac_f32 v14, v70, v74
  v_fmac_f32 v14, v71, v75
  ds_add_u32 v1, v3 offset:12
  s_branch L_grp1
L_prime:
  v_mov_b32 v68, 0
  v_mov_b32 v69, 0
  v_mov_b32 v70, 0
  v_mov_b32 v71, 0
  v_mov_b32 v72, 0
  v_mov_b32 v73, 0
  v_mov_b32 v74, 0
  v_mov_b32 v75, 0
  v_mov_b32 v76, 0
  v_mov_b32 v77, 0
  v_mov_b32 v78, 0
  v_mov_b32 v79, 0
  v_mov_b32 v80, 0
  v_mov_b32 v81, 0
  v_mov_b32 v82, 0
  v_mov_b32 v83, 0
  v_mov_b32 v22, 0
  v_mov_b32 v23, 0
  ds_read_u16_d16_hi v32, v7 offset:0
  ds_read_u16_d16_hi v33, v7 offset:128
  ds_read_u16_d16_hi v34, v7 offset:256
  ds_read_u16_d16_hi v35, v7 offset:384
  ds_read_u16_d16_hi v36, v7 offset:512
  ds_read_u16_d16_hi v37, v7 offset:640
  ds_read_u16_d16_hi v38, v7 offset:768
  ds_read_u16_d16_hi v39, v7 offset:896
  s_waitcnt lgkmcnt(0)
  v_cvt_pk_f16_f32 v43, v38, v39
  v_cvt_pk_f16_f32 v40, v32, v35
  v_cvt_pk_f16_f32 v41, v33, v36
  v_cvt_pk_f16_f32 v42, v34, v37
  ds_write_b128 v10, v[40:43]
  ds_read_b128 v[44:47], v11
  ds_read_b128 v[48:51], v12
  ds_read_b64_tr_b16 v[52:53], v8 offset:0
  ds_read_b64_tr_b16 v[54:55], v8 offset:512
  v_pk_mul_f16 v56, v40, v40 op_sel:[0,0] op_sel_hi:[1,1]
  v_pk_mul_f16 v57, v41, v41 op_sel:[0,0] op_sel_hi:[1,1]
  v_pk_mul_f16 v58, v42, v42 op_sel:[0,0] op_sel_hi:[1,1]
  v_pk_mul_f16 v59, v40, v41 op_sel:[0,0] op_sel_hi:[1,1]
  ds_read_u16_d16_hi v32, v7 offset:32
  ds_read_u16_d16_hi v33, v7 offset:160
L_cin_loop:
  s_cmp_lg_u32 s84, 0
  s_cbranch_scc1 L_pr0
  s_setprio 2
L_pr0:
  s_waitcnt lgkmcnt(2)
  v_mfma_f32_16x16x32_bf16 v[72:75], v[240:243], v[52:55], 0
  v_add_f32 v22, v80, v81
  v_add_f32 v23, v82, v83
  v_mfma_f32_16x16x32_f16 v[72:75], v[128:131], v[56:59], v[72:75]
  v_fmac_f32 v14, v76, v77
  v_fmac_f32 v14, v22, v78
  v_mfma_f32_16x16x32_f16 v[68:71], v[84:87], v[56:59], 0
  v_fmac_f32 v14, v23, v79
  v_pk_mul_f16 v60, v40, v41 op_sel:[0,1] op_sel_hi:[1,0]
  v_mfma_f32_16x16x32_f16 v[80:83], v[216:219], v[56:59], 0
  v_pk_mul_f16 v61, v40, v42 op_sel:[0,0] op_sel_hi:[1,1]
  v_pk_mul_f16 v62, v40, v42 op_sel:[0,1] op_sel_hi:[1,0]
  v_mfma_f32_16x16x32_bf16 v[76:79], v[244:247], v[52:55], 0
  v_pk_mul_f16 v63, v41, v42 op_sel:[0,0] op_sel_hi:[1,1]
  v_pk_mul_f16 v64, v41, v42 op_sel:[0,1] op_sel_hi:[1,0]
  v_mfma_f32_16x16x32_f16 v[76:79], v[172:175], v[56:59], v[76:79]
  v_pk_mul_f16 v65, v40, v43 op_sel:[0,0] op_sel_hi:[1,0]
  v_pk_mul_f16 v66, v41, v43 op_sel:[0,0] op_sel_hi:[1,0]
  v_pk_mul_f16 v67, v42, v43 op_sel:[0,0] op_sel_hi:[1,0]
  v_mfma_f32_16x16x32_f16 v[76:79], v[176:179], v[60:63], v[76:79]
  v_add_f32_dpp v14, v14, v14 row_shr:1 row_mask:0xf bank_mask:0xf
  v_alignbit_b32 v48, v48, v48, v13
  v_mfma_f32_16x16x32_f16 v[76:79], v[180:183], v[64:67], v[76:79]
  v_mul_f16_sdwa v52, v40, v40 dst_sel:WORD_0 dst_unused:UNUSED_PAD src0_sel:WORD_0 src1_sel:WORD_1
  v_mul_f16_sdwa v53, v42, v42 dst_sel:WORD_0 dst_unused:UNUSED_PAD src0_sel:WORD_0 src1_sel:WORD_1
  v_smfmac_f32_16x16x64_f16 v[80:83], v[220:223], v[60:67], v16
  v_add_f32_dpp v14, v14, v14 row_shr:2 row_mask:0xf bank_mask:0xf
  v_alignbit_b32 v49, v49, v49, v13
  v_mfma_f32_16x16x32_f16 v[68:71], v[88:91], v[60:63], v[68:71]
  v_mul_f16_sdwa v52, v41, v41 dst_sel:WORD_1 dst_unused:UNUSED_PRESERVE src0_sel:WORD_0 src1_sel:WORD_1
  v_mul_f16_sdwa v53, v43, v43 dst_sel:WORD_1 dst_unused:UNUSED_PRESERVE src0_sel:WORD_0 src1_sel:WORD_1
  v_mfma_f32_16x16x32_f16 v[68:71], v[92:95], v[64:67], v[68:71]
  v_add_f32_dpp v14, v14, v14 row_shr:4 row_mask:0xf bank_mask:0xf
  v_pk_mul_f16 v54, v40, v47 op_sel:[0,0] op_sel_hi:[1,0]
  v_mfma_f32_16x16x32_f16 v[72:75], v[132:135], v[60:63], v[72:75]
  v_pk_mul_f16 v55, v41, v47 op_sel:[0,0] op_sel_hi:[1,0]
  v_pk_mul_f16 v56, v42, v47 op_sel:[0,0] op_sel_hi:[1,0]
  v_mfma_f32_16x16x32_f16 v[72:75], v[136:139], v[64:67], v[72:75]
  v_pk_mul_f16 v57, v40, v44 op_sel:[0,0] op_sel_hi:[1,1]
  v_pk_mul_f16 v58, v40, v44 op_sel:[0,1] op_sel_hi:[1,0]
  v_pk_mul_f16 v59, v40, v45 op_sel:[0,0] op_sel_hi:[1,1]
  v_mfma_f32_16x16x32_f16 v[72:75], v[140:143], v[52:55], v[72:75]
  v_add_f32_dpp v14, v14, v14 row_shr:8 row_mask:0xf bank_mask:0xf
  v_pk_mul_f16 v60, v40, v45 op_sel:[0,1] op_sel_hi:[1,0]
  v_mfma_f32_16x16x32_f16 v[72:75], v[144:147], v[56:59], v[72:75]
  v_pk_mul_f16 v61, v40, v46 op_sel:[0,0] op_sel_hi:[1,1]
  v_pk_mul_f16 v62, v40, v46 op_sel:[0,1] op_sel_hi:[1,0]
  v_smfmac_f32_16x16x64_f16 v[80:83], v[224:227], v[52:59], v16
  v_add_f32_dpp v14, v14, v14 row_bcast:15 row_mask:0xa bank_mask:0xf
  v_pk_mul_f16 v63, v41, v44 op_sel:[0,0] op_sel_hi:[1,1]
  v_mfma_f32_16x16x32_f16 v[76:79], v[184:187], v[52:55], v[76:79]
  v_pk_mul_f16 v64, v41, v44 op_sel:[0,1] op_sel_hi:[1,0]
  v_pk_mul_f16 v65, v41, v45 op_sel:[0,0] op_sel_hi:[1,1]
  v_mfma_f32_16x16x32_f16 v[76:79], v[188:191], v[56:59], v[76:79]
  v_add_f32_dpp v14, v14, v14 row_bcast:31 row_mask:0xc bank_mask:0xf
  v_pk_mul_f16 v66, v41, v45 op_sel:[0,1] op_sel_hi:[1,0]
  v_mfma_f32_16x16x32_f16 v[68:71], v[96:99], v[52:55], v[68:71]
  v_pk_mul_f16 v67, v41, v46 op_sel:[0,0] op_sel_hi:[1,1]
  s_waitcnt vmcnt(0)
L_blk:
  s_cmp_eq_u32 s50, 0
  s_cbranch_scc1 L_blkend
  v_readlane_b32 s81, v14, 63
  v_ldexp_f32 v14, v14, s49
  v_and_b32 v14, -2, v14
  s_cmp_ge_u32 s50, 2
  s_cbranch_scc1 L_good
  s_cmp_eq_u64 s[90:91], 0
  s_cbranch_scc1 L_slow
  s_bfe_u32 s81, s81, 0x80017
  s_cmp_eq_u32 s81, 255
  s_cbranch_scc1 L_slow
L_good:
  s_mov_b32 exec_lo, 0
  s_mov_b32 exec_hi, 0x80000000
  buffer_store_dword v14, v251, s[60:63], s85 offen sc1
  s_mov_b64 exec, -1
  s_add_u32 s85, s85, 32
  s_sub_u32 s72, s72, 1
  s_cmp_eq_u32 s72, 0
  s_cbranch_scc1 L_cin_done
  s_cmp_eq_u32 s72, 1
  s_cbranch_scc1 L_lastnext
  v_lshl_add_u32 v24, v24, 7, v18
  v_lshl_add_u32 v25, v25, 7, v18
  s_mov_b32 exec_hi, 0x0000ffff
  v_lshl_add_u32 v26, v26, 7, v18
  v_lshl_add_u32 v27, v27, 7, v18
  s_mov_b32 exec_lo, 0
  s_mov_b32 exec_hi, 0xffff0000
  v_mov_b32 v27, v25
  v_mov_b32 v26, v25
  s_mov_b32 exec_hi, 0x00ff0000
  v_mov_b32 v26, v24
  s_mov_b64 exec, -1
  s_add_u32 m0, s74, 0
  s_nop 0
  buffer_load_dwordx4 v24, s[32:35], 0 offen lds
  s_add_u32 m0, s74, 1056
  s_nop 0
  buffer_load_dwordx4 v25, s[32:35], 0 offen lds
  s_add_u32 m0, s74, 2112
  s_nop 0
  buffer_load_dwordx4 v26, s[32:35], 0 offen lds
  s_add_u32 m0, s74, 3168
  s_mov_b32 exec_hi, 0x00ffffff
  buffer_load_dwordx4 v27, s[32:35], 0 offen lds
  s_mov_b32 exec_hi, -1
  s_add_u32 s94, s94, 832
  s_cmp_lg_u32 s72, s99
  s_cbranch_scc1 L_nodma
  s_lshr_b32 s81, s98, 14
  v_cmp_eq_u32 vcc, 0, v249
  s_nop 0
  s_bitcmp1_b32 vcc_lo, s81
  s_cbranch_scc0 L_tclr_ok
  s_mov_b32 s78, 0x40000
L_tclr:
  s_sub_u32 s78, s78, 1
  s_cbranch_scc1 L_tclr_ok
  v_lshlrev_b32 v249, 2, v0
  v_and_b32 v249, 31, v249
  buffer_load_dword v249, v249, s[64:67], 0 offen offset:128 sc1
  s_waitcnt vmcnt(0)
  v_cmp_eq_u32 vcc, 0, v249
  s_nop 0
  s_bitcmp1_b32 vcc_lo, s81
  s_cbranch_scc1 L_tclr
L_tclr_ok:
  v_mov_b32 v250, 1
  s_mov_b64 exec, 1
  buffer_atomic_add v250, v251, s[60:63], s98 offen sc0
  s_mov_b64 exec, -1
  s_mov_b32 s99, 8
  s_branch L_nodma
L_lastnext:
  s_cmp_lt_i32 s26, 0
  s_cselect_b32 s85, s85, s26
L_nodma:
  s_add_u32 s74, s74, s75
  s_sub_u32 s75, 0, s75
  s_mov_b32 s49, s48
  s_mov_b32 s97, 1
  s_cmp_eq_u32 s50, 3
  s_cbranch_scc1 L_slow2
L_blkend:
  s_mov_b32 s50, s97
  s_cmp_ge_u32 s101, 5537792
  s_cbranch_scc1 L_npf
  s_mov_b64 exec, 131071
  buffer_load_dword v255, v19, s[44:47], s101 offen
  s_mov_b64 exec, -1
  s_add_u32 s101, s101, 1171456
L_npf:
  v_alignbit_b32 v50, v50, v50, v13
  v_mfma_f32_16x16x32_f16 v[68:71], v[100:103], v[56:59], v[68:71]
  v_pk_mul_f16 v52, v41, v46 op_sel:[0,1] op_sel_hi:[1,0]
  v_pk_mul_f16 v53, v42, v44 op_sel:[0,0] op_sel_hi:[1,1]
  v_mfma_f32_16x16x32_f16 v[68:71], v[104:107], v[60:63], v[68:71]
  v_pk_mul_f16 v54, v42, v44 op_sel:[0,1] op_sel_hi:[1,0]
  v_pk_mul_f16 v55, v42, v45 op_sel:[0,0] op_sel_hi:[1,1]
  v_mfma_f32_16x16x32_f16 v[68:71], v[108:111], v[64:67], v[68:71]
  v_pk_mul_f16 v56, v42, v45 op_sel:[0,1] op_sel_hi:[1,0]
  v_pk_mul_f16 v57, v42, v46 op_sel:[0,0] op_sel_hi:[1,1]
  v_smfmac_f32_16x16x64_f16 v[80:83], v[228:231], v[60:67], v16
  v_pk_mul_f16 v58, v42, v46 op_sel:[0,1] op_sel_hi:[1,0]
  v_pk_mul_f16 v59, v40, v48 op_sel:[0,0] op_sel_hi:[1,1]
  v_mfma_f32_16x16x32_f16 v[72:75], v[148:151], v[60:63], v[72:75]
  ds_read_u16_d16_hi v34, v7 offset:288
  ds_read_u16_d16_hi v35, v7 offset:416
  v_mfma_f32_16x16x32_f16 v[72:75], v[152:155], v[64:67], v[72:75]
  ds_read_u16_d16_hi v36, v7 offset:544
  ds_read_u16_d16_hi v37, v7 offset:672
  v_mfma_f32_16x16x32_f16 v[76:79], v[192:195], v[60:63], v[76:79]
  ds_read_u16_d16_hi v38, v7 offset:800
  ds_read_u16_d16_hi v39, v7 offset:928
  v_mfma_f32_16x16x32_f16 v[76:79], v[196:199], v[64:67], v[76:79]
  v_pk_mul_f16 v60, v41, v49 op_sel:[0,0] op_sel_hi:[1,1]
  v_pk_mul_f16 v61, v42, v50 op_sel:[0,0] op_sel_hi:[1,1]
  v_mfma_f32_16x16x32_f16 v[76:79], v[200:203], v[52:55], v[76:79]
  v_pk_mul_f16 v62, v40, v49 op_sel:[0,0] op_sel_hi:[1,1]
  v_pk_mul_f16 v63, v40, v49 op_sel:[0,1] op_sel_hi:[1,0]
  v_mfma_f32_16x16x32_f16 v[76:79], v[204:207], v[56:59], v[76:79]
  v_pk_mul_f16 v64, v40, v50 op_sel:[0,0] op_sel_hi:[1,1]
  v_pk_mul_f16 v65, v40, v50 op_sel:[0,1] op_sel_hi:[1,0]
  v_smfmac_f32_16x16x64_f16 v[80:83], v[232:235], v[52:59], v16
  v_pk_mul_f16 v66, v41, v50 op_sel:[0,0] op_sel_hi:[1,1]
  v_pk_mul_f16 v67, v41, v50 op_sel:[0,1] op_sel_hi:[1,0]
  v_mfma_f32_16x16x32_f16 v[72:75], v[156:159], v[52:55], v[72:75]
  s_waitcnt lgkmcnt(0)
  v_cvt_pk_f16_f32 v43, v38, v39
  v_mfma_f32_16x16x32_f16 v[72:75], v[160:163], v[56:59], v[72:75]
  v_cvt_pk_f16_f32 v40, v32, v35
  v_cvt_pk_f16_f32 v41, v33, v36
  v_mfma_f32_16x16x32_f16 v[68:71], v[112:115], v[52:55], v[68:71]
  v_cvt_pk_f16_f32 v42, v34, v37
  v_mfma_f32_16x16x32_f16 v[68:71], v[116:119], v[56:59], v[68:71]
  ds_write_b128 v10, v[40:43]
  v_mfma_f32_16x16x32_f16 v[68:71], v[120:123], v[60:63], v[68:71]
  v_mfma_f32_16x16x32_f16 v[68:71], v[124:127], v[64:67], v[68:71]
  ds_read_b128 v[44:47], v11
  ds_read_b128 v[48:51], v12
  v_mfma_f32_16x16x32_f16 v[72:75], v[164:167], v[60:63], v[72:75]
  ds_read_b64_tr_b16 v[52:53], v8 offset:32
  ds_read_b64_tr_b16 v[54:55], v8 offset:544
  v_mfma_f32_16x16x32_f16 v[72:75], v[168:171], v[64:67], v[72:75]
  v_pk_mul_f16 v56, v40, v40 op_sel:[0,0] op_sel_hi:[1,1]
  v_pk_mul_f16 v57, v41, v41 op_sel:[0,0] op_sel_hi:[1,1]
  v_smfmac_f32_16x16x64_f16 v[80:83], v[236:239], v[60:67], v16
  v_pk_mul_f16 v58, v42, v42 op_sel:[0,0] op_sel_hi:[1,1]
  v_pk_mul_f16 v59, v40, v41 op_sel:[0,0] op_sel_hi:[1,1]
  v_mfma_f32_16x16x32_f16 v[76:79], v[208:211], v[60:63], v[76:79]
  s_nop 1
  v_mul_f32 v14, v68, v72
  v_fmac_f32 v14, v69, v73
  v_mfma_f32_16x16x32_f16 v[76:79], v[212:215], v[64:67], v[76:79]
  v_fmac_f32 v14, v70, v74
  v_fmac_f32 v14, v71, v75
L_grp1:
  s_waitcnt lgkmcnt(0)
  v_mfma_f32_16x16x32_bf16 v[72:75], v[240:243], v[52:55], 0
  v_add_f32 v22, v80, v81
  v_add_f32 v23, v82, v83
  v_mfma_f32_16x16x32_f16 v[72:75], v[128:131], v[56:59], v[72:75]
  s_nop 0
  v_fmac_f32 v14, v76, v77
  v_fmac_f32 v14, v22, v78
  v_mfma_f32_16x16x32_f16 v[68:71], v[84:87], v[56:59], 0
  v_fmac_f32 v14, v23, v79
  v_pk_mul_f16 v60, v40, v41 op_sel:[0,1] op_sel_hi:[1,0]
  v_mfma_f32_16x16x32_f16 v[80:83], v[216:219], v[56:59], 0
  v_pk_mul_f16 v61, v40, v42 op_sel:[0,0] op_sel_hi:[1,1]
  v_pk_mul_f16 v62, v40, v42 op_sel:[0,1] op_sel_hi:[1,0]
  v_mfma_f32_16x16x32_bf16 v[76:79], v[244:247], v[52:55], 0
  v_pk_mul_f16 v63, v41, v42 op_sel:[0,0] op_sel_hi:[1,1]
  v_pk_mul_f16 v64, v41, v42 op_sel:[0,1] op_sel_hi:[1,0]
  v_mfma_f32_16x16x32_f16 v[76:79], v[172:175], v[56:59], v[76:79]
  v_pk_mul_f16 v65, v40, v43 op_sel:[0,0] op_sel_hi:[1,0]
  v_pk_mul_f16 v66, v41, v43 op_sel:[0,0] op_sel_hi:[1,0]
  v_pk_mul_f16 v67, v42, v43 op_sel:[0,0] op_sel_hi:[1,0]
  v_mfma_f32_16x16x32_f16 v[76:79], v[176:179], v[60:63], v[76:79]
  v_or3_b32 v15, v56, v57, v58
  v_alignbit_b32 v48, v48, v48, v13
  v_mfma_f32_16x16x32_f16 v[76:79], v[180:183], v[64:67], v[76:79]
  v_mul_f16_sdwa v52, v40, v40 dst_sel:WORD_0 dst_unused:UNUSED_PAD src0_sel:WORD_0 src1_sel:WORD_1
  v_mul_f16_sdwa v53, v42, v42 dst_sel:WORD_0 dst_unused:UNUSED_PAD src0_sel:WORD_0 src1_sel:WORD_1
  v_smfmac_f32_16x16x64_f16 v[80:83], v[220:223], v[60:67], v16
  v_mul_f16_sdwa v52, v41, v41 dst_sel:WORD_1 dst_unused:UNUSED_PRESERVE src0_sel:WORD_0 src1_sel:WORD_1
  v_mul_f16_sdwa v53, v43, v43 dst_sel:WORD_1 dst_unused:UNUSED_PRESERVE src0_sel:WORD_0 src1_sel:WORD_1
  v_mfma_f32_16x16x32_f16 v[68:71], v[88:91], v[60:63], v[68:71]
  v_pk_mul_f16 v54, v40, v47 op_sel:[0,0] op_sel_hi:[1,0]
  v_pk_mul_f16 v55, v41, v47 op_sel:[0,0] op_sel_hi:[1,0]
  v_mfma_f32_16x16x32_f16 v[68:71], v[92:95], v[64:67], v[68:71]
  v_pk_mul_f16 v56, v42, v47 op_sel:[0,0] op_sel_hi:[1,0]
  v_pk_mul_f16 v57, v40, v44 op_sel:[0,0] op_sel_hi:[1,1]
  v_mfma_f32_16x16x32_f16 v[72:75], v[132:135], v[60:63], v[72:75]
  v_pk_mul_f16 v58, v40, v44 op_sel:[0,1] op_sel_hi:[1,0]
  v_pk_mul_f16 v59, v40, v45 op_sel:[0,0] op_sel_hi:[1,1]
  v_mfma_f32_16x16x32_f16 v[72:75], v[136:139], v[64:67], v[72:75]
  v_pk_mul_f16 v60, v40, v45 op_sel:[0,1] op_sel_hi:[1,0]
  v_pk_mul_f16 v61, v40, v46 op_sel:[0,0] op_sel_hi:[1,1]
  v_mfma_f32_16x16x32_f16 v[72:75], v[140:143], v[52:55], v[72:75]
  v_pk_mul_f16 v62, v40, v46 op_sel:[0,1] op_sel_hi:[1,0]
  v_pk_mul_f16 v63, v41, v44 op_sel:[0,0] op_sel_hi:[1,1]
  v_mfma_f32_16x16x32_f16 v[72:75], v[144:147], v[56:59], v[72:75]
  v_pk_mul_f16 v64, v41, v44 op_sel:[0,1] op_sel_hi:[1,0]
  v_pk_mul_f16 v65, v41, v45 op_sel:[0,0] op_sel_hi:[1,1]
  v_smfmac_f32_16x16x64_f16 v[80:83], v[224:227], v[52:59], v16
  v_pk_mul_f16 v66, v41, v45 op_sel:[0,1] op_sel_hi:[1,0]
  v_pk_mul_f16 v67, v41, v46 op_sel:[0,0] op_sel_hi:[1,1]
  v_mfma_f32_16x16x32_f16 v[76:79], v[184:187], v[52:55], v[76:79]
  v_alignbit_b32 v49, v49, v49, v13
  v_alignbit_b32 v50, v50, v50, v13
  v_mfma_f32_16x16x32_f16 v[76:79], v[188:191], v[56:59], v[76:79]
  ds_read_u16_d16_hi v32, v7 offset:64
  ds_read_u16_d16_hi v33, v7 offset:192
  v_mfma_f32_16x16x32_f16 v[68:71], v[96:99], v[52:55], v[68:71]
  v_pk_mul_f16 v52, v41, v46 op_sel:[0,1] op_sel_hi:[1,0]
  v_pk_mul_f16 v53, v42, v44 op_sel:[0,0] op_sel_hi:[1,1]
  v_mfma_f32_16x16x32_f16 v[68:71], v[100:103], v[56:59], v[68:71]
  v_pk_mul_f16 v54, v42, v44 op_sel:[0,1] op_sel_hi:[1,0]
  v_pk_mul_f16 v55, v42, v45 op_sel:[0,0] op_sel_hi:[1,1]
  v_mfma_f32_16x16x32_f16 v[68:71], v[104:107], v[60:63], v[68:71]
  v_pk_mul_f16 v56, v42, v45 op_sel:[0,1] op_sel_hi:[1,0]
  v_pk_mul_f16 v57, v42, v46 op_sel:[0,0] op_sel_hi:[1,1]
  v_mfma_f32_16x16x32_f16 v[68:71], v[108:111], v[64:67], v[68:71]
  v_pk_mul_f16 v58, v42, v46 op_sel:[0,1] op_sel_hi:[1,0]
  v_pk_mul_f16 v59, v40, v48 op_sel:[0,0] op_sel_hi:[1,1]
  v_smfmac_f32_16x16x64_f16 v[80:83], v[228:231], v[60:67], v16
  ds_read_u16_d16_hi v34, v7 offset:320
  ds_read_u16_d16_hi v35, v7 offset:448
  v_mfma_f32_16x16x32_f16 v[72:75], v[148:151], v[60:63], v[72:75]
  ds_read_u16_d16_hi v36, v7 offset:576
  ds_read_u16_d16_hi v37, v7 offset:704
  v_mfma_f32_16x16x32_f16 v[72:75], v[152:155], v[64:67], v[72:75]
  ds_read_u16_d16_hi v38, v7 offset:832
  ds_read_u16_d16_hi v39, v7 offset:960
  v_mfma_f32_16x16x32_f16 v[76:79], v[192:195], v[60:63], v[76:79]
  v_and_b32 v15, 0x60006000, v15
  v_cmp_ne_u32 s[90:91], 0, v15
  v_mfma_f32_16x16x32_f16 v[76:79], v[196:199], v[64:67], v[76:79]
  v_pk_mul_f16 v60, v41, v49 op_sel:[0,0] op_sel_hi:[1,1]
  v_pk_mul_f16 v61, v42, v50 op_sel:[0,0] op_sel_hi:[1,1]
  v_mfma_f32_16x16x32_f16 v[76:79], v[200:203], v[52:55], v[76:79]
  v_pk_mul_f16 v62, v40, v49 op_sel:[0,0] op_sel_hi:[1,1]
  v_pk_mul_f16 v63, v40, v49 op_sel:[0,1] op_sel_hi:[1,0]
  v_mfma_f32_16x16x32_f16 v[76:79], v[204:207], v[56:59], v[76:79]
  v_pk_mul_f16 v64, v40, v50 op_sel:[0,0] op_sel_hi:[1,1]
  v_pk_mul_f16 v65, v40, v50 op_sel:[0,1] op_sel_hi:[1,0]
  v_smfmac_f32_16x16x64_f16 v[80:83], v[232:235], v[52:59], v16
  v_pk_mul_f16 v66, v41, v50 op_sel:[0,0] op_sel_hi:[1,1]
  v_pk_mul_f16 v67, v41, v50 op_sel:[0,1] op_sel_hi:[1,0]
  v_mfma_f32_16x16x32_f16 v[72:75], v[156:159], v[52:55], v[72:75]
  s_waitcnt lgkmcnt(0)
  v_cvt_pk_f16_f32 v43, v38, v39
  v_mfma_f32_16x16x32_f16 v[72:75], v[160:163], v[56:59], v[72:75]
  v_cvt_pk_f16_f32 v40, v32, v35
  v_cvt_pk_f16_f32 v41, v33, v36
  v_mfma_f32_16x16x32_f16 v[68:71], v[112:115], v[52:55], v[68:71]
  v_cvt_pk_f16_f32 v42, v34, v37
  v_mfma_f32_16x16x32_f16 v[68:71], v[116:119], v[56:59], v[68:71]
  ds_write_b128 v10, v[40:43]
  v_mfma_f32_16x16x32_f16 v[68:71], v[120:123], v[60:63], v[68:71]
  v_mfma_f32_16x16x32_f16 v[68:71], v[124:127], v[64:67], v[68:71]
  ds_read_b128 v[44:47], v11
  ds_read_b128 v[48:51], v12
  v_mfma_f32_16x16x32_f16 v[72:75], v[164:167], v[60:63], v[72:75]
  ds_read_b64_tr_b16 v[52:53], v8 offset:64
  ds_read_b64_tr_b16 v[54:55], v8 offset:576
  v_mfma_f32_16x16x32_f16 v[72:75], v[168:171], v[64:67], v[72:75]
  v_pk_mul_f16 v56, v40, v40 op_sel:[0,0] op_sel_hi:[1,1]
  v_pk_mul_f16 v57, v41, v41 op_sel:[0,0] op_sel_hi:[1,1]
  v_smfmac_f32_16x16x64_f16 v[80:83], v[236:239], v[60:67], v16
  v_pk_mul_f16 v58, v42, v42 op_sel:[0,0] op_sel_hi:[1,1]
  v_pk_mul_f16 v59, v40, v41 op_sel:[0,0] op_sel_hi:[1,1]
  v_mfma_f32_16x16x32_f16 v[76:79], v[208:211], v[60:63], v[76:79]
  s_nop 1
  v_fmac_f32 v14, v68, v72
  v_fmac_f32 v14, v69, v73
  v_mfma_f32_16x16x32_f16 v[76:79], v[212:215], v[64:67], v[76:79]
  v_fmac_f32 v14, v70, v74
  v_fmac_f32 v14, v71, v75
  s_cmp_eq_u32 s72, s96
  s_cbranch_scc1 L_htail
  s_waitcnt lgkmcnt(0)
  v_mfma_f32_16x16x32_bf16 v[72:75], v[240:243], v[52:55], 0
  v_add_f32 v22, v80, v81
  v_add_f32 v23, v82, v83
  v_mfma_f32_16x16x32_f16 v[72:75], v[128:131], v[56:59], v[72:75]
  v_fmac_f32 v14, v76, v77
  v_fmac_f32 v14, v22, v78
  v_mfma_f32_16x16x32_f16 v[68:71], v[84:87], v[56:59], 0
  v_fmac_f32 v14, v23, v79
  v_pk_mul_f16 v60, v40, v41 op_sel:[0,1] op_sel_hi:[1,0]
  v_mfma_f32_16x16x32_f16 v[80:83], v[216:219], v[56:59], 0
  v_pk_mul_f16 v61, v40, v42 op_sel:[0,0] op_sel_hi:[1,1]
  v_pk_mul_f16 v62, v40, v42 op_sel:[0,1] op_sel_hi:[1,0]
  v_mfma_f32_16x16x32_bf16 v[76:79], v[244:247], v[52:55], 0
  v_pk_mul_f16 v63, v41, v42 op_sel:[0,0] op_sel_hi:[1,1]
  v_pk_mul_f16 v64, v41, v42 op_sel:[0,1] op_sel_hi:[1,0]
  v_mfma_f32_16x16x32_f16 v[76:79], v[172:175], v[56:59], v[76:79]
  v_pk_mul_f16 v65, v40, v43 op_sel:[0,0] op_sel_hi:[1,0]
  v_pk_mul_f16 v66, v41, v43 op_sel:[0,0] op_sel_hi:[1,0]
  v_pk_mul_f16 v67, v42, v43 op_sel:[0,0] op_sel_hi:[1,0]
  v_mfma_f32_16x16x32_f16 v[76:79], v[176:179], v[60:63], v[76:79]
  v_mul_f16_sdwa v52, v40, v40 dst_sel:WORD_0 dst_unused:UNUSED_PAD src0_sel:WORD_0 src1_sel:WORD_1
  v_mul_f16_sdwa v53, v42, v42 dst_sel:WORD_0 dst_unused:UNUSED_PAD src0_sel:WORD_0 src1_sel:WORD_1
  v_mfma_f32_16x16x32_f16 v[76:79], v[180:183], v[64:67], v[76:79]
  v_mul_f16_sdwa v52, v41, v41 dst_sel:WORD_1 dst_unused:UNUSED_PRESERVE src0_sel:WORD_0 src1_sel:WORD_1
  v_mul_f16_sdwa v53, v43, v43 dst_sel:WORD_1 dst_unused:UNUSED_PRESERVE src0_sel:WORD_0 src1_sel:WORD_1
  v_smfmac_f32_16x16x64_f16 v[80:83], v[220:223], v[60:67], v16
  v_pk_mul_f16 v54, v40, v47 op_sel:[0,0] op_sel_hi:[1,0]
  v_pk_mul_f16 v55, v41, v47 op_sel:[0,0] op_sel_hi:[1,0]
  v_mfma_f32_16x16x32_f16 v[68:71], v[88:91], v[60:63], v[68:71]
  v_pk_mul_f16 v56, v42, v47 op_sel:[0,0] op_sel_hi:[1,0]
  v_pk_mul_f16 v57, v40, v44 op_sel:[0,0] op_sel_hi:[1,1]
  v_mfma_f32_16x16x32_f16 v[68:71], v[92:95], v[64:67], v[68:71]
  v_pk_mul_f16 v58, v40, v44 op_sel:[0,1] op_sel_hi:[1,0]
  v_pk_mul_f16 v59, v40, v45 op_sel:[0,0] op_sel_hi:[1,1]
  v_mfma_f32_16x16x32_f16 v[72:75], v[132:135], v[60:63], v[72:75]
  v_pk_mul_f16 v60, v40, v45 op_sel:[0,1] op_sel_hi:[1,0]
  v_pk_mul_f16 v61, v40, v46 op_sel:[0,0] op_sel_hi:[1,1]
  v_mfma_f32_16x16x32_f16 v[72:75], v[136:139], v[64:67], v[72:75]
  v_pk_mul_f16 v62, v40, v46 op_sel:[0,1] op_sel_hi:[1,0]
  v_pk_mul_f16 v63, v41, v44 op_sel:[0,0] op_sel_hi:[1,1]
  v_mfma_f32_16x16x32_f16 v[72:75], v[140:143], v[52:55], v[72:75]
  v_pk_mul_f16 v64, v41, v44 op_sel:[0,1] op_sel_hi:[1,0]
  v_pk_mul_f16 v65, v41, v45 op_sel:[0,0] op_sel_hi:[1,1]
  v_mfma_f32_16x16x32_f16 v[72:75], v[144:147], v[56:59], v[72:75]
  v_pk_mul_f16 v66, v41, v45 op_sel:[0,1] op_sel_hi:[1,0]
  v_pk_mul_f16 v67, v41, v46 op_sel:[0,0] op_sel_hi:[1,1]
  v_smfmac_f32_16x16x64_f16 v[80:83], v[224:227], v[52:59], v16
  v_alignbit_b32 v48, v48, v48, v13
  v_alignbit_b32 v49, v49, v49, v13
  v_mfma_f32_16x16x32_f16 v[76:79], v[184:187], v[52:55], v[76:79]
  v_alignbit_b32 v50, v50, v50, v13
  ds_read_u16_d16_hi v32, v7 offset:96
  v_mfma_f32_16x16x32_f16 v[76:79], v[188:191], v[56:59], v[76:79]
  ds_read_u16_d16_hi v33, v7 offset:224
  ds_read_u16_d16_hi v34, v7 offset:352
  s_cmp_lg_u32 s99, 8
  s_cbranch_scc1 L_hk
  s_waitcnt vmcnt(0)
  v_readfirstlane_b32 s81, v250
  s_mov_b32 s99, 0
  s_add_u32 s81, s81, 1
  s_cmp_ge_u32 s81, 36
  s_cbranch_scc1 L_hk
  s_add_u32 s72, s72, 1
  s_mov_b32 s26, 10240
  s_cmp_lt_u32 s81, 20
  s_cbranch_scc1 L_hkf
  s_add_u32 s81, s81, 20
  s_and_b32 s94, s81, 1
  s_lshr_b32 s81, s81, 1
  s_mov_b32 s96, 1
  s_lshl_b32 s94, s94, 6
  v_xor_b32 v18, s94, v18
  s_lshl_b32 s94, s94, 5
  s_add_u32 s26, s26, s94
L_hkf:
  s_add_u32 s81, s81, 484
  s_lshl_b32 s94, s81, 2
  s_add_u32 s26, s26, s94
  s_andn2_b32 s94, s98, 0x3fff
  s_add_u32 s26, s26, s94
  s_lshr_b32 s94, s94, 5
  s_add_u32 s94, s94, s81
  s_mul_i32 s94, s94, 104
L_hk:
  buffer_load_dwordx4 v[24:27], v17, s[28:31], s94 offen offset:0
  v_mfma_f32_16x16x32_f16 v[68:71], v[96:99], v[52:55], v[68:71]
  v_pk_mul_f16 v52, v41, v46 op_sel:[0,1] op_sel_hi:[1,0]
  v_pk_mul_f16 v53, v42, v44 op_sel:[0,0] op_sel_hi:[1,1]
  v_mfma_f32_16x16x32_f16 v[68:71], v[100:103], v[56:59], v[68:71]
  v_pk_mul_f16 v54, v42, v44 op_sel:[0,1] op_sel_hi:[1,0]
  v_pk_mul_f16 v55, v42, v45 op_sel:[0,0] op_sel_hi:[1,1]
  v_mfma_f32_16x16x32_f16 v[68:71], v[104:107], v[60:63], v[68:71]
  v_pk_mul_f16 v56, v42, v45 op_sel:[0,1] op_sel_hi:[1,0]
  v_pk_mul_f16 v57, v42, v46 op_sel:[0,0] op_sel_hi:[1,1]
  v_mfma_f32_16x16x32_f16 v[68:71], v[108:111], v[64:67], v[68:71]
  v_pk_mul_f16 v58, v42, v46 op_sel:[0,1] op_sel_hi:[1,0]
  v_pk_mul_f16 v59, v40, v48 op_sel:[0,0] op_sel_hi:[1,1]
  v_smfmac_f32_16x16x64_f16 v[80:83], v[228:231], v[60:67], v16
  ds_read_u16_d16_hi v35, v7 offset:480
  ds_read_u16_d16_hi v36, v7 offset:608
  v_mfma_f32_16x16x32_f16 v[72:75], v[148:151], v[60:63], v[72:75]
  ds_read_u16_d16_hi v37, v7 offset:736
  ds_read_u16_d16_hi v38, v7 offset:864
  v_mfma_f32_16x16x32_f16 v[72:75], v[152:155], v[64:67], v[72:75]
  ds_read_u16_d16_hi v39, v7 offset:992
  v_mfma_f32_16x16x32_f16 v[76:79], v[192:195], v[60:63], v[76:79]
  v_pk_mul_f16 v60, v41, v49 op_sel:[0,0] op_sel_hi:[1,1]
  v_pk_mul_f16 v61, v42, v50 op_sel:[0,0] op_sel_hi:[1,1]
  v_mfma_f32_16x16x32_f16 v[76:79], v[196:199], v[64:67], v[76:79]
  v_pk_mul_f16 v62, v40, v49 op_sel:[0,0] op_sel_hi:[1,1]
  v_pk_mul_f16 v63, v40, v49 op_sel:[0,1] op_sel_hi:[1,0]
  v_mfma_f32_16x16x32_f16 v[76:79], v[200:203], v[52:55], v[76:79]
  v_pk_mul_f16 v64, v40, v50 op_sel:[0,0] op_sel_hi:[1,1]
  v_pk_mul_f16 v65, v40, v50 op_sel:[0,1] op_sel_hi:[1,0]
  s_cmp_lg_u32 s84, 0
  s_cbranch_scc1 L_pr110
  s_setprio 0
L_pr110:
  v_mfma_f32_16x16x32_f16 v[76:79], v[204:207], v[56:59], v[76:79]
  v_pk_mul_f16 v66, v41, v50 op_sel:[0,0] op_sel_hi:[1,1]
  v_pk_mul_f16 v67, v41, v50 op_sel:[0,1] op_sel_hi:[1,0]
  v_smfmac_f32_16x16x64_f16 v[80:83], v[232:235], v[52:59], v16
  s_waitcnt lgkmcnt(0)
  v_cvt_pk_f16_f32 v43, v38, v39
  v_mfma_f32_16x16x32_f16 v[72:75], v[156:159], v[52:55], v[72:75]
  v_cvt_pk_f16_f32 v40, v32, v35
  v_cvt_pk_f16_f32 v41, v33, v36
  v_mfma_f32_16x16x32_f16 v[72:75], v[160:163], v[56:59], v[72:75]
  v_cvt_pk_f16_f32 v42, v34, v37
  v_mfma_f32_16x16x32_f16 v[68:71], v[112:115], v[52:55], v[68:71]
  ds_write_b128 v10, v[40:43]
  v_mfma_f32_16x16x32_f16 v[68:71], v[116:119], v[56:59], v[68:71]
  v_add_u32 v7, s75, v7
  s_waitcnt vmcnt(1)
  v_mfma_f32_16x16x32_f16 v[68:71], v[120:123], v[60:63], v[68:71]
  ds_read_b128 v[44:47], v11
  ds_read_b128 v[48:51], v12
  v_mfma_f32_16x16x32_f16 v[68:71], v[124:127], v[64:67], v[68:71]
  ds_read_b64_tr_b16 v[52:53], v8 offset:96
  ds_read_b64_tr_b16 v[54:55], v8 offset:608
  v_mfma_f32_16x16x32_f16 v[72:75], v[164:167], v[60:63], v[72:75]
  v_pk_mul_f16 v56, v40, v40 op_sel:[0,0] op_sel_hi:[1,1]
  v_pk_mul_f16 v57, v41, v41 op_sel:[0,0] op_sel_hi:[1,1]
  v_mfma_f32_16x16x32_f16 v[72:75], v[168:171], v[64:67], v[72:75]
  v_pk_mul_f16 v58, v42, v42 op_sel:[0,0] op_sel_hi:[1,1]
  v_pk_mul_f16 v59, v40, v41 op_sel:[0,0] op_sel_hi:[1,1]
  v_smfmac_f32_16x16x64_f16 v[80:83], v[236:239], v[60:67], v16
  ds_read_u16_d16_hi v32, v7 offset:0
  ds_read_u16_d16_hi v33, v7 offset:128
  v_mfma_f32_16x16x32_f16 v[76:79], v[208:211], v[60:63], v[76:79]
  s_nop 1
  v_fmac_f32 v14, v68, v72
  v_fmac_f32 v14, v69, v73
  v_mfma_f32_16x16x32_f16 v[76:79], v[212:215], v[64:67], v[76:79]
  v_fmac_f32 v14, v70, v74
  v_fmac_f32 v14, v71, v75
  s_waitcnt lgkmcnt(2)
  v_mfma_f32_16x16x32_bf16 v[72:75], v[240:243], v[52:55], 0
  v_add_f32 v22, v80, v81
  v_add_f32 v23, v82, v83
  v_mfma_f32_16x16x32_f16 v[72:75], v[128:131], v[56:59], v[72:75]
  s_nop 0
  v_fmac_f32 v14, v76, v77
  v_fmac_f32 v14, v22, v78
  v_mfma_f32_16x16x32_f16 v[68:71], v[84:87], v[56:59], 0
  v_fmac_f32 v14, v23, v79
  v_pk_mul_f16 v60, v40, v41 op_sel:[0,1] op_sel_hi:[1,0]
  v_mfma_f32_16x16x32_f16 v[80:83], v[216:219], v[56:59], 0
  v_pk_mul_f16 v61, v40, v42 op_sel:[0,0] op_sel_hi:[1,1]
  v_pk_mul_f16 v62, v40, v42 op_sel:[0,1] op_sel_hi:[1,0]
  v_mfma_f32_16x16x32_bf16 v[76:79], v[244:247], v[52:55], 0
  v_pk_mul_f16 v63, v41, v42 op_sel:[0,0] op_sel_hi:[1,1]
  v_pk_mul_f16 v64, v41, v42 op_sel:[0,1] op_sel_hi:[1,0]
  v_mfma_f32_16x16x32_f16 v[76:79], v[172:175], v[56:59], v[76:79]
  v_pk_mul_f16 v65, v40, v43 op_sel:[0,0] op_sel_hi:[1,0]
  v_pk_mul_f16 v66, v41, v43 op_sel:[0,0] op_sel_hi:[1,0]
  v_pk_mul_f16 v67, v42, v43 op_sel:[0,0] op_sel_hi:[1,0]
  v_mfma_f32_16x16x32_f16 v[76:79], v[176:179], v[60:63], v[76:79]
  v_mul_f16_sdwa v52, v40, v40 dst_sel:WORD_0 dst_unused:UNUSED_PAD src0_sel:WORD_0 src1_sel:WORD_1
  v_mul_f16_sdwa v53, v42, v42 dst_sel:WORD_0 dst_unused:UNUSED_PAD src0_sel:WORD_0 src1_sel:WORD_1
  v_mfma_f32_16x16x32_f16 v[76:79], v[180:183], v[64:67], v[76:79]
  v_mul_f16_sdwa v52, v41, v41 dst_sel:WORD_1 dst_unused:UNUSED_PRESERVE src0_sel:WORD_0 src1_sel:WORD_1
  v_mul_f16_sdwa v53, v43, v43 dst_sel:WORD_1 dst_unused:UNUSED_PRESERVE src0_sel:WORD_0 src1_sel:WORD_1
  v_smfmac_f32_16x16x64_f16 v[80:83], v[220:223], v[60:67], v16
  v_pk_mul_f16 v54, v40, v47 op_sel:[0,0] op_sel_hi:[1,0]
  v_pk_mul_f16 v55, v41, v47 op_sel:[0,0] op_sel_hi:[1,0]
  v_mfma_f32_16x16x32_f16 v[68:71], v[88:91], v[60:63], v[68:71]
  v_pk_mul_f16 v56, v42, v47 op_sel:[0,0] op_sel_hi:[1,0]
  v_pk_mul_f16 v57, v40, v44 op_sel:[0,0] op_sel_hi:[1,1]
  v_mfma_f32_16x16x32_f16 v[68:71], v[92:95], v[64:67], v[68:71]
  v_pk_mul_f16 v58, v40, v44 op_sel:[0,1] op_sel_hi:[1,0]
  v_pk_mul_f16 v59, v40, v45 op_sel:[0,0] op_sel_hi:[1,1]
  v_mfma_f32_16x16x32_f16 v[72:75], v[132:135], v[60:63], v[72:75]
  v_pk_mul_f16 v60, v40, v45 op_sel:[0,1] op_sel_hi:[1,0]
  v_pk_mul_f16 v61, v40, v46 op_sel:[0,0] op_sel_hi:[1,1]
  v_mfma_f32_16x16x32_f16 v[72:75], v[136:139], v[64:67], v[72:75]
  v_pk_mul_f16 v62, v40, v46 op_sel:[0,1] op_sel_hi:[1,0]
  v_pk_mul_f16 v63, v41, v44 op_sel:[0,0] op_sel_hi:[1,1]
  v_mfma_f32_16x16x32_f16 v[72:75], v[140:143], v[52:55], v[72:75]
  v_pk_mul_f16 v64, v41, v44 op_sel:[0,1] op_sel_hi:[1,0]
  v_pk_mul_f16 v65, v41, v45 op_sel:[0,0] op_sel_hi:[1,1]
  v_mfma_f32_16x16x32_f16 v[72:75], v[144:147], v[56:59], v[72:75]
  v_pk_mul_f16 v66, v41, v45 op_sel:[0,1] op_sel_hi:[1,0]
  v_pk_mul_f16 v67, v41, v46 op_sel:[0,0] op_sel_hi:[1,1]
  v_smfmac_f32_16x16x64_f16 v[80:83], v[224:227], v[52:59], v16
  v_alignbit_b32 v48, v48, v48, v13
  v_alignbit_b32 v49, v49, v49, v13
  v_mfma_f32_16x16x32_f16 v[76:79], v[184:187], v[52:55], v[76:79]
  v_alignbit_b32 v50, v50, v50, v13
  ds_read_u16_d16_hi v34, v7 offset:256
  v_mfma_f32_16x16x32_f16 v[76:79], v[188:191], v[56:59], v[76:79]
  ds_read_u16_d16_hi v35, v7 offset:384
  ds_read_u16_d16_hi v36, v7 offset:512
  v_mfma_f32_16x16x32_f16 v[68:71], v[96:99], v[52:55], v[68:71]
  v_pk_mul_f16 v52, v41, v46 op_sel:[0,1] op_sel_hi:[1,0]
  v_pk_mul_f16 v53, v42, v44 op_sel:[0,0] op_sel_hi:[1,1]
  v_mfma_f32_16x16x32_f16 v[68:71], v[100:103], v[56:59], v[68:71]
  v_pk_mul_f16 v54, v42, v44 op_sel:[0,1] op_sel_hi:[1,0]
  v_pk_mul_f16 v55, v42, v45 op_sel:[0,0] op_sel_hi:[1,1]
  v_mfma_f32_16x16x32_f16 v[68:71], v[104:107], v[60:63], v[68:71]
  v_pk_mul_f16 v56, v42, v45 op_sel:[0,1] op_sel_hi:[1,0]
  v_pk_mul_f16 v57, v42, v46 op_sel:[0,0] op_sel_hi:[1,1]
  v_mfma_f32_16x16x32_f16 v[68:71], v[108:111], v[64:67], v[68:71]
  v_pk_mul_f16 v58, v42, v46 op_sel:[0,1] op_sel_hi:[1,0]
  v_pk_mul_f16 v59, v40, v48 op_sel:[0,0] op_sel_hi:[1,1]
  v_smfmac_f32_16x16x64_f16 v[80:83], v[228:231], v[60:67], v16
  ds_read_u16_d16_hi v37, v7 offset:640
  ds_read_u16_d16_hi v38, v7 offset:768
  v_mfma_f32_16x16x32_f16 v[72:75], v[148:151], v[60:63], v[72:75]
  ds_read_u16_d16_hi v39, v7 offset:896
  s_add_u32 s81, s74, s75
  v_add_u32 v8, s81, v9
  v_mfma_f32_16x16x32_f16 v[72:75], v[152:155], v[64:67], v[72:75]
  v_mfma_f32_16x16x32_f16 v[76:79], v[192:195], v[60:63], v[76:79]
  v_pk_mul_f16 v60, v41, v49 op_sel:[0,0] op_sel_hi:[1,1]
  v_pk_mul_f16 v61, v42, v50 op_sel:[0,0] op_sel_hi:[1,1]
  v_mfma_f32_16x16x32_f16 v[76:79], v[196:199], v[64:67], v[76:79]
  v_pk_mul_f16 v62, v40, v49 op_sel:[0,0] op_sel_hi:[1,1]
  v_pk_mul_f16 v63, v40, v49 op_sel:[0,1] op_sel_hi:[1,0]
  v_mfma_f32_16x16x32_f16 v[76:79], v[200:203], v[52:55], v[76:79]
  v_pk_mul_f16 v64, v40, v50 op_sel:[0,0] op_sel_hi:[1,1]
  v_pk_mul_f16 v65, v40, v50 op_sel:[0,1] op_sel_hi:[1,0]
  v_mfma_f32_16x16x32_f16 v[76:79], v[204:207], v[56:59], v[76:79]
  v_pk_mul_f16 v66, v41, v50 op_sel:[0,0] op_sel_hi:[1,1]
  v_pk_mul_f16 v67, v41, v50 op_sel:[0,1] op_sel_hi:[1,0]
  v_smfmac_f32_16x16x64_f16 v[80:83], v[232:235], v[52:59], v16
  s_waitcnt lgkmcnt(0)
  v_cvt_pk_f16_f32 v43, v38, v39
  v_mfma_f32_16x16x32_f16 v[72:75], v[156:159], v[52:55], v[72:75]
  v_cvt_pk_f16_f32 v40, v32, v35
  v_cvt_pk_f16_f32 v41, v33, v36
  v_mfma_f32_16x16x32_f16 v[72:75], v[160:163], v[56:59], v[72:75]
  v_cvt_pk_f16_f32 v42, v34, v37
  v_mfma_f32_16x16x32_f16 v[68:71], v[112:115], v[52:55], v[68:71]
  ds_write_b128 v10, v[40:43]
  v_mfma_f32_16x16x32_f16 v[68:71], v[116:119], v[56:59], v[68:71]
  v_mfma_f32_16x16x32_f16 v[68:71], v[120:123], v[60:63], v[68:71]
  ds_read_b128 v[44:47], v11
  ds_read_b128 v[48:51], v12
  v_mfma_f32_16x16x32_f16 v[68:71], v[124:127], v[64:67], v[68:71]
  ds_read_b64_tr_b16 v[52:53], v8 offset:0
  ds_read_b64_tr_b16 v[54:55], v8 offset:512
  v_mfma_f32_16x16x32_f16 v[72:75], v[164:167], v[60:63], v[72:75]
  v_pk_mul_f16 v56, v40, v40 op_sel:[0,0] op_sel_hi:[1,1]
  v_pk_mul_f16 v57, v41, v41 op_sel:[0,0] op_sel_hi:[1,1]
  v_mfma_f32_16x16x32_f16 v[72:75], v[168:171], v[64:67], v[72:75]
  v_pk_mul_f16 v58, v42, v42 op_sel:[0,0] op_sel_hi:[1,1]
  v_pk_mul_f16 v59, v40, v41 op_sel:[0,0] op_sel_hi:[1,1]
  v_smfmac_f32_16x16x64_f16 v[80:83], v[236:239], v[60:67], v16
  ds_read_u16_d16_hi v32, v7 offset:32
  ds_read_u16_d16_hi v33, v7 offset:160
  v_mfma_f32_16x16x32_f16 v[76:79], v[208:211], v[60:63], v[76:79]
  s_nop 1
  v_fmac_f32 v14, v68, v72
  v_fmac_f32 v14, v69, v73
  v_mfma_f32_16x16x32_f16 v[76:79], v[212:215], v[64:67], v[76:79]
  v_fmac_f32 v14, v70, v74
  v_fmac_f32 v14, v71, v75
  s_cmp_lg_u32 s72, 1
  s_cbranch_scc1 L_cin_loop
  v_add_f32 v22, v80, v81
  v_add_f32 v23, v82, v83
  s_nop 1
  v_fmac_f32 v14, v76, v77
  v_fmac_f32 v14, v22, v78
  v_fmac_f32 v14, v23, v79
  s_nop 1
  v_add_f32_dpp v14, v14, v14 row_shr:1 row_mask:0xf bank_mask:0xf
  s_nop 1
  v_add_f32_dpp v14, v14, v14 row_shr:2 row_mask:0xf bank_mask:0xf
  s_nop 1
  v_add_f32_dpp v14, v14, v14 row_shr:4 row_mask:0xf bank_mask:0xf
  s_nop 1
  v_add_f32_dpp v14, v14, v14 row_shr:8 row_mask:0xf bank_mask:0xf
  s_nop 1
  v_add_f32_dpp v14, v14, v14 row_bcast:15 row_mask:0xa bank_mask:0xf
  s_nop 1
  v_add_f32_dpp v14, v14, v14 row_bcast:31 row_mask:0xc bank_mask:0xf
  s_branch L_blk
L_htail:
  v_add_f32 v22, v80, v81
  v_add_f32 v23, v82, v83
  s_nop 1
  v_fmac_f32 v14, v76, v77
  v_fmac_f32 v14, v22, v78
  v_fmac_f32 v14, v23, v79
  s_nop 1
  v_add_f32_dpp v14, v14, v14 row_shr:1 row_mask:0xf bank_mask:0xf
  s_nop 1
  v_add_f32_dpp v14, v14, v14 row_shr:2 row_mask:0xf bank_mask:0xf
  s_nop 1
  v_add_f32_dpp v14, v14, v14 row_shr:4 row_mask:0xf bank_mask:0xf
  s_nop 1
  v_add_f32_dpp v14, v14, v14 row_shr:8 row_mask:0xf bank_mask:0xf
  s_nop 1
  v_add_f32_dpp v14, v14, v14 row_bcast:15 row_mask:0xa bank_mask:0xf
  s_nop 1
  v_add_f32_dpp v14, v14, v14 row_bcast:31 row_mask:0xc bank_mask:0xf
  v_add_u32 v7, s75, v7
  s_branch L_blk
L_slow:
  v_subrev_u32 v7, s75, v7
L_slow2:
  v_lshlrev_b32 v22, 1, v0
  v_add_u32 v23, s74, v22
  s_mul_i32 s81, s3, 4224
  s_add_u32 s81, s81, 1024
  v_add_u32 v22, s81, v22
  v_add_u32 v8, s81, v9
L_csync10:
  ds_read_b32 v4, v2 offset:12
  s_waitcnt lgkmcnt(0)
  v_cmp_gt_u32 vcc, 8, v4
  s_cbranch_vccnz L_csync10
  ds_read_u16 v52, v23 offset:0
  ds_read_u16 v53, v23 offset:128
  ds_read_u16 v54, v23 offset:256
  ds_read_u16 v55, v23 offset:384
  ds_read_u16 v56, v23 offset:512
  ds_read_u16 v57, v23 offset:640
  ds_read_u16 v58, v23 offset:768
  ds_read_u16 v59, v23 offset:896
  ds_read_u16 v60, v23 offset:1056
  ds_read_u16 v61, v23 offset:1184
  ds_read_u16 v62, v23 offset:1312
  ds_read_u16 v63, v23 offset:1440
  ds_read_u16 v64, v23 offset:1568
  ds_read_u16 v65, v23 offset:1696
  ds_read_u16 v66, v23 offset:1824
  ds_read_u16 v67, v23 offset:1952
  ds_read_u16 v68, v23 offset:2112
  ds_read_u16 v69, v23 offset:2240
  ds_read_u16 v70, v23 offset:2368
  ds_read_u16 v71, v23 offset:2496
  ds_read_u16 v72, v23 offset:2624
  ds_read_u16 v73, v23 offset:2752
  ds_read_u16 v74, v23 offset:2880
  ds_read_u16 v75, v23 offset:3008
  ds_read_u16 v76, v23 offset:3168
  ds_read_u16 v77, v23 offset:3296
  ds_read_u16 v78, v23 offset:3424
  ds_read_u16 v79, v23 offset:3552
  ds_read_u16 v80, v23 offset:3680
  ds_read_u16 v81, v23 offset:3808
  ds_read_u16 v82, v23 offset:3936
  s_waitcnt lgkmcnt(14)
  v_lshlrev_b32 v52, 16, v52
  v_lshlrev_b32 v53, 16, v53
  v_lshlrev_b32 v54, 16, v54
  v_lshlrev_b32 v55, 16, v55
  v_lshlrev_b32 v56, 16, v56
  v_lshlrev_b32 v57, 16, v57
  v_lshlrev_b32 v58, 16, v58
  v_lshlrev_b32 v59, 16, v59
  v_lshlrev_b32 v60, 16, v60
  v_lshlrev_b32 v61, 16, v61
  v_lshlrev_b32 v62, 16, v62
  v_lshlrev_b32 v63, 16, v63
  v_lshlrev_b32 v64, 16, v64
  v_lshlrev_b32 v65, 16, v65
  v_lshlrev_b32 v66, 16, v66
  v_lshlrev_b32 v67, 16, v67
  v_lshlrev_b32 v68, 16, v68
  s_waitcnt lgkmcnt(13)
  v_lshlrev_b32 v69, 16, v69
  s_waitcnt lgkmcnt(12)
  v_lshlrev_b32 v70, 16, v70
  s_waitcnt lgkmcnt(11)
  v_lshlrev_b32 v71, 16, v71
  s_waitcnt lgkmcnt(10)
  v_lshlrev_b32 v72, 16, v72
  s_waitcnt lgkmcnt(9)
  v_lshlrev_b32 v73, 16, v73
  s_waitcnt lgkmcnt(8)
  v_lshlrev_b32 v74, 16, v74
  s_waitcnt lgkmcnt(7)
  v_lshlrev_b32 v75, 16, v75
  s_waitcnt lgkmcnt(6)
  v_lshlrev_b32 v76, 16, v76
  s_waitcnt lgkmcnt(5)
  v_lshlrev_b32 v77, 16, v77
  s_waitcnt lgkmcnt(4)
  v_lshlrev_b32 v78, 16, v78
  s_waitcnt lgkmcnt(3)
  v_lshlrev_b32 v79, 16, v79
  s_waitcnt lgkmcnt(2)
  v_lshlrev_b32 v80, 16, v80
  s_waitcnt lgkmcnt(1)
  v_lshlrev_b32 v81, 16, v81
  s_waitcnt lgkmcnt(0)
  v_lshlrev_b32 v82, 16, v82
  v_max3_f32 v14, abs(v52), abs(v53), abs(v54)
  v_max3_f32 v14, v14, abs(v55), abs(v56)
  v_max3_f32 v14, v14, abs(v57), abs(v58)
  v_max3_f32 v14, v14, abs(v59), abs(v60)
  v_max3_f32 v14, v14, abs(v61), abs(v62)
  v_max3_f32 v14, v14, abs(v63), abs(v64)
  v_max3_f32 v14, v14, abs(v65), abs(v66)
  v_max3_f32 v14, v14, abs(v67), abs(v68)
  v_max3_f32 v14, v14, abs(v69), abs(v70)
  v_max3_f32 v14, v14, abs(v71), abs(v72)
  v_max3_f32 v14, v14, abs(v73), abs(v74)
  v_max3_f32 v14, v14, abs(v75), abs(v76)
  v_max3_f32 v14, v14, abs(v77), abs(v78)
  v_max3_f32 v14, v14, abs(v79), abs(v80)
  v_max3_f32 v14, v14, abs(v81), abs(v82)
  s_nop 1
  v_max_u32_dpp v14, v14, v14 row_shr:1 row_mask:0xf bank_mask:0xf
  s_nop 1
  v_max_u32_dpp v14, v14, v14 row_shr:2 row_mask:0xf bank_mask:0xf
  s_nop 1
  v_max_u32_dpp v14, v14, v14 row_shr:4 row_mask:0xf bank_mask:0xf
  s_nop 1
  v_max_u32_dpp v14, v14, v14 row_shr:8 row_mask:0xf bank_mask:0xf
  s_nop 1
  v_max_u32_dpp v14, v14, v14 row_bcast:15 row_mask:0xa bank_mask:0xf
  s_nop 1
  v_max_u32_dpp v14, v14, v14 row_bcast:31 row_mask:0xc bank_mask:0xf
  s_nop 0
  v_readlane_b32 s81, v14, 63
  s_nop 0
  s_lshr_b32 s81, s81, 23
  s_sub_i32 s81, 134, s81
  s_cmp_le_u32 s81, 9
  s_cselect_b32 s97, 2, 3
  s_min_i32 s81, s81, 16
  s_lshl_b32 s49, s81, 2
  s_sub_i32 s49, s48, s49
  s_add_i32 s81, s81, 127
  s_lshl_b32 s81, s81, 23
  v_mov_b32 v83, s81
  v_mul_f32 v52, s81, v52
  v_mul_f32 v53, s81, v53
  v_mul_f32 v54, s81, v54
  v_mul_f32 v55, s81, v55
  v_mul_f32 v56, s81, v56
  v_mul_f32 v57, s81, v57
  v_mul_f32 v58, s81, v58
  v_mul_f32 v59, s81, v59
  v_mul_f32 v60, s81, v60
  v_mul_f32 v61, s81, v61
  v_mul_f32 v62, s81, v62
  v_mul_f32 v63, s81, v63
  v_mul_f32 v64, s81, v64
  v_mul_f32 v65, s81, v65
  v_mul_f32 v66, s81, v66
  v_mul_f32 v67, s81, v67
  v_mul_f32 v68, s81, v68
  v_mul_f32 v69, s81, v69
  v_mul_f32 v70, s81, v70
  v_mul_f32 v71, s81, v71
  v_mul_f32 v72, s81, v72
  v_mul_f32 v73, s81, v73
  v_mul_f32 v74, s81, v74
  v_mul_f32 v75, s81, v75
  v_mul_f32 v76, s81, v76
  v_mul_f32 v77, s81, v77
  v_mul_f32 v78, s81, v78
  v_mul_f32 v79, s81, v79
  v_mul_f32 v80, s81, v80
  v_mul_f32 v81, s81, v81
  v_mul_f32 v82, s81, v82
  ds_write_b16_d16_hi v23, v52 offset:0
  ds_write_b16_d16_hi v23, v53 offset:128
  ds_write_b16_d16_hi v23, v54 offset:256
  ds_write_b16_d16_hi v23, v55 offset:384
  ds_write_b16_d16_hi v23, v56 offset:512
  ds_write_b16_d16_hi v23, v57 offset:640
  ds_write_b16_d16_hi v23, v58 offset:768
  ds_write_b16_d16_hi v23, v59 offset:896
  ds_write_b16_d16_hi v23, v60 offset:1056
  ds_write_b16_d16_hi v23, v61 offset:1184
  ds_write_b16_d16_hi v23, v62 offset:1312
  ds_write_b16_d16_hi v23, v63 offset:1440
  ds_write_b16_d16_hi v23, v64 offset:1568
  ds_write_b16_d16_hi v23, v65 offset:1696
  ds_write_b16_d16_hi v23, v66 offset:1824
  ds_write_b16_d16_hi v23, v67 offset:1952
  ds_write_b16_d16_hi v23, v68 offset:2112
  ds_write_b16_d16_hi v23, v69 offset:2240
  ds_write_b16_d16_hi v23, v70 offset:2368
  ds_write_b16_d16_hi v23, v71 offset:2496
  ds_write_b16_d16_hi v23, v72 offset:2624
  ds_write_b16_d16_hi v23, v73 offset:2752
  ds_write_b16_d16_hi v23, v74 offset:2880
  ds_write_b16_d16_hi v23, v75 offset:3008
  ds_write_b16_d16_hi v23, v76 offset:3168
  ds_write_b16_d16_hi v23, v77 offset:3296
  ds_write_b16_d16_hi v23, v78 offset:3424
  ds_write_b16_d16_hi v23, v79 offset:3552
  ds_write_b16_d16_hi v23, v80 offset:3680
  ds_write_b16_d16_hi v23, v81 offset:3808
  ds_write_b16_d16_hi v23, v82 offset:3936
  v_mul_f32 v52, s81, v52
  v_mul_f32 v53, s81, v53
  v_mul_f32 v54, s81, v54
  v_mul_f32 v55, s81, v55
  v_mul_f32 v56, s81, v56
  v_mul_f32 v57, s81, v57
  v_mul_f32 v58, s81, v58
  v_mul_f32 v59, s81, v59
  v_mul_f32 v60, s81, v60
  v_mul_f32 v61, s81, v61
  v_mul_f32 v62, s81, v62
  v_mul_f32 v63, s81, v63
  v_mul_f32 v64, s81, v64
  v_mul_f32 v65, s81, v65
  v_mul_f32 v66, s81, v66
  v_mul_f32 v67, s81, v67
  v_mul_f32 v68, s81, v68
  v_mul_f32 v69, s81, v69
  v_mul_f32 v70, s81, v70
  v_mul_f32 v71, s81, v71
  v_mul_f32 v72, s81, v72
  v_mul_f32 v73, s81, v73
  v_mul_f32 v74, s81, v74
  v_mul_f32 v75, s81, v75
  v_mul_f32 v76, s81, v76
  v_mul_f32 v77, s81, v77
  v_mul_f32 v78, s81, v78
  v_mul_f32 v79, s81, v79
  v_mul_f32 v80, s81, v80
  v_mul_f32 v81, s81, v81
  v_mul_f32 v82, s81, v82
  v_mul_f32 v83, s81, v83
  ds_write_b16_d16_hi v22, v52 offset:0
  ds_write_b16_d16_hi v22, v53 offset:128
  ds_write_b16_d16_hi v22, v54 offset:256
  ds_write_b16_d16_hi v22, v55 offset:384
  ds_write_b16_d16_hi v22, v56 offset:512
  ds_write_b16_d16_hi v22, v57 offset:640
  ds_write_b16_d16_hi v22, v58 offset:768
  ds_write_b16_d16_hi v22, v59 offset:896
  ds_write_b16_d16_hi v22, v60 offset:1056
  ds_write_b16_d16_hi v22, v61 offset:1184
  ds_write_b16_d16_hi v22, v62 offset:1312
  ds_write_b16_d16_hi v22, v63 offset:1440
  ds_write_b16_d16_hi v22, v64 offset:1568
  ds_write_b16_d16_hi v22, v65 offset:1696
  ds_write_b16_d16_hi v22, v66 offset:1824
  ds_write_b16_d16_hi v22, v67 offset:1952
  ds_write_b16_d16_hi v22, v68 offset:2112
  ds_write_b16_d16_hi v22, v69 offset:2240
  ds_write_b16_d16_hi v22, v70 offset:2368
  ds_write_b16_d16_hi v22, v71 offset:2496
  ds_write_b16_d16_hi v22, v72 offset:2624
  ds_write_b16_d16_hi v22, v73 offset:2752
  ds_write_b16_d16_hi v22, v74 offset:2880
  ds_write_b16_d16_hi v22, v75 offset:3008
  ds_write_b16_d16_hi v22, v76 offset:3168
  ds_write_b16_d16_hi v22, v77 offset:3296
  ds_write_b16_d16_hi v22, v78 offset:3424
  ds_write_b16_d16_hi v22, v79 offset:3552
  ds_write_b16_d16_hi v22, v80 offset:3680
  ds_write_b16_d16_hi v22, v81 offset:3808
  ds_write_b16_d16_hi v22, v82 offset:3936
  ds_write_b16_d16_hi v22, v83 offset:4064
  s_mov_b32 s50, 0
  s_waitcnt lgkmcnt(0)
  s_branch L_prime
L_cin_done:
  s_endpgm
L_rem:
  s_lshr_b32 s84, s3, 2
  s_and_b32 s68, s2, 7
  s_lshl_b32 s68, s68, 3
  s_add_u32 s68, s68, s3
  s_mul_i32 s68, s68, 6656
  s_lshl_b32 s76, s3, 14
  v_lshlrev_b32 v248, 4, v0
  v_lshrrev_b32 v246, 4, v0
  v_lshrrev_b32 v247, 3, v0
  v_mul_u32_u24 v13, 3328, v247
  v_and_b32 v247, 2, v247
  s_and_b32 s69, s3, 1
  s_lshl_b32 s69, s69, 2
  v_or_b32 v247, s69, v247
  v_and_b32 v9, 7, v0
  v_xor_b32 v247, v247, v9
  v_lshl_add_u32 v13, v247, 4, v13
  s_mul_i32 s74, s3, 26624
  s_add_u32 s74, s74, 3200
  s_lshl_b32 s75, s3, 10
  s_add_u32 s75, s75, 131072
  s_waitcnt lgkmcnt(0)
  s_load_dword s80, s[18:19], 0
  s_mov_b32 s28, s4
  s_and_b32 s29, s5, 0xffff
  s_mov_b32 s30, 425984
  s_mov_b32 s31, 0x20000
  s_add_u32 m0, s76, 8192
  s_nop 0
  buffer_load_dwordx4 v248, s[28:31], s68 offen lds
  s_add_u32 s68, s68, 1024
  s_add_u32 m0, s76, 9216
  s_nop 0
  buffer_load_dwordx4 v248, s[28:31], s68 offen lds
  s_add_u32 s68, s68, 1024
  s_add_u32 m0, s76, 10240
  s_nop 0
  buffer_load_dwordx4 v248, s[28:31], s68 offen lds
  s_add_u32 s68, s68, 1024
  s_add_u32 m0, s76, 11264
  s_nop 0
  buffer_load_dwordx4 v248, s[28:31], s68 offen lds
  s_add_u32 s68, s68, 1024
  s_add_u32 m0, s76, 12288
  s_nop 0
  buffer_load_dwordx4 v248, s[28:31], s68 offen lds
  s_add_u32 s68, s68, 1024
  s_add_u32 m0, s76, 13312
  s_nop 0
  buffer_load_dwordx4 v248, s[28:31], s68 offen lds
  s_add_u32 s68, s68, 1024
  s_add_u32 m0, s76, 14336
  s_nop 0
  buffer_load_dwordx4 v248, s[28:31], s68 offen lds
  s_add_u32 s68, s68, 1024
  s_mov_b32 s44, s12
  s_and_b32 s45, s13, 0xffff
  s_mov_b32 s46, 5537792
  s_mov_b32 s47, 0x20000
  s_add_u32 m0, s75, 0
  s_nop 0
  buffer_load_dwordx4 v13, s[44:47], s74 offen lds
  s_add_u32 s74, s74, 212992
  s_mov_b32 s60, s24
  s_and_b32 s61, s25, 0xffff
  s_mov_b32 s62, 268435456
  s_mov_b32 s63, 0x20000
  s_mov_b32 s64, s22
  s_and_b32 s65, s23, 0xffff
  s_mov_b32 s66, 256
  s_mov_b32 s67, 0x20000
  v_mov_b32 v64, -1
  v_mov_b32 v65, -1
  v_mov_b32 v66, -1
  v_mov_b32 v67, -1
  s_and_b32 s70, s2, 7
  s_lshl_b32 s68, s70, 3
  s_add_u32 s68, s68, s3
  s_lshl_b32 s68, s68, 11
  s_lshl_b32 s70, s70, 2
  buffer_store_dwordx4 v[64:67], v248, s[60:63], s68 offen sc1
  buffer_store_dwordx4 v[64:67], v248, s[60:63], s68 offen offset:1024 sc1
  s_mov_b32 s48, s14
  s_and_b32 s49, s15, 0xffff
  s_mov_b32 s50, 3328
  s_mov_b32 s51, 0x20000
  s_mov_b32 s52, s16
  s_and_b32 s53, s17, 0xffff
  s_mov_b32 s54, 3328
  s_mov_b32 s55, 0x20000
  s_mov_b32 s32, s6
  s_and_b32 s33, s7, 0xffff
  s_mov_b32 s34, 12800000
  s_mov_b32 s35, 0x20000
  v_xor_b32 v248, v9, v246
  v_lshlrev_b32 v14, 4, v248
  v_xor_b32 v15, 64, v14
  v_bfe_u32 v247, v0, 2, 2
  v_lshl_add_u32 v248, v246, 3, v247
  v_lshlrev_b32 v248, 7, v248
  v_and_b32 v247, 3, v0
  v_lshl_add_u32 v248, v247, 3, v248
  v_add_u32 v248, 131072, v248
  v_bfe_u32 v247, v0, 3, 2
  v_lshl_add_u32 v1, v247, 5, v248
  v_xor_b32 v2, 32, v1
  v_xor_b32 v7, 64, v1
  v_xor_b32 v8, 96, v1
  v_and_b32 v248, 15, v0
  v_lshlrev_b32 v248, 7, v248
  v_bfe_u32 v247, v0, 1, 3
  v_xor_b32 v247, v247, v246
  v_lshl_add_u32 v248, v247, 4, v248
  v_add_u32 v11, s76, v248
  v_xor_b32 v12, 64, v11
  v_lshrrev_b32 v247, 3, v0
  v_lshl_add_u32 v248, v9, 3, v247
  v_mul_u32_u24 v248, 104, v248
  v_add_u32 v248, s76, v248
  s_mov_b32 s56, s20
  s_and_b32 s57, s21, 0xffff
  s_mov_b32 s58, 8192
  s_mov_b32 s59, 0x20000
  s_and_b32 s77, s2, 7
  s_lshl_b32 s68, s77, 14
  s_lshl_b32 s69, s3, 8
  s_add_u32 s68, s68, s69
  s_add_u32 s69, s68, 4096
  s_add_u32 s71, s68, 8192
  s_lshl_b32 s77, s77, 3
  s_add_u32 s77, s77, s3
  s_lshl_b32 s77, s77, 7
  v_lshlrev_b32 v3, 2, v0
  v_lshlrev_b32 v4, 1, v0
  s_lshl_b32 s81, s3, 6
  v_add_u32 v5, s81, v0
  v_cmp_lt_u32 vcc, 503, v5
  v_add_u32 v5, 4096, v3
  v_mov_b32 v6, 0x7f000000
  v_cndmask_b32 v5, v6, v5, vcc
  v_mov_b32 v240, 0xc0135761
  v_mov_b32 v241, 0xc0135761
  v_mov_b32 v242, 0xbdd2d3e8
  v_mov_b32 v243, 0xbdd2d3e8
  v_mov_b32 v244, 0x71800000
  v_mov_b32 v160, 0
  v_mov_b32 v161, 0
  v_mov_b32 v162, 0
  v_mov_b32 v163, 0
  v_mov_b32 v164, 0
  v_mov_b32 v165, 0
  v_mov_b32 v166, 0
  v_mov_b32 v167, 0
  v_mov_b32 v168, 0
  v_mov_b32 v169, 0
  v_mov_b32 v170, 0
  v_mov_b32 v171, 0
  v_mov_b32 v172, 0
  v_mov_b32 v173, 0
  v_mov_b32 v174, 0
  v_mov_b32 v175, 0
  v_mov_b32 v176, 0
  v_mov_b32 v177, 0
  v_mov_b32 v178, 0
  v_mov_b32 v179, 0
  v_mov_b32 v180, 0
  v_mov_b32 v181, 0
  v_mov_b32 v182, 0
  v_mov_b32 v183, 0
  v_mov_b32 v184, 0
  v_mov_b32 v185, 0
  v_mov_b32 v186, 0
  v_mov_b32 v187, 0
  v_mov_b32 v188, 0
  v_mov_b32 v189, 0
  v_mov_b32 v190, 0
  v_mov_b32 v191, 0
  v_mov_b32 v192, 0
  v_mov_b32 v193, 0
  v_mov_b32 v194, 0
  v_mov_b32 v195, 0
  v_mov_b32 v196, 0
  v_mov_b32 v197, 0
  v_mov_b32 v198, 0
  v_mov_b32 v199, 0
  v_mov_b32 v200, 0
  v_mov_b32 v201, 0
  v_mov_b32 v202, 0
  v_mov_b32 v203, 0
  v_mov_b32 v204, 0
  v_mov_b32 v205, 0
  v_mov_b32 v206, 0
  v_mov_b32 v207, 0
  v_mov_b32 v208, 0
  v_mov_b32 v209, 0
  v_mov_b32 v210, 0
  v_mov_b32 v211, 0
  v_mov_b32 v212, 0
  v_mov_b32 v213, 0
  v_mov_b32 v214, 0
  v_mov_b32 v215, 0
  v_mov_b32 v216, 0
  v_mov_b32 v217, 0
  v_mov_b32 v218, 0
  v_mov_b32 v219, 0
  v_mov_b32 v220, 0
  v_mov_b32 v221, 0
  v_mov_b32 v222, 0
  v_mov_b32 v223, 0
  s_waitcnt vmcnt(0) lgkmcnt(0)
  s_lshl_b32 s80, s80, 16
  ds_read_b64 v[32:33], v248 offset:8192
  ds_read_b64 v[34:35], v248 offset:8200
  ds_read_b64 v[36:37], v248 offset:8208
  ds_read_b64 v[38:39], v248 offset:8216
  ds_read_b64 v[40:41], v248 offset:8224
  ds_read_b64 v[42:43], v248 offset:8232
  ds_read_b64 v[44:45], v248 offset:8240
  ds_read_b64 v[46:47], v248 offset:8248
  ds_read_b64 v[48:49], v248 offset:8256
  ds_read_b64 v[50:51], v248 offset:8264
  ds_read_b64 v[52:53], v248 offset:8272
  ds_read_b64 v[54:55], v248 offset:8280
  ds_read_b64 v[56:57], v248 offset:8288
  v_mov_b32 v24, 0
  v_mov_b32 v25, 0
  v_mov_b32 v26, 0
  v_mov_b32 v27, 0
  v_mov_b32 v28, 0
  v_mov_b32 v29, 0
  v_mov_b32 v30, 0
  v_mov_b32 v31, 0
  v_mov_b32 v58, 0x7f000000
  v_mov_b32 v59, 0x7f000000
  s_waitcnt lgkmcnt(12)
  v_lshlrev_b32 v32, 7, v32
  s_nop 1
  v_add_u32_dpp v24, v32, v14 row_newbcast:0 row_mask:0xf bank_mask:0x3
  v_add_u32_dpp v25, v32, v15 row_newbcast:1 row_mask:0xf bank_mask:0x3
  v_add_u32_dpp v26, v32, v14 row_newbcast:2 row_mask:0xf bank_mask:0x3
  v_add_u32_dpp v27, v32, v15 row_newbcast:3 row_mask:0xf bank_mask:0x3
  v_add_u32_dpp v24, v32, v14 row_newbcast:8 row_mask:0xf bank_mask:0xc
  v_add_u32_dpp v25, v32, v15 row_newbcast:9 row_mask:0xf bank_mask:0xc
  v_add_u32_dpp v26, v32, v14 row_newbcast:10 row_mask:0xf bank_mask:0xc
  v_add_u32_dpp v27, v32, v15 row_newbcast:11 row_mask:0xf bank_mask:0xc
  s_add_u32 m0, s76, 0
  s_nop 0
  buffer_load_dwordx4 v24, s[32:35], 0 offen lds
  s_add_u32 m0, s76, 1024
  s_nop 0
  buffer_load_dwordx4 v25, s[32:35], 0 offen lds
  s_add_u32 m0, s76, 2048
  s_nop 0
  buffer_load_dwordx4 v26, s[32:35], 0 offen lds
  s_add_u32 m0, s76, 3072
  s_nop 0
  buffer_load_dwordx4 v27, s[32:35], 0 offen lds
  v_add_u32_dpp v28, v32, v14 row_newbcast:4 row_mask:0xf bank_mask:0x3
  v_add_u32_dpp v29, v32, v15 row_newbcast:5 row_mask:0xf bank_mask:0x3
  v_add_u32_dpp v30, v32, v14 row_newbcast:6 row_mask:0xf bank_mask:0x3
  v_add_u32_dpp v31, v32, v15 row_newbcast:7 row_mask:0xf bank_mask:0x3
  v_add_u32_dpp v28, v32, v14 row_newbcast:12 row_mask:0xf bank_mask:0xc
  v_add_u32_dpp v29, v32, v15 row_newbcast:13 row_mask:0xf bank_mask:0xc
  v_add_u32_dpp v30, v32, v14 row_newbcast:14 row_mask:0xf bank_mask:0xc
  v_add_u32_dpp v31, v32, v15 row_newbcast:15 row_mask:0xf bank_mask:0xc
  s_add_u32 m0, s76, 4096
  s_nop 0
  buffer_load_dwordx4 v28, s[32:35], 0 offen lds
  s_add_u32 m0, s76, 5120
  s_nop 0
  buffer_load_dwordx4 v29, s[32:35], 0 offen lds
  s_add_u32 m0, s76, 6144
  s_nop 0
  buffer_load_dwordx4 v30, s[32:35], 0 offen lds
  s_add_u32 m0, s76, 7168
  s_nop 0
  buffer_load_dwordx4 v31, s[32:35], 0 offen lds
  s_add_u32 m0, s75, 8192
  s_nop 0
  buffer_load_dwordx4 v13, s[44:47], s74 offen lds
  s_add_u32 s74, s74, 212992
  s_waitcnt lgkmcnt(0)
  v_lshlrev_b32 v57, 7, v57
  v_lshlrev_b32 v56, 7, v56
  v_lshlrev_b32 v55, 7, v55
  v_lshlrev_b32 v54, 7, v54
  v_lshlrev_b32 v53, 7, v53
  v_lshlrev_b32 v52, 7, v52
  v_lshlrev_b32 v51, 7, v51
  v_lshlrev_b32 v50, 7, v50
  v_lshlrev_b32 v49, 7, v49
  v_lshlrev_b32 v48, 7, v48
  v_lshlrev_b32 v47, 7, v47
  v_lshlrev_b32 v46, 7, v46
  v_lshlrev_b32 v45, 7, v45
  v_lshlrev_b32 v44, 7, v44
  v_lshlrev_b32 v43, 7, v43
  v_lshlrev_b32 v42, 7, v42
  v_lshlrev_b32 v41, 7, v41
  v_lshlrev_b32 v40, 7, v40
  v_lshlrev_b32 v39, 7, v39
  v_lshlrev_b32 v38, 7, v38
  v_lshlrev_b32 v37, 7, v37
  v_lshlrev_b32 v36, 7, v36
  v_lshlrev_b32 v35, 7, v35
  v_lshlrev_b32 v34, 7, v34
  v_lshlrev_b32 v33, 7, v33
  s_nop 1
  v_add_u32_dpp v24, v33, v14 row_newbcast:0 row_mask:0xf bank_mask:0x3
  v_add_u32_dpp v25, v33, v15 row_newbcast:1 row_mask:0xf bank_mask:0x3
  v_add_u32_dpp v26, v33, v14 row_newbcast:2 row_mask:0xf bank_mask:0x3
  v_add_u32_dpp v27, v33, v15 row_newbcast:3 row_mask:0xf bank_mask:0x3
  v_add_u32_dpp v24, v33, v14 row_newbcast:8 row_mask:0xf bank_mask:0xc
  v_add_u32_dpp v25, v33, v15 row_newbcast:9 row_mask:0xf bank_mask:0xc
  v_add_u32_dpp v26, v33, v14 row_newbcast:10 row_mask:0xf bank_mask:0xc
  v_add_u32_dpp v27, v33, v15 row_newbcast:11 row_mask:0xf bank_mask:0xc
  s_add_u32 m0, s76, 8192
  s_nop 0
  buffer_load_dwordx4 v24, s[32:35], 0 offen lds
  s_add_u32 m0, s76, 9216
  s_nop 0
  buffer_load_dwordx4 v25, s[32:35], 0 offen lds
  s_add_u32 m0, s76, 10240
  s_nop 0
  buffer_load_dwordx4 v26, s[32:35], 0 offen lds
  s_add_u32 m0, s76, 11264
  s_nop 0
  buffer_load_dwordx4 v27, s[32:35], 0 offen lds
  v_add_u32_dpp v28, v33, v14 row_newbcast:4 row_mask:0xf bank_mask:0x3
  v_add_u32_dpp v29, v33, v15 row_newbcast:5 row_mask:0xf bank_mask:0x3
  v_add_u32_dpp v30, v33, v14 row_newbcast:6 row_mask:0xf bank_mask:0x3
  v_add_u32_dpp v31, v33, v15 row_newbcast:7 row_mask:0xf bank_mask:0x3
  v_add_u32_dpp v28, v33, v14 row_newbcast:12 row_mask:0xf bank_mask:0xc
  v_add_u32_dpp v29, v33, v15 row_newbcast:13 row_mask:0xf bank_mask:0xc
  v_add_u32_dpp v30, v33, v14 row_newbcast:14 row_mask:0xf bank_mask:0xc
  v_add_u32_dpp v31, v33, v15 row_newbcast:15 row_mask:0xf bank_mask:0xc
  s_add_u32 m0, s76, 12288
  s_nop 0
  buffer_load_dwordx4 v28, s[32:35], 0 offen lds
  s_add_u32 m0, s76, 13312
  s_nop 0
  buffer_load_dwordx4 v29, s[32:35], 0 offen lds
  s_add_u32 m0, s76, 14336
  s_nop 0
  buffer_load_dwordx4 v30, s[32:35], 0 offen lds
  s_add_u32 m0, s76, 15360
  s_nop 0
  buffer_load_dwordx4 v31, s[32:35], 0 offen lds
  s_add_u32 m0, s75, 16384
  s_nop 0
  buffer_load_dwordx4 v13, s[44:47], s74 offen lds
  s_add_u32 s74, s74, 212992
  v_lshlrev_b32 v248, 3, v246
  s_mov_b32 s73, 3
  v_mov_b32 v9, v34
  s_nop 1
  v_add_u32_dpp v24, v9, v14 row_newbcast:0 row_mask:0xf bank_mask:0x3
  v_add_u32_dpp v25, v9, v15 row_newbcast:1 row_mask:0xf bank_mask:0x3
  v_add_u32_dpp v26, v9, v14 row_newbcast:2 row_mask:0xf bank_mask:0x3
  v_add_u32_dpp v27, v9, v15 row_newbcast:3 row_mask:0xf bank_mask:0x3
  v_add_u32_dpp v24, v9, v14 row_newbcast:8 row_mask:0xf bank_mask:0xc
  v_add_u32_dpp v25, v9, v15 row_newbcast:9 row_mask:0xf bank_mask:0xc
  v_add_u32_dpp v26, v9, v14 row_newbcast:10 row_mask:0xf bank_mask:0xc
  v_add_u32_dpp v27, v9, v15 row_newbcast:11 row_mask:0xf bank_mask:0xc
  s_waitcnt vmcnt(14)
  s_barrier
  ds_read_b128 v[76:79], v12 offset:2048
  ds_read_b128 v[72:75], v11 offset:2048
  ds_read_b128 v[68:71], v12 offset:0
  ds_read_b128 v[64:67], v11 offset:0
  ds_read_b64_tr_b16 v[96:97], v1 offset:0
  ds_read_b64_tr_b16 v[98:99], v1 offset:512
  ds_read_b64_tr_b16 v[100:101], v1 offset:4096
  ds_read_b64_tr_b16 v[102:103], v1 offset:4608
  ds_read_b64_tr_b16 v[104:105], v2 offset:0
  ds_read_b64_tr_b16 v[106:107], v2 offset:512
  ds_read_b64_tr_b16 v[108:109], v2 offset:4096
  ds_read_b64_tr_b16 v[110:111], v2 offset:4608
  ds_read_b64_tr_b16 v[112:113], v7 offset:0
  ds_read_b64_tr_b16 v[114:115], v7 offset:512
  ds_read_b64_tr_b16 v[116:117], v7 offset:4096
  ds_read_b64_tr_b16 v[118:119], v7 offset:4608
  ds_read_b64_tr_b16 v[120:121], v8 offset:0
  ds_read_b64_tr_b16 v[122:123], v8 offset:512
  ds_read_b64_tr_b16 v[124:125], v8 offset:4096
  ds_read_b64_tr_b16 v[126:127], v8 offset:4608
  s_cmp_lg_u32 s3, 7
  s_cbranch_scc1 L_rem_loop
  s_mov_b64 exec, 1
  buffer_store_dword v240, v14, s[64:67], s70 offen offset:128 sc1
  s_mov_b64 exec, -1
L_rem_loop:
  s_waitcnt vmcnt(9)
  s_barrier
  s_waitcnt lgkmcnt(8)
  v_mfma_f32_16x16x32_bf16 v[160:163], v[96:99], v[64:67], v[160:163]
  ds_read_b128 v[92:95], v12 offset:6144
  ds_read_b128 v[88:91], v11 offset:6144
  s_waitcnt lgkmcnt(14)
  v_mfma_f32_16x16x32_bf16 v[160:163], v[100:103], v[68:71], v[160:163]
  ds_read_b128 v[84:87], v12 offset:4096
  s_add_u32 m0, s76, 0
  s_nop 0
  buffer_load_dwordx4 v24, s[32:35], 0 offen lds
  v_mfma_f32_16x16x32_bf16 v[164:167], v[96:99], v[72:75], v[164:167]
  ds_read_b128 v[80:83], v11 offset:4096
  v_mfma_f32_16x16x32_bf16 v[164:167], v[100:103], v[76:79], v[164:167]
  ds_read_b64_tr_b16 v[128:129], v1 offset:8192
  s_waitcnt lgkmcnt(14)
  v_mfma_f32_16x16x32_bf16 v[176:179], v[104:107], v[64:67], v[176:179]
  ds_read_b64_tr_b16 v[130:131], v1 offset:8704
  s_add_u32 m0, s76, 1024
  s_nop 0
  buffer_load_dwordx4 v25, s[32:35], 0 offen lds
  s_waitcnt lgkmcnt(14)
  v_mfma_f32_16x16x32_bf16 v[176:179], v[108:111], v[68:71], v[176:179]
  ds_read_b64_tr_b16 v[132:133], v1 offset:12288
  v_mfma_f32_16x16x32_bf16 v[180:183], v[104:107], v[72:75], v[180:183]
  ds_read_b64_tr_b16 v[134:135], v1 offset:12800
  v_mfma_f32_16x16x32_bf16 v[180:183], v[108:111], v[76:79], v[180:183]
  ds_read_b64_tr_b16 v[136:137], v2 offset:8192
  s_waitcnt lgkmcnt(14)
  v_mfma_f32_16x16x32_bf16 v[192:195], v[112:115], v[64:67], v[192:195]
  ds_read_b64_tr_b16 v[138:139], v2 offset:8704
  s_add_u32 m0, s76, 2048
  s_nop 0
  buffer_load_dwordx4 v26, s[32:35], 0 offen lds
  s_waitcnt lgkmcnt(14)
  v_mfma_f32_16x16x32_bf16 v[192:195], v[116:119], v[68:71], v[192:195]
  ds_read_b64_tr_b16 v[140:141], v2 offset:12288
  v_mfma_f32_16x16x32_bf16 v[196:199], v[112:115], v[72:75], v[196:199]
  ds_read_b64_tr_b16 v[142:143], v2 offset:12800
  v_mfma_f32_16x16x32_bf16 v[196:199], v[116:119], v[76:79], v[196:199]
  v_add_u32_dpp v28, v9, v14 row_newbcast:4 row_mask:0xf bank_mask:0x3
  v_add_u32_dpp v29, v9, v15 row_newbcast:5 row_mask:0xf bank_mask:0x3
  s_waitcnt lgkmcnt(14)
  v_mfma_f32_16x16x32_bf16 v[208:211], v[120:123], v[64:67], v[208:211]
  s_add_u32 m0, s76, 3072
  s_nop 0
  buffer_load_dwordx4 v27, s[32:35], 0 offen lds
  v_add_u32_dpp v30, v9, v14 row_newbcast:6 row_mask:0xf bank_mask:0x3
  v_add_u32_dpp v31, v9, v15 row_newbcast:7 row_mask:0xf bank_mask:0x3
  s_waitcnt lgkmcnt(12)
  v_mfma_f32_16x16x32_bf16 v[208:211], v[124:127], v[68:71], v[208:211]
  v_add_u32_dpp v28, v9, v14 row_newbcast:12 row_mask:0xf bank_mask:0xc
  v_mfma_f32_16x16x32_bf16 v[212:215], v[120:123], v[72:75], v[212:215]
  v_add_u32_dpp v29, v9, v15 row_newbcast:13 row_mask:0xf bank_mask:0xc
  v_add_u32_dpp v30, v9, v14 row_newbcast:14 row_mask:0xf bank_mask:0xc
  v_mfma_f32_16x16x32_bf16 v[212:215], v[124:127], v[76:79], v[212:215]
  v_add_u32_dpp v31, v9, v15 row_newbcast:15 row_mask:0xf bank_mask:0xc
  s_waitcnt vmcnt(9)
  s_waitcnt lgkmcnt(8)
  v_mfma_f32_16x16x32_bf16 v[168:171], v[96:99], v[80:83], v[168:171]
  ds_read_b128 v[76:79], v12 offset:10240
  ds_read_b128 v[72:75], v11 offset:10240
  v_mfma_f32_16x16x32_bf16 v[168:171], v[100:103], v[84:87], v[168:171]
  ds_read_b128 v[68:71], v12 offset:8192
  s_add_u32 m0, s76, 4096
  s_nop 0
  buffer_load_dwordx4 v28, s[32:35], 0 offen lds
  v_mfma_f32_16x16x32_bf16 v[172:175], v[96:99], v[88:91], v[172:175]
  ds_read_b128 v[64:67], v11 offset:8192
  v_mfma_f32_16x16x32_bf16 v[172:175], v[100:103], v[92:95], v[172:175]
  ds_read_b64_tr_b16 v[144:145], v7 offset:8192
  v_mfma_f32_16x16x32_bf16 v[184:187], v[104:107], v[80:83], v[184:187]
  ds_read_b64_tr_b16 v[146:147], v7 offset:8704
  s_add_u32 m0, s76, 5120
  s_nop 0
  buffer_load_dwordx4 v29, s[32:35], 0 offen lds
  v_mfma_f32_16x16x32_bf16 v[184:187], v[108:111], v[84:87], v[184:187]
  ds_read_b64_tr_b16 v[148:149], v7 offset:12288
  v_mfma_f32_16x16x32_bf16 v[188:191], v[104:107], v[88:91], v[188:191]
  ds_read_b64_tr_b16 v[150:151], v7 offset:12800
  v_mfma_f32_16x16x32_bf16 v[188:191], v[108:111], v[92:95], v[188:191]
  ds_read_b64_tr_b16 v[152:153], v8 offset:8192
  s_add_u32 m0, s76, 6144
  s_nop 0
  buffer_load_dwordx4 v30, s[32:35], 0 offen lds
  v_mfma_f32_16x16x32_bf16 v[200:203], v[112:115], v[80:83], v[200:203]
  ds_read_b64_tr_b16 v[154:155], v8 offset:8704
  v_mfma_f32_16x16x32_bf16 v[200:203], v[116:119], v[84:87], v[200:203]
  ds_read_b64_tr_b16 v[156:157], v8 offset:12288
  v_mfma_f32_16x16x32_bf16 v[204:207], v[112:115], v[88:91], v[204:207]
  ds_read_b64_tr_b16 v[158:159], v8 offset:12800
  s_add_u32 m0, s76, 7168
  s_nop 0
  buffer_load_dwordx4 v31, s[32:35], 0 offen lds
  v_mfma_f32_16x16x32_bf16 v[204:207], v[116:119], v[92:95], v[204:207]
  s_set_gpr_idx_on s73, gpr_idx(SRC0)
  s_nop 0
  v_mov_b32 v9, v32
  s_set_gpr_idx_off
  s_add_u32 s73, s73, 1
  v_add_u32_dpp v24, v9, v14 row_newbcast:0 row_mask:0xf bank_mask:0x3
  v_mfma_f32_16x16x32_bf16 v[216:219], v[120:123], v[80:83], v[216:219]
  v_add_u32_dpp v25, v9, v15 row_newbcast:1 row_mask:0xf bank_mask:0x3
  v_add_u32_dpp v26, v9, v14 row_newbcast:2 row_mask:0xf bank_mask:0x3
  v_mfma_f32_16x16x32_bf16 v[216:219], v[124:127], v[84:87], v[216:219]
  s_xor_b32 s75, s75, 16384
  s_add_u32 m0, s75, 8192
  s_nop 0
  buffer_load_dwordx4 v13, s[44:47], s74 offen lds
  s_add_u32 s74, s74, 212992
  s_xor_b32 s75, s75, 16384
  v_add_u32_dpp v27, v9, v15 row_newbcast:3 row_mask:0xf bank_mask:0x3
  v_add_u32_dpp v24, v9, v14 row_newbcast:8 row_mask:0xf bank_mask:0xc
  v_mfma_f32_16x16x32_bf16 v[220:223], v[120:123], v[88:91], v[220:223]
  v_add_u32_dpp v25, v9, v15 row_newbcast:9 row_mask:0xf bank_mask:0xc
  v_add_u32_dpp v26, v9, v14 row_newbcast:10 row_mask:0xf bank_mask:0xc
  v_mfma_f32_16x16x32_bf16 v[220:223], v[124:127], v[92:95], v[220:223]
  v_add_u32_dpp v27, v9, v15 row_newbcast:11 row_mask:0xf bank_mask:0xc
L_rnv:
  s_waitcnt vmcnt(9)
  s_barrier
  v_xor_b32 v1, 16384, v1
  v_xor_b32 v2, 16384, v2
  v_xor_b32 v7, 16384, v7
  v_xor_b32 v8, 16384, v8
  s_waitcnt lgkmcnt(8)
  v_mfma_f32_16x16x32_bf16 v[160:163], v[128:131], v[64:67], v[160:163]
  ds_read_b128 v[92:95], v12 offset:14336
  ds_read_b128 v[88:91], v11 offset:14336
  v_mfma_f32_16x16x32_bf16 v[160:163], v[132:135], v[68:71], v[160:163]
  ds_read_b128 v[84:87], v12 offset:12288
  s_add_u32 m0, s76, 8192
  s_nop 0
  buffer_load_dwordx4 v24, s[32:35], 0 offen lds
  v_mfma_f32_16x16x32_bf16 v[164:167], v[128:131], v[72:75], v[164:167]
  ds_read_b128 v[80:83], v11 offset:12288
  v_mfma_f32_16x16x32_bf16 v[164:167], v[132:135], v[76:79], v[164:167]
  ds_read_b64_tr_b16 v[96:97], v1 offset:0
  v_mfma_f32_16x16x32_bf16 v[176:179], v[136:139], v[64:67], v[176:179]
  ds_read_b64_tr_b16 v[98:99], v1 offset:512
  s_add_u32 m0, s76, 9216
  s_nop 0
  buffer_load_dwordx4 v25, s[32:35], 0 offen lds
  v_mfma_f32_16x16x32_bf16 v[176:179], v[140:143], v[68:71], v[176:179]
  ds_read_b64_tr_b16 v[100:101], v1 offset:4096
  v_mfma_f32_16x16x32_bf16 v[180:183], v[136:139], v[72:75], v[180:183]
  ds_read_b64_tr_b16 v[102:103], v1 offset:4608
  v_mfma_f32_16x16x32_bf16 v[180:183], v[140:143], v[76:79], v[180:183]
  ds_read_b64_tr_b16 v[104:105], v2 offset:0
  s_waitcnt lgkmcnt(14)
  v_mfma_f32_16x16x32_bf16 v[192:195], v[144:147], v[64:67], v[192:195]
  ds_read_b64_tr_b16 v[106:107], v2 offset:512
  s_add_u32 m0, s76, 10240
  s_nop 0
  buffer_load_dwordx4 v26, s[32:35], 0 offen lds
  s_waitcnt lgkmcnt(14)
  v_mfma_f32_16x16x32_bf16 v[192:195], v[148:151], v[68:71], v[192:195]
  ds_read_b64_tr_b16 v[108:109], v2 offset:4096
  v_mfma_f32_16x16x32_bf16 v[196:199], v[144:147], v[72:75], v[196:199]
  ds_read_b64_tr_b16 v[110:111], v2 offset:4608
  v_mfma_f32_16x16x32_bf16 v[196:199], v[148:151], v[76:79], v[196:199]
  v_add_u32_dpp v28, v9, v14 row_newbcast:4 row_mask:0xf bank_mask:0x3
  v_add_u32_dpp v29, v9, v15 row_newbcast:5 row_mask:0xf bank_mask:0x3
  s_waitcnt lgkmcnt(14)
  v_mfma_f32_16x16x32_bf16 v[208:211], v[152:155], v[64:67], v[208:211]
  s_add_u32 m0, s76, 11264
  s_nop 0
  buffer_load_dwordx4 v27, s[32:35], 0 offen lds
  v_add_u32_dpp v30, v9, v14 row_newbcast:6 row_mask:0xf bank_mask:0x3
  v_add_u32_dpp v31, v9, v15 row_newbcast:7 row_mask:0xf bank_mask:0x3
  s_waitcnt lgkmcnt(12)
  v_mfma_f32_16x16x32_bf16 v[208:211], v[156:159], v[68:71], v[208:211]
  v_add_u32_dpp v28, v9, v14 row_newbcast:12 row_mask:0xf bank_mask:0xc
  v_mfma_f32_16x16x32_bf16 v[212:215], v[152:155], v[72:75], v[212:215]
  v_add_u32_dpp v29, v9, v15 row_newbcast:13 row_mask:0xf bank_mask:0xc
  v_add_u32_dpp v30, v9, v14 row_newbcast:14 row_mask:0xf bank_mask:0xc
  v_mfma_f32_16x16x32_bf16 v[212:215], v[156:159], v[76:79], v[212:215]
  v_add_u32_dpp v31, v9, v15 row_newbcast:15 row_mask:0xf bank_mask:0xc
  s_waitcnt vmcnt(9)
  s_waitcnt lgkmcnt(8)
  v_mfma_f32_16x16x32_bf16 v[168:171], v[128:131], v[80:83], v[168:171]
  ds_read_b128 v[76:79], v12 offset:2048
  ds_read_b128 v[72:75], v11 offset:2048
  v_mfma_f32_16x16x32_bf16 v[168:171], v[132:135], v[84:87], v[168:171]
  ds_read_b128 v[68:71], v12 offset:0
  s_add_u32 m0, s76, 12288
  s_nop 0
  buffer_load_dwordx4 v28, s[32:35], 0 offen lds
  v_mfma_f32_16x16x32_bf16 v[172:175], v[128:131], v[88:91], v[172:175]
  ds_read_b128 v[64:67], v11 offset:0
  v_mfma_f32_16x16x32_bf16 v[172:175], v[132:135], v[92:95], v[172:175]
  ds_read_b64_tr_b16 v[112:113], v7 offset:0
  v_mfma_f32_16x16x32_bf16 v[184:187], v[136:139], v[80:83], v[184:187]
  ds_read_b64_tr_b16 v[114:115], v7 offset:512
  s_add_u32 m0, s76, 13312
  s_nop 0
  buffer_load_dwordx4 v29, s[32:35], 0 offen lds
  v_mfma_f32_16x16x32_bf16 v[184:187], v[140:143], v[84:87], v[184:187]
  ds_read_b64_tr_b16 v[116:117], v7 offset:4096
  v_mfma_f32_16x16x32_bf16 v[188:191], v[136:139], v[88:91], v[188:191]
  ds_read_b64_tr_b16 v[118:119], v7 offset:4608
  v_mfma_f32_16x16x32_bf16 v[188:191], v[140:143], v[92:95], v[188:191]
  ds_read_b64_tr_b16 v[120:121], v8 offset:0
  s_add_u32 m0, s76, 14336
  s_nop 0
  buffer_load_dwordx4 v30, s[32:35], 0 offen lds
  v_mfma_f32_16x16x32_bf16 v[200:203], v[144:147], v[80:83], v[200:203]
  ds_read_b64_tr_b16 v[122:123], v8 offset:512
  v_mfma_f32_16x16x32_bf16 v[200:203], v[148:151], v[84:87], v[200:203]
  ds_read_b64_tr_b16 v[124:125], v8 offset:4096
  v_mfma_f32_16x16x32_bf16 v[204:207], v[144:147], v[88:91], v[204:207]
  ds_read_b64_tr_b16 v[126:127], v8 offset:4608
  s_add_u32 m0, s76, 15360
  s_nop 0
  buffer_load_dwordx4 v31, s[32:35], 0 offen lds
  v_mfma_f32_16x16x32_bf16 v[204:207], v[148:151], v[92:95], v[204:207]
  s_set_gpr_idx_on s73, gpr_idx(SRC0)
  s_nop 0
  v_mov_b32 v9, v32
  s_set_gpr_idx_off
  s_add_u32 s73, s73, 1
  v_add_u32_dpp v24, v9, v14 row_newbcast:0 row_mask:0xf bank_mask:0x3
  v_mfma_f32_16x16x32_bf16 v[216:219], v[152:155], v[80:83], v[216:219]
  v_add_u32_dpp v25, v9, v15 row_newbcast:1 row_mask:0xf bank_mask:0x3
  v_add_u32_dpp v26, v9, v14 row_newbcast:2 row_mask:0xf bank_mask:0x3
  v_mfma_f32_16x16x32_bf16 v[216:219], v[156:159], v[84:87], v[216:219]
  s_add_u32 m0, s75, 0
  s_nop 0
  buffer_load_dwordx4 v13, s[44:47], s74 offen lds
  s_add_u32 s74, s74, 212992
  s_xor_b32 s75, s75, 16384
  v_add_u32_dpp v27, v9, v15 row_newbcast:3 row_mask:0xf bank_mask:0x3
  v_add_u32_dpp v24, v9, v14 row_newbcast:8 row_mask:0xf bank_mask:0xc
  v_mfma_f32_16x16x32_bf16 v[220:223], v[152:155], v[88:91], v[220:223]
  v_add_u32_dpp v25, v9, v15 row_newbcast:9 row_mask:0xf bank_mask:0xc
  v_add_u32_dpp v26, v9, v14 row_newbcast:10 row_mask:0xf bank_mask:0xc
  v_mfma_f32_16x16x32_bf16 v[220:223], v[156:159], v[92:95], v[220:223]
  v_add_u32_dpp v27, v9, v15 row_newbcast:11 row_mask:0xf bank_mask:0xc
  s_cmp_lt_u32 s73, 27
  s_cbranch_scc1 L_rem_loop
  s_waitcnt vmcnt(9)
  s_barrier
  s_waitcnt lgkmcnt(8)
  v_mfma_f32_16x16x32_bf16 v[160:163], v[96:99], v[64:67], v[160:163]
  ds_read_b128 v[92:95], v12 offset:6144
  ds_read_b128 v[88:91], v11 offset:6144
  v_mfma_f32_16x16x32_bf16 v[160:163], v[100:103], v[68:71], v[160:163]
  ds_read_b128 v[84:87], v12 offset:4096
  buffer_load_dwordx2 v[224:225], v248, s[48:51], 0 offen offset:3200
  v_mfma_f32_16x16x32_bf16 v[164:167], v[96:99], v[72:75], v[164:167]
  ds_read_b128 v[80:83], v11 offset:4096
  buffer_load_dwordx2 v[226:227], v248, s[48:51], 0 offen offset:3232
  v_mfma_f32_16x16x32_bf16 v[164:167], v[100:103], v[76:79], v[164:167]
  ds_read_b64_tr_b16 v[128:129], v1 offset:8192
  v_mfma_f32_16x16x32_bf16 v[176:179], v[104:107], v[64:67], v[176:179]
  ds_read_b64_tr_b16 v[130:131], v1 offset:8704
  buffer_load_dwordx2 v[228:229], v248, s[48:51], 0 offen offset:3264
  v_mfma_f32_16x16x32_bf16 v[176:179], v[108:111], v[68:71], v[176:179]
  ds_read_b64_tr_b16 v[132:133], v1 offset:12288
  v_mfma_f32_16x16x32_bf16 v[180:183], v[104:107], v[72:75], v[180:183]
  ds_read_b64_tr_b16 v[134:135], v1 offset:12800
  buffer_load_dwordx2 v[230:231], v248, s[48:51], 0 offen offset:3296
  v_mfma_f32_16x16x32_bf16 v[180:183], v[108:111], v[76:79], v[180:183]
  ds_read_b64_tr_b16 v[136:137], v2 offset:8192
  buffer_load_dwordx2 v[232:233], v248, s[52:55], 0 offen offset:3200
  s_waitcnt lgkmcnt(14)
  v_mfma_f32_16x16x32_bf16 v[192:195], v[112:115], v[64:67], v[192:195]
  ds_read_b64_tr_b16 v[138:139], v2 offset:8704
  s_waitcnt lgkmcnt(14)
  v_mfma_f32_16x16x32_bf16 v[192:195], v[116:119], v[68:71], v[192:195]
  ds_read_b64_tr_b16 v[140:141], v2 offset:12288
  buffer_load_dwordx2 v[234:235], v248, s[52:55], 0 offen offset:3232
  v_mfma_f32_16x16x32_bf16 v[196:199], v[112:115], v[72:75], v[196:199]
  ds_read_b64_tr_b16 v[142:143], v2 offset:12800
  v_mfma_f32_16x16x32_bf16 v[196:199], v[116:119], v[76:79], v[196:199]
  buffer_load_dwordx2 v[236:237], v248, s[52:55], 0 offen offset:3264
  s_waitcnt lgkmcnt(14)
  v_mfma_f32_16x16x32_bf16 v[208:211], v[120:123], v[64:67], v[208:211]
  buffer_load_dwordx2 v[238:239], v248, s[52:55], 0 offen offset:3296
  s_waitcnt lgkmcnt(12)
  v_mfma_f32_16x16x32_bf16 v[208:211], v[124:127], v[68:71], v[208:211]
  v_mfma_f32_16x16x32_bf16 v[212:215], v[120:123], v[72:75], v[212:215]
  buffer_load_dword v255, v3, s[56:59], s77 offen
  v_mfma_f32_16x16x32_bf16 v[212:215], v[124:127], v[76:79], v[212:215]
  s_waitcnt vmcnt(14)
  s_waitcnt lgkmcnt(8)
  v_mfma_f32_16x16x32_bf16 v[168:171], v[96:99], v[80:83], v[168:171]
  ds_read_b128 v[76:79], v12 offset:10240
  ds_read_b128 v[72:75], v11 offset:10240
  v_mfma_f32_16x16x32_bf16 v[168:171], v[100:103], v[84:87], v[168:171]
  ds_read_b128 v[68:71], v12 offset:8192
  v_mfma_f32_16x16x32_bf16 v[172:175], v[96:99], v[88:91], v[172:175]
  ds_read_b128 v[64:67], v11 offset:8192
  v_mfma_f32_16x16x32_bf16 v[172:175], v[100:103], v[92:95], v[172:175]
  ds_read_b64_tr_b16 v[144:145], v7 offset:8192
  v_mfma_f32_16x16x32_bf16 v[184:187], v[104:107], v[80:83], v[184:187]
  ds_read_b64_tr_b16 v[146:147], v7 offset:8704
  v_mfma_f32_16x16x32_bf16 v[184:187], v[108:111], v[84:87], v[184:187]
  ds_read_b64_tr_b16 v[148:149], v7 offset:12288
  v_mfma_f32_16x16x32_bf16 v[188:191], v[104:107], v[88:91], v[188:191]
  ds_read_b64_tr_b16 v[150:151], v7 offset:12800
  v_mfma_f32_16x16x32_bf16 v[188:191], v[108:111], v[92:95], v[188:191]
  ds_read_b64_tr_b16 v[152:153], v8 offset:8192
  v_mfma_f32_16x16x32_bf16 v[200:203], v[112:115], v[80:83], v[200:203]
  ds_read_b64_tr_b16 v[154:155], v8 offset:8704
  v_mfma_f32_16x16x32_bf16 v[200:203], v[116:119], v[84:87], v[200:203]
  ds_read_b64_tr_b16 v[156:157], v8 offset:12288
  v_mfma_f32_16x16x32_bf16 v[204:207], v[112:115], v[88:91], v[204:207]
  ds_read_b64_tr_b16 v[158:159], v8 offset:12800
  v_mfma_f32_16x16x32_bf16 v[204:207], v[116:119], v[92:95], v[204:207]
  v_mfma_f32_16x16x32_bf16 v[216:219], v[120:123], v[80:83], v[216:219]
  v_mfma_f32_16x16x32_bf16 v[216:219], v[124:127], v[84:87], v[216:219]
  v_mfma_f32_16x16x32_bf16 v[220:223], v[120:123], v[88:91], v[220:223]
  v_mfma_f32_16x16x32_bf16 v[220:223], v[124:127], v[92:95], v[220:223]
  s_waitcnt vmcnt(10)
  s_waitcnt lgkmcnt(8)
  v_mfma_f32_16x16x32_bf16 v[160:163], v[128:131], v[64:67], v[160:163]
  ds_read_b128 v[92:95], v12 offset:14336
  v_mfma_f32_16x16x32_bf16 v[160:163], v[132:135], v[68:71], v[160:163]
  v_mfma_f32_16x16x32_bf16 v[164:167], v[128:131], v[72:75], v[164:167]
  ds_read_b128 v[88:91], v11 offset:14336
  v_mfma_f32_16x16x32_bf16 v[164:167], v[132:135], v[76:79], v[164:167]
  s_waitcnt vmcnt(4)
  v_lshlrev_b32 v48, 16, v232
  v_and_b32 v49, 0xffff0000, v232
  v_mfma_f32_16x16x32_bf16 v[176:179], v[136:139], v[64:67], v[176:179]
  v_lshlrev_b32 v50, 16, v233
  v_and_b32 v51, 0xffff0000, v233
  v_mfma_f32_16x16x32_bf16 v[176:179], v[140:143], v[68:71], v[176:179]
  ds_read_b128 v[84:87], v12 offset:12288
  s_waitcnt vmcnt(3)
  v_lshlrev_b32 v52, 16, v234
  v_and_b32 v53, 0xffff0000, v234
  v_mfma_f32_16x16x32_bf16 v[180:183], v[136:139], v[72:75], v[180:183]
  v_lshlrev_b32 v54, 16, v235
  v_and_b32 v55, 0xffff0000, v235
  v_mfma_f32_16x16x32_bf16 v[180:183], v[140:143], v[76:79], v[180:183]
  s_waitcnt vmcnt(2)
  v_lshlrev_b32 v56, 16, v236
  v_and_b32 v57, 0xffff0000, v236
  s_waitcnt lgkmcnt(9)
  v_mfma_f32_16x16x32_bf16 v[192:195], v[144:147], v[64:67], v[192:195]
  ds_read_b128 v[80:83], v11 offset:12288
  v_lshlrev_b32 v58, 16, v237
  s_waitcnt lgkmcnt(8)
  v_mfma_f32_16x16x32_bf16 v[192:195], v[148:151], v[68:71], v[192:195]
  v_and_b32 v59, 0xffff0000, v237
  s_waitcnt vmcnt(1)
  v_lshlrev_b32 v60, 16, v238
  v_mfma_f32_16x16x32_bf16 v[196:199], v[144:147], v[72:75], v[196:199]
  v_and_b32 v61, 0xffff0000, v238
  v_lshlrev_b32 v62, 16, v239
  v_mfma_f32_16x16x32_bf16 v[196:199], v[148:151], v[76:79], v[196:199]
  v_and_b32 v63, 0xffff0000, v239
  v_lshlrev_b32 v32, 16, v224
  s_waitcnt lgkmcnt(6)
  v_mfma_f32_16x16x32_bf16 v[208:211], v[152:155], v[64:67], v[208:211]
  v_and_b32 v33, 0xffff0000, v224
  v_lshlrev_b32 v34, 16, v225
  s_waitcnt lgkmcnt(4)
  v_mfma_f32_16x16x32_bf16 v[208:211], v[156:159], v[68:71], v[208:211]
  v_and_b32 v35, 0xffff0000, v225
  v_lshlrev_b32 v36, 16, v226
  v_mfma_f32_16x16x32_bf16 v[212:215], v[152:155], v[72:75], v[212:215]
  v_and_b32 v37, 0xffff0000, v226
  v_mfma_f32_16x16x32_bf16 v[212:215], v[156:159], v[76:79], v[212:215]
  s_waitcnt lgkmcnt(0)
  v_mfma_f32_16x16x32_bf16 v[168:171], v[128:131], v[80:83], v[168:171]
  v_lshlrev_b32 v38, 16, v227
  v_and_b32 v39, 0xffff0000, v227
  v_mfma_f32_16x16x32_bf16 v[168:171], v[132:135], v[84:87], v[168:171]
  v_lshlrev_b32 v40, 16, v228
  v_mfma_f32_16x16x32_bf16 v[172:175], v[128:131], v[88:91], v[172:175]
  v_and_b32 v41, 0xffff0000, v228
  v_mfma_f32_16x16x32_bf16 v[172:175], v[132:135], v[92:95], v[172:175]
  v_lshlrev_b32 v42, 16, v229
  v_mfma_f32_16x16x32_bf16 v[184:187], v[136:139], v[80:83], v[184:187]
  v_and_b32 v43, 0xffff0000, v229
  v_lshlrev_b32 v44, 16, v230
  v_mfma_f32_16x16x32_bf16 v[184:187], v[140:143], v[84:87], v[184:187]
  v_and_b32 v45, 0xffff0000, v230
  v_mfma_f32_16x16x32_bf16 v[188:191], v[136:139], v[88:91], v[188:191]
  v_lshlrev_b32 v46, 16, v231
  v_mfma_f32_16x16x32_bf16 v[188:191], v[140:143], v[92:95], v[188:191]
  v_and_b32 v47, 0xffff0000, v231
  v_mfma_f32_16x16x32_bf16 v[200:203], v[144:147], v[80:83], v[200:203]
  v_rcp_f32 v48, v48
  v_rcp_f32 v49, v49
  v_mfma_f32_16x16x32_bf16 v[200:203], v[148:151], v[84:87], v[200:203]
  v_rcp_f32 v50, v50
  v_mfma_f32_16x16x32_bf16 v[204:207], v[144:147], v[88:91], v[204:207]
  v_rcp_f32 v51, v51
  v_mfma_f32_16x16x32_bf16 v[204:207], v[148:151], v[92:95], v[204:207]
  v_rcp_f32 v52, v52
  v_mfma_f32_16x16x32_bf16 v[216:219], v[152:155], v[80:83], v[216:219]
  v_rcp_f32 v53, v53
  v_rcp_f32 v54, v54
  v_mfma_f32_16x16x32_bf16 v[216:219], v[156:159], v[84:87], v[216:219]
  v_rcp_f32 v55, v55
  v_mfma_f32_16x16x32_bf16 v[220:223], v[152:155], v[88:91], v[220:223]
  v_rcp_f32 v56, v56
  v_mfma_f32_16x16x32_bf16 v[220:223], v[156:159], v[92:95], v[220:223]
  v_rcp_f32 v57, v57
L_repi:
  v_rcp_f32 v58, v58
  v_rcp_f32 v59, v59
  v_rcp_f32 v60, v60
  v_rcp_f32 v61, v61
  v_rcp_f32 v62, v62
  v_rcp_f32 v63, v63
  v_med3_f32 v48, v48, -v244, v244
  v_med3_f32 v49, v49, -v244, v244
  v_med3_f32 v50, v50, -v244, v244
  v_med3_f32 v51, v51, -v244, v244
  v_med3_f32 v52, v52, -v244, v244
  v_med3_f32 v53, v53, -v244, v244
  v_med3_f32 v54, v54, -v244, v244
  v_med3_f32 v55, v55, -v244, v244
  v_med3_f32 v56, v56, -v244, v244
  v_med3_f32 v57, v57, -v244, v244
  v_med3_f32 v58, v58, -v244, v244
  v_med3_f32 v59, v59, -v244, v244
  v_med3_f32 v60, v60, -v244, v244
  v_med3_f32 v61, v61, -v244, v244
  v_med3_f32 v62, v62, -v244, v244
  v_med3_f32 v63, v63, -v244, v244
  v_pk_add_f32 v[160:161], v[160:161], v[32:33]
  v_pk_add_f32 v[162:163], v[162:163], v[34:35]
  v_pk_add_f32 v[164:165], v[164:165], v[32:33]
  v_pk_add_f32 v[166:167], v[166:167], v[34:35]
  v_pk_add_f32 v[168:169], v[168:169], v[32:33]
  v_pk_add_f32 v[170:171], v[170:171], v[34:35]
  v_pk_add_f32 v[172:173], v[172:173], v[32:33]
  v_pk_add_f32 v[174:175], v[174:175], v[34:35]
  v_pk_add_f32 v[176:177], v[176:177], v[36:37]
  v_pk_add_f32 v[178:179], v[178:179], v[38:39]
  v_pk_add_f32 v[180:181], v[180:181], v[36:37]
  v_pk_add_f32 v[182:183], v[182:183], v[38:39]
  v_pk_add_f32 v[184:185], v[184:185], v[36:37]
  v_pk_add_f32 v[186:187], v[186:187], v[38:39]
  v_pk_add_f32 v[188:189], v[188:189], v[36:37]
  v_pk_add_f32 v[190:191], v[190:191], v[38:39]
  v_pk_add_f32 v[192:193], v[192:193], v[40:41]
  v_pk_add_f32 v[194:195], v[194:195], v[42:43]
  v_pk_add_f32 v[196:197], v[196:197], v[40:41]
  v_pk_add_f32 v[198:199], v[198:199], v[42:43]
  v_pk_add_f32 v[200:201], v[200:201], v[40:41]
  v_pk_add_f32 v[202:203], v[202:203], v[42:43]
  v_pk_add_f32 v[204:205], v[204:205], v[40:41]
  v_pk_add_f32 v[206:207], v[206:207], v[42:43]
  v_pk_add_f32 v[208:209], v[208:209], v[44:45]
  v_pk_add_f32 v[210:211], v[210:211], v[46:47]
  v_pk_add_f32 v[212:213], v[212:213], v[44:45]
  v_pk_add_f32 v[214:215], v[214:215], v[46:47]
  v_pk_add_f32 v[216:217], v[216:217], v[44:45]
  v_pk_add_f32 v[218:219], v[218:219], v[46:47]
  v_pk_add_f32 v[220:221], v[220:221], v[44:45]
  v_pk_add_f32 v[222:223], v[222:223], v[46:47]
  v_pk_mul_f32 v[64:65], v[160:161], v[160:161]
  v_pk_mul_f32 v[68:69], v[164:165], v[164:165]
  v_pk_mul_f32 v[72:73], v[168:169], v[168:169]
  v_pk_mul_f32 v[76:77], v[172:173], v[172:173]
  v_pk_fma_f32 v[64:65], v[64:65], v[242:243], v[240:241]
  v_pk_fma_f32 v[68:69], v[68:69], v[242:243], v[240:241]
  v_pk_fma_f32 v[72:73], v[72:73], v[242:243], v[240:241]
  v_pk_fma_f32 v[76:77], v[76:77], v[242:243], v[240:241]
  v_pk_mul_f32 v[64:65], v[64:65], v[160:161]
  v_pk_mul_f32 v[68:69], v[68:69], v[164:165]
  v_pk_mul_f32 v[72:73], v[72:73], v[168:169]
  v_pk_mul_f32 v[76:77], v[76:77], v[172:173]
  v_exp_f32 v64, v64
  v_exp_f32 v65, v65
  v_exp_f32 v68, v68
  v_exp_f32 v69, v69
  v_exp_f32 v72, v72
  v_exp_f32 v73, v73
  v_exp_f32 v76, v76
  v_exp_f32 v77, v77
  v_pk_fma_f32 v[64:65], v[64:65], v[48:49], v[48:49]
  v_pk_fma_f32 v[68:69], v[68:69], v[48:49], v[48:49]
  v_pk_fma_f32 v[72:73], v[72:73], v[48:49], v[48:49]
  v_pk_fma_f32 v[76:77], v[76:77], v[48:49], v[48:49]
  v_rcp_f32 v64, v64
  v_rcp_f32 v65, v65
  v_rcp_f32 v68, v68
  v_rcp_f32 v69, v69
  v_rcp_f32 v72, v72
  v_rcp_f32 v73, v73
  v_rcp_f32 v76, v76
  v_rcp_f32 v77, v77
  v_pk_mul_f32 v[16:17], v[64:65], v[160:161]
  v_pk_mul_f32 v[18:19], v[68:69], v[164:165]
  v_pk_mul_f32 v[20:21], v[72:73], v[168:169]
  v_pk_mul_f32 v[22:23], v[76:77], v[172:173]
  v_pk_mul_f32 v[80:81], v[162:163], v[162:163]
  v_pk_mul_f32 v[84:85], v[166:167], v[166:167]
  v_pk_mul_f32 v[88:89], v[170:171], v[170:171]
  v_pk_mul_f32 v[92:93], v[174:175], v[174:175]
  v_pk_fma_f32 v[80:81], v[80:81], v[242:243], v[240:241]
  v_pk_fma_f32 v[84:85], v[84:85], v[242:243], v[240:241]
  v_pk_fma_f32 v[88:89], v[88:89], v[242:243], v[240:241]
  v_pk_fma_f32 v[92:93], v[92:93], v[242:243], v[240:241]
  v_pk_mul_f32 v[80:81], v[80:81], v[162:163]
  v_pk_mul_f32 v[84:85], v[84:85], v[166:167]
  v_pk_mul_f32 v[88:89], v[88:89], v[170:171]
  v_pk_mul_f32 v[92:93], v[92:93], v[174:175]
  v_exp_f32 v80, v80
  v_exp_f32 v81, v81
  v_exp_f32 v84, v84
  v_exp_f32 v85, v85
  v_exp_f32 v88, v88
  v_exp_f32 v89, v89
  v_exp_f32 v92, v92
  v_exp_f32 v93, v93
  v_pk_fma_f32 v[80:81], v[80:81], v[50:51], v[50:51]
  v_pk_fma_f32 v[84:85], v[84:85], v[50:51], v[50:51]
  v_pk_fma_f32 v[88:89], v[88:89], v[50:51], v[50:51]
  v_pk_fma_f32 v[92:93], v[92:93], v[50:51], v[50:51]
  v_rcp_f32 v80, v80
  v_rcp_f32 v81, v81
  v_rcp_f32 v84, v84
  v_rcp_f32 v85, v85
  v_rcp_f32 v88, v88
  v_rcp_f32 v89, v89
  v_rcp_f32 v92, v92
  v_rcp_f32 v93, v93
  v_pk_fma_f32 v[16:17], v[80:81], v[162:163], v[16:17]
  v_pk_fma_f32 v[18:19], v[84:85], v[166:167], v[18:19]
  v_pk_fma_f32 v[20:21], v[88:89], v[170:171], v[20:21]
  v_pk_fma_f32 v[22:23], v[92:93], v[174:175], v[22:23]
  v_pk_mul_f32 v[64:65], v[176:177], v[176:177]
  v_pk_mul_f32 v[68:69], v[180:181], v[180:181]
  v_pk_mul_f32 v[72:73], v[184:185], v[184:185]
  v_pk_mul_f32 v[76:77], v[188:189], v[188:189]
  v_pk_fma_f32 v[64:65], v[64:65], v[242:243], v[240:241]
  v_pk_fma_f32 v[68:69], v[68:69], v[242:243], v[240:241]
  v_pk_fma_f32 v[72:73], v[72:73], v[242:243], v[240:241]
  v_pk_fma_f32 v[76:77], v[76:77], v[242:243], v[240:241]
  v_pk_mul_f32 v[64:65], v[64:65], v[176:177]
  v_pk_mul_f32 v[68:69], v[68:69], v[180:181]
  v_pk_mul_f32 v[72:73], v[72:73], v[184:185]
  v_pk_mul_f32 v[76:77], v[76:77], v[188:189]
  v_exp_f32 v64, v64
  v_exp_f32 v65, v65
  v_exp_f32 v68, v68
  v_exp_f32 v69, v69
  v_exp_f32 v72, v72
  v_exp_f32 v73, v73
  v_exp_f32 v76, v76
  v_exp_f32 v77, v77
  v_pk_fma_f32 v[64:65], v[64:65], v[52:53], v[52:53]
  v_pk_fma_f32 v[68:69], v[68:69], v[52:53], v[52:53]
  v_pk_fma_f32 v[72:73], v[72:73], v[52:53], v[52:53]
  v_pk_fma_f32 v[76:77], v[76:77], v[52:53], v[52:53]
  v_rcp_f32 v64, v64
  v_rcp_f32 v65, v65
  v_rcp_f32 v68, v68
  v_rcp_f32 v69, v69
  v_rcp_f32 v72, v72
  v_rcp_f32 v73, v73
  v_rcp_f32 v76, v76
  v_rcp_f32 v77, v77
  v_pk_fma_f32 v[16:17], v[64:65], v[176:177], v[16:17]
  v_pk_fma_f32 v[18:19], v[68:69], v[180:181], v[18:19]
  v_pk_fma_f32 v[20:21], v[72:73], v[184:185], v[20:21]
  v_pk_fma_f32 v[22:23], v[76:77], v[188:189], v[22:23]
  v_pk_mul_f32 v[80:81], v[178:179], v[178:179]
  v_pk_mul_f32 v[84:85], v[182:183], v[182:183]
  v_pk_mul_f32 v[88:89], v[186:187], v[186:187]
  v_pk_mul_f32 v[92:93], v[190:191], v[190:191]
  v_pk_fma_f32 v[80:81], v[80:81], v[242:243], v[240:241]
  v_pk_fma_f32 v[84:85], v[84:85], v[242:243], v[240:241]
  v_pk_fma_f32 v[88:89], v[88:89], v[242:243], v[240:241]
  v_pk_fma_f32 v[92:93], v[92:93], v[242:243], v[240:241]
  v_pk_mul_f32 v[80:81], v[80:81], v[178:179]
  v_pk_mul_f32 v[84:85], v[84:85], v[182:183]
  v_pk_mul_f32 v[88:89], v[88:89], v[186:187]
  v_pk_mul_f32 v[92:93], v[92:93], v[190:191]
  v_exp_f32 v80, v80
  v_exp_f32 v81, v81
  v_exp_f32 v84, v84
  v_exp_f32 v85, v85
  v_exp_f32 v88, v88
  v_exp_f32 v89, v89
  v_exp_f32 v92, v92
  v_exp_f32 v93, v93
  v_pk_fma_f32 v[80:81], v[80:81], v[54:55], v[54:55]
  v_pk_fma_f32 v[84:85], v[84:85], v[54:55], v[54:55]
  v_pk_fma_f32 v[88:89], v[88:89], v[54:55], v[54:55]
  v_pk_fma_f32 v[92:93], v[92:93], v[54:55], v[54:55]
  v_rcp_f32 v80, v80
  v_rcp_f32 v81, v81
  v_rcp_f32 v84, v84
  v_rcp_f32 v85, v85
  v_rcp_f32 v88, v88
  v_rcp_f32 v89, v89
  v_rcp_f32 v92, v92
  v_rcp_f32 v93, v93
  v_pk_fma_f32 v[16:17], v[80:81], v[178:179], v[16:17]
  v_pk_fma_f32 v[18:19], v[84:85], v[182:183], v[18:19]
  v_pk_fma_f32 v[20:21], v[88:89], v[186:187], v[20:21]
  v_pk_fma_f32 v[22:23], v[92:93], v[190:191], v[22:23]
  v_pk_mul_f32 v[64:65], v[192:193], v[192:193]
  v_pk_mul_f32 v[68:69], v[196:197], v[196:197]
  v_pk_mul_f32 v[72:73], v[200:201], v[200:201]
  v_pk_mul_f32 v[76:77], v[204:205], v[204:205]
  v_pk_fma_f32 v[64:65], v[64:65], v[242:243], v[240:241]
  v_pk_fma_f32 v[68:69], v[68:69], v[242:243], v[240:241]
  v_pk_fma_f32 v[72:73], v[72:73], v[242:243], v[240:241]
  v_pk_fma_f32 v[76:77], v[76:77], v[242:243], v[240:241]
  v_pk_mul_f32 v[64:65], v[64:65], v[192:193]
  v_pk_mul_f32 v[68:69], v[68:69], v[196:197]
  v_pk_mul_f32 v[72:73], v[72:73], v[200:201]
  v_pk_mul_f32 v[76:77], v[76:77], v[204:205]
  v_exp_f32 v64, v64
  v_exp_f32 v65, v65
  v_exp_f32 v68, v68
  v_exp_f32 v69, v69
  v_exp_f32 v72, v72
  v_exp_f32 v73, v73
  v_exp_f32 v76, v76
  v_exp_f32 v77, v77
  v_pk_fma_f32 v[64:65], v[64:65], v[56:57], v[56:57]
  v_pk_fma_f32 v[68:69], v[68:69], v[56:57], v[56:57]
  v_pk_fma_f32 v[72:73], v[72:73], v[56:57], v[56:57]
  v_pk_fma_f32 v[76:77], v[76:77], v[56:57], v[56:57]
  v_rcp_f32 v64, v64
  v_rcp_f32 v65, v65
  v_rcp_f32 v68, v68
  v_rcp_f32 v69, v69
  v_rcp_f32 v72, v72
  v_rcp_f32 v73, v73
  v_rcp_f32 v76, v76
  v_rcp_f32 v77, v77
  v_pk_fma_f32 v[16:17], v[64:65], v[192:193], v[16:17]
  v_pk_fma_f32 v[18:19], v[68:69], v[196:197], v[18:19]
  v_pk_fma_f32 v[20:21], v[72:73], v[200:201], v[20:21]
  v_pk_fma_f32 v[22:23], v[76:77], v[204:205], v[22:23]
  v_pk_mul_f32 v[80:81], v[194:195], v[194:195]
  v_pk_mul_f32 v[84:85], v[198:199], v[198:199]
  v_pk_mul_f32 v[88:89], v[202:203], v[202:203]
  v_pk_mul_f32 v[92:93], v[206:207], v[206:207]
  v_pk_fma_f32 v[80:81], v[80:81], v[242:243], v[240:241]
  v_pk_fma_f32 v[84:85], v[84:85], v[242:243], v[240:241]
  v_pk_fma_f32 v[88:89], v[88:89], v[242:243], v[240:241]
  v_pk_fma_f32 v[92:93], v[92:93], v[242:243], v[240:241]
  v_pk_mul_f32 v[80:81], v[80:81], v[194:195]
  v_pk_mul_f32 v[84:85], v[84:85], v[198:199]
  v_pk_mul_f32 v[88:89], v[88:89], v[202:203]
  v_pk_mul_f32 v[92:93], v[92:93], v[206:207]
  v_exp_f32 v80, v80
  v_exp_f32 v81, v81
  v_exp_f32 v84, v84
  v_exp_f32 v85, v85
  v_exp_f32 v88, v88
  v_exp_f32 v89, v89
  v_exp_f32 v92, v92
  v_exp_f32 v93, v93
  v_pk_fma_f32 v[80:81], v[80:81], v[58:59], v[58:59]
  v_pk_fma_f32 v[84:85], v[84:85], v[58:59], v[58:59]
  v_pk_fma_f32 v[88:89], v[88:89], v[58:59], v[58:59]
  v_pk_fma_f32 v[92:93], v[92:93], v[58:59], v[58:59]
  v_rcp_f32 v80, v80
  v_rcp_f32 v81, v81
  v_rcp_f32 v84, v84
  v_rcp_f32 v85, v85
  v_rcp_f32 v88, v88
  v_rcp_f32 v89, v89
  v_rcp_f32 v92, v92
  v_rcp_f32 v93, v93
  v_pk_fma_f32 v[16:17], v[80:81], v[194:195], v[16:17]
  v_pk_fma_f32 v[18:19], v[84:85], v[198:199], v[18:19]
  v_pk_fma_f32 v[20:21], v[88:89], v[202:203], v[20:21]
  v_pk_fma_f32 v[22:23], v[92:93], v[206:207], v[22:23]
  buffer_load_dword v128, v3, s[60:63], s68 offen offset:0 sc1
  buffer_load_dword v129, v3, s[60:63], s68 offen offset:2048 sc1
  buffer_load_dword v130, v3, s[60:63], s69 offen offset:0 sc1
  buffer_load_dword v131, v3, s[60:63], s69 offen offset:2048 sc1
  buffer_load_dword v132, v3, s[60:63], s71 offen offset:0 sc1
  buffer_load_dword v133, v3, s[60:63], s71 offen offset:2048 sc1
  buffer_load_dword v134, v5, s[60:63], s71 offen sc1
  v_pk_mul_f32 v[64:65], v[208:209], v[208:209]
  v_pk_mul_f32 v[68:69], v[212:213], v[212:213]
  v_pk_mul_f32 v[72:73], v[216:217], v[216:217]
  v_pk_mul_f32 v[76:77], v[220:221], v[220:221]
  v_pk_fma_f32 v[64:65], v[64:65], v[242:243], v[240:241]
  v_pk_fma_f32 v[68:69], v[68:69], v[242:243], v[240:241]
  v_pk_fma_f32 v[72:73], v[72:73], v[242:243], v[240:241]
  v_pk_fma_f32 v[76:77], v[76:77], v[242:243], v[240:241]
  v_pk_mul_f32 v[64:65], v[64:65], v[208:209]
  v_pk_mul_f32 v[68:69], v[68:69], v[212:213]
  v_pk_mul_f32 v[72:73], v[72:73], v[216:217]
  v_pk_mul_f32 v[76:77], v[76:77], v[220:221]
  v_exp_f32 v64, v64
  v_exp_f32 v65, v65
  v_exp_f32 v68, v68
  v_exp_f32 v69, v69
  v_exp_f32 v72, v72
  v_exp_f32 v73, v73
  v_exp_f32 v76, v76
  v_exp_f32 v77, v77
  v_pk_fma_f32 v[64:65], v[64:65], v[60:61], v[60:61]
  v_pk_fma_f32 v[68:69], v[68:69], v[60:61], v[60:61]
  v_pk_fma_f32 v[72:73], v[72:73], v[60:61], v[60:61]
  v_pk_fma_f32 v[76:77], v[76:77], v[60:61], v[60:61]
  v_rcp_f32 v64, v64
  v_rcp_f32 v65, v65
  v_rcp_f32 v68, v68
  v_rcp_f32 v69, v69
  v_rcp_f32 v72, v72
  v_rcp_f32 v73, v73
  v_rcp_f32 v76, v76
  v_rcp_f32 v77, v77
  v_pk_fma_f32 v[16:17], v[64:65], v[208:209], v[16:17]
  v_pk_fma_f32 v[18:19], v[68:69], v[212:213], v[18:19]
  v_pk_fma_f32 v[20:21], v[72:73], v[216:217], v[20:21]
  v_pk_fma_f32 v[22:23], v[76:77], v[220:221], v[22:23]
  v_pk_mul_f32 v[80:81], v[210:211], v[210:211]
  v_pk_mul_f32 v[84:85], v[214:215], v[214:215]
  v_pk_mul_f32 v[88:89], v[218:219], v[218:219]
  v_pk_mul_f32 v[92:93], v[222:223], v[222:223]
  v_pk_fma_f32 v[80:81], v[80:81], v[242:243], v[240:241]
  v_pk_fma_f32 v[84:85], v[84:85], v[242:243], v[240:241]
  v_pk_fma_f32 v[88:89], v[88:89], v[242:243], v[240:241]
  v_pk_fma_f32 v[92:93], v[92:93], v[242:243], v[240:241]
  v_pk_mul_f32 v[80:81], v[80:81], v[210:211]
  v_pk_mul_f32 v[84:85], v[84:85], v[214:215]
  v_pk_mul_f32 v[88:89], v[88:89], v[218:219]
  v_pk_mul_f32 v[92:93], v[92:93], v[222:223]
  v_exp_f32 v80, v80
  v_exp_f32 v81, v81
  v_exp_f32 v84, v84
  v_exp_f32 v85, v85
  v_exp_f32 v88, v88
  v_exp_f32 v89, v89
  v_exp_f32 v92, v92
  v_exp_f32 v93, v93
  v_pk_fma_f32 v[80:81], v[80:81], v[62:63], v[62:63]
  v_pk_fma_f32 v[84:85], v[84:85], v[62:63], v[62:63]
  v_pk_fma_f32 v[88:89], v[88:89], v[62:63], v[62:63]
  v_pk_fma_f32 v[92:93], v[92:93], v[62:63], v[62:63]
  v_rcp_f32 v80, v80
  v_rcp_f32 v81, v81
  v_rcp_f32 v84, v84
  v_rcp_f32 v85, v85
  v_rcp_f32 v88, v88
  v_rcp_f32 v89, v89
  v_rcp_f32 v92, v92
  v_rcp_f32 v93, v93
  v_pk_fma_f32 v[16:17], v[80:81], v[210:211], v[16:17]
  v_pk_fma_f32 v[18:19], v[84:85], v[214:215], v[18:19]
  v_pk_fma_f32 v[20:21], v[88:89], v[218:219], v[20:21]
  v_pk_fma_f32 v[22:23], v[92:93], v[222:223], v[22:23]
  v_add_f32 v16, v16, v17
  v_add_f32 v18, v18, v19
  v_add_f32 v20, v20, v21
  v_add_f32 v22, v22, v23
  s_nop 0
  v_permlane32_swap_b32 v16, v20
  v_permlane32_swap_b32 v18, v22
  v_add_f32 v16, v16, v20
  v_add_f32 v18, v18, v22
  s_nop 1
  v_permlane16_swap_b32 v16, v18
  v_add_f32 v16, v16, v18
  v_add_f32 v16, s80, v16
L_rclr:
  s_mov_b32 s72, 0x40000
  s_branch L_pchk
L_poll:
  s_sub_u32 s72, s72, 1
  s_cbranch_scc1 L_pollx
  buffer_load_dword v128, v3, s[60:63], s68 offen offset:0 sc1
  buffer_load_dword v129, v3, s[60:63], s68 offen offset:2048 sc1
  buffer_load_dword v130, v3, s[60:63], s69 offen offset:0 sc1
  buffer_load_dword v131, v3, s[60:63], s69 offen offset:2048 sc1
  buffer_load_dword v132, v3, s[60:63], s71 offen offset:0 sc1
  buffer_load_dword v133, v3, s[60:63], s71 offen offset:2048 sc1
  buffer_load_dword v134, v5, s[60:63], s71 offen sc1
L_pchk:
  s_waitcnt vmcnt(0)
  v_max3_u32 v136, v128, v129, v130
  v_max3_u32 v137, v131, v132, v133
  v_max3_u32 v136, v136, v137, v134
  v_cmp_eq_u32 vcc, -1, v136
  s_cbranch_vccnz L_poll
L_pollx:
  v_add_f32 v128, v128, v129
  v_add_f32 v130, v130, v131
  v_add_f32 v132, v132, v133
  v_add_f32 v16, v16, v134
  v_add_f32 v128, v128, v130
  v_add_f32 v132, v132, v16
  v_add_f32 v128, v128, v132
  v_cvt_pk_bf16_f32 v128, v128, v128
  buffer_store_short v128, v4, s[56:59], s77 offen
  s_endpgm
L_end:
  s_endpgm
.section .rodata,"a"
.p2align 6
.amdhsa_kernel standalone__deep_cross_xdeepfm__recsys_kernel
  .amdhsa_next_free_vgpr 256
  .amdhsa_next_free_sgpr 102
  .amdhsa_accum_offset 256
  .amdhsa_group_segment_fixed_size 0
  .amdhsa_kernarg_size 88
  .amdhsa_user_sgpr_count 2
  .amdhsa_user_sgpr_kernarg_segment_ptr 1
  .amdhsa_system_sgpr_workgroup_id_x 1
  .amdhsa_float_denorm_mode_32 3
.end_amdhsa_kernel
```

```asm
; @launch grid=(256,1,1) block=(512,1,1) lds=163840
.amdgcn_target "amdgcn-amd-amdhsa--gfx950"
.text
.globl standalone__deep_cross_xdeepfm__recsys_kernel
.p2align 8
.type standalone__deep_cross_xdeepfm__recsys_kernel,@function
standalone__deep_cross_xdeepfm__recsys_kernel:
  s_cmp_ge_u32 s2, 256
  s_cbranch_scc1 L_end
  s_load_dwordx16 s[4:19], s[0:1], 0
  s_load_dwordx4 s[20:23], s[0:1], 64
  s_load_dwordx2 s[24:25], s[0:1], 80
  v_lshrrev_b32 v1, 6, v0
  s_getpc_b64 s[92:93]
L_pc:
  s_and_b32 s68, s2, 0xf8
  v_add_u32 v2, s68, v1
  v_lshlrev_b32 v2, 7, v2
  v_and_b32 v3, 1, v0
  v_lshl_add_u32 v2, v3, 15, v2
  v_min_u32 v2, L_end-L_pc, v2
  v_mov_b32 v3, s93
  v_add_co_u32 v2, vcc, s92, v2
  s_nop 1
  v_addc_co_u32 v3, vcc, 0, v3, vcc
  global_load_dword v255, v[2:3], off
  v_and_b32 v0, 63, v0
  v_readfirstlane_b32 s3, v1
  s_and_b32 s68, s2, 7
  s_lshl_b32 s68, s68, 2
  s_lshr_b32 s26, s2, 6
  s_add_u32 s26, s26, s68
  s_bfe_u32 s27, s2, 0x30003
  s_and_b32 s80, s2, 0xf8
  s_add_u32 s80, s80, s3
  s_lshl_b32 s80, s80, 21
  s_lshr_b32 s68, s2, 3
  s_cmp_eq_u32 s68, 5
  s_cbranch_scc1 L_rem
  s_cmp_ge_u32 s27, 5
  s_cbranch_scc1 L_cin
  s_mul_i32 s77, s27, 640
  s_mul_i32 s70, s3, 7
  v_min_u32 v64, 6, v0
  v_add_u32 v64, s70, v64
  v_min_u32 v64, 51, v64
  v_lshrrev_b32 v62, 1, v64
  v_mul_u32_u24 v62, 96, v62
  v_lshl_add_u32 v64, v64, 2, v62
  s_mul_i32 s78, s27, 26
  s_min_u32 s78, s78, 102
  s_lshl_b32 s71, s26, 7
  s_add_u32 s78, s78, s71
  s_mul_i32 s78, s78, 104
  s_and_b32 s70, s26, 3
  s_lshl_b32 s70, s70, 3
  s_add_u32 s70, s70, s3
  s_mul_i32 s70, s70, 3328
  s_add_u32 s81, s70, s77
  v_min_u32 v56, 15, v0
  v_lshrrev_b32 v62, 3, v56
  s_mov_b32 s70, 106496
  v_mul_u32_u24 v62, s70, v62
  v_and_b32 v56, 7, v56
  v_min_u32 v56, 4, v56
  v_lshl_add_u32 v56, v56, 7, v62
  s_xor_b32 s70, s3, 4
  s_lshl_b32 s70, s70, 4
  s_add_u32 s70, s70, s71
  v_lshrrev_b32 v60, 3, v0
  v_add_u32 v60, s70, v60
  v_mul_u32_u24 v13, 104, v60
  s_waitcnt lgkmcnt(0)
  s_mov_b32 s28, s4
  s_and_b32 s29, s5, 0xffff
  s_mov_b32 s30, 425984
  s_mov_b32 s31, 0x20000
  buffer_load_dwordx3 v[52:54], v64, s[28:31], s78 offen
  buffer_load_dwordx2 v[44:45], v13, s[28:31], 0 offen offset:0
  buffer_load_dwordx2 v[48:49], v13, s[28:31], 0 offen offset:832
  s_mov_b32 s32, s6
  s_and_b32 s33, s7, 0xffff
  s_mov_b32 s34, 12800000
  s_mov_b32 s35, 0x20000
  v_mov_b32 v68, s80
  buffer_load_dword v255, v68, s[32:35], 0 offen
  v_lshlrev_b32 v37, 4, v0
  s_mov_b32 s48, s14
  s_and_b32 s49, s15, 0xffff
  s_mov_b32 s50, 3328
  s_mov_b32 s51, 0x20000
  s_mov_b32 s44, s12
  s_and_b32 s45, s13, 0xffff
  s_mov_b32 s46, 5537792
  s_mov_b32 s47, 0x20000
  buffer_load_dword v255, v56, s[44:47], s81 offen
  s_mov_b32 m0, 155648
  s_mov_b32 exec_hi, 0xff
  buffer_load_dwordx4 v37, s[48:51], s77 offen lds
  s_mov_b64 exec, -1
  s_lshr_b32 s68, s3, 2
  s_and_b32 s69, s3, 3
  s_mov_b32 s70, 1639
  s_and_b32 s78, s69, 1
  s_lshl_b32 s78, s78, 2
  s_mov_b32 s81, 3328
  v_mov_b32 v60, v0
  v_mul_u32_u24 v61, s70, v60
  v_lshrrev_b32 v61, 16, v61
  v_mul_u32_u24 v64, 40, v61
  v_sub_u32 v64, v60, v64
  v_and_b32 v63, 2, v61
  v_or_b32 v63, s78, v63
  v_xor_b32 v64, v64, v63
  v_mul_u32_u24 v61, s81, v61
  v_lshl_add_u32 v29, v64, 4, v61
  v_add_u32 v60, 64, v60
  v_mul_u32_u24 v61, s70, v60
  v_lshrrev_b32 v61, 16, v61
  v_mul_u32_u24 v64, 40, v61
  v_sub_u32 v64, v60, v64
  v_and_b32 v63, 2, v61
  v_or_b32 v63, s78, v63
  v_xor_b32 v64, v64, v63
  v_mul_u32_u24 v61, s81, v61
  v_lshl_add_u32 v30, v64, 4, v61
  v_subrev_u32 v30, 1024, v30
  v_add_u32 v60, 64, v60
  v_mul_u32_u24 v61, s70, v60
  v_lshrrev_b32 v61, 16, v61
  v_mul_u32_u24 v64, 40, v61
  v_sub_u32 v64, v60, v64
  v_and_b32 v63, 2, v61
  v_or_b32 v63, s78, v63
  v_xor_b32 v64, v64, v63
  v_mul_u32_u24 v61, s81, v61
  v_lshl_add_u32 v31, v64, 4, v61
  v_subrev_u32 v31, 2048, v31
  v_add_u32 v60, 64, v60
  v_mul_u32_u24 v61, s70, v60
  v_lshrrev_b32 v61, 16, v61
  v_mul_u32_u24 v64, 40, v61
  v_sub_u32 v64, v60, v64
  v_and_b32 v63, 2, v61
  v_or_b32 v63, s78, v63
  v_xor_b32 v64, v64, v63
  v_mul_u32_u24 v61, s81, v61
  v_lshl_add_u32 v32, v64, 4, v61
  v_subrev_u32 v32, 3072, v32
  v_add_u32 v60, 64, v60
  v_mul_u32_u24 v61, s70, v60
  v_lshrrev_b32 v61, 16, v61
  v_mul_u32_u24 v64, 40, v61
  v_sub_u32 v64, v60, v64
  v_and_b32 v63, 2, v61
  v_or_b32 v63, s78, v63
  v_xor_b32 v64, v64, v63
  v_mul_u32_u24 v61, s81, v61
  v_lshl_add_u32 v33, v64, 4, v61
  s_mul_i32 s70, s3, 26624
  s_add_u32 s74, s70, s77
  s_mul_i32 s75, s3, 5120
  s_add_u32 s75, s75, 32768
  s_lshl_b32 s71, s68, 14
  s_lshl_b32 s76, s69, 11
  s_add_u32 s76, s76, s71
  s_xor_b32 s76, s76, 16384
  v_and_b32 v64, 7, v0
  v_lshrrev_b32 v62, 4, v0
  v_xor_b32 v64, v64, v62
  v_lshlrev_b32 v14, 4, v64
  v_xor_b32 v15, 64, v14
  v_and_b32 v64, 15, v0
  v_lshlrev_b32 v64, 7, v64
  s_lshl_b32 s71, s68, 14
  v_bfe_u32 v63, v0, 1, 3
  v_xor_b32 v63, v63, v62
  v_lshl_add_u32 v64, v63, 4, v64
  v_add_u32 v11, s71, v64
  v_xor_b32 v12, 64, v11
  s_mov_b32 s52, s16
  s_and_b32 s53, s17, 0xffff
  s_mov_b32 s54, 3328
  s_mov_b32 s55, 0x20000
  s_mul_i32 s71, s69, 5
  v_bfe_u32 v63, v0, 2, 2
  v_lshl_add_u32 v64, v62, 3, v63
  v_mul_u32_u24 v64, 640, v64
  v_and_b32 v63, 3, v0
  v_lshl_add_u32 v64, v63, 3, v64
  v_add_u32 v64, 32768, v64
  v_bfe_u32 v63, v0, 3, 2
  v_xor_b32 v60, s71, v63
  v_lshl_add_u32 v1, v60, 5, v64
  v_add_u32 v6, 61440, v1
  s_add_u32 s71, s71, 1
  v_xor_b32 v60, s71, v63
  v_lshl_add_u32 v2, v60, 5, v64
  v_add_u32 v7, 61440, v2
  s_add_u32 s71, s71, 1
  v_xor_b32 v60, s71, v63
  v_lshl_add_u32 v3, v60, 5, v64
  v_add_u32 v8, 61440, v3
  s_add_u32 s71, s71, 1
  v_xor_b32 v60, s71, v63
  v_lshl_add_u32 v4, v60, 5, v64
  v_add_u32 v9, 61440, v4
  s_add_u32 s71, s71, 1
  v_xor_b32 v60, s71, v63
  v_lshl_add_u32 v5, v60, 5, v64
  v_add_u32 v10, 61440, v5
  s_add_u32 s71, s71, 1
  s_mul_i32 s71, s69, 160
  s_add_u32 s71, s71, 155648
  v_lshlrev_b32 v64, 3, v62
  v_add_u32 v35, s71, v64
  s_lshl_b32 s70, s69, 1
  s_add_u32 s70, s70, s68
  s_lshl_b32 s70, s70, 8
  s_add_u32 s70, s70, 156928
  v_lshlrev_b32 v36, 2, v0
  v_add_u32 v36, s70, v36
  s_add_u32 m0, s75, 0
  s_nop 0
  buffer_load_dwordx4 v29, s[44:47], s74 offen offset:0 lds
  buffer_load_dwordx4 v30, s[44:47], s74 offen offset:1024 lds
  buffer_load_dwordx4 v31, s[44:47], s74 offen offset:2048 lds
  buffer_load_dwordx4 v32, s[44:47], s74 offen offset:3072 lds
  s_add_u32 m0, m0, 4096
  s_nop 0
  buffer_load_dwordx4 v33, s[44:47], s74 offen offset:0 lds
  s_add_u32 s74, s74, 212992
  s_waitcnt vmcnt(10)
  v_lshlrev_b32 v52, 7, v52
  s_barrier
  buffer_load_dword v255, v52, s[32:35], 0 offen
  s_waitcnt vmcnt(9)
  v_lshl_add_u32 v34, v48, 7, v15
  v_lshl_add_u32 v28, v44, 7, v14
  s_add_u32 m0, s76, 0
  s_nop 0
  buffer_load_dwordx4 v28, s[32:35], 0 offen lds
  s_add_u32 m0, m0, 1024
  s_nop 0
  buffer_load_dwordx4 v34, s[32:35], 0 offen lds
  v_lshlrev_b32 v54, 7, v54
  buffer_load_dword v255, v54, s[32:35], 0 offen
  s_barrier
  s_waitcnt vmcnt(9)
  ds_read_b64 v[220:221], v35 offset:0
  ds_read_b64 v[222:223], v35 offset:32
  ds_read_b64 v[224:225], v35 offset:64
  ds_read_b64 v[226:227], v35 offset:96
  ds_read_b64 v[228:229], v35 offset:128
  s_waitcnt lgkmcnt(4)
  v_lshlrev_b32 v140, 16, v220
  v_and_b32 v141, 0xffff0000, v220
  v_lshlrev_b32 v142, 16, v221
  v_and_b32 v143, 0xffff0000, v221
  s_waitcnt lgkmcnt(3)
  v_lshlrev_b32 v156, 16, v222
  v_and_b32 v157, 0xffff0000, v222
  v_lshlrev_b32 v158, 16, v223
  v_and_b32 v159, 0xffff0000, v223
  s_waitcnt lgkmcnt(2)
  v_lshlrev_b32 v172, 16, v224
  v_and_b32 v173, 0xffff0000, v224
  v_lshlrev_b32 v174, 16, v225
  v_and_b32 v175, 0xffff0000, v225
  s_waitcnt lgkmcnt(1)
  v_lshlrev_b32 v188, 16, v226
  v_and_b32 v189, 0xffff0000, v226
  v_lshlrev_b32 v190, 16, v227
  v_and_b32 v191, 0xffff0000, v227
  s_waitcnt lgkmcnt(0)
  v_lshlrev_b32 v204, 16, v228
  v_and_b32 v205, 0xffff0000, v228
  v_lshlrev_b32 v206, 16, v229
  v_and_b32 v207, 0xffff0000, v229
  v_mov_b64 v[144:145], v[140:141]
  v_mov_b64 v[146:147], v[142:143]
  v_mov_b64 v[148:149], v[140:141]
  v_mov_b64 v[150:151], v[142:143]
  v_mov_b64 v[152:153], v[140:141]
  v_mov_b64 v[154:155], v[142:143]
  v_mov_b64 v[160:161], v[156:157]
  v_mov_b64 v[162:163], v[158:159]
  v_mov_b64 v[164:165], v[156:157]
  v_mov_b64 v[166:167], v[158:159]
  v_mov_b64 v[168:169], v[156:157]
  v_mov_b64 v[170:171], v[158:159]
  v_mov_b64 v[176:177], v[172:173]
  v_mov_b64 v[178:179], v[174:175]
  v_mov_b64 v[180:181], v[172:173]
  v_mov_b64 v[182:183], v[174:175]
  v_mov_b64 v[184:185], v[172:173]
  v_mov_b64 v[186:187], v[174:175]
  v_mov_b64 v[192:193], v[188:189]
  v_mov_b64 v[194:195], v[190:191]
  v_mov_b64 v[196:197], v[188:189]
  v_mov_b64 v[198:199], v[190:191]
  v_mov_b64 v[200:201], v[188:189]
  v_mov_b64 v[202:203], v[190:191]
  v_mov_b64 v[208:209], v[204:205]
  v_mov_b64 v[210:211], v[206:207]
  v_mov_b64 v[212:213], v[204:205]
  v_mov_b64 v[214:215], v[206:207]
  v_mov_b64 v[216:217], v[204:205]
  v_mov_b64 v[218:219], v[206:207]
  s_lshl_b32 s73, s68, 2
  s_add_u32 s73, s73, 4
  buffer_load_dwordx3 v[16:18], v13, s[28:31], s73 offen offset:0
  buffer_load_dwordx3 v[20:22], v13, s[28:31], s73 offen offset:832
  s_add_u32 s73, s73, 12
  s_mov_b32 s72, 0
  s_cmp_lg_u32 s68, 0
  s_cbranch_scc1 L_dnn_h1
L_dnn_h0:
  s_add_u32 m0, s75, 40960
  s_nop 0
  buffer_load_dwordx4 v29, s[44:47], s74 offen offset:0 lds
  buffer_load_dwordx4 v30, s[44:47], s74 offen offset:1024 lds
  buffer_load_dwordx4 v31, s[44:47], s74 offen offset:2048 lds
  buffer_load_dwordx4 v32, s[44:47], s74 offen offset:3072 lds
  s_add_u32 m0, m0, 4096
  s_nop 0
  buffer_load_dwordx4 v33, s[44:47], s74 offen offset:0 lds
  s_add_u32 s74, s74, 212992
  s_waitcnt vmcnt(11) lgkmcnt(0)
  s_barrier
  buffer_load_dwordx3 v[24:26], v13, s[28:31], s73 offen offset:0
  buffer_load_dwordx3 v[240:242], v13, s[28:31], s73 offen offset:832
  s_add_u32 s73, s73, 12
L_dnn_loop0:
  ds_read_b64_tr_b16 v[40:41], v1 offset:0
  s_add_u32 m0, s75, 81920
  s_nop 0
  buffer_load_dwordx4 v29, s[44:47], s74 offen offset:0 lds
  ds_read_b64_tr_b16 v[42:43], v1 offset:2560
  ds_read_b64_tr_b16 v[44:45], v1 offset:20480
  ds_read_b64_tr_b16 v[46:47], v1 offset:23040
  ds_read_b64_tr_b16 v[48:49], v2 offset:0
  buffer_load_dwordx4 v30, s[44:47], s74 offen offset:1024 lds
  ds_read_b64_tr_b16 v[50:51], v2 offset:2560
  ds_read_b64_tr_b16 v[52:53], v2 offset:20480
  ds_read_b64_tr_b16 v[54:55], v2 offset:23040
  ds_read_b64_tr_b16 v[56:57], v3 offset:0
  buffer_load_dwordx4 v31, s[44:47], s74 offen offset:2048 lds
  ds_read_b64_tr_b16 v[58:59], v3 offset:2560
  ds_read_b64_tr_b16 v[60:61], v3 offset:20480
  ds_read_b64_tr_b16 v[62:63], v3 offset:23040
  ds_read_b64_tr_b16 v[64:65], v4 offset:0
  buffer_load_dwordx4 v32, s[44:47], s74 offen offset:3072 lds
  ds_read_b64_tr_b16 v[66:67], v4 offset:2560
  ds_read_b64_tr_b16 v[68:69], v4 offset:20480
  ds_read_b64_tr_b16 v[70:71], v4 offset:23040
  ds_read_b128 v[80:83], v11 offset:0
  s_add_u32 m0, m0, 4096
  s_nop 0
  buffer_load_dwordx4 v33, s[44:47], s74 offen offset:0 lds
  s_add_u32 s74, s74, 212992
  ds_read_b128 v[84:87], v12 offset:0
  ds_read_b128 v[88:91], v11 offset:2048
  ds_read_b128 v[92:95], v12 offset:2048
  ds_read_b128 v[96:99], v11 offset:4096
  s_waitcnt vmcnt(12)
  v_lshl_add_u32 v34, v20, 7, v15
  v_lshl_add_u32 v28, v16, 7, v14
  s_add_u32 m0, s76, 8192
  s_nop 0
  buffer_load_dwordx4 v28, s[32:35], 0 offen lds
  ds_read_b128 v[100:103], v12 offset:4096
  ds_read_b128 v[104:107], v11 offset:6144
  ds_read_b128 v[108:111], v12 offset:6144
  ds_read_b64_tr_b16 v[72:73], v5 offset:0
  s_add_u32 m0, m0, 1024
  s_nop 0
  buffer_load_dwordx4 v34, s[32:35], 0 offen lds
  ds_read_b64_tr_b16 v[74:75], v5 offset:2560
  ds_read_b64_tr_b16 v[76:77], v5 offset:20480
  ds_read_b64_tr_b16 v[78:79], v5 offset:23040
  s_waitcnt vmcnt(9) lgkmcnt(0)
  s_barrier
  s_setprio 0
  v_mfma_f32_16x16x32_bf16 v[140:143], v[40:43], v[80:83], v[140:143]
  v_mfma_f32_16x16x32_bf16 v[140:143], v[44:47], v[84:87], v[140:143]
  v_mfma_f32_16x16x32_bf16 v[144:147], v[40:43], v[88:91], v[144:147]
  v_mfma_f32_16x16x32_bf16 v[144:147], v[44:47], v[92:95], v[144:147]
  v_mfma_f32_16x16x32_bf16 v[148:151], v[40:43], v[96:99], v[148:151]
  v_mfma_f32_16x16x32_bf16 v[148:151], v[44:47], v[100:103], v[148:151]
  v_mfma_f32_16x16x32_bf16 v[152:155], v[40:43], v[104:107], v[152:155]
  v_mfma_f32_16x16x32_bf16 v[152:155], v[44:47], v[108:111], v[152:155]
  v_mfma_f32_16x16x32_bf16 v[168:171], v[48:51], v[104:107], v[168:171]
  v_mfma_f32_16x16x32_bf16 v[168:171], v[52:55], v[108:111], v[168:171]
  v_mfma_f32_16x16x32_bf16 v[164:167], v[48:51], v[96:99], v[164:167]
  v_mfma_f32_16x16x32_bf16 v[164:167], v[52:55], v[100:103], v[164:167]
  v_mfma_f32_16x16x32_bf16 v[160:163], v[48:51], v[88:91], v[160:163]
  v_mfma_f32_16x16x32_bf16 v[160:163], v[52:55], v[92:95], v[160:163]
  v_mfma_f32_16x16x32_bf16 v[156:159], v[48:51], v[80:83], v[156:159]
  v_mfma_f32_16x16x32_bf16 v[156:159], v[52:55], v[84:87], v[156:159]
  v_mfma_f32_16x16x32_bf16 v[172:175], v[56:59], v[80:83], v[172:175]
  v_mfma_f32_16x16x32_bf16 v[172:175], v[60:63], v[84:87], v[172:175]
  v_mfma_f32_16x16x32_bf16 v[176:179], v[56:59], v[88:91], v[176:179]
  v_mfma_f32_16x16x32_bf16 v[176:179], v[60:63], v[92:95], v[176:179]
  v_mfma_f32_16x16x32_bf16 v[180:183], v[56:59], v[96:99], v[180:183]
  v_mfma_f32_16x16x32_bf16 v[180:183], v[60:63], v[100:103], v[180:183]
  v_mfma_f32_16x16x32_bf16 v[184:187], v[56:59], v[104:107], v[184:187]
  v_mfma_f32_16x16x32_bf16 v[184:187], v[60:63], v[108:111], v[184:187]
  v_mfma_f32_16x16x32_bf16 v[200:203], v[64:67], v[104:107], v[200:203]
  v_mfma_f32_16x16x32_bf16 v[200:203], v[68:71], v[108:111], v[200:203]
  v_mfma_f32_16x16x32_bf16 v[196:199], v[64:67], v[96:99], v[196:199]
  v_mfma_f32_16x16x32_bf16 v[196:199], v[68:71], v[100:103], v[196:199]
  v_mfma_f32_16x16x32_bf16 v[192:195], v[64:67], v[88:91], v[192:195]
  v_mfma_f32_16x16x32_bf16 v[192:195], v[68:71], v[92:95], v[192:195]
  v_mfma_f32_16x16x32_bf16 v[188:191], v[64:67], v[80:83], v[188:191]
  v_mfma_f32_16x16x32_bf16 v[188:191], v[68:71], v[84:87], v[188:191]
  v_mfma_f32_16x16x32_bf16 v[204:207], v[72:75], v[80:83], v[204:207]
  v_mfma_f32_16x16x32_bf16 v[204:207], v[76:79], v[84:87], v[204:207]
  v_mfma_f32_16x16x32_bf16 v[208:211], v[72:75], v[88:91], v[208:211]
  v_mfma_f32_16x16x32_bf16 v[208:211], v[76:79], v[92:95], v[208:211]
  v_mfma_f32_16x16x32_bf16 v[212:215], v[72:75], v[96:99], v[212:215]
  v_mfma_f32_16x16x32_bf16 v[212:215], v[76:79], v[100:103], v[212:215]
  v_mfma_f32_16x16x32_bf16 v[216:219], v[72:75], v[104:107], v[216:219]
  s_setprio 2
  s_waitcnt vmcnt(9)
  s_barrier
  v_mfma_f32_16x16x32_bf16 v[216:219], v[76:79], v[108:111], v[216:219]
  ds_read_b64_tr_b16 v[40:41], v1 offset:40960
  s_add_u32 m0, s75, 0
  s_nop 0
  buffer_load_dwordx4 v29, s[44:47], s74 offen offset:0 lds
  ds_read_b64_tr_b16 v[42:43], v1 offset:43520
  ds_read_b64_tr_b16 v[44:45], v6 offset:0
  ds_read_b64_tr_b16 v[46:47], v6 offset:2560
  ds_read_b64_tr_b16 v[48:49], v2 offset:40960
  buffer_load_dwordx4 v30, s[44:47], s74 offen offset:1024 lds
  ds_read_b64_tr_b16 v[50:51], v2 offset:43520
  ds_read_b64_tr_b16 v[52:53], v7 offset:0
  ds_read_b64_tr_b16 v[54:55], v7 offset:2560
  ds_read_b64_tr_b16 v[56:57], v3 offset:40960
  buffer_load_dwordx4 v31, s[44:47], s74 offen offset:2048 lds
  ds_read_b64_tr_b16 v[58:59], v3 offset:43520
  ds_read_b64_tr_b16 v[60:61], v8 offset:0
  ds_read_b64_tr_b16 v[62:63], v8 offset:2560
  ds_read_b64_tr_b16 v[64:65], v4 offset:40960
  buffer_load_dwordx4 v32, s[44:47], s74 offen offset:3072 lds
  ds_read_b64_tr_b16 v[66:67], v4 offset:43520
  ds_read_b64_tr_b16 v[68:69], v9 offset:0
  ds_read_b64_tr_b16 v[70:71], v9 offset:2560
  ds_read_b128 v[80:83], v11 offset:8192
  s_add_u32 m0, m0, 4096
  s_nop 0
  buffer_load_dwordx4 v33, s[44:47], s74 offen offset:0 lds
  s_add_u32 s74, s74, 212992
  ds_read_b128 v[84:87], v12 offset:8192
  ds_read_b128 v[88:91], v11 offset:10240
  ds_read_b128 v[92:95], v12 offset:10240
  ds_read_b128 v[96:99], v11 offset:12288
  v_lshl_add_u32 v34, v21, 7, v15
  v_lshl_add_u32 v28, v17, 7, v14
  s_add_u32 m0, s76, 0
  s_nop 0
  buffer_load_dwordx4 v28, s[32:35], 0 offen lds
  ds_read_b128 v[100:103], v12 offset:12288
  ds_read_b128 v[104:107], v11 offset:14336
  ds_read_b128 v[108:111], v12 offset:14336
  ds_read_b64_tr_b16 v[72:73], v5 offset:40960
  s_add_u32 m0, m0, 1024
  s_nop 0
  buffer_load_dwordx4 v34, s[32:35], 0 offen lds
  ds_read_b64_tr_b16 v[74:75], v5 offset:43520
  ds_read_b64_tr_b16 v[76:77], v10 offset:0
  ds_read_b64_tr_b16 v[78:79], v10 offset:2560
  s_waitcnt vmcnt(7) lgkmcnt(0)
  s_barrier
  s_setprio 0
  v_mfma_f32_16x16x32_bf16 v[140:143], v[40:43], v[80:83], v[140:143]
  v_mfma_f32_16x16x32_bf16 v[140:143], v[44:47], v[84:87], v[140:143]
  v_mfma_f32_16x16x32_bf16 v[144:147], v[40:43], v[88:91], v[144:147]
  v_mfma_f32_16x16x32_bf16 v[144:147], v[44:47], v[92:95], v[144:147]
  v_mfma_f32_16x16x32_bf16 v[148:151], v[40:43], v[96:99], v[148:151]
  v_mfma_f32_16x16x32_bf16 v[148:151], v[44:47], v[100:103], v[148:151]
  v_mfma_f32_16x16x32_bf16 v[152:155], v[40:43], v[104:107], v[152:155]
  v_mfma_f32_16x16x32_bf16 v[152:155], v[44:47], v[108:111], v[152:155]
  v_mfma_f32_16x16x32_bf16 v[168:171], v[48:51], v[104:107], v[168:171]
  v_mfma_f32_16x16x32_bf16 v[168:171], v[52:55], v[108:111], v[168:171]
  v_mfma_f32_16x16x32_bf16 v[164:167], v[48:51], v[96:99], v[164:167]
  v_mfma_f32_16x16x32_bf16 v[164:167], v[52:55], v[100:103], v[164:167]
  v_mfma_f32_16x16x32_bf16 v[160:163], v[48:51], v[88:91], v[160:163]
  v_mfma_f32_16x16x32_bf16 v[160:163], v[52:55], v[92:95], v[160:163]
  v_mfma_f32_16x16x32_bf16 v[156:159], v[48:51], v[80:83], v[156:159]
  v_mfma_f32_16x16x32_bf16 v[156:159], v[52:55], v[84:87], v[156:159]
  v_mfma_f32_16x16x32_bf16 v[172:175], v[56:59], v[80:83], v[172:175]
  v_mfma_f32_16x16x32_bf16 v[172:175], v[60:63], v[84:87], v[172:175]
  v_mfma_f32_16x16x32_bf16 v[176:179], v[56:59], v[88:91], v[176:179]
  v_mfma_f32_16x16x32_bf16 v[176:179], v[60:63], v[92:95], v[176:179]
  v_mfma_f32_16x16x32_bf16 v[180:183], v[56:59], v[96:99], v[180:183]
  v_mfma_f32_16x16x32_bf16 v[180:183], v[60:63], v[100:103], v[180:183]
  v_mfma_f32_16x16x32_bf16 v[184:187], v[56:59], v[104:107], v[184:187]
  v_mfma_f32_16x16x32_bf16 v[184:187], v[60:63], v[108:111], v[184:187]
  v_mfma_f32_16x16x32_bf16 v[200:203], v[64:67], v[104:107], v[200:203]
  v_mfma_f32_16x16x32_bf16 v[200:203], v[68:71], v[108:111], v[200:203]
  v_mfma_f32_16x16x32_bf16 v[196:199], v[64:67], v[96:99], v[196:199]
  v_mfma_f32_16x16x32_bf16 v[196:199], v[68:71], v[100:103], v[196:199]
  v_mfma_f32_16x16x32_bf16 v[192:195], v[64:67], v[88:91], v[192:195]
  v_mfma_f32_16x16x32_bf16 v[192:195], v[68:71], v[92:95], v[192:195]
  v_mfma_f32_16x16x32_bf16 v[188:191], v[64:67], v[80:83], v[188:191]
  v_mfma_f32_16x16x32_bf16 v[188:191], v[68:71], v[84:87], v[188:191]
  v_mfma_f32_16x16x32_bf16 v[204:207], v[72:75], v[80:83], v[204:207]
  v_mfma_f32_16x16x32_bf16 v[204:207], v[76:79], v[84:87], v[204:207]
  v_mfma_f32_16x16x32_bf16 v[208:211], v[72:75], v[88:91], v[208:211]
  v_mfma_f32_16x16x32_bf16 v[208:211], v[76:79], v[92:95], v[208:211]
  v_mfma_f32_16x16x32_bf16 v[212:215], v[72:75], v[96:99], v[212:215]
  v_mfma_f32_16x16x32_bf16 v[212:215], v[76:79], v[100:103], v[212:215]
  v_mfma_f32_16x16x32_bf16 v[216:219], v[72:75], v[104:107], v[216:219]
  s_setprio 2
  s_barrier
  v_mfma_f32_16x16x32_bf16 v[216:219], v[76:79], v[108:111], v[216:219]
  ds_read_b64_tr_b16 v[40:41], v6 offset:20480
  s_add_u32 m0, s75, 40960
  s_nop 0
  buffer_load_dwordx4 v29, s[44:47], s74 offen offset:0 lds
  ds_read_b64_tr_b16 v[42:43], v6 offset:23040
  ds_read_b64_tr_b16 v[44:45], v6 offset:40960
  ds_read_b64_tr_b16 v[46:47], v6 offset:43520
  ds_read_b64_tr_b16 v[48:49], v7 offset:20480
  buffer_load_dwordx4 v30, s[44:47], s74 offen offset:1024 lds
  ds_read_b64_tr_b16 v[50:51], v7 offset:23040
  ds_read_b64_tr_b16 v[52:53], v7 offset:40960
  ds_read_b64_tr_b16 v[54:55], v7 offset:43520
  ds_read_b64_tr_b16 v[56:57], v8 offset:20480
  buffer_load_dwordx4 v31, s[44:47], s74 offen offset:2048 lds
  ds_read_b64_tr_b16 v[58:59], v8 offset:23040
  ds_read_b64_tr_b16 v[60:61], v8 offset:40960
  ds_read_b64_tr_b16 v[62:63], v8 offset:43520
  ds_read_b64_tr_b16 v[64:65], v9 offset:20480
  buffer_load_dwordx4 v32, s[44:47], s74 offen offset:3072 lds
  ds_read_b64_tr_b16 v[66:67], v9 offset:23040
  ds_read_b64_tr_b16 v[68:69], v9 offset:40960
  ds_read_b64_tr_b16 v[70:71], v9 offset:43520
  ds_read_b128 v[80:83], v11 offset:0
  s_add_u32 m0, m0, 4096
  s_nop 0
  buffer_load_dwordx4 v33, s[44:47], s74 offen offset:0 lds
  s_add_u32 s74, s74, 212992
  ds_read_b128 v[84:87], v12 offset:0
  ds_read_b128 v[88:91], v11 offset:2048
  ds_read_b128 v[92:95], v12 offset:2048
  ds_read_b128 v[96:99], v11 offset:4096
  v_lshl_add_u32 v34, v22, 7, v15
  v_lshl_add_u32 v28, v18, 7, v14
  s_add_u32 m0, s76, 8192
  s_nop 0
  buffer_load_dwordx4 v28, s[32:35], 0 offen lds
  ds_read_b128 v[100:103], v12 offset:4096
  ds_read_b128 v[104:107], v11 offset:6144
  ds_read_b128 v[108:111], v12 offset:6144
  ds_read_b64_tr_b16 v[72:73], v10 offset:20480
  s_add_u32 m0, m0, 1024
  s_nop 0
  buffer_load_dwordx4 v34, s[32:35], 0 offen lds
  ds_read_b64_tr_b16 v[74:75], v10 offset:23040
  ds_read_b64_tr_b16 v[76:77], v10 offset:40960
  ds_read_b64_tr_b16 v[78:79], v10 offset:43520
  buffer_load_dwordx3 v[16:18], v13, s[28:31], s73 offen offset:0
  buffer_load_dwordx3 v[20:22], v13, s[28:31], s73 offen offset:832
  s_add_u32 s73, s73, 12
  s_waitcnt vmcnt(9) lgkmcnt(0)
  s_barrier
  s_setprio 0
  v_mfma_f32_16x16x32_bf16 v[140:143], v[40:43], v[80:83], v[140:143]
  v_mfma_f32_16x16x32_bf16 v[140:143], v[44:47], v[84:87], v[140:143]
  v_mfma_f32_16x16x32_bf16 v[144:147], v[40:43], v[88:91], v[144:147]
  v_mfma_f32_16x16x32_bf16 v[144:147], v[44:47], v[92:95], v[144:147]
  v_mfma_f32_16x16x32_bf16 v[148:151], v[40:43], v[96:99], v[148:151]
  v_mfma_f32_16x16x32_bf16 v[148:151], v[44:47], v[100:103], v[148:151]
  v_mfma_f32_16x16x32_bf16 v[152:155], v[40:43], v[104:107], v[152:155]
  v_mfma_f32_16x16x32_bf16 v[152:155], v[44:47], v[108:111], v[152:155]
  v_mfma_f32_16x16x32_bf16 v[168:171], v[48:51], v[104:107], v[168:171]
  v_mfma_f32_16x16x32_bf16 v[168:171], v[52:55], v[108:111], v[168:171]
  v_mfma_f32_16x16x32_bf16 v[164:167], v[48:51], v[96:99], v[164:167]
  v_mfma_f32_16x16x32_bf16 v[164:167], v[52:55], v[100:103], v[164:167]
  v_mfma_f32_16x16x32_bf16 v[160:163], v[48:51], v[88:91], v[160:163]
  v_mfma_f32_16x16x32_bf16 v[160:163], v[52:55], v[92:95], v[160:163]
  v_mfma_f32_16x16x32_bf16 v[156:159], v[48:51], v[80:83], v[156:159]
  v_mfma_f32_16x16x32_bf16 v[156:159], v[52:55], v[84:87], v[156:159]
  v_mfma_f32_16x16x32_bf16 v[172:175], v[56:59], v[80:83], v[172:175]
  v_mfma_f32_16x16x32_bf16 v[172:175], v[60:63], v[84:87], v[172:175]
  v_mfma_f32_16x16x32_bf16 v[176:179], v[56:59], v[88:91], v[176:179]
  v_mfma_f32_16x16x32_bf16 v[176:179], v[60:63], v[92:95], v[176:179]
  v_mfma_f32_16x16x32_bf16 v[180:183], v[56:59], v[96:99], v[180:183]
  v_mfma_f32_16x16x32_bf16 v[180:183], v[60:63], v[100:103], v[180:183]
  v_mfma_f32_16x16x32_bf16 v[184:187], v[56:59], v[104:107], v[184:187]
  v_mfma_f32_16x16x32_bf16 v[184:187], v[60:63], v[108:111], v[184:187]
  v_mfma_f32_16x16x32_bf16 v[200:203], v[64:67], v[104:107], v[200:203]
  v_mfma_f32_16x16x32_bf16 v[200:203], v[68:71], v[108:111], v[200:203]
  v_mfma_f32_16x16x32_bf16 v[196:199], v[64:67], v[96:99], v[196:199]
  v_mfma_f32_16x16x32_bf16 v[196:199], v[68:71], v[100:103], v[196:199]
  v_mfma_f32_16x16x32_bf16 v[192:195], v[64:67], v[88:91], v[192:195]
  v_mfma_f32_16x16x32_bf16 v[192:195], v[68:71], v[92:95], v[192:195]
  v_mfma_f32_16x16x32_bf16 v[188:191], v[64:67], v[80:83], v[188:191]
  v_mfma_f32_16x16x32_bf16 v[188:191], v[68:71], v[84:87], v[188:191]
  v_mfma_f32_16x16x32_bf16 v[204:207], v[72:75], v[80:83], v[204:207]
  v_mfma_f32_16x16x32_bf16 v[204:207], v[76:79], v[84:87], v[204:207]
  v_mfma_f32_16x16x32_bf16 v[208:211], v[72:75], v[88:91], v[208:211]
  v_mfma_f32_16x16x32_bf16 v[208:211], v[76:79], v[92:95], v[208:211]
  v_mfma_f32_16x16x32_bf16 v[212:215], v[72:75], v[96:99], v[212:215]
  v_mfma_f32_16x16x32_bf16 v[212:215], v[76:79], v[100:103], v[212:215]
  v_mfma_f32_16x16x32_bf16 v[216:219], v[72:75], v[104:107], v[216:219]
  s_setprio 2
  s_barrier
  v_mfma_f32_16x16x32_bf16 v[216:219], v[76:79], v[108:111], v[216:219]
  ds_read_b64_tr_b16 v[40:41], v1 offset:0
  s_add_u32 m0, s75, 81920
  s_nop 0
  buffer_load_dwordx4 v29, s[44:47], s74 offen offset:0 lds
  ds_read_b64_tr_b16 v[42:43], v1 offset:2560
  ds_read_b64_tr_b16 v[44:45], v1 offset:20480
  ds_read_b64_tr_b16 v[46:47], v1 offset:23040
  ds_read_b64_tr_b16 v[48:49], v2 offset:0
  buffer_load_dwordx4 v30, s[44:47], s74 offen offset:1024 lds
  ds_read_b64_tr_b16 v[50:51], v2 offset:2560
  ds_read_b64_tr_b16 v[52:53], v2 offset:20480
  ds_read_b64_tr_b16 v[54:55], v2 offset:23040
  ds_read_b64_tr_b16 v[56:57], v3 offset:0
  buffer_load_dwordx4 v31, s[44:47], s74 offen offset:2048 lds
  ds_read_b64_tr_b16 v[58:59], v3 offset:2560
  ds_read_b64_tr_b16 v[60:61], v3 offset:20480
  ds_read_b64_tr_b16 v[62:63], v3 offset:23040
  ds_read_b64_tr_b16 v[64:65], v4 offset:0
  buffer_load_dwordx4 v32, s[44:47], s74 offen offset:3072 lds
  ds_read_b64_tr_b16 v[66:67], v4 offset:2560
  ds_read_b64_tr_b16 v[68:69], v4 offset:20480
  ds_read_b64_tr_b16 v[70:71], v4 offset:23040
  ds_read_b128 v[80:83], v11 offset:8192
  s_add_u32 m0, m0, 4096
  s_nop 0
  buffer_load_dwordx4 v33, s[44:47], s74 offen offset:0 lds
  s_add_u32 s74, s74, 212992
  ds_read_b128 v[84:87], v12 offset:8192
  ds_read_b128 v[88:91], v11 offset:10240
  ds_read_b128 v[92:95], v12 offset:10240
  ds_read_b128 v[96:99], v11 offset:12288
  v_lshl_add_u32 v34, v240, 7, v15
  v_lshl_add_u32 v28, v24, 7, v14
  s_add_u32 m0, s76, 0
  s_nop 0
  buffer_load_dwordx4 v28, s[32:35], 0 offen lds
  ds_read_b128 v[100:103], v12 offset:12288
  ds_read_b128 v[104:107], v11 offset:14336
  ds_read_b128 v[108:111], v12 offset:14336
  ds_read_b64_tr_b16 v[72:73], v5 offset:0
  s_add_u32 m0, m0, 1024
  s_nop 0
  buffer_load_dwordx4 v34, s[32:35], 0 offen lds
  ds_read_b64_tr_b16 v[74:75], v5 offset:2560
  ds_read_b64_tr_b16 v[76:77], v5 offset:20480
  ds_read_b64_tr_b16 v[78:79], v5 offset:23040
  s_waitcnt vmcnt(9) lgkmcnt(0)
  s_barrier
  s_setprio 0
  v_mfma_f32_16x16x32_bf16 v[140:143], v[40:43], v[80:83], v[140:143]
  v_mfma_f32_16x16x32_bf16 v[140:143], v[44:47], v[84:87], v[140:143]
  v_mfma_f32_16x16x32_bf16 v[144:147], v[40:43], v[88:91], v[144:147]
  v_mfma_f32_16x16x32_bf16 v[144:147], v[44:47], v[92:95], v[144:147]
  v_mfma_f32_16x16x32_bf16 v[148:151], v[40:43], v[96:99], v[148:151]
  v_mfma_f32_16x16x32_bf16 v[148:151], v[44:47], v[100:103], v[148:151]
  v_mfma_f32_16x16x32_bf16 v[152:155], v[40:43], v[104:107], v[152:155]
  v_mfma_f32_16x16x32_bf16 v[152:155], v[44:47], v[108:111], v[152:155]
  v_mfma_f32_16x16x32_bf16 v[168:171], v[48:51], v[104:107], v[168:171]
  v_mfma_f32_16x16x32_bf16 v[168:171], v[52:55], v[108:111], v[168:171]
  v_mfma_f32_16x16x32_bf16 v[164:167], v[48:51], v[96:99], v[164:167]
  v_mfma_f32_16x16x32_bf16 v[164:167], v[52:55], v[100:103], v[164:167]
  v_mfma_f32_16x16x32_bf16 v[160:163], v[48:51], v[88:91], v[160:163]
  v_mfma_f32_16x16x32_bf16 v[160:163], v[52:55], v[92:95], v[160:163]
  v_mfma_f32_16x16x32_bf16 v[156:159], v[48:51], v[80:83], v[156:159]
  v_mfma_f32_16x16x32_bf16 v[156:159], v[52:55], v[84:87], v[156:159]
  v_mfma_f32_16x16x32_bf16 v[172:175], v[56:59], v[80:83], v[172:175]
  v_mfma_f32_16x16x32_bf16 v[172:175], v[60:63], v[84:87], v[172:175]
  v_mfma_f32_16x16x32_bf16 v[176:179], v[56:59], v[88:91], v[176:179]
  v_mfma_f32_16x16x32_bf16 v[176:179], v[60:63], v[92:95], v[176:179]
  v_mfma_f32_16x16x32_bf16 v[180:183], v[56:59], v[96:99], v[180:183]
  v_mfma_f32_16x16x32_bf16 v[180:183], v[60:63], v[100:103], v[180:183]
  v_mfma_f32_16x16x32_bf16 v[184:187], v[56:59], v[104:107], v[184:187]
  v_mfma_f32_16x16x32_bf16 v[184:187], v[60:63], v[108:111], v[184:187]
  v_mfma_f32_16x16x32_bf16 v[200:203], v[64:67], v[104:107], v[200:203]
  v_mfma_f32_16x16x32_bf16 v[200:203], v[68:71], v[108:111], v[200:203]
  v_mfma_f32_16x16x32_bf16 v[196:199], v[64:67], v[96:99], v[196:199]
  v_mfma_f32_16x16x32_bf16 v[196:199], v[68:71], v[100:103], v[196:199]
  v_mfma_f32_16x16x32_bf16 v[192:195], v[64:67], v[88:91], v[192:195]
  v_mfma_f32_16x16x32_bf16 v[192:195], v[68:71], v[92:95], v[192:195]
  v_mfma_f32_16x16x32_bf16 v[188:191], v[64:67], v[80:83], v[188:191]
  v_mfma_f32_16x16x32_bf16 v[188:191], v[68:71], v[84:87], v[188:191]
  v_mfma_f32_16x16x32_bf16 v[204:207], v[72:75], v[80:83], v[204:207]
  v_mfma_f32_16x16x32_bf16 v[204:207], v[76:79], v[84:87], v[204:207]
  v_mfma_f32_16x16x32_bf16 v[208:211], v[72:75], v[88:91], v[208:211]
  v_mfma_f32_16x16x32_bf16 v[208:211], v[76:79], v[92:95], v[208:211]
  v_mfma_f32_16x16x32_bf16 v[212:215], v[72:75], v[96:99], v[212:215]
  v_mfma_f32_16x16x32_bf16 v[212:215], v[76:79], v[100:103], v[212:215]
  v_mfma_f32_16x16x32_bf16 v[216:219], v[72:75], v[104:107], v[216:219]
  s_setprio 2
  s_barrier
  v_mfma_f32_16x16x32_bf16 v[216:219], v[76:79], v[108:111], v[216:219]
  ds_read_b64_tr_b16 v[40:41], v1 offset:40960
  s_add_u32 m0, s75, 0
  s_nop 0
  buffer_load_dwordx4 v29, s[44:47], s74 offen offset:0 lds
  ds_read_b64_tr_b16 v[42:43], v1 offset:43520
  ds_read_b64_tr_b16 v[44:45], v6 offset:0
  ds_read_b64_tr_b16 v[46:47], v6 offset:2560
  ds_read_b64_tr_b16 v[48:49], v2 offset:40960
  buffer_load_dwordx4 v30, s[44:47], s74 offen offset:1024 lds
  ds_read_b64_tr_b16 v[50:51], v2 offset:43520
  ds_read_b64_tr_b16 v[52:53], v7 offset:0
  ds_read_b64_tr_b16 v[54:55], v7 offset:2560
  ds_read_b64_tr_b16 v[56:57], v3 offset:40960
  buffer_load_dwordx4 v31, s[44:47], s74 offen offset:2048 lds
  ds_read_b64_tr_b16 v[58:59], v3 offset:43520
  ds_read_b64_tr_b16 v[60:61], v8 offset:0
  ds_read_b64_tr_b16 v[62:63], v8 offset:2560
  ds_read_b64_tr_b16 v[64:65], v4 offset:40960
  buffer_load_dwordx4 v32, s[44:47], s74 offen offset:3072 lds
  ds_read_b64_tr_b16 v[66:67], v4 offset:43520
  ds_read_b64_tr_b16 v[68:69], v9 offset:0
  ds_read_b64_tr_b16 v[70:71], v9 offset:2560
  ds_read_b128 v[80:83], v11 offset:0
  s_add_u32 m0, m0, 4096
  s_nop 0
  buffer_load_dwordx4 v33, s[44:47], s74 offen offset:0 lds
  s_add_u32 s74, s74, 212992
  ds_read_b128 v[84:87], v12 offset:0
  ds_read_b128 v[88:91], v11 offset:2048
  ds_read_b128 v[92:95], v12 offset:2048
  ds_read_b128 v[96:99], v11 offset:4096
  v_lshl_add_u32 v34, v241, 7, v15
  v_lshl_add_u32 v28, v25, 7, v14
  s_add_u32 m0, s76, 8192
  s_nop 0
  buffer_load_dwordx4 v28, s[32:35], 0 offen lds
  ds_read_b128 v[100:103], v12 offset:4096
  ds_read_b128 v[104:107], v11 offset:6144
  ds_read_b128 v[108:111], v12 offset:6144
  ds_read_b64_tr_b16 v[72:73], v5 offset:40960
  s_add_u32 m0, m0, 1024
  s_nop 0
  buffer_load_dwordx4 v34, s[32:35], 0 offen lds
  ds_read_b64_tr_b16 v[74:75], v5 offset:43520
  ds_read_b64_tr_b16 v[76:77], v10 offset:0
  ds_read_b64_tr_b16 v[78:79], v10 offset:2560
  s_waitcnt vmcnt(7) lgkmcnt(0)
  s_barrier
  s_setprio 0
  v_mfma_f32_16x16x32_bf16 v[140:143], v[40:43], v[80:83], v[140:143]
  v_mfma_f32_16x16x32_bf16 v[140:143], v[44:47], v[84:87], v[140:143]
  v_mfma_f32_16x16x32_bf16 v[144:147], v[40:43], v[88:91], v[144:147]
  v_mfma_f32_16x16x32_bf16 v[144:147], v[44:47], v[92:95], v[144:147]
  v_mfma_f32_16x16x32_bf16 v[148:151], v[40:43], v[96:99], v[148:151]
  v_mfma_f32_16x16x32_bf16 v[148:151], v[44:47], v[100:103], v[148:151]
  v_mfma_f32_16x16x32_bf16 v[152:155], v[40:43], v[104:107], v[152:155]
  v_mfma_f32_16x16x32_bf16 v[152:155], v[44:47], v[108:111], v[152:155]
  v_mfma_f32_16x16x32_bf16 v[168:171], v[48:51], v[104:107], v[168:171]
  v_mfma_f32_16x16x32_bf16 v[168:171], v[52:55], v[108:111], v[168:171]
  v_mfma_f32_16x16x32_bf16 v[164:167], v[48:51], v[96:99], v[164:167]
  v_mfma_f32_16x16x32_bf16 v[164:167], v[52:55], v[100:103], v[164:167]
  v_mfma_f32_16x16x32_bf16 v[160:163], v[48:51], v[88:91], v[160:163]
  v_mfma_f32_16x16x32_bf16 v[160:163], v[52:55], v[92:95], v[160:163]
  v_mfma_f32_16x16x32_bf16 v[156:159], v[48:51], v[80:83], v[156:159]
  v_mfma_f32_16x16x32_bf16 v[156:159], v[52:55], v[84:87], v[156:159]
  v_mfma_f32_16x16x32_bf16 v[172:175], v[56:59], v[80:83], v[172:175]
  v_mfma_f32_16x16x32_bf16 v[172:175], v[60:63], v[84:87], v[172:175]
  v_mfma_f32_16x16x32_bf16 v[176:179], v[56:59], v[88:91], v[176:179]
  v_mfma_f32_16x16x32_bf16 v[176:179], v[60:63], v[92:95], v[176:179]
  v_mfma_f32_16x16x32_bf16 v[180:183], v[56:59], v[96:99], v[180:183]
  v_mfma_f32_16x16x32_bf16 v[180:183], v[60:63], v[100:103], v[180:183]
  v_mfma_f32_16x16x32_bf16 v[184:187], v[56:59], v[104:107], v[184:187]
  v_mfma_f32_16x16x32_bf16 v[184:187], v[60:63], v[108:111], v[184:187]
  v_mfma_f32_16x16x32_bf16 v[200:203], v[64:67], v[104:107], v[200:203]
  v_mfma_f32_16x16x32_bf16 v[200:203], v[68:71], v[108:111], v[200:203]
  v_mfma_f32_16x16x32_bf16 v[196:199], v[64:67], v[96:99], v[196:199]
  v_mfma_f32_16x16x32_bf16 v[196:199], v[68:71], v[100:103], v[196:199]
  v_mfma_f32_16x16x32_bf16 v[192:195], v[64:67], v[88:91], v[192:195]
  v_mfma_f32_16x16x32_bf16 v[192:195], v[68:71], v[92:95], v[192:195]
  v_mfma_f32_16x16x32_bf16 v[188:191], v[64:67], v[80:83], v[188:191]
  v_mfma_f32_16x16x32_bf16 v[188:191], v[68:71], v[84:87], v[188:191]
  v_mfma_f32_16x16x32_bf16 v[204:207], v[72:75], v[80:83], v[204:207]
  v_mfma_f32_16x16x32_bf16 v[204:207], v[76:79], v[84:87], v[204:207]
  v_mfma_f32_16x16x32_bf16 v[208:211], v[72:75], v[88:91], v[208:211]
  v_mfma_f32_16x16x32_bf16 v[208:211], v[76:79], v[92:95], v[208:211]
  v_mfma_f32_16x16x32_bf16 v[212:215], v[72:75], v[96:99], v[212:215]
  v_mfma_f32_16x16x32_bf16 v[212:215], v[76:79], v[100:103], v[212:215]
  v_mfma_f32_16x16x32_bf16 v[216:219], v[72:75], v[104:107], v[216:219]
  s_setprio 2
  s_barrier
  v_mfma_f32_16x16x32_bf16 v[216:219], v[76:79], v[108:111], v[216:219]
  ds_read_b64_tr_b16 v[40:41], v6 offset:20480
  s_add_u32 m0, s75, 40960
  s_nop 0
  buffer_load_dwordx4 v29, s[44:47], s74 offen offset:0 lds
  ds_read_b64_tr_b16 v[42:43], v6 offset:23040
  ds_read_b64_tr_b16 v[44:45], v6 offset:40960
  ds_read_b64_tr_b16 v[46:47], v6 offset:43520
  ds_read_b64_tr_b16 v[48:49], v7 offset:20480
  buffer_load_dwordx4 v30, s[44:47], s74 offen offset:1024 lds
  ds_read_b64_tr_b16 v[50:51], v7 offset:23040
  ds_read_b64_tr_b16 v[52:53], v7 offset:40960
  ds_read_b64_tr_b16 v[54:55], v7 offset:43520
  ds_read_b64_tr_b16 v[56:57], v8 offset:20480
  buffer_load_dwordx4 v31, s[44:47], s74 offen offset:2048 lds
  ds_read_b64_tr_b16 v[58:59], v8 offset:23040
  ds_read_b64_tr_b16 v[60:61], v8 offset:40960
  ds_read_b64_tr_b16 v[62:63], v8 offset:43520
  ds_read_b64_tr_b16 v[64:65], v9 offset:20480
  buffer_load_dwordx4 v32, s[44:47], s74 offen offset:3072 lds
  ds_read_b64_tr_b16 v[66:67], v9 offset:23040
  ds_read_b64_tr_b16 v[68:69], v9 offset:40960
  ds_read_b64_tr_b16 v[70:71], v9 offset:43520
  ds_read_b128 v[80:83], v11 offset:8192
  s_add_u32 m0, m0, 4096
  s_nop 0
  buffer_load_dwordx4 v33, s[44:47], s74 offen offset:0 lds
  s_add_u32 s74, s74, 212992
  ds_read_b128 v[84:87], v12 offset:8192
  ds_read_b128 v[88:91], v11 offset:10240
  ds_read_b128 v[92:95], v12 offset:10240
  ds_read_b128 v[96:99], v11 offset:12288
  v_lshl_add_u32 v34, v242, 7, v15
  v_lshl_add_u32 v28, v26, 7, v14
  s_add_u32 m0, s76, 0
  s_nop 0
  buffer_load_dwordx4 v28, s[32:35], 0 offen lds
  ds_read_b128 v[100:103], v12 offset:12288
  ds_read_b128 v[104:107], v11 offset:14336
  ds_read_b128 v[108:111], v12 offset:14336
  ds_read_b64_tr_b16 v[72:73], v10 offset:20480
  s_add_u32 m0, m0, 1024
  s_nop 0
  buffer_load_dwordx4 v34, s[32:35], 0 offen lds
  ds_read_b64_tr_b16 v[74:75], v10 offset:23040
  ds_read_b64_tr_b16 v[76:77], v10 offset:40960
  ds_read_b64_tr_b16 v[78:79], v10 offset:43520
  buffer_load_dwordx3 v[24:26], v13, s[28:31], s73 offen offset:0
  buffer_load_dwordx3 v[240:242], v13, s[28:31], s73 offen offset:832
  s_add_u32 s73, s73, 12
  s_waitcnt vmcnt(9) lgkmcnt(0)
  s_barrier
  s_setprio 0
  v_mfma_f32_16x16x32_bf16 v[140:143], v[40:43], v[80:83], v[140:143]
  s_add_u32 s72, s72, 1
  v_mfma_f32_16x16x32_bf16 v[140:143], v[44:47], v[84:87], v[140:143]
  v_mfma_f32_16x16x32_bf16 v[144:147], v[40:43], v[88:91], v[144:147]
  v_mfma_f32_16x16x32_bf16 v[144:147], v[44:47], v[92:95], v[144:147]
  v_mfma_f32_16x16x32_bf16 v[148:151], v[40:43], v[96:99], v[148:151]
  v_mfma_f32_16x16x32_bf16 v[148:151], v[44:47], v[100:103], v[148:151]
  v_mfma_f32_16x16x32_bf16 v[152:155], v[40:43], v[104:107], v[152:155]
  v_mfma_f32_16x16x32_bf16 v[152:155], v[44:47], v[108:111], v[152:155]
  v_mfma_f32_16x16x32_bf16 v[168:171], v[48:51], v[104:107], v[168:171]
  v_mfma_f32_16x16x32_bf16 v[168:171], v[52:55], v[108:111], v[168:171]
  v_mfma_f32_16x16x32_bf16 v[164:167], v[48:51], v[96:99], v[164:167]
  v_mfma_f32_16x16x32_bf16 v[164:167], v[52:55], v[100:103], v[164:167]
  v_mfma_f32_16x16x32_bf16 v[160:163], v[48:51], v[88:91], v[160:163]
  v_mfma_f32_16x16x32_bf16 v[160:163], v[52:55], v[92:95], v[160:163]
  v_mfma_f32_16x16x32_bf16 v[156:159], v[48:51], v[80:83], v[156:159]
  v_mfma_f32_16x16x32_bf16 v[156:159], v[52:55], v[84:87], v[156:159]
  v_mfma_f32_16x16x32_bf16 v[172:175], v[56:59], v[80:83], v[172:175]
  v_mfma_f32_16x16x32_bf16 v[172:175], v[60:63], v[84:87], v[172:175]
  v_mfma_f32_16x16x32_bf16 v[176:179], v[56:59], v[88:91], v[176:179]
  v_mfma_f32_16x16x32_bf16 v[176:179], v[60:63], v[92:95], v[176:179]
  s_cmp_lt_u32 s72, 4
  v_mfma_f32_16x16x32_bf16 v[180:183], v[56:59], v[96:99], v[180:183]
  v_mfma_f32_16x16x32_bf16 v[180:183], v[60:63], v[100:103], v[180:183]
  v_mfma_f32_16x16x32_bf16 v[184:187], v[56:59], v[104:107], v[184:187]
  v_mfma_f32_16x16x32_bf16 v[184:187], v[60:63], v[108:111], v[184:187]
  v_mfma_f32_16x16x32_bf16 v[200:203], v[64:67], v[104:107], v[200:203]
  v_mfma_f32_16x16x32_bf16 v[200:203], v[68:71], v[108:111], v[200:203]
  v_mfma_f32_16x16x32_bf16 v[196:199], v[64:67], v[96:99], v[196:199]
  v_mfma_f32_16x16x32_bf16 v[196:199], v[68:71], v[100:103], v[196:199]
  v_mfma_f32_16x16x32_bf16 v[192:195], v[64:67], v[88:91], v[192:195]
  v_mfma_f32_16x16x32_bf16 v[192:195], v[68:71], v[92:95], v[192:195]
  v_mfma_f32_16x16x32_bf16 v[188:191], v[64:67], v[80:83], v[188:191]
  v_mfma_f32_16x16x32_bf16 v[188:191], v[68:71], v[84:87], v[188:191]
  v_mfma_f32_16x16x32_bf16 v[204:207], v[72:75], v[80:83], v[204:207]
  v_mfma_f32_16x16x32_bf16 v[204:207], v[76:79], v[84:87], v[204:207]
  v_mfma_f32_16x16x32_bf16 v[208:211], v[72:75], v[88:91], v[208:211]
  v_mfma_f32_16x16x32_bf16 v[208:211], v[76:79], v[92:95], v[208:211]
  v_mfma_f32_16x16x32_bf16 v[212:215], v[72:75], v[96:99], v[212:215]
  v_mfma_f32_16x16x32_bf16 v[212:215], v[76:79], v[100:103], v[212:215]
  v_mfma_f32_16x16x32_bf16 v[216:219], v[72:75], v[104:107], v[216:219]
  s_setprio 2
  s_barrier
  v_mfma_f32_16x16x32_bf16 v[216:219], v[76:79], v[108:111], v[216:219]
  s_cbranch_scc1 L_dnn_loop0
  ds_read_b64_tr_b16 v[40:41], v1 offset:0
  v_lshl_add_u32 v34, v20, 7, v15
  v_lshl_add_u32 v28, v16, 7, v14
  s_add_u32 m0, s76, 8192
  s_nop 0
  buffer_load_dwordx4 v28, s[32:35], 0 offen lds
  ds_read_b64_tr_b16 v[42:43], v1 offset:2560
  ds_read_b64_tr_b16 v[44:45], v1 offset:20480
  ds_read_b64_tr_b16 v[46:47], v1 offset:23040
  ds_read_b64_tr_b16 v[48:49], v2 offset:0
  ds_read_b64_tr_b16 v[50:51], v2 offset:2560
  ds_read_b64_tr_b16 v[52:53], v2 offset:20480
  ds_read_b64_tr_b16 v[54:55], v2 offset:23040
  ds_read_b64_tr_b16 v[56:57], v3 offset:0
  ds_read_b64_tr_b16 v[58:59], v3 offset:2560
  ds_read_b64_tr_b16 v[60:61], v3 offset:20480
  ds_read_b64_tr_b16 v[62:63], v3 offset:23040
  ds_read_b64_tr_b16 v[64:65], v4 offset:0
  ds_read_b64_tr_b16 v[66:67], v4 offset:2560
  ds_read_b64_tr_b16 v[68:69], v4 offset:20480
  ds_read_b64_tr_b16 v[70:71], v4 offset:23040
  ds_read_b128 v[80:83], v11 offset:0
  s_add_u32 m0, m0, 1024
  s_nop 0
  buffer_load_dwordx4 v34, s[32:35], 0 offen lds
  ds_read_b128 v[84:87], v12 offset:0
  ds_read_b128 v[88:91], v11 offset:2048
  ds_read_b128 v[92:95], v12 offset:2048
  ds_read_b128 v[96:99], v11 offset:4096
  ds_read_b128 v[100:103], v12 offset:4096
  ds_read_b128 v[104:107], v11 offset:6144
  ds_read_b128 v[108:111], v12 offset:6144
  ds_read_b64_tr_b16 v[72:73], v5 offset:0
  ds_read_b64_tr_b16 v[74:75], v5 offset:2560
  ds_read_b64_tr_b16 v[76:77], v5 offset:20480
  ds_read_b64_tr_b16 v[78:79], v5 offset:23040
  ds_read_b64 v[220:221], v35 offset:640
  ds_read_b64 v[222:223], v35 offset:672
  ds_read_b64 v[224:225], v35 offset:704
  ds_read_b64 v[226:227], v35 offset:736
  ds_read_b64 v[228:229], v35 offset:768
  s_mov_b32 s60, s24
  s_and_b32 s61, s25, 0xffff
  s_mov_b32 s62, 268435456
  s_mov_b32 s63, 0x20000
  s_mov_b32 s64, s22
  s_and_b32 s65, s23, 0xffff
  s_mov_b32 s66, 256
  s_mov_b32 s67, 0x20000
  v_lshlrev_b32 v28, 2, v0
  s_mov_b64 exec, 0xff
  s_mov_b32 s81, 0x80000
  buffer_load_dword v255, v28, s[60:63], s81 offen
  buffer_load_dword v37, v28, s[64:67], 0 offen offset:128 sc1
  s_mov_b64 exec, -1
  v_mov_b32 v28, 0
  s_waitcnt vmcnt(6) lgkmcnt(0)
  s_barrier
  s_setprio 0
  v_mfma_f32_16x16x32_bf16 v[140:143], v[40:43], v[80:83], v[140:143]
  v_mov_b32 v232, 0xc0135761
  v_mov_b32 v233, 0xc0135761
  v_mfma_f32_16x16x32_bf16 v[140:143], v[44:47], v[84:87], v[140:143]
  v_mov_b32 v234, 0xbdd2d3e8
  v_mov_b32 v235, 0xbdd2d3e8
  v_mfma_f32_16x16x32_bf16 v[144:147], v[40:43], v[88:91], v[144:147]
  v_mov_b32 v236, 0xc2b40000
  v_mov_b32 v237, 0xc2b40000
  v_mfma_f32_16x16x32_bf16 v[144:147], v[44:47], v[92:95], v[144:147]
  v_lshlrev_b32 v112, 16, v220
  v_and_b32 v113, 0xffff0000, v220
  v_mfma_f32_16x16x32_bf16 v[148:151], v[40:43], v[96:99], v[148:151]
  v_lshlrev_b32 v114, 16, v221
  v_and_b32 v115, 0xffff0000, v221
  v_mfma_f32_16x16x32_bf16 v[148:151], v[44:47], v[100:103], v[148:151]
  v_lshlrev_b32 v116, 16, v222
  v_and_b32 v117, 0xffff0000, v222
  v_mfma_f32_16x16x32_bf16 v[152:155], v[40:43], v[104:107], v[152:155]
  v_lshlrev_b32 v118, 16, v223
  v_and_b32 v119, 0xffff0000, v223
  v_mfma_f32_16x16x32_bf16 v[152:155], v[44:47], v[108:111], v[152:155]
  v_lshlrev_b32 v120, 16, v224
  v_and_b32 v121, 0xffff0000, v224
  v_mfma_f32_16x16x32_bf16 v[168:171], v[48:51], v[104:107], v[168:171]
  v_lshlrev_b32 v122, 16, v225
  v_and_b32 v123, 0xffff0000, v225
  v_mfma_f32_16x16x32_bf16 v[168:171], v[52:55], v[108:111], v[168:171]
  v_lshlrev_b32 v124, 16, v226
  v_mfma_f32_16x16x32_bf16 v[164:167], v[48:51], v[96:99], v[164:167]
  v_and_b32 v125, 0xffff0000, v226
  v_lshlrev_b32 v126, 16, v227
  v_mfma_f32_16x16x32_bf16 v[164:167], v[52:55], v[100:103], v[164:167]
  v_and_b32 v127, 0xffff0000, v227
  v_lshlrev_b32 v128, 16, v228
  v_mfma_f32_16x16x32_bf16 v[160:163], v[48:51], v[88:91], v[160:163]
  v_and_b32 v129, 0xffff0000, v228
  v_lshlrev_b32 v130, 16, v229
  v_mfma_f32_16x16x32_bf16 v[160:163], v[52:55], v[92:95], v[160:163]
  v_and_b32 v131, 0xffff0000, v229
  v_mov_b32 v239, 0x21800000
  v_mfma_f32_16x16x32_bf16 v[156:159], v[48:51], v[80:83], v[156:159]
  v_mov_b32 v238, 0x30800000
  v_max3_f32 v239, v239, abs(v112), abs(v113)
  v_mfma_f32_16x16x32_bf16 v[156:159], v[52:55], v[84:87], v[156:159]
  v_max3_f32 v239, v239, abs(v114), abs(v115)
  v_max3_f32 v239, v239, abs(v116), abs(v117)
  v_mfma_f32_16x16x32_bf16 v[172:175], v[56:59], v[80:83], v[172:175]
  v_max3_f32 v239, v239, abs(v118), abs(v119)
  v_max3_f32 v239, v239, abs(v120), abs(v121)
  v_mfma_f32_16x16x32_bf16 v[172:175], v[60:63], v[84:87], v[172:175]
  v_max3_f32 v239, v239, abs(v122), abs(v123)
  v_max3_f32 v239, v239, abs(v124), abs(v125)
  v_mfma_f32_16x16x32_bf16 v[176:179], v[56:59], v[88:91], v[176:179]
  v_max3_f32 v239, v239, abs(v126), abs(v127)
  v_mfma_f32_16x16x32_bf16 v[176:179], v[60:63], v[92:95], v[176:179]
  v_max3_f32 v239, v239, abs(v128), abs(v129)
  v_max3_f32 v239, v239, abs(v130), abs(v131)
  v_mfma_f32_16x16x32_bf16 v[180:183], v[56:59], v[96:99], v[180:183]
  v_and_b32 v239, 0x7f800000, v239
  v_mul_f32 v239, 0x22000000, v239
  v_mfma_f32_16x16x32_bf16 v[180:183], v[60:63], v[100:103], v[180:183]
  v_rcp_f32 v112, v112
  v_mfma_f32_16x16x32_bf16 v[184:187], v[56:59], v[104:107], v[184:187]
  v_rcp_f32 v113, v113
  v_mfma_f32_16x16x32_bf16 v[184:187], v[60:63], v[108:111], v[184:187]
  v_rcp_f32 v114, v114
  v_mfma_f32_16x16x32_bf16 v[200:203], v[64:67], v[104:107], v[200:203]
  v_rcp_f32 v115, v115
  v_mfma_f32_16x16x32_bf16 v[200:203], v[68:71], v[108:111], v[200:203]
  v_rcp_f32 v116, v116
  v_mfma_f32_16x16x32_bf16 v[196:199], v[64:67], v[96:99], v[196:199]
  v_rcp_f32 v117, v117
  v_mfma_f32_16x16x32_bf16 v[196:199], v[68:71], v[100:103], v[196:199]
  v_rcp_f32 v118, v118
  v_mfma_f32_16x16x32_bf16 v[192:195], v[64:67], v[88:91], v[192:195]
  v_rcp_f32 v119, v119
  v_mfma_f32_16x16x32_bf16 v[192:195], v[68:71], v[92:95], v[192:195]
  v_rcp_f32 v120, v120
  v_mfma_f32_16x16x32_bf16 v[188:191], v[64:67], v[80:83], v[188:191]
  v_rcp_f32 v121, v121
  v_mfma_f32_16x16x32_bf16 v[188:191], v[68:71], v[84:87], v[188:191]
  v_rcp_f32 v122, v122
  v_mfma_f32_16x16x32_bf16 v[204:207], v[72:75], v[80:83], v[204:207]
  v_rcp_f32 v123, v123
  v_mfma_f32_16x16x32_bf16 v[204:207], v[76:79], v[84:87], v[204:207]
  v_rcp_f32 v124, v124
  v_mfma_f32_16x16x32_bf16 v[208:211], v[72:75], v[88:91], v[208:211]
  v_rcp_f32 v125, v125
  v_mfma_f32_16x16x32_bf16 v[208:211], v[76:79], v[92:95], v[208:211]
  v_rcp_f32 v126, v126
  v_mfma_f32_16x16x32_bf16 v[212:215], v[72:75], v[96:99], v[212:215]
  v_rcp_f32 v127, v127
  v_mfma_f32_16x16x32_bf16 v[212:215], v[76:79], v[100:103], v[212:215]
  v_mfma_f32_16x16x32_bf16 v[216:219], v[72:75], v[104:107], v[216:219]
  s_setprio 2
  s_barrier
  v_mfma_f32_16x16x32_bf16 v[216:219], v[76:79], v[108:111], v[216:219]
  ds_read_b64_tr_b16 v[40:41], v1 offset:40960
  ds_read_b64_tr_b16 v[42:43], v1 offset:43520
  ds_read_b64_tr_b16 v[44:45], v6 offset:0
  ds_read_b64_tr_b16 v[46:47], v6 offset:2560
  ds_read_b64_tr_b16 v[48:49], v2 offset:40960
  ds_read_b64_tr_b16 v[50:51], v2 offset:43520
  ds_read_b64_tr_b16 v[52:53], v7 offset:0
  ds_read_b64_tr_b16 v[54:55], v7 offset:2560
  ds_read_b64_tr_b16 v[56:57], v3 offset:40960
  ds_read_b64_tr_b16 v[58:59], v3 offset:43520
  ds_read_b64_tr_b16 v[60:61], v8 offset:0
  ds_read_b64_tr_b16 v[62:63], v8 offset:2560
  ds_read_b64_tr_b16 v[64:65], v4 offset:40960
  ds_read_b64_tr_b16 v[66:67], v4 offset:43520
  ds_read_b64_tr_b16 v[68:69], v9 offset:0
  ds_read_b64_tr_b16 v[70:71], v9 offset:2560
  ds_read_b128 v[80:83], v11 offset:8192
  ds_read_b128 v[84:87], v12 offset:8192
  ds_read_b128 v[88:91], v11 offset:10240
  ds_read_b128 v[92:95], v12 offset:10240
  ds_read_b128 v[96:99], v11 offset:12288
  ds_read_b128 v[100:103], v12 offset:12288
  ds_read_b128 v[104:107], v11 offset:14336
  ds_read_b128 v[108:111], v12 offset:14336
  ds_read_b64_tr_b16 v[72:73], v5 offset:40960
  ds_read_b64_tr_b16 v[74:75], v5 offset:43520
  ds_read_b64_tr_b16 v[76:77], v10 offset:0
  ds_read_b64_tr_b16 v[78:79], v10 offset:2560
  s_waitcnt vmcnt(2) lgkmcnt(0)
  s_barrier
  s_setprio 0
  v_mfma_f32_16x16x32_bf16 v[140:143], v[40:43], v[80:83], v[140:143]
  v_rcp_f32 v128, v128
  v_mfma_f32_16x16x32_bf16 v[140:143], v[44:47], v[84:87], v[140:143]
  v_rcp_f32 v129, v129
  v_mfma_f32_16x16x32_bf16 v[144:147], v[40:43], v[88:91], v[144:147]
  v_rcp_f32 v130, v130
  v_mfma_f32_16x16x32_bf16 v[144:147], v[44:47], v[92:95], v[144:147]
  v_rcp_f32 v131, v131
  v_mfma_f32_16x16x32_bf16 v[148:151], v[40:43], v[96:99], v[148:151]
  v_mul_f32 v112, v239, v112
  v_mfma_f32_16x16x32_bf16 v[148:151], v[44:47], v[100:103], v[148:151]
  v_mul_f32 v113, v239, v113
  v_mul_f32 v114, v239, v114
  v_mfma_f32_16x16x32_bf16 v[152:155], v[40:43], v[104:107], v[152:155]
  v_mul_f32 v115, v239, v115
  v_mul_f32 v116, v239, v116
  v_mfma_f32_16x16x32_bf16 v[152:155], v[44:47], v[108:111], v[152:155]
  v_mul_f32 v117, v239, v117
  v_mul_f32 v118, v239, v118
  v_mfma_f32_16x16x32_bf16 v[168:171], v[48:51], v[104:107], v[168:171]
  v_mul_f32 v119, v239, v119
  v_mul_f32 v120, v239, v120
  v_mfma_f32_16x16x32_bf16 v[168:171], v[52:55], v[108:111], v[168:171]
  v_mul_f32 v121, v239, v121
  v_mfma_f32_16x16x32_bf16 v[164:167], v[48:51], v[96:99], v[164:167]
  v_mul_f32 v122, v239, v122
  v_mul_f32 v123, v239, v123
  v_mfma_f32_16x16x32_bf16 v[164:167], v[52:55], v[100:103], v[164:167]
  v_mul_f32 v124, v239, v124
  v_mul_f32 v125, v239, v125
  v_mfma_f32_16x16x32_bf16 v[160:163], v[48:51], v[88:91], v[160:163]
  v_mul_f32 v126, v239, v126
  v_mul_f32 v127, v239, v127
  v_mfma_f32_16x16x32_bf16 v[160:163], v[52:55], v[92:95], v[160:163]
  v_mul_f32 v128, v239, v128
  v_mul_f32 v129, v239, v129
  v_mfma_f32_16x16x32_bf16 v[156:159], v[48:51], v[80:83], v[156:159]
  v_mul_f32 v130, v239, v130
  v_mfma_f32_16x16x32_bf16 v[156:159], v[52:55], v[84:87], v[156:159]
  v_mul_f32 v131, v239, v131
  v_med3_f32 v112, v112, -v238, v238
  v_mfma_f32_16x16x32_bf16 v[172:175], v[56:59], v[80:83], v[172:175]
  v_med3_f32 v113, v113, -v238, v238
  v_med3_f32 v114, v114, -v238, v238
  v_mfma_f32_16x16x32_bf16 v[172:175], v[60:63], v[84:87], v[172:175]
  v_med3_f32 v115, v115, -v238, v238
  v_med3_f32 v116, v116, -v238, v238
  v_mfma_f32_16x16x32_bf16 v[176:179], v[56:59], v[88:91], v[176:179]
  v_med3_f32 v117, v117, -v238, v238
  v_mfma_f32_16x16x32_bf16 v[176:179], v[60:63], v[92:95], v[176:179]
  v_med3_f32 v118, v118, -v238, v238
  v_med3_f32 v119, v119, -v238, v238
  v_mfma_f32_16x16x32_bf16 v[180:183], v[56:59], v[96:99], v[180:183]
  v_med3_f32 v120, v120, -v238, v238
  v_med3_f32 v121, v121, -v238, v238
  v_mfma_f32_16x16x32_bf16 v[180:183], v[60:63], v[100:103], v[180:183]
  v_med3_f32 v122, v122, -v238, v238
  v_med3_f32 v123, v123, -v238, v238
  v_mfma_f32_16x16x32_bf16 v[184:187], v[56:59], v[104:107], v[184:187]
  v_med3_f32 v124, v124, -v238, v238
  v_med3_f32 v125, v125, -v238, v238
  v_mfma_f32_16x16x32_bf16 v[184:187], v[60:63], v[108:111], v[184:187]
  v_med3_f32 v126, v126, -v238, v238
  v_mfma_f32_16x16x32_bf16 v[200:203], v[64:67], v[104:107], v[200:203]
  v_med3_f32 v127, v127, -v238, v238
  v_med3_f32 v128, v128, -v238, v238
  v_mfma_f32_16x16x32_bf16 v[200:203], v[68:71], v[108:111], v[200:203]
  v_med3_f32 v129, v129, -v238, v238
  v_med3_f32 v130, v130, -v238, v238
  v_mfma_f32_16x16x32_bf16 v[196:199], v[64:67], v[96:99], v[196:199]
  v_med3_f32 v131, v131, -v238, v238
  v_mul_f32 v132, 0x6c800000, v112
  v_mfma_f32_16x16x32_bf16 v[196:199], v[68:71], v[100:103], v[196:199]
  v_mul_f32 v133, 0x6c800000, v113
  v_mul_f32 v134, 0x6c800000, v114
  v_mfma_f32_16x16x32_bf16 v[192:195], v[64:67], v[88:91], v[192:195]
  v_mul_f32 v135, 0x6c800000, v115
  v_mfma_f32_16x16x32_bf16 v[192:195], v[68:71], v[92:95], v[192:195]
  v_mul_f32 v136, 0x6c800000, v116
  v_mul_f32 v137, 0x6c800000, v117
  v_mfma_f32_16x16x32_bf16 v[188:191], v[64:67], v[80:83], v[188:191]
  v_mul_f32 v138, 0x6c800000, v118
  v_mul_f32 v139, 0x6c800000, v119
  v_mfma_f32_16x16x32_bf16 v[188:191], v[68:71], v[84:87], v[188:191]
  v_mul_f32 v220, 0x6c800000, v120
  v_mul_f32 v221, 0x6c800000, v121
  v_mfma_f32_16x16x32_bf16 v[204:207], v[72:75], v[80:83], v[204:207]
  v_mul_f32 v222, 0x6c800000, v122
  v_mul_f32 v223, 0x6c800000, v123
  v_mfma_f32_16x16x32_bf16 v[204:207], v[76:79], v[84:87], v[204:207]
  v_mul_f32 v224, 0x6c800000, v124
  v_mfma_f32_16x16x32_bf16 v[208:211], v[72:75], v[88:91], v[208:211]
  v_mul_f32 v225, 0x6c800000, v125
  v_mul_f32 v226, 0x6c800000, v126
  v_mfma_f32_16x16x32_bf16 v[208:211], v[76:79], v[92:95], v[208:211]
  v_mul_f32 v227, 0x6c800000, v127
  v_mul_f32 v228, 0x6c800000, v128
  v_mfma_f32_16x16x32_bf16 v[212:215], v[72:75], v[96:99], v[212:215]
  v_mul_f32 v229, 0x6c800000, v129
  v_mul_f32 v230, 0x6c800000, v130
  v_mfma_f32_16x16x32_bf16 v[212:215], v[76:79], v[100:103], v[212:215]
  v_mul_f32 v231, 0x6c800000, v131
  v_mfma_f32_16x16x32_bf16 v[216:219], v[72:75], v[104:107], v[216:219]
  s_setprio 2
  s_barrier
  v_mfma_f32_16x16x32_bf16 v[216:219], v[76:79], v[108:111], v[216:219]
  s_setprio 0
  s_branch L_epi
L_dnn_h1:
  v_lshl_add_u32 v34, v49, 7, v15
  v_lshl_add_u32 v28, v45, 7, v14
  s_add_u32 m0, s76, 8192
  s_nop 0
  buffer_load_dwordx4 v28, s[32:35], 0 offen lds
  s_add_u32 m0, m0, 1024
  s_nop 0
  buffer_load_dwordx4 v34, s[32:35], 0 offen lds
  s_add_u32 m0, s75, 40960
  s_nop 0
  buffer_load_dwordx4 v29, s[44:47], s74 offen offset:0 lds
  buffer_load_dwordx4 v30, s[44:47], s74 offen offset:1024 lds
  buffer_load_dwordx4 v31, s[44:47], s74 offen offset:2048 lds
  buffer_load_dwordx4 v32, s[44:47], s74 offen offset:3072 lds
  s_add_u32 m0, m0, 4096
  s_nop 0
  buffer_load_dwordx4 v33, s[44:47], s74 offen offset:0 lds
  s_add_u32 s74, s74, 212992
  s_waitcnt vmcnt(13)
  s_waitcnt vmcnt(10) lgkmcnt(0)
  s_barrier
  buffer_load_dwordx3 v[24:26], v13, s[28:31], s73 offen offset:0
  buffer_load_dwordx3 v[240:242], v13, s[28:31], s73 offen offset:832
  s_add_u32 s73, s73, 12
  s_barrier
L_dnn_loop1:
  ds_read_b64_tr_b16 v[40:41], v1 offset:0
  s_add_u32 m0, s75, 81920
  s_nop 0
  buffer_load_dwordx4 v29, s[44:47], s74 offen offset:0 lds
  ds_read_b64_tr_b16 v[42:43], v1 offset:2560
  ds_read_b64_tr_b16 v[44:45], v1 offset:20480
  ds_read_b64_tr_b16 v[46:47], v1 offset:23040
  ds_read_b64_tr_b16 v[48:49], v2 offset:0
  buffer_load_dwordx4 v30, s[44:47], s74 offen offset:1024 lds
  ds_read_b64_tr_b16 v[50:51], v2 offset:2560
  ds_read_b64_tr_b16 v[52:53], v2 offset:20480
  ds_read_b64_tr_b16 v[54:55], v2 offset:23040
  ds_read_b64_tr_b16 v[56:57], v3 offset:0
  buffer_load_dwordx4 v31, s[44:47], s74 offen offset:2048 lds
  ds_read_b64_tr_b16 v[58:59], v3 offset:2560
  ds_read_b64_tr_b16 v[60:61], v3 offset:20480
  ds_read_b64_tr_b16 v[62:63], v3 offset:23040
  ds_read_b64_tr_b16 v[64:65], v4 offset:0
  buffer_load_dwordx4 v32, s[44:47], s74 offen offset:3072 lds
  ds_read_b64_tr_b16 v[66:67], v4 offset:2560
  ds_read_b64_tr_b16 v[68:69], v4 offset:20480
  ds_read_b64_tr_b16 v[70:71], v4 offset:23040
  ds_read_b128 v[80:83], v11 offset:0
  s_add_u32 m0, m0, 4096
  s_nop 0
  buffer_load_dwordx4 v33, s[44:47], s74 offen offset:0 lds
  s_add_u32 s74, s74, 212992
  ds_read_b128 v[84:87], v12 offset:0
  ds_read_b128 v[88:91], v11 offset:2048
  ds_read_b128 v[92:95], v12 offset:2048
  ds_read_b128 v[96:99], v11 offset:4096
  s_waitcnt vmcnt(14)
  v_lshl_add_u32 v34, v20, 7, v15
  v_lshl_add_u32 v28, v16, 7, v14
  s_add_u32 m0, s76, 0
  s_nop 0
  buffer_load_dwordx4 v28, s[32:35], 0 offen lds
  ds_read_b128 v[100:103], v12 offset:4096
  ds_read_b128 v[104:107], v11 offset:6144
  ds_read_b128 v[108:111], v12 offset:6144
  ds_read_b64_tr_b16 v[72:73], v5 offset:0
  s_add_u32 m0, m0, 1024
  s_nop 0
  buffer_load_dwordx4 v34, s[32:35], 0 offen lds
  ds_read_b64_tr_b16 v[74:75], v5 offset:2560
  ds_read_b64_tr_b16 v[76:77], v5 offset:20480
  ds_read_b64_tr_b16 v[78:79], v5 offset:23040
  s_waitcnt vmcnt(9) lgkmcnt(0)
  s_waitcnt vmcnt(9)
  s_barrier
  s_setprio 0
  v_mfma_f32_16x16x32_bf16 v[140:143], v[40:43], v[80:83], v[140:143]
  v_mfma_f32_16x16x32_bf16 v[140:143], v[44:47], v[84:87], v[140:143]
  v_mfma_f32_16x16x32_bf16 v[144:147], v[40:43], v[88:91], v[144:147]
  v_mfma_f32_16x16x32_bf16 v[144:147], v[44:47], v[92:95], v[144:147]
  v_mfma_f32_16x16x32_bf16 v[148:151], v[40:43], v[96:99], v[148:151]
  v_mfma_f32_16x16x32_bf16 v[148:151], v[44:47], v[100:103], v[148:151]
  v_mfma_f32_16x16x32_bf16 v[152:155], v[40:43], v[104:107], v[152:155]
  v_mfma_f32_16x16x32_bf16 v[152:155], v[44:47], v[108:111], v[152:155]
  v_mfma_f32_16x16x32_bf16 v[168:171], v[48:51], v[104:107], v[168:171]
  v_mfma_f32_16x16x32_bf16 v[168:171], v[52:55], v[108:111], v[168:171]
  v_mfma_f32_16x16x32_bf16 v[164:167], v[48:51], v[96:99], v[164:167]
  v_mfma_f32_16x16x32_bf16 v[164:167], v[52:55], v[100:103], v[164:167]
  v_mfma_f32_16x16x32_bf16 v[160:163], v[48:51], v[88:91], v[160:163]
  v_mfma_f32_16x16x32_bf16 v[160:163], v[52:55], v[92:95], v[160:163]
  v_mfma_f32_16x16x32_bf16 v[156:159], v[48:51], v[80:83], v[156:159]
  v_mfma_f32_16x16x32_bf16 v[156:159], v[52:55], v[84:87], v[156:159]
  v_mfma_f32_16x16x32_bf16 v[172:175], v[56:59], v[80:83], v[172:175]
  v_mfma_f32_16x16x32_bf16 v[172:175], v[60:63], v[84:87], v[172:175]
  v_mfma_f32_16x16x32_bf16 v[176:179], v[56:59], v[88:91], v[176:179]
  v_mfma_f32_16x16x32_bf16 v[176:179], v[60:63], v[92:95], v[176:179]
  v_mfma_f32_16x16x32_bf16 v[180:183], v[56:59], v[96:99], v[180:183]
  v_mfma_f32_16x16x32_bf16 v[180:183], v[60:63], v[100:103], v[180:183]
  v_mfma_f32_16x16x32_bf16 v[184:187], v[56:59], v[104:107], v[184:187]
  v_mfma_f32_16x16x32_bf16 v[184:187], v[60:63], v[108:111], v[184:187]
  v_mfma_f32_16x16x32_bf16 v[200:203], v[64:67], v[104:107], v[200:203]
  v_mfma_f32_16x16x32_bf16 v[200:203], v[68:71], v[108:111], v[200:203]
  v_mfma_f32_16x16x32_bf16 v[196:199], v[64:67], v[96:99], v[196:199]
  v_mfma_f32_16x16x32_bf16 v[196:199], v[68:71], v[100:103], v[196:199]
  v_mfma_f32_16x16x32_bf16 v[192:195], v[64:67], v[88:91], v[192:195]
  v_mfma_f32_16x16x32_bf16 v[192:195], v[68:71], v[92:95], v[192:195]
  v_mfma_f32_16x16x32_bf16 v[188:191], v[64:67], v[80:83], v[188:191]
  v_mfma_f32_16x16x32_bf16 v[188:191], v[68:71], v[84:87], v[188:191]
  v_mfma_f32_16x16x32_bf16 v[204:207], v[72:75], v[80:83], v[204:207]
  v_mfma_f32_16x16x32_bf16 v[204:207], v[76:79], v[84:87], v[204:207]
  v_mfma_f32_16x16x32_bf16 v[208:211], v[72:75], v[88:91], v[208:211]
  v_mfma_f32_16x16x32_bf16 v[208:211], v[76:79], v[92:95], v[208:211]
  v_mfma_f32_16x16x32_bf16 v[212:215], v[72:75], v[96:99], v[212:215]
  v_mfma_f32_16x16x32_bf16 v[212:215], v[76:79], v[100:103], v[212:215]
  v_mfma_f32_16x16x32_bf16 v[216:219], v[72:75], v[104:107], v[216:219]
  s_setprio 2
  s_barrier
  v_mfma_f32_16x16x32_bf16 v[216:219], v[76:79], v[108:111], v[216:219]
  ds_read_b64_tr_b16 v[40:41], v1 offset:40960
  s_add_u32 m0, s75, 0
  s_nop 0
  buffer_load_dwordx4 v29, s[44:47], s74 offen offset:0 lds
  ds_read_b64_tr_b16 v[42:43], v1 offset:43520
  ds_read_b64_tr_b16 v[44:45], v6 offset:0
  ds_read_b64_tr_b16 v[46:47], v6 offset:2560
  ds_read_b64_tr_b16 v[48:49], v2 offset:40960
  buffer_load_dwordx4 v30, s[44:47], s74 offen offset:1024 lds
  ds_read_b64_tr_b16 v[50:51], v2 offset:43520
  ds_read_b64_tr_b16 v[52:53], v7 offset:0
  ds_read_b64_tr_b16 v[54:55], v7 offset:2560
  ds_read_b64_tr_b16 v[56:57], v3 offset:40960
  buffer_load_dwordx4 v31, s[44:47], s74 offen offset:2048 lds
  ds_read_b64_tr_b16 v[58:59], v3 offset:43520
  ds_read_b64_tr_b16 v[60:61], v8 offset:0
  ds_read_b64_tr_b16 v[62:63], v8 offset:2560
  ds_read_b64_tr_b16 v[64:65], v4 offset:40960
  buffer_load_dwordx4 v32, s[44:47], s74 offen offset:3072 lds
  ds_read_b64_tr_b16 v[66:67], v4 offset:43520
  ds_read_b64_tr_b16 v[68:69], v9 offset:0
  ds_read_b64_tr_b16 v[70:71], v9 offset:2560
  ds_read_b128 v[80:83], v11 offset:8192
  s_add_u32 m0, m0, 4096
  s_nop 0
  buffer_load_dwordx4 v33, s[44:47], s74 offen offset:0 lds
  s_add_u32 s74, s74, 212992
  ds_read_b128 v[84:87], v12 offset:8192
  ds_read_b128 v[88:91], v11 offset:10240
  ds_read_b128 v[92:95], v12 offset:10240
  ds_read_b128 v[96:99], v11 offset:12288
  v_lshl_add_u32 v34, v21, 7, v15
  v_lshl_add_u32 v28, v17, 7, v14
  s_add_u32 m0, s76, 8192
  s_nop 0
  buffer_load_dwordx4 v28, s[32:35], 0 offen lds
  ds_read_b128 v[100:103], v12 offset:12288
  ds_read_b128 v[104:107], v11 offset:14336
  ds_read_b128 v[108:111], v12 offset:14336
  ds_read_b64_tr_b16 v[72:73], v5 offset:40960
  s_add_u32 m0, m0, 1024
  s_nop 0
  buffer_load_dwordx4 v34, s[32:35], 0 offen lds
  ds_read_b64_tr_b16 v[74:75], v5 offset:43520
  ds_read_b64_tr_b16 v[76:77], v10 offset:0
  ds_read_b64_tr_b16 v[78:79], v10 offset:2560
  s_waitcnt vmcnt(7) lgkmcnt(0)
  s_barrier
  s_setprio 0
  v_mfma_f32_16x16x32_bf16 v[140:143], v[40:43], v[80:83], v[140:143]
  v_mfma_f32_16x16x32_bf16 v[140:143], v[44:47], v[84:87], v[140:143]
  v_mfma_f32_16x16x32_bf16 v[144:147], v[40:43], v[88:91], v[144:147]
  v_mfma_f32_16x16x32_bf16 v[144:147], v[44:47], v[92:95], v[144:147]
  v_mfma_f32_16x16x32_bf16 v[148:151], v[40:43], v[96:99], v[148:151]
  v_mfma_f32_16x16x32_bf16 v[148:151], v[44:47], v[100:103], v[148:151]
  v_mfma_f32_16x16x32_bf16 v[152:155], v[40:43], v[104:107], v[152:155]
  v_mfma_f32_16x16x32_bf16 v[152:155], v[44:47], v[108:111], v[152:155]
  v_mfma_f32_16x16x32_bf16 v[168:171], v[48:51], v[104:107], v[168:171]
  v_mfma_f32_16x16x32_bf16 v[168:171], v[52:55], v[108:111], v[168:171]
  v_mfma_f32_16x16x32_bf16 v[164:167], v[48:51], v[96:99], v[164:167]
  v_mfma_f32_16x16x32_bf16 v[164:167], v[52:55], v[100:103], v[164:167]
  v_mfma_f32_16x16x32_bf16 v[160:163], v[48:51], v[88:91], v[160:163]
  v_mfma_f32_16x16x32_bf16 v[160:163], v[52:55], v[92:95], v[160:163]
  v_mfma_f32_16x16x32_bf16 v[156:159], v[48:51], v[80:83], v[156:159]
  v_mfma_f32_16x16x32_bf16 v[156:159], v[52:55], v[84:87], v[156:159]
  v_mfma_f32_16x16x32_bf16 v[172:175], v[56:59], v[80:83], v[172:175]
  v_mfma_f32_16x16x32_bf16 v[172:175], v[60:63], v[84:87], v[172:175]
  v_mfma_f32_16x16x32_bf16 v[176:179], v[56:59], v[88:91], v[176:179]
  v_mfma_f32_16x16x32_bf16 v[176:179], v[60:63], v[92:95], v[176:179]
  v_mfma_f32_16x16x32_bf16 v[180:183], v[56:59], v[96:99], v[180:183]
  v_mfma_f32_16x16x32_bf16 v[180:183], v[60:63], v[100:103], v[180:183]
  v_mfma_f32_16x16x32_bf16 v[184:187], v[56:59], v[104:107], v[184:187]
  v_mfma_f32_16x16x32_bf16 v[184:187], v[60:63], v[108:111], v[184:187]
  v_mfma_f32_16x16x32_bf16 v[200:203], v[64:67], v[104:107], v[200:203]
  v_mfma_f32_16x16x32_bf16 v[200:203], v[68:71], v[108:111], v[200:203]
  v_mfma_f32_16x16x32_bf16 v[196:199], v[64:67], v[96:99], v[196:199]
  v_mfma_f32_16x16x32_bf16 v[196:199], v[68:71], v[100:103], v[196:199]
  v_mfma_f32_16x16x32_bf16 v[192:195], v[64:67], v[88:91], v[192:195]
  v_mfma_f32_16x16x32_bf16 v[192:195], v[68:71], v[92:95], v[192:195]
  v_mfma_f32_16x16x32_bf16 v[188:191], v[64:67], v[80:83], v[188:191]
  v_mfma_f32_16x16x32_bf16 v[188:191], v[68:71], v[84:87], v[188:191]
  v_mfma_f32_16x16x32_bf16 v[204:207], v[72:75], v[80:83], v[204:207]
  v_mfma_f32_16x16x32_bf16 v[204:207], v[76:79], v[84:87], v[204:207]
  v_mfma_f32_16x16x32_bf16 v[208:211], v[72:75], v[88:91], v[208:211]
  v_mfma_f32_16x16x32_bf16 v[208:211], v[76:79], v[92:95], v[208:211]
  v_mfma_f32_16x16x32_bf16 v[212:215], v[72:75], v[96:99], v[212:215]
  v_mfma_f32_16x16x32_bf16 v[212:215], v[76:79], v[100:103], v[212:215]
  v_mfma_f32_16x16x32_bf16 v[216:219], v[72:75], v[104:107], v[216:219]
  s_setprio 2
  s_barrier
  v_mfma_f32_16x16x32_bf16 v[216:219], v[76:79], v[108:111], v[216:219]
  ds_read_b64_tr_b16 v[40:41], v6 offset:20480
  s_add_u32 m0, s75, 40960
  s_nop 0
  buffer_load_dwordx4 v29, s[44:47], s74 offen offset:0 lds
  ds_read_b64_tr_b16 v[42:43], v6 offset:23040
  ds_read_b64_tr_b16 v[44:45], v6 offset:40960
  ds_read_b64_tr_b16 v[46:47], v6 offset:43520
  ds_read_b64_tr_b16 v[48:49], v7 offset:20480
  buffer_load_dwordx4 v30, s[44:47], s74 offen offset:1024 lds
  ds_read_b64_tr_b16 v[50:51], v7 offset:23040
  ds_read_b64_tr_b16 v[52:53], v7 offset:40960
  ds_read_b64_tr_b16 v[54:55], v7 offset:43520
  ds_read_b64_tr_b16 v[56:57], v8 offset:20480
  buffer_load_dwordx4 v31, s[44:47], s74 offen offset:2048 lds
  ds_read_b64_tr_b16 v[58:59], v8 offset:23040
  ds_read_b64_tr_b16 v[60:61], v8 offset:40960
  ds_read_b64_tr_b16 v[62:63], v8 offset:43520
  ds_read_b64_tr_b16 v[64:65], v9 offset:20480
  buffer_load_dwordx4 v32, s[44:47], s74 offen offset:3072 lds
  ds_read_b64_tr_b16 v[66:67], v9 offset:23040
  ds_read_b64_tr_b16 v[68:69], v9 offset:40960
  ds_read_b64_tr_b16 v[70:71], v9 offset:43520
  ds_read_b128 v[80:83], v11 offset:0
  s_add_u32 m0, m0, 4096
  s_nop 0
  buffer_load_dwordx4 v33, s[44:47], s74 offen offset:0 lds
  s_add_u32 s74, s74, 212992
  ds_read_b128 v[84:87], v12 offset:0
  ds_read_b128 v[88:91], v11 offset:2048
  ds_read_b128 v[92:95], v12 offset:2048
  ds_read_b128 v[96:99], v11 offset:4096
  v_lshl_add_u32 v34, v22, 7, v15
  v_lshl_add_u32 v28, v18, 7, v14
  s_add_u32 m0, s76, 0
  s_nop 0
  buffer_load_dwordx4 v28, s[32:35], 0 offen lds
  ds_read_b128 v[100:103], v12 offset:4096
  ds_read_b128 v[104:107], v11 offset:6144
  ds_read_b128 v[108:111], v12 offset:6144
  ds_read_b64_tr_b16 v[72:73], v10 offset:20480
  s_add_u32 m0, m0, 1024
  s_nop 0
  buffer_load_dwordx4 v34, s[32:35], 0 offen lds
  ds_read_b64_tr_b16 v[74:75], v10 offset:23040
  ds_read_b64_tr_b16 v[76:77], v10 offset:40960
  ds_read_b64_tr_b16 v[78:79], v10 offset:43520
  buffer_load_dwordx3 v[16:18], v13, s[28:31], s73 offen offset:0
  buffer_load_dwordx3 v[20:22], v13, s[28:31], s73 offen offset:832
  s_add_u32 s73, s73, 12
  s_waitcnt vmcnt(9) lgkmcnt(0)
  s_barrier
  s_setprio 0
  v_mfma_f32_16x16x32_bf16 v[140:143], v[40:43], v[80:83], v[140:143]
  v_mfma_f32_16x16x32_bf16 v[140:143], v[44:47], v[84:87], v[140:143]
  v_mfma_f32_16x16x32_bf16 v[144:147], v[40:43], v[88:91], v[144:147]
  v_mfma_f32_16x16x32_bf16 v[144:147], v[44:47], v[92:95], v[144:147]
  v_mfma_f32_16x16x32_bf16 v[148:151], v[40:43], v[96:99], v[148:151]
  v_mfma_f32_16x16x32_bf16 v[148:151], v[44:47], v[100:103], v[148:151]
  v_mfma_f32_16x16x32_bf16 v[152:155], v[40:43], v[104:107], v[152:155]
  v_mfma_f32_16x16x32_bf16 v[152:155], v[44:47], v[108:111], v[152:155]
  v_mfma_f32_16x16x32_bf16 v[168:171], v[48:51], v[104:107], v[168:171]
  v_mfma_f32_16x16x32_bf16 v[168:171], v[52:55], v[108:111], v[168:171]
  v_mfma_f32_16x16x32_bf16 v[164:167], v[48:51], v[96:99], v[164:167]
  v_mfma_f32_16x16x32_bf16 v[164:167], v[52:55], v[100:103], v[164:167]
  v_mfma_f32_16x16x32_bf16 v[160:163], v[48:51], v[88:91], v[160:163]
  v_mfma_f32_16x16x32_bf16 v[160:163], v[52:55], v[92:95], v[160:163]
  v_mfma_f32_16x16x32_bf16 v[156:159], v[48:51], v[80:83], v[156:159]
  v_mfma_f32_16x16x32_bf16 v[156:159], v[52:55], v[84:87], v[156:159]
  v_mfma_f32_16x16x32_bf16 v[172:175], v[56:59], v[80:83], v[172:175]
  v_mfma_f32_16x16x32_bf16 v[172:175], v[60:63], v[84:87], v[172:175]
  v_mfma_f32_16x16x32_bf16 v[176:179], v[56:59], v[88:91], v[176:179]
  v_mfma_f32_16x16x32_bf16 v[176:179], v[60:63], v[92:95], v[176:179]
  v_mfma_f32_16x16x32_bf16 v[180:183], v[56:59], v[96:99], v[180:183]
  v_mfma_f32_16x16x32_bf16 v[180:183], v[60:63], v[100:103], v[180:183]
  v_mfma_f32_16x16x32_bf16 v[184:187], v[56:59], v[104:107], v[184:187]
  v_mfma_f32_16x16x32_bf16 v[184:187], v[60:63], v[108:111], v[184:187]
  v_mfma_f32_16x16x32_bf16 v[200:203], v[64:67], v[104:107], v[200:203]
  v_mfma_f32_16x16x32_bf16 v[200:203], v[68:71], v[108:111], v[200:203]
  v_mfma_f32_16x16x32_bf16 v[196:199], v[64:67], v[96:99], v[196:199]
  v_mfma_f32_16x16x32_bf16 v[196:199], v[68:71], v[100:103], v[196:199]
  v_mfma_f32_16x16x32_bf16 v[192:195], v[64:67], v[88:91], v[192:195]
  v_mfma_f32_16x16x32_bf16 v[192:195], v[68:71], v[92:95], v[192:195]
  v_mfma_f32_16x16x32_bf16 v[188:191], v[64:67], v[80:83], v[188:191]
  v_mfma_f32_16x16x32_bf16 v[188:191], v[68:71], v[84:87], v[188:191]
  v_mfma_f32_16x16x32_bf16 v[204:207], v[72:75], v[80:83], v[204:207]
  v_mfma_f32_16x16x32_bf16 v[204:207], v[76:79], v[84:87], v[204:207]
  v_mfma_f32_16x16x32_bf16 v[208:211], v[72:75], v[88:91], v[208:211]
  v_mfma_f32_16x16x32_bf16 v[208:211], v[76:79], v[92:95], v[208:211]
  v_mfma_f32_16x16x32_bf16 v[212:215], v[72:75], v[96:99], v[212:215]
  v_mfma_f32_16x16x32_bf16 v[212:215], v[76:79], v[100:103], v[212:215]
  v_mfma_f32_16x16x32_bf16 v[216:219], v[72:75], v[104:107], v[216:219]
  s_setprio 2
  s_barrier
  v_mfma_f32_16x16x32_bf16 v[216:219], v[76:79], v[108:111], v[216:219]
  ds_read_b64_tr_b16 v[40:41], v1 offset:0
  s_add_u32 m0, s75, 81920
  s_nop 0
  buffer_load_dwordx4 v29, s[44:47], s74 offen offset:0 lds
  ds_read_b64_tr_b16 v[42:43], v1 offset:2560
  ds_read_b64_tr_b16 v[44:45], v1 offset:20480
  ds_read_b64_tr_b16 v[46:47], v1 offset:23040
  ds_read_b64_tr_b16 v[48:49], v2 offset:0
  buffer_load_dwordx4 v30, s[44:47], s74 offen offset:1024 lds
  ds_read_b64_tr_b16 v[50:51], v2 offset:2560
  ds_read_b64_tr_b16 v[52:53], v2 offset:20480
  ds_read_b64_tr_b16 v[54:55], v2 offset:23040
  ds_read_b64_tr_b16 v[56:57], v3 offset:0
  buffer_load_dwordx4 v31, s[44:47], s74 offen offset:2048 lds
  ds_read_b64_tr_b16 v[58:59], v3 offset:2560
  ds_read_b64_tr_b16 v[60:61], v3 offset:20480
  ds_read_b64_tr_b16 v[62:63], v3 offset:23040
  ds_read_b64_tr_b16 v[64:65], v4 offset:0
  buffer_load_dwordx4 v32, s[44:47], s74 offen offset:3072 lds
  ds_read_b64_tr_b16 v[66:67], v4 offset:2560
  ds_read_b64_tr_b16 v[68:69], v4 offset:20480
  ds_read_b64_tr_b16 v[70:71], v4 offset:23040
  ds_read_b128 v[80:83], v11 offset:8192
  s_add_u32 m0, m0, 4096
  s_nop 0
  buffer_load_dwordx4 v33, s[44:47], s74 offen offset:0 lds
  s_add_u32 s74, s74, 212992
  ds_read_b128 v[84:87], v12 offset:8192
  ds_read_b128 v[88:91], v11 offset:10240
  ds_read_b128 v[92:95], v12 offset:10240
  ds_read_b128 v[96:99], v11 offset:12288
  v_lshl_add_u32 v34, v240, 7, v15
  v_lshl_add_u32 v28, v24, 7, v14
  s_add_u32 m0, s76, 8192
  s_nop 0
  buffer_load_dwordx4 v28, s[32:35], 0 offen lds
  ds_read_b128 v[100:103], v12 offset:12288
  ds_read_b128 v[104:107], v11 offset:14336
  ds_read_b128 v[108:111], v12 offset:14336
  ds_read_b64_tr_b16 v[72:73], v5 offset:0
  s_add_u32 m0, m0, 1024
  s_nop 0
  buffer_load_dwordx4 v34, s[32:35], 0 offen lds
  ds_read_b64_tr_b16 v[74:75], v5 offset:2560
  ds_read_b64_tr_b16 v[76:77], v5 offset:20480
  ds_read_b64_tr_b16 v[78:79], v5 offset:23040
  s_waitcnt vmcnt(9) lgkmcnt(0)
  s_barrier
  s_setprio 0
  v_mfma_f32_16x16x32_bf16 v[140:143], v[40:43], v[80:83], v[140:143]
  v_mfma_f32_16x16x32_bf16 v[140:143], v[44:47], v[84:87], v[140:143]
  v_mfma_f32_16x16x32_bf16 v[144:147], v[40:43], v[88:91], v[144:147]
  v_mfma_f32_16x16x32_bf16 v[144:147], v[44:47], v[92:95], v[144:147]
  v_mfma_f32_16x16x32_bf16 v[148:151], v[40:43], v[96:99], v[148:151]
  v_mfma_f32_16x16x32_bf16 v[148:151], v[44:47], v[100:103], v[148:151]
  v_mfma_f32_16x16x32_bf16 v[152:155], v[40:43], v[104:107], v[152:155]
  v_mfma_f32_16x16x32_bf16 v[152:155], v[44:47], v[108:111], v[152:155]
  v_mfma_f32_16x16x32_bf16 v[168:171], v[48:51], v[104:107], v[168:171]
  v_mfma_f32_16x16x32_bf16 v[168:171], v[52:55], v[108:111], v[168:171]
  v_mfma_f32_16x16x32_bf16 v[164:167], v[48:51], v[96:99], v[164:167]
  v_mfma_f32_16x16x32_bf16 v[164:167], v[52:55], v[100:103], v[164:167]
  v_mfma_f32_16x16x32_bf16 v[160:163], v[48:51], v[88:91], v[160:163]
  v_mfma_f32_16x16x32_bf16 v[160:163], v[52:55], v[92:95], v[160:163]
  v_mfma_f32_16x16x32_bf16 v[156:159], v[48:51], v[80:83], v[156:159]
  v_mfma_f32_16x16x32_bf16 v[156:159], v[52:55], v[84:87], v[156:159]
  v_mfma_f32_16x16x32_bf16 v[172:175], v[56:59], v[80:83], v[172:175]
  v_mfma_f32_16x16x32_bf16 v[172:175], v[60:63], v[84:87], v[172:175]
  v_mfma_f32_16x16x32_bf16 v[176:179], v[56:59], v[88:91], v[176:179]
  v_mfma_f32_16x16x32_bf16 v[176:179], v[60:63], v[92:95], v[176:179]
  v_mfma_f32_16x16x32_bf16 v[180:183], v[56:59], v[96:99], v[180:183]
  v_mfma_f32_16x16x32_bf16 v[180:183], v[60:63], v[100:103], v[180:183]
  v_mfma_f32_16x16x32_bf16 v[184:187], v[56:59], v[104:107], v[184:187]
  v_mfma_f32_16x16x32_bf16 v[184:187], v[60:63], v[108:111], v[184:187]
  v_mfma_f32_16x16x32_bf16 v[200:203], v[64:67], v[104:107], v[200:203]
  v_mfma_f32_16x16x32_bf16 v[200:203], v[68:71], v[108:111], v[200:203]
  v_mfma_f32_16x16x32_bf16 v[196:199], v[64:67], v[96:99], v[196:199]
  v_mfma_f32_16x16x32_bf16 v[196:199], v[68:71], v[100:103], v[196:199]
  v_mfma_f32_16x16x32_bf16 v[192:195], v[64:67], v[88:91], v[192:195]
  v_mfma_f32_16x16x32_bf16 v[192:195], v[68:71], v[92:95], v[192:195]
  v_mfma_f32_16x16x32_bf16 v[188:191], v[64:67], v[80:83], v[188:191]
  v_mfma_f32_16x16x32_bf16 v[188:191], v[68:71], v[84:87], v[188:191]
  v_mfma_f32_16x16x32_bf16 v[204:207], v[72:75], v[80:83], v[204:207]
  v_mfma_f32_16x16x32_bf16 v[204:207], v[76:79], v[84:87], v[204:207]
  v_mfma_f32_16x16x32_bf16 v[208:211], v[72:75], v[88:91], v[208:211]
  v_mfma_f32_16x16x32_bf16 v[208:211], v[76:79], v[92:95], v[208:211]
  v_mfma_f32_16x16x32_bf16 v[212:215], v[72:75], v[96:99], v[212:215]
  v_mfma_f32_16x16x32_bf16 v[212:215], v[76:79], v[100:103], v[212:215]
  v_mfma_f32_16x16x32_bf16 v[216:219], v[72:75], v[104:107], v[216:219]
  s_setprio 2
  s_barrier
  v_mfma_f32_16x16x32_bf16 v[216:219], v[76:79], v[108:111], v[216:219]
  ds_read_b64_tr_b16 v[40:41], v1 offset:40960
  s_add_u32 m0, s75, 0
  s_nop 0
  buffer_load_dwordx4 v29, s[44:47], s74 offen offset:0 lds
  ds_read_b64_tr_b16 v[42:43], v1 offset:43520
  ds_read_b64_tr_b16 v[44:45], v6 offset:0
  ds_read_b64_tr_b16 v[46:47], v6 offset:2560
  ds_read_b64_tr_b16 v[48:49], v2 offset:40960
  buffer_load_dwordx4 v30, s[44:47], s74 offen offset:1024 lds
  ds_read_b64_tr_b16 v[50:51], v2 offset:43520
  ds_read_b64_tr_b16 v[52:53], v7 offset:0
  ds_read_b64_tr_b16 v[54:55], v7 offset:2560
  ds_read_b64_tr_b16 v[56:57], v3 offset:40960
  buffer_load_dwordx4 v31, s[44:47], s74 offen offset:2048 lds
  ds_read_b64_tr_b16 v[58:59], v3 offset:43520
  ds_read_b64_tr_b16 v[60:61], v8 offset:0
  ds_read_b64_tr_b16 v[62:63], v8 offset:2560
  ds_read_b64_tr_b16 v[64:65], v4 offset:40960
  buffer_load_dwordx4 v32, s[44:47], s74 offen offset:3072 lds
  ds_read_b64_tr_b16 v[66:67], v4 offset:43520
  ds_read_b64_tr_b16 v[68:69], v9 offset:0
  ds_read_b64_tr_b16 v[70:71], v9 offset:2560
  ds_read_b128 v[80:83], v11 offset:0
  s_add_u32 m0, m0, 4096
  s_nop 0
  buffer_load_dwordx4 v33, s[44:47], s74 offen offset:0 lds
  s_add_u32 s74, s74, 212992
  ds_read_b128 v[84:87], v12 offset:0
  ds_read_b128 v[88:91], v11 offset:2048
  ds_read_b128 v[92:95], v12 offset:2048
  ds_read_b128 v[96:99], v11 offset:4096
  v_lshl_add_u32 v34, v241, 7, v15
  v_lshl_add_u32 v28, v25, 7, v14
  s_add_u32 m0, s76, 0
  s_nop 0
  buffer_load_dwordx4 v28, s[32:35], 0 offen lds
  ds_read_b128 v[100:103], v12 offset:4096
  ds_read_b128 v[104:107], v11 offset:6144
  ds_read_b128 v[108:111], v12 offset:6144
  ds_read_b64_tr_b16 v[72:73], v5 offset:40960
  s_add_u32 m0, m0, 1024
  s_nop 0
  buffer_load_dwordx4 v34, s[32:35], 0 offen lds
  ds_read_b64_tr_b16 v[74:75], v5 offset:43520
  ds_read_b64_tr_b16 v[76:77], v10 offset:0
  ds_read_b64_tr_b16 v[78:79], v10 offset:2560
  s_mov_b32 m0, 156288
  s_mov_b32 exec_hi, 0xff
  buffer_load_dwordx4 v37, s[52:55], s77 offen lds
  s_mov_b64 exec, -1
  s_waitcnt vmcnt(8) lgkmcnt(0)
  s_barrier
  s_setprio 0
  v_mfma_f32_16x16x32_bf16 v[140:143], v[40:43], v[80:83], v[140:143]
  v_mfma_f32_16x16x32_bf16 v[140:143], v[44:47], v[84:87], v[140:143]
  v_mfma_f32_16x16x32_bf16 v[144:147], v[40:43], v[88:91], v[144:147]
  v_mfma_f32_16x16x32_bf16 v[144:147], v[44:47], v[92:95], v[144:147]
  v_mfma_f32_16x16x32_bf16 v[148:151], v[40:43], v[96:99], v[148:151]
  v_mfma_f32_16x16x32_bf16 v[148:151], v[44:47], v[100:103], v[148:151]
  v_mfma_f32_16x16x32_bf16 v[152:155], v[40:43], v[104:107], v[152:155]
  v_mfma_f32_16x16x32_bf16 v[152:155], v[44:47], v[108:111], v[152:155]
  v_mfma_f32_16x16x32_bf16 v[168:171], v[48:51], v[104:107], v[168:171]
  v_mfma_f32_16x16x32_bf16 v[168:171], v[52:55], v[108:111], v[168:171]
  v_mfma_f32_16x16x32_bf16 v[164:167], v[48:51], v[96:99], v[164:167]
  v_mfma_f32_16x16x32_bf16 v[164:167], v[52:55], v[100:103], v[164:167]
  v_mfma_f32_16x16x32_bf16 v[160:163], v[48:51], v[88:91], v[160:163]
  v_mfma_f32_16x16x32_bf16 v[160:163], v[52:55], v[92:95], v[160:163]
  v_mfma_f32_16x16x32_bf16 v[156:159], v[48:51], v[80:83], v[156:159]
  v_mfma_f32_16x16x32_bf16 v[156:159], v[52:55], v[84:87], v[156:159]
  v_mfma_f32_16x16x32_bf16 v[172:175], v[56:59], v[80:83], v[172:175]
  v_mfma_f32_16x16x32_bf16 v[172:175], v[60:63], v[84:87], v[172:175]
  v_mfma_f32_16x16x32_bf16 v[176:179], v[56:59], v[88:91], v[176:179]
  v_mfma_f32_16x16x32_bf16 v[176:179], v[60:63], v[92:95], v[176:179]
  v_mfma_f32_16x16x32_bf16 v[180:183], v[56:59], v[96:99], v[180:183]
  v_mfma_f32_16x16x32_bf16 v[180:183], v[60:63], v[100:103], v[180:183]
  v_mfma_f32_16x16x32_bf16 v[184:187], v[56:59], v[104:107], v[184:187]
  v_mfma_f32_16x16x32_bf16 v[184:187], v[60:63], v[108:111], v[184:187]
  v_mfma_f32_16x16x32_bf16 v[200:203], v[64:67], v[104:107], v[200:203]
  v_mfma_f32_16x16x32_bf16 v[200:203], v[68:71], v[108:111], v[200:203]
  v_mfma_f32_16x16x32_bf16 v[196:199], v[64:67], v[96:99], v[196:199]
  v_mfma_f32_16x16x32_bf16 v[196:199], v[68:71], v[100:103], v[196:199]
  v_mfma_f32_16x16x32_bf16 v[192:195], v[64:67], v[88:91], v[192:195]
  v_mfma_f32_16x16x32_bf16 v[192:195], v[68:71], v[92:95], v[192:195]
  v_mfma_f32_16x16x32_bf16 v[188:191], v[64:67], v[80:83], v[188:191]
  v_mfma_f32_16x16x32_bf16 v[188:191], v[68:71], v[84:87], v[188:191]
  v_mfma_f32_16x16x32_bf16 v[204:207], v[72:75], v[80:83], v[204:207]
  v_mfma_f32_16x16x32_bf16 v[204:207], v[76:79], v[84:87], v[204:207]
  v_mfma_f32_16x16x32_bf16 v[208:211], v[72:75], v[88:91], v[208:211]
  v_mfma_f32_16x16x32_bf16 v[208:211], v[76:79], v[92:95], v[208:211]
  v_mfma_f32_16x16x32_bf16 v[212:215], v[72:75], v[96:99], v[212:215]
  v_mfma_f32_16x16x32_bf16 v[212:215], v[76:79], v[100:103], v[212:215]
  v_mfma_f32_16x16x32_bf16 v[216:219], v[72:75], v[104:107], v[216:219]
  s_setprio 2
  s_barrier
  v_mfma_f32_16x16x32_bf16 v[216:219], v[76:79], v[108:111], v[216:219]
  ds_read_b64_tr_b16 v[40:41], v6 offset:20480
  s_add_u32 m0, s75, 40960
  s_nop 0
  buffer_load_dwordx4 v29, s[44:47], s74 offen offset:0 lds
  ds_read_b64_tr_b16 v[42:43], v6 offset:23040
  ds_read_b64_tr_b16 v[44:45], v6 offset:40960
  ds_read_b64_tr_b16 v[46:47], v6 offset:43520
  ds_read_b64_tr_b16 v[48:49], v7 offset:20480
  buffer_load_dwordx4 v30, s[44:47], s74 offen offset:1024 lds
  ds_read_b64_tr_b16 v[50:51], v7 offset:23040
  ds_read_b64_tr_b16 v[52:53], v7 offset:40960
  ds_read_b64_tr_b16 v[54:55], v7 offset:43520
  ds_read_b64_tr_b16 v[56:57], v8 offset:20480
  buffer_load_dwordx4 v31, s[44:47], s74 offen offset:2048 lds
  ds_read_b64_tr_b16 v[58:59], v8 offset:23040
  ds_read_b64_tr_b16 v[60:61], v8 offset:40960
  ds_read_b64_tr_b16 v[62:63], v8 offset:43520
  ds_read_b64_tr_b16 v[64:65], v9 offset:20480
  buffer_load_dwordx4 v32, s[44:47], s74 offen offset:3072 lds
  ds_read_b64_tr_b16 v[66:67], v9 offset:23040
  ds_read_b64_tr_b16 v[68:69], v9 offset:40960
  ds_read_b64_tr_b16 v[70:71], v9 offset:43520
  ds_read_b128 v[80:83], v11 offset:8192
  s_add_u32 m0, m0, 4096
  s_nop 0
  buffer_load_dwordx4 v33, s[44:47], s74 offen offset:0 lds
  s_add_u32 s74, s74, 212992
  ds_read_b128 v[84:87], v12 offset:8192
  ds_read_b128 v[88:91], v11 offset:10240
  ds_read_b128 v[92:95], v12 offset:10240
  ds_read_b128 v[96:99], v11 offset:12288
  v_lshl_add_u32 v34, v242, 7, v15
  v_lshl_add_u32 v28, v26, 7, v14
  s_add_u32 m0, s76, 8192
  s_nop 0
  buffer_load_dwordx4 v28, s[32:35], 0 offen lds
  ds_read_b128 v[100:103], v12 offset:12288
  ds_read_b128 v[104:107], v11 offset:14336
  ds_read_b128 v[108:111], v12 offset:14336
  ds_read_b64_tr_b16 v[72:73], v10 offset:20480
  s_add_u32 m0, m0, 1024
  s_nop 0
  buffer_load_dwordx4 v34, s[32:35], 0 offen lds
  ds_read_b64_tr_b16 v[74:75], v10 offset:23040
  ds_read_b64_tr_b16 v[76:77], v10 offset:40960
  ds_read_b64_tr_b16 v[78:79], v10 offset:43520
  buffer_load_dwordx3 v[24:26], v13, s[28:31], s73 offen offset:0
  buffer_load_dwordx3 v[240:242], v13, s[28:31], s73 offen offset:832
  s_add_u32 s73, s73, 12
  s_waitcnt vmcnt(10) lgkmcnt(0)
  s_barrier
  s_setprio 0
  v_mfma_f32_16x16x32_bf16 v[140:143], v[40:43], v[80:83], v[140:143]
  s_add_u32 s72, s72, 1
  v_mfma_f32_16x16x32_bf16 v[140:143], v[44:47], v[84:87], v[140:143]
  v_mfma_f32_16x16x32_bf16 v[144:147], v[40:43], v[88:91], v[144:147]
  v_mfma_f32_16x16x32_bf16 v[144:147], v[44:47], v[92:95], v[144:147]
  v_mfma_f32_16x16x32_bf16 v[148:151], v[40:43], v[96:99], v[148:151]
  v_mfma_f32_16x16x32_bf16 v[148:151], v[44:47], v[100:103], v[148:151]
  v_mfma_f32_16x16x32_bf16 v[152:155], v[40:43], v[104:107], v[152:155]
  v_mfma_f32_16x16x32_bf16 v[152:155], v[44:47], v[108:111], v[152:155]
  v_mfma_f32_16x16x32_bf16 v[168:171], v[48:51], v[104:107], v[168:171]
  v_mfma_f32_16x16x32_bf16 v[168:171], v[52:55], v[108:111], v[168:171]
  v_mfma_f32_16x16x32_bf16 v[164:167], v[48:51], v[96:99], v[164:167]
  v_mfma_f32_16x16x32_bf16 v[164:167], v[52:55], v[100:103], v[164:167]
  v_mfma_f32_16x16x32_bf16 v[160:163], v[48:51], v[88:91], v[160:163]
  v_mfma_f32_16x16x32_bf16 v[160:163], v[52:55], v[92:95], v[160:163]
  v_mfma_f32_16x16x32_bf16 v[156:159], v[48:51], v[80:83], v[156:159]
  v_mfma_f32_16x16x32_bf16 v[156:159], v[52:55], v[84:87], v[156:159]
  v_mfma_f32_16x16x32_bf16 v[172:175], v[56:59], v[80:83], v[172:175]
  v_mfma_f32_16x16x32_bf16 v[172:175], v[60:63], v[84:87], v[172:175]
  v_mfma_f32_16x16x32_bf16 v[176:179], v[56:59], v[88:91], v[176:179]
  v_mfma_f32_16x16x32_bf16 v[176:179], v[60:63], v[92:95], v[176:179]
  s_cmp_lt_u32 s72, 4
  v_mfma_f32_16x16x32_bf16 v[180:183], v[56:59], v[96:99], v[180:183]
  v_mfma_f32_16x16x32_bf16 v[180:183], v[60:63], v[100:103], v[180:183]
  v_mfma_f32_16x16x32_bf16 v[184:187], v[56:59], v[104:107], v[184:187]
  v_mfma_f32_16x16x32_bf16 v[184:187], v[60:63], v[108:111], v[184:187]
  v_mfma_f32_16x16x32_bf16 v[200:203], v[64:67], v[104:107], v[200:203]
  v_mfma_f32_16x16x32_bf16 v[200:203], v[68:71], v[108:111], v[200:203]
  v_mfma_f32_16x16x32_bf16 v[196:199], v[64:67], v[96:99], v[196:199]
  v_mfma_f32_16x16x32_bf16 v[196:199], v[68:71], v[100:103], v[196:199]
  v_mfma_f32_16x16x32_bf16 v[192:195], v[64:67], v[88:91], v[192:195]
  v_mfma_f32_16x16x32_bf16 v[192:195], v[68:71], v[92:95], v[192:195]
  v_mfma_f32_16x16x32_bf16 v[188:191], v[64:67], v[80:83], v[188:191]
  v_mfma_f32_16x16x32_bf16 v[188:191], v[68:71], v[84:87], v[188:191]
  v_mfma_f32_16x16x32_bf16 v[204:207], v[72:75], v[80:83], v[204:207]
  v_mfma_f32_16x16x32_bf16 v[204:207], v[76:79], v[84:87], v[204:207]
  v_mfma_f32_16x16x32_bf16 v[208:211], v[72:75], v[88:91], v[208:211]
  v_mfma_f32_16x16x32_bf16 v[208:211], v[76:79], v[92:95], v[208:211]
  v_mfma_f32_16x16x32_bf16 v[212:215], v[72:75], v[96:99], v[212:215]
  v_mfma_f32_16x16x32_bf16 v[212:215], v[76:79], v[100:103], v[212:215]
  v_mfma_f32_16x16x32_bf16 v[216:219], v[72:75], v[104:107], v[216:219]
  s_setprio 2
  s_barrier
  v_mfma_f32_16x16x32_bf16 v[216:219], v[76:79], v[108:111], v[216:219]
  s_cbranch_scc1 L_dnn_loop1
  ds_read_b64_tr_b16 v[40:41], v1 offset:0
  ds_read_b64_tr_b16 v[42:43], v1 offset:2560
  ds_read_b64_tr_b16 v[44:45], v1 offset:20480
  ds_read_b64_tr_b16 v[46:47], v1 offset:23040
  ds_read_b64_tr_b16 v[48:49], v2 offset:0
  ds_read_b64_tr_b16 v[50:51], v2 offset:2560
  ds_read_b64_tr_b16 v[52:53], v2 offset:20480
  ds_read_b64_tr_b16 v[54:55], v2 offset:23040
  ds_read_b64_tr_b16 v[56:57], v3 offset:0
  ds_read_b64_tr_b16 v[58:59], v3 offset:2560
  ds_read_b64_tr_b16 v[60:61], v3 offset:20480
  ds_read_b64_tr_b16 v[62:63], v3 offset:23040
  ds_read_b64_tr_b16 v[64:65], v4 offset:0
  ds_read_b64_tr_b16 v[66:67], v4 offset:2560
  ds_read_b64_tr_b16 v[68:69], v4 offset:20480
  ds_read_b64_tr_b16 v[70:71], v4 offset:23040
  ds_read_b128 v[80:83], v11 offset:0
  ds_read_b128 v[84:87], v12 offset:0
  ds_read_b128 v[88:91], v11 offset:2048
  ds_read_b128 v[92:95], v12 offset:2048
  ds_read_b128 v[96:99], v11 offset:4096
  ds_read_b128 v[100:103], v12 offset:4096
  ds_read_b128 v[104:107], v11 offset:6144
  ds_read_b128 v[108:111], v12 offset:6144
  ds_read_b64_tr_b16 v[72:73], v5 offset:0
  ds_read_b64_tr_b16 v[74:75], v5 offset:2560
  ds_read_b64_tr_b16 v[76:77], v5 offset:20480
  ds_read_b64_tr_b16 v[78:79], v5 offset:23040
  ds_read_b64 v[220:221], v35 offset:640
  ds_read_b64 v[222:223], v35 offset:672
  ds_read_b64 v[224:225], v35 offset:704
  ds_read_b64 v[226:227], v35 offset:736
  ds_read_b64 v[228:229], v35 offset:768
  s_waitcnt vmcnt(2) lgkmcnt(0)
  s_barrier
  s_setprio 0
  v_mfma_f32_16x16x32_bf16 v[140:143], v[40:43], v[80:83], v[140:143]
  v_mov_b32 v232, 0xc0135761
  v_mov_b32 v233, 0xc0135761
  v_mfma_f32_16x16x32_bf16 v[140:143], v[44:47], v[84:87], v[140:143]
  v_mov_b32 v234, 0xbdd2d3e8
  v_mov_b32 v235, 0xbdd2d3e8
  v_mfma_f32_16x16x32_bf16 v[144:147], v[40:43], v[88:91], v[144:147]
  v_mov_b32 v236, 0xc2b40000
  v_mov_b32 v237, 0xc2b40000
  v_mfma_f32_16x16x32_bf16 v[144:147], v[44:47], v[92:95], v[144:147]
  v_lshlrev_b32 v112, 16, v220
  v_and_b32 v113, 0xffff0000, v220
  v_mfma_f32_16x16x32_bf16 v[148:151], v[40:43], v[96:99], v[148:151]
  v_lshlrev_b32 v114, 16, v221
  v_and_b32 v115, 0xffff0000, v221
  v_mfma_f32_16x16x32_bf16 v[148:151], v[44:47], v[100:103], v[148:151]
  v_lshlrev_b32 v116, 16, v222
  v_and_b32 v117, 0xffff0000, v222
  v_mfma_f32_16x16x32_bf16 v[152:155], v[40:43], v[104:107], v[152:155]
  v_lshlrev_b32 v118, 16, v223
  v_and_b32 v119, 0xffff0000, v223
  v_mfma_f32_16x16x32_bf16 v[152:155], v[44:47], v[108:111], v[152:155]
  v_lshlrev_b32 v120, 16, v224
  v_and_b32 v121, 0xffff0000, v224
  v_mfma_f32_16x16x32_bf16 v[168:171], v[48:51], v[104:107], v[168:171]
  v_lshlrev_b32 v122, 16, v225
  v_and_b32 v123, 0xffff0000, v225
  v_mfma_f32_16x16x32_bf16 v[168:171], v[52:55], v[108:111], v[168:171]
  v_lshlrev_b32 v124, 16, v226
  v_mfma_f32_16x16x32_bf16 v[164:167], v[48:51], v[96:99], v[164:167]
  v_and_b32 v125, 0xffff0000, v226
  v_lshlrev_b32 v126, 16, v227
  v_mfma_f32_16x16x32_bf16 v[164:167], v[52:55], v[100:103], v[164:167]
  v_and_b32 v127, 0xffff0000, v227
  v_lshlrev_b32 v128, 16, v228
  v_mfma_f32_16x16x32_bf16 v[160:163], v[48:51], v[88:91], v[160:163]
  v_and_b32 v129, 0xffff0000, v228
  v_lshlrev_b32 v130, 16, v229
  v_mfma_f32_16x16x32_bf16 v[160:163], v[52:55], v[92:95], v[160:163]
  v_and_b32 v131, 0xffff0000, v229
  v_mov_b32 v239, 0x21800000
  v_mfma_f32_16x16x32_bf16 v[156:159], v[48:51], v[80:83], v[156:159]
  v_mov_b32 v238, 0x30800000
  v_max3_f32 v239, v239, abs(v112), abs(v113)
  v_mfma_f32_16x16x32_bf16 v[156:159], v[52:55], v[84:87], v[156:159]
  v_max3_f32 v239, v239, abs(v114), abs(v115)
  v_max3_f32 v239, v239, abs(v116), abs(v117)
  v_mfma_f32_16x16x32_bf16 v[172:175], v[56:59], v[80:83], v[172:175]
  v_max3_f32 v239, v239, abs(v118), abs(v119)
  v_max3_f32 v239, v239, abs(v120), abs(v121)
  v_mfma_f32_16x16x32_bf16 v[172:175], v[60:63], v[84:87], v[172:175]
  v_max3_f32 v239, v239, abs(v122), abs(v123)
  v_max3_f32 v239, v239, abs(v124), abs(v125)
  v_mfma_f32_16x16x32_bf16 v[176:179], v[56:59], v[88:91], v[176:179]
  v_max3_f32 v239, v239, abs(v126), abs(v127)
  v_mfma_f32_16x16x32_bf16 v[176:179], v[60:63], v[92:95], v[176:179]
  v_max3_f32 v239, v239, abs(v128), abs(v129)
  v_max3_f32 v239, v239, abs(v130), abs(v131)
  v_mfma_f32_16x16x32_bf16 v[180:183], v[56:59], v[96:99], v[180:183]
  v_and_b32 v239, 0x7f800000, v239
  v_mul_f32 v239, 0x22000000, v239
  v_mfma_f32_16x16x32_bf16 v[180:183], v[60:63], v[100:103], v[180:183]
  v_rcp_f32 v112, v112
  v_mfma_f32_16x16x32_bf16 v[184:187], v[56:59], v[104:107], v[184:187]
  v_rcp_f32 v113, v113
  v_mfma_f32_16x16x32_bf16 v[184:187], v[60:63], v[108:111], v[184:187]
  v_rcp_f32 v114, v114
  v_mfma_f32_16x16x32_bf16 v[200:203], v[64:67], v[104:107], v[200:203]
  v_rcp_f32 v115, v115
  v_mfma_f32_16x16x32_bf16 v[200:203], v[68:71], v[108:111], v[200:203]
  v_rcp_f32 v116, v116
  v_mfma_f32_16x16x32_bf16 v[196:199], v[64:67], v[96:99], v[196:199]
  v_rcp_f32 v117, v117
  v_mfma_f32_16x16x32_bf16 v[196:199], v[68:71], v[100:103], v[196:199]
  v_rcp_f32 v118, v118
  v_mfma_f32_16x16x32_bf16 v[192:195], v[64:67], v[88:91], v[192:195]
  v_rcp_f32 v119, v119
  v_mfma_f32_16x16x32_bf16 v[192:195], v[68:71], v[92:95], v[192:195]
  v_rcp_f32 v120, v120
  v_mfma_f32_16x16x32_bf16 v[188:191], v[64:67], v[80:83], v[188:191]
  v_rcp_f32 v121, v121
  v_mfma_f32_16x16x32_bf16 v[188:191], v[68:71], v[84:87], v[188:191]
  v_rcp_f32 v122, v122
  v_mfma_f32_16x16x32_bf16 v[204:207], v[72:75], v[80:83], v[204:207]
  v_rcp_f32 v123, v123
  v_mfma_f32_16x16x32_bf16 v[204:207], v[76:79], v[84:87], v[204:207]
  v_rcp_f32 v124, v124
  v_mfma_f32_16x16x32_bf16 v[208:211], v[72:75], v[88:91], v[208:211]
  v_rcp_f32 v125, v125
  v_mfma_f32_16x16x32_bf16 v[208:211], v[76:79], v[92:95], v[208:211]
  v_rcp_f32 v126, v126
  v_mfma_f32_16x16x32_bf16 v[212:215], v[72:75], v[96:99], v[212:215]
  v_rcp_f32 v127, v127
  v_mfma_f32_16x16x32_bf16 v[212:215], v[76:79], v[100:103], v[212:215]
  v_mfma_f32_16x16x32_bf16 v[216:219], v[72:75], v[104:107], v[216:219]
  s_setprio 2
  s_barrier
  v_mfma_f32_16x16x32_bf16 v[216:219], v[76:79], v[108:111], v[216:219]
  ds_read_b64_tr_b16 v[40:41], v1 offset:40960
  ds_read_b64_tr_b16 v[42:43], v1 offset:43520
  ds_read_b64_tr_b16 v[44:45], v6 offset:0
  ds_read_b64_tr_b16 v[46:47], v6 offset:2560
  ds_read_b64_tr_b16 v[48:49], v2 offset:40960
  ds_read_b64_tr_b16 v[50:51], v2 offset:43520
  ds_read_b64_tr_b16 v[52:53], v7 offset:0
  ds_read_b64_tr_b16 v[54:55], v7 offset:2560
  ds_read_b64_tr_b16 v[56:57], v3 offset:40960
  ds_read_b64_tr_b16 v[58:59], v3 offset:43520
  ds_read_b64_tr_b16 v[60:61], v8 offset:0
  ds_read_b64_tr_b16 v[62:63], v8 offset:2560
  ds_read_b64_tr_b16 v[64:65], v4 offset:40960
  ds_read_b64_tr_b16 v[66:67], v4 offset:43520
  ds_read_b64_tr_b16 v[68:69], v9 offset:0
  ds_read_b64_tr_b16 v[70:71], v9 offset:2560
  ds_read_b128 v[80:83], v11 offset:8192
  ds_read_b128 v[84:87], v12 offset:8192
  ds_read_b128 v[88:91], v11 offset:10240
  ds_read_b128 v[92:95], v12 offset:10240
  ds_read_b128 v[96:99], v11 offset:12288
  ds_read_b128 v[100:103], v12 offset:12288
  ds_read_b128 v[104:107], v11 offset:14336
  ds_read_b128 v[108:111], v12 offset:14336
  ds_read_b64_tr_b16 v[72:73], v5 offset:40960
  ds_read_b64_tr_b16 v[74:75], v5 offset:43520
  ds_read_b64_tr_b16 v[76:77], v10 offset:0
  ds_read_b64_tr_b16 v[78:79], v10 offset:2560
  s_waitcnt lgkmcnt(0)
  s_barrier
  v_mfma_f32_16x16x32_bf16 v[140:143], v[40:43], v[80:83], v[140:143]
  v_rcp_f32 v128, v128
  v_mfma_f32_16x16x32_bf16 v[140:143], v[44:47], v[84:87], v[140:143]
  v_rcp_f32 v129, v129
  v_mfma_f32_16x16x32_bf16 v[144:147], v[40:43], v[88:91], v[144:147]
  v_rcp_f32 v130, v130
  v_mfma_f32_16x16x32_bf16 v[144:147], v[44:47], v[92:95], v[144:147]
  v_rcp_f32 v131, v131
  v_mfma_f32_16x16x32_bf16 v[148:151], v[40:43], v[96:99], v[148:151]
  v_mul_f32 v112, v239, v112
  v_mfma_f32_16x16x32_bf16 v[148:151], v[44:47], v[100:103], v[148:151]
  v_mul_f32 v113, v239, v113
  v_mul_f32 v114, v239, v114
  v_mfma_f32_16x16x32_bf16 v[152:155], v[40:43], v[104:107], v[152:155]
  v_mul_f32 v115, v239, v115
  v_mul_f32 v116, v239, v116
  v_mfma_f32_16x16x32_bf16 v[152:155], v[44:47], v[108:111], v[152:155]
  v_mul_f32 v117, v239, v117
  v_mul_f32 v118, v239, v118
  v_mfma_f32_16x16x32_bf16 v[168:171], v[48:51], v[104:107], v[168:171]
  v_mul_f32 v119, v239, v119
  v_mul_f32 v120, v239, v120
  v_mfma_f32_16x16x32_bf16 v[168:171], v[52:55], v[108:111], v[168:171]
  v_mul_f32 v121, v239, v121
  v_mfma_f32_16x16x32_bf16 v[164:167], v[48:51], v[96:99], v[164:167]
  v_mul_f32 v122, v239, v122
  v_mul_f32 v123, v239, v123
  v_mfma_f32_16x16x32_bf16 v[164:167], v[52:55], v[100:103], v[164:167]
  v_mul_f32 v124, v239, v124
  v_mul_f32 v125, v239, v125
  v_mfma_f32_16x16x32_bf16 v[160:163], v[48:51], v[88:91], v[160:163]
  v_mul_f32 v126, v239, v126
  v_mul_f32 v127, v239, v127
  v_mfma_f32_16x16x32_bf16 v[160:163], v[52:55], v[92:95], v[160:163]
  v_mul_f32 v128, v239, v128
  v_mul_f32 v129, v239, v129
  v_mfma_f32_16x16x32_bf16 v[156:159], v[48:51], v[80:83], v[156:159]
  v_mul_f32 v130, v239, v130
  v_mfma_f32_16x16x32_bf16 v[156:159], v[52:55], v[84:87], v[156:159]
  v_mul_f32 v131, v239, v131
  v_med3_f32 v112, v112, -v238, v238
  v_mfma_f32_16x16x32_bf16 v[172:175], v[56:59], v[80:83], v[172:175]
  v_med3_f32 v113, v113, -v238, v238
  v_med3_f32 v114, v114, -v238, v238
  v_mfma_f32_16x16x32_bf16 v[172:175], v[60:63], v[84:87], v[172:175]
  v_med3_f32 v115, v115, -v238, v238
  v_med3_f32 v116, v116, -v238, v238
  v_mfma_f32_16x16x32_bf16 v[176:179], v[56:59], v[88:91], v[176:179]
  v_med3_f32 v117, v117, -v238, v238
  v_mfma_f32_16x16x32_bf16 v[176:179], v[60:63], v[92:95], v[176:179]
  v_med3_f32 v118, v118, -v238, v238
  v_med3_f32 v119, v119, -v238, v238
  v_mfma_f32_16x16x32_bf16 v[180:183], v[56:59], v[96:99], v[180:183]
  v_med3_f32 v120, v120, -v238, v238
  v_med3_f32 v121, v121, -v238, v238
  v_mfma_f32_16x16x32_bf16 v[180:183], v[60:63], v[100:103], v[180:183]
  v_med3_f32 v122, v122, -v238, v238
  v_med3_f32 v123, v123, -v238, v238
  v_mfma_f32_16x16x32_bf16 v[184:187], v[56:59], v[104:107], v[184:187]
  v_med3_f32 v124, v124, -v238, v238
  v_med3_f32 v125, v125, -v238, v238
  v_mfma_f32_16x16x32_bf16 v[184:187], v[60:63], v[108:111], v[184:187]
  v_med3_f32 v126, v126, -v238, v238
  v_mfma_f32_16x16x32_bf16 v[200:203], v[64:67], v[104:107], v[200:203]
  v_med3_f32 v127, v127, -v238, v238
  v_med3_f32 v128, v128, -v238, v238
  v_mfma_f32_16x16x32_bf16 v[200:203], v[68:71], v[108:111], v[200:203]
  v_med3_f32 v129, v129, -v238, v238
  v_med3_f32 v130, v130, -v238, v238
  v_mfma_f32_16x16x32_bf16 v[196:199], v[64:67], v[96:99], v[196:199]
  v_med3_f32 v131, v131, -v238, v238
  v_mul_f32 v132, 0x6c800000, v112
  v_mfma_f32_16x16x32_bf16 v[196:199], v[68:71], v[100:103], v[196:199]
  v_mul_f32 v133, 0x6c800000, v113
  v_mul_f32 v134, 0x6c800000, v114
  v_mfma_f32_16x16x32_bf16 v[192:195], v[64:67], v[88:91], v[192:195]
  v_mul_f32 v135, 0x6c800000, v115
  v_mfma_f32_16x16x32_bf16 v[192:195], v[68:71], v[92:95], v[192:195]
  v_mul_f32 v136, 0x6c800000, v116
  v_mul_f32 v137, 0x6c800000, v117
  v_mfma_f32_16x16x32_bf16 v[188:191], v[64:67], v[80:83], v[188:191]
  v_mul_f32 v138, 0x6c800000, v118
  v_mul_f32 v139, 0x6c800000, v119
  v_mfma_f32_16x16x32_bf16 v[188:191], v[68:71], v[84:87], v[188:191]
  v_mul_f32 v220, 0x6c800000, v120
  v_mul_f32 v221, 0x6c800000, v121
  v_mfma_f32_16x16x32_bf16 v[204:207], v[72:75], v[80:83], v[204:207]
  v_mul_f32 v222, 0x6c800000, v122
  v_mul_f32 v223, 0x6c800000, v123
  v_mfma_f32_16x16x32_bf16 v[204:207], v[76:79], v[84:87], v[204:207]
  v_mul_f32 v224, 0x6c800000, v124
  v_mfma_f32_16x16x32_bf16 v[208:211], v[72:75], v[88:91], v[208:211]
  v_mul_f32 v225, 0x6c800000, v125
  v_mul_f32 v226, 0x6c800000, v126
  v_mfma_f32_16x16x32_bf16 v[208:211], v[76:79], v[92:95], v[208:211]
  v_mul_f32 v227, 0x6c800000, v127
  v_mul_f32 v228, 0x6c800000, v128
  v_mfma_f32_16x16x32_bf16 v[212:215], v[72:75], v[96:99], v[212:215]
  v_mul_f32 v229, 0x6c800000, v129
  v_mul_f32 v230, 0x6c800000, v130
  v_mfma_f32_16x16x32_bf16 v[212:215], v[76:79], v[100:103], v[212:215]
  v_mul_f32 v231, 0x6c800000, v131
  v_mfma_f32_16x16x32_bf16 v[216:219], v[72:75], v[104:107], v[216:219]
  v_mfma_f32_16x16x32_bf16 v[216:219], v[76:79], v[108:111], v[216:219]
  s_setprio 0
  s_nop 0
L_epi:
  s_lshl_b32 s69, s27, 11
  s_and_b32 s71, s26, 3
  s_lshl_b32 s71, s71, 9
  s_add_u32 s69, s69, s71
  s_lshr_b32 s68, s26, 2
  s_lshl_b32 s68, s68, 14
  s_add_u32 s69, s69, s68
  v_lshlrev_b32 v3, 3, v0
  v_add_u32 v2, 156928, v3
  v_pk_mul_f32 v[40:41], v[140:141], v[140:141]
  v_pk_mul_f32 v[42:43], v[142:143], v[142:143]
  v_pk_mul_f32 v[46:47], v[144:145], v[144:145]
  v_pk_mul_f32 v[48:49], v[146:147], v[146:147]
  v_pk_mul_f32 v[52:53], v[148:149], v[148:149]
  v_pk_mul_f32 v[54:55], v[150:151], v[150:151]
  v_pk_mul_f32 v[58:59], v[152:153], v[152:153]
  v_pk_mul_f32 v[60:61], v[154:155], v[154:155]
  v_pk_fma_f32 v[40:41], v[40:41], v[234:235], v[232:233]
  v_pk_fma_f32 v[42:43], v[42:43], v[234:235], v[232:233]
  v_pk_fma_f32 v[46:47], v[46:47], v[234:235], v[232:233]
  v_pk_fma_f32 v[48:49], v[48:49], v[234:235], v[232:233]
  v_pk_fma_f32 v[52:53], v[52:53], v[234:235], v[232:233]
  v_pk_fma_f32 v[54:55], v[54:55], v[234:235], v[232:233]
  v_pk_fma_f32 v[58:59], v[58:59], v[234:235], v[232:233]
  v_pk_fma_f32 v[60:61], v[60:61], v[234:235], v[232:233]
  v_pk_fma_f32 v[40:41], v[40:41], v[140:141], v[236:237]
  v_pk_fma_f32 v[42:43], v[42:43], v[142:143], v[236:237]
  v_pk_fma_f32 v[46:47], v[46:47], v[144:145], v[236:237]
  v_pk_fma_f32 v[48:49], v[48:49], v[146:147], v[236:237]
  v_pk_fma_f32 v[52:53], v[52:53], v[148:149], v[236:237]
  v_pk_fma_f32 v[54:55], v[54:55], v[150:151], v[236:237]
  v_pk_fma_f32 v[58:59], v[58:59], v[152:153], v[236:237]
  v_pk_fma_f32 v[60:61], v[60:61], v[154:155], v[236:237]
  v_exp_f32 v40, v40 clamp
  v_exp_f32 v41, v41 clamp
  v_exp_f32 v42, v42 clamp
  v_exp_f32 v43, v43 clamp
  v_exp_f32 v46, v46 clamp
  v_exp_f32 v47, v47 clamp
  v_exp_f32 v48, v48 clamp
  v_exp_f32 v49, v49 clamp
  v_exp_f32 v52, v52 clamp
  v_exp_f32 v53, v53 clamp
  v_exp_f32 v54, v54 clamp
  v_exp_f32 v55, v55 clamp
  v_exp_f32 v58, v58 clamp
  v_exp_f32 v59, v59 clamp
  v_exp_f32 v60, v60 clamp
  v_exp_f32 v61, v61 clamp
  v_pk_fma_f32 v[40:41], v[40:41], v[132:133], v[112:113]
  v_pk_fma_f32 v[42:43], v[42:43], v[134:135], v[114:115]
  v_pk_fma_f32 v[46:47], v[46:47], v[132:133], v[112:113]
  v_pk_fma_f32 v[48:49], v[48:49], v[134:135], v[114:115]
  v_pk_fma_f32 v[52:53], v[52:53], v[132:133], v[112:113]
  v_pk_fma_f32 v[54:55], v[54:55], v[134:135], v[114:115]
  v_pk_fma_f32 v[58:59], v[58:59], v[132:133], v[112:113]
  v_pk_fma_f32 v[60:61], v[60:61], v[134:135], v[114:115]
  v_pk_mul_f32 v[44:45], v[140:141], v[42:43]
  v_pk_mul_f32 v[50:51], v[144:145], v[48:49]
  v_pk_mul_f32 v[56:57], v[148:149], v[54:55]
  v_pk_mul_f32 v[62:63], v[152:153], v[60:61]
  v_pk_fma_f32 v[44:45], v[142:143], v[40:41], v[44:45]
  v_pk_fma_f32 v[50:51], v[146:147], v[46:47], v[50:51]
  v_pk_fma_f32 v[56:57], v[150:151], v[52:53], v[56:57]
  v_pk_fma_f32 v[62:63], v[154:155], v[58:59], v[62:63]
  v_pk_mul_f32 v[40:41], v[40:41], v[42:43]
  v_pk_mul_f32 v[46:47], v[46:47], v[48:49]
  v_pk_mul_f32 v[52:53], v[52:53], v[54:55]
  v_pk_mul_f32 v[58:59], v[58:59], v[60:61]
  v_rcp_f32 v40, v40
  v_rcp_f32 v41, v41
  v_rcp_f32 v46, v46
  v_rcp_f32 v47, v47
  v_rcp_f32 v52, v52
  v_rcp_f32 v53, v53
  v_rcp_f32 v58, v58
  v_rcp_f32 v59, v59
  v_pk_mul_f32 v[16:17], v[40:41], v[44:45]
  v_pk_mul_f32 v[18:19], v[46:47], v[50:51]
  v_pk_mul_f32 v[20:21], v[52:53], v[56:57]
  v_pk_mul_f32 v[22:23], v[58:59], v[62:63]
  v_pk_mul_f32 v[64:65], v[156:157], v[156:157]
  v_pk_mul_f32 v[66:67], v[158:159], v[158:159]
  v_pk_mul_f32 v[70:71], v[160:161], v[160:161]
  v_pk_mul_f32 v[72:73], v[162:163], v[162:163]
  v_pk_mul_f32 v[76:77], v[164:165], v[164:165]
  v_pk_mul_f32 v[78:79], v[166:167], v[166:167]
  v_pk_mul_f32 v[82:83], v[168:169], v[168:169]
  v_pk_mul_f32 v[84:85], v[170:171], v[170:171]
  v_pk_fma_f32 v[64:65], v[64:65], v[234:235], v[232:233]
  v_pk_fma_f32 v[66:67], v[66:67], v[234:235], v[232:233]
  v_pk_fma_f32 v[70:71], v[70:71], v[234:235], v[232:233]
  v_pk_fma_f32 v[72:73], v[72:73], v[234:235], v[232:233]
  v_pk_fma_f32 v[76:77], v[76:77], v[234:235], v[232:233]
  v_pk_fma_f32 v[78:79], v[78:79], v[234:235], v[232:233]
  v_pk_fma_f32 v[82:83], v[82:83], v[234:235], v[232:233]
  v_pk_fma_f32 v[84:85], v[84:85], v[234:235], v[232:233]
  v_pk_fma_f32 v[64:65], v[64:65], v[156:157], v[236:237]
  v_pk_fma_f32 v[66:67], v[66:67], v[158:159], v[236:237]
  v_pk_fma_f32 v[70:71], v[70:71], v[160:161], v[236:237]
  v_pk_fma_f32 v[72:73], v[72:73], v[162:163], v[236:237]
  v_pk_fma_f32 v[76:77], v[76:77], v[164:165], v[236:237]
  v_pk_fma_f32 v[78:79], v[78:79], v[166:167], v[236:237]
  v_pk_fma_f32 v[82:83], v[82:83], v[168:169], v[236:237]
  v_pk_fma_f32 v[84:85], v[84:85], v[170:171], v[236:237]
  v_exp_f32 v64, v64 clamp
  v_exp_f32 v65, v65 clamp
  v_exp_f32 v66, v66 clamp
  v_exp_f32 v67, v67 clamp
  v_exp_f32 v70, v70 clamp
  v_exp_f32 v71, v71 clamp
  v_exp_f32 v72, v72 clamp
  v_exp_f32 v73, v73 clamp
  v_exp_f32 v76, v76 clamp
  v_exp_f32 v77, v77 clamp
  v_exp_f32 v78, v78 clamp
  v_exp_f32 v79, v79 clamp
  v_exp_f32 v82, v82 clamp
  v_exp_f32 v83, v83 clamp
  v_exp_f32 v84, v84 clamp
  v_exp_f32 v85, v85 clamp
  v_pk_fma_f32 v[64:65], v[64:65], v[136:137], v[116:117]
  v_pk_fma_f32 v[66:67], v[66:67], v[138:139], v[118:119]
  v_pk_fma_f32 v[70:71], v[70:71], v[136:137], v[116:117]
  v_pk_fma_f32 v[72:73], v[72:73], v[138:139], v[118:119]
  v_pk_fma_f32 v[76:77], v[76:77], v[136:137], v[116:117]
  v_pk_fma_f32 v[78:79], v[78:79], v[138:139], v[118:119]
  v_pk_fma_f32 v[82:83], v[82:83], v[136:137], v[116:117]
  v_pk_fma_f32 v[84:85], v[84:85], v[138:139], v[118:119]
  v_pk_mul_f32 v[68:69], v[156:157], v[66:67]
  v_pk_mul_f32 v[74:75], v[160:161], v[72:73]
  v_pk_mul_f32 v[80:81], v[164:165], v[78:79]
  v_pk_mul_f32 v[86:87], v[168:169], v[84:85]
  v_pk_fma_f32 v[68:69], v[158:159], v[64:65], v[68:69]
  v_pk_fma_f32 v[74:75], v[162:163], v[70:71], v[74:75]
  v_pk_fma_f32 v[80:81], v[166:167], v[76:77], v[80:81]
  v_pk_fma_f32 v[86:87], v[170:171], v[82:83], v[86:87]
  v_pk_mul_f32 v[64:65], v[64:65], v[66:67]
  v_pk_mul_f32 v[70:71], v[70:71], v[72:73]
  v_pk_mul_f32 v[76:77], v[76:77], v[78:79]
  v_pk_mul_f32 v[82:83], v[82:83], v[84:85]
  v_rcp_f32 v64, v64
  v_rcp_f32 v65, v65
  v_rcp_f32 v70, v70
  v_rcp_f32 v71, v71
  v_rcp_f32 v76, v76
  v_rcp_f32 v77, v77
  v_rcp_f32 v82, v82
  v_rcp_f32 v83, v83
  v_pk_fma_f32 v[16:17], v[64:65], v[68:69], v[16:17]
  v_pk_fma_f32 v[18:19], v[70:71], v[74:75], v[18:19]
  v_pk_fma_f32 v[20:21], v[76:77], v[80:81], v[20:21]
  v_pk_fma_f32 v[22:23], v[82:83], v[86:87], v[22:23]
  v_pk_mul_f32 v[40:41], v[172:173], v[172:173]
  v_pk_mul_f32 v[42:43], v[174:175], v[174:175]
  v_pk_mul_f32 v[46:47], v[176:177], v[176:177]
  v_pk_mul_f32 v[48:49], v[178:179], v[178:179]
  v_pk_mul_f32 v[52:53], v[180:181], v[180:181]
  v_pk_mul_f32 v[54:55], v[182:183], v[182:183]
  v_pk_mul_f32 v[58:59], v[184:185], v[184:185]
  v_pk_mul_f32 v[60:61], v[186:187], v[186:187]
  v_pk_fma_f32 v[40:41], v[40:41], v[234:235], v[232:233]
  v_pk_fma_f32 v[42:43], v[42:43], v[234:235], v[232:233]
  v_pk_fma_f32 v[46:47], v[46:47], v[234:235], v[232:233]
  v_pk_fma_f32 v[48:49], v[48:49], v[234:235], v[232:233]
  v_pk_fma_f32 v[52:53], v[52:53], v[234:235], v[232:233]
  v_pk_fma_f32 v[54:55], v[54:55], v[234:235], v[232:233]
  v_pk_fma_f32 v[58:59], v[58:59], v[234:235], v[232:233]
  v_pk_fma_f32 v[60:61], v[60:61], v[234:235], v[232:233]
  v_pk_fma_f32 v[40:41], v[40:41], v[172:173], v[236:237]
  v_pk_fma_f32 v[42:43], v[42:43], v[174:175], v[236:237]
  v_pk_fma_f32 v[46:47], v[46:47], v[176:177], v[236:237]
  v_pk_fma_f32 v[48:49], v[48:49], v[178:179], v[236:237]
  v_pk_fma_f32 v[52:53], v[52:53], v[180:181], v[236:237]
  v_pk_fma_f32 v[54:55], v[54:55], v[182:183], v[236:237]
  v_pk_fma_f32 v[58:59], v[58:59], v[184:185], v[236:237]
  v_pk_fma_f32 v[60:61], v[60:61], v[186:187], v[236:237]
  v_exp_f32 v40, v40 clamp
  v_exp_f32 v41, v41 clamp
  v_exp_f32 v42, v42 clamp
  v_exp_f32 v43, v43 clamp
  v_exp_f32 v46, v46 clamp
  v_exp_f32 v47, v47 clamp
  v_exp_f32 v48, v48 clamp
  v_exp_f32 v49, v49 clamp
  v_exp_f32 v52, v52 clamp
  v_exp_f32 v53, v53 clamp
  v_exp_f32 v54, v54 clamp
  v_exp_f32 v55, v55 clamp
  v_exp_f32 v58, v58 clamp
  v_exp_f32 v59, v59 clamp
  v_exp_f32 v60, v60 clamp
  v_exp_f32 v61, v61 clamp
  v_pk_fma_f32 v[40:41], v[40:41], v[220:221], v[120:121]
  v_pk_fma_f32 v[42:43], v[42:43], v[222:223], v[122:123]
  v_pk_fma_f32 v[46:47], v[46:47], v[220:221], v[120:121]
  v_pk_fma_f32 v[48:49], v[48:49], v[222:223], v[122:123]
  v_pk_fma_f32 v[52:53], v[52:53], v[220:221], v[120:121]
  v_pk_fma_f32 v[54:55], v[54:55], v[222:223], v[122:123]
  v_pk_fma_f32 v[58:59], v[58:59], v[220:221], v[120:121]
  v_pk_fma_f32 v[60:61], v[60:61], v[222:223], v[122:123]
  v_pk_mul_f32 v[44:45], v[172:173], v[42:43]
  v_pk_mul_f32 v[50:51], v[176:177], v[48:49]
  v_pk_mul_f32 v[56:57], v[180:181], v[54:55]
  v_pk_mul_f32 v[62:63], v[184:185], v[60:61]
  v_pk_fma_f32 v[44:45], v[174:175], v[40:41], v[44:45]
  v_pk_fma_f32 v[50:51], v[178:179], v[46:47], v[50:51]
  v_pk_fma_f32 v[56:57], v[182:183], v[52:53], v[56:57]
  v_pk_fma_f32 v[62:63], v[186:187], v[58:59], v[62:63]
  v_pk_mul_f32 v[40:41], v[40:41], v[42:43]
  v_pk_mul_f32 v[46:47], v[46:47], v[48:49]
  v_pk_mul_f32 v[52:53], v[52:53], v[54:55]
  v_pk_mul_f32 v[58:59], v[58:59], v[60:61]
  v_rcp_f32 v40, v40
  v_rcp_f32 v41, v41
  v_rcp_f32 v46, v46
  v_rcp_f32 v47, v47
  v_rcp_f32 v52, v52
  v_rcp_f32 v53, v53
  v_rcp_f32 v58, v58
  v_rcp_f32 v59, v59
  v_pk_fma_f32 v[16:17], v[40:41], v[44:45], v[16:17]
  v_pk_fma_f32 v[18:19], v[46:47], v[50:51], v[18:19]
  v_pk_fma_f32 v[20:21], v[52:53], v[56:57], v[20:21]
  v_pk_fma_f32 v[22:23], v[58:59], v[62:63], v[22:23]
  v_pk_mul_f32 v[64:65], v[188:189], v[188:189]
  v_pk_mul_f32 v[66:67], v[190:191], v[190:191]
  v_pk_mul_f32 v[70:71], v[192:193], v[192:193]
  v_pk_mul_f32 v[72:73], v[194:195], v[194:195]
  v_pk_mul_f32 v[76:77], v[196:197], v[196:197]
  v_pk_mul_f32 v[78:79], v[198:199], v[198:199]
  v_pk_mul_f32 v[82:83], v[200:201], v[200:201]
  v_pk_mul_f32 v[84:85], v[202:203], v[202:203]
  v_pk_fma_f32 v[64:65], v[64:65], v[234:235], v[232:233]
  v_pk_fma_f32 v[66:67], v[66:67], v[234:235], v[232:233]
  v_pk_fma_f32 v[70:71], v[70:71], v[234:235], v[232:233]
  v_pk_fma_f32 v[72:73], v[72:73], v[234:235], v[232:233]
  v_pk_fma_f32 v[76:77], v[76:77], v[234:235], v[232:233]
  v_pk_fma_f32 v[78:79], v[78:79], v[234:235], v[232:233]
  v_pk_fma_f32 v[82:83], v[82:83], v[234:235], v[232:233]
  v_pk_fma_f32 v[84:85], v[84:85], v[234:235], v[232:233]
  v_pk_fma_f32 v[64:65], v[64:65], v[188:189], v[236:237]
  v_pk_fma_f32 v[66:67], v[66:67], v[190:191], v[236:237]
  v_pk_fma_f32 v[70:71], v[70:71], v[192:193], v[236:237]
  v_pk_fma_f32 v[72:73], v[72:73], v[194:195], v[236:237]
  v_pk_fma_f32 v[76:77], v[76:77], v[196:197], v[236:237]
  v_pk_fma_f32 v[78:79], v[78:79], v[198:199], v[236:237]
  v_pk_fma_f32 v[82:83], v[82:83], v[200:201], v[236:237]
  v_pk_fma_f32 v[84:85], v[84:85], v[202:203], v[236:237]
  v_exp_f32 v64, v64 clamp
  v_exp_f32 v65, v65 clamp
  v_exp_f32 v66, v66 clamp
  v_exp_f32 v67, v67 clamp
  v_exp_f32 v70, v70 clamp
  v_exp_f32 v71, v71 clamp
  v_exp_f32 v72, v72 clamp
  v_exp_f32 v73, v73 clamp
  v_exp_f32 v76, v76 clamp
  v_exp_f32 v77, v77 clamp
  v_exp_f32 v78, v78 clamp
  v_exp_f32 v79, v79 clamp
  v_exp_f32 v82, v82 clamp
  v_exp_f32 v83, v83 clamp
  v_exp_f32 v84, v84 clamp
  v_exp_f32 v85, v85 clamp
  v_pk_fma_f32 v[64:65], v[64:65], v[224:225], v[124:125]
  v_pk_fma_f32 v[66:67], v[66:67], v[226:227], v[126:127]
  v_pk_fma_f32 v[70:71], v[70:71], v[224:225], v[124:125]
  v_pk_fma_f32 v[72:73], v[72:73], v[226:227], v[126:127]
  v_pk_fma_f32 v[76:77], v[76:77], v[224:225], v[124:125]
  v_pk_fma_f32 v[78:79], v[78:79], v[226:227], v[126:127]
  v_pk_fma_f32 v[82:83], v[82:83], v[224:225], v[124:125]
  v_pk_fma_f32 v[84:85], v[84:85], v[226:227], v[126:127]
  v_pk_mul_f32 v[68:69], v[188:189], v[66:67]
  v_pk_mul_f32 v[74:75], v[192:193], v[72:73]
  v_pk_mul_f32 v[80:81], v[196:197], v[78:79]
  v_pk_mul_f32 v[86:87], v[200:201], v[84:85]
  v_pk_fma_f32 v[68:69], v[190:191], v[64:65], v[68:69]
  v_pk_fma_f32 v[74:75], v[194:195], v[70:71], v[74:75]
  v_pk_fma_f32 v[80:81], v[198:199], v[76:77], v[80:81]
  v_pk_fma_f32 v[86:87], v[202:203], v[82:83], v[86:87]
  v_pk_mul_f32 v[64:65], v[64:65], v[66:67]
  v_pk_mul_f32 v[70:71], v[70:71], v[72:73]
  v_pk_mul_f32 v[76:77], v[76:77], v[78:79]
  v_pk_mul_f32 v[82:83], v[82:83], v[84:85]
  v_rcp_f32 v64, v64
  v_rcp_f32 v65, v65
  v_rcp_f32 v70, v70
  v_rcp_f32 v71, v71
  v_rcp_f32 v76, v76
  v_rcp_f32 v77, v77
  v_rcp_f32 v82, v82
  v_rcp_f32 v83, v83
  v_pk_fma_f32 v[16:17], v[64:65], v[68:69], v[16:17]
  v_pk_fma_f32 v[18:19], v[70:71], v[74:75], v[18:19]
  v_pk_fma_f32 v[20:21], v[76:77], v[80:81], v[20:21]
  v_pk_fma_f32 v[22:23], v[82:83], v[86:87], v[22:23]
  v_pk_mul_f32 v[40:41], v[204:205], v[204:205]
  v_pk_mul_f32 v[42:43], v[206:207], v[206:207]
  v_pk_mul_f32 v[46:47], v[208:209], v[208:209]
  v_pk_mul_f32 v[48:49], v[210:211], v[210:211]
  v_pk_mul_f32 v[52:53], v[212:213], v[212:213]
  v_pk_mul_f32 v[54:55], v[214:215], v[214:215]
  v_pk_mul_f32 v[58:59], v[216:217], v[216:217]
  v_pk_mul_f32 v[60:61], v[218:219], v[218:219]
  v_pk_fma_f32 v[40:41], v[40:41], v[234:235], v[232:233]
  v_pk_fma_f32 v[42:43], v[42:43], v[234:235], v[232:233]
  v_pk_fma_f32 v[46:47], v[46:47], v[234:235], v[232:233]
  v_pk_fma_f32 v[48:49], v[48:49], v[234:235], v[232:233]
  v_pk_fma_f32 v[52:53], v[52:53], v[234:235], v[232:233]
  v_pk_fma_f32 v[54:55], v[54:55], v[234:235], v[232:233]
  v_pk_fma_f32 v[58:59], v[58:59], v[234:235], v[232:233]
  v_pk_fma_f32 v[60:61], v[60:61], v[234:235], v[232:233]
  v_pk_fma_f32 v[40:41], v[40:41], v[204:205], v[236:237]
  v_pk_fma_f32 v[42:43], v[42:43], v[206:207], v[236:237]
  v_pk_fma_f32 v[46:47], v[46:47], v[208:209], v[236:237]
  v_pk_fma_f32 v[48:49], v[48:49], v[210:211], v[236:237]
  v_pk_fma_f32 v[52:53], v[52:53], v[212:213], v[236:237]
  v_pk_fma_f32 v[54:55], v[54:55], v[214:215], v[236:237]
  v_pk_fma_f32 v[58:59], v[58:59], v[216:217], v[236:237]
  v_pk_fma_f32 v[60:61], v[60:61], v[218:219], v[236:237]
  v_exp_f32 v40, v40 clamp
  v_exp_f32 v41, v41 clamp
  v_exp_f32 v42, v42 clamp
  v_exp_f32 v43, v43 clamp
  v_exp_f32 v46, v46 clamp
  v_exp_f32 v47, v47 clamp
  v_exp_f32 v48, v48 clamp
  v_exp_f32 v49, v49 clamp
  v_exp_f32 v52, v52 clamp
  v_exp_f32 v53, v53 clamp
  v_exp_f32 v54, v54 clamp
  v_exp_f32 v55, v55 clamp
  v_exp_f32 v58, v58 clamp
  v_exp_f32 v59, v59 clamp
  v_exp_f32 v60, v60 clamp
  v_exp_f32 v61, v61 clamp
  v_pk_fma_f32 v[40:41], v[40:41], v[228:229], v[128:129]
  v_pk_fma_f32 v[42:43], v[42:43], v[230:231], v[130:131]
  v_pk_fma_f32 v[46:47], v[46:47], v[228:229], v[128:129]
  v_pk_fma_f32 v[48:49], v[48:49], v[230:231], v[130:131]
  v_pk_fma_f32 v[52:53], v[52:53], v[228:229], v[128:129]
  v_pk_fma_f32 v[54:55], v[54:55], v[230:231], v[130:131]
  v_pk_fma_f32 v[58:59], v[58:59], v[228:229], v[128:129]
  v_pk_fma_f32 v[60:61], v[60:61], v[230:231], v[130:131]
  v_pk_mul_f32 v[44:45], v[204:205], v[42:43]
  v_pk_mul_f32 v[50:51], v[208:209], v[48:49]
  v_pk_mul_f32 v[56:57], v[212:213], v[54:55]
  v_pk_mul_f32 v[62:63], v[216:217], v[60:61]
  v_pk_fma_f32 v[44:45], v[206:207], v[40:41], v[44:45]
  v_pk_fma_f32 v[50:51], v[210:211], v[46:47], v[50:51]
  v_pk_fma_f32 v[56:57], v[214:215], v[52:53], v[56:57]
  v_pk_fma_f32 v[62:63], v[218:219], v[58:59], v[62:63]
  v_pk_mul_f32 v[40:41], v[40:41], v[42:43]
  v_pk_mul_f32 v[46:47], v[46:47], v[48:49]
  v_pk_mul_f32 v[52:53], v[52:53], v[54:55]
  v_pk_mul_f32 v[58:59], v[58:59], v[60:61]
  v_rcp_f32 v40, v40
  v_rcp_f32 v41, v41
  v_rcp_f32 v46, v46
  v_rcp_f32 v47, v47
  v_rcp_f32 v52, v52
  v_rcp_f32 v53, v53
  v_rcp_f32 v58, v58
  v_rcp_f32 v59, v59
  v_pk_fma_f32 v[16:17], v[40:41], v[44:45], v[16:17]
  v_pk_fma_f32 v[18:19], v[46:47], v[50:51], v[18:19]
  v_pk_fma_f32 v[20:21], v[52:53], v[56:57], v[20:21]
  v_pk_fma_f32 v[22:23], v[58:59], v[62:63], v[22:23]
  v_add_f32 v16, v16, v17
  v_add_f32 v18, v18, v19
  v_add_f32 v20, v20, v21
  v_add_f32 v22, v22, v23
  v_mul_f32 v16, v239, v16
  v_mul_f32 v18, v239, v18
  v_mul_f32 v20, v239, v20
  v_mul_f32 v22, v239, v22
  s_nop 0
  v_permlane32_swap_b32 v16, v20
  v_permlane32_swap_b32 v18, v22
  v_add_f32 v16, v16, v20
  v_add_f32 v18, v18, v22
  s_nop 1
  v_permlane16_swap_b32 v16, v18
  v_add_f32 v16, v16, v18
  ds_write_b32 v36, v16
  s_waitcnt lgkmcnt(0)
  s_cmp_eq_u32 s3, 0
  s_cbranch_scc1 L_dpub
  s_barrier
  s_endpgm
L_dpub:
  s_mov_b32 s60, s24
  s_and_b32 s61, s25, 0xffff
  s_mov_b32 s62, 268435456
  s_mov_b32 s63, 0x20000
  s_mov_b32 s64, s22
  s_and_b32 s65, s23, 0xffff
  s_mov_b32 s66, 256
  s_mov_b32 s67, 0x20000
  s_and_b32 s81, s2, 7
  s_waitcnt vmcnt(0)
  v_cmp_eq_u32 vcc, 0, v37
  s_nop 0
  s_bitcmp1_b32 vcc_lo, s81
  s_cbranch_scc0 L_dclr_ok
  s_mov_b32 s78, 0x40000
L_dclr:
  s_sub_u32 s78, s78, 1
  s_cbranch_scc1 L_dclr_ok
  v_lshlrev_b32 v37, 2, v0
  v_and_b32 v37, 31, v37
  buffer_load_dword v37, v37, s[64:67], 0 offen offset:128 sc1
  s_waitcnt vmcnt(0)
  v_cmp_eq_u32 vcc, 0, v37
  s_nop 0
  s_bitcmp1_b32 vcc_lo, s81
  s_cbranch_scc1 L_dclr
L_dclr_ok:
  s_barrier
  ds_read_b64 v[64:65], v2 offset:0
  ds_read_b64 v[66:67], v2 offset:512
  ds_read_b64 v[68:69], v2 offset:1024
  ds_read_b64 v[70:71], v2 offset:1536
  s_waitcnt lgkmcnt(2)
  v_pk_add_f32 v[64:65], v[64:65], v[66:67]
  s_waitcnt lgkmcnt(0)
  v_pk_add_f32 v[68:69], v[68:69], v[70:71]
  v_pk_add_f32 v[64:65], v[64:65], v[68:69]
  v_and_b32 v64, -2, v64
  v_and_b32 v65, -2, v65
  buffer_store_dwordx2 v[64:65], v3, s[60:63], s69 offen sc1
  s_endpgm
L_cin:
  s_and_b32 s68, s26, 3
  s_mul_i32 s68, s68, 3
  s_add_u32 s27, s68, s27
  s_sub_u32 s27, s27, 6
  s_and_b32 s79, s3, 3
  s_lshr_b32 s84, s3, 2
  s_lshl_b32 s100, s27, 3
  s_add_u32 s100, s100, s3
  s_mul_i32 s68, s100, 1280
  v_min_u32 v40, 9, v0
  v_lshlrev_b32 v40, 7, v40
  v_lshlrev_b32 v48, 4, v0
  s_lshl_b32 s95, s79, 10
  s_cmp_eq_u32 s79, 2
  s_cselect_b64 s[82:83], 0x3fffff, -1
  s_cmp_eq_u32 s79, 3
  s_cselect_b32 s96, 0, 32768
  s_add_u32 s96, s96, s95
  s_mul_i32 s69, s27, 2979
  s_lshr_b32 s69, s69, 6
  s_mul_i32 s98, s27, 44
  s_and_b32 s70, s2, 7
  s_add_u32 s85, s98, s3
  s_lshl_b32 s85, s85, 2
  s_lshl_b32 s98, s70, 14
  s_add_u32 s85, s85, s98
  s_add_u32 s85, s85, 10240
  s_mul_i32 s98, s27, 44
  s_lshl_b32 s77, s70, 9
  s_add_u32 s94, s77, s98
  s_add_u32 s77, s77, s69
  s_add_u32 s94, s94, s3
  s_mul_i32 s94, s94, 104
  s_lshl_b32 s98, s27, 2
  s_add_u32 s98, s98, s3
  s_add_u32 s98, s98, s70
  s_and_b32 s98, s98, 7
  s_mul_i32 s98, s98, 16640
  s_add_u32 s98, s98, 12288
  s_sub_u32 s72, 6, s84
  s_lshl_b32 s99, s84, 1
  s_mov_b32 s26, -1
  v_lshrrev_b32 v43, 3, v0
  v_min_u32 v43, 6, v43
  v_lshlrev_b32 v17, 4, v43
  s_mul_i32 s70, s70, 88
  s_add_u32 s70, s100, s70
  s_mov_b32 s71, 704
  v_mov_b32 v44, s70
  v_mad_u32_u24 v19, v0, s71, v44
  s_mul_i32 s70, s100, 104
  s_sub_u32 s70, s70, 313
  v_min_u32 v44, 16, v0
  v_mul_u32_u24 v45, 26, v44
  v_add_u32 v45, s70, v45
  v_cmp_lt_u32 vcc, 12, v44
  s_nop 1
  v_cndmask_b32 v19, v19, v45, vcc
  v_lshlrev_b32 v19, 7, v19
  s_mov_b32 s101, 212992
  v_mov_b32 v2, 110464
  v_lshlrev_b32 v1, 20, v0
  v_add_u32 v1, 110464, v1
  v_and_b32 v44, 7, v0
  v_lshlrev_b32 v18, 4, v44
  v_and_b32 v44, 15, v0
  v_lshl_add_u32 v44, v44, 2, v2
  v_mov_b32 v3, 0
  ds_write_b32 v44, v3
  v_lshrrev_b32 v41, 5, v0
  v_and_b32 v42, 31, v0
  s_waitcnt lgkmcnt(0)
  v_mov_b32 v3, 1
  s_mov_b32 s32, s6
  s_and_b32 s33, s7, 0xffff
  s_mov_b32 s34, 12800000
  s_mov_b32 s35, 0x20000
  v_mov_b32 v45, s80
  buffer_load_dword v255, v45, s[32:35], 0 offen
  s_mov_b32 s36, s8
  s_and_b32 s37, s9, 0xffff
  s_mov_b32 s38, 105456
  s_mov_b32 s39, 0x20000
  buffer_load_dword v255, v40, s[36:39], s68 offen
  s_mov_b32 s44, s12
  s_and_b32 s45, s13, 0xffff
  s_mov_b32 s46, 5537792
  s_mov_b32 s47, 0x20000
  s_barrier
  s_mov_b64 exec, 131071
  buffer_load_dword v255, v19, s[44:47], s101 offen
  s_mov_b64 exec, -1
  s_add_u32 s101, s101, 1171456
  s_mov_b32 s28, s4
  s_and_b32 s29, s5, 0xffff
  s_mov_b32 s30, 425984
  s_mov_b32 s31, 0x20000
  v_add_u32 v248, s95, v48
  v_cmp_gt_u32 vcc, 1152, v248
  s_nop 1
  v_cndmask_b32 v248, 0, 4, vcc
  v_add_u32 v248, v248, v48
  s_cmp_lg_u32 s84, 0
  s_cbranch_scc1 L_g1a
  s_mov_b32 s40, s10
  s_and_b32 s41, s11, 0xffff
  s_mov_b32 s42, 156
  s_mov_b32 s43, 0x20000
  s_mov_b32 m0, 110272
  s_mov_b64 exec, 0x7ff
  buffer_load_dwordx4 v48, s[40:43], 0 offen lds
  s_mov_b64 exec, -1
  s_add_u32 m0, s95, 71552
  s_add_u32 s81, s95, 70304
  buffer_load_dwordx4 v48, s[36:39], s81 offen lds
  s_add_u32 m0, s95, 75648
  s_add_u32 s81, s95, 74400
  buffer_load_dwordx4 v48, s[36:39], s81 offen lds
  s_add_u32 m0, s95, 79744
  s_add_u32 s81, s95, 78496
  buffer_load_dwordx4 v48, s[36:39], s81 offen lds
  s_add_u32 m0, s95, 83840
  s_add_u32 s81, s95, 82592
  buffer_load_dwordx4 v48, s[36:39], s81 offen lds
  s_add_u32 m0, s95, 87936
  s_add_u32 s81, s95, 86688
  buffer_load_dwordx4 v48, s[36:39], s81 offen lds
  s_add_u32 m0, s95, 92032
  s_add_u32 s81, s95, 90784
  buffer_load_dwordx4 v48, s[36:39], s81 offen lds
  s_add_u32 m0, s95, 96128
  s_add_u32 s81, s95, 94880
  buffer_load_dwordx4 v48, s[36:39], s81 offen lds
  s_add_u32 m0, s95, 100224
  s_add_u32 s81, s95, 98976
  buffer_load_dwordx4 v48, s[36:39], s81 offen lds
  s_add_u32 m0, s96, 71552
  s_add_u32 s81, s96, 70304
  s_mov_b64 exec, s[82:83]
  buffer_load_dwordx4 v48, s[36:39], s81 offen lds
  s_mov_b64 exec, -1
  s_add_u32 m0, s95, 36288
  s_add_u32 s81, s95, 35152
  buffer_load_dwordx4 v48, s[36:39], s81 offen lds
  s_add_u32 m0, s95, 40384
  s_add_u32 s81, s95, 39248
  buffer_load_dwordx4 v48, s[36:39], s81 offen lds
  s_add_u32 m0, s95, 44480
  s_add_u32 s81, s95, 43344
  buffer_load_dwordx4 v48, s[36:39], s81 offen lds
  s_add_u32 m0, s95, 48576
  s_add_u32 s81, s95, 47440
  buffer_load_dwordx4 v48, s[36:39], s81 offen lds
  s_branch L_addrc
L_g1a:
  s_setprio 1
  v_bfe_u32 v43, v0, 2, 2
  v_lshl_add_u32 v43, v41, 3, v43
  v_bfe_u32 v44, v0, 4, 1
  v_lshlrev_b32 v44, 5, v44
  v_and_b32 v45, 3, v0
  v_lshl_add_u32 v44, v45, 3, v44
  v_lshl_add_u32 v240, v43, 6, v44
  v_add_u32 v240, 106816, v240
  s_lshl_b32 s68, s79, 6
  s_add_u32 s68, s68, 36288
  v_add_u32 v44, s68, v44
  v_mul_u32_u24 v45, 1352, v43
  v_add_u32 v241, v44, v45
  v_add_u32 v45, 16, v43
  v_min_u32 v45, 25, v45
  v_mul_u32_u24 v45, 1352, v45
  v_add_u32 v242, v44, v45
  v_add_u32 v45, 20, v43
  v_min_u32 v45, 25, v45
  v_mul_u32_u24 v45, 1352, v45
  v_add_u32 v243, v44, v45
  s_lshl_b32 s68, s79, 5
  v_add_u32 v246, s68, v42
  v_mul_u32_u24 v43, 52, v246
  v_lshl_add_u32 v43, v41, 3, v43
  v_add_u32 v244, 71552, v43
  v_lshlrev_b32 v43, 1, v246
  v_add_u32 v245, 108864, v43
  v_mov_b32 v216, 0
  v_mov_b32 v217, 0
  v_lshlrev_b32 v43, 3, v0
  v_add_u32 v44, 106816, v43
  s_lshl_b32 s68, s79, 9
  v_add_u32 v44, s68, v44
  ds_write_b64 v44, v[216:217]
  v_lshl_add_u32 v43, v41, 7, v246
  s_mov_b32 s69, 2521
  s_mov_b32 s70, 106816
  v_mul_u32_u24 v44, s69, v43
  v_lshrrev_b32 v44, 16, v44
  v_mad_u32_u24 v44, v44, 12, s70
  v_lshl_add_u32 v68, v43, 1, v44
  v_add_u32 v43, 256, v43
  v_mul_u32_u24 v44, s69, v43
  v_lshrrev_b32 v44, 16, v44
  v_mad_u32_u24 v44, v44, 12, s70
  v_lshl_add_u32 v69, v43, 1, v44
  v_add_u32 v43, 256, v43
  v_mul_u32_u24 v44, s69, v43
  v_lshrrev_b32 v44, 16, v44
  v_mad_u32_u24 v44, v44, 12, s70
  v_lshl_add_u32 v70, v43, 1, v44
  v_mov_b32 v44, 676
  v_cmp_gt_u32 s[92:93], v44, v43
  v_add_u32 v43, 0, v246
  v_mul_u32_u24 v44, s69, v43
  v_lshrrev_b32 v44, 16, v44
  v_lshl_add_u32 v44, v44, 2, v244
  v_add_u32 v72, 0, v44
  v_add_u32 v43, 128, v246
  v_mul_u32_u24 v44, s69, v43
  v_lshrrev_b32 v44, 16, v44
  v_lshl_add_u32 v44, v44, 2, v244
  v_add_u32 v73, 6656, v44
  v_add_u32 v43, 256, v246
  v_mul_u32_u24 v44, s69, v43
  v_lshrrev_b32 v44, 16, v44
  v_lshl_add_u32 v44, v44, 2, v244
  v_add_u32 v74, 13312, v44
  v_add_u32 v43, 384, v246
  v_mul_u32_u24 v44, s69, v43
  v_lshrrev_b32 v44, 16, v44
  v_lshl_add_u32 v44, v44, 2, v244
  v_add_u32 v75, 19968, v44
  v_add_u32 v43, 512, v246
  v_mul_u32_u24 v44, s69, v43
  v_lshrrev_b32 v44, 16, v44
  v_lshl_add_u32 v44, v44, 2, v244
  v_add_u32 v76, 26624, v44
  v_add_u32 v43, 640, v246
  v_mul_u32_u24 v44, s69, v43
  v_lshrrev_b32 v44, 16, v44
  v_lshl_add_u32 v44, v44, 2, v244
  v_add_u32 v77, 33280, v44
  v_lshlrev_b32 v78, 4, v41
  v_add_u32 v78, 110376, v78
  v_lshlrev_b32 v79, 1, v0
  v_add_u32 v79, 110272, v79
  v_lshlrev_b32 v80, 6, v0
  v_add_u32 v80, 106868, v80
L_addrc:
  s_and_b32 s70, s3, 1
  s_lshl_b32 s70, s70, 1
  v_add_u32 v46, s70, v41
  v_min_u32 v43, 25, v42
  s_mul_i32 s68, s84, 4
  s_add_u32 s68, s68, 1352
  s_mul_i32 s69, s84, 70528
  s_add_u32 s69, s69, 1024
  v_mul_u32_u24 v44, s68, v43
  v_add_u32 v44, s69, v44
  v_lshlrev_b32 v247, 2, v43
  v_add_u32 v247, 70528, v247
  s_lshl_b32 s68, s84, 2
  s_xor_b32 s68, s68, 4
  v_lshrrev_b32 v45, 2, v43
  v_and_b32 v45, s68, v45
  v_add_u32 v44, v44, v45
  v_sub_u32 v247, v247, v45
  v_mul_u32_u24 v65, 52, v43
  v_lshl_add_u32 v65, v46, 1, v65
  v_add_u32 v65, 108864, v65
  v_lshlrev_b32 v67, 1, v43
  v_add_u32 v67, 110272, v67
  v_mad_u32_u24 v60, v46, 52, v44
  v_lshl_add_u32 v61, v46, 1, v44
  v_lshl_add_u32 v49, v46, 1, v60
  v_lshlrev_b32 v43, 3, v46
  s_mov_b32 s68, 0x01000100
  v_bfe_i32 v45, s68, v43, 8
  v_lshl_add_u32 v50, v45, 1, v60
  v_mad_i32_i24 v51, v45, 52, v61
  s_mov_b32 s68, 0xff00ff00
  v_bfe_i32 v45, s68, v43, 8
  v_lshl_add_u32 v52, v45, 1, v60
  v_mad_i32_i24 v53, v45, 52, v61
  s_mov_b32 s68, 0xff020100
  v_bfe_i32 v45, s68, v43, 8
  v_lshl_add_u32 v54, v45, 1, v60
  v_mad_i32_i24 v55, v45, 52, v61
  s_mov_b32 s68, 0x0b0a0100
  v_bfe_i32 v45, s68, v43, 8
  v_lshl_add_u32 v56, v45, 1, v60
  v_mad_i32_i24 v57, v45, 52, v61
  s_mov_b32 s68, 0xf3f20100
  v_bfe_i32 v45, s68, v43, 8
  v_lshl_add_u32 v58, v45, 1, v60
  v_mad_i32_i24 v59, v45, 52, v61
  s_mov_b32 s68, 0x00023600
  v_bfe_u32 v45, s68, v43, 8
  v_add_u32 v60, v45, v44
  v_add_u32 v61, 52, v44
  v_mov_b32 v47, 1048576
  v_cmp_eq_u32 vcc, 3, v46
  s_nop 1
  v_cndmask_b32 v60, v60, v47, vcc
  v_cndmask_b32 v67, v47, v67, vcc
  v_cmp_eq_u32 vcc, 2, v46
  s_nop 1
  v_cndmask_b32 v61, v47, v61, vcc
  v_cmp_gt_u32 vcc, 2, v46
  s_nop 1
  v_cndmask_b32 v64, v47, v65, vcc
  s_lshr_b32 s69, s79, 1
  s_mul_i32 s69, s69, 6144
  s_mul_i32 s68, s84, 6144
  v_lshlrev_b32 v45, 8, v46
  v_lshl_add_u32 v43, v42, 4, v45
  v_add_u32 v63, 1024, v43
  v_add_u32 v66, 36288, v43
  v_bfe_u32 v43, v0, 2, 2
  v_lshl_add_u32 v45, v43, 4, v45
  v_and_b32 v43, 3, v0
  v_lshl_add_u32 v44, v43, 6, v45
  v_add_u32 v44, 12288, v44
  v_cmp_lt_u32 vcc, 15, v42
  s_nop 1
  v_cndmask_b32 v63, v63, v44, vcc
  v_add_u32 v44, 16, v44
  v_cndmask_b32 v66, v66, v44, vcc
  v_lshl_add_u32 v44, v43, 5, v45
  v_add_u32 v44, 24560, v44
  v_cmp_lt_u32 vcc, 19, v42
  s_nop 1
  v_cndmask_b32 v63, v63, v44, vcc
  v_add_u32 v63, s69, v63
  v_add_u32 v66, s68, v66
  v_cmp_lt_u32 vcc, 25, v42
  s_nop 1
  v_cndmask_b32 v63, v63, v47, vcc
  v_cndmask_b32 v66, v66, v47, vcc
  v_mov_b32 v62, 0
  s_mul_i32 s74, s3, 4224
  s_add_u32 s74, s74, 111040
  s_mov_b32 s75, -39488
  v_add_u32 v28, 1024, v48
  v_and_b32 v43, 11, v0
  v_cmp_eq_u32 vcc, 11, v43
  s_nop 1
  v_cndmask_b32 v31, v28, v47, vcc
  v_and_b32 v43, 3, v0
  v_cmp_eq_u32 vcc, 0, v43
  s_nop 1
  v_cndmask_b32 v30, v31, v47, vcc
  v_lshrrev_b32 v46, 4, v0
  v_bfe_u32 v43, v0, 1, 3
  v_lshlrev_b32 v45, 4, v43
  v_add_u32 v45, 24576, v45
  v_and_b32 v43, 10, v0
  v_cmp_eq_u32 vcc, 10, v43
  s_nop 1
  v_cndmask_b32 v45, v45, v47, vcc
  v_and_b32 v44, 1, v0
  v_lshl_add_u32 v29, v46, 9, v45
  v_lshl_add_u32 v29, v44, 2, v29
  v_add_u32 v29, 1024, v29
  v_lshl_add_u32 v22, v46, 8, v45
  v_lshl_add_u32 v22, v44, 20, v22
  v_and_b32 v47, 15, v0
  s_mov_b32 s68, 1056
  v_lshlrev_b32 v43, 1, v47
  v_add_u32 v43, s74, v43
  v_mad_u32_u24 v7, v46, s68, v43
  s_lshl_b32 s68, s3, 10
  s_add_u32 s68, s68, 144832
  v_add_u32 v10, s68, v48
  v_add_u32 v43, 256, v48
  v_and_b32 v43, 1023, v43
  v_add_u32 v11, s68, v43
  v_xor_b32 v43, 512, v48
  v_add_u32 v12, s68, v43
  v_lshlrev_b32 v13, 4, v41
  v_mov_b32 v32, 0
  v_mov_b32 v33, 0
  v_mov_b32 v34, 0
  v_mov_b32 v35, 0
  v_mov_b32 v36, 0
  v_mov_b32 v37, 0
  v_mov_b32 v38, 0
  v_mov_b32 v39, 0
  v_mov_b32 v216, 0
  v_mov_b32 v217, 0
  v_mov_b32 v218, 0
  v_mov_b32 v219, 0
  v_mov_b32 v220, 0
  v_mov_b32 v221, 0
  v_mov_b32 v222, 0
  v_mov_b32 v223, 0
  v_mov_b32 v224, 0
  v_mov_b32 v225, 0
  v_mov_b32 v226, 0
  v_mov_b32 v227, 0
  v_mov_b32 v228, 0
  v_mov_b32 v229, 0
  v_mov_b32 v230, 0
  v_mov_b32 v231, 0
  v_mov_b32 v232, 0
  v_mov_b32 v233, 0
  v_mov_b32 v234, 0
  v_mov_b32 v235, 0
  v_mov_b32 v236, 0
  v_mov_b32 v237, 0
  v_mov_b32 v238, 0
  v_mov_b32 v239, 0
  v_mul_u32_u24 v44, 1056, v46
  v_bfe_u32 v45, v0, 2, 2
  v_lshl_add_u32 v44, v45, 7, v44
  v_and_b32 v45, 3, v0
  v_lshl_add_u32 v9, v45, 3, v44
  v_add_u32 v8, s74, v9
  v_and_b32 v45, 1, v0
  s_mov_b32 s68, 0xaaaaaaaa
  v_mul_lo_u32 v16, s68, v45
  v_or_b32 v16, 0x44444444, v16
  v_lshlrev_b32 v15, 1, v0
  v_add_u32 v15, s74, v15
  v_mov_b32 v14, 0x3f80
  ds_write_b16 v15, v14 offset:4064
  v_add_u32 v15, s75, v15
  s_mul_i32 s71, s3, 6
  s_add_u32 s77, s77, s71
  s_mul_i32 s77, s77, 104
  s_add_u32 s73, s77, 80
  s_add_u32 s77, s77, 16
  s_mov_b32 s71, 10923
  v_min_u32 v43, 35, v0
  v_mul_u32_u24 v44, s71, v43
  v_lshrrev_b32 v44, 16, v44
  v_mul_u32_u24 v44, 80, v44
  v_lshl_add_u32 v20, v43, 2, v44
  s_cmp_eq_u32 s84, 0
  s_cbranch_scc1 L_g0pf
  s_waitcnt lgkmcnt(0)
  ds_add_u32 v1, v3 offset:0
  s_sub_u32 s94, s94, 416
  buffer_load_dwordx4 v[204:207], v17, s[28:31], s94 offen offset:0
  s_add_u32 s94, s94, 416
  buffer_load_dwordx4 v[24:27], v17, s[28:31], s94 offen offset:0
  s_add_u32 s94, s94, 832
  s_sub_u32 s68, s77, 2496
  buffer_load_dword v208, v20, s[28:31], s68 offen
  buffer_load_dword v209, v20, s[28:31], s77 offen
  s_add_u32 s77, s77, 24
  buffer_load_dword v21, v20, s[28:31], s77 offen
  s_cmp_eq_u32 s77, s73
  s_cselect_b32 s73, 0x7000000, s73
  s_cselect_b32 s77, 0x7000000, s77
  s_add_u32 s77, s77, 24
  s_min_u32 s77, s77, s73
L_csync1:
  ds_read_b32 v4, v2 offset:0
  s_waitcnt lgkmcnt(0)
  v_cmp_gt_u32 vcc, 8, v4
  s_cbranch_vccnz L_csync1
  ds_read_b64 v[132:133], v78 offset:0
  ds_read_b64 v[134:135], v78 offset:8
  ds_read_b64 v[136:137], v78 offset:32
  ds_read_b64 v[138:139], v78 offset:40
  ds_read_u16 v45, v79 offset:52
  ds_read_b64_tr_b16 v[84:85], v241 offset:35264
  ds_read_b64_tr_b16 v[86:87], v241 offset:40672
  ds_read_b64_tr_b16 v[88:89], v242 offset:35264
  ds_read_b64_tr_b16 v[90:91], v243 offset:35264
  ds_read_b64_tr_b16 v[92:93], v241 offset:35520
  ds_read_b64_tr_b16 v[94:95], v241 offset:40928
  ds_read_b64_tr_b16 v[96:97], v242 offset:35520
  ds_read_b64_tr_b16 v[98:99], v243 offset:35520
  ds_read_b64_tr_b16 v[100:101], v241 offset:35776
  ds_read_b64_tr_b16 v[102:103], v241 offset:41184
  ds_read_b64_tr_b16 v[104:105], v242 offset:35776
  ds_read_b64_tr_b16 v[106:107], v243 offset:35776
  ds_read_b64_tr_b16 v[108:109], v241 offset:36032
  ds_read_b64_tr_b16 v[110:111], v241 offset:41440
  ds_read_b64_tr_b16 v[112:113], v242 offset:36032
  ds_read_b64_tr_b16 v[114:115], v243 offset:36032
  s_waitcnt lgkmcnt(14)
  v_mfma_f32_32x32x16_bf16 v[140:155], v[132:135], v[84:87], 0
  s_waitcnt lgkmcnt(12)
  v_mfma_f32_32x32x16_bf16 v[140:155], v[136:139], v[88:91], v[140:155]
  ds_read_b64_tr_b16 v[116:117], v241 offset:36288
  ds_read_b64_tr_b16 v[118:119], v241 offset:41696
  ds_read_b64_tr_b16 v[120:121], v242 offset:36288
  ds_read_b64_tr_b16 v[122:123], v243 offset:36288
  s_waitcnt lgkmcnt(14)
  v_mfma_f32_32x32x16_bf16 v[156:171], v[132:135], v[92:95], 0
  s_waitcnt lgkmcnt(12)
  v_mfma_f32_32x32x16_bf16 v[156:171], v[136:139], v[96:99], v[156:171]
  ds_read_b64_tr_b16 v[124:125], v241 offset:36544
  ds_read_b64_tr_b16 v[126:127], v241 offset:41952
  ds_read_b64_tr_b16 v[128:129], v242 offset:36544
  ds_read_b64_tr_b16 v[130:131], v243 offset:36544
  s_waitcnt lgkmcnt(14)
  v_mfma_f32_32x32x16_bf16 v[172:187], v[132:135], v[100:103], 0
  s_waitcnt lgkmcnt(12)
  v_mfma_f32_32x32x16_bf16 v[172:187], v[136:139], v[104:107], v[172:187]
  v_cvt_pk_bf16_f32 v81, v140, 0
  s_waitcnt lgkmcnt(10)
  v_mfma_f32_32x32x16_bf16 v[188:203], v[132:135], v[108:111], 0
  s_waitcnt lgkmcnt(8)
  v_mfma_f32_32x32x16_bf16 v[188:203], v[136:139], v[112:115], v[188:203]
  s_mov_b32 exec_lo, 0
  v_cvt_pk_bf16_f32 v81, v156, 0
  s_mov_b32 exec_lo, -1
  ds_write_b16 v68, v81
  s_waitcnt lgkmcnt(7)
  v_mfma_f32_32x32x16_bf16 v[140:155], v[132:135], v[116:119], 0
  s_waitcnt lgkmcnt(5)
  v_mfma_f32_32x32x16_bf16 v[140:155], v[136:139], v[120:123], v[140:155]
  v_cvt_pk_bf16_f32 v82, v172, 0
  s_waitcnt lgkmcnt(3)
  v_mfma_f32_32x32x16_bf16 v[156:171], v[132:135], v[124:127], 0
  s_waitcnt lgkmcnt(1)
  v_mfma_f32_32x32x16_bf16 v[156:171], v[136:139], v[128:131], v[156:171]
  s_mov_b32 exec_lo, 0
  v_cvt_pk_bf16_f32 v82, v188, 0
  s_mov_b32 exec_lo, -1
  ds_write_b16 v69, v82
  s_nop 2
  v_cvt_pk_bf16_f32 v83, v140, 0
  s_mov_b32 exec_lo, 0
  s_nop 2
  v_cvt_pk_bf16_f32 v83, v156, 0
  s_mov_b64 exec, s[92:93]
  ds_write_b16 v70, v83
  s_mov_b64 exec, 0x3ffffff
  ds_write_b16 v80, v45
  s_mov_b64 exec, -1
  s_waitcnt lgkmcnt(0)
  ds_add_u32 v1, v3 offset:32
  v_cmp_gt_u32 s[92:93], 36, v246
L_csync2:
  ds_read_b32 v4, v2 offset:4
  s_waitcnt lgkmcnt(0)
  v_cmp_gt_u32 vcc, 4, v4
  s_cbranch_vccnz L_csync2
  ds_read_b64_tr_b16 v[84:85], v241 offset:0
  ds_read_b64_tr_b16 v[86:87], v241 offset:5408
  ds_read_b64_tr_b16 v[88:89], v242 offset:0
  ds_read_b64_tr_b16 v[90:91], v243 offset:0
  ds_read_b64_tr_b16 v[92:93], v241 offset:256
  ds_read_b64_tr_b16 v[94:95], v241 offset:5664
  ds_read_b64_tr_b16 v[96:97], v242 offset:256
  ds_read_b64_tr_b16 v[98:99], v243 offset:256
  ds_read_b64_tr_b16 v[100:101], v241 offset:512
  ds_read_b64_tr_b16 v[102:103], v241 offset:5920
  ds_read_b64_tr_b16 v[104:105], v242 offset:512
  ds_read_b64_tr_b16 v[106:107], v243 offset:512
  ds_read_b64_tr_b16 v[108:109], v241 offset:768
  ds_read_b64_tr_b16 v[110:111], v241 offset:6176
  ds_read_b64_tr_b16 v[112:113], v242 offset:768
  ds_read_b64_tr_b16 v[114:115], v243 offset:768
  ds_read_b64_tr_b16 v[116:117], v241 offset:1024
  ds_read_b64_tr_b16 v[118:119], v241 offset:6432
  ds_read_b64_tr_b16 v[120:121], v242 offset:1024
  ds_read_b64_tr_b16 v[122:123], v243 offset:1024
  ds_read_b64_tr_b16 v[124:125], v241 offset:1280
  ds_read_b64_tr_b16 v[126:127], v241 offset:6688
  ds_read_b64_tr_b16 v[128:129], v242 offset:1280
  ds_read_b64_tr_b16 v[130:131], v243 offset:1280
L_csync3:
  ds_read_b32 v4, v2 offset:32
  s_waitcnt lgkmcnt(0)
  v_cmp_gt_u32 vcc, 4, v4
  s_cbranch_vccnz L_csync3
  s_setprio 0
  s_waitcnt vmcnt(2)
  v_lshlrev_b32 v208, 7, v208
  buffer_load_dword v255, v208, s[32:35], 0 offen
  s_waitcnt vmcnt(2)
  v_lshlrev_b32 v209, 7, v209
  buffer_load_dword v255, v209, s[32:35], 0 offen
  s_mov_b64 exec, 131071
  buffer_load_dword v255, v19, s[44:47], s101 offen
  s_mov_b64 exec, -1
  s_add_u32 s101, s101, 1171456
  ds_read_b64_tr_b16 v[132:133], v240 offset:0
  ds_read_b64_tr_b16 v[134:135], v240 offset:256
  ds_read_b64_tr_b16 v[136:137], v240 offset:1024
  ds_read_b64_tr_b16 v[138:139], v240 offset:1280
  s_waitcnt lgkmcnt(2)
  v_mfma_f32_32x32x16_bf16 v[140:155], v[132:135], v[84:87], 0
  s_waitcnt lgkmcnt(0)
  v_mfma_f32_32x32x16_bf16 v[140:155], v[136:139], v[88:91], v[140:155]
  v_mfma_f32_32x32x16_bf16 v[156:171], v[132:135], v[92:95], 0
  v_mfma_f32_32x32x16_bf16 v[156:171], v[136:139], v[96:99], v[156:171]
  v_mfma_f32_32x32x16_bf16 v[172:187], v[132:135], v[100:103], 0
  v_mfma_f32_32x32x16_bf16 v[172:187], v[136:139], v[104:107], v[172:187]
  s_nop 7
  v_cvt_pk_bf16_f32 v84, v140, v141
  v_cvt_pk_bf16_f32 v85, v142, v143
  v_cvt_pk_bf16_f32 v86, v144, v145
  v_cvt_pk_bf16_f32 v87, v146, v147
  v_cvt_pk_bf16_f32 v88, v148, v149
  v_cvt_pk_bf16_f32 v89, v150, v151
  v_cvt_pk_bf16_f32 v90, v152, v153
  v_cvt_pk_bf16_f32 v91, v154, v155
  ds_write2_b32 v72, v84, v85 offset0:0 offset1:1
  v_max3_f32 v62, v62, abs(v140), abs(v141)
  v_max3_f32 v62, v62, abs(v142), abs(v143)
  v_max3_f32 v62, v62, abs(v144), abs(v145)
  ds_write2_b32 v72, v86, v87 offset0:4 offset1:5
  v_max3_f32 v62, v62, abs(v146), abs(v147)
  v_max3_f32 v62, v62, abs(v148), abs(v149)
  ds_write2_b32 v72, v88, v89 offset0:8 offset1:9
  v_max3_f32 v62, v62, abs(v150), abs(v151)
  v_max3_f32 v62, v62, abs(v152), abs(v153)
  v_mfma_f32_32x32x16_bf16 v[188:203], v[132:135], v[108:111], 0
  v_mfma_f32_32x32x16_bf16 v[188:203], v[136:139], v[112:115], v[188:203]
  v_cvt_pk_bf16_f32 v92, v156, v157
  v_cvt_pk_bf16_f32 v93, v158, v159
  v_cvt_pk_bf16_f32 v94, v160, v161
  v_cvt_pk_bf16_f32 v95, v162, v163
  v_cvt_pk_bf16_f32 v96, v164, v165
  v_cvt_pk_bf16_f32 v97, v166, v167
  v_cvt_pk_bf16_f32 v98, v168, v169
  v_cvt_pk_bf16_f32 v99, v170, v171
  ds_write2_b32 v73, v92, v93 offset0:0 offset1:1
  v_max3_f32 v62, v62, abs(v156), abs(v157)
  v_max3_f32 v62, v62, abs(v158), abs(v159)
  v_max3_f32 v62, v62, abs(v160), abs(v161)
  ds_write2_b32 v73, v94, v95 offset0:4 offset1:5
  v_max3_f32 v62, v62, abs(v162), abs(v163)
  v_max3_f32 v62, v62, abs(v164), abs(v165)
  ds_write2_b32 v73, v96, v97 offset0:8 offset1:9
  v_max3_f32 v62, v62, abs(v166), abs(v167)
  v_max3_f32 v62, v62, abs(v168), abs(v169)
  v_mfma_f32_32x32x16_bf16 v[140:155], v[132:135], v[116:119], 0
  v_mfma_f32_32x32x16_bf16 v[140:155], v[136:139], v[120:123], v[140:155]
  v_cvt_pk_bf16_f32 v100, v172, v173
  v_cvt_pk_bf16_f32 v101, v174, v175
  v_cvt_pk_bf16_f32 v102, v176, v177
  v_cvt_pk_bf16_f32 v103, v178, v179
  v_cvt_pk_bf16_f32 v104, v180, v181
  v_cvt_pk_bf16_f32 v105, v182, v183
  v_cvt_pk_bf16_f32 v106, v184, v185
  v_cvt_pk_bf16_f32 v107, v186, v187
  ds_write2_b32 v74, v100, v101 offset0:0 offset1:1
  v_max3_f32 v62, v62, abs(v172), abs(v173)
  v_max3_f32 v62, v62, abs(v174), abs(v175)
  v_max3_f32 v62, v62, abs(v176), abs(v177)
  ds_write2_b32 v74, v102, v103 offset0:4 offset1:5
  v_max3_f32 v62, v62, abs(v178), abs(v179)
  v_max3_f32 v62, v62, abs(v180), abs(v181)
  ds_write2_b32 v74, v104, v105 offset0:8 offset1:9
  v_max3_f32 v62, v62, abs(v182), abs(v183)
  v_max3_f32 v62, v62, abs(v184), abs(v185)
  v_mfma_f32_32x32x16_bf16 v[156:171], v[132:135], v[124:127], 0
  v_mfma_f32_32x32x16_bf16 v[156:171], v[136:139], v[128:131], v[156:171]
  v_cvt_pk_bf16_f32 v108, v188, v189
  v_cvt_pk_bf16_f32 v109, v190, v191
  v_cvt_pk_bf16_f32 v110, v192, v193
  v_cvt_pk_bf16_f32 v111, v194, v195
  v_cvt_pk_bf16_f32 v112, v196, v197
  v_cvt_pk_bf16_f32 v113, v198, v199
  v_cvt_pk_bf16_f32 v114, v200, v201
  v_cvt_pk_bf16_f32 v115, v202, v203
  ds_write2_b32 v75, v108, v109 offset0:0 offset1:1
  v_max3_f32 v62, v62, abs(v188), abs(v189)
  v_max3_f32 v62, v62, abs(v190), abs(v191)
  v_max3_f32 v62, v62, abs(v192), abs(v193)
  ds_write2_b32 v75, v110, v111 offset0:4 offset1:5
  v_max3_f32 v62, v62, abs(v194), abs(v195)
  v_max3_f32 v62, v62, abs(v196), abs(v197)
  ds_write2_b32 v75, v112, v113 offset0:8 offset1:9
  v_max3_f32 v62, v62, abs(v198), abs(v199)
  v_max3_f32 v62, v62, abs(v200), abs(v201)
  v_cvt_pk_bf16_f32 v116, v140, v141
  v_cvt_pk_bf16_f32 v117, v142, v143
  v_cvt_pk_bf16_f32 v118, v144, v145
  v_cvt_pk_bf16_f32 v119, v146, v147
  v_cvt_pk_bf16_f32 v120, v148, v149
  v_cvt_pk_bf16_f32 v121, v150, v151
  v_cvt_pk_bf16_f32 v122, v152, v153
  v_cvt_pk_bf16_f32 v123, v154, v155
  ds_write2_b32 v76, v116, v117 offset0:0 offset1:1
  v_max3_f32 v62, v62, abs(v140), abs(v141)
  v_max3_f32 v62, v62, abs(v142), abs(v143)
  v_max3_f32 v62, v62, abs(v144), abs(v145)
  ds_write2_b32 v76, v118, v119 offset0:4 offset1:5
  v_max3_f32 v62, v62, abs(v146), abs(v147)
  v_max3_f32 v62, v62, abs(v148), abs(v149)
  ds_write2_b32 v76, v120, v121 offset0:8 offset1:9
  v_max3_f32 v62, v62, abs(v150), abs(v151)
  v_max3_f32 v62, v62, abs(v152), abs(v153)
  v_cvt_pk_bf16_f32 v124, v156, v157
  v_cvt_pk_bf16_f32 v125, v158, v159
  v_cvt_pk_bf16_f32 v126, v160, v161
  v_cvt_pk_bf16_f32 v127, v162, v163
  v_cvt_pk_bf16_f32 v128, v164, v165
  v_cvt_pk_bf16_f32 v129, v166, v167
  v_cvt_pk_bf16_f32 v130, v168, v169
  v_cvt_pk_bf16_f32 v131, v170, v171
  s_mov_b64 exec, s[92:93]
  ds_write2_b32 v77, v124, v125 offset0:0 offset1:1
  v_max3_f32 v62, v62, abs(v156), abs(v157)
  v_max3_f32 v62, v62, abs(v158), abs(v159)
  v_max3_f32 v62, v62, abs(v160), abs(v161)
  ds_write2_b32 v77, v126, v127 offset0:4 offset1:5
  v_max3_f32 v62, v62, abs(v162), abs(v163)
  v_max3_f32 v62, v62, abs(v164), abs(v165)
  ds_write2_b32 v77, v128, v129 offset0:8 offset1:9
  v_max3_f32 v62, v62, abs(v166), abs(v167)
  v_max3_f32 v62, v62, abs(v168), abs(v169)
  s_mov_b32 exec_hi, 0
  ds_write_b32 v77, v130 offset:48
  ds_write_b16 v245, v131 offset:1280
  s_mov_b32 exec_lo, -1
  ds_write_b32 v76, v122 offset:48
  ds_write_b16 v245, v123 offset:1024
  ds_write_b32 v75, v114 offset:48
  ds_write_b16 v245, v115 offset:768
  ds_write_b32 v74, v106 offset:48
  ds_write_b16 v245, v107 offset:512
  ds_write_b32 v73, v98 offset:48
  ds_write_b16 v245, v99 offset:256
  ds_write_b32 v72, v90 offset:48
  ds_write_b16 v245, v91 offset:0
  s_mov_b64 exec, -1
  v_max_u32_dpp v62, v62, v62 row_shr:1 row_mask:0xf bank_mask:0xf
  s_nop 1
  v_max_u32_dpp v62, v62, v62 row_shr:2 row_mask:0xf bank_mask:0xf
  s_nop 1
  v_max_u32_dpp v62, v62, v62 row_shr:4 row_mask:0xf bank_mask:0xf
  s_nop 1
  v_max_u32_dpp v62, v62, v62 row_shr:8 row_mask:0xf bank_mask:0xf
  s_nop 1
  v_max_u32_dpp v62, v62, v62 row_bcast:15 row_mask:0xa bank_mask:0xf
  s_nop 1
  v_max_u32_dpp v62, v62, v62 row_bcast:31 row_mask:0xc bank_mask:0xf
  s_nop 0
  v_readlane_b32 s68, v62, 63
  s_nop 1
  v_mov_b32 v62, s68
  ds_max_u32 v1, v62 offset:28
  ds_add_u32 v1, v3 offset:24
  s_setprio 0
  v_lshl_add_u32 v24, v24, 7, v18
  v_lshl_add_u32 v25, v25, 7, v18
  s_mov_b32 exec_hi, 0x0000ffff
  v_lshl_add_u32 v26, v26, 7, v18
  v_lshl_add_u32 v27, v27, 7, v18
  s_mov_b32 exec_lo, 0
  s_mov_b32 exec_hi, 0xffff0000
  v_mov_b32 v27, v25
  v_mov_b32 v26, v25
  s_mov_b32 exec_hi, 0x00ff0000
  v_mov_b32 v26, v24
  s_mov_b64 exec, -1
  s_add_u32 m0, s74, 0
  s_nop 0
  buffer_load_dwordx4 v24, s[32:35], 0 offen lds
  s_add_u32 m0, s74, 1056
  s_nop 0
  buffer_load_dwordx4 v25, s[32:35], 0 offen lds
  s_add_u32 m0, s74, 2112
  s_nop 0
  buffer_load_dwordx4 v26, s[32:35], 0 offen lds
  s_add_u32 m0, s74, 3168
  s_mov_b32 exec_hi, 0x00ffffff
  buffer_load_dwordx4 v27, s[32:35], 0 offen lds
  s_mov_b32 exec_hi, -1
  v_lshl_add_u32 v204, v204, 7, v18
  v_lshl_add_u32 v205, v205, 7, v18
  s_mov_b32 exec_hi, 0x0000ffff
  v_lshl_add_u32 v206, v206, 7, v18
  v_lshl_add_u32 v207, v207, 7, v18
  s_mov_b32 exec_lo, 0
  s_mov_b32 exec_hi, 0xffff0000
  v_mov_b32 v207, v205
  v_mov_b32 v206, v205
  s_mov_b32 exec_hi, 0x00ff0000
  v_mov_b32 v206, v204
  s_mov_b64 exec, -1
  s_add_u32 m0, s74, -16896
  s_nop 0
  buffer_load_dwordx4 v204, s[32:35], 0 offen lds
  s_add_u32 m0, s74, -15840
  s_nop 0
  buffer_load_dwordx4 v205, s[32:35], 0 offen lds
  s_add_u32 m0, s74, -14784
  s_nop 0
  buffer_load_dwordx4 v206, s[32:35], 0 offen lds
  s_add_u32 m0, s74, -13728
  s_mov_b32 exec_hi, 0x00ffffff
  buffer_load_dwordx4 v207, s[32:35], 0 offen lds
  s_mov_b32 exec_hi, -1
  buffer_load_dwordx4 v[24:27], v17, s[28:31], s94 offen offset:0
  s_add_u32 s94, s94, 832
  s_branch L_uph
L_g0pf:
  s_waitcnt vmcnt(4) lgkmcnt(0)
  ds_add_u32 v1, v3 offset:0
  s_add_u32 m0, s95, 52672
  s_add_u32 s81, s95, 51536
  buffer_load_dwordx4 v48, s[36:39], s81 offen lds
  s_add_u32 m0, s95, 56768
  s_add_u32 s81, s95, 55632
  buffer_load_dwordx4 v48, s[36:39], s81 offen lds
  s_add_u32 m0, s95, 60864
  s_add_u32 s81, s95, 59728
  buffer_load_dwordx4 v48, s[36:39], s81 offen lds
  s_add_u32 m0, s95, 64960
  s_add_u32 s81, s95, 63824
  buffer_load_dwordx4 v48, s[36:39], s81 offen lds
  s_add_u32 m0, s96, 36288
  s_add_u32 s81, s96, 35152
  s_mov_b64 exec, s[82:83]
  buffer_load_dwordx4 v48, s[36:39], s81 offen lds
  s_mov_b64 exec, -1
  s_add_u32 m0, s95, 1024
  s_add_u32 s81, s95, 0
  buffer_load_dwordx4 v48, s[36:39], s81 offen lds
  s_add_u32 m0, s95, 5120
  s_add_u32 s81, s95, 4096
  buffer_load_dwordx4 v48, s[36:39], s81 offen lds
  s_add_u32 m0, s95, 9216
  s_add_u32 s81, s95, 8192
  buffer_load_dwordx4 v48, s[36:39], s81 offen lds
  s_add_u32 m0, s95, 13312
  s_add_u32 s81, s95, 12288
  buffer_load_dwordx4 v48, s[36:39], s81 offen lds
  s_waitcnt vmcnt(4) lgkmcnt(0)
  ds_add_u32 v1, v3 offset:4
  s_add_u32 m0, s95, 17408
  s_add_u32 s81, s95, 16384
  buffer_load_dwordx4 v48, s[36:39], s81 offen lds
  s_add_u32 m0, s95, 21504
  s_add_u32 s81, s95, 20476
  buffer_load_dwordx4 v248, s[36:39], s81 offen lds
  s_add_u32 m0, s95, 25600
  s_add_u32 s81, s95, 24572
  buffer_load_dwordx4 v48, s[36:39], s81 offen lds
  s_add_u32 m0, s95, 29696
  s_add_u32 s81, s95, 28668
  buffer_load_dwordx4 v48, s[36:39], s81 offen lds
  s_add_u32 m0, s96, 1024
  s_lshr_b32 s81, s96, 13
  s_sub_u32 s81, s96, s81
  s_mov_b64 exec, s[82:83]
  buffer_load_dwordx4 v48, s[36:39], s81 offen lds
  s_mov_b64 exec, -1
  s_add_u32 s94, s94, 832
  s_add_u32 s77, s77, 24
  buffer_load_dwordx4 v[24:27], v17, s[28:31], s94 offen offset:0
  s_add_u32 s94, s94, 832
  buffer_load_dword v21, v20, s[28:31], s77 offen
  s_cmp_eq_u32 s77, s73
  s_cselect_b32 s73, 0x7000000, s73
  s_cselect_b32 s77, 0x7000000, s77
  s_add_u32 s77, s77, 24
  s_min_u32 s77, s77, s73
  s_mov_b64 exec, 131071
  buffer_load_dword v255, v19, s[44:47], s101 offen
  s_mov_b64 exec, -1
  s_add_u32 s101, s101, 1171456
  s_waitcnt vmcnt(3) lgkmcnt(0)
  ds_add_u32 v1, v3 offset:8
  s_mov_b32 s97, 0
L_csync4:
  ds_read_b32 v4, v2 offset:8
  s_waitcnt lgkmcnt(0)
  v_cmp_gt_u32 vcc, 4, v4
  s_cbranch_vccnz L_csync4
  s_cmp_ge_u32 s79, 2
  s_cbranch_scc1 L_chunk2
L_chunk0:
  ds_read_u16_d16_hi v216, v49 offset:0
  ds_read_u16_d16_hi v218, v49 offset:648
  ds_read_u16_d16_hi v220, v49 offset:216
  ds_read_u16_d16_hi v222, v49 offset:864
  ds_read_u16_d16_hi v224, v49 offset:432
  ds_read_u16_d16_hi v226, v49 offset:1080
  ds_read_u16_d16_hi v228, v49 offset:8
  ds_read_u16_d16_hi v229, v49 offset:208
  ds_read_u16_d16_hi v230, v49 offset:656
  ds_read_u16_d16_hi v231, v49 offset:856
  ds_read_u16_d16_hi v232, v49 offset:32
  ds_read_u16_d16_hi v233, v49 offset:832
  ds_read_u16_d16_hi v234, v49 offset:632
  ds_read_u16_d16_hi v235, v49 offset:232
  s_waitcnt lgkmcnt(12)
  v_mov_b32 v85, v218
  v_mov_b32 v84, v216
  v_max3_f32 v62, v62, abs(v84), abs(v85)
  ds_read_u16_d16_hi v236, v49 offset:16
  ds_read_u16_d16_hi v237, v49 offset:416
  ds_read_u16_d16_hi v238, v49 offset:664
  ds_read_u16_d16_hi v239, v49 offset:1064
  s_waitcnt lgkmcnt(14)
  v_mov_b32 v87, v222
  v_mov_b32 v86, v220
  v_max3_f32 v62, v62, abs(v86), abs(v87)
  ds_read_u16_d16_hi v216, v49 offset:40
  ds_read_u16_d16_hi v217, v49 offset:1040
  ds_read_u16_d16_hi v218, v49 offset:640
  ds_read_u16_d16_hi v219, v49 offset:440
  s_waitcnt lgkmcnt(14)
  v_mov_b32 v89, v226
  v_mov_b32 v88, v224
  v_max3_f32 v62, v62, abs(v88), abs(v89)
  ds_read_u16_d16_hi v220, v49 offset:224
  ds_read_u16_d16_hi v221, v49 offset:424
  ds_read_u16_d16_hi v222, v49 offset:872
  ds_read_u16_d16_hi v223, v49 offset:1072
  s_waitcnt lgkmcnt(14)
  v_add_f32 v91, v230, v231
  v_add_f32 v90, v228, v229
  v_max3_f32 v62, v62, abs(v90), abs(v91)
  ds_read_u16_d16_hi v224, v49 offset:248
  ds_read_u16_d16_hi v225, v49 offset:1048
  ds_read_u16_d16_hi v226, v49 offset:848
  ds_read_u16_d16_hi v227, v49 offset:448
  s_waitcnt lgkmcnt(14)
  v_add_f32 v93, v234, v235
  v_add_f32 v92, v232, v233
  v_max3_f32 v62, v62, abs(v92), abs(v93)
  ds_read_u16_d16_hi v228, v50 offset:48
  ds_read_u16_d16_hi v229, v51 offset:1248
  ds_read_u16_d16_hi v230, v50 offset:672
  ds_read_u16_d16_hi v231, v51 offset:1272
  s_waitcnt lgkmcnt(14)
  v_add_f32 v95, v238, v239
  v_add_f32 v94, v236, v237
  v_max3_f32 v62, v62, abs(v94), abs(v95)
  ds_read_u16_d16_hi v232, v50 offset:256
  ds_read_u16_d16_hi v233, v51 offset:1256
  ds_read_u16_d16_hi v234, v50 offset:880
  ds_read_u16_d16_hi v235, v51 offset:1280
  s_waitcnt lgkmcnt(14)
  v_add_f32 v97, v218, v219
  v_add_f32 v96, v216, v217
  v_max3_f32 v62, v62, abs(v96), abs(v97)
  ds_read_u16_d16_hi v236, v50 offset:464
  ds_read_u16_d16_hi v237, v51 offset:1264
  ds_read_u16_d16_hi v238, v50 offset:1088
  ds_read_u16_d16_hi v239, v51 offset:1288
  s_waitcnt lgkmcnt(14)
  v_add_f32 v99, v222, v223
  v_add_f32 v98, v220, v221
  v_max3_f32 v62, v62, abs(v98), abs(v99)
  s_waitcnt lgkmcnt(12)
  v_add_f32 v101, v226, v227
  v_add_f32 v100, v224, v225
  v_max3_f32 v62, v62, abs(v100), abs(v101)
  s_waitcnt lgkmcnt(8)
  v_add_f32 v103, v230, v231
  v_add_f32 v102, v228, v229
  v_max3_f32 v62, v62, abs(v102), abs(v103)
  s_waitcnt lgkmcnt(4)
  v_add_f32 v105, v234, v235
  v_add_f32 v104, v232, v233
  v_max3_f32 v62, v62, abs(v104), abs(v105)
  s_waitcnt lgkmcnt(0)
  v_add_f32 v107, v238, v239
  v_add_f32 v106, v236, v237
  v_max3_f32 v62, v62, abs(v106), abs(v107)
  s_cmp_lg_u32 s97, 0
  s_cbranch_scc1 L_uconv0
L_chunk1:
  ds_read_u16_d16_hi v216, v49 offset:24
  ds_read_u16_d16_hi v217, v49 offset:624
  ds_read_u16_d16_hi v218, v49 offset:240
  ds_read_u16_d16_hi v219, v49 offset:840
  ds_read_u16_d16_hi v220, v49 offset:456
  ds_read_u16_d16_hi v221, v49 offset:1056
  ds_read_u16_d16_hi v222, v60 offset:1296
  ds_read_u16_d16_hi v223, v61 offset:1296
  ds_read_u16_d16_hi v224, v52 offset:50
  ds_read_u16_d16_hi v225, v53 offset:1300
  ds_read_u16_d16_hi v226, v52 offset:674
  ds_read_u16_d16_hi v227, v53 offset:1324
  ds_read_u16_d16_hi v228, v52 offset:258
  ds_read_u16_d16_hi v229, v53 offset:1308
  ds_read_u16_d16_hi v230, v52 offset:882
  ds_read_u16_d16_hi v231, v53 offset:1332
  ds_read_u16_d16_hi v232, v52 offset:466
  ds_read_u16_d16_hi v233, v53 offset:1316
  ds_read_u16_d16_hi v234, v52 offset:1090
  ds_read_u16_d16_hi v235, v53 offset:1340
  s_waitcnt lgkmcnt(14)
  v_add_f32 v109, v218, v219
  v_add_f32 v108, v216, v217
  v_max3_f32 v62, v62, abs(v108), abs(v109)
  ds_read_u16_d16_hi v236, v54 offset:2
  ds_read_u16_d16_hi v237, v55 offset:52
  ds_read_u16_d16_hi v238, v54 offset:650
  ds_read_u16_d16_hi v239, v55 offset:700
  s_waitcnt lgkmcnt(14)
  v_add_f32 v111, v222, v223
  v_add_f32 v110, v220, v221
  v_max3_f32 v62, v62, abs(v110), abs(v111)
  ds_read_u16_d16_hi v216, v54 offset:26
  ds_read_u16_d16_hi v217, v55 offset:676
  ds_read_u16_d16_hi v218, v54 offset:626
  ds_read_u16_d16_hi v219, v55 offset:76
  s_waitcnt lgkmcnt(14)
  v_add_f32 v113, v226, v227
  v_add_f32 v112, v224, v225
  v_max3_f32 v62, v62, abs(v112), abs(v113)
  ds_read_u16_d16_hi v220, v54 offset:10
  ds_read_u16_d16_hi v221, v55 offset:260
  ds_read_u16_d16_hi v222, v54 offset:658
  ds_read_u16_d16_hi v223, v55 offset:908
  s_waitcnt lgkmcnt(14)
  v_add_f32 v115, v230, v231
  v_add_f32 v114, v228, v229
  v_max3_f32 v62, v62, abs(v114), abs(v115)
  ds_read_u16_d16_hi v224, v54 offset:34
  ds_read_u16_d16_hi v225, v55 offset:884
  ds_read_u16_d16_hi v226, v54 offset:634
  ds_read_u16_d16_hi v227, v55 offset:284
  s_waitcnt lgkmcnt(14)
  v_add_f32 v117, v234, v235
  v_add_f32 v116, v232, v233
  v_max3_f32 v62, v62, abs(v116), abs(v117)
  ds_read_u16_d16_hi v228, v54 offset:18
  ds_read_u16_d16_hi v229, v55 offset:468
  ds_read_u16_d16_hi v230, v54 offset:666
  ds_read_u16_d16_hi v231, v55 offset:1116
  s_waitcnt lgkmcnt(14)
  v_add_f32 v119, v238, v239
  v_add_f32 v118, v236, v237
  v_max3_f32 v62, v62, abs(v118), abs(v119)
  ds_read_u16_d16_hi v232, v54 offset:42
  ds_read_u16_d16_hi v233, v55 offset:1092
  ds_read_u16_d16_hi v234, v54 offset:642
  ds_read_u16_d16_hi v235, v55 offset:492
  s_waitcnt lgkmcnt(14)
  v_add_f32 v121, v218, v219
  v_add_f32 v120, v216, v217
  v_max3_f32 v62, v62, abs(v120), abs(v121)
  ds_read_u16_d16_hi v236, v54 offset:210
  ds_read_u16_d16_hi v237, v55 offset:60
  ds_read_u16_d16_hi v238, v54 offset:858
  ds_read_u16_d16_hi v239, v55 offset:708
  s_waitcnt lgkmcnt(14)
  v_add_f32 v123, v222, v223
  v_add_f32 v122, v220, v221
  v_max3_f32 v62, v62, abs(v122), abs(v123)
  s_waitcnt lgkmcnt(12)
  v_add_f32 v125, v226, v227
  v_add_f32 v124, v224, v225
  v_max3_f32 v62, v62, abs(v124), abs(v125)
  s_waitcnt lgkmcnt(8)
  v_add_f32 v127, v230, v231
  v_add_f32 v126, v228, v229
  v_max3_f32 v62, v62, abs(v126), abs(v127)
  s_waitcnt lgkmcnt(4)
  v_add_f32 v129, v234, v235
  v_add_f32 v128, v232, v233
  v_max3_f32 v62, v62, abs(v128), abs(v129)
  s_waitcnt lgkmcnt(0)
  v_add_f32 v131, v238, v239
  v_add_f32 v130, v236, v237
  v_max3_f32 v62, v62, abs(v130), abs(v131)
  s_cmp_lg_u32 s97, 0
  s_cbranch_scc1 L_uconv1
  s_branch L_w1conv
L_chunk2:
  ds_read_u16_d16_hi v216, v54 offset:234
  ds_read_u16_d16_hi v217, v55 offset:684
  ds_read_u16_d16_hi v218, v54 offset:834
  ds_read_u16_d16_hi v219, v55 offset:84
  ds_read_u16_d16_hi v220, v54 offset:218
  ds_read_u16_d16_hi v221, v55 offset:268
  ds_read_u16_d16_hi v222, v54 offset:866
  ds_read_u16_d16_hi v223, v55 offset:916
  ds_read_u16_d16_hi v224, v54 offset:242
  ds_read_u16_d16_hi v225, v55 offset:892
  ds_read_u16_d16_hi v226, v54 offset:842
  ds_read_u16_d16_hi v227, v55 offset:292
  ds_read_u16_d16_hi v228, v54 offset:226
  ds_read_u16_d16_hi v229, v55 offset:476
  ds_read_u16_d16_hi v230, v54 offset:874
  ds_read_u16_d16_hi v231, v55 offset:1124
  ds_read_u16_d16_hi v232, v54 offset:250
  ds_read_u16_d16_hi v233, v55 offset:1100
  ds_read_u16_d16_hi v234, v54 offset:850
  ds_read_u16_d16_hi v235, v55 offset:500
  s_waitcnt lgkmcnt(14)
  v_add_f32 v85, v218, v219
  v_add_f32 v84, v216, v217
  v_max3_f32 v62, v62, abs(v84), abs(v85)
  ds_read_u16_d16_hi v236, v54 offset:418
  ds_read_u16_d16_hi v237, v55 offset:68
  ds_read_u16_d16_hi v238, v54 offset:1066
  ds_read_u16_d16_hi v239, v55 offset:716
  s_waitcnt lgkmcnt(14)
  v_add_f32 v87, v222, v223
  v_add_f32 v86, v220, v221
  v_max3_f32 v62, v62, abs(v86), abs(v87)
  ds_read_u16_d16_hi v216, v54 offset:442
  ds_read_u16_d16_hi v217, v55 offset:692
  ds_read_u16_d16_hi v218, v54 offset:1042
  ds_read_u16_d16_hi v219, v55 offset:92
  s_waitcnt lgkmcnt(14)
  v_add_f32 v89, v226, v227
  v_add_f32 v88, v224, v225
  v_max3_f32 v62, v62, abs(v88), abs(v89)
  ds_read_u16_d16_hi v220, v54 offset:426
  ds_read_u16_d16_hi v221, v55 offset:276
  ds_read_u16_d16_hi v222, v54 offset:1074
  ds_read_u16_d16_hi v223, v55 offset:924
  s_waitcnt lgkmcnt(14)
  v_add_f32 v91, v230, v231
  v_add_f32 v90, v228, v229
  v_max3_f32 v62, v62, abs(v90), abs(v91)
  ds_read_u16_d16_hi v224, v54 offset:450
  ds_read_u16_d16_hi v225, v55 offset:900
  ds_read_u16_d16_hi v226, v54 offset:1050
  ds_read_u16_d16_hi v227, v55 offset:300
  s_waitcnt lgkmcnt(14)
  v_add_f32 v93, v234, v235
  v_add_f32 v92, v232, v233
  v_max3_f32 v62, v62, abs(v92), abs(v93)
  ds_read_u16_d16_hi v228, v54 offset:434
  ds_read_u16_d16_hi v229, v55 offset:484
  ds_read_u16_d16_hi v230, v54 offset:1082
  ds_read_u16_d16_hi v231, v55 offset:1132
  s_waitcnt lgkmcnt(14)
  v_add_f32 v95, v238, v239
  v_add_f32 v94, v236, v237
  v_max3_f32 v62, v62, abs(v94), abs(v95)
  ds_read_u16_d16_hi v232, v54 offset:458
  ds_read_u16_d16_hi v233, v55 offset:1108
  ds_read_u16_d16_hi v234, v54 offset:1058
  ds_read_u16_d16_hi v235, v55 offset:508
  s_waitcnt lgkmcnt(14)
  v_add_f32 v97, v218, v219
  v_add_f32 v96, v216, v217
  v_max3_f32 v62, v62, abs(v96), abs(v97)
  ds_read_u16_d16_hi v236, v56 offset:4
  ds_read_u16_d16_hi v237, v57 offset:104
  ds_read_u16_d16_hi v238, v58 offset:652
  ds_read_u16_d16_hi v239, v59 offset:752
  s_waitcnt lgkmcnt(14)
  v_add_f32 v99, v222, v223
  v_add_f32 v98, v220, v221
  v_max3_f32 v62, v62, abs(v98), abs(v99)
  s_waitcnt lgkmcnt(12)
  v_add_f32 v101, v226, v227
  v_add_f32 v100, v224, v225
  v_max3_f32 v62, v62, abs(v100), abs(v101)
  s_waitcnt lgkmcnt(8)
  v_add_f32 v103, v230, v231
  v_add_f32 v102, v228, v229
  v_max3_f32 v62, v62, abs(v102), abs(v103)
  s_waitcnt lgkmcnt(4)
  v_add_f32 v105, v234, v235
  v_add_f32 v104, v232, v233
  v_max3_f32 v62, v62, abs(v104), abs(v105)
  s_waitcnt lgkmcnt(0)
  v_add_f32 v107, v238, v239
  v_add_f32 v106, v236, v237
  v_max3_f32 v62, v62, abs(v106), abs(v107)
  s_cmp_lg_u32 s97, 0
  s_cbranch_scc1 L_uconv0
L_chunk3:
  ds_read_u16_d16_hi v216, v56 offset:220
  ds_read_u16_d16_hi v217, v57 offset:320
  ds_read_u16_d16_hi v218, v58 offset:868
  ds_read_u16_d16_hi v219, v59 offset:968
  ds_read_u16_d16_hi v220, v56 offset:436
  ds_read_u16_d16_hi v221, v57 offset:536
  ds_read_u16_d16_hi v222, v58 offset:1084
  ds_read_u16_d16_hi v223, v59 offset:1184
  ds_read_u16_d16_hi v224, v56 offset:12
  ds_read_u16_d16_hi v225, v57 offset:312
  ds_read_u16_d16_hi v226, v58 offset:660
  ds_read_u16_d16_hi v227, v59 offset:960
  ds_read_u16_d16_hi v228, v58 offset:36
  ds_read_u16_d16_hi v229, v59 offset:936
  ds_read_u16_d16_hi v230, v56 offset:636
  ds_read_u16_d16_hi v231, v57 offset:336
  ds_read_u16_d16_hi v232, v56 offset:20
  ds_read_u16_d16_hi v233, v57 offset:520
  ds_read_u16_d16_hi v234, v58 offset:668
  ds_read_u16_d16_hi v235, v59 offset:1168
  s_waitcnt lgkmcnt(14)
  v_add_f32 v109, v218, v219
  v_add_f32 v108, v216, v217
  v_max3_f32 v62, v62, abs(v108), abs(v109)
  ds_read_u16_d16_hi v236, v58 offset:44
  ds_read_u16_d16_hi v237, v59 offset:1144
  ds_read_u16_d16_hi v238, v56 offset:644
  ds_read_u16_d16_hi v239, v57 offset:544
  s_waitcnt lgkmcnt(14)
  v_add_f32 v111, v222, v223
  v_add_f32 v110, v220, v221
  v_max3_f32 v62, v62, abs(v110), abs(v111)
  ds_read_u16_d16_hi v216, v56 offset:228
  ds_read_u16_d16_hi v217, v57 offset:528
  ds_read_u16_d16_hi v218, v58 offset:876
  ds_read_u16_d16_hi v219, v59 offset:1176
  s_waitcnt lgkmcnt(14)
  v_add_f32 v113, v226, v227
  v_add_f32 v112, v224, v225
  v_max3_f32 v62, v62, abs(v112), abs(v113)
  ds_read_u16_d16_hi v220, v58 offset:252
  ds_read_u16_d16_hi v221, v59 offset:1152
  ds_read_u16_d16_hi v222, v56 offset:852
  ds_read_u16_d16_hi v223, v57 offset:552
  s_waitcnt lgkmcnt(14)
  v_add_f32 v115, v230, v231
  v_add_f32 v114, v228, v229
  v_max3_f32 v62, v62, abs(v114), abs(v115)
  ds_read_u16_d16_hi v224, v65 offset:0
  ds_read_u16_d16_hi v225, v65 offset:8
  ds_read_u16_d16_hi v226, v65 offset:16
  ds_read_u16_d16_hi v227, v65 offset:24
  ds_read_u16_d16_hi v228, v65 offset:32
  ds_read_u16_d16_hi v229, v65 offset:40
  ds_read_u16_d16_hi v230, v64 offset:48
  ds_read_u16_d16_hi v231, v67
  s_waitcnt lgkmcnt(14)
  v_add_f32 v117, v234, v235
  v_add_f32 v116, v232, v233
  v_max3_f32 v62, v62, abs(v116), abs(v117)
  v_add_f32 v119, v238, v239
  v_add_f32 v118, v236, v237
  v_max3_f32 v62, v62, abs(v118), abs(v119)
  s_waitcnt lgkmcnt(12)
  v_add_f32 v121, v218, v219
  v_add_f32 v120, v216, v217
  v_max3_f32 v62, v62, abs(v120), abs(v121)
  s_waitcnt lgkmcnt(8)
  v_add_f32 v123, v222, v223
  v_add_f32 v122, v220, v221
  v_max3_f32 v62, v62, abs(v122), abs(v123)
  s_cmp_lg_u32 s97, 0
  s_cbranch_scc1 L_uconv1
L_w1conv:
  v_max_u32_dpp v62, v62, v62 row_shr:1 row_mask:0xf bank_mask:0xf
  s_nop 1
  v_max_u32_dpp v62, v62, v62 row_shr:2 row_mask:0xf bank_mask:0xf
  s_nop 1
  v_max_u32_dpp v62, v62, v62 row_shr:4 row_mask:0xf bank_mask:0xf
  s_nop 1
  v_max_u32_dpp v62, v62, v62 row_shr:8 row_mask:0xf bank_mask:0xf
  s_nop 1
  v_max_u32_dpp v62, v62, v62 row_bcast:15 row_mask:0xa bank_mask:0xf
  s_nop 1
  v_max_u32_dpp v62, v62, v62 row_bcast:31 row_mask:0xc bank_mask:0xf
  s_nop 0
  v_readlane_b32 s68, v62, 63
  s_nop 1
  v_mov_b32 v62, s68
  ds_max_u32 v1, v62 offset:20
  ds_add_u32 v1, v3 offset:16
  v_add_u32 v49, v49, v247
  v_add_u32 v50, v50, v247
  v_add_u32 v51, v51, v247
  v_add_u32 v52, v52, v247
  v_add_u32 v53, v53, v247
  v_add_u32 v54, v54, v247
  v_add_u32 v55, v55, v247
  v_add_u32 v56, v56, v247
  v_add_u32 v57, v57, v247
  v_add_u32 v58, v58, v247
  v_add_u32 v59, v59, v247
  v_add_u32 v60, v60, v247
  v_add_u32 v61, v61, v247
L_csync5:
  ds_read_b64 v[40:41], v2 offset:16
  s_waitcnt lgkmcnt(0)
  v_cmp_gt_u32 vcc, 4, v40
  s_cbranch_vccnz L_csync5
  v_readfirstlane_b32 s70, v41
  s_nop 0
  s_lshr_b32 s70, s70, 23
  s_sub_i32 s70, 141, s70
  s_min_i32 s70, s70, 40
  s_add_i32 s51, s70, 127
  s_lshl_b32 s51, s51, 23
  v_fma_mixlo_f16 v132, v84, s51, 0
  v_fma_mixlo_f16 v133, v86, s51, 0
  v_fma_mixlo_f16 v134, v88, s51, 0
  v_fma_mixlo_f16 v135, v90, s51, 0
  v_fma_mixhi_f16 v132, v85, s51, 0
  v_fma_mixhi_f16 v133, v87, s51, 0
  v_fma_mixhi_f16 v134, v89, s51, 0
  v_fma_mixhi_f16 v135, v91, s51, 0
  v_fma_mixlo_f16 v136, v92, s51, 0
  v_fma_mixlo_f16 v137, v94, s51, 0
  v_fma_mixlo_f16 v138, v96, s51, 0
  v_fma_mixlo_f16 v139, v98, s51, 0
  v_fma_mixhi_f16 v136, v93, s51, 0
  v_fma_mixhi_f16 v137, v95, s51, 0
  v_fma_mixhi_f16 v138, v97, s51, 0
  v_fma_mixhi_f16 v139, v99, s51, 0
  ds_write_b128 v63, v[132:135] offset:0
  v_fma_mixlo_f16 v140, v100, s51, 0
  v_fma_mixlo_f16 v141, v102, s51, 0
  v_fma_mixlo_f16 v142, v104, s51, 0
  v_fma_mixlo_f16 v143, v106, s51, 0
  v_fma_mixhi_f16 v140, v101, s51, 0
  v_fma_mixhi_f16 v141, v103, s51, 0
  v_fma_mixhi_f16 v142, v105, s51, 0
  v_fma_mixhi_f16 v143, v107, s51, 0
  ds_write_b128 v63, v[136:139] offset:1024
  v_fma_mixlo_f16 v144, v108, s51, 0
  v_fma_mixlo_f16 v145, v110, s51, 0
  v_fma_mixlo_f16 v146, v112, s51, 0
  v_fma_mixlo_f16 v147, v114, s51, 0
  v_fma_mixhi_f16 v144, v109, s51, 0
  v_fma_mixhi_f16 v145, v111, s51, 0
  v_fma_mixhi_f16 v146, v113, s51, 0
  v_fma_mixhi_f16 v147, v115, s51, 0
  ds_write_b128 v63, v[140:143] offset:2048
  v_fma_mixlo_f16 v148, v116, s51, 0
  v_fma_mixlo_f16 v149, v118, s51, 0
  v_fma_mixlo_f16 v150, v120, s51, 0
  v_fma_mixlo_f16 v151, v122, s51, 0
  v_fma_mixhi_f16 v148, v117, s51, 0
  v_fma_mixhi_f16 v149, v119, s51, 0
  v_fma_mixhi_f16 v150, v121, s51, 0
  v_fma_mixhi_f16 v151, v123, s51, 0
  ds_write_b128 v63, v[144:147] offset:3072
  ds_write_b128 v63, v[148:151] offset:4096
  s_cmp_ge_u32 s79, 2
  s_cbranch_scc1 L_w1x
  v_fma_mixlo_f16 v152, v124, s51, 0
  v_fma_mixlo_f16 v153, v126, s51, 0
  v_fma_mixlo_f16 v154, v128, s51, 0
  v_fma_mixlo_f16 v155, v130, s51, 0
  v_fma_mixhi_f16 v152, v125, s51, 0
  v_fma_mixhi_f16 v153, v127, s51, 0
  v_fma_mixhi_f16 v154, v129, s51, 0
  v_fma_mixhi_f16 v155, v131, s51, 0
  ds_write_b128 v63, v[152:155] offset:5120
L_w1x:
L_uph:
L_csync6:
  ds_read_b64 v[40:41], v2 offset:24
  s_waitcnt lgkmcnt(0)
  v_cmp_gt_u32 vcc, 4, v40
  s_cbranch_vccnz L_csync6
  v_readfirstlane_b32 s71, v41
  s_nop 0
  s_lshr_b32 s71, s71, 23
  s_sub_i32 s71, 140, s71
  s_min_i32 s71, s71, 40
  s_add_i32 s51, s71, 127
  s_lshl_b32 s51, s51, 23
  s_mov_b32 s97, 1
  s_lshr_b32 s69, s3, 1
  s_cmp_eq_u32 s69, 0
  s_cbranch_scc1 L_chunk0
  s_cmp_eq_u32 s69, 1
  s_cbranch_scc1 L_chunk1
  s_cmp_eq_u32 s69, 2
  s_cbranch_scc1 L_chunk2
  s_branch L_chunk3
L_uconv0:
  v_fma_mixlo_f16 v132, v84, s51, 0
  v_fma_mixlo_f16 v133, v86, s51, 0
  v_fma_mixlo_f16 v134, v88, s51, 0
  v_fma_mixlo_f16 v135, v90, s51, 0
  v_fma_mixhi_f16 v132, v85, s51, 0
  v_fma_mixhi_f16 v133, v87, s51, 0
  v_fma_mixhi_f16 v134, v89, s51, 0
  v_fma_mixhi_f16 v135, v91, s51, 0
L_csync7:
  ds_read_b64 v[40:41], v2 offset:16
  s_waitcnt lgkmcnt(0)
  v_cmp_gt_u32 vcc, 4, v40
  s_cbranch_vccnz L_csync7
  v_readfirstlane_b32 s70, v41
  s_nop 0
  s_lshr_b32 s70, s70, 23
  s_sub_i32 s70, 141, s70
  s_min_i32 s70, s70, 40
  ds_write_b128 v66, v[132:135] offset:0
  v_fma_mixlo_f16 v136, v92, s51, 0
  v_fma_mixlo_f16 v137, v94, s51, 0
  v_fma_mixlo_f16 v138, v96, s51, 0
  v_fma_mixlo_f16 v139, v98, s51, 0
  v_fma_mixhi_f16 v136, v93, s51, 0
  v_fma_mixhi_f16 v137, v95, s51, 0
  v_fma_mixhi_f16 v138, v97, s51, 0
  v_fma_mixhi_f16 v139, v99, s51, 0
  ds_write_b128 v66, v[136:139] offset:1024
  v_fma_mixlo_f16 v140, v100, s51, 0
  v_fma_mixlo_f16 v141, v102, s51, 0
  v_fma_mixlo_f16 v142, v104, s51, 0
  v_fma_mixlo_f16 v143, v106, s51, 0
  v_fma_mixhi_f16 v140, v101, s51, 0
  v_fma_mixhi_f16 v141, v103, s51, 0
  v_fma_mixhi_f16 v142, v105, s51, 0
  v_fma_mixhi_f16 v143, v107, s51, 0
  ds_write_b128 v66, v[140:143] offset:2048
  s_branch L_built
L_uconv1:
  v_fma_mixlo_f16 v144, v108, s51, 0
  v_fma_mixlo_f16 v145, v110, s51, 0
  v_fma_mixlo_f16 v146, v112, s51, 0
  v_fma_mixlo_f16 v147, v114, s51, 0
  v_fma_mixhi_f16 v144, v109, s51, 0
  v_fma_mixhi_f16 v145, v111, s51, 0
  v_fma_mixhi_f16 v146, v113, s51, 0
  v_fma_mixhi_f16 v147, v115, s51, 0
L_csync8:
  ds_read_b64 v[40:41], v2 offset:16
  s_waitcnt lgkmcnt(0)
  v_cmp_gt_u32 vcc, 4, v40
  s_cbranch_vccnz L_csync8
  v_readfirstlane_b32 s70, v41
  s_nop 0
  s_lshr_b32 s70, s70, 23
  s_sub_i32 s70, 141, s70
  s_min_i32 s70, s70, 40
  ds_write_b128 v66, v[144:147] offset:3072
  v_fma_mixlo_f16 v148, v116, s51, 0
  v_fma_mixlo_f16 v149, v118, s51, 0
  v_fma_mixlo_f16 v150, v120, s51, 0
  v_fma_mixlo_f16 v151, v122, s51, 0
  v_fma_mixhi_f16 v148, v117, s51, 0
  v_fma_mixhi_f16 v149, v119, s51, 0
  v_fma_mixhi_f16 v150, v121, s51, 0
  v_fma_mixhi_f16 v151, v123, s51, 0
  ds_write_b128 v66, v[148:151] offset:4096
  s_cmp_lg_u32 s84, 0
  s_cbranch_scc1 L_ulin
  v_fma_mixlo_f16 v152, v124, s51, 0
  v_fma_mixlo_f16 v153, v126, s51, 0
  v_fma_mixlo_f16 v154, v128, s51, 0
  v_fma_mixlo_f16 v155, v130, s51, 0
  v_fma_mixhi_f16 v152, v125, s51, 0
  v_fma_mixhi_f16 v153, v127, s51, 0
  v_fma_mixhi_f16 v154, v129, s51, 0
  v_fma_mixhi_f16 v155, v131, s51, 0
  ds_write_b128 v66, v[152:155] offset:5120
  s_branch L_built
L_ulin:
  v_mul_f32 v224, s51, v224
  v_mul_f32 v225, s51, v225
  v_mul_f32 v226, s51, v226
  v_mul_f32 v227, s51, v227
  v_mul_f32 v228, s51, v228
  v_mul_f32 v229, s51, v229
  v_mul_f32 v230, s51, v230
  v_mul_f32 v231, s51, v231
  v_cvt_pk_bf16_f32 v152, v224, v225
  v_cvt_pk_bf16_f32 v153, v226, v227
  v_cvt_pk_bf16_f32 v154, v228, v229
  v_cvt_pk_bf16_f32 v155, v230, v231
  ds_write_b128 v66, v[152:155] offset:5120
L_built:
  s_waitcnt vmcnt(1)
  v_mov_b32 v4, s84
  ds_add_u32 v1, v4 offset:36
  s_mov_b32 s60, s24
  s_and_b32 s61, s25, 0xffff
  s_mov_b32 s62, 268435456
  s_mov_b32 s63, 0x20000
  s_mov_b32 s64, s22
  s_and_b32 s65, s23, 0xffff
  s_mov_b32 s66, 256
  s_mov_b32 s67, 0x20000
  v_lshlrev_b32 v251, 2, v0
  s_mov_b64 exec, 0xff
  s_mov_b32 s81, 0x80000
  buffer_load_dword v255, v251, s[60:63], s81 offen
  buffer_load_dword v249, v251, s[64:67], 0 offen offset:128 sc1
  s_mov_b64 exec, -1
  v_mov_b32 v251, 0
  s_add_i32 s48, s70, s71
L_csync9:
  ds_read_b32 v4, v2 offset:36
  s_waitcnt lgkmcnt(0)
  v_cmp_gt_u32 vcc, 4, v4
  s_cbranch_vccnz L_csync9
  ds_read_u16_d16_hi v32, v7 offset:0
  ds_read_u16_d16_hi v33, v7 offset:128
  ds_read_u16_d16_hi v34, v7 offset:256
  ds_read_u16_d16_hi v35, v7 offset:384
  ds_read_u16_d16_hi v36, v7 offset:512
  ds_read_u16_d16_hi v37, v7 offset:640
  ds_read_u16_d16_hi v38, v7 offset:768
  ds_read_u16_d16_hi v39, v7 offset:896
  s_waitcnt lgkmcnt(0)
  v_cvt_pk_f16_f32 v43, v38, v39
  v_cvt_pk_f16_f32 v40, v32, v35
  v_cvt_pk_f16_f32 v41, v33, v36
  v_cvt_pk_f16_f32 v42, v34, v37
  ds_write_b128 v10, v[40:43]
  ds_read_b128 v[44:47], v11
  ds_read_b128 v[48:51], v12
  ds_read_b64_tr_b16 v[52:53], v8 offset:0
  ds_read_b64_tr_b16 v[54:55], v8 offset:512
  v_pk_mul_f16 v56, v40, v40 op_sel:[0,0] op_sel_hi:[1,1]
  v_pk_mul_f16 v57, v41, v41 op_sel:[0,0] op_sel_hi:[1,1]
  v_pk_mul_f16 v58, v42, v42 op_sel:[0,0] op_sel_hi:[1,1]
  v_pk_mul_f16 v59, v40, v41 op_sel:[0,0] op_sel_hi:[1,1]
  ds_read_u16_d16_hi v32, v7 offset:32
  ds_read_u16_d16_hi v33, v7 offset:160
  s_waitcnt vmcnt(3)
  v_lshlrev_b32 v21, 7, v21
  buffer_load_dword v255, v21, s[32:35], 0 offen
  s_mov_b64 exec, 131071
  buffer_load_dword v255, v19, s[44:47], s101 offen
  s_mov_b64 exec, -1
  s_add_u32 s101, s101, 1171456
  s_waitcnt lgkmcnt(0)
  s_barrier
  s_setprio 1
  ds_read_b128 v[240:243], v28 offset:46528
  ds_read_b128 v[128:131], v28 offset:35264
  ds_read_b128 v[84:87], v28 offset:0
  ds_read_b128 v[216:219], v22
  ds_read_b128 v[244:247], v30 offset:22528
  ds_read_b128 v[172:175], v31 offset:11264
  ds_read_b128 v[176:179], v31 offset:12288
  ds_read_b128 v[180:183], v31 offset:13312
  ds_read2_b32 v[220:221], v29 offset0:0 offset1:2
  ds_read2_b32 v[222:223], v29 offset0:64 offset1:66
  v_add_u32 v29, 2048, v29
  ds_read_b128 v[88:91], v28 offset:1024
  ds_read_b128 v[92:95], v28 offset:2048
  ds_read_b128 v[132:135], v28 offset:36288
  ds_read_b128 v[136:139], v28 offset:37312
  ds_read_b128 v[140:143], v28 offset:38336
  ds_read_b128 v[144:147], v28 offset:39360
  ds_read2_b32 v[224:225], v29 offset0:0 offset1:2
  ds_read2_b32 v[226:227], v29 offset0:64 offset1:66
  v_add_u32 v29, 2048, v29
  s_cmp_lg_u32 s84, 0
  s_cbranch_scc1 L_prf
  s_setprio 2
L_prf:
  s_waitcnt lgkmcnt(14)
  v_mfma_f32_16x16x32_bf16 v[72:75], v[240:243], v[52:55], 0
  ds_read_b128 v[184:187], v31 offset:14336
  v_mfma_f32_16x16x32_f16 v[72:75], v[128:131], v[56:59], v[72:75]
  ds_read_b128 v[188:191], v31 offset:15360
  v_mfma_f32_16x16x32_f16 v[68:71], v[84:87], v[56:59], 0
  ds_read_b128 v[96:99], v28 offset:3072
  v_pk_mul_f16 v60, v40, v41 op_sel:[0,1] op_sel_hi:[1,0]
  v_mfma_f32_16x16x32_f16 v[80:83], v[216:219], v[56:59], 0
  ds_read_b128 v[100:103], v28 offset:4096
  v_pk_mul_f16 v61, v40, v42 op_sel:[0,0] op_sel_hi:[1,1]
  v_pk_mul_f16 v62, v40, v42 op_sel:[0,1] op_sel_hi:[1,0]
  s_waitcnt lgkmcnt(14)
  v_mfma_f32_16x16x32_bf16 v[76:79], v[244:247], v[52:55], 0
  ds_read_b128 v[104:107], v28 offset:5120
  v_pk_mul_f16 v63, v41, v42 op_sel:[0,0] op_sel_hi:[1,1]
  v_pk_mul_f16 v64, v41, v42 op_sel:[0,1] op_sel_hi:[1,0]
  v_mfma_f32_16x16x32_f16 v[76:79], v[172:175], v[56:59], v[76:79]
  ds_read_b128 v[108:111], v28 offset:6144
  v_pk_mul_f16 v65, v40, v43 op_sel:[0,0] op_sel_hi:[1,0]
  v_pk_mul_f16 v66, v41, v43 op_sel:[0,0] op_sel_hi:[1,0]
  v_pk_mul_f16 v67, v42, v43 op_sel:[0,0] op_sel_hi:[1,0]
  v_mfma_f32_16x16x32_f16 v[76:79], v[176:179], v[60:63], v[76:79]
  ds_read2_b32 v[228:229], v29 offset0:0 offset1:2
  ds_read2_b32 v[230:231], v29 offset0:64 offset1:66
  v_add_u32 v29, 2048, v29
  v_alignbit_b32 v48, v48, v48, v13
  v_mfma_f32_16x16x32_f16 v[76:79], v[180:183], v[64:67], v[76:79]
  ds_read_b128 v[148:151], v28 offset:40384
  v_mul_f16_sdwa v52, v40, v40 dst_sel:WORD_0 dst_unused:UNUSED_PAD src0_sel:WORD_0 src1_sel:WORD_1
  v_mul_f16_sdwa v53, v42, v42 dst_sel:WORD_0 dst_unused:UNUSED_PAD src0_sel:WORD_0 src1_sel:WORD_1
  s_waitcnt lgkmcnt(14)
  v_smfmac_f32_16x16x64_f16 v[80:83], v[220:223], v[60:67], v16
  ds_read_b128 v[152:155], v28 offset:41408
  v_alignbit_b32 v49, v49, v49, v13
  v_mfma_f32_16x16x32_f16 v[68:71], v[88:91], v[60:63], v[68:71]
  ds_read_b128 v[192:195], v31 offset:16384
  v_mul_f16_sdwa v52, v41, v41 dst_sel:WORD_1 dst_unused:UNUSED_PRESERVE src0_sel:WORD_0 src1_sel:WORD_1
  v_mul_f16_sdwa v53, v43, v43 dst_sel:WORD_1 dst_unused:UNUSED_PRESERVE src0_sel:WORD_0 src1_sel:WORD_1
  v_mfma_f32_16x16x32_f16 v[68:71], v[92:95], v[64:67], v[68:71]
  ds_read_b128 v[196:199], v31 offset:17408
  v_pk_mul_f16 v54, v40, v47 op_sel:[0,0] op_sel_hi:[1,0]
  v_mfma_f32_16x16x32_f16 v[72:75], v[132:135], v[60:63], v[72:75]
  ds_read_b128 v[200:203], v31 offset:18432
  v_pk_mul_f16 v55, v41, v47 op_sel:[0,0] op_sel_hi:[1,0]
  v_pk_mul_f16 v56, v42, v47 op_sel:[0,0] op_sel_hi:[1,0]
  s_waitcnt lgkmcnt(14)
  v_mfma_f32_16x16x32_f16 v[72:75], v[136:139], v[64:67], v[72:75]
  ds_read_b128 v[204:207], v31 offset:19456
  v_pk_mul_f16 v57, v40, v44 op_sel:[0,0] op_sel_hi:[1,1]
  v_pk_mul_f16 v58, v40, v44 op_sel:[0,1] op_sel_hi:[1,0]
  v_pk_mul_f16 v59, v40, v45 op_sel:[0,0] op_sel_hi:[1,1]
  v_mfma_f32_16x16x32_f16 v[72:75], v[140:143], v[52:55], v[72:75]
  ds_read2_b32 v[232:233], v29 offset0:0 offset1:2
  ds_read2_b32 v[234:235], v29 offset0:64 offset1:66
  v_add_u32 v29, 2048, v29
  v_pk_mul_f16 v60, v40, v45 op_sel:[0,1] op_sel_hi:[1,0]
  v_mfma_f32_16x16x32_f16 v[72:75], v[144:147], v[56:59], v[72:75]
  ds_read_b128 v[156:159], v28 offset:42432
  v_pk_mul_f16 v61, v40, v46 op_sel:[0,0] op_sel_hi:[1,1]
  v_pk_mul_f16 v62, v40, v46 op_sel:[0,1] op_sel_hi:[1,0]
  s_waitcnt lgkmcnt(14)
  v_smfmac_f32_16x16x64_f16 v[80:83], v[224:227], v[52:59], v16
  ds_read_b128 v[160:163], v28 offset:43456
  v_pk_mul_f16 v63, v41, v44 op_sel:[0,0] op_sel_hi:[1,1]
  v_mfma_f32_16x16x32_f16 v[76:79], v[184:187], v[52:55], v[76:79]
  ds_read_b128 v[112:115], v28 offset:7168
  v_pk_mul_f16 v64, v41, v44 op_sel:[0,1] op_sel_hi:[1,0]
  v_pk_mul_f16 v65, v41, v45 op_sel:[0,0] op_sel_hi:[1,1]
  v_mfma_f32_16x16x32_f16 v[76:79], v[188:191], v[56:59], v[76:79]
  ds_read_b128 v[116:119], v28 offset:8192
  v_pk_mul_f16 v66, v41, v45 op_sel:[0,1] op_sel_hi:[1,0]
  v_mfma_f32_16x16x32_f16 v[68:71], v[96:99], v[52:55], v[68:71]
  ds_read_b128 v[120:123], v28 offset:9216
  v_pk_mul_f16 v67, v41, v46 op_sel:[0,0] op_sel_hi:[1,1]
  ds_write_b16 v15, v14 offset:4064
  s_and_b32 s81, s2, 7
  s_waitcnt vmcnt(2)
  v_cmp_eq_u32 vcc, 0, v249
  s_nop 0
  s_bitcmp1_b32 vcc_lo, s81
  s_cbranch_scc0 L_cclr_ok
  s_mov_b32 s78, 0x40000
L_cclr:
  s_sub_u32 s78, s78, 1
  s_cbranch_scc1 L_cclr_ok
  v_lshlrev_b32 v249, 2, v0
  v_and_b32 v249, 31, v249
  buffer_load_dword v249, v249, s[64:67], 0 offen offset:128 sc1
  s_waitcnt vmcnt(0)
  v_cmp_eq_u32 vcc, 0, v249
  s_nop 0
  s_bitcmp1_b32 vcc_lo, s81
  s_cbranch_scc1 L_cclr
L_cclr_ok:
  v_lshl_add_u32 v24, v24, 7, v18
  v_lshl_add_u32 v25, v25, 7, v18
  s_mov_b32 exec_hi, 0x0000ffff
  v_lshl_add_u32 v26, v26, 7, v18
  v_lshl_add_u32 v27, v27, 7, v18
  s_mov_b32 exec_lo, 0
  s_mov_b32 exec_hi, 0xffff0000
  v_mov_b32 v27, v25
  v_mov_b32 v26, v25
  s_mov_b32 exec_hi, 0x00ff0000
  v_mov_b32 v26, v24
  s_mov_b64 exec, -1
  s_add_u32 m0, s74, -39488
  s_nop 0
  buffer_load_dwordx4 v24, s[32:35], 0 offen lds
  s_add_u32 m0, s74, -38432
  s_nop 0
  buffer_load_dwordx4 v25, s[32:35], 0 offen lds
  s_add_u32 m0, s74, -37376
  s_nop 0
  buffer_load_dwordx4 v26, s[32:35], 0 offen lds
  s_add_u32 m0, s74, -36320
  s_mov_b32 exec_hi, 0x00ffffff
  buffer_load_dwordx4 v27, s[32:35], 0 offen lds
  s_mov_b32 exec_hi, -1
  s_mov_b64 exec, 131071
  buffer_load_dword v255, v19, s[44:47], s101 offen
  s_mov_b64 exec, -1
  s_add_u32 s101, s101, 1171456
  s_sub_i32 s48, 0, s48
  s_mov_b32 s49, s48
  s_mov_b32 s97, 1
  s_mov_b32 s50, 1
  s_mov_b32 s96, 0
  s_cmp_lg_u32 s3, 7
  s_cbranch_scc1 L_nw0
  s_mov_b32 s52, s16
  s_and_b32 s53, s17, 0xffff
  s_mov_b32 s54, 3328
  s_mov_b32 s55, 0x20000
  v_lshlrev_b32 v22, 7, v0
  buffer_load_dword v255, v22, s[52:55], 0 offen
L_nw0:
  v_alignbit_b32 v50, v50, v50, v13
  s_waitcnt lgkmcnt(14)
  v_mfma_f32_16x16x32_f16 v[68:71], v[100:103], v[56:59], v[68:71]
  ds_read_b128 v[124:127], v28 offset:10240
  v_pk_mul_f16 v52, v41, v46 op_sel:[0,1] op_sel_hi:[1,0]
  v_pk_mul_f16 v53, v42, v44 op_sel:[0,0] op_sel_hi:[1,1]
  v_mfma_f32_16x16x32_f16 v[68:71], v[104:107], v[60:63], v[68:71]
  ds_read_b128 v[164:167], v28 offset:44480
  v_pk_mul_f16 v54, v42, v44 op_sel:[0,1] op_sel_hi:[1,0]
  v_pk_mul_f16 v55, v42, v45 op_sel:[0,0] op_sel_hi:[1,1]
  v_mfma_f32_16x16x32_f16 v[68:71], v[108:111], v[64:67], v[68:71]
  ds_read_b128 v[168:171], v28 offset:45504
  v_pk_mul_f16 v56, v42, v45 op_sel:[0,1] op_sel_hi:[1,0]
  v_pk_mul_f16 v57, v42, v46 op_sel:[0,0] op_sel_hi:[1,1]
  v_smfmac_f32_16x16x64_f16 v[80:83], v[228:231], v[60:67], v16
  ds_read2_b32 v[236:237], v29 offset0:0 offset1:2
  ds_read2_b32 v[238:239], v29 offset0:64 offset1:66
  v_add_u32 v29, 2048, v29
  v_pk_mul_f16 v58, v42, v46 op_sel:[0,1] op_sel_hi:[1,0]
  v_pk_mul_f16 v59, v40, v48 op_sel:[0,0] op_sel_hi:[1,1]
  s_waitcnt lgkmcnt(14)
  v_mfma_f32_16x16x32_f16 v[72:75], v[148:151], v[60:63], v[72:75]
  ds_read_b128 v[208:211], v31 offset:20480
  ds_read_u16_d16_hi v34, v7 offset:288
  ds_read_u16_d16_hi v35, v7 offset:416
  v_mfma_f32_16x16x32_f16 v[72:75], v[152:155], v[64:67], v[72:75]
  ds_read_b128 v[212:215], v31 offset:21504
  ds_read_u16_d16_hi v36, v7 offset:544
  ds_read_u16_d16_hi v37, v7 offset:672
  v_mfma_f32_16x16x32_f16 v[76:79], v[192:195], v[60:63], v[76:79]
  ds_read_u16_d16_hi v38, v7 offset:800
  ds_read_u16_d16_hi v39, v7 offset:928
  v_mfma_f32_16x16x32_f16 v[76:79], v[196:199], v[64:67], v[76:79]
  v_pk_mul_f16 v60, v41, v49 op_sel:[0,0] op_sel_hi:[1,1]
  v_pk_mul_f16 v61, v42, v50 op_sel:[0,0] op_sel_hi:[1,1]
  v_mfma_f32_16x16x32_f16 v[76:79], v[200:203], v[52:55], v[76:79]
  v_pk_mul_f16 v62, v40, v49 op_sel:[0,0] op_sel_hi:[1,1]
  v_pk_mul_f16 v63, v40, v49 op_sel:[0,1] op_sel_hi:[1,0]
  s_waitcnt lgkmcnt(14)
  v_mfma_f32_16x16x32_f16 v[76:79], v[204:207], v[56:59], v[76:79]
  v_pk_mul_f16 v64, v40, v50 op_sel:[0,0] op_sel_hi:[1,1]
  v_pk_mul_f16 v65, v40, v50 op_sel:[0,1] op_sel_hi:[1,0]
  v_smfmac_f32_16x16x64_f16 v[80:83], v[232:235], v[52:59], v16
  v_pk_mul_f16 v66, v41, v50 op_sel:[0,0] op_sel_hi:[1,1]
  v_pk_mul_f16 v67, v41, v50 op_sel:[0,1] op_sel_hi:[1,0]
  v_mfma_f32_16x16x32_f16 v[72:75], v[156:159], v[52:55], v[72:75]
  s_waitcnt lgkmcnt(0)
  v_cvt_pk_f16_f32 v43, v38, v39
  v_mfma_f32_16x16x32_f16 v[72:75], v[160:163], v[56:59], v[72:75]
  v_cvt_pk_f16_f32 v40, v32, v35
  v_cvt_pk_f16_f32 v41, v33, v36
  v_mfma_f32_16x16x32_f16 v[68:71], v[112:115], v[52:55], v[68:71]
  v_cvt_pk_f16_f32 v42, v34, v37
  v_mfma_f32_16x16x32_f16 v[68:71], v[116:119], v[56:59], v[68:71]
  ds_write_b128 v10, v[40:43]
  v_mfma_f32_16x16x32_f16 v[68:71], v[120:123], v[60:63], v[68:71]
  v_mfma_f32_16x16x32_f16 v[68:71], v[124:127], v[64:67], v[68:71]
  ds_read_b128 v[44:47], v11
  ds_read_b128 v[48:51], v12
  v_mfma_f32_16x16x32_f16 v[72:75], v[164:167], v[60:63], v[72:75]
  ds_read_b64_tr_b16 v[52:53], v8 offset:32
  ds_read_b64_tr_b16 v[54:55], v8 offset:544
  v_mfma_f32_16x16x32_f16 v[72:75], v[168:171], v[64:67], v[72:75]
  v_pk_mul_f16 v56, v40, v40 op_sel:[0,0] op_sel_hi:[1,1]
  v_pk_mul_f16 v57, v41, v41 op_sel:[0,0] op_sel_hi:[1,1]
  v_smfmac_f32_16x16x64_f16 v[80:83], v[236:239], v[60:67], v16
  v_pk_mul_f16 v58, v42, v42 op_sel:[0,0] op_sel_hi:[1,1]
  v_pk_mul_f16 v59, v40, v41 op_sel:[0,0] op_sel_hi:[1,1]
  v_mfma_f32_16x16x32_f16 v[76:79], v[208:211], v[60:63], v[76:79]
  s_nop 1
  v_mul_f32 v14, v68, v72
  v_fmac_f32 v14, v69, v73
  v_mfma_f32_16x16x32_f16 v[76:79], v[212:215], v[64:67], v[76:79]
  v_fmac_f32 v14, v70, v74
  v_fmac_f32 v14, v71, v75
  ds_add_u32 v1, v3 offset:12
  s_branch L_grp1
L_prime:
  v_mov_b32 v68, 0
  v_mov_b32 v69, 0
  v_mov_b32 v70, 0
  v_mov_b32 v71, 0
  v_mov_b32 v72, 0
  v_mov_b32 v73, 0
  v_mov_b32 v74, 0
  v_mov_b32 v75, 0
  v_mov_b32 v76, 0
  v_mov_b32 v77, 0
  v_mov_b32 v78, 0
  v_mov_b32 v79, 0
  v_mov_b32 v80, 0
  v_mov_b32 v81, 0
  v_mov_b32 v82, 0
  v_mov_b32 v83, 0
  v_mov_b32 v22, 0
  v_mov_b32 v23, 0
  ds_read_u16_d16_hi v32, v7 offset:0
  ds_read_u16_d16_hi v33, v7 offset:128
  ds_read_u16_d16_hi v34, v7 offset:256
  ds_read_u16_d16_hi v35, v7 offset:384
  ds_read_u16_d16_hi v36, v7 offset:512
  ds_read_u16_d16_hi v37, v7 offset:640
  ds_read_u16_d16_hi v38, v7 offset:768
  ds_read_u16_d16_hi v39, v7 offset:896
  s_waitcnt lgkmcnt(0)
  v_cvt_pk_f16_f32 v43, v38, v39
  v_cvt_pk_f16_f32 v40, v32, v35
  v_cvt_pk_f16_f32 v41, v33, v36
  v_cvt_pk_f16_f32 v42, v34, v37
  ds_write_b128 v10, v[40:43]
  ds_read_b128 v[44:47], v11
  ds_read_b128 v[48:51], v12
  ds_read_b64_tr_b16 v[52:53], v8 offset:0
  ds_read_b64_tr_b16 v[54:55], v8 offset:512
  v_pk_mul_f16 v56, v40, v40 op_sel:[0,0] op_sel_hi:[1,1]
  v_pk_mul_f16 v57, v41, v41 op_sel:[0,0] op_sel_hi:[1,1]
  v_pk_mul_f16 v58, v42, v42 op_sel:[0,0] op_sel_hi:[1,1]
  v_pk_mul_f16 v59, v40, v41 op_sel:[0,0] op_sel_hi:[1,1]
  ds_read_u16_d16_hi v32, v7 offset:32
  ds_read_u16_d16_hi v33, v7 offset:160
L_cin_loop:
  s_cmp_lg_u32 s84, 0
  s_cbranch_scc1 L_pr0
  s_setprio 2
L_pr0:
  s_waitcnt lgkmcnt(2)
  v_mfma_f32_16x16x32_bf16 v[72:75], v[240:243], v[52:55], 0
  v_add_f32 v22, v80, v81
  v_add_f32 v23, v82, v83
  v_mfma_f32_16x16x32_f16 v[72:75], v[128:131], v[56:59], v[72:75]
  v_fmac_f32 v14, v76, v77
  v_fmac_f32 v14, v22, v78
  v_mfma_f32_16x16x32_f16 v[68:71], v[84:87], v[56:59], 0
  v_fmac_f32 v14, v23, v79
  v_pk_mul_f16 v60, v40, v41 op_sel:[0,1] op_sel_hi:[1,0]
  v_mfma_f32_16x16x32_f16 v[80:83], v[216:219], v[56:59], 0
  v_pk_mul_f16 v61, v40, v42 op_sel:[0,0] op_sel_hi:[1,1]
  v_pk_mul_f16 v62, v40, v42 op_sel:[0,1] op_sel_hi:[1,0]
  v_mfma_f32_16x16x32_bf16 v[76:79], v[244:247], v[52:55], 0
  v_pk_mul_f16 v63, v41, v42 op_sel:[0,0] op_sel_hi:[1,1]
  v_pk_mul_f16 v64, v41, v42 op_sel:[0,1] op_sel_hi:[1,0]
  v_mfma_f32_16x16x32_f16 v[76:79], v[172:175], v[56:59], v[76:79]
  v_pk_mul_f16 v65, v40, v43 op_sel:[0,0] op_sel_hi:[1,0]
  v_pk_mul_f16 v66, v41, v43 op_sel:[0,0] op_sel_hi:[1,0]
  v_pk_mul_f16 v67, v42, v43 op_sel:[0,0] op_sel_hi:[1,0]
  v_mfma_f32_16x16x32_f16 v[76:79], v[176:179], v[60:63], v[76:79]
  v_add_f32_dpp v14, v14, v14 row_shr:1 row_mask:0xf bank_mask:0xf
  v_alignbit_b32 v48, v48, v48, v13
  v_mfma_f32_16x16x32_f16 v[76:79], v[180:183], v[64:67], v[76:79]
  v_mul_f16_sdwa v52, v40, v40 dst_sel:WORD_0 dst_unused:UNUSED_PAD src0_sel:WORD_0 src1_sel:WORD_1
  v_mul_f16_sdwa v53, v42, v42 dst_sel:WORD_0 dst_unused:UNUSED_PAD src0_sel:WORD_0 src1_sel:WORD_1
  v_smfmac_f32_16x16x64_f16 v[80:83], v[220:223], v[60:67], v16
  v_add_f32_dpp v14, v14, v14 row_shr:2 row_mask:0xf bank_mask:0xf
  v_alignbit_b32 v49, v49, v49, v13
  v_mfma_f32_16x16x32_f16 v[68:71], v[88:91], v[60:63], v[68:71]
  v_mul_f16_sdwa v52, v41, v41 dst_sel:WORD_1 dst_unused:UNUSED_PRESERVE src0_sel:WORD_0 src1_sel:WORD_1
  v_mul_f16_sdwa v53, v43, v43 dst_sel:WORD_1 dst_unused:UNUSED_PRESERVE src0_sel:WORD_0 src1_sel:WORD_1
  v_mfma_f32_16x16x32_f16 v[68:71], v[92:95], v[64:67], v[68:71]
  v_add_f32_dpp v14, v14, v14 row_shr:4 row_mask:0xf bank_mask:0xf
  v_pk_mul_f16 v54, v40, v47 op_sel:[0,0] op_sel_hi:[1,0]
  v_mfma_f32_16x16x32_f16 v[72:75], v[132:135], v[60:63], v[72:75]
  v_pk_mul_f16 v55, v41, v47 op_sel:[0,0] op_sel_hi:[1,0]
  v_pk_mul_f16 v56, v42, v47 op_sel:[0,0] op_sel_hi:[1,0]
  v_mfma_f32_16x16x32_f16 v[72:75], v[136:139], v[64:67], v[72:75]
  v_pk_mul_f16 v57, v40, v44 op_sel:[0,0] op_sel_hi:[1,1]
  v_pk_mul_f16 v58, v40, v44 op_sel:[0,1] op_sel_hi:[1,0]
  v_pk_mul_f16 v59, v40, v45 op_sel:[0,0] op_sel_hi:[1,1]
  v_mfma_f32_16x16x32_f16 v[72:75], v[140:143], v[52:55], v[72:75]
  v_add_f32_dpp v14, v14, v14 row_shr:8 row_mask:0xf bank_mask:0xf
  v_pk_mul_f16 v60, v40, v45 op_sel:[0,1] op_sel_hi:[1,0]
  v_mfma_f32_16x16x32_f16 v[72:75], v[144:147], v[56:59], v[72:75]
  v_pk_mul_f16 v61, v40, v46 op_sel:[0,0] op_sel_hi:[1,1]
  v_pk_mul_f16 v62, v40, v46 op_sel:[0,1] op_sel_hi:[1,0]
  v_smfmac_f32_16x16x64_f16 v[80:83], v[224:227], v[52:59], v16
  v_add_f32_dpp v14, v14, v14 row_bcast:15 row_mask:0xa bank_mask:0xf
  v_pk_mul_f16 v63, v41, v44 op_sel:[0,0] op_sel_hi:[1,1]
  v_mfma_f32_16x16x32_f16 v[76:79], v[184:187], v[52:55], v[76:79]
  v_pk_mul_f16 v64, v41, v44 op_sel:[0,1] op_sel_hi:[1,0]
  v_pk_mul_f16 v65, v41, v45 op_sel:[0,0] op_sel_hi:[1,1]
  v_mfma_f32_16x16x32_f16 v[76:79], v[188:191], v[56:59], v[76:79]
  v_add_f32_dpp v14, v14, v14 row_bcast:31 row_mask:0xc bank_mask:0xf
  v_pk_mul_f16 v66, v41, v45 op_sel:[0,1] op_sel_hi:[1,0]
  v_mfma_f32_16x16x32_f16 v[68:71], v[96:99], v[52:55], v[68:71]
  v_pk_mul_f16 v67, v41, v46 op_sel:[0,0] op_sel_hi:[1,1]
  s_waitcnt vmcnt(0)
L_blk:
  s_cmp_eq_u32 s50, 0
  s_cbranch_scc1 L_blkend
  v_readlane_b32 s81, v14, 63
  v_ldexp_f32 v14, v14, s49
  v_and_b32 v14, -2, v14
  s_cmp_ge_u32 s50, 2
  s_cbranch_scc1 L_good
  s_cmp_eq_u64 s[90:91], 0
  s_cbranch_scc1 L_slow
  s_bfe_u32 s81, s81, 0x80017
  s_cmp_eq_u32 s81, 255
  s_cbranch_scc1 L_slow
L_good:
  s_mov_b32 exec_lo, 0
  s_mov_b32 exec_hi, 0x80000000
  buffer_store_dword v14, v251, s[60:63], s85 offen sc1
  s_mov_b64 exec, -1
  s_add_u32 s85, s85, 32
  s_sub_u32 s72, s72, 1
  s_cmp_eq_u32 s72, 0
  s_cbranch_scc1 L_cin_done
  s_cmp_eq_u32 s72, 1
  s_cbranch_scc1 L_lastnext
  v_lshl_add_u32 v24, v24, 7, v18
  v_lshl_add_u32 v25, v25, 7, v18
  s_mov_b32 exec_hi, 0x0000ffff
  v_lshl_add_u32 v26, v26, 7, v18
  v_lshl_add_u32 v27, v27, 7, v18
  s_mov_b32 exec_lo, 0
  s_mov_b32 exec_hi, 0xffff0000
  v_mov_b32 v27, v25
  v_mov_b32 v26, v25
  s_mov_b32 exec_hi, 0x00ff0000
  v_mov_b32 v26, v24
  s_mov_b64 exec, -1
  s_add_u32 m0, s74, 0
  s_nop 0
  buffer_load_dwordx4 v24, s[32:35], 0 offen lds
  s_add_u32 m0, s74, 1056
  s_nop 0
  buffer_load_dwordx4 v25, s[32:35], 0 offen lds
  s_add_u32 m0, s74, 2112
  s_nop 0
  buffer_load_dwordx4 v26, s[32:35], 0 offen lds
  s_add_u32 m0, s74, 3168
  s_mov_b32 exec_hi, 0x00ffffff
  buffer_load_dwordx4 v27, s[32:35], 0 offen lds
  s_mov_b32 exec_hi, -1
  s_add_u32 s94, s94, 832
  s_cmp_lg_u32 s72, s99
  s_cbranch_scc1 L_nodma
  s_lshr_b32 s81, s98, 14
  v_cmp_eq_u32 vcc, 0, v249
  s_nop 0
  s_bitcmp1_b32 vcc_lo, s81
  s_cbranch_scc0 L_tclr_ok
  s_mov_b32 s78, 0x40000
L_tclr:
  s_sub_u32 s78, s78, 1
  s_cbranch_scc1 L_tclr_ok
  v_lshlrev_b32 v249, 2, v0
  v_and_b32 v249, 31, v249
  buffer_load_dword v249, v249, s[64:67], 0 offen offset:128 sc1
  s_waitcnt vmcnt(0)
  v_cmp_eq_u32 vcc, 0, v249
  s_nop 0
  s_bitcmp1_b32 vcc_lo, s81
  s_cbranch_scc1 L_tclr
L_tclr_ok:
  v_mov_b32 v250, 1
  s_mov_b64 exec, 1
  buffer_atomic_add v250, v251, s[60:63], s98 offen sc0
  s_mov_b64 exec, -1
  s_mov_b32 s99, 8
  s_branch L_nodma
L_lastnext:
  s_cmp_lt_i32 s26, 0
  s_cselect_b32 s85, s85, s26
L_nodma:
  s_add_u32 s74, s74, s75
  s_sub_u32 s75, 0, s75
  s_mov_b32 s49, s48
  s_mov_b32 s97, 1
  s_cmp_eq_u32 s50, 3
  s_cbranch_scc1 L_slow2
L_blkend:
  s_mov_b32 s50, s97
  s_cmp_ge_u32 s101, 5537792
  s_cbranch_scc1 L_npf
  s_mov_b64 exec, 131071
  buffer_load_dword v255, v19, s[44:47], s101 offen
  s_mov_b64 exec, -1
  s_add_u32 s101, s101, 1171456
L_npf:
  v_alignbit_b32 v50, v50, v50, v13
  v_mfma_f32_16x16x32_f16 v[68:71], v[100:103], v[56:59], v[68:71]
  v_pk_mul_f16 v52, v41, v46 op_sel:[0,1] op_sel_hi:[1,0]
  v_pk_mul_f16 v53, v42, v44 op_sel:[0,0] op_sel_hi:[1,1]
  v_mfma_f32_16x16x32_f16 v[68:71], v[104:107], v[60:63], v[68:71]
  v_pk_mul_f16 v54, v42, v44 op_sel:[0,1] op_sel_hi:[1,0]
  v_pk_mul_f16 v55, v42, v45 op_sel:[0,0] op_sel_hi:[1,1]
  v_mfma_f32_16x16x32_f16 v[68:71], v[108:111], v[64:67], v[68:71]
  v_pk_mul_f16 v56, v42, v45 op_sel:[0,1] op_sel_hi:[1,0]
  v_pk_mul_f16 v57, v42, v46 op_sel:[0,0] op_sel_hi:[1,1]
  v_smfmac_f32_16x16x64_f16 v[80:83], v[228:231], v[60:67], v16
  v_pk_mul_f16 v58, v42, v46 op_sel:[0,1] op_sel_hi:[1,0]
  v_pk_mul_f16 v59, v40, v48 op_sel:[0,0] op_sel_hi:[1,1]
  v_mfma_f32_16x16x32_f16 v[72:75], v[148:151], v[60:63], v[72:75]
  ds_read_u16_d16_hi v34, v7 offset:288
  ds_read_u16_d16_hi v35, v7 offset:416
  v_mfma_f32_16x16x32_f16 v[72:75], v[152:155], v[64:67], v[72:75]
  ds_read_u16_d16_hi v36, v7 offset:544
  ds_read_u16_d16_hi v37, v7 offset:672
  v_mfma_f32_16x16x32_f16 v[76:79], v[192:195], v[60:63], v[76:79]
  ds_read_u16_d16_hi v38, v7 offset:800
  ds_read_u16_d16_hi v39, v7 offset:928
  v_mfma_f32_16x16x32_f16 v[76:79], v[196:199], v[64:67], v[76:79]
  v_pk_mul_f16 v60, v41, v49 op_sel:[0,0] op_sel_hi:[1,1]
  v_pk_mul_f16 v61, v42, v50 op_sel:[0,0] op_sel_hi:[1,1]
  v_mfma_f32_16x16x32_f16 v[76:79], v[200:203], v[52:55], v[76:79]
  v_pk_mul_f16 v62, v40, v49 op_sel:[0,0] op_sel_hi:[1,1]
  v_pk_mul_f16 v63, v40, v49 op_sel:[0,1] op_sel_hi:[1,0]
  v_mfma_f32_16x16x32_f16 v[76:79], v[204:207], v[56:59], v[76:79]
  v_pk_mul_f16 v64, v40, v50 op_sel:[0,0] op_sel_hi:[1,1]
  v_pk_mul_f16 v65, v40, v50 op_sel:[0,1] op_sel_hi:[1,0]
  v_smfmac_f32_16x16x64_f16 v[80:83], v[232:235], v[52:59], v16
  v_pk_mul_f16 v66, v41, v50 op_sel:[0,0] op_sel_hi:[1,1]
  v_pk_mul_f16 v67, v41, v50 op_sel:[0,1] op_sel_hi:[1,0]
  v_mfma_f32_16x16x32_f16 v[72:75], v[156:159], v[52:55], v[72:75]
  s_waitcnt lgkmcnt(0)
  v_cvt_pk_f16_f32 v43, v38, v39
  v_mfma_f32_16x16x32_f16 v[72:75], v[160:163], v[56:59], v[72:75]
  v_cvt_pk_f16_f32 v40, v32, v35
  v_cvt_pk_f16_f32 v41, v33, v36
  v_mfma_f32_16x16x32_f16 v[68:71], v[112:115], v[52:55], v[68:71]
  v_cvt_pk_f16_f32 v42, v34, v37
  v_mfma_f32_16x16x32_f16 v[68:71], v[116:119], v[56:59], v[68:71]
  ds_write_b128 v10, v[40:43]
  v_mfma_f32_16x16x32_f16 v[68:71], v[120:123], v[60:63], v[68:71]
  v_mfma_f32_16x16x32_f16 v[68:71], v[124:127], v[64:67], v[68:71]
  ds_read_b128 v[44:47], v11
  ds_read_b128 v[48:51], v12
  v_mfma_f32_16x16x32_f16 v[72:75], v[164:167], v[60:63], v[72:75]
  ds_read_b64_tr_b16 v[52:53], v8 offset:32
  ds_read_b64_tr_b16 v[54:55], v8 offset:544
  v_mfma_f32_16x16x32_f16 v[72:75], v[168:171], v[64:67], v[72:75]
  v_pk_mul_f16 v56, v40, v40 op_sel:[0,0] op_sel_hi:[1,1]
  v_pk_mul_f16 v57, v41, v41 op_sel:[0,0] op_sel_hi:[1,1]
  v_smfmac_f32_16x16x64_f16 v[80:83], v[236:239], v[60:67], v16
  v_pk_mul_f16 v58, v42, v42 op_sel:[0,0] op_sel_hi:[1,1]
  v_pk_mul_f16 v59, v40, v41 op_sel:[0,0] op_sel_hi:[1,1]
  v_mfma_f32_16x16x32_f16 v[76:79], v[208:211], v[60:63], v[76:79]
  s_nop 1
  v_mul_f32 v14, v68, v72
  v_fmac_f32 v14, v69, v73
  v_mfma_f32_16x16x32_f16 v[76:79], v[212:215], v[64:67], v[76:79]
  v_fmac_f32 v14, v70, v74
  v_fmac_f32 v14, v71, v75
L_grp1:
  s_waitcnt lgkmcnt(0)
  v_mfma_f32_16x16x32_bf16 v[72:75], v[240:243], v[52:55], 0
  v_add_f32 v22, v80, v81
  v_add_f32 v23, v82, v83
  v_mfma_f32_16x16x32_f16 v[72:75], v[128:131], v[56:59], v[72:75]
  s_nop 0
  v_fmac_f32 v14, v76, v77
  v_fmac_f32 v14, v22, v78
  v_mfma_f32_16x16x32_f16 v[68:71], v[84:87], v[56:59], 0
  v_fmac_f32 v14, v23, v79
  v_pk_mul_f16 v60, v40, v41 op_sel:[0,1] op_sel_hi:[1,0]
  v_mfma_f32_16x16x32_f16 v[80:83], v[216:219], v[56:59], 0
  v_pk_mul_f16 v61, v40, v42 op_sel:[0,0] op_sel_hi:[1,1]
  v_pk_mul_f16 v62, v40, v42 op_sel:[0,1] op_sel_hi:[1,0]
  v_mfma_f32_16x16x32_bf16 v[76:79], v[244:247], v[52:55], 0
  v_pk_mul_f16 v63, v41, v42 op_sel:[0,0] op_sel_hi:[1,1]
  v_pk_mul_f16 v64, v41, v42 op_sel:[0,1] op_sel_hi:[1,0]
  v_mfma_f32_16x16x32_f16 v[76:79], v[172:175], v[56:59], v[76:79]
  v_pk_mul_f16 v65, v40, v43 op_sel:[0,0] op_sel_hi:[1,0]
  v_pk_mul_f16 v66, v41, v43 op_sel:[0,0] op_sel_hi:[1,0]
  v_pk_mul_f16 v67, v42, v43 op_sel:[0,0] op_sel_hi:[1,0]
  v_mfma_f32_16x16x32_f16 v[76:79], v[176:179], v[60:63], v[76:79]
  v_or3_b32 v15, v56, v57, v58
  v_alignbit_b32 v48, v48, v48, v13
  v_mfma_f32_16x16x32_f16 v[76:79], v[180:183], v[64:67], v[76:79]
  v_mul_f16_sdwa v52, v40, v40 dst_sel:WORD_0 dst_unused:UNUSED_PAD src0_sel:WORD_0 src1_sel:WORD_1
  v_mul_f16_sdwa v53, v42, v42 dst_sel:WORD_0 dst_unused:UNUSED_PAD src0_sel:WORD_0 src1_sel:WORD_1
  v_smfmac_f32_16x16x64_f16 v[80:83], v[220:223], v[60:67], v16
  v_mul_f16_sdwa v52, v41, v41 dst_sel:WORD_1 dst_unused:UNUSED_PRESERVE src0_sel:WORD_0 src1_sel:WORD_1
  v_mul_f16_sdwa v53, v43, v43 dst_sel:WORD_1 dst_unused:UNUSED_PRESERVE src0_sel:WORD_0 src1_sel:WORD_1
  v_mfma_f32_16x16x32_f16 v[68:71], v[88:91], v[60:63], v[68:71]
  v_pk_mul_f16 v54, v40, v47 op_sel:[0,0] op_sel_hi:[1,0]
  v_pk_mul_f16 v55, v41, v47 op_sel:[0,0] op_sel_hi:[1,0]
  v_mfma_f32_16x16x32_f16 v[68:71], v[92:95], v[64:67], v[68:71]
  v_pk_mul_f16 v56, v42, v47 op_sel:[0,0] op_sel_hi:[1,0]
  v_pk_mul_f16 v57, v40, v44 op_sel:[0,0] op_sel_hi:[1,1]
  v_mfma_f32_16x16x32_f16 v[72:75], v[132:135], v[60:63], v[72:75]
  v_pk_mul_f16 v58, v40, v44 op_sel:[0,1] op_sel_hi:[1,0]
  v_pk_mul_f16 v59, v40, v45 op_sel:[0,0] op_sel_hi:[1,1]
  v_mfma_f32_16x16x32_f16 v[72:75], v[136:139], v[64:67], v[72:75]
  v_pk_mul_f16 v60, v40, v45 op_sel:[0,1] op_sel_hi:[1,0]
  v_pk_mul_f16 v61, v40, v46 op_sel:[0,0] op_sel_hi:[1,1]
  v_mfma_f32_16x16x32_f16 v[72:75], v[140:143], v[52:55], v[72:75]
  v_pk_mul_f16 v62, v40, v46 op_sel:[0,1] op_sel_hi:[1,0]
  v_pk_mul_f16 v63, v41, v44 op_sel:[0,0] op_sel_hi:[1,1]
  v_mfma_f32_16x16x32_f16 v[72:75], v[144:147], v[56:59], v[72:75]
  v_pk_mul_f16 v64, v41, v44 op_sel:[0,1] op_sel_hi:[1,0]
  v_pk_mul_f16 v65, v41, v45 op_sel:[0,0] op_sel_hi:[1,1]
  v_smfmac_f32_16x16x64_f16 v[80:83], v[224:227], v[52:59], v16
  v_pk_mul_f16 v66, v41, v45 op_sel:[0,1] op_sel_hi:[1,0]
  v_pk_mul_f16 v67, v41, v46 op_sel:[0,0] op_sel_hi:[1,1]
  v_mfma_f32_16x16x32_f16 v[76:79], v[184:187], v[52:55], v[76:79]
  v_alignbit_b32 v49, v49, v49, v13
  v_alignbit_b32 v50, v50, v50, v13
  v_mfma_f32_16x16x32_f16 v[76:79], v[188:191], v[56:59], v[76:79]
  ds_read_u16_d16_hi v32, v7 offset:64
  ds_read_u16_d16_hi v33, v7 offset:192
  v_mfma_f32_16x16x32_f16 v[68:71], v[96:99], v[52:55], v[68:71]
  v_pk_mul_f16 v52, v41, v46 op_sel:[0,1] op_sel_hi:[1,0]
  v_pk_mul_f16 v53, v42, v44 op_sel:[0,0] op_sel_hi:[1,1]
  v_mfma_f32_16x16x32_f16 v[68:71], v[100:103], v[56:59], v[68:71]
  v_pk_mul_f16 v54, v42, v44 op_sel:[0,1] op_sel_hi:[1,0]
  v_pk_mul_f16 v55, v42, v45 op_sel:[0,0] op_sel_hi:[1,1]
  v_mfma_f32_16x16x32_f16 v[68:71], v[104:107], v[60:63], v[68:71]
  v_pk_mul_f16 v56, v42, v45 op_sel:[0,1] op_sel_hi:[1,0]
  v_pk_mul_f16 v57, v42, v46 op_sel:[0,0] op_sel_hi:[1,1]
  v_mfma_f32_16x16x32_f16 v[68:71], v[108:111], v[64:67], v[68:71]
  v_pk_mul_f16 v58, v42, v46 op_sel:[0,1] op_sel_hi:[1,0]
  v_pk_mul_f16 v59, v40, v48 op_sel:[0,0] op_sel_hi:[1,1]
  v_smfmac_f32_16x16x64_f16 v[80:83], v[228:231], v[60:67], v16
  ds_read_u16_d16_hi v34, v7 offset:320
  ds_read_u16_d16_hi v35, v7 offset:448
  v_mfma_f32_16x16x32_f16 v[72:75], v[148:151], v[60:63], v[72:75]
  ds_read_u16_d16_hi v36, v7 offset:576
  ds_read_u16_d16_hi v37, v7 offset:704
  v_mfma_f32_16x16x32_f16 v[72:75], v[152:155], v[64:67], v[72:75]
  ds_read_u16_d16_hi v38, v7 offset:832
  ds_read_u16_d16_hi v39, v7 offset:960
  v_mfma_f32_16x16x32_f16 v[76:79], v[192:195], v[60:63], v[76:79]
  v_and_b32 v15, 0x60006000, v15
  v_cmp_ne_u32 s[90:91], 0, v15
  v_mfma_f32_16x16x32_f16 v[76:79], v[196:199], v[64:67], v[76:79]
  v_pk_mul_f16 v60, v41, v49 op_sel:[0,0] op_sel_hi:[1,1]
  v_pk_mul_f16 v61, v42, v50 op_sel:[0,0] op_sel_hi:[1,1]
  v_mfma_f32_16x16x32_f16 v[76:79], v[200:203], v[52:55], v[76:79]
  v_pk_mul_f16 v62, v40, v49 op_sel:[0,0] op_sel_hi:[1,1]
  v_pk_mul_f16 v63, v40, v49 op_sel:[0,1] op_sel_hi:[1,0]
  v_mfma_f32_16x16x32_f16 v[76:79], v[204:207], v[56:59], v[76:79]
  v_pk_mul_f16 v64, v40, v50 op_sel:[0,0] op_sel_hi:[1,1]
  v_pk_mul_f16 v65, v40, v50 op_sel:[0,1] op_sel_hi:[1,0]
  v_smfmac_f32_16x16x64_f16 v[80:83], v[232:235], v[52:59], v16
  v_pk_mul_f16 v66, v41, v50 op_sel:[0,0] op_sel_hi:[1,1]
  v_pk_mul_f16 v67, v41, v50 op_sel:[0,1] op_sel_hi:[1,0]
  v_mfma_f32_16x16x32_f16 v[72:75], v[156:159], v[52:55], v[72:75]
  s_waitcnt lgkmcnt(0)
  v_cvt_pk_f16_f32 v43, v38, v39
  v_mfma_f32_16x16x32_f16 v[72:75], v[160:163], v[56:59], v[72:75]
  v_cvt_pk_f16_f32 v40, v32, v35
  v_cvt_pk_f16_f32 v41, v33, v36
  v_mfma_f32_16x16x32_f16 v[68:71], v[112:115], v[52:55], v[68:71]
  v_cvt_pk_f16_f32 v42, v34, v37
  v_mfma_f32_16x16x32_f16 v[68:71], v[116:119], v[56:59], v[68:71]
  ds_write_b128 v10, v[40:43]
  v_mfma_f32_16x16x32_f16 v[68:71], v[120:123], v[60:63], v[68:71]
  v_mfma_f32_16x16x32_f16 v[68:71], v[124:127], v[64:67], v[68:71]
  ds_read_b128 v[44:47], v11
  ds_read_b128 v[48:51], v12
  v_mfma_f32_16x16x32_f16 v[72:75], v[164:167], v[60:63], v[72:75]
  ds_read_b64_tr_b16 v[52:53], v8 offset:64
  ds_read_b64_tr_b16 v[54:55], v8 offset:576
  v_mfma_f32_16x16x32_f16 v[72:75], v[168:171], v[64:67], v[72:75]
  v_pk_mul_f16 v56, v40, v40 op_sel:[0,0] op_sel_hi:[1,1]
  v_pk_mul_f16 v57, v41, v41 op_sel:[0,0] op_sel_hi:[1,1]
  v_smfmac_f32_16x16x64_f16 v[80:83], v[236:239], v[60:67], v16
  v_pk_mul_f16 v58, v42, v42 op_sel:[0,0] op_sel_hi:[1,1]
  v_pk_mul_f16 v59, v40, v41 op_sel:[0,0] op_sel_hi:[1,1]
  v_mfma_f32_16x16x32_f16 v[76:79], v[208:211], v[60:63], v[76:79]
  s_nop 1
  v_fmac_f32 v14, v68, v72
  v_fmac_f32 v14, v69, v73
  v_mfma_f32_16x16x32_f16 v[76:79], v[212:215], v[64:67], v[76:79]
  v_fmac_f32 v14, v70, v74
  v_fmac_f32 v14, v71, v75
  s_cmp_eq_u32 s72, s96
  s_cbranch_scc1 L_htail
  s_waitcnt lgkmcnt(0)
  v_mfma_f32_16x16x32_bf16 v[72:75], v[240:243], v[52:55], 0
  v_add_f32 v22, v80, v81
  v_add_f32 v23, v82, v83
  v_mfma_f32_16x16x32_f16 v[72:75], v[128:131], v[56:59], v[72:75]
  v_fmac_f32 v14, v76, v77
  v_fmac_f32 v14, v22, v78
  v_mfma_f32_16x16x32_f16 v[68:71], v[84:87], v[56:59], 0
  v_fmac_f32 v14, v23, v79
  v_pk_mul_f16 v60, v40, v41 op_sel:[0,1] op_sel_hi:[1,0]
  v_mfma_f32_16x16x32_f16 v[80:83], v[216:219], v[56:59], 0
  v_pk_mul_f16 v61, v40, v42 op_sel:[0,0] op_sel_hi:[1,1]
  v_pk_mul_f16 v62, v40, v42 op_sel:[0,1] op_sel_hi:[1,0]
  v_mfma_f32_16x16x32_bf16 v[76:79], v[244:247], v[52:55], 0
  v_pk_mul_f16 v63, v41, v42 op_sel:[0,0] op_sel_hi:[1,1]
  v_pk_mul_f16 v64, v41, v42 op_sel:[0,1] op_sel_hi:[1,0]
  v_mfma_f32_16x16x32_f16 v[76:79], v[172:175], v[56:59], v[76:79]
  v_pk_mul_f16 v65, v40, v43 op_sel:[0,0] op_sel_hi:[1,0]
  v_pk_mul_f16 v66, v41, v43 op_sel:[0,0] op_sel_hi:[1,0]
  v_pk_mul_f16 v67, v42, v43 op_sel:[0,0] op_sel_hi:[1,0]
  v_mfma_f32_16x16x32_f16 v[76:79], v[176:179], v[60:63], v[76:79]
  v_mul_f16_sdwa v52, v40, v40 dst_sel:WORD_0 dst_unused:UNUSED_PAD src0_sel:WORD_0 src1_sel:WORD_1
  v_mul_f16_sdwa v53, v42, v42 dst_sel:WORD_0 dst_unused:UNUSED_PAD src0_sel:WORD_0 src1_sel:WORD_1
  v_mfma_f32_16x16x32_f16 v[76:79], v[180:183], v[64:67], v[76:79]
  v_mul_f16_sdwa v52, v41, v41 dst_sel:WORD_1 dst_unused:UNUSED_PRESERVE src0_sel:WORD_0 src1_sel:WORD_1
  v_mul_f16_sdwa v53, v43, v43 dst_sel:WORD_1 dst_unused:UNUSED_PRESERVE src0_sel:WORD_0 src1_sel:WORD_1
  v_smfmac_f32_16x16x64_f16 v[80:83], v[220:223], v[60:67], v16
  v_pk_mul_f16 v54, v40, v47 op_sel:[0,0] op_sel_hi:[1,0]
  v_pk_mul_f16 v55, v41, v47 op_sel:[0,0] op_sel_hi:[1,0]
  v_mfma_f32_16x16x32_f16 v[68:71], v[88:91], v[60:63], v[68:71]
  v_pk_mul_f16 v56, v42, v47 op_sel:[0,0] op_sel_hi:[1,0]
  v_pk_mul_f16 v57, v40, v44 op_sel:[0,0] op_sel_hi:[1,1]
  v_mfma_f32_16x16x32_f16 v[68:71], v[92:95], v[64:67], v[68:71]
  v_pk_mul_f16 v58, v40, v44 op_sel:[0,1] op_sel_hi:[1,0]
  v_pk_mul_f16 v59, v40, v45 op_sel:[0,0] op_sel_hi:[1,1]
  v_mfma_f32_16x16x32_f16 v[72:75], v[132:135], v[60:63], v[72:75]
  v_pk_mul_f16 v60, v40, v45 op_sel:[0,1] op_sel_hi:[1,0]
  v_pk_mul_f16 v61, v40, v46 op_sel:[0,0] op_sel_hi:[1,1]
  v_mfma_f32_16x16x32_f16 v[72:75], v[136:139], v[64:67], v[72:75]
  v_pk_mul_f16 v62, v40, v46 op_sel:[0,1] op_sel_hi:[1,0]
  v_pk_mul_f16 v63, v41, v44 op_sel:[0,0] op_sel_hi:[1,1]
  v_mfma_f32_16x16x32_f16 v[72:75], v[140:143], v[52:55], v[72:75]
  v_pk_mul_f16 v64, v41, v44 op_sel:[0,1] op_sel_hi:[1,0]
  v_pk_mul_f16 v65, v41, v45 op_sel:[0,0] op_sel_hi:[1,1]
  v_mfma_f32_16x16x32_f16 v[72:75], v[144:147], v[56:59], v[72:75]
  v_pk_mul_f16 v66, v41, v45 op_sel:[0,1] op_sel_hi:[1,0]
  v_pk_mul_f16 v67, v41, v46 op_sel:[0,0] op_sel_hi:[1,1]
  v_smfmac_f32_16x16x64_f16 v[80:83], v[224:227], v[52:59], v16
  v_alignbit_b32 v48, v48, v48, v13
  v_alignbit_b32 v49, v49, v49, v13
  v_mfma_f32_16x16x32_f16 v[76:79], v[184:187], v[52:55], v[76:79]
  v_alignbit_b32 v50, v50, v50, v13
  ds_read_u16_d16_hi v32, v7 offset:96
  v_mfma_f32_16x16x32_f16 v[76:79], v[188:191], v[56:59], v[76:79]
  ds_read_u16_d16_hi v33, v7 offset:224
  ds_read_u16_d16_hi v34, v7 offset:352
  s_cmp_lg_u32 s99, 8
  s_cbranch_scc1 L_hk
  s_waitcnt vmcnt(0)
  v_readfirstlane_b32 s81, v250
  s_mov_b32 s99, 0
  s_add_u32 s81, s81, 1
  s_cmp_ge_u32 s81, 36
  s_cbranch_scc1 L_hk
  s_add_u32 s72, s72, 1
  s_mov_b32 s26, 10240
  s_cmp_lt_u32 s81, 20
  s_cbranch_scc1 L_hkf
  s_add_u32 s81, s81, 20
  s_and_b32 s94, s81, 1
  s_lshr_b32 s81, s81, 1
  s_mov_b32 s96, 1
  s_lshl_b32 s94, s94, 6
  v_xor_b32 v18, s94, v18
  s_lshl_b32 s94, s94, 5
  s_add_u32 s26, s26, s94
L_hkf:
  s_add_u32 s81, s81, 484
  s_lshl_b32 s94, s81, 2
  s_add_u32 s26, s26, s94
  s_andn2_b32 s94, s98, 0x3fff
  s_add_u32 s26, s26, s94
  s_lshr_b32 s94, s94, 5
  s_add_u32 s94, s94, s81
  s_mul_i32 s94, s94, 104
L_hk:
  buffer_load_dwordx4 v[24:27], v17, s[28:31], s94 offen offset:0
  v_mfma_f32_16x16x32_f16 v[68:71], v[96:99], v[52:55], v[68:71]
  v_pk_mul_f16 v52, v41, v46 op_sel:[0,1] op_sel_hi:[1,0]
  v_pk_mul_f16 v53, v42, v44 op_sel:[0,0] op_sel_hi:[1,1]
  v_mfma_f32_16x16x32_f16 v[68:71], v[100:103], v[56:59], v[68:71]
  v_pk_mul_f16 v54, v42, v44 op_sel:[0,1] op_sel_hi:[1,0]
  v_pk_mul_f16 v55, v42, v45 op_sel:[0,0] op_sel_hi:[1,1]
  v_mfma_f32_16x16x32_f16 v[68:71], v[104:107], v[60:63], v[68:71]
  v_pk_mul_f16 v56, v42, v45 op_sel:[0,1] op_sel_hi:[1,0]
  v_pk_mul_f16 v57, v42, v46 op_sel:[0,0] op_sel_hi:[1,1]
  v_mfma_f32_16x16x32_f16 v[68:71], v[108:111], v[64:67], v[68:71]
  v_pk_mul_f16 v58, v42, v46 op_sel:[0,1] op_sel_hi:[1,0]
  v_pk_mul_f16 v59, v40, v48 op_sel:[0,0] op_sel_hi:[1,1]
  v_smfmac_f32_16x16x64_f16 v[80:83], v[228:231], v[60:67], v16
  ds_read_u16_d16_hi v35, v7 offset:480
  ds_read_u16_d16_hi v36, v7 offset:608
  v_mfma_f32_16x16x32_f16 v[72:75], v[148:151], v[60:63], v[72:75]
  ds_read_u16_d16_hi v37, v7 offset:736
  ds_read_u16_d16_hi v38, v7 offset:864
  v_mfma_f32_16x16x32_f16 v[72:75], v[152:155], v[64:67], v[72:75]
  ds_read_u16_d16_hi v39, v7 offset:992
  v_mfma_f32_16x16x32_f16 v[76:79], v[192:195], v[60:63], v[76:79]
  v_pk_mul_f16 v60, v41, v49 op_sel:[0,0] op_sel_hi:[1,1]
  v_pk_mul_f16 v61, v42, v50 op_sel:[0,0] op_sel_hi:[1,1]
  v_mfma_f32_16x16x32_f16 v[76:79], v[196:199], v[64:67], v[76:79]
  v_pk_mul_f16 v62, v40, v49 op_sel:[0,0] op_sel_hi:[1,1]
  v_pk_mul_f16 v63, v40, v49 op_sel:[0,1] op_sel_hi:[1,0]
  v_mfma_f32_16x16x32_f16 v[76:79], v[200:203], v[52:55], v[76:79]
  v_pk_mul_f16 v64, v40, v50 op_sel:[0,0] op_sel_hi:[1,1]
  v_pk_mul_f16 v65, v40, v50 op_sel:[0,1] op_sel_hi:[1,0]
  s_cmp_lg_u32 s84, 0
  s_cbranch_scc1 L_pr110
  s_setprio 0
L_pr110:
  v_mfma_f32_16x16x32_f16 v[76:79], v[204:207], v[56:59], v[76:79]
  v_pk_mul_f16 v66, v41, v50 op_sel:[0,0] op_sel_hi:[1,1]
  v_pk_mul_f16 v67, v41, v50 op_sel:[0,1] op_sel_hi:[1,0]
  v_smfmac_f32_16x16x64_f16 v[80:83], v[232:235], v[52:59], v16
  s_waitcnt lgkmcnt(0)
  v_cvt_pk_f16_f32 v43, v38, v39
  v_mfma_f32_16x16x32_f16 v[72:75], v[156:159], v[52:55], v[72:75]
  v_cvt_pk_f16_f32 v40, v32, v35
  v_cvt_pk_f16_f32 v41, v33, v36
  v_mfma_f32_16x16x32_f16 v[72:75], v[160:163], v[56:59], v[72:75]
  v_cvt_pk_f16_f32 v42, v34, v37
  v_mfma_f32_16x16x32_f16 v[68:71], v[112:115], v[52:55], v[68:71]
  ds_write_b128 v10, v[40:43]
  v_mfma_f32_16x16x32_f16 v[68:71], v[116:119], v[56:59], v[68:71]
  v_add_u32 v7, s75, v7
  s_waitcnt vmcnt(1)
  v_mfma_f32_16x16x32_f16 v[68:71], v[120:123], v[60:63], v[68:71]
  ds_read_b128 v[44:47], v11
  ds_read_b128 v[48:51], v12
  v_mfma_f32_16x16x32_f16 v[68:71], v[124:127], v[64:67], v[68:71]
  ds_read_b64_tr_b16 v[52:53], v8 offset:96
  ds_read_b64_tr_b16 v[54:55], v8 offset:608
  v_mfma_f32_16x16x32_f16 v[72:75], v[164:167], v[60:63], v[72:75]
  v_pk_mul_f16 v56, v40, v40 op_sel:[0,0] op_sel_hi:[1,1]
  v_pk_mul_f16 v57, v41, v41 op_sel:[0,0] op_sel_hi:[1,1]
  v_mfma_f32_16x16x32_f16 v[72:75], v[168:171], v[64:67], v[72:75]
  v_pk_mul_f16 v58, v42, v42 op_sel:[0,0] op_sel_hi:[1,1]
  v_pk_mul_f16 v59, v40, v41 op_sel:[0,0] op_sel_hi:[1,1]
  v_smfmac_f32_16x16x64_f16 v[80:83], v[236:239], v[60:67], v16
  ds_read_u16_d16_hi v32, v7 offset:0
  ds_read_u16_d16_hi v33, v7 offset:128
  v_mfma_f32_16x16x32_f16 v[76:79], v[208:211], v[60:63], v[76:79]
  s_nop 1
  v_fmac_f32 v14, v68, v72
  v_fmac_f32 v14, v69, v73
  v_mfma_f32_16x16x32_f16 v[76:79], v[212:215], v[64:67], v[76:79]
  v_fmac_f32 v14, v70, v74
  v_fmac_f32 v14, v71, v75
  s_waitcnt lgkmcnt(2)
  v_mfma_f32_16x16x32_bf16 v[72:75], v[240:243], v[52:55], 0
  v_add_f32 v22, v80, v81
  v_add_f32 v23, v82, v83
  v_mfma_f32_16x16x32_f16 v[72:75], v[128:131], v[56:59], v[72:75]
  s_nop 0
  v_fmac_f32 v14, v76, v77
  v_fmac_f32 v14, v22, v78
  v_mfma_f32_16x16x32_f16 v[68:71], v[84:87], v[56:59], 0
  v_fmac_f32 v14, v23, v79
  v_pk_mul_f16 v60, v40, v41 op_sel:[0,1] op_sel_hi:[1,0]
  v_mfma_f32_16x16x32_f16 v[80:83], v[216:219], v[56:59], 0
  v_pk_mul_f16 v61, v40, v42 op_sel:[0,0] op_sel_hi:[1,1]
  v_pk_mul_f16 v62, v40, v42 op_sel:[0,1] op_sel_hi:[1,0]
  v_mfma_f32_16x16x32_bf16 v[76:79], v[244:247], v[52:55], 0
  v_pk_mul_f16 v63, v41, v42 op_sel:[0,0] op_sel_hi:[1,1]
  v_pk_mul_f16 v64, v41, v42 op_sel:[0,1] op_sel_hi:[1,0]
  v_mfma_f32_16x16x32_f16 v[76:79], v[172:175], v[56:59], v[76:79]
  v_pk_mul_f16 v65, v40, v43 op_sel:[0,0] op_sel_hi:[1,0]
  v_pk_mul_f16 v66, v41, v43 op_sel:[0,0] op_sel_hi:[1,0]
  v_pk_mul_f16 v67, v42, v43 op_sel:[0,0] op_sel_hi:[1,0]
  v_mfma_f32_16x16x32_f16 v[76:79], v[176:179], v[60:63], v[76:79]
  v_mul_f16_sdwa v52, v40, v40 dst_sel:WORD_0 dst_unused:UNUSED_PAD src0_sel:WORD_0 src1_sel:WORD_1
  v_mul_f16_sdwa v53, v42, v42 dst_sel:WORD_0 dst_unused:UNUSED_PAD src0_sel:WORD_0 src1_sel:WORD_1
  v_mfma_f32_16x16x32_f16 v[76:79], v[180:183], v[64:67], v[76:79]
  v_mul_f16_sdwa v52, v41, v41 dst_sel:WORD_1 dst_unused:UNUSED_PRESERVE src0_sel:WORD_0 src1_sel:WORD_1
  v_mul_f16_sdwa v53, v43, v43 dst_sel:WORD_1 dst_unused:UNUSED_PRESERVE src0_sel:WORD_0 src1_sel:WORD_1
  v_smfmac_f32_16x16x64_f16 v[80:83], v[220:223], v[60:67], v16
  v_pk_mul_f16 v54, v40, v47 op_sel:[0,0] op_sel_hi:[1,0]
  v_pk_mul_f16 v55, v41, v47 op_sel:[0,0] op_sel_hi:[1,0]
  v_mfma_f32_16x16x32_f16 v[68:71], v[88:91], v[60:63], v[68:71]
  v_pk_mul_f16 v56, v42, v47 op_sel:[0,0] op_sel_hi:[1,0]
  v_pk_mul_f16 v57, v40, v44 op_sel:[0,0] op_sel_hi:[1,1]
  v_mfma_f32_16x16x32_f16 v[68:71], v[92:95], v[64:67], v[68:71]
  v_pk_mul_f16 v58, v40, v44 op_sel:[0,1] op_sel_hi:[1,0]
  v_pk_mul_f16 v59, v40, v45 op_sel:[0,0] op_sel_hi:[1,1]
  v_mfma_f32_16x16x32_f16 v[72:75], v[132:135], v[60:63], v[72:75]
  v_pk_mul_f16 v60, v40, v45 op_sel:[0,1] op_sel_hi:[1,0]
  v_pk_mul_f16 v61, v40, v46 op_sel:[0,0] op_sel_hi:[1,1]
  v_mfma_f32_16x16x32_f16 v[72:75], v[136:139], v[64:67], v[72:75]
  v_pk_mul_f16 v62, v40, v46 op_sel:[0,1] op_sel_hi:[1,0]
  v_pk_mul_f16 v63, v41, v44 op_sel:[0,0] op_sel_hi:[1,1]
  v_mfma_f32_16x16x32_f16 v[72:75], v[140:143], v[52:55], v[72:75]
  v_pk_mul_f16 v64, v41, v44 op_sel:[0,1] op_sel_hi:[1,0]
  v_pk_mul_f16 v65, v41, v45 op_sel:[0,0] op_sel_hi:[1,1]
  v_mfma_f32_16x16x32_f16 v[72:75], v[144:147], v[56:59], v[72:75]
  v_pk_mul_f16 v66, v41, v45 op_sel:[0,1] op_sel_hi:[1,0]
  v_pk_mul_f16 v67, v41, v46 op_sel:[0,0] op_sel_hi:[1,1]
  v_smfmac_f32_16x16x64_f16 v[80:83], v[224:227], v[52:59], v16
  v_alignbit_b32 v48, v48, v48, v13
  v_alignbit_b32 v49, v49, v49, v13
  v_mfma_f32_16x16x32_f16 v[76:79], v[184:187], v[52:55], v[76:79]
  v_alignbit_b32 v50, v50, v50, v13
  ds_read_u16_d16_hi v34, v7 offset:256
  v_mfma_f32_16x16x32_f16 v[76:79], v[188:191], v[56:59], v[76:79]
  ds_read_u16_d16_hi v35, v7 offset:384
  ds_read_u16_d16_hi v36, v7 offset:512
  v_mfma_f32_16x16x32_f16 v[68:71], v[96:99], v[52:55], v[68:71]
  v_pk_mul_f16 v52, v41, v46 op_sel:[0,1] op_sel_hi:[1,0]
  v_pk_mul_f16 v53, v42, v44 op_sel:[0,0] op_sel_hi:[1,1]
  v_mfma_f32_16x16x32_f16 v[68:71], v[100:103], v[56:59], v[68:71]
  v_pk_mul_f16 v54, v42, v44 op_sel:[0,1] op_sel_hi:[1,0]
  v_pk_mul_f16 v55, v42, v45 op_sel:[0,0] op_sel_hi:[1,1]
  v_mfma_f32_16x16x32_f16 v[68:71], v[104:107], v[60:63], v[68:71]
  v_pk_mul_f16 v56, v42, v45 op_sel:[0,1] op_sel_hi:[1,0]
  v_pk_mul_f16 v57, v42, v46 op_sel:[0,0] op_sel_hi:[1,1]
  v_mfma_f32_16x16x32_f16 v[68:71], v[108:111], v[64:67], v[68:71]
  v_pk_mul_f16 v58, v42, v46 op_sel:[0,1] op_sel_hi:[1,0]
  v_pk_mul_f16 v59, v40, v48 op_sel:[0,0] op_sel_hi:[1,1]
  v_smfmac_f32_16x16x64_f16 v[80:83], v[228:231], v[60:67], v16
  ds_read_u16_d16_hi v37, v7 offset:640
  ds_read_u16_d16_hi v38, v7 offset:768
  v_mfma_f32_16x16x32_f16 v[72:75], v[148:151], v[60:63], v[72:75]
  ds_read_u16_d16_hi v39, v7 offset:896
  s_add_u32 s81, s74, s75
  v_add_u32 v8, s81, v9
  v_mfma_f32_16x16x32_f16 v[72:75], v[152:155], v[64:67], v[72:75]
  v_mfma_f32_16x16x32_f16 v[76:79], v[192:195], v[60:63], v[76:79]
  v_pk_mul_f16 v60, v41, v49 op_sel:[0,0] op_sel_hi:[1,1]
  v_pk_mul_f16 v61, v42, v50 op_sel:[0,0] op_sel_hi:[1,1]
  v_mfma_f32_16x16x32_f16 v[76:79], v[196:199], v[64:67], v[76:79]
  v_pk_mul_f16 v62, v40, v49 op_sel:[0,0] op_sel_hi:[1,1]
  v_pk_mul_f16 v63, v40, v49 op_sel:[0,1] op_sel_hi:[1,0]
  v_mfma_f32_16x16x32_f16 v[76:79], v[200:203], v[52:55], v[76:79]
  v_pk_mul_f16 v64, v40, v50 op_sel:[0,0] op_sel_hi:[1,1]
  v_pk_mul_f16 v65, v40, v50 op_sel:[0,1] op_sel_hi:[1,0]
  v_mfma_f32_16x16x32_f16 v[76:79], v[204:207], v[56:59], v[76:79]
  v_pk_mul_f16 v66, v41, v50 op_sel:[0,0] op_sel_hi:[1,1]
  v_pk_mul_f16 v67, v41, v50 op_sel:[0,1] op_sel_hi:[1,0]
  v_smfmac_f32_16x16x64_f16 v[80:83], v[232:235], v[52:59], v16
  s_waitcnt lgkmcnt(0)
  v_cvt_pk_f16_f32 v43, v38, v39
  v_mfma_f32_16x16x32_f16 v[72:75], v[156:159], v[52:55], v[72:75]
  v_cvt_pk_f16_f32 v40, v32, v35
  v_cvt_pk_f16_f32 v41, v33, v36
  v_mfma_f32_16x16x32_f16 v[72:75], v[160:163], v[56:59], v[72:75]
  v_cvt_pk_f16_f32 v42, v34, v37
  v_mfma_f32_16x16x32_f16 v[68:71], v[112:115], v[52:55], v[68:71]
  ds_write_b128 v10, v[40:43]
  v_mfma_f32_16x16x32_f16 v[68:71], v[116:119], v[56:59], v[68:71]
  v_mfma_f32_16x16x32_f16 v[68:71], v[120:123], v[60:63], v[68:71]
  ds_read_b128 v[44:47], v11
  ds_read_b128 v[48:51], v12
  v_mfma_f32_16x16x32_f16 v[68:71], v[124:127], v[64:67], v[68:71]
  ds_read_b64_tr_b16 v[52:53], v8 offset:0
  ds_read_b64_tr_b16 v[54:55], v8 offset:512
  v_mfma_f32_16x16x32_f16 v[72:75], v[164:167], v[60:63], v[72:75]
  v_pk_mul_f16 v56, v40, v40 op_sel:[0,0] op_sel_hi:[1,1]
  v_pk_mul_f16 v57, v41, v41 op_sel:[0,0] op_sel_hi:[1,1]
  v_mfma_f32_16x16x32_f16 v[72:75], v[168:171], v[64:67], v[72:75]
  v_pk_mul_f16 v58, v42, v42 op_sel:[0,0] op_sel_hi:[1,1]
  v_pk_mul_f16 v59, v40, v41 op_sel:[0,0] op_sel_hi:[1,1]
  v_smfmac_f32_16x16x64_f16 v[80:83], v[236:239], v[60:67], v16
  ds_read_u16_d16_hi v32, v7 offset:32
  ds_read_u16_d16_hi v33, v7 offset:160
  v_mfma_f32_16x16x32_f16 v[76:79], v[208:211], v[60:63], v[76:79]
  s_nop 1
  v_fmac_f32 v14, v68, v72
  v_fmac_f32 v14, v69, v73
  v_mfma_f32_16x16x32_f16 v[76:79], v[212:215], v[64:67], v[76:79]
  v_fmac_f32 v14, v70, v74
  v_fmac_f32 v14, v71, v75
  s_cmp_lg_u32 s72, 1
  s_cbranch_scc1 L_cin_loop
  v_add_f32 v22, v80, v81
  v_add_f32 v23, v82, v83
  s_nop 1
  v_fmac_f32 v14, v76, v77
  v_fmac_f32 v14, v22, v78
  v_fmac_f32 v14, v23, v79
  s_nop 1
  v_add_f32_dpp v14, v14, v14 row_shr:1 row_mask:0xf bank_mask:0xf
  s_nop 1
  v_add_f32_dpp v14, v14, v14 row_shr:2 row_mask:0xf bank_mask:0xf
  s_nop 1
  v_add_f32_dpp v14, v14, v14 row_shr:4 row_mask:0xf bank_mask:0xf
  s_nop 1
  v_add_f32_dpp v14, v14, v14 row_shr:8 row_mask:0xf bank_mask:0xf
  s_nop 1
  v_add_f32_dpp v14, v14, v14 row_bcast:15 row_mask:0xa bank_mask:0xf
  s_nop 1
  v_add_f32_dpp v14, v14, v14 row_bcast:31 row_mask:0xc bank_mask:0xf
  s_branch L_blk
L_htail:
  v_add_f32 v22, v80, v81
  v_add_f32 v23, v82, v83
  s_nop 1
  v_fmac_f32 v14, v76, v77
  v_fmac_f32 v14, v22, v78
  v_fmac_f32 v14, v23, v79
  s_nop 1
  v_add_f32_dpp v14, v14, v14 row_shr:1 row_mask:0xf bank_mask:0xf
  s_nop 1
  v_add_f32_dpp v14, v14, v14 row_shr:2 row_mask:0xf bank_mask:0xf
  s_nop 1
  v_add_f32_dpp v14, v14, v14 row_shr:4 row_mask:0xf bank_mask:0xf
  s_nop 1
  v_add_f32_dpp v14, v14, v14 row_shr:8 row_mask:0xf bank_mask:0xf
  s_nop 1
  v_add_f32_dpp v14, v14, v14 row_bcast:15 row_mask:0xa bank_mask:0xf
  s_nop 1
  v_add_f32_dpp v14, v14, v14 row_bcast:31 row_mask:0xc bank_mask:0xf
  v_add_u32 v7, s75, v7
  s_branch L_blk
L_slow:
  v_subrev_u32 v7, s75, v7
L_slow2:
  v_lshlrev_b32 v22, 1, v0
  v_add_u32 v23, s74, v22
  s_mul_i32 s81, s3, 4224
  s_add_u32 s81, s81, 1024
  v_add_u32 v22, s81, v22
  v_add_u32 v8, s81, v9
L_csync10:
  ds_read_b32 v4, v2 offset:12
  s_waitcnt lgkmcnt(0)
  v_cmp_gt_u32 vcc, 8, v4
  s_cbranch_vccnz L_csync10
  ds_read_u16 v52, v23 offset:0
  ds_read_u16 v53, v23 offset:128
  ds_read_u16 v54, v23 offset:256
  ds_read_u16 v55, v23 offset:384
  ds_read_u16 v56, v23 offset:512
  ds_read_u16 v57, v23 offset:640
  ds_read_u16 v58, v23 offset:768
  ds_read_u16 v59, v23 offset:896
  ds_read_u16 v60, v23 offset:1056
  ds_read_u16 v61, v23 offset:1184
  ds_read_u16 v62, v23 offset:1312
  ds_read_u16 v63, v23 offset:1440
  ds_read_u16 v64, v23 offset:1568
  ds_read_u16 v65, v23 offset:1696
  ds_read_u16 v66, v23 offset:1824
  ds_read_u16 v67, v23 offset:1952
  ds_read_u16 v68, v23 offset:2112
  ds_read_u16 v69, v23 offset:2240
  ds_read_u16 v70, v23 offset:2368
  ds_read_u16 v71, v23 offset:2496
  ds_read_u16 v72, v23 offset:2624
  ds_read_u16 v73, v23 offset:2752
  ds_read_u16 v74, v23 offset:2880
  ds_read_u16 v75, v23 offset:3008
  ds_read_u16 v76, v23 offset:3168
  ds_read_u16 v77, v23 offset:3296
  ds_read_u16 v78, v23 offset:3424
  ds_read_u16 v79, v23 offset:3552
  ds_read_u16 v80, v23 offset:3680
  ds_read_u16 v81, v23 offset:3808
  ds_read_u16 v82, v23 offset:3936
  s_waitcnt lgkmcnt(14)
  v_lshlrev_b32 v52, 16, v52
  v_lshlrev_b32 v53, 16, v53
  v_lshlrev_b32 v54, 16, v54
  v_lshlrev_b32 v55, 16, v55
  v_lshlrev_b32 v56, 16, v56
  v_lshlrev_b32 v57, 16, v57
  v_lshlrev_b32 v58, 16, v58
  v_lshlrev_b32 v59, 16, v59
  v_lshlrev_b32 v60, 16, v60
  v_lshlrev_b32 v61, 16, v61
  v_lshlrev_b32 v62, 16, v62
  v_lshlrev_b32 v63, 16, v63
  v_lshlrev_b32 v64, 16, v64
  v_lshlrev_b32 v65, 16, v65
  v_lshlrev_b32 v66, 16, v66
  v_lshlrev_b32 v67, 16, v67
  v_lshlrev_b32 v68, 16, v68
  s_waitcnt lgkmcnt(13)
  v_lshlrev_b32 v69, 16, v69
  s_waitcnt lgkmcnt(12)
  v_lshlrev_b32 v70, 16, v70
  s_waitcnt lgkmcnt(11)
  v_lshlrev_b32 v71, 16, v71
  s_waitcnt lgkmcnt(10)
  v_lshlrev_b32 v72, 16, v72
  s_waitcnt lgkmcnt(9)
  v_lshlrev_b32 v73, 16, v73
  s_waitcnt lgkmcnt(8)
  v_lshlrev_b32 v74, 16, v74
  s_waitcnt lgkmcnt(7)
  v_lshlrev_b32 v75, 16, v75
  s_waitcnt lgkmcnt(6)
  v_lshlrev_b32 v76, 16, v76
  s_waitcnt lgkmcnt(5)
  v_lshlrev_b32 v77, 16, v77
  s_waitcnt lgkmcnt(4)
  v_lshlrev_b32 v78, 16, v78
  s_waitcnt lgkmcnt(3)
  v_lshlrev_b32 v79, 16, v79
  s_waitcnt lgkmcnt(2)
  v_lshlrev_b32 v80, 16, v80
  s_waitcnt lgkmcnt(1)
  v_lshlrev_b32 v81, 16, v81
  s_waitcnt lgkmcnt(0)
  v_lshlrev_b32 v82, 16, v82
  v_max3_f32 v14, abs(v52), abs(v53), abs(v54)
  v_max3_f32 v14, v14, abs(v55), abs(v56)
  v_max3_f32 v14, v14, abs(v57), abs(v58)
  v_max3_f32 v14, v14, abs(v59), abs(v60)
  v_max3_f32 v14, v14, abs(v61), abs(v62)
  v_max3_f32 v14, v14, abs(v63), abs(v64)
  v_max3_f32 v14, v14, abs(v65), abs(v66)
  v_max3_f32 v14, v14, abs(v67), abs(v68)
  v_max3_f32 v14, v14, abs(v69), abs(v70)
  v_max3_f32 v14, v14, abs(v71), abs(v72)
  v_max3_f32 v14, v14, abs(v73), abs(v74)
  v_max3_f32 v14, v14, abs(v75), abs(v76)
  v_max3_f32 v14, v14, abs(v77), abs(v78)
  v_max3_f32 v14, v14, abs(v79), abs(v80)
  v_max3_f32 v14, v14, abs(v81), abs(v82)
  s_nop 1
  v_max_u32_dpp v14, v14, v14 row_shr:1 row_mask:0xf bank_mask:0xf
  s_nop 1
  v_max_u32_dpp v14, v14, v14 row_shr:2 row_mask:0xf bank_mask:0xf
  s_nop 1
  v_max_u32_dpp v14, v14, v14 row_shr:4 row_mask:0xf bank_mask:0xf
  s_nop 1
  v_max_u32_dpp v14, v14, v14 row_shr:8 row_mask:0xf bank_mask:0xf
  s_nop 1
  v_max_u32_dpp v14, v14, v14 row_bcast:15 row_mask:0xa bank_mask:0xf
  s_nop 1
  v_max_u32_dpp v14, v14, v14 row_bcast:31 row_mask:0xc bank_mask:0xf
  s_nop 0
  v_readlane_b32 s81, v14, 63
  s_nop 0
  s_lshr_b32 s81, s81, 23
  s_sub_i32 s81, 134, s81
  s_cmp_le_u32 s81, 9
  s_cselect_b32 s97, 2, 3
  s_min_i32 s81, s81, 16
  s_lshl_b32 s49, s81, 2
  s_sub_i32 s49, s48, s49
  s_add_i32 s81, s81, 127
  s_lshl_b32 s81, s81, 23
  v_mov_b32 v83, s81
  v_mul_f32 v52, s81, v52
  v_mul_f32 v53, s81, v53
  v_mul_f32 v54, s81, v54
  v_mul_f32 v55, s81, v55
  v_mul_f32 v56, s81, v56
  v_mul_f32 v57, s81, v57
  v_mul_f32 v58, s81, v58
  v_mul_f32 v59, s81, v59
  v_mul_f32 v60, s81, v60
  v_mul_f32 v61, s81, v61
  v_mul_f32 v62, s81, v62
  v_mul_f32 v63, s81, v63
  v_mul_f32 v64, s81, v64
  v_mul_f32 v65, s81, v65
  v_mul_f32 v66, s81, v66
  v_mul_f32 v67, s81, v67
  v_mul_f32 v68, s81, v68
  v_mul_f32 v69, s81, v69
  v_mul_f32 v70, s81, v70
  v_mul_f32 v71, s81, v71
  v_mul_f32 v72, s81, v72
  v_mul_f32 v73, s81, v73
  v_mul_f32 v74, s81, v74
  v_mul_f32 v75, s81, v75
  v_mul_f32 v76, s81, v76
  v_mul_f32 v77, s81, v77
  v_mul_f32 v78, s81, v78
  v_mul_f32 v79, s81, v79
  v_mul_f32 v80, s81, v80
  v_mul_f32 v81, s81, v81
  v_mul_f32 v82, s81, v82
  ds_write_b16_d16_hi v23, v52 offset:0
  ds_write_b16_d16_hi v23, v53 offset:128
  ds_write_b16_d16_hi v23, v54 offset:256
  ds_write_b16_d16_hi v23, v55 offset:384
  ds_write_b16_d16_hi v23, v56 offset:512
  ds_write_b16_d16_hi v23, v57 offset:640
  ds_write_b16_d16_hi v23, v58 offset:768
  ds_write_b16_d16_hi v23, v59 offset:896
  ds_write_b16_d16_hi v23, v60 offset:1056
  ds_write_b16_d16_hi v23, v61 offset:1184
  ds_write_b16_d16_hi v23, v62 offset:1312
  ds_write_b16_d16_hi v23, v63 offset:1440
  ds_write_b16_d16_hi v23, v64 offset:1568
  ds_write_b16_d16_hi v23, v65 offset:1696
  ds_write_b16_d16_hi v23, v66 offset:1824
  ds_write_b16_d16_hi v23, v67 offset:1952
  ds_write_b16_d16_hi v23, v68 offset:2112
  ds_write_b16_d16_hi v23, v69 offset:2240
  ds_write_b16_d16_hi v23, v70 offset:2368
  ds_write_b16_d16_hi v23, v71 offset:2496
  ds_write_b16_d16_hi v23, v72 offset:2624
  ds_write_b16_d16_hi v23, v73 offset:2752
  ds_write_b16_d16_hi v23, v74 offset:2880
  ds_write_b16_d16_hi v23, v75 offset:3008
  ds_write_b16_d16_hi v23, v76 offset:3168
  ds_write_b16_d16_hi v23, v77 offset:3296
  ds_write_b16_d16_hi v23, v78 offset:3424
  ds_write_b16_d16_hi v23, v79 offset:3552
  ds_write_b16_d16_hi v23, v80 offset:3680
  ds_write_b16_d16_hi v23, v81 offset:3808
  ds_write_b16_d16_hi v23, v82 offset:3936
  v_mul_f32 v52, s81, v52
  v_mul_f32 v53, s81, v53
  v_mul_f32 v54, s81, v54
  v_mul_f32 v55, s81, v55
  v_mul_f32 v56, s81, v56
  v_mul_f32 v57, s81, v57
  v_mul_f32 v58, s81, v58
  v_mul_f32 v59, s81, v59
  v_mul_f32 v60, s81, v60
  v_mul_f32 v61, s81, v61
  v_mul_f32 v62, s81, v62
  v_mul_f32 v63, s81, v63
  v_mul_f32 v64, s81, v64
  v_mul_f32 v65, s81, v65
  v_mul_f32 v66, s81, v66
  v_mul_f32 v67, s81, v67
  v_mul_f32 v68, s81, v68
  v_mul_f32 v69, s81, v69
  v_mul_f32 v70, s81, v70
  v_mul_f32 v71, s81, v71
  v_mul_f32 v72, s81, v72
  v_mul_f32 v73, s81, v73
  v_mul_f32 v74, s81, v74
  v_mul_f32 v75, s81, v75
  v_mul_f32 v76, s81, v76
  v_mul_f32 v77, s81, v77
  v_mul_f32 v78, s81, v78
  v_mul_f32 v79, s81, v79
  v_mul_f32 v80, s81, v80
  v_mul_f32 v81, s81, v81
  v_mul_f32 v82, s81, v82
  v_mul_f32 v83, s81, v83
  ds_write_b16_d16_hi v22, v52 offset:0
  ds_write_b16_d16_hi v22, v53 offset:128
  ds_write_b16_d16_hi v22, v54 offset:256
  ds_write_b16_d16_hi v22, v55 offset:384
  ds_write_b16_d16_hi v22, v56 offset:512
  ds_write_b16_d16_hi v22, v57 offset:640
  ds_write_b16_d16_hi v22, v58 offset:768
  ds_write_b16_d16_hi v22, v59 offset:896
  ds_write_b16_d16_hi v22, v60 offset:1056
  ds_write_b16_d16_hi v22, v61 offset:1184
  ds_write_b16_d16_hi v22, v62 offset:1312
  ds_write_b16_d16_hi v22, v63 offset:1440
  ds_write_b16_d16_hi v22, v64 offset:1568
  ds_write_b16_d16_hi v22, v65 offset:1696
  ds_write_b16_d16_hi v22, v66 offset:1824
  ds_write_b16_d16_hi v22, v67 offset:1952
  ds_write_b16_d16_hi v22, v68 offset:2112
  ds_write_b16_d16_hi v22, v69 offset:2240
  ds_write_b16_d16_hi v22, v70 offset:2368
  ds_write_b16_d16_hi v22, v71 offset:2496
  ds_write_b16_d16_hi v22, v72 offset:2624
  ds_write_b16_d16_hi v22, v73 offset:2752
  ds_write_b16_d16_hi v22, v74 offset:2880
  ds_write_b16_d16_hi v22, v75 offset:3008
  ds_write_b16_d16_hi v22, v76 offset:3168
  ds_write_b16_d16_hi v22, v77 offset:3296
  ds_write_b16_d16_hi v22, v78 offset:3424
  ds_write_b16_d16_hi v22, v79 offset:3552
  ds_write_b16_d16_hi v22, v80 offset:3680
  ds_write_b16_d16_hi v22, v81 offset:3808
  ds_write_b16_d16_hi v22, v82 offset:3936
  ds_write_b16_d16_hi v22, v83 offset:4064
  s_mov_b32 s50, 0
  s_waitcnt lgkmcnt(0)
  s_branch L_prime
L_cin_done:
  s_endpgm
L_rem:
  s_lshr_b32 s84, s3, 2
  s_and_b32 s68, s2, 7
  s_lshl_b32 s68, s68, 3
  s_add_u32 s68, s68, s3
  s_mul_i32 s68, s68, 6656
  s_lshl_b32 s76, s3, 14
  v_lshlrev_b32 v248, 4, v0
  v_lshrrev_b32 v246, 4, v0
  v_lshrrev_b32 v247, 3, v0
  v_mul_u32_u24 v13, 3328, v247
  v_and_b32 v247, 2, v247
  s_and_b32 s69, s3, 1
  s_lshl_b32 s69, s69, 2
  v_or_b32 v247, s69, v247
  v_and_b32 v9, 7, v0
  v_xor_b32 v247, v247, v9
  v_lshl_add_u32 v13, v247, 4, v13
  s_mul_i32 s74, s3, 26624
  s_add_u32 s74, s74, 3200
  s_lshl_b32 s75, s3, 10
  s_add_u32 s75, s75, 131072
  s_waitcnt lgkmcnt(0)
  s_load_dword s80, s[18:19], 0
  s_mov_b32 s28, s4
  s_and_b32 s29, s5, 0xffff
  s_mov_b32 s30, 425984
  s_mov_b32 s31, 0x20000
  s_add_u32 m0, s76, 8192
  s_nop 0
  buffer_load_dwordx4 v248, s[28:31], s68 offen lds
  s_add_u32 s68, s68, 1024
  s_add_u32 m0, s76, 9216
  s_nop 0
  buffer_load_dwordx4 v248, s[28:31], s68 offen lds
  s_add_u32 s68, s68, 1024
  s_add_u32 m0, s76, 10240
  s_nop 0
  buffer_load_dwordx4 v248, s[28:31], s68 offen lds
  s_add_u32 s68, s68, 1024
  s_add_u32 m0, s76, 11264
  s_nop 0
  buffer_load_dwordx4 v248, s[28:31], s68 offen lds
  s_add_u32 s68, s68, 1024
  s_add_u32 m0, s76, 12288
  s_nop 0
  buffer_load_dwordx4 v248, s[28:31], s68 offen lds
  s_add_u32 s68, s68, 1024
  s_add_u32 m0, s76, 13312
  s_nop 0
  buffer_load_dwordx4 v248, s[28:31], s68 offen lds
  s_add_u32 s68, s68, 1024
  s_add_u32 m0, s76, 14336
  s_nop 0
  buffer_load_dwordx4 v248, s[28:31], s68 offen lds
  s_add_u32 s68, s68, 1024
  s_mov_b32 s44, s12
  s_and_b32 s45, s13, 0xffff
  s_mov_b32 s46, 5537792
  s_mov_b32 s47, 0x20000
  s_add_u32 m0, s75, 0
  s_nop 0
  buffer_load_dwordx4 v13, s[44:47], s74 offen lds
  s_add_u32 s74, s74, 212992
  s_mov_b32 s60, s24
  s_and_b32 s61, s25, 0xffff
  s_mov_b32 s62, 268435456
  s_mov_b32 s63, 0x20000
  s_mov_b32 s64, s22
  s_and_b32 s65, s23, 0xffff
  s_mov_b32 s66, 256
  s_mov_b32 s67, 0x20000
  v_mov_b32 v64, -1
  v_mov_b32 v65, -1
  v_mov_b32 v66, -1
  v_mov_b32 v67, -1
  s_and_b32 s70, s2, 7
  s_lshl_b32 s68, s70, 3
  s_add_u32 s68, s68, s3
  s_lshl_b32 s68, s68, 11
  s_lshl_b32 s70, s70, 2
  buffer_store_dwordx4 v[64:67], v248, s[60:63], s68 offen sc1
  buffer_store_dwordx4 v[64:67], v248, s[60:63], s68 offen offset:1024 sc1
  s_mov_b32 s48, s14
  s_and_b32 s49, s15, 0xffff
  s_mov_b32 s50, 3328
  s_mov_b32 s51, 0x20000
  s_mov_b32 s52, s16
  s_and_b32 s53, s17, 0xffff
  s_mov_b32 s54, 3328
  s_mov_b32 s55, 0x20000
  s_mov_b32 s32, s6
  s_and_b32 s33, s7, 0xffff
  s_mov_b32 s34, 12800000
  s_mov_b32 s35, 0x20000
  v_xor_b32 v248, v9, v246
  v_lshlrev_b32 v14, 4, v248
  v_xor_b32 v15, 64, v14
  v_bfe_u32 v247, v0, 2, 2
  v_lshl_add_u32 v248, v246, 3, v247
  v_lshlrev_b32 v248, 7, v248
  v_and_b32 v247, 3, v0
  v_lshl_add_u32 v248, v247, 3, v248
  v_add_u32 v248, 131072, v248
  v_bfe_u32 v247, v0, 3, 2
  v_lshl_add_u32 v1, v247, 5, v248
  v_xor_b32 v2, 32, v1
  v_xor_b32 v7, 64, v1
  v_xor_b32 v8, 96, v1
  v_and_b32 v248, 15, v0
  v_lshlrev_b32 v248, 7, v248
  v_bfe_u32 v247, v0, 1, 3
  v_xor_b32 v247, v247, v246
  v_lshl_add_u32 v248, v247, 4, v248
  v_add_u32 v11, s76, v248
  v_xor_b32 v12, 64, v11
  v_lshrrev_b32 v247, 3, v0
  v_lshl_add_u32 v248, v9, 3, v247
  v_mul_u32_u24 v248, 104, v248
  v_add_u32 v248, s76, v248
  s_mov_b32 s56, s20
  s_and_b32 s57, s21, 0xffff
  s_mov_b32 s58, 8192
  s_mov_b32 s59, 0x20000
  s_and_b32 s77, s2, 7
  s_lshl_b32 s68, s77, 14
  s_lshl_b32 s69, s3, 8
  s_add_u32 s68, s68, s69
  s_add_u32 s69, s68, 4096
  s_add_u32 s71, s68, 8192
  s_lshl_b32 s77, s77, 3
  s_add_u32 s77, s77, s3
  s_lshl_b32 s77, s77, 7
  v_lshlrev_b32 v3, 2, v0
  v_lshlrev_b32 v4, 1, v0
  s_lshl_b32 s81, s3, 6
  v_add_u32 v5, s81, v0
  v_cmp_lt_u32 vcc, 503, v5
  v_add_u32 v5, 4096, v3
  v_mov_b32 v6, 0x7f000000
  v_cndmask_b32 v5, v6, v5, vcc
  v_mov_b32 v240, 0xc0135761
  v_mov_b32 v241, 0xc0135761
  v_mov_b32 v242, 0xbdd2d3e8
  v_mov_b32 v243, 0xbdd2d3e8
  v_mov_b32 v244, 0x71800000
  v_mov_b32 v160, 0
  v_mov_b32 v161, 0
  v_mov_b32 v162, 0
  v_mov_b32 v163, 0
  v_mov_b32 v164, 0
  v_mov_b32 v165, 0
  v_mov_b32 v166, 0
  v_mov_b32 v167, 0
  v_mov_b32 v168, 0
  v_mov_b32 v169, 0
  v_mov_b32 v170, 0
  v_mov_b32 v171, 0
  v_mov_b32 v172, 0
  v_mov_b32 v173, 0
  v_mov_b32 v174, 0
  v_mov_b32 v175, 0
  v_mov_b32 v176, 0
  v_mov_b32 v177, 0
  v_mov_b32 v178, 0
  v_mov_b32 v179, 0
  v_mov_b32 v180, 0
  v_mov_b32 v181, 0
  v_mov_b32 v182, 0
  v_mov_b32 v183, 0
  v_mov_b32 v184, 0
  v_mov_b32 v185, 0
  v_mov_b32 v186, 0
  v_mov_b32 v187, 0
  v_mov_b32 v188, 0
  v_mov_b32 v189, 0
  v_mov_b32 v190, 0
  v_mov_b32 v191, 0
  v_mov_b32 v192, 0
  v_mov_b32 v193, 0
  v_mov_b32 v194, 0
  v_mov_b32 v195, 0
  v_mov_b32 v196, 0
  v_mov_b32 v197, 0
  v_mov_b32 v198, 0
  v_mov_b32 v199, 0
  v_mov_b32 v200, 0
  v_mov_b32 v201, 0
  v_mov_b32 v202, 0
  v_mov_b32 v203, 0
  v_mov_b32 v204, 0
  v_mov_b32 v205, 0
  v_mov_b32 v206, 0
  v_mov_b32 v207, 0
  v_mov_b32 v208, 0
  v_mov_b32 v209, 0
  v_mov_b32 v210, 0
  v_mov_b32 v211, 0
  v_mov_b32 v212, 0
  v_mov_b32 v213, 0
  v_mov_b32 v214, 0
  v_mov_b32 v215, 0
  v_mov_b32 v216, 0
  v_mov_b32 v217, 0
  v_mov_b32 v218, 0
  v_mov_b32 v219, 0
  v_mov_b32 v220, 0
  v_mov_b32 v221, 0
  v_mov_b32 v222, 0
  v_mov_b32 v223, 0
  s_waitcnt vmcnt(0) lgkmcnt(0)
  s_lshl_b32 s80, s80, 16
  ds_read_b64 v[32:33], v248 offset:8192
  ds_read_b64 v[34:35], v248 offset:8200
  ds_read_b64 v[36:37], v248 offset:8208
  ds_read_b64 v[38:39], v248 offset:8216
  ds_read_b64 v[40:41], v248 offset:8224
  ds_read_b64 v[42:43], v248 offset:8232
  ds_read_b64 v[44:45], v248 offset:8240
  ds_read_b64 v[46:47], v248 offset:8248
  ds_read_b64 v[48:49], v248 offset:8256
  ds_read_b64 v[50:51], v248 offset:8264
  ds_read_b64 v[52:53], v248 offset:8272
  ds_read_b64 v[54:55], v248 offset:8280
  ds_read_b64 v[56:57], v248 offset:8288
  v_mov_b32 v24, 0
  v_mov_b32 v25, 0
  v_mov_b32 v26, 0
  v_mov_b32 v27, 0
  v_mov_b32 v28, 0
  v_mov_b32 v29, 0
  v_mov_b32 v30, 0
  v_mov_b32 v31, 0
  v_mov_b32 v58, 0x7f000000
  v_mov_b32 v59, 0x7f000000
  s_waitcnt lgkmcnt(12)
  v_lshlrev_b32 v32, 7, v32
  s_nop 1
  v_add_u32_dpp v24, v32, v14 row_newbcast:0 row_mask:0xf bank_mask:0x3
  v_add_u32_dpp v25, v32, v15 row_newbcast:1 row_mask:0xf bank_mask:0x3
  v_add_u32_dpp v26, v32, v14 row_newbcast:2 row_mask:0xf bank_mask:0x3
  v_add_u32_dpp v27, v32, v15 row_newbcast:3 row_mask:0xf bank_mask:0x3
  v_add_u32_dpp v24, v32, v14 row_newbcast:8 row_mask:0xf bank_mask:0xc
  v_add_u32_dpp v25, v32, v15 row_newbcast:9 row_mask:0xf bank_mask:0xc
  v_add_u32_dpp v26, v32, v14 row_newbcast:10 row_mask:0xf bank_mask:0xc
  v_add_u32_dpp v27, v32, v15 row_newbcast:11 row_mask:0xf bank_mask:0xc
  s_add_u32 m0, s76, 0
  s_nop 0
  buffer_load_dwordx4 v24, s[32:35], 0 offen lds
  s_add_u32 m0, s76, 1024
  s_nop 0
  buffer_load_dwordx4 v25, s[32:35], 0 offen lds
  s_add_u32 m0, s76, 2048
  s_nop 0
  buffer_load_dwordx4 v26, s[32:35], 0 offen lds
  s_add_u32 m0, s76, 3072
  s_nop 0
  buffer_load_dwordx4 v27, s[32:35], 0 offen lds
  v_add_u32_dpp v28, v32, v14 row_newbcast:4 row_mask:0xf bank_mask:0x3
  v_add_u32_dpp v29, v32, v15 row_newbcast:5 row_mask:0xf bank_mask:0x3
  v_add_u32_dpp v30, v32, v14 row_newbcast:6 row_mask:0xf bank_mask:0x3
  v_add_u32_dpp v31, v32, v15 row_newbcast:7 row_mask:0xf bank_mask:0x3
  v_add_u32_dpp v28, v32, v14 row_newbcast:12 row_mask:0xf bank_mask:0xc
  v_add_u32_dpp v29, v32, v15 row_newbcast:13 row_mask:0xf bank_mask:0xc
  v_add_u32_dpp v30, v32, v14 row_newbcast:14 row_mask:0xf bank_mask:0xc
  v_add_u32_dpp v31, v32, v15 row_newbcast:15 row_mask:0xf bank_mask:0xc
  s_add_u32 m0, s76, 4096
  s_nop 0
  buffer_load_dwordx4 v28, s[32:35], 0 offen lds
  s_add_u32 m0, s76, 5120
  s_nop 0
  buffer_load_dwordx4 v29, s[32:35], 0 offen lds
  s_add_u32 m0, s76, 6144
  s_nop 0
  buffer_load_dwordx4 v30, s[32:35], 0 offen lds
  s_add_u32 m0, s76, 7168
  s_nop 0
  buffer_load_dwordx4 v31, s[32:35], 0 offen lds
  s_add_u32 m0, s75, 8192
  s_nop 0
  buffer_load_dwordx4 v13, s[44:47], s74 offen lds
  s_add_u32 s74, s74, 212992
  s_waitcnt lgkmcnt(0)
  v_lshlrev_b32 v57, 7, v57
  v_lshlrev_b32 v56, 7, v56
  v_lshlrev_b32 v55, 7, v55
  v_lshlrev_b32 v54, 7, v54
  v_lshlrev_b32 v53, 7, v53
  v_lshlrev_b32 v52, 7, v52
  v_lshlrev_b32 v51, 7, v51
  v_lshlrev_b32 v50, 7, v50
  v_lshlrev_b32 v49, 7, v49
  v_lshlrev_b32 v48, 7, v48
  v_lshlrev_b32 v47, 7, v47
  v_lshlrev_b32 v46, 7, v46
  v_lshlrev_b32 v45, 7, v45
  v_lshlrev_b32 v44, 7, v44
  v_lshlrev_b32 v43, 7, v43
  v_lshlrev_b32 v42, 7, v42
  v_lshlrev_b32 v41, 7, v41
  v_lshlrev_b32 v40, 7, v40
  v_lshlrev_b32 v39, 7, v39
  v_lshlrev_b32 v38, 7, v38
  v_lshlrev_b32 v37, 7, v37
  v_lshlrev_b32 v36, 7, v36
  v_lshlrev_b32 v35, 7, v35
  v_lshlrev_b32 v34, 7, v34
  v_lshlrev_b32 v33, 7, v33
  s_nop 1
  v_add_u32_dpp v24, v33, v14 row_newbcast:0 row_mask:0xf bank_mask:0x3
  v_add_u32_dpp v25, v33, v15 row_newbcast:1 row_mask:0xf bank_mask:0x3
  v_add_u32_dpp v26, v33, v14 row_newbcast:2 row_mask:0xf bank_mask:0x3
  v_add_u32_dpp v27, v33, v15 row_newbcast:3 row_mask:0xf bank_mask:0x3
  v_add_u32_dpp v24, v33, v14 row_newbcast:8 row_mask:0xf bank_mask:0xc
  v_add_u32_dpp v25, v33, v15 row_newbcast:9 row_mask:0xf bank_mask:0xc
  v_add_u32_dpp v26, v33, v14 row_newbcast:10 row_mask:0xf bank_mask:0xc
  v_add_u32_dpp v27, v33, v15 row_newbcast:11 row_mask:0xf bank_mask:0xc
  s_add_u32 m0, s76, 8192
  s_nop 0
  buffer_load_dwordx4 v24, s[32:35], 0 offen lds
  s_add_u32 m0, s76, 9216
  s_nop 0
  buffer_load_dwordx4 v25, s[32:35], 0 offen lds
  s_add_u32 m0, s76, 10240
  s_nop 0
  buffer_load_dwordx4 v26, s[32:35], 0 offen lds
  s_add_u32 m0, s76, 11264
  s_nop 0
  buffer_load_dwordx4 v27, s[32:35], 0 offen lds
  v_add_u32_dpp v28, v33, v14 row_newbcast:4 row_mask:0xf bank_mask:0x3
  v_add_u32_dpp v29, v33, v15 row_newbcast:5 row_mask:0xf bank_mask:0x3
  v_add_u32_dpp v30, v33, v14 row_newbcast:6 row_mask:0xf bank_mask:0x3
  v_add_u32_dpp v31, v33, v15 row_newbcast:7 row_mask:0xf bank_mask:0x3
  v_add_u32_dpp v28, v33, v14 row_newbcast:12 row_mask:0xf bank_mask:0xc
  v_add_u32_dpp v29, v33, v15 row_newbcast:13 row_mask:0xf bank_mask:0xc
  v_add_u32_dpp v30, v33, v14 row_newbcast:14 row_mask:0xf bank_mask:0xc
  v_add_u32_dpp v31, v33, v15 row_newbcast:15 row_mask:0xf bank_mask:0xc
  s_add_u32 m0, s76, 12288
  s_nop 0
  buffer_load_dwordx4 v28, s[32:35], 0 offen lds
  s_add_u32 m0, s76, 13312
  s_nop 0
  buffer_load_dwordx4 v29, s[32:35], 0 offen lds
  s_add_u32 m0, s76, 14336
  s_nop 0
  buffer_load_dwordx4 v30, s[32:35], 0 offen lds
  s_add_u32 m0, s76, 15360
  s_nop 0
  buffer_load_dwordx4 v31, s[32:35], 0 offen lds
  s_add_u32 m0, s75, 16384
  s_nop 0
  buffer_load_dwordx4 v13, s[44:47], s74 offen lds
  s_add_u32 s74, s74, 212992
  v_lshlrev_b32 v248, 3, v246
  s_mov_b32 s73, 3
  v_mov_b32 v9, v34
  s_nop 1
  v_add_u32_dpp v24, v9, v14 row_newbcast:0 row_mask:0xf bank_mask:0x3
  v_add_u32_dpp v25, v9, v15 row_newbcast:1 row_mask:0xf bank_mask:0x3
  v_add_u32_dpp v26, v9, v14 row_newbcast:2 row_mask:0xf bank_mask:0x3
  v_add_u32_dpp v27, v9, v15 row_newbcast:3 row_mask:0xf bank_mask:0x3
  v_add_u32_dpp v24, v9, v14 row_newbcast:8 row_mask:0xf bank_mask:0xc
  v_add_u32_dpp v25, v9, v15 row_newbcast:9 row_mask:0xf bank_mask:0xc
  v_add_u32_dpp v26, v9, v14 row_newbcast:10 row_mask:0xf bank_mask:0xc
  v_add_u32_dpp v27, v9, v15 row_newbcast:11 row_mask:0xf bank_mask:0xc
  s_waitcnt vmcnt(14)
  s_barrier
  ds_read_b128 v[76:79], v12 offset:2048
  ds_read_b128 v[72:75], v11 offset:2048
  ds_read_b128 v[68:71], v12 offset:0
  ds_read_b128 v[64:67], v11 offset:0
  ds_read_b64_tr_b16 v[96:97], v1 offset:0
  ds_read_b64_tr_b16 v[98:99], v1 offset:512
  ds_read_b64_tr_b16 v[100:101], v1 offset:4096
  ds_read_b64_tr_b16 v[102:103], v1 offset:4608
  ds_read_b64_tr_b16 v[104:105], v2 offset:0
  ds_read_b64_tr_b16 v[106:107], v2 offset:512
  ds_read_b64_tr_b16 v[108:109], v2 offset:4096
  ds_read_b64_tr_b16 v[110:111], v2 offset:4608
  ds_read_b64_tr_b16 v[112:113], v7 offset:0
  ds_read_b64_tr_b16 v[114:115], v7 offset:512
  ds_read_b64_tr_b16 v[116:117], v7 offset:4096
  ds_read_b64_tr_b16 v[118:119], v7 offset:4608
  ds_read_b64_tr_b16 v[120:121], v8 offset:0
  ds_read_b64_tr_b16 v[122:123], v8 offset:512
  ds_read_b64_tr_b16 v[124:125], v8 offset:4096
  ds_read_b64_tr_b16 v[126:127], v8 offset:4608
  s_cmp_lg_u32 s3, 7
  s_cbranch_scc1 L_rem_loop
  s_mov_b64 exec, 1
  buffer_store_dword v240, v14, s[64:67], s70 offen offset:128 sc1
  s_mov_b64 exec, -1
L_rem_loop:
  s_waitcnt vmcnt(9)
  s_barrier
  s_waitcnt lgkmcnt(8)
  v_mfma_f32_16x16x32_bf16 v[160:163], v[96:99], v[64:67], v[160:163]
  ds_read_b128 v[92:95], v12 offset:6144
  ds_read_b128 v[88:91], v11 offset:6144
  s_waitcnt lgkmcnt(14)
  v_mfma_f32_16x16x32_bf16 v[160:163], v[100:103], v[68:71], v[160:163]
  ds_read_b128 v[84:87], v12 offset:4096
  s_add_u32 m0, s76, 0
  s_nop 0
  buffer_load_dwordx4 v24, s[32:35], 0 offen lds
  v_mfma_f32_16x16x32_bf16 v[164:167], v[96:99], v[72:75], v[164:167]
  ds_read_b128 v[80:83], v11 offset:4096
  v_mfma_f32_16x16x32_bf16 v[164:167], v[100:103], v[76:79], v[164:167]
  ds_read_b64_tr_b16 v[128:129], v1 offset:8192
  s_waitcnt lgkmcnt(14)
  v_mfma_f32_16x16x32_bf16 v[176:179], v[104:107], v[64:67], v[176:179]
  ds_read_b64_tr_b16 v[130:131], v1 offset:8704
  s_add_u32 m0, s76, 1024
  s_nop 0
  buffer_load_dwordx4 v25, s[32:35], 0 offen lds
  s_waitcnt lgkmcnt(14)
  v_mfma_f32_16x16x32_bf16 v[176:179], v[108:111], v[68:71], v[176:179]
  ds_read_b64_tr_b16 v[132:133], v1 offset:12288
  v_mfma_f32_16x16x32_bf16 v[180:183], v[104:107], v[72:75], v[180:183]
  ds_read_b64_tr_b16 v[134:135], v1 offset:12800
  v_mfma_f32_16x16x32_bf16 v[180:183], v[108:111], v[76:79], v[180:183]
  ds_read_b64_tr_b16 v[136:137], v2 offset:8192
  s_waitcnt lgkmcnt(14)
  v_mfma_f32_16x16x32_bf16 v[192:195], v[112:115], v[64:67], v[192:195]
  ds_read_b64_tr_b16 v[138:139], v2 offset:8704
  s_add_u32 m0, s76, 2048
  s_nop 0
  buffer_load_dwordx4 v26, s[32:35], 0 offen lds
  s_waitcnt lgkmcnt(14)
  v_mfma_f32_16x16x32_bf16 v[192:195], v[116:119], v[68:71], v[192:195]
  ds_read_b64_tr_b16 v[140:141], v2 offset:12288
  v_mfma_f32_16x16x32_bf16 v[196:199], v[112:115], v[72:75], v[196:199]
  ds_read_b64_tr_b16 v[142:143], v2 offset:12800
  v_mfma_f32_16x16x32_bf16 v[196:199], v[116:119], v[76:79], v[196:199]
  v_add_u32_dpp v28, v9, v14 row_newbcast:4 row_mask:0xf bank_mask:0x3
  v_add_u32_dpp v29, v9, v15 row_newbcast:5 row_mask:0xf bank_mask:0x3
  s_waitcnt lgkmcnt(14)
  v_mfma_f32_16x16x32_bf16 v[208:211], v[120:123], v[64:67], v[208:211]
  s_add_u32 m0, s76, 3072
  s_nop 0
  buffer_load_dwordx4 v27, s[32:35], 0 offen lds
  v_add_u32_dpp v30, v9, v14 row_newbcast:6 row_mask:0xf bank_mask:0x3
  v_add_u32_dpp v31, v9, v15 row_newbcast:7 row_mask:0xf bank_mask:0x3
  s_waitcnt lgkmcnt(12)
  v_mfma_f32_16x16x32_bf16 v[208:211], v[124:127], v[68:71], v[208:211]
  v_add_u32_dpp v28, v9, v14 row_newbcast:12 row_mask:0xf bank_mask:0xc
  v_mfma_f32_16x16x32_bf16 v[212:215], v[120:123], v[72:75], v[212:215]
  v_add_u32_dpp v29, v9, v15 row_newbcast:13 row_mask:0xf bank_mask:0xc
  v_add_u32_dpp v30, v9, v14 row_newbcast:14 row_mask:0xf bank_mask:0xc
  v_mfma_f32_16x16x32_bf16 v[212:215], v[124:127], v[76:79], v[212:215]
  v_add_u32_dpp v31, v9, v15 row_newbcast:15 row_mask:0xf bank_mask:0xc
  s_waitcnt vmcnt(9)
  s_waitcnt lgkmcnt(8)
  v_mfma_f32_16x16x32_bf16 v[168:171], v[96:99], v[80:83], v[168:171]
  ds_read_b128 v[76:79], v12 offset:10240
  ds_read_b128 v[72:75], v11 offset:10240
  v_mfma_f32_16x16x32_bf16 v[168:171], v[100:103], v[84:87], v[168:171]
  ds_read_b128 v[68:71], v12 offset:8192
  s_add_u32 m0, s76, 4096
  s_nop 0
  buffer_load_dwordx4 v28, s[32:35], 0 offen lds
  v_mfma_f32_16x16x32_bf16 v[172:175], v[96:99], v[88:91], v[172:175]
  ds_read_b128 v[64:67], v11 offset:8192
  v_mfma_f32_16x16x32_bf16 v[172:175], v[100:103], v[92:95], v[172:175]
  ds_read_b64_tr_b16 v[144:145], v7 offset:8192
  v_mfma_f32_16x16x32_bf16 v[184:187], v[104:107], v[80:83], v[184:187]
  ds_read_b64_tr_b16 v[146:147], v7 offset:8704
  s_add_u32 m0, s76, 5120
  s_nop 0
  buffer_load_dwordx4 v29, s[32:35], 0 offen lds
  v_mfma_f32_16x16x32_bf16 v[184:187], v[108:111], v[84:87], v[184:187]
  ds_read_b64_tr_b16 v[148:149], v7 offset:12288
  v_mfma_f32_16x16x32_bf16 v[188:191], v[104:107], v[88:91], v[188:191]
  ds_read_b64_tr_b16 v[150:151], v7 offset:12800
  v_mfma_f32_16x16x32_bf16 v[188:191], v[108:111], v[92:95], v[188:191]
  ds_read_b64_tr_b16 v[152:153], v8 offset:8192
  s_add_u32 m0, s76, 6144
  s_nop 0
  buffer_load_dwordx4 v30, s[32:35], 0 offen lds
  v_mfma_f32_16x16x32_bf16 v[200:203], v[112:115], v[80:83], v[200:203]
  ds_read_b64_tr_b16 v[154:155], v8 offset:8704
  v_mfma_f32_16x16x32_bf16 v[200:203], v[116:119], v[84:87], v[200:203]
  ds_read_b64_tr_b16 v[156:157], v8 offset:12288
  v_mfma_f32_16x16x32_bf16 v[204:207], v[112:115], v[88:91], v[204:207]
  ds_read_b64_tr_b16 v[158:159], v8 offset:12800
  s_add_u32 m0, s76, 7168
  s_nop 0
  buffer_load_dwordx4 v31, s[32:35], 0 offen lds
  v_mfma_f32_16x16x32_bf16 v[204:207], v[116:119], v[92:95], v[204:207]
  s_set_gpr_idx_on s73, gpr_idx(SRC0)
  s_nop 0
  v_mov_b32 v9, v32
  s_set_gpr_idx_off
  s_add_u32 s73, s73, 1
  v_add_u32_dpp v24, v9, v14 row_newbcast:0 row_mask:0xf bank_mask:0x3
  v_mfma_f32_16x16x32_bf16 v[216:219], v[120:123], v[80:83], v[216:219]
  v_add_u32_dpp v25, v9, v15 row_newbcast:1 row_mask:0xf bank_mask:0x3
  v_add_u32_dpp v26, v9, v14 row_newbcast:2 row_mask:0xf bank_mask:0x3
  v_mfma_f32_16x16x32_bf16 v[216:219], v[124:127], v[84:87], v[216:219]
  s_xor_b32 s75, s75, 16384
  s_add_u32 m0, s75, 8192
  s_nop 0
  buffer_load_dwordx4 v13, s[44:47], s74 offen lds
  s_add_u32 s74, s74, 212992
  s_xor_b32 s75, s75, 16384
  v_add_u32_dpp v27, v9, v15 row_newbcast:3 row_mask:0xf bank_mask:0x3
  v_add_u32_dpp v24, v9, v14 row_newbcast:8 row_mask:0xf bank_mask:0xc
  v_mfma_f32_16x16x32_bf16 v[220:223], v[120:123], v[88:91], v[220:223]
  v_add_u32_dpp v25, v9, v15 row_newbcast:9 row_mask:0xf bank_mask:0xc
  v_add_u32_dpp v26, v9, v14 row_newbcast:10 row_mask:0xf bank_mask:0xc
  v_mfma_f32_16x16x32_bf16 v[220:223], v[124:127], v[92:95], v[220:223]
  v_add_u32_dpp v27, v9, v15 row_newbcast:11 row_mask:0xf bank_mask:0xc
L_rnv:
  s_waitcnt vmcnt(9)
  s_barrier
  v_xor_b32 v1, 16384, v1
  v_xor_b32 v2, 16384, v2
  v_xor_b32 v7, 16384, v7
  v_xor_b32 v8, 16384, v8
  s_waitcnt lgkmcnt(8)
  v_mfma_f32_16x16x32_bf16 v[160:163], v[128:131], v[64:67], v[160:163]
  ds_read_b128 v[92:95], v12 offset:14336
  ds_read_b128 v[88:91], v11 offset:14336
  v_mfma_f32_16x16x32_bf16 v[160:163], v[132:135], v[68:71], v[160:163]
  ds_read_b128 v[84:87], v12 offset:12288
  s_add_u32 m0, s76, 8192
  s_nop 0
  buffer_load_dwordx4 v24, s[32:35], 0 offen lds
  v_mfma_f32_16x16x32_bf16 v[164:167], v[128:131], v[72:75], v[164:167]
  ds_read_b128 v[80:83], v11 offset:12288
  v_mfma_f32_16x16x32_bf16 v[164:167], v[132:135], v[76:79], v[164:167]
  ds_read_b64_tr_b16 v[96:97], v1 offset:0
  v_mfma_f32_16x16x32_bf16 v[176:179], v[136:139], v[64:67], v[176:179]
  ds_read_b64_tr_b16 v[98:99], v1 offset:512
  s_add_u32 m0, s76, 9216
  s_nop 0
  buffer_load_dwordx4 v25, s[32:35], 0 offen lds
  v_mfma_f32_16x16x32_bf16 v[176:179], v[140:143], v[68:71], v[176:179]
  ds_read_b64_tr_b16 v[100:101], v1 offset:4096
  v_mfma_f32_16x16x32_bf16 v[180:183], v[136:139], v[72:75], v[180:183]
  ds_read_b64_tr_b16 v[102:103], v1 offset:4608
  v_mfma_f32_16x16x32_bf16 v[180:183], v[140:143], v[76:79], v[180:183]
  ds_read_b64_tr_b16 v[104:105], v2 offset:0
  s_waitcnt lgkmcnt(14)
  v_mfma_f32_16x16x32_bf16 v[192:195], v[144:147], v[64:67], v[192:195]
  ds_read_b64_tr_b16 v[106:107], v2 offset:512
  s_add_u32 m0, s76, 10240
  s_nop 0
  buffer_load_dwordx4 v26, s[32:35], 0 offen lds
  s_waitcnt lgkmcnt(14)
  v_mfma_f32_16x16x32_bf16 v[192:195], v[148:151], v[68:71], v[192:195]
  ds_read_b64_tr_b16 v[108:109], v2 offset:4096
  v_mfma_f32_16x16x32_bf16 v[196:199], v[144:147], v[72:75], v[196:199]
  ds_read_b64_tr_b16 v[110:111], v2 offset:4608
  v_mfma_f32_16x16x32_bf16 v[196:199], v[148:151], v[76:79], v[196:199]
  v_add_u32_dpp v28, v9, v14 row_newbcast:4 row_mask:0xf bank_mask:0x3
  v_add_u32_dpp v29, v9, v15 row_newbcast:5 row_mask:0xf bank_mask:0x3
  s_waitcnt lgkmcnt(14)
  v_mfma_f32_16x16x32_bf16 v[208:211], v[152:155], v[64:67], v[208:211]
  s_add_u32 m0, s76, 11264
  s_nop 0
  buffer_load_dwordx4 v27, s[32:35], 0 offen lds
  v_add_u32_dpp v30, v9, v14 row_newbcast:6 row_mask:0xf bank_mask:0x3
  v_add_u32_dpp v31, v9, v15 row_newbcast:7 row_mask:0xf bank_mask:0x3
  s_waitcnt lgkmcnt(12)
  v_mfma_f32_16x16x32_bf16 v[208:211], v[156:159], v[68:71], v[208:211]
  v_add_u32_dpp v28, v9, v14 row_newbcast:12 row_mask:0xf bank_mask:0xc
  v_mfma_f32_16x16x32_bf16 v[212:215], v[152:155], v[72:75], v[212:215]
  v_add_u32_dpp v29, v9, v15 row_newbcast:13 row_mask:0xf bank_mask:0xc
  v_add_u32_dpp v30, v9, v14 row_newbcast:14 row_mask:0xf bank_mask:0xc
  v_mfma_f32_16x16x32_bf16 v[212:215], v[156:159], v[76:79], v[212:215]
  v_add_u32_dpp v31, v9, v15 row_newbcast:15 row_mask:0xf bank_mask:0xc
  s_waitcnt vmcnt(9)
  s_waitcnt lgkmcnt(8)
  v_mfma_f32_16x16x32_bf16 v[168:171], v[128:131], v[80:83], v[168:171]
  ds_read_b128 v[76:79], v12 offset:2048
  ds_read_b128 v[72:75], v11 offset:2048
  v_mfma_f32_16x16x32_bf16 v[168:171], v[132:135], v[84:87], v[168:171]
  ds_read_b128 v[68:71], v12 offset:0
  s_add_u32 m0, s76, 12288
  s_nop 0
  buffer_load_dwordx4 v28, s[32:35], 0 offen lds
  v_mfma_f32_16x16x32_bf16 v[172:175], v[128:131], v[88:91], v[172:175]
  ds_read_b128 v[64:67], v11 offset:0
  v_mfma_f32_16x16x32_bf16 v[172:175], v[132:135], v[92:95], v[172:175]
  ds_read_b64_tr_b16 v[112:113], v7 offset:0
  v_mfma_f32_16x16x32_bf16 v[184:187], v[136:139], v[80:83], v[184:187]
  ds_read_b64_tr_b16 v[114:115], v7 offset:512
  s_add_u32 m0, s76, 13312
  s_nop 0
  buffer_load_dwordx4 v29, s[32:35], 0 offen lds
  v_mfma_f32_16x16x32_bf16 v[184:187], v[140:143], v[84:87], v[184:187]
  ds_read_b64_tr_b16 v[116:117], v7 offset:4096
  v_mfma_f32_16x16x32_bf16 v[188:191], v[136:139], v[88:91], v[188:191]
  ds_read_b64_tr_b16 v[118:119], v7 offset:4608
  v_mfma_f32_16x16x32_bf16 v[188:191], v[140:143], v[92:95], v[188:191]
  ds_read_b64_tr_b16 v[120:121], v8 offset:0
  s_add_u32 m0, s76, 14336
  s_nop 0
  buffer_load_dwordx4 v30, s[32:35], 0 offen lds
  v_mfma_f32_16x16x32_bf16 v[200:203], v[144:147], v[80:83], v[200:203]
  ds_read_b64_tr_b16 v[122:123], v8 offset:512
  v_mfma_f32_16x16x32_bf16 v[200:203], v[148:151], v[84:87], v[200:203]
  ds_read_b64_tr_b16 v[124:125], v8 offset:4096
  v_mfma_f32_16x16x32_bf16 v[204:207], v[144:147], v[88:91], v[204:207]
  ds_read_b64_tr_b16 v[126:127], v8 offset:4608
  s_add_u32 m0, s76, 15360
  s_nop 0
  buffer_load_dwordx4 v31, s[32:35], 0 offen lds
  v_mfma_f32_16x16x32_bf16 v[204:207], v[148:151], v[92:95], v[204:207]
  s_set_gpr_idx_on s73, gpr_idx(SRC0)
  s_nop 0
  v_mov_b32 v9, v32
  s_set_gpr_idx_off
  s_add_u32 s73, s73, 1
  v_add_u32_dpp v24, v9, v14 row_newbcast:0 row_mask:0xf bank_mask:0x3
  v_mfma_f32_16x16x32_bf16 v[216:219], v[152:155], v[80:83], v[216:219]
  v_add_u32_dpp v25, v9, v15 row_newbcast:1 row_mask:0xf bank_mask:0x3
  v_add_u32_dpp v26, v9, v14 row_newbcast:2 row_mask:0xf bank_mask:0x3
  v_mfma_f32_16x16x32_bf16 v[216:219], v[156:159], v[84:87], v[216:219]
  s_add_u32 m0, s75, 0
  s_nop 0
  buffer_load_dwordx4 v13, s[44:47], s74 offen lds
  s_add_u32 s74, s74, 212992
  s_xor_b32 s75, s75, 16384
  v_add_u32_dpp v27, v9, v15 row_newbcast:3 row_mask:0xf bank_mask:0x3
  v_add_u32_dpp v24, v9, v14 row_newbcast:8 row_mask:0xf bank_mask:0xc
  v_mfma_f32_16x16x32_bf16 v[220:223], v[152:155], v[88:91], v[220:223]
  v_add_u32_dpp v25, v9, v15 row_newbcast:9 row_mask:0xf bank_mask:0xc
  v_add_u32_dpp v26, v9, v14 row_newbcast:10 row_mask:0xf bank_mask:0xc
  v_mfma_f32_16x16x32_bf16 v[220:223], v[156:159], v[92:95], v[220:223]
  v_add_u32_dpp v27, v9, v15 row_newbcast:11 row_mask:0xf bank_mask:0xc
  s_cmp_lt_u32 s73, 27
  s_cbranch_scc1 L_rem_loop
  s_waitcnt vmcnt(9)
  s_barrier
  s_waitcnt lgkmcnt(8)
  v_mfma_f32_16x16x32_bf16 v[160:163], v[96:99], v[64:67], v[160:163]
  ds_read_b128 v[92:95], v12 offset:6144
  ds_read_b128 v[88:91], v11 offset:6144
  v_mfma_f32_16x16x32_bf16 v[160:163], v[100:103], v[68:71], v[160:163]
  ds_read_b128 v[84:87], v12 offset:4096
  buffer_load_dwordx2 v[224:225], v248, s[48:51], 0 offen offset:3200
  v_mfma_f32_16x16x32_bf16 v[164:167], v[96:99], v[72:75], v[164:167]
  ds_read_b128 v[80:83], v11 offset:4096
  buffer_load_dwordx2 v[226:227], v248, s[48:51], 0 offen offset:3232
  v_mfma_f32_16x16x32_bf16 v[164:167], v[100:103], v[76:79], v[164:167]
  ds_read_b64_tr_b16 v[128:129], v1 offset:8192
  v_mfma_f32_16x16x32_bf16 v[176:179], v[104:107], v[64:67], v[176:179]
  ds_read_b64_tr_b16 v[130:131], v1 offset:8704
  buffer_load_dwordx2 v[228:229], v248, s[48:51], 0 offen offset:3264
  v_mfma_f32_16x16x32_bf16 v[176:179], v[108:111], v[68:71], v[176:179]
  ds_read_b64_tr_b16 v[132:133], v1 offset:12288
  v_mfma_f32_16x16x32_bf16 v[180:183], v[104:107], v[72:75], v[180:183]
  ds_read_b64_tr_b16 v[134:135], v1 offset:12800
  buffer_load_dwordx2 v[230:231], v248, s[48:51], 0 offen offset:3296
  v_mfma_f32_16x16x32_bf16 v[180:183], v[108:111], v[76:79], v[180:183]
  ds_read_b64_tr_b16 v[136:137], v2 offset:8192
  buffer_load_dwordx2 v[232:233], v248, s[52:55], 0 offen offset:3200
  s_waitcnt lgkmcnt(14)
  v_mfma_f32_16x16x32_bf16 v[192:195], v[112:115], v[64:67], v[192:195]
  ds_read_b64_tr_b16 v[138:139], v2 offset:8704
  s_waitcnt lgkmcnt(14)
  v_mfma_f32_16x16x32_bf16 v[192:195], v[116:119], v[68:71], v[192:195]
  ds_read_b64_tr_b16 v[140:141], v2 offset:12288
  buffer_load_dwordx2 v[234:235], v248, s[52:55], 0 offen offset:3232
  v_mfma_f32_16x16x32_bf16 v[196:199], v[112:115], v[72:75], v[196:199]
  ds_read_b64_tr_b16 v[142:143], v2 offset:12800
  v_mfma_f32_16x16x32_bf16 v[196:199], v[116:119], v[76:79], v[196:199]
  buffer_load_dwordx2 v[236:237], v248, s[52:55], 0 offen offset:3264
  s_waitcnt lgkmcnt(14)
  v_mfma_f32_16x16x32_bf16 v[208:211], v[120:123], v[64:67], v[208:211]
  buffer_load_dwordx2 v[238:239], v248, s[52:55], 0 offen offset:3296
  s_waitcnt lgkmcnt(12)
  v_mfma_f32_16x16x32_bf16 v[208:211], v[124:127], v[68:71], v[208:211]
  v_mfma_f32_16x16x32_bf16 v[212:215], v[120:123], v[72:75], v[212:215]
  buffer_load_dword v255, v3, s[56:59], s77 offen
  v_mfma_f32_16x16x32_bf16 v[212:215], v[124:127], v[76:79], v[212:215]
  s_waitcnt vmcnt(14)
  s_waitcnt lgkmcnt(8)
  v_mfma_f32_16x16x32_bf16 v[168:171], v[96:99], v[80:83], v[168:171]
  ds_read_b128 v[76:79], v12 offset:10240
  ds_read_b128 v[72:75], v11 offset:10240
  v_mfma_f32_16x16x32_bf16 v[168:171], v[100:103], v[84:87], v[168:171]
  ds_read_b128 v[68:71], v12 offset:8192
  v_mfma_f32_16x16x32_bf16 v[172:175], v[96:99], v[88:91], v[172:175]
  ds_read_b128 v[64:67], v11 offset:8192
  v_mfma_f32_16x16x32_bf16 v[172:175], v[100:103], v[92:95], v[172:175]
  ds_read_b64_tr_b16 v[144:145], v7 offset:8192
  v_mfma_f32_16x16x32_bf16 v[184:187], v[104:107], v[80:83], v[184:187]
  ds_read_b64_tr_b16 v[146:147], v7 offset:8704
  v_mfma_f32_16x16x32_bf16 v[184:187], v[108:111], v[84:87], v[184:187]
  ds_read_b64_tr_b16 v[148:149], v7 offset:12288
  v_mfma_f32_16x16x32_bf16 v[188:191], v[104:107], v[88:91], v[188:191]
  ds_read_b64_tr_b16 v[150:151], v7 offset:12800
  v_mfma_f32_16x16x32_bf16 v[188:191], v[108:111], v[92:95], v[188:191]
  ds_read_b64_tr_b16 v[152:153], v8 offset:8192
  v_mfma_f32_16x16x32_bf16 v[200:203], v[112:115], v[80:83], v[200:203]
  ds_read_b64_tr_b16 v[154:155], v8 offset:8704
  v_mfma_f32_16x16x32_bf16 v[200:203], v[116:119], v[84:87], v[200:203]
  ds_read_b64_tr_b16 v[156:157], v8 offset:12288
  v_mfma_f32_16x16x32_bf16 v[204:207], v[112:115], v[88:91], v[204:207]
  ds_read_b64_tr_b16 v[158:159], v8 offset:12800
  v_mfma_f32_16x16x32_bf16 v[204:207], v[116:119], v[92:95], v[204:207]
  v_mfma_f32_16x16x32_bf16 v[216:219], v[120:123], v[80:83], v[216:219]
  v_mfma_f32_16x16x32_bf16 v[216:219], v[124:127], v[84:87], v[216:219]
  v_mfma_f32_16x16x32_bf16 v[220:223], v[120:123], v[88:91], v[220:223]
  v_mfma_f32_16x16x32_bf16 v[220:223], v[124:127], v[92:95], v[220:223]
  s_waitcnt vmcnt(10)
  s_waitcnt lgkmcnt(8)
  v_mfma_f32_16x16x32_bf16 v[160:163], v[128:131], v[64:67], v[160:163]
  ds_read_b128 v[92:95], v12 offset:14336
  v_mfma_f32_16x16x32_bf16 v[160:163], v[132:135], v[68:71], v[160:163]
  v_mfma_f32_16x16x32_bf16 v[164:167], v[128:131], v[72:75], v[164:167]
  ds_read_b128 v[88:91], v11 offset:14336
  v_mfma_f32_16x16x32_bf16 v[164:167], v[132:135], v[76:79], v[164:167]
  s_waitcnt vmcnt(4)
  v_lshlrev_b32 v48, 16, v232
  v_and_b32 v49, 0xffff0000, v232
  v_mfma_f32_16x16x32_bf16 v[176:179], v[136:139], v[64:67], v[176:179]
  v_lshlrev_b32 v50, 16, v233
  v_and_b32 v51, 0xffff0000, v233
  v_mfma_f32_16x16x32_bf16 v[176:179], v[140:143], v[68:71], v[176:179]
  ds_read_b128 v[84:87], v12 offset:12288
  s_waitcnt vmcnt(3)
  v_lshlrev_b32 v52, 16, v234
  v_and_b32 v53, 0xffff0000, v234
  v_mfma_f32_16x16x32_bf16 v[180:183], v[136:139], v[72:75], v[180:183]
  v_lshlrev_b32 v54, 16, v235
  v_and_b32 v55, 0xffff0000, v235
  v_mfma_f32_16x16x32_bf16 v[180:183], v[140:143], v[76:79], v[180:183]
  s_waitcnt vmcnt(2)
  v_lshlrev_b32 v56, 16, v236
  v_and_b32 v57, 0xffff0000, v236
  s_waitcnt lgkmcnt(9)
  v_mfma_f32_16x16x32_bf16 v[192:195], v[144:147], v[64:67], v[192:195]
  ds_read_b128 v[80:83], v11 offset:12288
  v_lshlrev_b32 v58, 16, v237
  s_waitcnt lgkmcnt(8)
  v_mfma_f32_16x16x32_bf16 v[192:195], v[148:151], v[68:71], v[192:195]
  v_and_b32 v59, 0xffff0000, v237
  s_waitcnt vmcnt(1)
  v_lshlrev_b32 v60, 16, v238
  v_mfma_f32_16x16x32_bf16 v[196:199], v[144:147], v[72:75], v[196:199]
  v_and_b32 v61, 0xffff0000, v238
  v_lshlrev_b32 v62, 16, v239
  v_mfma_f32_16x16x32_bf16 v[196:199], v[148:151], v[76:79], v[196:199]
  v_and_b32 v63, 0xffff0000, v239
  v_lshlrev_b32 v32, 16, v224
  s_waitcnt lgkmcnt(6)
  v_mfma_f32_16x16x32_bf16 v[208:211], v[152:155], v[64:67], v[208:211]
  v_and_b32 v33, 0xffff0000, v224
  v_lshlrev_b32 v34, 16, v225
  s_waitcnt lgkmcnt(4)
  v_mfma_f32_16x16x32_bf16 v[208:211], v[156:159], v[68:71], v[208:211]
  v_and_b32 v35, 0xffff0000, v225
  v_lshlrev_b32 v36, 16, v226
  v_mfma_f32_16x16x32_bf16 v[212:215], v[152:155], v[72:75], v[212:215]
  v_and_b32 v37, 0xffff0000, v226
  v_mfma_f32_16x16x32_bf16 v[212:215], v[156:159], v[76:79], v[212:215]
  s_waitcnt lgkmcnt(0)
  v_mfma_f32_16x16x32_bf16 v[168:171], v[128:131], v[80:83], v[168:171]
  v_lshlrev_b32 v38, 16, v227
  v_and_b32 v39, 0xffff0000, v227
  v_mfma_f32_16x16x32_bf16 v[168:171], v[132:135], v[84:87], v[168:171]
  v_lshlrev_b32 v40, 16, v228
  v_mfma_f32_16x16x32_bf16 v[172:175], v[128:131], v[88:91], v[172:175]
  v_and_b32 v41, 0xffff0000, v228
  v_mfma_f32_16x16x32_bf16 v[172:175], v[132:135], v[92:95], v[172:175]
  v_lshlrev_b32 v42, 16, v229
  v_mfma_f32_16x16x32_bf16 v[184:187], v[136:139], v[80:83], v[184:187]
  v_and_b32 v43, 0xffff0000, v229
  v_lshlrev_b32 v44, 16, v230
  v_mfma_f32_16x16x32_bf16 v[184:187], v[140:143], v[84:87], v[184:187]
  v_and_b32 v45, 0xffff0000, v230
  v_mfma_f32_16x16x32_bf16 v[188:191], v[136:139], v[88:91], v[188:191]
  v_lshlrev_b32 v46, 16, v231
  v_mfma_f32_16x16x32_bf16 v[188:191], v[140:143], v[92:95], v[188:191]
  v_and_b32 v47, 0xffff0000, v231
  v_mfma_f32_16x16x32_bf16 v[200:203], v[144:147], v[80:83], v[200:203]
  v_rcp_f32 v48, v48
  v_rcp_f32 v49, v49
  v_mfma_f32_16x16x32_bf16 v[200:203], v[148:151], v[84:87], v[200:203]
  v_rcp_f32 v50, v50
  v_mfma_f32_16x16x32_bf16 v[204:207], v[144:147], v[88:91], v[204:207]
  v_rcp_f32 v51, v51
  v_mfma_f32_16x16x32_bf16 v[204:207], v[148:151], v[92:95], v[204:207]
  v_rcp_f32 v52, v52
  v_mfma_f32_16x16x32_bf16 v[216:219], v[152:155], v[80:83], v[216:219]
  v_rcp_f32 v53, v53
  v_rcp_f32 v54, v54
  v_mfma_f32_16x16x32_bf16 v[216:219], v[156:159], v[84:87], v[216:219]
  v_rcp_f32 v55, v55
  v_mfma_f32_16x16x32_bf16 v[220:223], v[152:155], v[88:91], v[220:223]
  v_rcp_f32 v56, v56
  v_mfma_f32_16x16x32_bf16 v[220:223], v[156:159], v[92:95], v[220:223]
  v_rcp_f32 v57, v57
  s_nop 0
L_repi:
  v_rcp_f32 v58, v58
  v_rcp_f32 v59, v59
  v_rcp_f32 v60, v60
  v_rcp_f32 v61, v61
  v_rcp_f32 v62, v62
  v_rcp_f32 v63, v63
  v_med3_f32 v48, v48, -v244, v244
  v_med3_f32 v49, v49, -v244, v244
  v_med3_f32 v50, v50, -v244, v244
  v_med3_f32 v51, v51, -v244, v244
  v_med3_f32 v52, v52, -v244, v244
  v_med3_f32 v53, v53, -v244, v244
  v_med3_f32 v54, v54, -v244, v244
  v_med3_f32 v55, v55, -v244, v244
  v_med3_f32 v56, v56, -v244, v244
  v_med3_f32 v57, v57, -v244, v244
  v_med3_f32 v58, v58, -v244, v244
  v_med3_f32 v59, v59, -v244, v244
  v_med3_f32 v60, v60, -v244, v244
  v_med3_f32 v61, v61, -v244, v244
  v_med3_f32 v62, v62, -v244, v244
  v_med3_f32 v63, v63, -v244, v244
  v_pk_add_f32 v[160:161], v[160:161], v[32:33]
  v_pk_add_f32 v[162:163], v[162:163], v[34:35]
  v_pk_add_f32 v[164:165], v[164:165], v[32:33]
  v_pk_add_f32 v[166:167], v[166:167], v[34:35]
  v_pk_add_f32 v[168:169], v[168:169], v[32:33]
  v_pk_add_f32 v[170:171], v[170:171], v[34:35]
  v_pk_add_f32 v[172:173], v[172:173], v[32:33]
  v_pk_add_f32 v[174:175], v[174:175], v[34:35]
  v_pk_add_f32 v[176:177], v[176:177], v[36:37]
  v_pk_add_f32 v[178:179], v[178:179], v[38:39]
  v_pk_add_f32 v[180:181], v[180:181], v[36:37]
  v_pk_add_f32 v[182:183], v[182:183], v[38:39]
  v_pk_add_f32 v[184:185], v[184:185], v[36:37]
  v_pk_add_f32 v[186:187], v[186:187], v[38:39]
  v_pk_add_f32 v[188:189], v[188:189], v[36:37]
  v_pk_add_f32 v[190:191], v[190:191], v[38:39]
  v_pk_add_f32 v[192:193], v[192:193], v[40:41]
  v_pk_add_f32 v[194:195], v[194:195], v[42:43]
  v_pk_add_f32 v[196:197], v[196:197], v[40:41]
  v_pk_add_f32 v[198:199], v[198:199], v[42:43]
  v_pk_add_f32 v[200:201], v[200:201], v[40:41]
  v_pk_add_f32 v[202:203], v[202:203], v[42:43]
  v_pk_add_f32 v[204:205], v[204:205], v[40:41]
  v_pk_add_f32 v[206:207], v[206:207], v[42:43]
  v_pk_add_f32 v[208:209], v[208:209], v[44:45]
  v_pk_add_f32 v[210:211], v[210:211], v[46:47]
  v_pk_add_f32 v[212:213], v[212:213], v[44:45]
  v_pk_add_f32 v[214:215], v[214:215], v[46:47]
  v_pk_add_f32 v[216:217], v[216:217], v[44:45]
  v_pk_add_f32 v[218:219], v[218:219], v[46:47]
  v_pk_add_f32 v[220:221], v[220:221], v[44:45]
  v_pk_add_f32 v[222:223], v[222:223], v[46:47]
  v_pk_mul_f32 v[64:65], v[160:161], v[160:161]
  v_pk_mul_f32 v[68:69], v[164:165], v[164:165]
  v_pk_mul_f32 v[72:73], v[168:169], v[168:169]
  v_pk_mul_f32 v[76:77], v[172:173], v[172:173]
  v_pk_fma_f32 v[64:65], v[64:65], v[242:243], v[240:241]
  v_pk_fma_f32 v[68:69], v[68:69], v[242:243], v[240:241]
  v_pk_fma_f32 v[72:73], v[72:73], v[242:243], v[240:241]
  v_pk_fma_f32 v[76:77], v[76:77], v[242:243], v[240:241]
  v_pk_mul_f32 v[64:65], v[64:65], v[160:161]
  v_pk_mul_f32 v[68:69], v[68:69], v[164:165]
  v_pk_mul_f32 v[72:73], v[72:73], v[168:169]
  v_pk_mul_f32 v[76:77], v[76:77], v[172:173]
  v_exp_f32 v64, v64
  v_exp_f32 v65, v65
  v_exp_f32 v68, v68
  v_exp_f32 v69, v69
  v_exp_f32 v72, v72
  v_exp_f32 v73, v73
  v_exp_f32 v76, v76
  v_exp_f32 v77, v77
  v_pk_fma_f32 v[64:65], v[64:65], v[48:49], v[48:49]
  v_pk_fma_f32 v[68:69], v[68:69], v[48:49], v[48:49]
  v_pk_fma_f32 v[72:73], v[72:73], v[48:49], v[48:49]
  v_pk_fma_f32 v[76:77], v[76:77], v[48:49], v[48:49]
  v_rcp_f32 v64, v64
  v_rcp_f32 v65, v65
  v_rcp_f32 v68, v68
  v_rcp_f32 v69, v69
  v_rcp_f32 v72, v72
  v_rcp_f32 v73, v73
  v_rcp_f32 v76, v76
  v_rcp_f32 v77, v77
  v_pk_mul_f32 v[16:17], v[64:65], v[160:161]
  v_pk_mul_f32 v[18:19], v[68:69], v[164:165]
  v_pk_mul_f32 v[20:21], v[72:73], v[168:169]
  v_pk_mul_f32 v[22:23], v[76:77], v[172:173]
  v_pk_mul_f32 v[80:81], v[162:163], v[162:163]
  v_pk_mul_f32 v[84:85], v[166:167], v[166:167]
  v_pk_mul_f32 v[88:89], v[170:171], v[170:171]
  v_pk_mul_f32 v[92:93], v[174:175], v[174:175]
  v_pk_fma_f32 v[80:81], v[80:81], v[242:243], v[240:241]
  v_pk_fma_f32 v[84:85], v[84:85], v[242:243], v[240:241]
  v_pk_fma_f32 v[88:89], v[88:89], v[242:243], v[240:241]
  v_pk_fma_f32 v[92:93], v[92:93], v[242:243], v[240:241]
  v_pk_mul_f32 v[80:81], v[80:81], v[162:163]
  v_pk_mul_f32 v[84:85], v[84:85], v[166:167]
  v_pk_mul_f32 v[88:89], v[88:89], v[170:171]
  v_pk_mul_f32 v[92:93], v[92:93], v[174:175]
  v_exp_f32 v80, v80
  v_exp_f32 v81, v81
  v_exp_f32 v84, v84
  v_exp_f32 v85, v85
  v_exp_f32 v88, v88
  v_exp_f32 v89, v89
  v_exp_f32 v92, v92
  v_exp_f32 v93, v93
  v_pk_fma_f32 v[80:81], v[80:81], v[50:51], v[50:51]
  v_pk_fma_f32 v[84:85], v[84:85], v[50:51], v[50:51]
  v_pk_fma_f32 v[88:89], v[88:89], v[50:51], v[50:51]
  v_pk_fma_f32 v[92:93], v[92:93], v[50:51], v[50:51]
  v_rcp_f32 v80, v80
  v_rcp_f32 v81, v81
  v_rcp_f32 v84, v84
  v_rcp_f32 v85, v85
  v_rcp_f32 v88, v88
  v_rcp_f32 v89, v89
  v_rcp_f32 v92, v92
  v_rcp_f32 v93, v93
  v_pk_fma_f32 v[16:17], v[80:81], v[162:163], v[16:17]
  v_pk_fma_f32 v[18:19], v[84:85], v[166:167], v[18:19]
  v_pk_fma_f32 v[20:21], v[88:89], v[170:171], v[20:21]
  v_pk_fma_f32 v[22:23], v[92:93], v[174:175], v[22:23]
  v_pk_mul_f32 v[64:65], v[176:177], v[176:177]
  v_pk_mul_f32 v[68:69], v[180:181], v[180:181]
  v_pk_mul_f32 v[72:73], v[184:185], v[184:185]
  v_pk_mul_f32 v[76:77], v[188:189], v[188:189]
  v_pk_fma_f32 v[64:65], v[64:65], v[242:243], v[240:241]
  v_pk_fma_f32 v[68:69], v[68:69], v[242:243], v[240:241]
  v_pk_fma_f32 v[72:73], v[72:73], v[242:243], v[240:241]
  v_pk_fma_f32 v[76:77], v[76:77], v[242:243], v[240:241]
  v_pk_mul_f32 v[64:65], v[64:65], v[176:177]
  v_pk_mul_f32 v[68:69], v[68:69], v[180:181]
  v_pk_mul_f32 v[72:73], v[72:73], v[184:185]
  v_pk_mul_f32 v[76:77], v[76:77], v[188:189]
  v_exp_f32 v64, v64
  v_exp_f32 v65, v65
  v_exp_f32 v68, v68
  v_exp_f32 v69, v69
  v_exp_f32 v72, v72
  v_exp_f32 v73, v73
  v_exp_f32 v76, v76
  v_exp_f32 v77, v77
  v_pk_fma_f32 v[64:65], v[64:65], v[52:53], v[52:53]
  v_pk_fma_f32 v[68:69], v[68:69], v[52:53], v[52:53]
  v_pk_fma_f32 v[72:73], v[72:73], v[52:53], v[52:53]
  v_pk_fma_f32 v[76:77], v[76:77], v[52:53], v[52:53]
  v_rcp_f32 v64, v64
  v_rcp_f32 v65, v65
  v_rcp_f32 v68, v68
  v_rcp_f32 v69, v69
  v_rcp_f32 v72, v72
  v_rcp_f32 v73, v73
  v_rcp_f32 v76, v76
  v_rcp_f32 v77, v77
  v_pk_fma_f32 v[16:17], v[64:65], v[176:177], v[16:17]
  v_pk_fma_f32 v[18:19], v[68:69], v[180:181], v[18:19]
  v_pk_fma_f32 v[20:21], v[72:73], v[184:185], v[20:21]
  v_pk_fma_f32 v[22:23], v[76:77], v[188:189], v[22:23]
  v_pk_mul_f32 v[80:81], v[178:179], v[178:179]
  v_pk_mul_f32 v[84:85], v[182:183], v[182:183]
  v_pk_mul_f32 v[88:89], v[186:187], v[186:187]
  v_pk_mul_f32 v[92:93], v[190:191], v[190:191]
  v_pk_fma_f32 v[80:81], v[80:81], v[242:243], v[240:241]
  v_pk_fma_f32 v[84:85], v[84:85], v[242:243], v[240:241]
  v_pk_fma_f32 v[88:89], v[88:89], v[242:243], v[240:241]
  v_pk_fma_f32 v[92:93], v[92:93], v[242:243], v[240:241]
  v_pk_mul_f32 v[80:81], v[80:81], v[178:179]
  v_pk_mul_f32 v[84:85], v[84:85], v[182:183]
  v_pk_mul_f32 v[88:89], v[88:89], v[186:187]
  v_pk_mul_f32 v[92:93], v[92:93], v[190:191]
  v_exp_f32 v80, v80
  v_exp_f32 v81, v81
  v_exp_f32 v84, v84
  v_exp_f32 v85, v85
  v_exp_f32 v88, v88
  v_exp_f32 v89, v89
  v_exp_f32 v92, v92
  v_exp_f32 v93, v93
  v_pk_fma_f32 v[80:81], v[80:81], v[54:55], v[54:55]
  v_pk_fma_f32 v[84:85], v[84:85], v[54:55], v[54:55]
  v_pk_fma_f32 v[88:89], v[88:89], v[54:55], v[54:55]
  v_pk_fma_f32 v[92:93], v[92:93], v[54:55], v[54:55]
  v_rcp_f32 v80, v80
  v_rcp_f32 v81, v81
  v_rcp_f32 v84, v84
  v_rcp_f32 v85, v85
  v_rcp_f32 v88, v88
  v_rcp_f32 v89, v89
  v_rcp_f32 v92, v92
  v_rcp_f32 v93, v93
  v_pk_fma_f32 v[16:17], v[80:81], v[178:179], v[16:17]
  v_pk_fma_f32 v[18:19], v[84:85], v[182:183], v[18:19]
  v_pk_fma_f32 v[20:21], v[88:89], v[186:187], v[20:21]
  v_pk_fma_f32 v[22:23], v[92:93], v[190:191], v[22:23]
  v_pk_mul_f32 v[64:65], v[192:193], v[192:193]
  v_pk_mul_f32 v[68:69], v[196:197], v[196:197]
  v_pk_mul_f32 v[72:73], v[200:201], v[200:201]
  v_pk_mul_f32 v[76:77], v[204:205], v[204:205]
  v_pk_fma_f32 v[64:65], v[64:65], v[242:243], v[240:241]
  v_pk_fma_f32 v[68:69], v[68:69], v[242:243], v[240:241]
  v_pk_fma_f32 v[72:73], v[72:73], v[242:243], v[240:241]
  v_pk_fma_f32 v[76:77], v[76:77], v[242:243], v[240:241]
  v_pk_mul_f32 v[64:65], v[64:65], v[192:193]
  v_pk_mul_f32 v[68:69], v[68:69], v[196:197]
  v_pk_mul_f32 v[72:73], v[72:73], v[200:201]
  v_pk_mul_f32 v[76:77], v[76:77], v[204:205]
  v_exp_f32 v64, v64
  v_exp_f32 v65, v65
  v_exp_f32 v68, v68
  v_exp_f32 v69, v69
  v_exp_f32 v72, v72
  v_exp_f32 v73, v73
  v_exp_f32 v76, v76
  v_exp_f32 v77, v77
  v_pk_fma_f32 v[64:65], v[64:65], v[56:57], v[56:57]
  v_pk_fma_f32 v[68:69], v[68:69], v[56:57], v[56:57]
  v_pk_fma_f32 v[72:73], v[72:73], v[56:57], v[56:57]
  v_pk_fma_f32 v[76:77], v[76:77], v[56:57], v[56:57]
  v_rcp_f32 v64, v64
  v_rcp_f32 v65, v65
  v_rcp_f32 v68, v68
  v_rcp_f32 v69, v69
  v_rcp_f32 v72, v72
  v_rcp_f32 v73, v73
  v_rcp_f32 v76, v76
  v_rcp_f32 v77, v77
  v_pk_fma_f32 v[16:17], v[64:65], v[192:193], v[16:17]
  v_pk_fma_f32 v[18:19], v[68:69], v[196:197], v[18:19]
  v_pk_fma_f32 v[20:21], v[72:73], v[200:201], v[20:21]
  v_pk_fma_f32 v[22:23], v[76:77], v[204:205], v[22:23]
  v_pk_mul_f32 v[80:81], v[194:195], v[194:195]
  v_pk_mul_f32 v[84:85], v[198:199], v[198:199]
  v_pk_mul_f32 v[88:89], v[202:203], v[202:203]
  v_pk_mul_f32 v[92:93], v[206:207], v[206:207]
  v_pk_fma_f32 v[80:81], v[80:81], v[242:243], v[240:241]
  v_pk_fma_f32 v[84:85], v[84:85], v[242:243], v[240:241]
  v_pk_fma_f32 v[88:89], v[88:89], v[242:243], v[240:241]
  v_pk_fma_f32 v[92:93], v[92:93], v[242:243], v[240:241]
  v_pk_mul_f32 v[80:81], v[80:81], v[194:195]
  v_pk_mul_f32 v[84:85], v[84:85], v[198:199]
  v_pk_mul_f32 v[88:89], v[88:89], v[202:203]
  v_pk_mul_f32 v[92:93], v[92:93], v[206:207]
  v_exp_f32 v80, v80
  v_exp_f32 v81, v81
  v_exp_f32 v84, v84
  v_exp_f32 v85, v85
  v_exp_f32 v88, v88
  v_exp_f32 v89, v89
  v_exp_f32 v92, v92
  v_exp_f32 v93, v93
  v_pk_fma_f32 v[80:81], v[80:81], v[58:59], v[58:59]
  v_pk_fma_f32 v[84:85], v[84:85], v[58:59], v[58:59]
  v_pk_fma_f32 v[88:89], v[88:89], v[58:59], v[58:59]
  v_pk_fma_f32 v[92:93], v[92:93], v[58:59], v[58:59]
  v_rcp_f32 v80, v80
  v_rcp_f32 v81, v81
  v_rcp_f32 v84, v84
  v_rcp_f32 v85, v85
  v_rcp_f32 v88, v88
  v_rcp_f32 v89, v89
  v_rcp_f32 v92, v92
  v_rcp_f32 v93, v93
  v_pk_fma_f32 v[16:17], v[80:81], v[194:195], v[16:17]
  v_pk_fma_f32 v[18:19], v[84:85], v[198:199], v[18:19]
  v_pk_fma_f32 v[20:21], v[88:89], v[202:203], v[20:21]
  v_pk_fma_f32 v[22:23], v[92:93], v[206:207], v[22:23]
  buffer_load_dword v128, v3, s[60:63], s68 offen offset:0 sc1
  buffer_load_dword v129, v3, s[60:63], s68 offen offset:2048 sc1
  buffer_load_dword v130, v3, s[60:63], s69 offen offset:0 sc1
  buffer_load_dword v131, v3, s[60:63], s69 offen offset:2048 sc1
  buffer_load_dword v132, v3, s[60:63], s71 offen offset:0 sc1
  buffer_load_dword v133, v3, s[60:63], s71 offen offset:2048 sc1
  buffer_load_dword v134, v5, s[60:63], s71 offen sc1
  v_pk_mul_f32 v[64:65], v[208:209], v[208:209]
  v_pk_mul_f32 v[68:69], v[212:213], v[212:213]
  v_pk_mul_f32 v[72:73], v[216:217], v[216:217]
  v_pk_mul_f32 v[76:77], v[220:221], v[220:221]
  v_pk_fma_f32 v[64:65], v[64:65], v[242:243], v[240:241]
  v_pk_fma_f32 v[68:69], v[68:69], v[242:243], v[240:241]
  v_pk_fma_f32 v[72:73], v[72:73], v[242:243], v[240:241]
  v_pk_fma_f32 v[76:77], v[76:77], v[242:243], v[240:241]
  v_pk_mul_f32 v[64:65], v[64:65], v[208:209]
  v_pk_mul_f32 v[68:69], v[68:69], v[212:213]
  v_pk_mul_f32 v[72:73], v[72:73], v[216:217]
  v_pk_mul_f32 v[76:77], v[76:77], v[220:221]
  v_exp_f32 v64, v64
  v_exp_f32 v65, v65
  v_exp_f32 v68, v68
  v_exp_f32 v69, v69
  v_exp_f32 v72, v72
  v_exp_f32 v73, v73
  v_exp_f32 v76, v76
  v_exp_f32 v77, v77
  v_pk_fma_f32 v[64:65], v[64:65], v[60:61], v[60:61]
  v_pk_fma_f32 v[68:69], v[68:69], v[60:61], v[60:61]
  v_pk_fma_f32 v[72:73], v[72:73], v[60:61], v[60:61]
  v_pk_fma_f32 v[76:77], v[76:77], v[60:61], v[60:61]
  v_rcp_f32 v64, v64
  v_rcp_f32 v65, v65
  v_rcp_f32 v68, v68
  v_rcp_f32 v69, v69
  v_rcp_f32 v72, v72
  v_rcp_f32 v73, v73
  v_rcp_f32 v76, v76
  v_rcp_f32 v77, v77
  v_pk_fma_f32 v[16:17], v[64:65], v[208:209], v[16:17]
  v_pk_fma_f32 v[18:19], v[68:69], v[212:213], v[18:19]
  v_pk_fma_f32 v[20:21], v[72:73], v[216:217], v[20:21]
  v_pk_fma_f32 v[22:23], v[76:77], v[220:221], v[22:23]
  v_pk_mul_f32 v[80:81], v[210:211], v[210:211]
  v_pk_mul_f32 v[84:85], v[214:215], v[214:215]
  v_pk_mul_f32 v[88:89], v[218:219], v[218:219]
  v_pk_mul_f32 v[92:93], v[222:223], v[222:223]
  v_pk_fma_f32 v[80:81], v[80:81], v[242:243], v[240:241]
  v_pk_fma_f32 v[84:85], v[84:85], v[242:243], v[240:241]
  v_pk_fma_f32 v[88:89], v[88:89], v[242:243], v[240:241]
  v_pk_fma_f32 v[92:93], v[92:93], v[242:243], v[240:241]
  v_pk_mul_f32 v[80:81], v[80:81], v[210:211]
  v_pk_mul_f32 v[84:85], v[84:85], v[214:215]
  v_pk_mul_f32 v[88:89], v[88:89], v[218:219]
  v_pk_mul_f32 v[92:93], v[92:93], v[222:223]
  v_exp_f32 v80, v80
  v_exp_f32 v81, v81
  v_exp_f32 v84, v84
  v_exp_f32 v85, v85
  v_exp_f32 v88, v88
  v_exp_f32 v89, v89
  v_exp_f32 v92, v92
  v_exp_f32 v93, v93
  v_pk_fma_f32 v[80:81], v[80:81], v[62:63], v[62:63]
  v_pk_fma_f32 v[84:85], v[84:85], v[62:63], v[62:63]
  v_pk_fma_f32 v[88:89], v[88:89], v[62:63], v[62:63]
  v_pk_fma_f32 v[92:93], v[92:93], v[62:63], v[62:63]
  v_rcp_f32 v80, v80
  v_rcp_f32 v81, v81
  v_rcp_f32 v84, v84
  v_rcp_f32 v85, v85
  v_rcp_f32 v88, v88
  v_rcp_f32 v89, v89
  v_rcp_f32 v92, v92
  v_rcp_f32 v93, v93
  v_pk_fma_f32 v[16:17], v[80:81], v[210:211], v[16:17]
  v_pk_fma_f32 v[18:19], v[84:85], v[214:215], v[18:19]
  v_pk_fma_f32 v[20:21], v[88:89], v[218:219], v[20:21]
  v_pk_fma_f32 v[22:23], v[92:93], v[222:223], v[22:23]
  v_add_f32 v16, v16, v17
  v_add_f32 v18, v18, v19
  v_add_f32 v20, v20, v21
  v_add_f32 v22, v22, v23
  s_nop 0
  v_permlane32_swap_b32 v16, v20
  v_permlane32_swap_b32 v18, v22
  v_add_f32 v16, v16, v20
  v_add_f32 v18, v18, v22
  s_nop 1
  v_permlane16_swap_b32 v16, v18
  v_add_f32 v16, v16, v18
  v_add_f32 v16, s80, v16
L_rclr:
  s_mov_b32 s72, 0x40000
  s_branch L_pchk
L_poll:
  s_sub_u32 s72, s72, 1
  s_cbranch_scc1 L_pollx
  buffer_load_dword v128, v3, s[60:63], s68 offen offset:0 sc1
  buffer_load_dword v129, v3, s[60:63], s68 offen offset:2048 sc1
  buffer_load_dword v130, v3, s[60:63], s69 offen offset:0 sc1
  buffer_load_dword v131, v3, s[60:63], s69 offen offset:2048 sc1
  buffer_load_dword v132, v3, s[60:63], s71 offen offset:0 sc1
  buffer_load_dword v133, v3, s[60:63], s71 offen offset:2048 sc1
  buffer_load_dword v134, v5, s[60:63], s71 offen sc1
L_pchk:
  s_waitcnt vmcnt(0)
  v_max3_u32 v136, v128, v129, v130
  v_max3_u32 v137, v131, v132, v133
  v_max3_u32 v136, v136, v137, v134
  v_cmp_eq_u32 vcc, -1, v136
  s_cbranch_vccnz L_poll
L_pollx:
  v_add_f32 v128, v128, v129
  v_add_f32 v130, v130, v131
  v_add_f32 v132, v132, v133
  v_add_f32 v16, v16, v134
  v_add_f32 v128, v128, v130
  v_add_f32 v132, v132, v16
  v_add_f32 v128, v128, v132
  v_cvt_pk_bf16_f32 v128, v128, v128
  buffer_store_short v128, v4, s[56:59], s77 offen
  s_endpgm
L_end:
  s_endpgm
.section .rodata,"a"
.p2align 6
.amdhsa_kernel standalone__deep_cross_xdeepfm__recsys_kernel
  .amdhsa_next_free_vgpr 256
  .amdhsa_next_free_sgpr 102
  .amdhsa_accum_offset 256
  .amdhsa_group_segment_fixed_size 0
  .amdhsa_kernarg_size 88
  .amdhsa_user_sgpr_count 2
  .amdhsa_user_sgpr_kernarg_segment_ptr 1
  .amdhsa_system_sgpr_workgroup_id_x 1
  .amdhsa_float_denorm_mode_32 3
.end_amdhsa_kernel
```

```asm
; @launch grid=(256,1,1) block=(512,1,1) lds=163840
.amdgcn_target "amdgcn-amd-amdhsa--gfx950"
.text
.globl standalone__deep_cross_xdeepfm__recsys_kernel
.p2align 8
.type standalone__deep_cross_xdeepfm__recsys_kernel,@function
standalone__deep_cross_xdeepfm__recsys_kernel:
  s_cmp_ge_u32 s2, 256
  s_cbranch_scc1 L_end
  s_load_dwordx16 s[4:19], s[0:1], 0
  s_load_dwordx4 s[20:23], s[0:1], 64
  s_load_dwordx2 s[24:25], s[0:1], 80
  v_lshrrev_b32 v1, 6, v0
  s_getpc_b64 s[92:93]
L_pc:
  s_and_b32 s68, s2, 0xf8
  v_add_u32 v2, s68, v1
  v_lshlrev_b32 v2, 7, v2
  v_and_b32 v3, 1, v0
  v_lshl_add_u32 v2, v3, 15, v2
  v_min_u32 v2, L_end-L_pc, v2
  v_mov_b32 v3, s93
  v_add_co_u32 v2, vcc, s92, v2
  s_nop 1
  v_addc_co_u32 v3, vcc, 0, v3, vcc
  global_load_dword v255, v[2:3], off
  v_and_b32 v0, 63, v0
  v_readfirstlane_b32 s3, v1
  s_and_b32 s68, s2, 7
  s_lshl_b32 s68, s68, 2
  s_lshr_b32 s26, s2, 6
  s_add_u32 s26, s26, s68
  s_bfe_u32 s27, s2, 0x30003
  s_and_b32 s80, s2, 0xf8
  s_add_u32 s80, s80, s3
  s_lshl_b32 s80, s80, 21
  s_lshr_b32 s68, s2, 3
  s_cmp_eq_u32 s68, 5
  s_cbranch_scc1 L_rem
  s_cmp_ge_u32 s27, 5
  s_cbranch_scc1 L_cin
  s_mul_i32 s77, s27, 640
  s_mul_i32 s70, s3, 7
  v_min_u32 v64, 6, v0
  v_add_u32 v64, s70, v64
  v_min_u32 v64, 51, v64
  v_lshrrev_b32 v62, 1, v64
  v_mul_u32_u24 v62, 96, v62
  v_lshl_add_u32 v64, v64, 2, v62
  s_mul_i32 s78, s27, 26
  s_min_u32 s78, s78, 102
  s_lshl_b32 s71, s26, 7
  s_add_u32 s78, s78, s71
  s_mul_i32 s78, s78, 104
  s_and_b32 s70, s26, 3
  s_lshl_b32 s70, s70, 3
  s_add_u32 s70, s70, s3
  s_mul_i32 s70, s70, 3328
  s_add_u32 s81, s70, s77
  v_min_u32 v56, 15, v0
  v_lshrrev_b32 v62, 3, v56
  s_mov_b32 s70, 106496
  v_mul_u32_u24 v62, s70, v62
  v_and_b32 v56, 7, v56
  v_min_u32 v56, 4, v56
  v_lshl_add_u32 v56, v56, 7, v62
  s_xor_b32 s70, s3, 4
  s_lshl_b32 s70, s70, 4
  s_add_u32 s70, s70, s71
  v_lshrrev_b32 v60, 3, v0
  v_add_u32 v60, s70, v60
  v_mul_u32_u24 v13, 104, v60
  s_waitcnt lgkmcnt(0)
  s_mov_b32 s28, s4
  s_and_b32 s29, s5, 0xffff
  s_mov_b32 s30, 425984
  s_mov_b32 s31, 0x20000
  buffer_load_dwordx3 v[52:54], v64, s[28:31], s78 offen
  buffer_load_dwordx2 v[44:45], v13, s[28:31], 0 offen offset:0
  buffer_load_dwordx2 v[48:49], v13, s[28:31], 0 offen offset:832
  s_mov_b32 s32, s6
  s_and_b32 s33, s7, 0xffff
  s_mov_b32 s34, 12800000
  s_mov_b32 s35, 0x20000
  v_mov_b32 v68, s80
  buffer_load_dword v255, v68, s[32:35], 0 offen
  v_lshlrev_b32 v37, 4, v0
  s_mov_b32 s48, s14
  s_and_b32 s49, s15, 0xffff
  s_mov_b32 s50, 3328
  s_mov_b32 s51, 0x20000
  s_mov_b32 s44, s12
  s_and_b32 s45, s13, 0xffff
  s_mov_b32 s46, 5537792
  s_mov_b32 s47, 0x20000
  buffer_load_dword v255, v56, s[44:47], s81 offen
  s_mov_b32 m0, 155648
  s_mov_b32 exec_hi, 0xff
  buffer_load_dwordx4 v37, s[48:51], s77 offen lds
  s_mov_b64 exec, -1
  s_mul_i32 s81, s26, 5
  s_add_u32 s81, s81, s27
  s_lshl_b32 s81, s81, 3
  s_add_u32 s81, s81, s3
  s_add_u32 s81, s81, 1664
  s_lshl_b32 s81, s81, 7
  v_min_u32 v56, 2, v0
  v_mul_u32_u24 v56, 163840, v56
  buffer_load_dword v255, v56, s[44:47], s81 offen
  s_lshr_b32 s68, s3, 2
  s_and_b32 s69, s3, 3
  s_mov_b32 s70, 1639
  s_and_b32 s78, s69, 1
  s_lshl_b32 s78, s78, 2
  s_mov_b32 s81, 3328
  v_mov_b32 v60, v0
  v_mul_u32_u24 v61, s70, v60
  v_lshrrev_b32 v61, 16, v61
  v_mul_u32_u24 v64, 40, v61
  v_sub_u32 v64, v60, v64
  v_and_b32 v63, 2, v61
  v_or_b32 v63, s78, v63
  v_xor_b32 v64, v64, v63
  v_mul_u32_u24 v61, s81, v61
  v_lshl_add_u32 v29, v64, 4, v61
  v_add_u32 v60, 64, v60
  v_mul_u32_u24 v61, s70, v60
  v_lshrrev_b32 v61, 16, v61
  v_mul_u32_u24 v64, 40, v61
  v_sub_u32 v64, v60, v64
  v_and_b32 v63, 2, v61
  v_or_b32 v63, s78, v63
  v_xor_b32 v64, v64, v63
  v_mul_u32_u24 v61, s81, v61
  v_lshl_add_u32 v30, v64, 4, v61
  v_subrev_u32 v30, 1024, v30
  v_add_u32 v60, 64, v60
  v_mul_u32_u24 v61, s70, v60
  v_lshrrev_b32 v61, 16, v61
  v_mul_u32_u24 v64, 40, v61
  v_sub_u32 v64, v60, v64
  v_and_b32 v63, 2, v61
  v_or_b32 v63, s78, v63
  v_xor_b32 v64, v64, v63
  v_mul_u32_u24 v61, s81, v61
  v_lshl_add_u32 v31, v64, 4, v61
  v_subrev_u32 v31, 2048, v31
  v_add_u32 v60, 64, v60
  v_mul_u32_u24 v61, s70, v60
  v_lshrrev_b32 v61, 16, v61
  v_mul_u32_u24 v64, 40, v61
  v_sub_u32 v64, v60, v64
  v_and_b32 v63, 2, v61
  v_or_b32 v63, s78, v63
  v_xor_b32 v64, v64, v63
  v_mul_u32_u24 v61, s81, v61
  v_lshl_add_u32 v32, v64, 4, v61
  v_subrev_u32 v32, 3072, v32
  v_add_u32 v60, 64, v60
  v_mul_u32_u24 v61, s70, v60
  v_lshrrev_b32 v61, 16, v61
  v_mul_u32_u24 v64, 40, v61
  v_sub_u32 v64, v60, v64
  v_and_b32 v63, 2, v61
  v_or_b32 v63, s78, v63
  v_xor_b32 v64, v64, v63
  v_mul_u32_u24 v61, s81, v61
  v_lshl_add_u32 v33, v64, 4, v61
  s_mul_i32 s70, s3, 26624
  s_add_u32 s74, s70, s77
  s_mul_i32 s75, s3, 5120
  s_add_u32 s75, s75, 32768
  s_lshl_b32 s71, s68, 14
  s_lshl_b32 s76, s69, 11
  s_add_u32 s76, s76, s71
  s_xor_b32 s76, s76, 16384
  v_and_b32 v64, 7, v0
  v_lshrrev_b32 v62, 4, v0
  v_xor_b32 v64, v64, v62
  v_lshlrev_b32 v14, 4, v64
  v_xor_b32 v15, 64, v14
  v_and_b32 v64, 15, v0
  v_lshlrev_b32 v64, 7, v64
  s_lshl_b32 s71, s68, 14
  v_bfe_u32 v63, v0, 1, 3
  v_xor_b32 v63, v63, v62
  v_lshl_add_u32 v64, v63, 4, v64
  v_add_u32 v11, s71, v64
  v_xor_b32 v12, 64, v11
  s_mov_b32 s52, s16
  s_and_b32 s53, s17, 0xffff
  s_mov_b32 s54, 3328
  s_mov_b32 s55, 0x20000
  s_mul_i32 s71, s69, 5
  v_bfe_u32 v63, v0, 2, 2
  v_lshl_add_u32 v64, v62, 3, v63
  v_mul_u32_u24 v64, 640, v64
  v_and_b32 v63, 3, v0
  v_lshl_add_u32 v64, v63, 3, v64
  v_add_u32 v64, 32768, v64
  v_bfe_u32 v63, v0, 3, 2
  v_xor_b32 v60, s71, v63
  v_lshl_add_u32 v1, v60, 5, v64
  v_add_u32 v6, 61440, v1
  s_add_u32 s71, s71, 1
  v_xor_b32 v60, s71, v63
  v_lshl_add_u32 v2, v60, 5, v64
  v_add_u32 v7, 61440, v2
  s_add_u32 s71, s71, 1
  v_xor_b32 v60, s71, v63
  v_lshl_add_u32 v3, v60, 5, v64
  v_add_u32 v8, 61440, v3
  s_add_u32 s71, s71, 1
  v_xor_b32 v60, s71, v63
  v_lshl_add_u32 v4, v60, 5, v64
  v_add_u32 v9, 61440, v4
  s_add_u32 s71, s71, 1
  v_xor_b32 v60, s71, v63
  v_lshl_add_u32 v5, v60, 5, v64
  v_add_u32 v10, 61440, v5
  s_add_u32 s71, s71, 1
  s_mul_i32 s71, s69, 160
  s_add_u32 s71, s71, 155648
  v_lshlrev_b32 v64, 3, v62
  v_add_u32 v35, s71, v64
  s_lshl_b32 s70, s69, 1
  s_add_u32 s70, s70, s68
  s_lshl_b32 s70, s70, 8
  s_add_u32 s70, s70, 156928
  v_lshlrev_b32 v36, 2, v0
  v_add_u32 v36, s70, v36
  s_add_u32 m0, s75, 0
  s_nop 0
  buffer_load_dwordx4 v29, s[44:47], s74 offen offset:0 lds
  buffer_load_dwordx4 v30, s[44:47], s74 offen offset:1024 lds
  buffer_load_dwordx4 v31, s[44:47], s74 offen offset:2048 lds
  buffer_load_dwordx4 v32, s[44:47], s74 offen offset:3072 lds
  s_add_u32 m0, m0, 4096
  s_nop 0
  buffer_load_dwordx4 v33, s[44:47], s74 offen offset:0 lds
  s_add_u32 s74, s74, 212992
  s_waitcnt vmcnt(11)
  v_lshlrev_b32 v52, 7, v52
  s_barrier
  buffer_load_dword v255, v52, s[32:35], 0 offen
  s_waitcnt vmcnt(10)
  v_lshl_add_u32 v34, v48, 7, v15
  v_lshl_add_u32 v28, v44, 7, v14
  s_add_u32 m0, s76, 0
  s_nop 0
  buffer_load_dwordx4 v28, s[32:35], 0 offen lds
  s_add_u32 m0, m0, 1024
  s_nop 0
  buffer_load_dwordx4 v34, s[32:35], 0 offen lds
  v_lshlrev_b32 v54, 7, v54
  buffer_load_dword v255, v54, s[32:35], 0 offen
  s_barrier
  s_waitcnt vmcnt(10)
  ds_read_b64 v[220:221], v35 offset:0
  ds_read_b64 v[222:223], v35 offset:32
  ds_read_b64 v[224:225], v35 offset:64
  ds_read_b64 v[226:227], v35 offset:96
  ds_read_b64 v[228:229], v35 offset:128
  s_waitcnt lgkmcnt(4)
  v_lshlrev_b32 v140, 16, v220
  v_and_b32 v141, 0xffff0000, v220
  v_lshlrev_b32 v142, 16, v221
  v_and_b32 v143, 0xffff0000, v221
  s_waitcnt lgkmcnt(3)
  v_lshlrev_b32 v156, 16, v222
  v_and_b32 v157, 0xffff0000, v222
  v_lshlrev_b32 v158, 16, v223
  v_and_b32 v159, 0xffff0000, v223
  s_waitcnt lgkmcnt(2)
  v_lshlrev_b32 v172, 16, v224
  v_and_b32 v173, 0xffff0000, v224
  v_lshlrev_b32 v174, 16, v225
  v_and_b32 v175, 0xffff0000, v225
  s_waitcnt lgkmcnt(1)
  v_lshlrev_b32 v188, 16, v226
  v_and_b32 v189, 0xffff0000, v226
  v_lshlrev_b32 v190, 16, v227
  v_and_b32 v191, 0xffff0000, v227
  s_waitcnt lgkmcnt(0)
  v_lshlrev_b32 v204, 16, v228
  v_and_b32 v205, 0xffff0000, v228
  v_lshlrev_b32 v206, 16, v229
  v_and_b32 v207, 0xffff0000, v229
  v_mov_b64 v[144:145], v[140:141]
  v_mov_b64 v[146:147], v[142:143]
  v_mov_b64 v[148:149], v[140:141]
  v_mov_b64 v[150:151], v[142:143]
  v_mov_b64 v[152:153], v[140:141]
  v_mov_b64 v[154:155], v[142:143]
  v_mov_b64 v[160:161], v[156:157]
  v_mov_b64 v[162:163], v[158:159]
  v_mov_b64 v[164:165], v[156:157]
  v_mov_b64 v[166:167], v[158:159]
  v_mov_b64 v[168:169], v[156:157]
  v_mov_b64 v[170:171], v[158:159]
  v_mov_b64 v[176:177], v[172:173]
  v_mov_b64 v[178:179], v[174:175]
  v_mov_b64 v[180:181], v[172:173]
  v_mov_b64 v[182:183], v[174:175]
  v_mov_b64 v[184:185], v[172:173]
  v_mov_b64 v[186:187], v[174:175]
  v_mov_b64 v[192:193], v[188:189]
  v_mov_b64 v[194:195], v[190:191]
  v_mov_b64 v[196:197], v[188:189]
  v_mov_b64 v[198:199], v[190:191]
  v_mov_b64 v[200:201], v[188:189]
  v_mov_b64 v[202:203], v[190:191]
  v_mov_b64 v[208:209], v[204:205]
  v_mov_b64 v[210:211], v[206:207]
  v_mov_b64 v[212:213], v[204:205]
  v_mov_b64 v[214:215], v[206:207]
  v_mov_b64 v[216:217], v[204:205]
  v_mov_b64 v[218:219], v[206:207]
  s_lshl_b32 s73, s68, 2
  s_add_u32 s73, s73, 4
  buffer_load_dwordx3 v[16:18], v13, s[28:31], s73 offen offset:0
  buffer_load_dwordx3 v[20:22], v13, s[28:31], s73 offen offset:832
  s_add_u32 s73, s73, 12
  s_mov_b32 s72, 0
  s_cmp_lg_u32 s68, 0
  s_cbranch_scc1 L_dnn_h1
L_dnn_h0:
  s_add_u32 m0, s75, 40960
  s_nop 0
  buffer_load_dwordx4 v29, s[44:47], s74 offen offset:0 lds
  buffer_load_dwordx4 v30, s[44:47], s74 offen offset:1024 lds
  buffer_load_dwordx4 v31, s[44:47], s74 offen offset:2048 lds
  buffer_load_dwordx4 v32, s[44:47], s74 offen offset:3072 lds
  s_add_u32 m0, m0, 4096
  s_nop 0
  buffer_load_dwordx4 v33, s[44:47], s74 offen offset:0 lds
  s_add_u32 s74, s74, 212992
  s_waitcnt vmcnt(11) lgkmcnt(0)
  s_barrier
  buffer_load_dwordx3 v[24:26], v13, s[28:31], s73 offen offset:0
  buffer_load_dwordx3 v[240:242], v13, s[28:31], s73 offen offset:832
  s_add_u32 s73, s73, 12
L_dnn_loop0:
  ds_read_b64_tr_b16 v[40:41], v1 offset:0
  s_add_u32 m0, s75, 81920
  s_nop 0
  buffer_load_dwordx4 v29, s[44:47], s74 offen offset:0 lds
  ds_read_b64_tr_b16 v[42:43], v1 offset:2560
  ds_read_b64_tr_b16 v[44:45], v1 offset:20480
  ds_read_b64_tr_b16 v[46:47], v1 offset:23040
  ds_read_b64_tr_b16 v[48:49], v2 offset:0
  buffer_load_dwordx4 v30, s[44:47], s74 offen offset:1024 lds
  ds_read_b64_tr_b16 v[50:51], v2 offset:2560
  ds_read_b64_tr_b16 v[52:53], v2 offset:20480
  ds_read_b64_tr_b16 v[54:55], v2 offset:23040
  ds_read_b64_tr_b16 v[56:57], v3 offset:0
  buffer_load_dwordx4 v31, s[44:47], s74 offen offset:2048 lds
  ds_read_b64_tr_b16 v[58:59], v3 offset:2560
  ds_read_b64_tr_b16 v[60:61], v3 offset:20480
  ds_read_b64_tr_b16 v[62:63], v3 offset:23040
  ds_read_b64_tr_b16 v[64:65], v4 offset:0
  buffer_load_dwordx4 v32, s[44:47], s74 offen offset:3072 lds
  ds_read_b64_tr_b16 v[66:67], v4 offset:2560
  ds_read_b64_tr_b16 v[68:69], v4 offset:20480
  ds_read_b64_tr_b16 v[70:71], v4 offset:23040
  ds_read_b128 v[80:83], v11 offset:0
  s_add_u32 m0, m0, 4096
  s_nop 0
  buffer_load_dwordx4 v33, s[44:47], s74 offen offset:0 lds
  s_add_u32 s74, s74, 212992
  ds_read_b128 v[84:87], v12 offset:0
  ds_read_b128 v[88:91], v11 offset:2048
  ds_read_b128 v[92:95], v12 offset:2048
  ds_read_b128 v[96:99], v11 offset:4096
  s_waitcnt vmcnt(12)
  v_lshl_add_u32 v34, v20, 7, v15
  v_lshl_add_u32 v28, v16, 7, v14
  s_add_u32 m0, s76, 8192
  s_nop 0
  buffer_load_dwordx4 v28, s[32:35], 0 offen lds
  ds_read_b128 v[100:103], v12 offset:4096
  ds_read_b128 v[104:107], v11 offset:6144
  ds_read_b128 v[108:111], v12 offset:6144
  ds_read_b64_tr_b16 v[72:73], v5 offset:0
  s_add_u32 m0, m0, 1024
  s_nop 0
  buffer_load_dwordx4 v34, s[32:35], 0 offen lds
  ds_read_b64_tr_b16 v[74:75], v5 offset:2560
  ds_read_b64_tr_b16 v[76:77], v5 offset:20480
  ds_read_b64_tr_b16 v[78:79], v5 offset:23040
  s_waitcnt vmcnt(9) lgkmcnt(0)
  s_barrier
  s_setprio 0
  v_mfma_f32_16x16x32_bf16 v[140:143], v[40:43], v[80:83], v[140:143]
  v_mfma_f32_16x16x32_bf16 v[140:143], v[44:47], v[84:87], v[140:143]
  v_mfma_f32_16x16x32_bf16 v[144:147], v[40:43], v[88:91], v[144:147]
  v_mfma_f32_16x16x32_bf16 v[144:147], v[44:47], v[92:95], v[144:147]
  v_mfma_f32_16x16x32_bf16 v[148:151], v[40:43], v[96:99], v[148:151]
  v_mfma_f32_16x16x32_bf16 v[148:151], v[44:47], v[100:103], v[148:151]
  v_mfma_f32_16x16x32_bf16 v[152:155], v[40:43], v[104:107], v[152:155]
  v_mfma_f32_16x16x32_bf16 v[152:155], v[44:47], v[108:111], v[152:155]
  v_mfma_f32_16x16x32_bf16 v[168:171], v[48:51], v[104:107], v[168:171]
  v_mfma_f32_16x16x32_bf16 v[168:171], v[52:55], v[108:111], v[168:171]
  v_mfma_f32_16x16x32_bf16 v[164:167], v[48:51], v[96:99], v[164:167]
  v_mfma_f32_16x16x32_bf16 v[164:167], v[52:55], v[100:103], v[164:167]
  v_mfma_f32_16x16x32_bf16 v[160:163], v[48:51], v[88:91], v[160:163]
  v_mfma_f32_16x16x32_bf16 v[160:163], v[52:55], v[92:95], v[160:163]
  v_mfma_f32_16x16x32_bf16 v[156:159], v[48:51], v[80:83], v[156:159]
  v_mfma_f32_16x16x32_bf16 v[156:159], v[52:55], v[84:87], v[156:159]
  v_mfma_f32_16x16x32_bf16 v[172:175], v[56:59], v[80:83], v[172:175]
  v_mfma_f32_16x16x32_bf16 v[172:175], v[60:63], v[84:87], v[172:175]
  v_mfma_f32_16x16x32_bf16 v[176:179], v[56:59], v[88:91], v[176:179]
  v_mfma_f32_16x16x32_bf16 v[176:179], v[60:63], v[92:95], v[176:179]
  v_mfma_f32_16x16x32_bf16 v[180:183], v[56:59], v[96:99], v[180:183]
  v_mfma_f32_16x16x32_bf16 v[180:183], v[60:63], v[100:103], v[180:183]
  v_mfma_f32_16x16x32_bf16 v[184:187], v[56:59], v[104:107], v[184:187]
  v_mfma_f32_16x16x32_bf16 v[184:187], v[60:63], v[108:111], v[184:187]
  v_mfma_f32_16x16x32_bf16 v[200:203], v[64:67], v[104:107], v[200:203]
  v_mfma_f32_16x16x32_bf16 v[200:203], v[68:71], v[108:111], v[200:203]
  v_mfma_f32_16x16x32_bf16 v[196:199], v[64:67], v[96:99], v[196:199]
  v_mfma_f32_16x16x32_bf16 v[196:199], v[68:71], v[100:103], v[196:199]
  v_mfma_f32_16x16x32_bf16 v[192:195], v[64:67], v[88:91], v[192:195]
  v_mfma_f32_16x16x32_bf16 v[192:195], v[68:71], v[92:95], v[192:195]
  v_mfma_f32_16x16x32_bf16 v[188:191], v[64:67], v[80:83], v[188:191]
  v_mfma_f32_16x16x32_bf16 v[188:191], v[68:71], v[84:87], v[188:191]
  v_mfma_f32_16x16x32_bf16 v[204:207], v[72:75], v[80:83], v[204:207]
  v_mfma_f32_16x16x32_bf16 v[204:207], v[76:79], v[84:87], v[204:207]
  v_mfma_f32_16x16x32_bf16 v[208:211], v[72:75], v[88:91], v[208:211]
  v_mfma_f32_16x16x32_bf16 v[208:211], v[76:79], v[92:95], v[208:211]
  v_mfma_f32_16x16x32_bf16 v[212:215], v[72:75], v[96:99], v[212:215]
  v_mfma_f32_16x16x32_bf16 v[212:215], v[76:79], v[100:103], v[212:215]
  v_mfma_f32_16x16x32_bf16 v[216:219], v[72:75], v[104:107], v[216:219]
  s_setprio 2
  s_waitcnt vmcnt(9)
  s_barrier
  v_mfma_f32_16x16x32_bf16 v[216:219], v[76:79], v[108:111], v[216:219]
  ds_read_b64_tr_b16 v[40:41], v1 offset:40960
  s_add_u32 m0, s75, 0
  s_nop 0
  buffer_load_dwordx4 v29, s[44:47], s74 offen offset:0 lds
  ds_read_b64_tr_b16 v[42:43], v1 offset:43520
  ds_read_b64_tr_b16 v[44:45], v6 offset:0
  ds_read_b64_tr_b16 v[46:47], v6 offset:2560
  ds_read_b64_tr_b16 v[48:49], v2 offset:40960
  buffer_load_dwordx4 v30, s[44:47], s74 offen offset:1024 lds
  ds_read_b64_tr_b16 v[50:51], v2 offset:43520
  ds_read_b64_tr_b16 v[52:53], v7 offset:0
  ds_read_b64_tr_b16 v[54:55], v7 offset:2560
  ds_read_b64_tr_b16 v[56:57], v3 offset:40960
  buffer_load_dwordx4 v31, s[44:47], s74 offen offset:2048 lds
  ds_read_b64_tr_b16 v[58:59], v3 offset:43520
  ds_read_b64_tr_b16 v[60:61], v8 offset:0
  ds_read_b64_tr_b16 v[62:63], v8 offset:2560
  ds_read_b64_tr_b16 v[64:65], v4 offset:40960
  buffer_load_dwordx4 v32, s[44:47], s74 offen offset:3072 lds
  ds_read_b64_tr_b16 v[66:67], v4 offset:43520
  ds_read_b64_tr_b16 v[68:69], v9 offset:0
  ds_read_b64_tr_b16 v[70:71], v9 offset:2560
  ds_read_b128 v[80:83], v11 offset:8192
  s_add_u32 m0, m0, 4096
  s_nop 0
  buffer_load_dwordx4 v33, s[44:47], s74 offen offset:0 lds
  s_add_u32 s74, s74, 212992
  ds_read_b128 v[84:87], v12 offset:8192
  ds_read_b128 v[88:91], v11 offset:10240
  ds_read_b128 v[92:95], v12 offset:10240
  ds_read_b128 v[96:99], v11 offset:12288
  v_lshl_add_u32 v34, v21, 7, v15
  v_lshl_add_u32 v28, v17, 7, v14
  s_add_u32 m0, s76, 0
  s_nop 0
  buffer_load_dwordx4 v28, s[32:35], 0 offen lds
  ds_read_b128 v[100:103], v12 offset:12288
  ds_read_b128 v[104:107], v11 offset:14336
  ds_read_b128 v[108:111], v12 offset:14336
  ds_read_b64_tr_b16 v[72:73], v5 offset:40960
  s_add_u32 m0, m0, 1024
  s_nop 0
  buffer_load_dwordx4 v34, s[32:35], 0 offen lds
  ds_read_b64_tr_b16 v[74:75], v5 offset:43520
  ds_read_b64_tr_b16 v[76:77], v10 offset:0
  ds_read_b64_tr_b16 v[78:79], v10 offset:2560
  s_waitcnt vmcnt(7) lgkmcnt(0)
  s_barrier
  s_setprio 0
  v_mfma_f32_16x16x32_bf16 v[140:143], v[40:43], v[80:83], v[140:143]
  v_mfma_f32_16x16x32_bf16 v[140:143], v[44:47], v[84:87], v[140:143]
  v_mfma_f32_16x16x32_bf16 v[144:147], v[40:43], v[88:91], v[144:147]
  v_mfma_f32_16x16x32_bf16 v[144:147], v[44:47], v[92:95], v[144:147]
  v_mfma_f32_16x16x32_bf16 v[148:151], v[40:43], v[96:99], v[148:151]
  v_mfma_f32_16x16x32_bf16 v[148:151], v[44:47], v[100:103], v[148:151]
  v_mfma_f32_16x16x32_bf16 v[152:155], v[40:43], v[104:107], v[152:155]
  v_mfma_f32_16x16x32_bf16 v[152:155], v[44:47], v[108:111], v[152:155]
  v_mfma_f32_16x16x32_bf16 v[168:171], v[48:51], v[104:107], v[168:171]
  v_mfma_f32_16x16x32_bf16 v[168:171], v[52:55], v[108:111], v[168:171]
  v_mfma_f32_16x16x32_bf16 v[164:167], v[48:51], v[96:99], v[164:167]
  v_mfma_f32_16x16x32_bf16 v[164:167], v[52:55], v[100:103], v[164:167]
  v_mfma_f32_16x16x32_bf16 v[160:163], v[48:51], v[88:91], v[160:163]
  v_mfma_f32_16x16x32_bf16 v[160:163], v[52:55], v[92:95], v[160:163]
  v_mfma_f32_16x16x32_bf16 v[156:159], v[48:51], v[80:83], v[156:159]
  v_mfma_f32_16x16x32_bf16 v[156:159], v[52:55], v[84:87], v[156:159]
  v_mfma_f32_16x16x32_bf16 v[172:175], v[56:59], v[80:83], v[172:175]
  v_mfma_f32_16x16x32_bf16 v[172:175], v[60:63], v[84:87], v[172:175]
  v_mfma_f32_16x16x32_bf16 v[176:179], v[56:59], v[88:91], v[176:179]
  v_mfma_f32_16x16x32_bf16 v[176:179], v[60:63], v[92:95], v[176:179]
  v_mfma_f32_16x16x32_bf16 v[180:183], v[56:59], v[96:99], v[180:183]
  v_mfma_f32_16x16x32_bf16 v[180:183], v[60:63], v[100:103], v[180:183]
  v_mfma_f32_16x16x32_bf16 v[184:187], v[56:59], v[104:107], v[184:187]
  v_mfma_f32_16x16x32_bf16 v[184:187], v[60:63], v[108:111], v[184:187]
  v_mfma_f32_16x16x32_bf16 v[200:203], v[64:67], v[104:107], v[200:203]
  v_mfma_f32_16x16x32_bf16 v[200:203], v[68:71], v[108:111], v[200:203]
  v_mfma_f32_16x16x32_bf16 v[196:199], v[64:67], v[96:99], v[196:199]
  v_mfma_f32_16x16x32_bf16 v[196:199], v[68:71], v[100:103], v[196:199]
  v_mfma_f32_16x16x32_bf16 v[192:195], v[64:67], v[88:91], v[192:195]
  v_mfma_f32_16x16x32_bf16 v[192:195], v[68:71], v[92:95], v[192:195]
  v_mfma_f32_16x16x32_bf16 v[188:191], v[64:67], v[80:83], v[188:191]
  v_mfma_f32_16x16x32_bf16 v[188:191], v[68:71], v[84:87], v[188:191]
  v_mfma_f32_16x16x32_bf16 v[204:207], v[72:75], v[80:83], v[204:207]
  v_mfma_f32_16x16x32_bf16 v[204:207], v[76:79], v[84:87], v[204:207]
  v_mfma_f32_16x16x32_bf16 v[208:211], v[72:75], v[88:91], v[208:211]
  v_mfma_f32_16x16x32_bf16 v[208:211], v[76:79], v[92:95], v[208:211]
  v_mfma_f32_16x16x32_bf16 v[212:215], v[72:75], v[96:99], v[212:215]
  v_mfma_f32_16x16x32_bf16 v[212:215], v[76:79], v[100:103], v[212:215]
  v_mfma_f32_16x16x32_bf16 v[216:219], v[72:75], v[104:107], v[216:219]
  s_setprio 2
  s_barrier
  v_mfma_f32_16x16x32_bf16 v[216:219], v[76:79], v[108:111], v[216:219]
  ds_read_b64_tr_b16 v[40:41], v6 offset:20480
  s_add_u32 m0, s75, 40960
  s_nop 0
  buffer_load_dwordx4 v29, s[44:47], s74 offen offset:0 lds
  ds_read_b64_tr_b16 v[42:43], v6 offset:23040
  ds_read_b64_tr_b16 v[44:45], v6 offset:40960
  ds_read_b64_tr_b16 v[46:47], v6 offset:43520
  ds_read_b64_tr_b16 v[48:49], v7 offset:20480
  buffer_load_dwordx4 v30, s[44:47], s74 offen offset:1024 lds
  ds_read_b64_tr_b16 v[50:51], v7 offset:23040
  ds_read_b64_tr_b16 v[52:53], v7 offset:40960
  ds_read_b64_tr_b16 v[54:55], v7 offset:43520
  ds_read_b64_tr_b16 v[56:57], v8 offset:20480
  buffer_load_dwordx4 v31, s[44:47], s74 offen offset:2048 lds
  ds_read_b64_tr_b16 v[58:59], v8 offset:23040
  ds_read_b64_tr_b16 v[60:61], v8 offset:40960
  ds_read_b64_tr_b16 v[62:63], v8 offset:43520
  ds_read_b64_tr_b16 v[64:65], v9 offset:20480
  buffer_load_dwordx4 v32, s[44:47], s74 offen offset:3072 lds
  ds_read_b64_tr_b16 v[66:67], v9 offset:23040
  ds_read_b64_tr_b16 v[68:69], v9 offset:40960
  ds_read_b64_tr_b16 v[70:71], v9 offset:43520
  ds_read_b128 v[80:83], v11 offset:0
  s_add_u32 m0, m0, 4096
  s_nop 0
  buffer_load_dwordx4 v33, s[44:47], s74 offen offset:0 lds
  s_add_u32 s74, s74, 212992
  ds_read_b128 v[84:87], v12 offset:0
  ds_read_b128 v[88:91], v11 offset:2048
  ds_read_b128 v[92:95], v12 offset:2048
  ds_read_b128 v[96:99], v11 offset:4096
  v_lshl_add_u32 v34, v22, 7, v15
  v_lshl_add_u32 v28, v18, 7, v14
  s_add_u32 m0, s76, 8192
  s_nop 0
  buffer_load_dwordx4 v28, s[32:35], 0 offen lds
  ds_read_b128 v[100:103], v12 offset:4096
  ds_read_b128 v[104:107], v11 offset:6144
  ds_read_b128 v[108:111], v12 offset:6144
  ds_read_b64_tr_b16 v[72:73], v10 offset:20480
  s_add_u32 m0, m0, 1024
  s_nop 0
  buffer_load_dwordx4 v34, s[32:35], 0 offen lds
  ds_read_b64_tr_b16 v[74:75], v10 offset:23040
  ds_read_b64_tr_b16 v[76:77], v10 offset:40960
  ds_read_b64_tr_b16 v[78:79], v10 offset:43520
  buffer_load_dwordx3 v[16:18], v13, s[28:31], s73 offen offset:0
  buffer_load_dwordx3 v[20:22], v13, s[28:31], s73 offen offset:832
  s_add_u32 s73, s73, 12
  s_waitcnt vmcnt(9) lgkmcnt(0)
  s_barrier
  s_setprio 0
  v_mfma_f32_16x16x32_bf16 v[140:143], v[40:43], v[80:83], v[140:143]
  v_mfma_f32_16x16x32_bf16 v[140:143], v[44:47], v[84:87], v[140:143]
  v_mfma_f32_16x16x32_bf16 v[144:147], v[40:43], v[88:91], v[144:147]
  v_mfma_f32_16x16x32_bf16 v[144:147], v[44:47], v[92:95], v[144:147]
  v_mfma_f32_16x16x32_bf16 v[148:151], v[40:43], v[96:99], v[148:151]
  v_mfma_f32_16x16x32_bf16 v[148:151], v[44:47], v[100:103], v[148:151]
  v_mfma_f32_16x16x32_bf16 v[152:155], v[40:43], v[104:107], v[152:155]
  v_mfma_f32_16x16x32_bf16 v[152:155], v[44:47], v[108:111], v[152:155]
  v_mfma_f32_16x16x32_bf16 v[168:171], v[48:51], v[104:107], v[168:171]
  v_mfma_f32_16x16x32_bf16 v[168:171], v[52:55], v[108:111], v[168:171]
  v_mfma_f32_16x16x32_bf16 v[164:167], v[48:51], v[96:99], v[164:167]
  v_mfma_f32_16x16x32_bf16 v[164:167], v[52:55], v[100:103], v[164:167]
  v_mfma_f32_16x16x32_bf16 v[160:163], v[48:51], v[88:91], v[160:163]
  v_mfma_f32_16x16x32_bf16 v[160:163], v[52:55], v[92:95], v[160:163]
  v_mfma_f32_16x16x32_bf16 v[156:159], v[48:51], v[80:83], v[156:159]
  v_mfma_f32_16x16x32_bf16 v[156:159], v[52:55], v[84:87], v[156:159]
  v_mfma_f32_16x16x32_bf16 v[172:175], v[56:59], v[80:83], v[172:175]
  v_mfma_f32_16x16x32_bf16 v[172:175], v[60:63], v[84:87], v[172:175]
  v_mfma_f32_16x16x32_bf16 v[176:179], v[56:59], v[88:91], v[176:179]
  v_mfma_f32_16x16x32_bf16 v[176:179], v[60:63], v[92:95], v[176:179]
  v_mfma_f32_16x16x32_bf16 v[180:183], v[56:59], v[96:99], v[180:183]
  v_mfma_f32_16x16x32_bf16 v[180:183], v[60:63], v[100:103], v[180:183]
  v_mfma_f32_16x16x32_bf16 v[184:187], v[56:59], v[104:107], v[184:187]
  v_mfma_f32_16x16x32_bf16 v[184:187], v[60:63], v[108:111], v[184:187]
  v_mfma_f32_16x16x32_bf16 v[200:203], v[64:67], v[104:107], v[200:203]
  v_mfma_f32_16x16x32_bf16 v[200:203], v[68:71], v[108:111], v[200:203]
  v_mfma_f32_16x16x32_bf16 v[196:199], v[64:67], v[96:99], v[196:199]
  v_mfma_f32_16x16x32_bf16 v[196:199], v[68:71], v[100:103], v[196:199]
  v_mfma_f32_16x16x32_bf16 v[192:195], v[64:67], v[88:91], v[192:195]
  v_mfma_f32_16x16x32_bf16 v[192:195], v[68:71], v[92:95], v[192:195]
  v_mfma_f32_16x16x32_bf16 v[188:191], v[64:67], v[80:83], v[188:191]
  v_mfma_f32_16x16x32_bf16 v[188:191], v[68:71], v[84:87], v[188:191]
  v_mfma_f32_16x16x32_bf16 v[204:207], v[72:75], v[80:83], v[204:207]
  v_mfma_f32_16x16x32_bf16 v[204:207], v[76:79], v[84:87], v[204:207]
  v_mfma_f32_16x16x32_bf16 v[208:211], v[72:75], v[88:91], v[208:211]
  v_mfma_f32_16x16x32_bf16 v[208:211], v[76:79], v[92:95], v[208:211]
  v_mfma_f32_16x16x32_bf16 v[212:215], v[72:75], v[96:99], v[212:215]
  v_mfma_f32_16x16x32_bf16 v[212:215], v[76:79], v[100:103], v[212:215]
  v_mfma_f32_16x16x32_bf16 v[216:219], v[72:75], v[104:107], v[216:219]
  s_setprio 2
  s_barrier
  v_mfma_f32_16x16x32_bf16 v[216:219], v[76:79], v[108:111], v[216:219]
  ds_read_b64_tr_b16 v[40:41], v1 offset:0
  s_add_u32 m0, s75, 81920
  s_nop 0
  buffer_load_dwordx4 v29, s[44:47], s74 offen offset:0 lds
  ds_read_b64_tr_b16 v[42:43], v1 offset:2560
  ds_read_b64_tr_b16 v[44:45], v1 offset:20480
  ds_read_b64_tr_b16 v[46:47], v1 offset:23040
  ds_read_b64_tr_b16 v[48:49], v2 offset:0
  buffer_load_dwordx4 v30, s[44:47], s74 offen offset:1024 lds
  ds_read_b64_tr_b16 v[50:51], v2 offset:2560
  ds_read_b64_tr_b16 v[52:53], v2 offset:20480
  ds_read_b64_tr_b16 v[54:55], v2 offset:23040
  ds_read_b64_tr_b16 v[56:57], v3 offset:0
  buffer_load_dwordx4 v31, s[44:47], s74 offen offset:2048 lds
  ds_read_b64_tr_b16 v[58:59], v3 offset:2560
  ds_read_b64_tr_b16 v[60:61], v3 offset:20480
  ds_read_b64_tr_b16 v[62:63], v3 offset:23040
  ds_read_b64_tr_b16 v[64:65], v4 offset:0
  buffer_load_dwordx4 v32, s[44:47], s74 offen offset:3072 lds
  ds_read_b64_tr_b16 v[66:67], v4 offset:2560
  ds_read_b64_tr_b16 v[68:69], v4 offset:20480
  ds_read_b64_tr_b16 v[70:71], v4 offset:23040
  ds_read_b128 v[80:83], v11 offset:8192
  s_add_u32 m0, m0, 4096
  s_nop 0
  buffer_load_dwordx4 v33, s[44:47], s74 offen offset:0 lds
  s_add_u32 s74, s74, 212992
  ds_read_b128 v[84:87], v12 offset:8192
  ds_read_b128 v[88:91], v11 offset:10240
  ds_read_b128 v[92:95], v12 offset:10240
  ds_read_b128 v[96:99], v11 offset:12288
  v_lshl_add_u32 v34, v240, 7, v15
  v_lshl_add_u32 v28, v24, 7, v14
  s_add_u32 m0, s76, 0
  s_nop 0
  buffer_load_dwordx4 v28, s[32:35], 0 offen lds
  ds_read_b128 v[100:103], v12 offset:12288
  ds_read_b128 v[104:107], v11 offset:14336
  ds_read_b128 v[108:111], v12 offset:14336
  ds_read_b64_tr_b16 v[72:73], v5 offset:0
  s_add_u32 m0, m0, 1024
  s_nop 0
  buffer_load_dwordx4 v34, s[32:35], 0 offen lds
  ds_read_b64_tr_b16 v[74:75], v5 offset:2560
  ds_read_b64_tr_b16 v[76:77], v5 offset:20480
  ds_read_b64_tr_b16 v[78:79], v5 offset:23040
  s_waitcnt vmcnt(9) lgkmcnt(0)
  s_barrier
  s_setprio 0
  v_mfma_f32_16x16x32_bf16 v[140:143], v[40:43], v[80:83], v[140:143]
  v_mfma_f32_16x16x32_bf16 v[140:143], v[44:47], v[84:87], v[140:143]
  v_mfma_f32_16x16x32_bf16 v[144:147], v[40:43], v[88:91], v[144:147]
  v_mfma_f32_16x16x32_bf16 v[144:147], v[44:47], v[92:95], v[144:147]
  v_mfma_f32_16x16x32_bf16 v[148:151], v[40:43], v[96:99], v[148:151]
  v_mfma_f32_16x16x32_bf16 v[148:151], v[44:47], v[100:103], v[148:151]
  v_mfma_f32_16x16x32_bf16 v[152:155], v[40:43], v[104:107], v[152:155]
  v_mfma_f32_16x16x32_bf16 v[152:155], v[44:47], v[108:111], v[152:155]
  v_mfma_f32_16x16x32_bf16 v[168:171], v[48:51], v[104:107], v[168:171]
  v_mfma_f32_16x16x32_bf16 v[168:171], v[52:55], v[108:111], v[168:171]
  v_mfma_f32_16x16x32_bf16 v[164:167], v[48:51], v[96:99], v[164:167]
  v_mfma_f32_16x16x32_bf16 v[164:167], v[52:55], v[100:103], v[164:167]
  v_mfma_f32_16x16x32_bf16 v[160:163], v[48:51], v[88:91], v[160:163]
  v_mfma_f32_16x16x32_bf16 v[160:163], v[52:55], v[92:95], v[160:163]
  v_mfma_f32_16x16x32_bf16 v[156:159], v[48:51], v[80:83], v[156:159]
  v_mfma_f32_16x16x32_bf16 v[156:159], v[52:55], v[84:87], v[156:159]
  v_mfma_f32_16x16x32_bf16 v[172:175], v[56:59], v[80:83], v[172:175]
  v_mfma_f32_16x16x32_bf16 v[172:175], v[60:63], v[84:87], v[172:175]
  v_mfma_f32_16x16x32_bf16 v[176:179], v[56:59], v[88:91], v[176:179]
  v_mfma_f32_16x16x32_bf16 v[176:179], v[60:63], v[92:95], v[176:179]
  v_mfma_f32_16x16x32_bf16 v[180:183], v[56:59], v[96:99], v[180:183]
  v_mfma_f32_16x16x32_bf16 v[180:183], v[60:63], v[100:103], v[180:183]
  v_mfma_f32_16x16x32_bf16 v[184:187], v[56:59], v[104:107], v[184:187]
  v_mfma_f32_16x16x32_bf16 v[184:187], v[60:63], v[108:111], v[184:187]
  v_mfma_f32_16x16x32_bf16 v[200:203], v[64:67], v[104:107], v[200:203]
  v_mfma_f32_16x16x32_bf16 v[200:203], v[68:71], v[108:111], v[200:203]
  v_mfma_f32_16x16x32_bf16 v[196:199], v[64:67], v[96:99], v[196:199]
  v_mfma_f32_16x16x32_bf16 v[196:199], v[68:71], v[100:103], v[196:199]
  v_mfma_f32_16x16x32_bf16 v[192:195], v[64:67], v[88:91], v[192:195]
  v_mfma_f32_16x16x32_bf16 v[192:195], v[68:71], v[92:95], v[192:195]
  v_mfma_f32_16x16x32_bf16 v[188:191], v[64:67], v[80:83], v[188:191]
  v_mfma_f32_16x16x32_bf16 v[188:191], v[68:71], v[84:87], v[188:191]
  v_mfma_f32_16x16x32_bf16 v[204:207], v[72:75], v[80:83], v[204:207]
  v_mfma_f32_16x16x32_bf16 v[204:207], v[76:79], v[84:87], v[204:207]
  v_mfma_f32_16x16x32_bf16 v[208:211], v[72:75], v[88:91], v[208:211]
  v_mfma_f32_16x16x32_bf16 v[208:211], v[76:79], v[92:95], v[208:211]
  v_mfma_f32_16x16x32_bf16 v[212:215], v[72:75], v[96:99], v[212:215]
  v_mfma_f32_16x16x32_bf16 v[212:215], v[76:79], v[100:103], v[212:215]
  v_mfma_f32_16x16x32_bf16 v[216:219], v[72:75], v[104:107], v[216:219]
  s_setprio 2
  s_barrier
  v_mfma_f32_16x16x32_bf16 v[216:219], v[76:79], v[108:111], v[216:219]
  ds_read_b64_tr_b16 v[40:41], v1 offset:40960
  s_add_u32 m0, s75, 0
  s_nop 0
  buffer_load_dwordx4 v29, s[44:47], s74 offen offset:0 lds
  ds_read_b64_tr_b16 v[42:43], v1 offset:43520
  ds_read_b64_tr_b16 v[44:45], v6 offset:0
  ds_read_b64_tr_b16 v[46:47], v6 offset:2560
  ds_read_b64_tr_b16 v[48:49], v2 offset:40960
  buffer_load_dwordx4 v30, s[44:47], s74 offen offset:1024 lds
  ds_read_b64_tr_b16 v[50:51], v2 offset:43520
  ds_read_b64_tr_b16 v[52:53], v7 offset:0
  ds_read_b64_tr_b16 v[54:55], v7 offset:2560
  ds_read_b64_tr_b16 v[56:57], v3 offset:40960
  buffer_load_dwordx4 v31, s[44:47], s74 offen offset:2048 lds
  ds_read_b64_tr_b16 v[58:59], v3 offset:43520
  ds_read_b64_tr_b16 v[60:61], v8 offset:0
  ds_read_b64_tr_b16 v[62:63], v8 offset:2560
  ds_read_b64_tr_b16 v[64:65], v4 offset:40960
  buffer_load_dwordx4 v32, s[44:47], s74 offen offset:3072 lds
  ds_read_b64_tr_b16 v[66:67], v4 offset:43520
  ds_read_b64_tr_b16 v[68:69], v9 offset:0
  ds_read_b64_tr_b16 v[70:71], v9 offset:2560
  ds_read_b128 v[80:83], v11 offset:0
  s_add_u32 m0, m0, 4096
  s_nop 0
  buffer_load_dwordx4 v33, s[44:47], s74 offen offset:0 lds
  s_add_u32 s74, s74, 212992
  ds_read_b128 v[84:87], v12 offset:0
  ds_read_b128 v[88:91], v11 offset:2048
  ds_read_b128 v[92:95], v12 offset:2048
  ds_read_b128 v[96:99], v11 offset:4096
  v_lshl_add_u32 v34, v241, 7, v15
  v_lshl_add_u32 v28, v25, 7, v14
  s_add_u32 m0, s76, 8192
  s_nop 0
  buffer_load_dwordx4 v28, s[32:35], 0 offen lds
  ds_read_b128 v[100:103], v12 offset:4096
  ds_read_b128 v[104:107], v11 offset:6144
  ds_read_b128 v[108:111], v12 offset:6144
  ds_read_b64_tr_b16 v[72:73], v5 offset:40960
  s_add_u32 m0, m0, 1024
  s_nop 0
  buffer_load_dwordx4 v34, s[32:35], 0 offen lds
  ds_read_b64_tr_b16 v[74:75], v5 offset:43520
  ds_read_b64_tr_b16 v[76:77], v10 offset:0
  ds_read_b64_tr_b16 v[78:79], v10 offset:2560
  s_waitcnt vmcnt(7) lgkmcnt(0)
  s_barrier
  s_setprio 0
  v_mfma_f32_16x16x32_bf16 v[140:143], v[40:43], v[80:83], v[140:143]
  v_mfma_f32_16x16x32_bf16 v[140:143], v[44:47], v[84:87], v[140:143]
  v_mfma_f32_16x16x32_bf16 v[144:147], v[40:43], v[88:91], v[144:147]
  v_mfma_f32_16x16x32_bf16 v[144:147], v[44:47], v[92:95], v[144:147]
  v_mfma_f32_16x16x32_bf16 v[148:151], v[40:43], v[96:99], v[148:151]
  v_mfma_f32_16x16x32_bf16 v[148:151], v[44:47], v[100:103], v[148:151]
  v_mfma_f32_16x16x32_bf16 v[152:155], v[40:43], v[104:107], v[152:155]
  v_mfma_f32_16x16x32_bf16 v[152:155], v[44:47], v[108:111], v[152:155]
  v_mfma_f32_16x16x32_bf16 v[168:171], v[48:51], v[104:107], v[168:171]
  v_mfma_f32_16x16x32_bf16 v[168:171], v[52:55], v[108:111], v[168:171]
  v_mfma_f32_16x16x32_bf16 v[164:167], v[48:51], v[96:99], v[164:167]
  v_mfma_f32_16x16x32_bf16 v[164:167], v[52:55], v[100:103], v[164:167]
  v_mfma_f32_16x16x32_bf16 v[160:163], v[48:51], v[88:91], v[160:163]
  v_mfma_f32_16x16x32_bf16 v[160:163], v[52:55], v[92:95], v[160:163]
  v_mfma_f32_16x16x32_bf16 v[156:159], v[48:51], v[80:83], v[156:159]
  v_mfma_f32_16x16x32_bf16 v[156:159], v[52:55], v[84:87], v[156:159]
  v_mfma_f32_16x16x32_bf16 v[172:175], v[56:59], v[80:83], v[172:175]
  v_mfma_f32_16x16x32_bf16 v[172:175], v[60:63], v[84:87], v[172:175]
  v_mfma_f32_16x16x32_bf16 v[176:179], v[56:59], v[88:91], v[176:179]
  v_mfma_f32_16x16x32_bf16 v[176:179], v[60:63], v[92:95], v[176:179]
  v_mfma_f32_16x16x32_bf16 v[180:183], v[56:59], v[96:99], v[180:183]
  v_mfma_f32_16x16x32_bf16 v[180:183], v[60:63], v[100:103], v[180:183]
  v_mfma_f32_16x16x32_bf16 v[184:187], v[56:59], v[104:107], v[184:187]
  v_mfma_f32_16x16x32_bf16 v[184:187], v[60:63], v[108:111], v[184:187]
  v_mfma_f32_16x16x32_bf16 v[200:203], v[64:67], v[104:107], v[200:203]
  v_mfma_f32_16x16x32_bf16 v[200:203], v[68:71], v[108:111], v[200:203]
  v_mfma_f32_16x16x32_bf16 v[196:199], v[64:67], v[96:99], v[196:199]
  v_mfma_f32_16x16x32_bf16 v[196:199], v[68:71], v[100:103], v[196:199]
  v_mfma_f32_16x16x32_bf16 v[192:195], v[64:67], v[88:91], v[192:195]
  v_mfma_f32_16x16x32_bf16 v[192:195], v[68:71], v[92:95], v[192:195]
  v_mfma_f32_16x16x32_bf16 v[188:191], v[64:67], v[80:83], v[188:191]
  v_mfma_f32_16x16x32_bf16 v[188:191], v[68:71], v[84:87], v[188:191]
  v_mfma_f32_16x16x32_bf16 v[204:207], v[72:75], v[80:83], v[204:207]
  v_mfma_f32_16x16x32_bf16 v[204:207], v[76:79], v[84:87], v[204:207]
  v_mfma_f32_16x16x32_bf16 v[208:211], v[72:75], v[88:91], v[208:211]
  v_mfma_f32_16x16x32_bf16 v[208:211], v[76:79], v[92:95], v[208:211]
  v_mfma_f32_16x16x32_bf16 v[212:215], v[72:75], v[96:99], v[212:215]
  v_mfma_f32_16x16x32_bf16 v[212:215], v[76:79], v[100:103], v[212:215]
  v_mfma_f32_16x16x32_bf16 v[216:219], v[72:75], v[104:107], v[216:219]
  s_setprio 2
  s_barrier
  v_mfma_f32_16x16x32_bf16 v[216:219], v[76:79], v[108:111], v[216:219]
  ds_read_b64_tr_b16 v[40:41], v6 offset:20480
  s_add_u32 m0, s75, 40960
  s_nop 0
  buffer_load_dwordx4 v29, s[44:47], s74 offen offset:0 lds
  ds_read_b64_tr_b16 v[42:43], v6 offset:23040
  ds_read_b64_tr_b16 v[44:45], v6 offset:40960
  ds_read_b64_tr_b16 v[46:47], v6 offset:43520
  ds_read_b64_tr_b16 v[48:49], v7 offset:20480
  buffer_load_dwordx4 v30, s[44:47], s74 offen offset:1024 lds
  ds_read_b64_tr_b16 v[50:51], v7 offset:23040
  ds_read_b64_tr_b16 v[52:53], v7 offset:40960
  ds_read_b64_tr_b16 v[54:55], v7 offset:43520
  ds_read_b64_tr_b16 v[56:57], v8 offset:20480
  buffer_load_dwordx4 v31, s[44:47], s74 offen offset:2048 lds
  ds_read_b64_tr_b16 v[58:59], v8 offset:23040
  ds_read_b64_tr_b16 v[60:61], v8 offset:40960
  ds_read_b64_tr_b16 v[62:63], v8 offset:43520
  ds_read_b64_tr_b16 v[64:65], v9 offset:20480
  buffer_load_dwordx4 v32, s[44:47], s74 offen offset:3072 lds
  ds_read_b64_tr_b16 v[66:67], v9 offset:23040
  ds_read_b64_tr_b16 v[68:69], v9 offset:40960
  ds_read_b64_tr_b16 v[70:71], v9 offset:43520
  ds_read_b128 v[80:83], v11 offset:8192
  s_add_u32 m0, m0, 4096
  s_nop 0
  buffer_load_dwordx4 v33, s[44:47], s74 offen offset:0 lds
  s_add_u32 s74, s74, 212992
  ds_read_b128 v[84:87], v12 offset:8192
  ds_read_b128 v[88:91], v11 offset:10240
  ds_read_b128 v[92:95], v12 offset:10240
  ds_read_b128 v[96:99], v11 offset:12288
  v_lshl_add_u32 v34, v242, 7, v15
  v_lshl_add_u32 v28, v26, 7, v14
  s_add_u32 m0, s76, 0
  s_nop 0
  buffer_load_dwordx4 v28, s[32:35], 0 offen lds
  ds_read_b128 v[100:103], v12 offset:12288
  ds_read_b128 v[104:107], v11 offset:14336
  ds_read_b128 v[108:111], v12 offset:14336
  ds_read_b64_tr_b16 v[72:73], v10 offset:20480
  s_add_u32 m0, m0, 1024
  s_nop 0
  buffer_load_dwordx4 v34, s[32:35], 0 offen lds
  ds_read_b64_tr_b16 v[74:75], v10 offset:23040
  ds_read_b64_tr_b16 v[76:77], v10 offset:40960
  ds_read_b64_tr_b16 v[78:79], v10 offset:43520
  buffer_load_dwordx3 v[24:26], v13, s[28:31], s73 offen offset:0
  buffer_load_dwordx3 v[240:242], v13, s[28:31], s73 offen offset:832
  s_add_u32 s73, s73, 12
  s_waitcnt vmcnt(9) lgkmcnt(0)
  s_barrier
  s_setprio 0
  v_mfma_f32_16x16x32_bf16 v[140:143], v[40:43], v[80:83], v[140:143]
  s_add_u32 s72, s72, 1
  v_mfma_f32_16x16x32_bf16 v[140:143], v[44:47], v[84:87], v[140:143]
  v_mfma_f32_16x16x32_bf16 v[144:147], v[40:43], v[88:91], v[144:147]
  v_mfma_f32_16x16x32_bf16 v[144:147], v[44:47], v[92:95], v[144:147]
  v_mfma_f32_16x16x32_bf16 v[148:151], v[40:43], v[96:99], v[148:151]
  v_mfma_f32_16x16x32_bf16 v[148:151], v[44:47], v[100:103], v[148:151]
  v_mfma_f32_16x16x32_bf16 v[152:155], v[40:43], v[104:107], v[152:155]
  v_mfma_f32_16x16x32_bf16 v[152:155], v[44:47], v[108:111], v[152:155]
  v_mfma_f32_16x16x32_bf16 v[168:171], v[48:51], v[104:107], v[168:171]
  v_mfma_f32_16x16x32_bf16 v[168:171], v[52:55], v[108:111], v[168:171]
  v_mfma_f32_16x16x32_bf16 v[164:167], v[48:51], v[96:99], v[164:167]
  v_mfma_f32_16x16x32_bf16 v[164:167], v[52:55], v[100:103], v[164:167]
  v_mfma_f32_16x16x32_bf16 v[160:163], v[48:51], v[88:91], v[160:163]
  v_mfma_f32_16x16x32_bf16 v[160:163], v[52:55], v[92:95], v[160:163]
  v_mfma_f32_16x16x32_bf16 v[156:159], v[48:51], v[80:83], v[156:159]
  v_mfma_f32_16x16x32_bf16 v[156:159], v[52:55], v[84:87], v[156:159]
  v_mfma_f32_16x16x32_bf16 v[172:175], v[56:59], v[80:83], v[172:175]
  v_mfma_f32_16x16x32_bf16 v[172:175], v[60:63], v[84:87], v[172:175]
  v_mfma_f32_16x16x32_bf16 v[176:179], v[56:59], v[88:91], v[176:179]
  v_mfma_f32_16x16x32_bf16 v[176:179], v[60:63], v[92:95], v[176:179]
  s_cmp_lt_u32 s72, 4
  v_mfma_f32_16x16x32_bf16 v[180:183], v[56:59], v[96:99], v[180:183]
  v_mfma_f32_16x16x32_bf16 v[180:183], v[60:63], v[100:103], v[180:183]
  v_mfma_f32_16x16x32_bf16 v[184:187], v[56:59], v[104:107], v[184:187]
  v_mfma_f32_16x16x32_bf16 v[184:187], v[60:63], v[108:111], v[184:187]
  v_mfma_f32_16x16x32_bf16 v[200:203], v[64:67], v[104:107], v[200:203]
  v_mfma_f32_16x16x32_bf16 v[200:203], v[68:71], v[108:111], v[200:203]
  v_mfma_f32_16x16x32_bf16 v[196:199], v[64:67], v[96:99], v[196:199]
  v_mfma_f32_16x16x32_bf16 v[196:199], v[68:71], v[100:103], v[196:199]
  v_mfma_f32_16x16x32_bf16 v[192:195], v[64:67], v[88:91], v[192:195]
  v_mfma_f32_16x16x32_bf16 v[192:195], v[68:71], v[92:95], v[192:195]
  v_mfma_f32_16x16x32_bf16 v[188:191], v[64:67], v[80:83], v[188:191]
  v_mfma_f32_16x16x32_bf16 v[188:191], v[68:71], v[84:87], v[188:191]
  v_mfma_f32_16x16x32_bf16 v[204:207], v[72:75], v[80:83], v[204:207]
  v_mfma_f32_16x16x32_bf16 v[204:207], v[76:79], v[84:87], v[204:207]
  v_mfma_f32_16x16x32_bf16 v[208:211], v[72:75], v[88:91], v[208:211]
  v_mfma_f32_16x16x32_bf16 v[208:211], v[76:79], v[92:95], v[208:211]
  v_mfma_f32_16x16x32_bf16 v[212:215], v[72:75], v[96:99], v[212:215]
  v_mfma_f32_16x16x32_bf16 v[212:215], v[76:79], v[100:103], v[212:215]
  v_mfma_f32_16x16x32_bf16 v[216:219], v[72:75], v[104:107], v[216:219]
  s_setprio 2
  s_barrier
  v_mfma_f32_16x16x32_bf16 v[216:219], v[76:79], v[108:111], v[216:219]
  s_cbranch_scc1 L_dnn_loop0
  ds_read_b64_tr_b16 v[40:41], v1 offset:0
  v_lshl_add_u32 v34, v20, 7, v15
  v_lshl_add_u32 v28, v16, 7, v14
  s_add_u32 m0, s76, 8192
  s_nop 0
  buffer_load_dwordx4 v28, s[32:35], 0 offen lds
  ds_read_b64_tr_b16 v[42:43], v1 offset:2560
  ds_read_b64_tr_b16 v[44:45], v1 offset:20480
  ds_read_b64_tr_b16 v[46:47], v1 offset:23040
  ds_read_b64_tr_b16 v[48:49], v2 offset:0
  ds_read_b64_tr_b16 v[50:51], v2 offset:2560
  ds_read_b64_tr_b16 v[52:53], v2 offset:20480
  ds_read_b64_tr_b16 v[54:55], v2 offset:23040
  ds_read_b64_tr_b16 v[56:57], v3 offset:0
  ds_read_b64_tr_b16 v[58:59], v3 offset:2560
  ds_read_b64_tr_b16 v[60:61], v3 offset:20480
  ds_read_b64_tr_b16 v[62:63], v3 offset:23040
  ds_read_b64_tr_b16 v[64:65], v4 offset:0
  ds_read_b64_tr_b16 v[66:67], v4 offset:2560
  ds_read_b64_tr_b16 v[68:69], v4 offset:20480
  ds_read_b64_tr_b16 v[70:71], v4 offset:23040
  ds_read_b128 v[80:83], v11 offset:0
  s_add_u32 m0, m0, 1024
  s_nop 0
  buffer_load_dwordx4 v34, s[32:35], 0 offen lds
  ds_read_b128 v[84:87], v12 offset:0
  ds_read_b128 v[88:91], v11 offset:2048
  ds_read_b128 v[92:95], v12 offset:2048
  ds_read_b128 v[96:99], v11 offset:4096
  ds_read_b128 v[100:103], v12 offset:4096
  ds_read_b128 v[104:107], v11 offset:6144
  ds_read_b128 v[108:111], v12 offset:6144
  ds_read_b64_tr_b16 v[72:73], v5 offset:0
  ds_read_b64_tr_b16 v[74:75], v5 offset:2560
  ds_read_b64_tr_b16 v[76:77], v5 offset:20480
  ds_read_b64_tr_b16 v[78:79], v5 offset:23040
  ds_read_b64 v[220:221], v35 offset:640
  ds_read_b64 v[222:223], v35 offset:672
  ds_read_b64 v[224:225], v35 offset:704
  ds_read_b64 v[226:227], v35 offset:736
  ds_read_b64 v[228:229], v35 offset:768
  s_mov_b32 s60, s24
  s_and_b32 s61, s25, 0xffff
  s_mov_b32 s62, 268435456
  s_mov_b32 s63, 0x20000
  s_mov_b32 s64, s22
  s_and_b32 s65, s23, 0xffff
  s_mov_b32 s66, 256
  s_mov_b32 s67, 0x20000
  v_lshlrev_b32 v28, 2, v0
  s_mov_b64 exec, 0xff
  s_mov_b32 s81, 0x80000
  buffer_load_dword v255, v28, s[60:63], s81 offen
  buffer_load_dword v37, v28, s[64:67], 0 offen offset:128 sc1
  s_mov_b64 exec, -1
  v_mov_b32 v28, 0
  s_waitcnt vmcnt(6) lgkmcnt(0)
  s_barrier
  s_setprio 0
  v_mfma_f32_16x16x32_bf16 v[140:143], v[40:43], v[80:83], v[140:143]
  v_mov_b32 v232, 0xc0135761
  v_mov_b32 v233, 0xc0135761
  v_mfma_f32_16x16x32_bf16 v[140:143], v[44:47], v[84:87], v[140:143]
  v_mov_b32 v234, 0xbdd2d3e8
  v_mov_b32 v235, 0xbdd2d3e8
  v_mfma_f32_16x16x32_bf16 v[144:147], v[40:43], v[88:91], v[144:147]
  v_mov_b32 v236, 0xc2b40000
  v_mov_b32 v237, 0xc2b40000
  v_mfma_f32_16x16x32_bf16 v[144:147], v[44:47], v[92:95], v[144:147]
  v_lshlrev_b32 v112, 16, v220
  v_and_b32 v113, 0xffff0000, v220
  v_mfma_f32_16x16x32_bf16 v[148:151], v[40:43], v[96:99], v[148:151]
  v_lshlrev_b32 v114, 16, v221
  v_and_b32 v115, 0xffff0000, v221
  v_mfma_f32_16x16x32_bf16 v[148:151], v[44:47], v[100:103], v[148:151]
  v_lshlrev_b32 v116, 16, v222
  v_and_b32 v117, 0xffff0000, v222
  v_mfma_f32_16x16x32_bf16 v[152:155], v[40:43], v[104:107], v[152:155]
  v_lshlrev_b32 v118, 16, v223
  v_and_b32 v119, 0xffff0000, v223
  v_mfma_f32_16x16x32_bf16 v[152:155], v[44:47], v[108:111], v[152:155]
  v_lshlrev_b32 v120, 16, v224
  v_and_b32 v121, 0xffff0000, v224
  v_mfma_f32_16x16x32_bf16 v[168:171], v[48:51], v[104:107], v[168:171]
  v_lshlrev_b32 v122, 16, v225
  v_and_b32 v123, 0xffff0000, v225
  v_mfma_f32_16x16x32_bf16 v[168:171], v[52:55], v[108:111], v[168:171]
  v_lshlrev_b32 v124, 16, v226
  v_mfma_f32_16x16x32_bf16 v[164:167], v[48:51], v[96:99], v[164:167]
  v_and_b32 v125, 0xffff0000, v226
  v_lshlrev_b32 v126, 16, v227
  v_mfma_f32_16x16x32_bf16 v[164:167], v[52:55], v[100:103], v[164:167]
  v_and_b32 v127, 0xffff0000, v227
  v_lshlrev_b32 v128, 16, v228
  v_mfma_f32_16x16x32_bf16 v[160:163], v[48:51], v[88:91], v[160:163]
  v_and_b32 v129, 0xffff0000, v228
  v_lshlrev_b32 v130, 16, v229
  v_mfma_f32_16x16x32_bf16 v[160:163], v[52:55], v[92:95], v[160:163]
  v_and_b32 v131, 0xffff0000, v229
  v_mov_b32 v239, 0x21800000
  v_mfma_f32_16x16x32_bf16 v[156:159], v[48:51], v[80:83], v[156:159]
  v_mov_b32 v238, 0x30800000
  v_max3_f32 v239, v239, abs(v112), abs(v113)
  v_mfma_f32_16x16x32_bf16 v[156:159], v[52:55], v[84:87], v[156:159]
  v_max3_f32 v239, v239, abs(v114), abs(v115)
  v_max3_f32 v239, v239, abs(v116), abs(v117)
  v_mfma_f32_16x16x32_bf16 v[172:175], v[56:59], v[80:83], v[172:175]
  v_max3_f32 v239, v239, abs(v118), abs(v119)
  v_max3_f32 v239, v239, abs(v120), abs(v121)
  v_mfma_f32_16x16x32_bf16 v[172:175], v[60:63], v[84:87], v[172:175]
  v_max3_f32 v239, v239, abs(v122), abs(v123)
  v_max3_f32 v239, v239, abs(v124), abs(v125)
  v_mfma_f32_16x16x32_bf16 v[176:179], v[56:59], v[88:91], v[176:179]
  v_max3_f32 v239, v239, abs(v126), abs(v127)
  v_mfma_f32_16x16x32_bf16 v[176:179], v[60:63], v[92:95], v[176:179]
  v_max3_f32 v239, v239, abs(v128), abs(v129)
  v_max3_f32 v239, v239, abs(v130), abs(v131)
  v_mfma_f32_16x16x32_bf16 v[180:183], v[56:59], v[96:99], v[180:183]
  v_and_b32 v239, 0x7f800000, v239
  v_mul_f32 v239, 0x22000000, v239
  v_mfma_f32_16x16x32_bf16 v[180:183], v[60:63], v[100:103], v[180:183]
  v_rcp_f32 v112, v112
  v_mfma_f32_16x16x32_bf16 v[184:187], v[56:59], v[104:107], v[184:187]
  v_rcp_f32 v113, v113
  v_mfma_f32_16x16x32_bf16 v[184:187], v[60:63], v[108:111], v[184:187]
  v_rcp_f32 v114, v114
  v_mfma_f32_16x16x32_bf16 v[200:203], v[64:67], v[104:107], v[200:203]
  v_rcp_f32 v115, v115
  v_mfma_f32_16x16x32_bf16 v[200:203], v[68:71], v[108:111], v[200:203]
  v_rcp_f32 v116, v116
  v_mfma_f32_16x16x32_bf16 v[196:199], v[64:67], v[96:99], v[196:199]
  v_rcp_f32 v117, v117
  v_mfma_f32_16x16x32_bf16 v[196:199], v[68:71], v[100:103], v[196:199]
  v_rcp_f32 v118, v118
  v_mfma_f32_16x16x32_bf16 v[192:195], v[64:67], v[88:91], v[192:195]
  v_rcp_f32 v119, v119
  v_mfma_f32_16x16x32_bf16 v[192:195], v[68:71], v[92:95], v[192:195]
  v_rcp_f32 v120, v120
  v_mfma_f32_16x16x32_bf16 v[188:191], v[64:67], v[80:83], v[188:191]
  v_rcp_f32 v121, v121
  v_mfma_f32_16x16x32_bf16 v[188:191], v[68:71], v[84:87], v[188:191]
  v_rcp_f32 v122, v122
  v_mfma_f32_16x16x32_bf16 v[204:207], v[72:75], v[80:83], v[204:207]
  v_rcp_f32 v123, v123
  v_mfma_f32_16x16x32_bf16 v[204:207], v[76:79], v[84:87], v[204:207]
  v_rcp_f32 v124, v124
  v_mfma_f32_16x16x32_bf16 v[208:211], v[72:75], v[88:91], v[208:211]
  v_rcp_f32 v125, v125
  v_mfma_f32_16x16x32_bf16 v[208:211], v[76:79], v[92:95], v[208:211]
  v_rcp_f32 v126, v126
  v_mfma_f32_16x16x32_bf16 v[212:215], v[72:75], v[96:99], v[212:215]
  v_rcp_f32 v127, v127
  v_mfma_f32_16x16x32_bf16 v[212:215], v[76:79], v[100:103], v[212:215]
  v_mfma_f32_16x16x32_bf16 v[216:219], v[72:75], v[104:107], v[216:219]
  s_setprio 2
  s_barrier
  v_mfma_f32_16x16x32_bf16 v[216:219], v[76:79], v[108:111], v[216:219]
  ds_read_b64_tr_b16 v[40:41], v1 offset:40960
  ds_read_b64_tr_b16 v[42:43], v1 offset:43520
  ds_read_b64_tr_b16 v[44:45], v6 offset:0
  ds_read_b64_tr_b16 v[46:47], v6 offset:2560
  ds_read_b64_tr_b16 v[48:49], v2 offset:40960
  ds_read_b64_tr_b16 v[50:51], v2 offset:43520
  ds_read_b64_tr_b16 v[52:53], v7 offset:0
  ds_read_b64_tr_b16 v[54:55], v7 offset:2560
  ds_read_b64_tr_b16 v[56:57], v3 offset:40960
  ds_read_b64_tr_b16 v[58:59], v3 offset:43520
  ds_read_b64_tr_b16 v[60:61], v8 offset:0
  ds_read_b64_tr_b16 v[62:63], v8 offset:2560
  ds_read_b64_tr_b16 v[64:65], v4 offset:40960
  ds_read_b64_tr_b16 v[66:67], v4 offset:43520
  ds_read_b64_tr_b16 v[68:69], v9 offset:0
  ds_read_b64_tr_b16 v[70:71], v9 offset:2560
  ds_read_b128 v[80:83], v11 offset:8192
  ds_read_b128 v[84:87], v12 offset:8192
  ds_read_b128 v[88:91], v11 offset:10240
  ds_read_b128 v[92:95], v12 offset:10240
  ds_read_b128 v[96:99], v11 offset:12288
  ds_read_b128 v[100:103], v12 offset:12288
  ds_read_b128 v[104:107], v11 offset:14336
  ds_read_b128 v[108:111], v12 offset:14336
  ds_read_b64_tr_b16 v[72:73], v5 offset:40960
  ds_read_b64_tr_b16 v[74:75], v5 offset:43520
  ds_read_b64_tr_b16 v[76:77], v10 offset:0
  ds_read_b64_tr_b16 v[78:79], v10 offset:2560
  s_waitcnt vmcnt(2) lgkmcnt(0)
  s_barrier
  s_setprio 0
  v_mfma_f32_16x16x32_bf16 v[140:143], v[40:43], v[80:83], v[140:143]
  v_rcp_f32 v128, v128
  v_mfma_f32_16x16x32_bf16 v[140:143], v[44:47], v[84:87], v[140:143]
  v_rcp_f32 v129, v129
  v_mfma_f32_16x16x32_bf16 v[144:147], v[40:43], v[88:91], v[144:147]
  v_rcp_f32 v130, v130
  v_mfma_f32_16x16x32_bf16 v[144:147], v[44:47], v[92:95], v[144:147]
  v_rcp_f32 v131, v131
  v_mfma_f32_16x16x32_bf16 v[148:151], v[40:43], v[96:99], v[148:151]
  v_mul_f32 v112, v239, v112
  v_mfma_f32_16x16x32_bf16 v[148:151], v[44:47], v[100:103], v[148:151]
  v_mul_f32 v113, v239, v113
  v_mul_f32 v114, v239, v114
  v_mfma_f32_16x16x32_bf16 v[152:155], v[40:43], v[104:107], v[152:155]
  v_mul_f32 v115, v239, v115
  v_mul_f32 v116, v239, v116
  v_mfma_f32_16x16x32_bf16 v[152:155], v[44:47], v[108:111], v[152:155]
  v_mul_f32 v117, v239, v117
  v_mul_f32 v118, v239, v118
  v_mfma_f32_16x16x32_bf16 v[168:171], v[48:51], v[104:107], v[168:171]
  v_mul_f32 v119, v239, v119
  v_mul_f32 v120, v239, v120
  v_mfma_f32_16x16x32_bf16 v[168:171], v[52:55], v[108:111], v[168:171]
  v_mul_f32 v121, v239, v121
  v_mfma_f32_16x16x32_bf16 v[164:167], v[48:51], v[96:99], v[164:167]
  v_mul_f32 v122, v239, v122
  v_mul_f32 v123, v239, v123
  v_mfma_f32_16x16x32_bf16 v[164:167], v[52:55], v[100:103], v[164:167]
  v_mul_f32 v124, v239, v124
  v_mul_f32 v125, v239, v125
  v_mfma_f32_16x16x32_bf16 v[160:163], v[48:51], v[88:91], v[160:163]
  v_mul_f32 v126, v239, v126
  v_mul_f32 v127, v239, v127
  v_mfma_f32_16x16x32_bf16 v[160:163], v[52:55], v[92:95], v[160:163]
  v_mul_f32 v128, v239, v128
  v_mul_f32 v129, v239, v129
  v_mfma_f32_16x16x32_bf16 v[156:159], v[48:51], v[80:83], v[156:159]
  v_mul_f32 v130, v239, v130
  v_mfma_f32_16x16x32_bf16 v[156:159], v[52:55], v[84:87], v[156:159]
  v_mul_f32 v131, v239, v131
  v_med3_f32 v112, v112, -v238, v238
  v_mfma_f32_16x16x32_bf16 v[172:175], v[56:59], v[80:83], v[172:175]
  v_med3_f32 v113, v113, -v238, v238
  v_med3_f32 v114, v114, -v238, v238
  v_mfma_f32_16x16x32_bf16 v[172:175], v[60:63], v[84:87], v[172:175]
  v_med3_f32 v115, v115, -v238, v238
  v_med3_f32 v116, v116, -v238, v238
  v_mfma_f32_16x16x32_bf16 v[176:179], v[56:59], v[88:91], v[176:179]
  v_med3_f32 v117, v117, -v238, v238
  v_mfma_f32_16x16x32_bf16 v[176:179], v[60:63], v[92:95], v[176:179]
  v_med3_f32 v118, v118, -v238, v238
  v_med3_f32 v119, v119, -v238, v238
  v_mfma_f32_16x16x32_bf16 v[180:183], v[56:59], v[96:99], v[180:183]
  v_med3_f32 v120, v120, -v238, v238
  v_med3_f32 v121, v121, -v238, v238
  v_mfma_f32_16x16x32_bf16 v[180:183], v[60:63], v[100:103], v[180:183]
  v_med3_f32 v122, v122, -v238, v238
  v_med3_f32 v123, v123, -v238, v238
  v_mfma_f32_16x16x32_bf16 v[184:187], v[56:59], v[104:107], v[184:187]
  v_med3_f32 v124, v124, -v238, v238
  v_med3_f32 v125, v125, -v238, v238
  v_mfma_f32_16x16x32_bf16 v[184:187], v[60:63], v[108:111], v[184:187]
  v_med3_f32 v126, v126, -v238, v238
  v_mfma_f32_16x16x32_bf16 v[200:203], v[64:67], v[104:107], v[200:203]
  v_med3_f32 v127, v127, -v238, v238
  v_med3_f32 v128, v128, -v238, v238
  v_mfma_f32_16x16x32_bf16 v[200:203], v[68:71], v[108:111], v[200:203]
  v_med3_f32 v129, v129, -v238, v238
  v_med3_f32 v130, v130, -v238, v238
  v_mfma_f32_16x16x32_bf16 v[196:199], v[64:67], v[96:99], v[196:199]
  v_med3_f32 v131, v131, -v238, v238
  v_mul_f32 v132, 0x6c800000, v112
  v_mfma_f32_16x16x32_bf16 v[196:199], v[68:71], v[100:103], v[196:199]
  v_mul_f32 v133, 0x6c800000, v113
  v_mul_f32 v134, 0x6c800000, v114
  v_mfma_f32_16x16x32_bf16 v[192:195], v[64:67], v[88:91], v[192:195]
  v_mul_f32 v135, 0x6c800000, v115
  v_mfma_f32_16x16x32_bf16 v[192:195], v[68:71], v[92:95], v[192:195]
  v_mul_f32 v136, 0x6c800000, v116
  v_mul_f32 v137, 0x6c800000, v117
  v_mfma_f32_16x16x32_bf16 v[188:191], v[64:67], v[80:83], v[188:191]
  v_mul_f32 v138, 0x6c800000, v118
  v_mul_f32 v139, 0x6c800000, v119
  v_mfma_f32_16x16x32_bf16 v[188:191], v[68:71], v[84:87], v[188:191]
  v_mul_f32 v220, 0x6c800000, v120
  v_mul_f32 v221, 0x6c800000, v121
  v_mfma_f32_16x16x32_bf16 v[204:207], v[72:75], v[80:83], v[204:207]
  v_mul_f32 v222, 0x6c800000, v122
  v_mul_f32 v223, 0x6c800000, v123
  v_mfma_f32_16x16x32_bf16 v[204:207], v[76:79], v[84:87], v[204:207]
  v_mul_f32 v224, 0x6c800000, v124
  v_mfma_f32_16x16x32_bf16 v[208:211], v[72:75], v[88:91], v[208:211]
  v_mul_f32 v225, 0x6c800000, v125
  v_mul_f32 v226, 0x6c800000, v126
  v_mfma_f32_16x16x32_bf16 v[208:211], v[76:79], v[92:95], v[208:211]
  v_mul_f32 v227, 0x6c800000, v127
  v_mul_f32 v228, 0x6c800000, v128
  v_mfma_f32_16x16x32_bf16 v[212:215], v[72:75], v[96:99], v[212:215]
  v_mul_f32 v229, 0x6c800000, v129
  v_mul_f32 v230, 0x6c800000, v130
  v_mfma_f32_16x16x32_bf16 v[212:215], v[76:79], v[100:103], v[212:215]
  v_mul_f32 v231, 0x6c800000, v131
  v_mfma_f32_16x16x32_bf16 v[216:219], v[72:75], v[104:107], v[216:219]
  s_setprio 2
  s_barrier
  v_mfma_f32_16x16x32_bf16 v[216:219], v[76:79], v[108:111], v[216:219]
  s_setprio 0
  s_branch L_epi
L_dnn_h1:
  v_lshl_add_u32 v34, v49, 7, v15
  v_lshl_add_u32 v28, v45, 7, v14
  s_add_u32 m0, s76, 8192
  s_nop 0
  buffer_load_dwordx4 v28, s[32:35], 0 offen lds
  s_add_u32 m0, m0, 1024
  s_nop 0
  buffer_load_dwordx4 v34, s[32:35], 0 offen lds
  s_add_u32 m0, s75, 40960
  s_nop 0
  buffer_load_dwordx4 v29, s[44:47], s74 offen offset:0 lds
  buffer_load_dwordx4 v30, s[44:47], s74 offen offset:1024 lds
  buffer_load_dwordx4 v31, s[44:47], s74 offen offset:2048 lds
  buffer_load_dwordx4 v32, s[44:47], s74 offen offset:3072 lds
  s_add_u32 m0, m0, 4096
  s_nop 0
  buffer_load_dwordx4 v33, s[44:47], s74 offen offset:0 lds
  s_add_u32 s74, s74, 212992
  s_waitcnt vmcnt(13)
  s_waitcnt vmcnt(10) lgkmcnt(0)
  s_barrier
  buffer_load_dwordx3 v[24:26], v13, s[28:31], s73 offen offset:0
  buffer_load_dwordx3 v[240:242], v13, s[28:31], s73 offen offset:832
  s_add_u32 s73, s73, 12
  s_barrier
L_dnn_loop1:
  ds_read_b64_tr_b16 v[40:41], v1 offset:0
  s_add_u32 m0, s75, 81920
  s_nop 0
  buffer_load_dwordx4 v29, s[44:47], s74 offen offset:0 lds
  ds_read_b64_tr_b16 v[42:43], v1 offset:2560
  ds_read_b64_tr_b16 v[44:45], v1 offset:20480
  ds_read_b64_tr_b16 v[46:47], v1 offset:23040
  ds_read_b64_tr_b16 v[48:49], v2 offset:0
  buffer_load_dwordx4 v30, s[44:47], s74 offen offset:1024 lds
  ds_read_b64_tr_b16 v[50:51], v2 offset:2560
  ds_read_b64_tr_b16 v[52:53], v2 offset:20480
  ds_read_b64_tr_b16 v[54:55], v2 offset:23040
  ds_read_b64_tr_b16 v[56:57], v3 offset:0
  buffer_load_dwordx4 v31, s[44:47], s74 offen offset:2048 lds
  ds_read_b64_tr_b16 v[58:59], v3 offset:2560
  ds_read_b64_tr_b16 v[60:61], v3 offset:20480
  ds_read_b64_tr_b16 v[62:63], v3 offset:23040
  ds_read_b64_tr_b16 v[64:65], v4 offset:0
  buffer_load_dwordx4 v32, s[44:47], s74 offen offset:3072 lds
  ds_read_b64_tr_b16 v[66:67], v4 offset:2560
  ds_read_b64_tr_b16 v[68:69], v4 offset:20480
  ds_read_b64_tr_b16 v[70:71], v4 offset:23040
  ds_read_b128 v[80:83], v11 offset:0
  s_add_u32 m0, m0, 4096
  s_nop 0
  buffer_load_dwordx4 v33, s[44:47], s74 offen offset:0 lds
  s_add_u32 s74, s74, 212992
  ds_read_b128 v[84:87], v12 offset:0
  ds_read_b128 v[88:91], v11 offset:2048
  ds_read_b128 v[92:95], v12 offset:2048
  ds_read_b128 v[96:99], v11 offset:4096
  s_waitcnt vmcnt(14)
  v_lshl_add_u32 v34, v20, 7, v15
  v_lshl_add_u32 v28, v16, 7, v14
  s_add_u32 m0, s76, 0
  s_nop 0
  buffer_load_dwordx4 v28, s[32:35], 0 offen lds
  ds_read_b128 v[100:103], v12 offset:4096
  ds_read_b128 v[104:107], v11 offset:6144
  ds_read_b128 v[108:111], v12 offset:6144
  ds_read_b64_tr_b16 v[72:73], v5 offset:0
  s_add_u32 m0, m0, 1024
  s_nop 0
  buffer_load_dwordx4 v34, s[32:35], 0 offen lds
  ds_read_b64_tr_b16 v[74:75], v5 offset:2560
  ds_read_b64_tr_b16 v[76:77], v5 offset:20480
  ds_read_b64_tr_b16 v[78:79], v5 offset:23040
  s_waitcnt vmcnt(9) lgkmcnt(0)
  s_waitcnt vmcnt(9)
  s_barrier
  s_setprio 0
  v_mfma_f32_16x16x32_bf16 v[140:143], v[40:43], v[80:83], v[140:143]
  v_mfma_f32_16x16x32_bf16 v[140:143], v[44:47], v[84:87], v[140:143]
  v_mfma_f32_16x16x32_bf16 v[144:147], v[40:43], v[88:91], v[144:147]
  v_mfma_f32_16x16x32_bf16 v[144:147], v[44:47], v[92:95], v[144:147]
  v_mfma_f32_16x16x32_bf16 v[148:151], v[40:43], v[96:99], v[148:151]
  v_mfma_f32_16x16x32_bf16 v[148:151], v[44:47], v[100:103], v[148:151]
  v_mfma_f32_16x16x32_bf16 v[152:155], v[40:43], v[104:107], v[152:155]
  v_mfma_f32_16x16x32_bf16 v[152:155], v[44:47], v[108:111], v[152:155]
  v_mfma_f32_16x16x32_bf16 v[168:171], v[48:51], v[104:107], v[168:171]
  v_mfma_f32_16x16x32_bf16 v[168:171], v[52:55], v[108:111], v[168:171]
  v_mfma_f32_16x16x32_bf16 v[164:167], v[48:51], v[96:99], v[164:167]
  v_mfma_f32_16x16x32_bf16 v[164:167], v[52:55], v[100:103], v[164:167]
  v_mfma_f32_16x16x32_bf16 v[160:163], v[48:51], v[88:91], v[160:163]
  v_mfma_f32_16x16x32_bf16 v[160:163], v[52:55], v[92:95], v[160:163]
  v_mfma_f32_16x16x32_bf16 v[156:159], v[48:51], v[80:83], v[156:159]
  v_mfma_f32_16x16x32_bf16 v[156:159], v[52:55], v[84:87], v[156:159]
  v_mfma_f32_16x16x32_bf16 v[172:175], v[56:59], v[80:83], v[172:175]
  v_mfma_f32_16x16x32_bf16 v[172:175], v[60:63], v[84:87], v[172:175]
  v_mfma_f32_16x16x32_bf16 v[176:179], v[56:59], v[88:91], v[176:179]
  v_mfma_f32_16x16x32_bf16 v[176:179], v[60:63], v[92:95], v[176:179]
  v_mfma_f32_16x16x32_bf16 v[180:183], v[56:59], v[96:99], v[180:183]
  v_mfma_f32_16x16x32_bf16 v[180:183], v[60:63], v[100:103], v[180:183]
  v_mfma_f32_16x16x32_bf16 v[184:187], v[56:59], v[104:107], v[184:187]
  v_mfma_f32_16x16x32_bf16 v[184:187], v[60:63], v[108:111], v[184:187]
  v_mfma_f32_16x16x32_bf16 v[200:203], v[64:67], v[104:107], v[200:203]
  v_mfma_f32_16x16x32_bf16 v[200:203], v[68:71], v[108:111], v[200:203]
  v_mfma_f32_16x16x32_bf16 v[196:199], v[64:67], v[96:99], v[196:199]
  v_mfma_f32_16x16x32_bf16 v[196:199], v[68:71], v[100:103], v[196:199]
  v_mfma_f32_16x16x32_bf16 v[192:195], v[64:67], v[88:91], v[192:195]
  v_mfma_f32_16x16x32_bf16 v[192:195], v[68:71], v[92:95], v[192:195]
  v_mfma_f32_16x16x32_bf16 v[188:191], v[64:67], v[80:83], v[188:191]
  v_mfma_f32_16x16x32_bf16 v[188:191], v[68:71], v[84:87], v[188:191]
  v_mfma_f32_16x16x32_bf16 v[204:207], v[72:75], v[80:83], v[204:207]
  v_mfma_f32_16x16x32_bf16 v[204:207], v[76:79], v[84:87], v[204:207]
  v_mfma_f32_16x16x32_bf16 v[208:211], v[72:75], v[88:91], v[208:211]
  v_mfma_f32_16x16x32_bf16 v[208:211], v[76:79], v[92:95], v[208:211]
  v_mfma_f32_16x16x32_bf16 v[212:215], v[72:75], v[96:99], v[212:215]
  v_mfma_f32_16x16x32_bf16 v[212:215], v[76:79], v[100:103], v[212:215]
  v_mfma_f32_16x16x32_bf16 v[216:219], v[72:75], v[104:107], v[216:219]
  s_setprio 2
  s_barrier
  v_mfma_f32_16x16x32_bf16 v[216:219], v[76:79], v[108:111], v[216:219]
  ds_read_b64_tr_b16 v[40:41], v1 offset:40960
  s_add_u32 m0, s75, 0
  s_nop 0
  buffer_load_dwordx4 v29, s[44:47], s74 offen offset:0 lds
  ds_read_b64_tr_b16 v[42:43], v1 offset:43520
  ds_read_b64_tr_b16 v[44:45], v6 offset:0
  ds_read_b64_tr_b16 v[46:47], v6 offset:2560
  ds_read_b64_tr_b16 v[48:49], v2 offset:40960
  buffer_load_dwordx4 v30, s[44:47], s74 offen offset:1024 lds
  ds_read_b64_tr_b16 v[50:51], v2 offset:43520
  ds_read_b64_tr_b16 v[52:53], v7 offset:0
  ds_read_b64_tr_b16 v[54:55], v7 offset:2560
  ds_read_b64_tr_b16 v[56:57], v3 offset:40960
  buffer_load_dwordx4 v31, s[44:47], s74 offen offset:2048 lds
  ds_read_b64_tr_b16 v[58:59], v3 offset:43520
  ds_read_b64_tr_b16 v[60:61], v8 offset:0
  ds_read_b64_tr_b16 v[62:63], v8 offset:2560
  ds_read_b64_tr_b16 v[64:65], v4 offset:40960
  buffer_load_dwordx4 v32, s[44:47], s74 offen offset:3072 lds
  ds_read_b64_tr_b16 v[66:67], v4 offset:43520
  ds_read_b64_tr_b16 v[68:69], v9 offset:0
  ds_read_b64_tr_b16 v[70:71], v9 offset:2560
  ds_read_b128 v[80:83], v11 offset:8192
  s_add_u32 m0, m0, 4096
  s_nop 0
  buffer_load_dwordx4 v33, s[44:47], s74 offen offset:0 lds
  s_add_u32 s74, s74, 212992
  ds_read_b128 v[84:87], v12 offset:8192
  ds_read_b128 v[88:91], v11 offset:10240
  ds_read_b128 v[92:95], v12 offset:10240
  ds_read_b128 v[96:99], v11 offset:12288
  v_lshl_add_u32 v34, v21, 7, v15
  v_lshl_add_u32 v28, v17, 7, v14
  s_add_u32 m0, s76, 8192
  s_nop 0
  buffer_load_dwordx4 v28, s[32:35], 0 offen lds
  ds_read_b128 v[100:103], v12 offset:12288
  ds_read_b128 v[104:107], v11 offset:14336
  ds_read_b128 v[108:111], v12 offset:14336
  ds_read_b64_tr_b16 v[72:73], v5 offset:40960
  s_add_u32 m0, m0, 1024
  s_nop 0
  buffer_load_dwordx4 v34, s[32:35], 0 offen lds
  ds_read_b64_tr_b16 v[74:75], v5 offset:43520
  ds_read_b64_tr_b16 v[76:77], v10 offset:0
  ds_read_b64_tr_b16 v[78:79], v10 offset:2560
  s_waitcnt vmcnt(7) lgkmcnt(0)
  s_barrier
  s_setprio 0
  v_mfma_f32_16x16x32_bf16 v[140:143], v[40:43], v[80:83], v[140:143]
  v_mfma_f32_16x16x32_bf16 v[140:143], v[44:47], v[84:87], v[140:143]
  v_mfma_f32_16x16x32_bf16 v[144:147], v[40:43], v[88:91], v[144:147]
  v_mfma_f32_16x16x32_bf16 v[144:147], v[44:47], v[92:95], v[144:147]
  v_mfma_f32_16x16x32_bf16 v[148:151], v[40:43], v[96:99], v[148:151]
  v_mfma_f32_16x16x32_bf16 v[148:151], v[44:47], v[100:103], v[148:151]
  v_mfma_f32_16x16x32_bf16 v[152:155], v[40:43], v[104:107], v[152:155]
  v_mfma_f32_16x16x32_bf16 v[152:155], v[44:47], v[108:111], v[152:155]
  v_mfma_f32_16x16x32_bf16 v[168:171], v[48:51], v[104:107], v[168:171]
  v_mfma_f32_16x16x32_bf16 v[168:171], v[52:55], v[108:111], v[168:171]
  v_mfma_f32_16x16x32_bf16 v[164:167], v[48:51], v[96:99], v[164:167]
  v_mfma_f32_16x16x32_bf16 v[164:167], v[52:55], v[100:103], v[164:167]
  v_mfma_f32_16x16x32_bf16 v[160:163], v[48:51], v[88:91], v[160:163]
  v_mfma_f32_16x16x32_bf16 v[160:163], v[52:55], v[92:95], v[160:163]
  v_mfma_f32_16x16x32_bf16 v[156:159], v[48:51], v[80:83], v[156:159]
  v_mfma_f32_16x16x32_bf16 v[156:159], v[52:55], v[84:87], v[156:159]
  v_mfma_f32_16x16x32_bf16 v[172:175], v[56:59], v[80:83], v[172:175]
  v_mfma_f32_16x16x32_bf16 v[172:175], v[60:63], v[84:87], v[172:175]
  v_mfma_f32_16x16x32_bf16 v[176:179], v[56:59], v[88:91], v[176:179]
  v_mfma_f32_16x16x32_bf16 v[176:179], v[60:63], v[92:95], v[176:179]
  v_mfma_f32_16x16x32_bf16 v[180:183], v[56:59], v[96:99], v[180:183]
  v_mfma_f32_16x16x32_bf16 v[180:183], v[60:63], v[100:103], v[180:183]
  v_mfma_f32_16x16x32_bf16 v[184:187], v[56:59], v[104:107], v[184:187]
  v_mfma_f32_16x16x32_bf16 v[184:187], v[60:63], v[108:111], v[184:187]
  v_mfma_f32_16x16x32_bf16 v[200:203], v[64:67], v[104:107], v[200:203]
  v_mfma_f32_16x16x32_bf16 v[200:203], v[68:71], v[108:111], v[200:203]
  v_mfma_f32_16x16x32_bf16 v[196:199], v[64:67], v[96:99], v[196:199]
  v_mfma_f32_16x16x32_bf16 v[196:199], v[68:71], v[100:103], v[196:199]
  v_mfma_f32_16x16x32_bf16 v[192:195], v[64:67], v[88:91], v[192:195]
  v_mfma_f32_16x16x32_bf16 v[192:195], v[68:71], v[92:95], v[192:195]
  v_mfma_f32_16x16x32_bf16 v[188:191], v[64:67], v[80:83], v[188:191]
  v_mfma_f32_16x16x32_bf16 v[188:191], v[68:71], v[84:87], v[188:191]
  v_mfma_f32_16x16x32_bf16 v[204:207], v[72:75], v[80:83], v[204:207]
  v_mfma_f32_16x16x32_bf16 v[204:207], v[76:79], v[84:87], v[204:207]
  v_mfma_f32_16x16x32_bf16 v[208:211], v[72:75], v[88:91], v[208:211]
  v_mfma_f32_16x16x32_bf16 v[208:211], v[76:79], v[92:95], v[208:211]
  v_mfma_f32_16x16x32_bf16 v[212:215], v[72:75], v[96:99], v[212:215]
  v_mfma_f32_16x16x32_bf16 v[212:215], v[76:79], v[100:103], v[212:215]
  v_mfma_f32_16x16x32_bf16 v[216:219], v[72:75], v[104:107], v[216:219]
  s_setprio 2
  s_barrier
  v_mfma_f32_16x16x32_bf16 v[216:219], v[76:79], v[108:111], v[216:219]
  ds_read_b64_tr_b16 v[40:41], v6 offset:20480
  s_add_u32 m0, s75, 40960
  s_nop 0
  buffer_load_dwordx4 v29, s[44:47], s74 offen offset:0 lds
  ds_read_b64_tr_b16 v[42:43], v6 offset:23040
  ds_read_b64_tr_b16 v[44:45], v6 offset:40960
  ds_read_b64_tr_b16 v[46:47], v6 offset:43520
  ds_read_b64_tr_b16 v[48:49], v7 offset:20480
  buffer_load_dwordx4 v30, s[44:47], s74 offen offset:1024 lds
  ds_read_b64_tr_b16 v[50:51], v7 offset:23040
  ds_read_b64_tr_b16 v[52:53], v7 offset:40960
  ds_read_b64_tr_b16 v[54:55], v7 offset:43520
  ds_read_b64_tr_b16 v[56:57], v8 offset:20480
  buffer_load_dwordx4 v31, s[44:47], s74 offen offset:2048 lds
  ds_read_b64_tr_b16 v[58:59], v8 offset:23040
  ds_read_b64_tr_b16 v[60:61], v8 offset:40960
  ds_read_b64_tr_b16 v[62:63], v8 offset:43520
  ds_read_b64_tr_b16 v[64:65], v9 offset:20480
  buffer_load_dwordx4 v32, s[44:47], s74 offen offset:3072 lds
  ds_read_b64_tr_b16 v[66:67], v9 offset:23040
  ds_read_b64_tr_b16 v[68:69], v9 offset:40960
  ds_read_b64_tr_b16 v[70:71], v9 offset:43520
  ds_read_b128 v[80:83], v11 offset:0
  s_add_u32 m0, m0, 4096
  s_nop 0
  buffer_load_dwordx4 v33, s[44:47], s74 offen offset:0 lds
  s_add_u32 s74, s74, 212992
  ds_read_b128 v[84:87], v12 offset:0
  ds_read_b128 v[88:91], v11 offset:2048
  ds_read_b128 v[92:95], v12 offset:2048
  ds_read_b128 v[96:99], v11 offset:4096
  v_lshl_add_u32 v34, v22, 7, v15
  v_lshl_add_u32 v28, v18, 7, v14
  s_add_u32 m0, s76, 0
  s_nop 0
  buffer_load_dwordx4 v28, s[32:35], 0 offen lds
  ds_read_b128 v[100:103], v12 offset:4096
  ds_read_b128 v[104:107], v11 offset:6144
  ds_read_b128 v[108:111], v12 offset:6144
  ds_read_b64_tr_b16 v[72:73], v10 offset:20480
  s_add_u32 m0, m0, 1024
  s_nop 0
  buffer_load_dwordx4 v34, s[32:35], 0 offen lds
  ds_read_b64_tr_b16 v[74:75], v10 offset:23040
  ds_read_b64_tr_b16 v[76:77], v10 offset:40960
  ds_read_b64_tr_b16 v[78:79], v10 offset:43520
  buffer_load_dwordx3 v[16:18], v13, s[28:31], s73 offen offset:0
  buffer_load_dwordx3 v[20:22], v13, s[28:31], s73 offen offset:832
  s_add_u32 s73, s73, 12
  s_waitcnt vmcnt(9) lgkmcnt(0)
  s_barrier
  s_setprio 0
  v_mfma_f32_16x16x32_bf16 v[140:143], v[40:43], v[80:83], v[140:143]
  v_mfma_f32_16x16x32_bf16 v[140:143], v[44:47], v[84:87], v[140:143]
  v_mfma_f32_16x16x32_bf16 v[144:147], v[40:43], v[88:91], v[144:147]
  v_mfma_f32_16x16x32_bf16 v[144:147], v[44:47], v[92:95], v[144:147]
  v_mfma_f32_16x16x32_bf16 v[148:151], v[40:43], v[96:99], v[148:151]
  v_mfma_f32_16x16x32_bf16 v[148:151], v[44:47], v[100:103], v[148:151]
  v_mfma_f32_16x16x32_bf16 v[152:155], v[40:43], v[104:107], v[152:155]
  v_mfma_f32_16x16x32_bf16 v[152:155], v[44:47], v[108:111], v[152:155]
  v_mfma_f32_16x16x32_bf16 v[168:171], v[48:51], v[104:107], v[168:171]
  v_mfma_f32_16x16x32_bf16 v[168:171], v[52:55], v[108:111], v[168:171]
  v_mfma_f32_16x16x32_bf16 v[164:167], v[48:51], v[96:99], v[164:167]
  v_mfma_f32_16x16x32_bf16 v[164:167], v[52:55], v[100:103], v[164:167]
  v_mfma_f32_16x16x32_bf16 v[160:163], v[48:51], v[88:91], v[160:163]
  v_mfma_f32_16x16x32_bf16 v[160:163], v[52:55], v[92:95], v[160:163]
  v_mfma_f32_16x16x32_bf16 v[156:159], v[48:51], v[80:83], v[156:159]
  v_mfma_f32_16x16x32_bf16 v[156:159], v[52:55], v[84:87], v[156:159]
  v_mfma_f32_16x16x32_bf16 v[172:175], v[56:59], v[80:83], v[172:175]
  v_mfma_f32_16x16x32_bf16 v[172:175], v[60:63], v[84:87], v[172:175]
  v_mfma_f32_16x16x32_bf16 v[176:179], v[56:59], v[88:91], v[176:179]
  v_mfma_f32_16x16x32_bf16 v[176:179], v[60:63], v[92:95], v[176:179]
  v_mfma_f32_16x16x32_bf16 v[180:183], v[56:59], v[96:99], v[180:183]
  v_mfma_f32_16x16x32_bf16 v[180:183], v[60:63], v[100:103], v[180:183]
  v_mfma_f32_16x16x32_bf16 v[184:187], v[56:59], v[104:107], v[184:187]
  v_mfma_f32_16x16x32_bf16 v[184:187], v[60:63], v[108:111], v[184:187]
  v_mfma_f32_16x16x32_bf16 v[200:203], v[64:67], v[104:107], v[200:203]
  v_mfma_f32_16x16x32_bf16 v[200:203], v[68:71], v[108:111], v[200:203]
  v_mfma_f32_16x16x32_bf16 v[196:199], v[64:67], v[96:99], v[196:199]
  v_mfma_f32_16x16x32_bf16 v[196:199], v[68:71], v[100:103], v[196:199]
  v_mfma_f32_16x16x32_bf16 v[192:195], v[64:67], v[88:91], v[192:195]
  v_mfma_f32_16x16x32_bf16 v[192:195], v[68:71], v[92:95], v[192:195]
  v_mfma_f32_16x16x32_bf16 v[188:191], v[64:67], v[80:83], v[188:191]
  v_mfma_f32_16x16x32_bf16 v[188:191], v[68:71], v[84:87], v[188:191]
  v_mfma_f32_16x16x32_bf16 v[204:207], v[72:75], v[80:83], v[204:207]
  v_mfma_f32_16x16x32_bf16 v[204:207], v[76:79], v[84:87], v[204:207]
  v_mfma_f32_16x16x32_bf16 v[208:211], v[72:75], v[88:91], v[208:211]
  v_mfma_f32_16x16x32_bf16 v[208:211], v[76:79], v[92:95], v[208:211]
  v_mfma_f32_16x16x32_bf16 v[212:215], v[72:75], v[96:99], v[212:215]
  v_mfma_f32_16x16x32_bf16 v[212:215], v[76:79], v[100:103], v[212:215]
  v_mfma_f32_16x16x32_bf16 v[216:219], v[72:75], v[104:107], v[216:219]
  s_setprio 2
  s_barrier
  v_mfma_f32_16x16x32_bf16 v[216:219], v[76:79], v[108:111], v[216:219]
  ds_read_b64_tr_b16 v[40:41], v1 offset:0
  s_add_u32 m0, s75, 81920
  s_nop 0
  buffer_load_dwordx4 v29, s[44:47], s74 offen offset:0 lds
  ds_read_b64_tr_b16 v[42:43], v1 offset:2560
  ds_read_b64_tr_b16 v[44:45], v1 offset:20480
  ds_read_b64_tr_b16 v[46:47], v1 offset:23040
  ds_read_b64_tr_b16 v[48:49], v2 offset:0
  buffer_load_dwordx4 v30, s[44:47], s74 offen offset:1024 lds
  ds_read_b64_tr_b16 v[50:51], v2 offset:2560
  ds_read_b64_tr_b16 v[52:53], v2 offset:20480
  ds_read_b64_tr_b16 v[54:55], v2 offset:23040
  ds_read_b64_tr_b16 v[56:57], v3 offset:0
  buffer_load_dwordx4 v31, s[44:47], s74 offen offset:2048 lds
  ds_read_b64_tr_b16 v[58:59], v3 offset:2560
  ds_read_b64_tr_b16 v[60:61], v3 offset:20480
  ds_read_b64_tr_b16 v[62:63], v3 offset:23040
  ds_read_b64_tr_b16 v[64:65], v4 offset:0
  buffer_load_dwordx4 v32, s[44:47], s74 offen offset:3072 lds
  ds_read_b64_tr_b16 v[66:67], v4 offset:2560
  ds_read_b64_tr_b16 v[68:69], v4 offset:20480
  ds_read_b64_tr_b16 v[70:71], v4 offset:23040
  ds_read_b128 v[80:83], v11 offset:8192
  s_add_u32 m0, m0, 4096
  s_nop 0
  buffer_load_dwordx4 v33, s[44:47], s74 offen offset:0 lds
  s_add_u32 s74, s74, 212992
  ds_read_b128 v[84:87], v12 offset:8192
  ds_read_b128 v[88:91], v11 offset:10240
  ds_read_b128 v[92:95], v12 offset:10240
  ds_read_b128 v[96:99], v11 offset:12288
  v_lshl_add_u32 v34, v240, 7, v15
  v_lshl_add_u32 v28, v24, 7, v14
  s_add_u32 m0, s76, 8192
  s_nop 0
  buffer_load_dwordx4 v28, s[32:35], 0 offen lds
  ds_read_b128 v[100:103], v12 offset:12288
  ds_read_b128 v[104:107], v11 offset:14336
  ds_read_b128 v[108:111], v12 offset:14336
  ds_read_b64_tr_b16 v[72:73], v5 offset:0
  s_add_u32 m0, m0, 1024
  s_nop 0
  buffer_load_dwordx4 v34, s[32:35], 0 offen lds
  ds_read_b64_tr_b16 v[74:75], v5 offset:2560
  ds_read_b64_tr_b16 v[76:77], v5 offset:20480
  ds_read_b64_tr_b16 v[78:79], v5 offset:23040
  s_waitcnt vmcnt(9) lgkmcnt(0)
  s_barrier
  s_setprio 0
  v_mfma_f32_16x16x32_bf16 v[140:143], v[40:43], v[80:83], v[140:143]
  v_mfma_f32_16x16x32_bf16 v[140:143], v[44:47], v[84:87], v[140:143]
  v_mfma_f32_16x16x32_bf16 v[144:147], v[40:43], v[88:91], v[144:147]
  v_mfma_f32_16x16x32_bf16 v[144:147], v[44:47], v[92:95], v[144:147]
  v_mfma_f32_16x16x32_bf16 v[148:151], v[40:43], v[96:99], v[148:151]
  v_mfma_f32_16x16x32_bf16 v[148:151], v[44:47], v[100:103], v[148:151]
  v_mfma_f32_16x16x32_bf16 v[152:155], v[40:43], v[104:107], v[152:155]
  v_mfma_f32_16x16x32_bf16 v[152:155], v[44:47], v[108:111], v[152:155]
  v_mfma_f32_16x16x32_bf16 v[168:171], v[48:51], v[104:107], v[168:171]
  v_mfma_f32_16x16x32_bf16 v[168:171], v[52:55], v[108:111], v[168:171]
  v_mfma_f32_16x16x32_bf16 v[164:167], v[48:51], v[96:99], v[164:167]
  v_mfma_f32_16x16x32_bf16 v[164:167], v[52:55], v[100:103], v[164:167]
  v_mfma_f32_16x16x32_bf16 v[160:163], v[48:51], v[88:91], v[160:163]
  v_mfma_f32_16x16x32_bf16 v[160:163], v[52:55], v[92:95], v[160:163]
  v_mfma_f32_16x16x32_bf16 v[156:159], v[48:51], v[80:83], v[156:159]
  v_mfma_f32_16x16x32_bf16 v[156:159], v[52:55], v[84:87], v[156:159]
  v_mfma_f32_16x16x32_bf16 v[172:175], v[56:59], v[80:83], v[172:175]
  v_mfma_f32_16x16x32_bf16 v[172:175], v[60:63], v[84:87], v[172:175]
  v_mfma_f32_16x16x32_bf16 v[176:179], v[56:59], v[88:91], v[176:179]
  v_mfma_f32_16x16x32_bf16 v[176:179], v[60:63], v[92:95], v[176:179]
  v_mfma_f32_16x16x32_bf16 v[180:183], v[56:59], v[96:99], v[180:183]
  v_mfma_f32_16x16x32_bf16 v[180:183], v[60:63], v[100:103], v[180:183]
  v_mfma_f32_16x16x32_bf16 v[184:187], v[56:59], v[104:107], v[184:187]
  v_mfma_f32_16x16x32_bf16 v[184:187], v[60:63], v[108:111], v[184:187]
  v_mfma_f32_16x16x32_bf16 v[200:203], v[64:67], v[104:107], v[200:203]
  v_mfma_f32_16x16x32_bf16 v[200:203], v[68:71], v[108:111], v[200:203]
  v_mfma_f32_16x16x32_bf16 v[196:199], v[64:67], v[96:99], v[196:199]
  v_mfma_f32_16x16x32_bf16 v[196:199], v[68:71], v[100:103], v[196:199]
  v_mfma_f32_16x16x32_bf16 v[192:195], v[64:67], v[88:91], v[192:195]
  v_mfma_f32_16x16x32_bf16 v[192:195], v[68:71], v[92:95], v[192:195]
  v_mfma_f32_16x16x32_bf16 v[188:191], v[64:67], v[80:83], v[188:191]
  v_mfma_f32_16x16x32_bf16 v[188:191], v[68:71], v[84:87], v[188:191]
  v_mfma_f32_16x16x32_bf16 v[204:207], v[72:75], v[80:83], v[204:207]
  v_mfma_f32_16x16x32_bf16 v[204:207], v[76:79], v[84:87], v[204:207]
  v_mfma_f32_16x16x32_bf16 v[208:211], v[72:75], v[88:91], v[208:211]
  v_mfma_f32_16x16x32_bf16 v[208:211], v[76:79], v[92:95], v[208:211]
  v_mfma_f32_16x16x32_bf16 v[212:215], v[72:75], v[96:99], v[212:215]
  v_mfma_f32_16x16x32_bf16 v[212:215], v[76:79], v[100:103], v[212:215]
  v_mfma_f32_16x16x32_bf16 v[216:219], v[72:75], v[104:107], v[216:219]
  s_setprio 2
  s_barrier
  v_mfma_f32_16x16x32_bf16 v[216:219], v[76:79], v[108:111], v[216:219]
  ds_read_b64_tr_b16 v[40:41], v1 offset:40960
  s_add_u32 m0, s75, 0
  s_nop 0
  buffer_load_dwordx4 v29, s[44:47], s74 offen offset:0 lds
  ds_read_b64_tr_b16 v[42:43], v1 offset:43520
  ds_read_b64_tr_b16 v[44:45], v6 offset:0
  ds_read_b64_tr_b16 v[46:47], v6 offset:2560
  ds_read_b64_tr_b16 v[48:49], v2 offset:40960
  buffer_load_dwordx4 v30, s[44:47], s74 offen offset:1024 lds
  ds_read_b64_tr_b16 v[50:51], v2 offset:43520
  ds_read_b64_tr_b16 v[52:53], v7 offset:0
  ds_read_b64_tr_b16 v[54:55], v7 offset:2560
  ds_read_b64_tr_b16 v[56:57], v3 offset:40960
  buffer_load_dwordx4 v31, s[44:47], s74 offen offset:2048 lds
  ds_read_b64_tr_b16 v[58:59], v3 offset:43520
  ds_read_b64_tr_b16 v[60:61], v8 offset:0
  ds_read_b64_tr_b16 v[62:63], v8 offset:2560
  ds_read_b64_tr_b16 v[64:65], v4 offset:40960
  buffer_load_dwordx4 v32, s[44:47], s74 offen offset:3072 lds
  ds_read_b64_tr_b16 v[66:67], v4 offset:43520
  ds_read_b64_tr_b16 v[68:69], v9 offset:0
  ds_read_b64_tr_b16 v[70:71], v9 offset:2560
  ds_read_b128 v[80:83], v11 offset:0
  s_add_u32 m0, m0, 4096
  s_nop 0
  buffer_load_dwordx4 v33, s[44:47], s74 offen offset:0 lds
  s_add_u32 s74, s74, 212992
  ds_read_b128 v[84:87], v12 offset:0
  ds_read_b128 v[88:91], v11 offset:2048
  ds_read_b128 v[92:95], v12 offset:2048
  ds_read_b128 v[96:99], v11 offset:4096
  v_lshl_add_u32 v34, v241, 7, v15
  v_lshl_add_u32 v28, v25, 7, v14
  s_add_u32 m0, s76, 0
  s_nop 0
  buffer_load_dwordx4 v28, s[32:35], 0 offen lds
  ds_read_b128 v[100:103], v12 offset:4096
  ds_read_b128 v[104:107], v11 offset:6144
  ds_read_b128 v[108:111], v12 offset:6144
  ds_read_b64_tr_b16 v[72:73], v5 offset:40960
  s_add_u32 m0, m0, 1024
  s_nop 0
  buffer_load_dwordx4 v34, s[32:35], 0 offen lds
  ds_read_b64_tr_b16 v[74:75], v5 offset:43520
  ds_read_b64_tr_b16 v[76:77], v10 offset:0
  ds_read_b64_tr_b16 v[78:79], v10 offset:2560
  s_mov_b32 m0, 156288
  s_mov_b32 exec_hi, 0xff
  buffer_load_dwordx4 v37, s[52:55], s77 offen lds
  s_mov_b64 exec, -1
  s_waitcnt vmcnt(8) lgkmcnt(0)
  s_barrier
  s_setprio 0
  v_mfma_f32_16x16x32_bf16 v[140:143], v[40:43], v[80:83], v[140:143]
  v_mfma_f32_16x16x32_bf16 v[140:143], v[44:47], v[84:87], v[140:143]
  v_mfma_f32_16x16x32_bf16 v[144:147], v[40:43], v[88:91], v[144:147]
  v_mfma_f32_16x16x32_bf16 v[144:147], v[44:47], v[92:95], v[144:147]
  v_mfma_f32_16x16x32_bf16 v[148:151], v[40:43], v[96:99], v[148:151]
  v_mfma_f32_16x16x32_bf16 v[148:151], v[44:47], v[100:103], v[148:151]
  v_mfma_f32_16x16x32_bf16 v[152:155], v[40:43], v[104:107], v[152:155]
  v_mfma_f32_16x16x32_bf16 v[152:155], v[44:47], v[108:111], v[152:155]
  v_mfma_f32_16x16x32_bf16 v[168:171], v[48:51], v[104:107], v[168:171]
  v_mfma_f32_16x16x32_bf16 v[168:171], v[52:55], v[108:111], v[168:171]
  v_mfma_f32_16x16x32_bf16 v[164:167], v[48:51], v[96:99], v[164:167]
  v_mfma_f32_16x16x32_bf16 v[164:167], v[52:55], v[100:103], v[164:167]
  v_mfma_f32_16x16x32_bf16 v[160:163], v[48:51], v[88:91], v[160:163]
  v_mfma_f32_16x16x32_bf16 v[160:163], v[52:55], v[92:95], v[160:163]
  v_mfma_f32_16x16x32_bf16 v[156:159], v[48:51], v[80:83], v[156:159]
  v_mfma_f32_16x16x32_bf16 v[156:159], v[52:55], v[84:87], v[156:159]
  v_mfma_f32_16x16x32_bf16 v[172:175], v[56:59], v[80:83], v[172:175]
  v_mfma_f32_16x16x32_bf16 v[172:175], v[60:63], v[84:87], v[172:175]
  v_mfma_f32_16x16x32_bf16 v[176:179], v[56:59], v[88:91], v[176:179]
  v_mfma_f32_16x16x32_bf16 v[176:179], v[60:63], v[92:95], v[176:179]
  v_mfma_f32_16x16x32_bf16 v[180:183], v[56:59], v[96:99], v[180:183]
  v_mfma_f32_16x16x32_bf16 v[180:183], v[60:63], v[100:103], v[180:183]
  v_mfma_f32_16x16x32_bf16 v[184:187], v[56:59], v[104:107], v[184:187]
  v_mfma_f32_16x16x32_bf16 v[184:187], v[60:63], v[108:111], v[184:187]
  v_mfma_f32_16x16x32_bf16 v[200:203], v[64:67], v[104:107], v[200:203]
  v_mfma_f32_16x16x32_bf16 v[200:203], v[68:71], v[108:111], v[200:203]
  v_mfma_f32_16x16x32_bf16 v[196:199], v[64:67], v[96:99], v[196:199]
  v_mfma_f32_16x16x32_bf16 v[196:199], v[68:71], v[100:103], v[196:199]
  v_mfma_f32_16x16x32_bf16 v[192:195], v[64:67], v[88:91], v[192:195]
  v_mfma_f32_16x16x32_bf16 v[192:195], v[68:71], v[92:95], v[192:195]
  v_mfma_f32_16x16x32_bf16 v[188:191], v[64:67], v[80:83], v[188:191]
  v_mfma_f32_16x16x32_bf16 v[188:191], v[68:71], v[84:87], v[188:191]
  v_mfma_f32_16x16x32_bf16 v[204:207], v[72:75], v[80:83], v[204:207]
  v_mfma_f32_16x16x32_bf16 v[204:207], v[76:79], v[84:87], v[204:207]
  v_mfma_f32_16x16x32_bf16 v[208:211], v[72:75], v[88:91], v[208:211]
  v_mfma_f32_16x16x32_bf16 v[208:211], v[76:79], v[92:95], v[208:211]
  v_mfma_f32_16x16x32_bf16 v[212:215], v[72:75], v[96:99], v[212:215]
  v_mfma_f32_16x16x32_bf16 v[212:215], v[76:79], v[100:103], v[212:215]
  v_mfma_f32_16x16x32_bf16 v[216:219], v[72:75], v[104:107], v[216:219]
  s_setprio 2
  s_barrier
  v_mfma_f32_16x16x32_bf16 v[216:219], v[76:79], v[108:111], v[216:219]
  ds_read_b64_tr_b16 v[40:41], v6 offset:20480
  s_add_u32 m0, s75, 40960
  s_nop 0
  buffer_load_dwordx4 v29, s[44:47], s74 offen offset:0 lds
  ds_read_b64_tr_b16 v[42:43], v6 offset:23040
  ds_read_b64_tr_b16 v[44:45], v6 offset:40960
  ds_read_b64_tr_b16 v[46:47], v6 offset:43520
  ds_read_b64_tr_b16 v[48:49], v7 offset:20480
  buffer_load_dwordx4 v30, s[44:47], s74 offen offset:1024 lds
  ds_read_b64_tr_b16 v[50:51], v7 offset:23040
  ds_read_b64_tr_b16 v[52:53], v7 offset:40960
  ds_read_b64_tr_b16 v[54:55], v7 offset:43520
  ds_read_b64_tr_b16 v[56:57], v8 offset:20480
  buffer_load_dwordx4 v31, s[44:47], s74 offen offset:2048 lds
  ds_read_b64_tr_b16 v[58:59], v8 offset:23040
  ds_read_b64_tr_b16 v[60:61], v8 offset:40960
  ds_read_b64_tr_b16 v[62:63], v8 offset:43520
  ds_read_b64_tr_b16 v[64:65], v9 offset:20480
  buffer_load_dwordx4 v32, s[44:47], s74 offen offset:3072 lds
  ds_read_b64_tr_b16 v[66:67], v9 offset:23040
  ds_read_b64_tr_b16 v[68:69], v9 offset:40960
  ds_read_b64_tr_b16 v[70:71], v9 offset:43520
  ds_read_b128 v[80:83], v11 offset:8192
  s_add_u32 m0, m0, 4096
  s_nop 0
  buffer_load_dwordx4 v33, s[44:47], s74 offen offset:0 lds
  s_add_u32 s74, s74, 212992
  ds_read_b128 v[84:87], v12 offset:8192
  ds_read_b128 v[88:91], v11 offset:10240
  ds_read_b128 v[92:95], v12 offset:10240
  ds_read_b128 v[96:99], v11 offset:12288
  v_lshl_add_u32 v34, v242, 7, v15
  v_lshl_add_u32 v28, v26, 7, v14
  s_add_u32 m0, s76, 8192
  s_nop 0
  buffer_load_dwordx4 v28, s[32:35], 0 offen lds
  ds_read_b128 v[100:103], v12 offset:12288
  ds_read_b128 v[104:107], v11 offset:14336
  ds_read_b128 v[108:111], v12 offset:14336
  ds_read_b64_tr_b16 v[72:73], v10 offset:20480
  s_add_u32 m0, m0, 1024
  s_nop 0
  buffer_load_dwordx4 v34, s[32:35], 0 offen lds
  ds_read_b64_tr_b16 v[74:75], v10 offset:23040
  ds_read_b64_tr_b16 v[76:77], v10 offset:40960
  ds_read_b64_tr_b16 v[78:79], v10 offset:43520
  buffer_load_dwordx3 v[24:26], v13, s[28:31], s73 offen offset:0
  buffer_load_dwordx3 v[240:242], v13, s[28:31], s73 offen offset:832
  s_add_u32 s73, s73, 12
  s_waitcnt vmcnt(10) lgkmcnt(0)
  s_barrier
  s_setprio 0
  v_mfma_f32_16x16x32_bf16 v[140:143], v[40:43], v[80:83], v[140:143]
  s_add_u32 s72, s72, 1
  v_mfma_f32_16x16x32_bf16 v[140:143], v[44:47], v[84:87], v[140:143]
  v_mfma_f32_16x16x32_bf16 v[144:147], v[40:43], v[88:91], v[144:147]
  v_mfma_f32_16x16x32_bf16 v[144:147], v[44:47], v[92:95], v[144:147]
  v_mfma_f32_16x16x32_bf16 v[148:151], v[40:43], v[96:99], v[148:151]
  v_mfma_f32_16x16x32_bf16 v[148:151], v[44:47], v[100:103], v[148:151]
  v_mfma_f32_16x16x32_bf16 v[152:155], v[40:43], v[104:107], v[152:155]
  v_mfma_f32_16x16x32_bf16 v[152:155], v[44:47], v[108:111], v[152:155]
  v_mfma_f32_16x16x32_bf16 v[168:171], v[48:51], v[104:107], v[168:171]
  v_mfma_f32_16x16x32_bf16 v[168:171], v[52:55], v[108:111], v[168:171]
  v_mfma_f32_16x16x32_bf16 v[164:167], v[48:51], v[96:99], v[164:167]
  v_mfma_f32_16x16x32_bf16 v[164:167], v[52:55], v[100:103], v[164:167]
  v_mfma_f32_16x16x32_bf16 v[160:163], v[48:51], v[88:91], v[160:163]
  v_mfma_f32_16x16x32_bf16 v[160:163], v[52:55], v[92:95], v[160:163]
  v_mfma_f32_16x16x32_bf16 v[156:159], v[48:51], v[80:83], v[156:159]
  v_mfma_f32_16x16x32_bf16 v[156:159], v[52:55], v[84:87], v[156:159]
  v_mfma_f32_16x16x32_bf16 v[172:175], v[56:59], v[80:83], v[172:175]
  v_mfma_f32_16x16x32_bf16 v[172:175], v[60:63], v[84:87], v[172:175]
  v_mfma_f32_16x16x32_bf16 v[176:179], v[56:59], v[88:91], v[176:179]
  v_mfma_f32_16x16x32_bf16 v[176:179], v[60:63], v[92:95], v[176:179]
  s_cmp_lt_u32 s72, 4
  v_mfma_f32_16x16x32_bf16 v[180:183], v[56:59], v[96:99], v[180:183]
  v_mfma_f32_16x16x32_bf16 v[180:183], v[60:63], v[100:103], v[180:183]
  v_mfma_f32_16x16x32_bf16 v[184:187], v[56:59], v[104:107], v[184:187]
  v_mfma_f32_16x16x32_bf16 v[184:187], v[60:63], v[108:111], v[184:187]
  v_mfma_f32_16x16x32_bf16 v[200:203], v[64:67], v[104:107], v[200:203]
  v_mfma_f32_16x16x32_bf16 v[200:203], v[68:71], v[108:111], v[200:203]
  v_mfma_f32_16x16x32_bf16 v[196:199], v[64:67], v[96:99], v[196:199]
  v_mfma_f32_16x16x32_bf16 v[196:199], v[68:71], v[100:103], v[196:199]
  v_mfma_f32_16x16x32_bf16 v[192:195], v[64:67], v[88:91], v[192:195]
  v_mfma_f32_16x16x32_bf16 v[192:195], v[68:71], v[92:95], v[192:195]
  v_mfma_f32_16x16x32_bf16 v[188:191], v[64:67], v[80:83], v[188:191]
  v_mfma_f32_16x16x32_bf16 v[188:191], v[68:71], v[84:87], v[188:191]
  v_mfma_f32_16x16x32_bf16 v[204:207], v[72:75], v[80:83], v[204:207]
  v_mfma_f32_16x16x32_bf16 v[204:207], v[76:79], v[84:87], v[204:207]
  v_mfma_f32_16x16x32_bf16 v[208:211], v[72:75], v[88:91], v[208:211]
  v_mfma_f32_16x16x32_bf16 v[208:211], v[76:79], v[92:95], v[208:211]
  v_mfma_f32_16x16x32_bf16 v[212:215], v[72:75], v[96:99], v[212:215]
  v_mfma_f32_16x16x32_bf16 v[212:215], v[76:79], v[100:103], v[212:215]
  v_mfma_f32_16x16x32_bf16 v[216:219], v[72:75], v[104:107], v[216:219]
  s_setprio 2
  s_barrier
  v_mfma_f32_16x16x32_bf16 v[216:219], v[76:79], v[108:111], v[216:219]
  s_cbranch_scc1 L_dnn_loop1
  ds_read_b64_tr_b16 v[40:41], v1 offset:0
  ds_read_b64_tr_b16 v[42:43], v1 offset:2560
  ds_read_b64_tr_b16 v[44:45], v1 offset:20480
  ds_read_b64_tr_b16 v[46:47], v1 offset:23040
  ds_read_b64_tr_b16 v[48:49], v2 offset:0
  ds_read_b64_tr_b16 v[50:51], v2 offset:2560
  ds_read_b64_tr_b16 v[52:53], v2 offset:20480
  ds_read_b64_tr_b16 v[54:55], v2 offset:23040
  ds_read_b64_tr_b16 v[56:57], v3 offset:0
  ds_read_b64_tr_b16 v[58:59], v3 offset:2560
  ds_read_b64_tr_b16 v[60:61], v3 offset:20480
  ds_read_b64_tr_b16 v[62:63], v3 offset:23040
  ds_read_b64_tr_b16 v[64:65], v4 offset:0
  ds_read_b64_tr_b16 v[66:67], v4 offset:2560
  ds_read_b64_tr_b16 v[68:69], v4 offset:20480
  ds_read_b64_tr_b16 v[70:71], v4 offset:23040
  ds_read_b128 v[80:83], v11 offset:0
  ds_read_b128 v[84:87], v12 offset:0
  ds_read_b128 v[88:91], v11 offset:2048
  ds_read_b128 v[92:95], v12 offset:2048
  ds_read_b128 v[96:99], v11 offset:4096
  ds_read_b128 v[100:103], v12 offset:4096
  ds_read_b128 v[104:107], v11 offset:6144
  ds_read_b128 v[108:111], v12 offset:6144
  ds_read_b64_tr_b16 v[72:73], v5 offset:0
  ds_read_b64_tr_b16 v[74:75], v5 offset:2560
  ds_read_b64_tr_b16 v[76:77], v5 offset:20480
  ds_read_b64_tr_b16 v[78:79], v5 offset:23040
  ds_read_b64 v[220:221], v35 offset:640
  ds_read_b64 v[222:223], v35 offset:672
  ds_read_b64 v[224:225], v35 offset:704
  ds_read_b64 v[226:227], v35 offset:736
  ds_read_b64 v[228:229], v35 offset:768
  s_waitcnt vmcnt(2) lgkmcnt(0)
  s_barrier
  s_setprio 0
  v_mfma_f32_16x16x32_bf16 v[140:143], v[40:43], v[80:83], v[140:143]
  v_mov_b32 v232, 0xc0135761
  v_mov_b32 v233, 0xc0135761
  v_mfma_f32_16x16x32_bf16 v[140:143], v[44:47], v[84:87], v[140:143]
  v_mov_b32 v234, 0xbdd2d3e8
  v_mov_b32 v235, 0xbdd2d3e8
  v_mfma_f32_16x16x32_bf16 v[144:147], v[40:43], v[88:91], v[144:147]
  v_mov_b32 v236, 0xc2b40000
  v_mov_b32 v237, 0xc2b40000
  v_mfma_f32_16x16x32_bf16 v[144:147], v[44:47], v[92:95], v[144:147]
  v_lshlrev_b32 v112, 16, v220
  v_and_b32 v113, 0xffff0000, v220
  v_mfma_f32_16x16x32_bf16 v[148:151], v[40:43], v[96:99], v[148:151]
  v_lshlrev_b32 v114, 16, v221
  v_and_b32 v115, 0xffff0000, v221
  v_mfma_f32_16x16x32_bf16 v[148:151], v[44:47], v[100:103], v[148:151]
  v_lshlrev_b32 v116, 16, v222
  v_and_b32 v117, 0xffff0000, v222
  v_mfma_f32_16x16x32_bf16 v[152:155], v[40:43], v[104:107], v[152:155]
  v_lshlrev_b32 v118, 16, v223
  v_and_b32 v119, 0xffff0000, v223
  v_mfma_f32_16x16x32_bf16 v[152:155], v[44:47], v[108:111], v[152:155]
  v_lshlrev_b32 v120, 16, v224
  v_and_b32 v121, 0xffff0000, v224
  v_mfma_f32_16x16x32_bf16 v[168:171], v[48:51], v[104:107], v[168:171]
  v_lshlrev_b32 v122, 16, v225
  v_and_b32 v123, 0xffff0000, v225
  v_mfma_f32_16x16x32_bf16 v[168:171], v[52:55], v[108:111], v[168:171]
  v_lshlrev_b32 v124, 16, v226
  v_mfma_f32_16x16x32_bf16 v[164:167], v[48:51], v[96:99], v[164:167]
  v_and_b32 v125, 0xffff0000, v226
  v_lshlrev_b32 v126, 16, v227
  v_mfma_f32_16x16x32_bf16 v[164:167], v[52:55], v[100:103], v[164:167]
  v_and_b32 v127, 0xffff0000, v227
  v_lshlrev_b32 v128, 16, v228
  v_mfma_f32_16x16x32_bf16 v[160:163], v[48:51], v[88:91], v[160:163]
  v_and_b32 v129, 0xffff0000, v228
  v_lshlrev_b32 v130, 16, v229
  v_mfma_f32_16x16x32_bf16 v[160:163], v[52:55], v[92:95], v[160:163]
  v_and_b32 v131, 0xffff0000, v229
  v_mov_b32 v239, 0x21800000
  v_mfma_f32_16x16x32_bf16 v[156:159], v[48:51], v[80:83], v[156:159]
  v_mov_b32 v238, 0x30800000
  v_max3_f32 v239, v239, abs(v112), abs(v113)
  v_mfma_f32_16x16x32_bf16 v[156:159], v[52:55], v[84:87], v[156:159]
  v_max3_f32 v239, v239, abs(v114), abs(v115)
  v_max3_f32 v239, v239, abs(v116), abs(v117)
  v_mfma_f32_16x16x32_bf16 v[172:175], v[56:59], v[80:83], v[172:175]
  v_max3_f32 v239, v239, abs(v118), abs(v119)
  v_max3_f32 v239, v239, abs(v120), abs(v121)
  v_mfma_f32_16x16x32_bf16 v[172:175], v[60:63], v[84:87], v[172:175]
  v_max3_f32 v239, v239, abs(v122), abs(v123)
  v_max3_f32 v239, v239, abs(v124), abs(v125)
  v_mfma_f32_16x16x32_bf16 v[176:179], v[56:59], v[88:91], v[176:179]
  v_max3_f32 v239, v239, abs(v126), abs(v127)
  v_mfma_f32_16x16x32_bf16 v[176:179], v[60:63], v[92:95], v[176:179]
  v_max3_f32 v239, v239, abs(v128), abs(v129)
  v_max3_f32 v239, v239, abs(v130), abs(v131)
  v_mfma_f32_16x16x32_bf16 v[180:183], v[56:59], v[96:99], v[180:183]
  v_and_b32 v239, 0x7f800000, v239
  v_mul_f32 v239, 0x22000000, v239
  v_mfma_f32_16x16x32_bf16 v[180:183], v[60:63], v[100:103], v[180:183]
  v_rcp_f32 v112, v112
  v_mfma_f32_16x16x32_bf16 v[184:187], v[56:59], v[104:107], v[184:187]
  v_rcp_f32 v113, v113
  v_mfma_f32_16x16x32_bf16 v[184:187], v[60:63], v[108:111], v[184:187]
  v_rcp_f32 v114, v114
  v_mfma_f32_16x16x32_bf16 v[200:203], v[64:67], v[104:107], v[200:203]
  v_rcp_f32 v115, v115
  v_mfma_f32_16x16x32_bf16 v[200:203], v[68:71], v[108:111], v[200:203]
  v_rcp_f32 v116, v116
  v_mfma_f32_16x16x32_bf16 v[196:199], v[64:67], v[96:99], v[196:199]
  v_rcp_f32 v117, v117
  v_mfma_f32_16x16x32_bf16 v[196:199], v[68:71], v[100:103], v[196:199]
  v_rcp_f32 v118, v118
  v_mfma_f32_16x16x32_bf16 v[192:195], v[64:67], v[88:91], v[192:195]
  v_rcp_f32 v119, v119
  v_mfma_f32_16x16x32_bf16 v[192:195], v[68:71], v[92:95], v[192:195]
  v_rcp_f32 v120, v120
  v_mfma_f32_16x16x32_bf16 v[188:191], v[64:67], v[80:83], v[188:191]
  v_rcp_f32 v121, v121
  v_mfma_f32_16x16x32_bf16 v[188:191], v[68:71], v[84:87], v[188:191]
  v_rcp_f32 v122, v122
  v_mfma_f32_16x16x32_bf16 v[204:207], v[72:75], v[80:83], v[204:207]
  v_rcp_f32 v123, v123
  v_mfma_f32_16x16x32_bf16 v[204:207], v[76:79], v[84:87], v[204:207]
  v_rcp_f32 v124, v124
  v_mfma_f32_16x16x32_bf16 v[208:211], v[72:75], v[88:91], v[208:211]
  v_rcp_f32 v125, v125
  v_mfma_f32_16x16x32_bf16 v[208:211], v[76:79], v[92:95], v[208:211]
  v_rcp_f32 v126, v126
  v_mfma_f32_16x16x32_bf16 v[212:215], v[72:75], v[96:99], v[212:215]
  v_rcp_f32 v127, v127
  v_mfma_f32_16x16x32_bf16 v[212:215], v[76:79], v[100:103], v[212:215]
  v_mfma_f32_16x16x32_bf16 v[216:219], v[72:75], v[104:107], v[216:219]
  s_setprio 2
  s_barrier
  v_mfma_f32_16x16x32_bf16 v[216:219], v[76:79], v[108:111], v[216:219]
  ds_read_b64_tr_b16 v[40:41], v1 offset:40960
  ds_read_b64_tr_b16 v[42:43], v1 offset:43520
  ds_read_b64_tr_b16 v[44:45], v6 offset:0
  ds_read_b64_tr_b16 v[46:47], v6 offset:2560
  ds_read_b64_tr_b16 v[48:49], v2 offset:40960
  ds_read_b64_tr_b16 v[50:51], v2 offset:43520
  ds_read_b64_tr_b16 v[52:53], v7 offset:0
  ds_read_b64_tr_b16 v[54:55], v7 offset:2560
  ds_read_b64_tr_b16 v[56:57], v3 offset:40960
  ds_read_b64_tr_b16 v[58:59], v3 offset:43520
  ds_read_b64_tr_b16 v[60:61], v8 offset:0
  ds_read_b64_tr_b16 v[62:63], v8 offset:2560
  ds_read_b64_tr_b16 v[64:65], v4 offset:40960
  ds_read_b64_tr_b16 v[66:67], v4 offset:43520
  ds_read_b64_tr_b16 v[68:69], v9 offset:0
  ds_read_b64_tr_b16 v[70:71], v9 offset:2560
  ds_read_b128 v[80:83], v11 offset:8192
  ds_read_b128 v[84:87], v12 offset:8192
  ds_read_b128 v[88:91], v11 offset:10240
  ds_read_b128 v[92:95], v12 offset:10240
  ds_read_b128 v[96:99], v11 offset:12288
  ds_read_b128 v[100:103], v12 offset:12288
  ds_read_b128 v[104:107], v11 offset:14336
  ds_read_b128 v[108:111], v12 offset:14336
  ds_read_b64_tr_b16 v[72:73], v5 offset:40960
  ds_read_b64_tr_b16 v[74:75], v5 offset:43520
  ds_read_b64_tr_b16 v[76:77], v10 offset:0
  ds_read_b64_tr_b16 v[78:79], v10 offset:2560
  s_waitcnt lgkmcnt(0)
  s_barrier
  v_mfma_f32_16x16x32_bf16 v[140:143], v[40:43], v[80:83], v[140:143]
  v_rcp_f32 v128, v128
  v_mfma_f32_16x16x32_bf16 v[140:143], v[44:47], v[84:87], v[140:143]
  v_rcp_f32 v129, v129
  v_mfma_f32_16x16x32_bf16 v[144:147], v[40:43], v[88:91], v[144:147]
  v_rcp_f32 v130, v130
  v_mfma_f32_16x16x32_bf16 v[144:147], v[44:47], v[92:95], v[144:147]
  v_rcp_f32 v131, v131
  v_mfma_f32_16x16x32_bf16 v[148:151], v[40:43], v[96:99], v[148:151]
  v_mul_f32 v112, v239, v112
  v_mfma_f32_16x16x32_bf16 v[148:151], v[44:47], v[100:103], v[148:151]
  v_mul_f32 v113, v239, v113
  v_mul_f32 v114, v239, v114
  v_mfma_f32_16x16x32_bf16 v[152:155], v[40:43], v[104:107], v[152:155]
  v_mul_f32 v115, v239, v115
  v_mul_f32 v116, v239, v116
  v_mfma_f32_16x16x32_bf16 v[152:155], v[44:47], v[108:111], v[152:155]
  v_mul_f32 v117, v239, v117
  v_mul_f32 v118, v239, v118
  v_mfma_f32_16x16x32_bf16 v[168:171], v[48:51], v[104:107], v[168:171]
  v_mul_f32 v119, v239, v119
  v_mul_f32 v120, v239, v120
  v_mfma_f32_16x16x32_bf16 v[168:171], v[52:55], v[108:111], v[168:171]
  v_mul_f32 v121, v239, v121
  v_mfma_f32_16x16x32_bf16 v[164:167], v[48:51], v[96:99], v[164:167]
  v_mul_f32 v122, v239, v122
  v_mul_f32 v123, v239, v123
  v_mfma_f32_16x16x32_bf16 v[164:167], v[52:55], v[100:103], v[164:167]
  v_mul_f32 v124, v239, v124
  v_mul_f32 v125, v239, v125
  v_mfma_f32_16x16x32_bf16 v[160:163], v[48:51], v[88:91], v[160:163]
  v_mul_f32 v126, v239, v126
  v_mul_f32 v127, v239, v127
  v_mfma_f32_16x16x32_bf16 v[160:163], v[52:55], v[92:95], v[160:163]
  v_mul_f32 v128, v239, v128
  v_mul_f32 v129, v239, v129
  v_mfma_f32_16x16x32_bf16 v[156:159], v[48:51], v[80:83], v[156:159]
  v_mul_f32 v130, v239, v130
  v_mfma_f32_16x16x32_bf16 v[156:159], v[52:55], v[84:87], v[156:159]
  v_mul_f32 v131, v239, v131
  v_med3_f32 v112, v112, -v238, v238
  v_mfma_f32_16x16x32_bf16 v[172:175], v[56:59], v[80:83], v[172:175]
  v_med3_f32 v113, v113, -v238, v238
  v_med3_f32 v114, v114, -v238, v238
  v_mfma_f32_16x16x32_bf16 v[172:175], v[60:63], v[84:87], v[172:175]
  v_med3_f32 v115, v115, -v238, v238
  v_med3_f32 v116, v116, -v238, v238
  v_mfma_f32_16x16x32_bf16 v[176:179], v[56:59], v[88:91], v[176:179]
  v_med3_f32 v117, v117, -v238, v238
  v_mfma_f32_16x16x32_bf16 v[176:179], v[60:63], v[92:95], v[176:179]
  v_med3_f32 v118, v118, -v238, v238
  v_med3_f32 v119, v119, -v238, v238
  v_mfma_f32_16x16x32_bf16 v[180:183], v[56:59], v[96:99], v[180:183]
  v_med3_f32 v120, v120, -v238, v238
  v_med3_f32 v121, v121, -v238, v238
  v_mfma_f32_16x16x32_bf16 v[180:183], v[60:63], v[100:103], v[180:183]
  v_med3_f32 v122, v122, -v238, v238
  v_med3_f32 v123, v123, -v238, v238
  v_mfma_f32_16x16x32_bf16 v[184:187], v[56:59], v[104:107], v[184:187]
  v_med3_f32 v124, v124, -v238, v238
  v_med3_f32 v125, v125, -v238, v238
  v_mfma_f32_16x16x32_bf16 v[184:187], v[60:63], v[108:111], v[184:187]
  v_med3_f32 v126, v126, -v238, v238
  v_mfma_f32_16x16x32_bf16 v[200:203], v[64:67], v[104:107], v[200:203]
  v_med3_f32 v127, v127, -v238, v238
  v_med3_f32 v128, v128, -v238, v238
  v_mfma_f32_16x16x32_bf16 v[200:203], v[68:71], v[108:111], v[200:203]
  v_med3_f32 v129, v129, -v238, v238
  v_med3_f32 v130, v130, -v238, v238
  v_mfma_f32_16x16x32_bf16 v[196:199], v[64:67], v[96:99], v[196:199]
  v_med3_f32 v131, v131, -v238, v238
  v_mul_f32 v132, 0x6c800000, v112
  v_mfma_f32_16x16x32_bf16 v[196:199], v[68:71], v[100:103], v[196:199]
  v_mul_f32 v133, 0x6c800000, v113
  v_mul_f32 v134, 0x6c800000, v114
  v_mfma_f32_16x16x32_bf16 v[192:195], v[64:67], v[88:91], v[192:195]
  v_mul_f32 v135, 0x6c800000, v115
  v_mfma_f32_16x16x32_bf16 v[192:195], v[68:71], v[92:95], v[192:195]
  v_mul_f32 v136, 0x6c800000, v116
  v_mul_f32 v137, 0x6c800000, v117
  v_mfma_f32_16x16x32_bf16 v[188:191], v[64:67], v[80:83], v[188:191]
  v_mul_f32 v138, 0x6c800000, v118
  v_mul_f32 v139, 0x6c800000, v119
  v_mfma_f32_16x16x32_bf16 v[188:191], v[68:71], v[84:87], v[188:191]
  v_mul_f32 v220, 0x6c800000, v120
  v_mul_f32 v221, 0x6c800000, v121
  v_mfma_f32_16x16x32_bf16 v[204:207], v[72:75], v[80:83], v[204:207]
  v_mul_f32 v222, 0x6c800000, v122
  v_mul_f32 v223, 0x6c800000, v123
  v_mfma_f32_16x16x32_bf16 v[204:207], v[76:79], v[84:87], v[204:207]
  v_mul_f32 v224, 0x6c800000, v124
  v_mfma_f32_16x16x32_bf16 v[208:211], v[72:75], v[88:91], v[208:211]
  v_mul_f32 v225, 0x6c800000, v125
  v_mul_f32 v226, 0x6c800000, v126
  v_mfma_f32_16x16x32_bf16 v[208:211], v[76:79], v[92:95], v[208:211]
  v_mul_f32 v227, 0x6c800000, v127
  v_mul_f32 v228, 0x6c800000, v128
  v_mfma_f32_16x16x32_bf16 v[212:215], v[72:75], v[96:99], v[212:215]
  v_mul_f32 v229, 0x6c800000, v129
  v_mul_f32 v230, 0x6c800000, v130
  v_mfma_f32_16x16x32_bf16 v[212:215], v[76:79], v[100:103], v[212:215]
  v_mul_f32 v231, 0x6c800000, v131
  v_mfma_f32_16x16x32_bf16 v[216:219], v[72:75], v[104:107], v[216:219]
  v_mfma_f32_16x16x32_bf16 v[216:219], v[76:79], v[108:111], v[216:219]
  s_setprio 0
  s_nop 0
L_epi:
  s_lshl_b32 s69, s27, 11
  s_and_b32 s71, s26, 3
  s_lshl_b32 s71, s71, 9
  s_add_u32 s69, s69, s71
  s_lshr_b32 s68, s26, 2
  s_lshl_b32 s68, s68, 14
  s_add_u32 s69, s69, s68
  v_lshlrev_b32 v3, 3, v0
  v_add_u32 v2, 156928, v3
  v_pk_mul_f32 v[40:41], v[140:141], v[140:141]
  v_pk_mul_f32 v[42:43], v[142:143], v[142:143]
  v_pk_mul_f32 v[46:47], v[144:145], v[144:145]
  v_pk_mul_f32 v[48:49], v[146:147], v[146:147]
  v_pk_mul_f32 v[52:53], v[148:149], v[148:149]
  v_pk_mul_f32 v[54:55], v[150:151], v[150:151]
  v_pk_mul_f32 v[58:59], v[152:153], v[152:153]
  v_pk_mul_f32 v[60:61], v[154:155], v[154:155]
  v_pk_fma_f32 v[40:41], v[40:41], v[234:235], v[232:233]
  v_pk_fma_f32 v[42:43], v[42:43], v[234:235], v[232:233]
  v_pk_fma_f32 v[46:47], v[46:47], v[234:235], v[232:233]
  v_pk_fma_f32 v[48:49], v[48:49], v[234:235], v[232:233]
  v_pk_fma_f32 v[52:53], v[52:53], v[234:235], v[232:233]
  v_pk_fma_f32 v[54:55], v[54:55], v[234:235], v[232:233]
  v_pk_fma_f32 v[58:59], v[58:59], v[234:235], v[232:233]
  v_pk_fma_f32 v[60:61], v[60:61], v[234:235], v[232:233]
  v_pk_fma_f32 v[40:41], v[40:41], v[140:141], v[236:237]
  v_pk_fma_f32 v[42:43], v[42:43], v[142:143], v[236:237]
  v_pk_fma_f32 v[46:47], v[46:47], v[144:145], v[236:237]
  v_pk_fma_f32 v[48:49], v[48:49], v[146:147], v[236:237]
  v_pk_fma_f32 v[52:53], v[52:53], v[148:149], v[236:237]
  v_pk_fma_f32 v[54:55], v[54:55], v[150:151], v[236:237]
  v_pk_fma_f32 v[58:59], v[58:59], v[152:153], v[236:237]
  v_pk_fma_f32 v[60:61], v[60:61], v[154:155], v[236:237]
  v_exp_f32 v40, v40 clamp
  v_exp_f32 v41, v41 clamp
  v_exp_f32 v42, v42 clamp
  v_exp_f32 v43, v43 clamp
  v_exp_f32 v46, v46 clamp
  v_exp_f32 v47, v47 clamp
  v_exp_f32 v48, v48 clamp
  v_exp_f32 v49, v49 clamp
  v_exp_f32 v52, v52 clamp
  v_exp_f32 v53, v53 clamp
  v_exp_f32 v54, v54 clamp
  v_exp_f32 v55, v55 clamp
  v_exp_f32 v58, v58 clamp
  v_exp_f32 v59, v59 clamp
  v_exp_f32 v60, v60 clamp
  v_exp_f32 v61, v61 clamp
  v_pk_fma_f32 v[40:41], v[40:41], v[132:133], v[112:113]
  v_pk_fma_f32 v[42:43], v[42:43], v[134:135], v[114:115]
  v_pk_fma_f32 v[46:47], v[46:47], v[132:133], v[112:113]
  v_pk_fma_f32 v[48:49], v[48:49], v[134:135], v[114:115]
  v_pk_fma_f32 v[52:53], v[52:53], v[132:133], v[112:113]
  v_pk_fma_f32 v[54:55], v[54:55], v[134:135], v[114:115]
  v_pk_fma_f32 v[58:59], v[58:59], v[132:133], v[112:113]
  v_pk_fma_f32 v[60:61], v[60:61], v[134:135], v[114:115]
  v_pk_mul_f32 v[44:45], v[140:141], v[42:43]
  v_pk_mul_f32 v[50:51], v[144:145], v[48:49]
  v_pk_mul_f32 v[56:57], v[148:149], v[54:55]
  v_pk_mul_f32 v[62:63], v[152:153], v[60:61]
  v_pk_fma_f32 v[44:45], v[142:143], v[40:41], v[44:45]
  v_pk_fma_f32 v[50:51], v[146:147], v[46:47], v[50:51]
  v_pk_fma_f32 v[56:57], v[150:151], v[52:53], v[56:57]
  v_pk_fma_f32 v[62:63], v[154:155], v[58:59], v[62:63]
  v_pk_mul_f32 v[40:41], v[40:41], v[42:43]
  v_pk_mul_f32 v[46:47], v[46:47], v[48:49]
  v_pk_mul_f32 v[52:53], v[52:53], v[54:55]
  v_pk_mul_f32 v[58:59], v[58:59], v[60:61]
  v_rcp_f32 v40, v40
  v_rcp_f32 v41, v41
  v_rcp_f32 v46, v46
  v_rcp_f32 v47, v47
  v_rcp_f32 v52, v52
  v_rcp_f32 v53, v53
  v_rcp_f32 v58, v58
  v_rcp_f32 v59, v59
  v_pk_mul_f32 v[16:17], v[40:41], v[44:45]
  v_pk_mul_f32 v[18:19], v[46:47], v[50:51]
  v_pk_mul_f32 v[20:21], v[52:53], v[56:57]
  v_pk_mul_f32 v[22:23], v[58:59], v[62:63]
  v_pk_mul_f32 v[64:65], v[156:157], v[156:157]
  v_pk_mul_f32 v[66:67], v[158:159], v[158:159]
  v_pk_mul_f32 v[70:71], v[160:161], v[160:161]
  v_pk_mul_f32 v[72:73], v[162:163], v[162:163]
  v_pk_mul_f32 v[76:77], v[164:165], v[164:165]
  v_pk_mul_f32 v[78:79], v[166:167], v[166:167]
  v_pk_mul_f32 v[82:83], v[168:169], v[168:169]
  v_pk_mul_f32 v[84:85], v[170:171], v[170:171]
  v_pk_fma_f32 v[64:65], v[64:65], v[234:235], v[232:233]
  v_pk_fma_f32 v[66:67], v[66:67], v[234:235], v[232:233]
  v_pk_fma_f32 v[70:71], v[70:71], v[234:235], v[232:233]
  v_pk_fma_f32 v[72:73], v[72:73], v[234:235], v[232:233]
  v_pk_fma_f32 v[76:77], v[76:77], v[234:235], v[232:233]
  v_pk_fma_f32 v[78:79], v[78:79], v[234:235], v[232:233]
  v_pk_fma_f32 v[82:83], v[82:83], v[234:235], v[232:233]
  v_pk_fma_f32 v[84:85], v[84:85], v[234:235], v[232:233]
  v_pk_fma_f32 v[64:65], v[64:65], v[156:157], v[236:237]
  v_pk_fma_f32 v[66:67], v[66:67], v[158:159], v[236:237]
  v_pk_fma_f32 v[70:71], v[70:71], v[160:161], v[236:237]
  v_pk_fma_f32 v[72:73], v[72:73], v[162:163], v[236:237]
  v_pk_fma_f32 v[76:77], v[76:77], v[164:165], v[236:237]
  v_pk_fma_f32 v[78:79], v[78:79], v[166:167], v[236:237]
  v_pk_fma_f32 v[82:83], v[82:83], v[168:169], v[236:237]
  v_pk_fma_f32 v[84:85], v[84:85], v[170:171], v[236:237]
  v_exp_f32 v64, v64 clamp
  v_exp_f32 v65, v65 clamp
  v_exp_f32 v66, v66 clamp
  v_exp_f32 v67, v67 clamp
  v_exp_f32 v70, v70 clamp
  v_exp_f32 v71, v71 clamp
  v_exp_f32 v72, v72 clamp
  v_exp_f32 v73, v73 clamp
  v_exp_f32 v76, v76 clamp
  v_exp_f32 v77, v77 clamp
  v_exp_f32 v78, v78 clamp
  v_exp_f32 v79, v79 clamp
  v_exp_f32 v82, v82 clamp
  v_exp_f32 v83, v83 clamp
  v_exp_f32 v84, v84 clamp
  v_exp_f32 v85, v85 clamp
  v_pk_fma_f32 v[64:65], v[64:65], v[136:137], v[116:117]
  v_pk_fma_f32 v[66:67], v[66:67], v[138:139], v[118:119]
  v_pk_fma_f32 v[70:71], v[70:71], v[136:137], v[116:117]
  v_pk_fma_f32 v[72:73], v[72:73], v[138:139], v[118:119]
  v_pk_fma_f32 v[76:77], v[76:77], v[136:137], v[116:117]
  v_pk_fma_f32 v[78:79], v[78:79], v[138:139], v[118:119]
  v_pk_fma_f32 v[82:83], v[82:83], v[136:137], v[116:117]
  v_pk_fma_f32 v[84:85], v[84:85], v[138:139], v[118:119]
  v_pk_mul_f32 v[68:69], v[156:157], v[66:67]
  v_pk_mul_f32 v[74:75], v[160:161], v[72:73]
  v_pk_mul_f32 v[80:81], v[164:165], v[78:79]
  v_pk_mul_f32 v[86:87], v[168:169], v[84:85]
  v_pk_fma_f32 v[68:69], v[158:159], v[64:65], v[68:69]
  v_pk_fma_f32 v[74:75], v[162:163], v[70:71], v[74:75]
  v_pk_fma_f32 v[80:81], v[166:167], v[76:77], v[80:81]
  v_pk_fma_f32 v[86:87], v[170:171], v[82:83], v[86:87]
  v_pk_mul_f32 v[64:65], v[64:65], v[66:67]
  v_pk_mul_f32 v[70:71], v[70:71], v[72:73]
  v_pk_mul_f32 v[76:77], v[76:77], v[78:79]
  v_pk_mul_f32 v[82:83], v[82:83], v[84:85]
  v_rcp_f32 v64, v64
  v_rcp_f32 v65, v65
  v_rcp_f32 v70, v70
  v_rcp_f32 v71, v71
  v_rcp_f32 v76, v76
  v_rcp_f32 v77, v77
  v_rcp_f32 v82, v82
  v_rcp_f32 v83, v83
  v_pk_fma_f32 v[16:17], v[64:65], v[68:69], v[16:17]
  v_pk_fma_f32 v[18:19], v[70:71], v[74:75], v[18:19]
  v_pk_fma_f32 v[20:21], v[76:77], v[80:81], v[20:21]
  v_pk_fma_f32 v[22:23], v[82:83], v[86:87], v[22:23]
  v_pk_mul_f32 v[40:41], v[172:173], v[172:173]
  v_pk_mul_f32 v[42:43], v[174:175], v[174:175]
  v_pk_mul_f32 v[46:47], v[176:177], v[176:177]
  v_pk_mul_f32 v[48:49], v[178:179], v[178:179]
  v_pk_mul_f32 v[52:53], v[180:181], v[180:181]
  v_pk_mul_f32 v[54:55], v[182:183], v[182:183]
  v_pk_mul_f32 v[58:59], v[184:185], v[184:185]
  v_pk_mul_f32 v[60:61], v[186:187], v[186:187]
  v_pk_fma_f32 v[40:41], v[40:41], v[234:235], v[232:233]
  v_pk_fma_f32 v[42:43], v[42:43], v[234:235], v[232:233]
  v_pk_fma_f32 v[46:47], v[46:47], v[234:235], v[232:233]
  v_pk_fma_f32 v[48:49], v[48:49], v[234:235], v[232:233]
  v_pk_fma_f32 v[52:53], v[52:53], v[234:235], v[232:233]
  v_pk_fma_f32 v[54:55], v[54:55], v[234:235], v[232:233]
  v_pk_fma_f32 v[58:59], v[58:59], v[234:235], v[232:233]
  v_pk_fma_f32 v[60:61], v[60:61], v[234:235], v[232:233]
  v_pk_fma_f32 v[40:41], v[40:41], v[172:173], v[236:237]
  v_pk_fma_f32 v[42:43], v[42:43], v[174:175], v[236:237]
  v_pk_fma_f32 v[46:47], v[46:47], v[176:177], v[236:237]
  v_pk_fma_f32 v[48:49], v[48:49], v[178:179], v[236:237]
  v_pk_fma_f32 v[52:53], v[52:53], v[180:181], v[236:237]
  v_pk_fma_f32 v[54:55], v[54:55], v[182:183], v[236:237]
  v_pk_fma_f32 v[58:59], v[58:59], v[184:185], v[236:237]
  v_pk_fma_f32 v[60:61], v[60:61], v[186:187], v[236:237]
  v_exp_f32 v40, v40 clamp
  v_exp_f32 v41, v41 clamp
  v_exp_f32 v42, v42 clamp
  v_exp_f32 v43, v43 clamp
  v_exp_f32 v46, v46 clamp
  v_exp_f32 v47, v47 clamp
  v_exp_f32 v48, v48 clamp
  v_exp_f32 v49, v49 clamp
  v_exp_f32 v52, v52 clamp
  v_exp_f32 v53, v53 clamp
  v_exp_f32 v54, v54 clamp
  v_exp_f32 v55, v55 clamp
  v_exp_f32 v58, v58 clamp
  v_exp_f32 v59, v59 clamp
  v_exp_f32 v60, v60 clamp
  v_exp_f32 v61, v61 clamp
  v_pk_fma_f32 v[40:41], v[40:41], v[220:221], v[120:121]
  v_pk_fma_f32 v[42:43], v[42:43], v[222:223], v[122:123]
  v_pk_fma_f32 v[46:47], v[46:47], v[220:221], v[120:121]
  v_pk_fma_f32 v[48:49], v[48:49], v[222:223], v[122:123]
  v_pk_fma_f32 v[52:53], v[52:53], v[220:221], v[120:121]
  v_pk_fma_f32 v[54:55], v[54:55], v[222:223], v[122:123]
  v_pk_fma_f32 v[58:59], v[58:59], v[220:221], v[120:121]
  v_pk_fma_f32 v[60:61], v[60:61], v[222:223], v[122:123]
  v_pk_mul_f32 v[44:45], v[172:173], v[42:43]
  v_pk_mul_f32 v[50:51], v[176:177], v[48:49]
  v_pk_mul_f32 v[56:57], v[180:181], v[54:55]
  v_pk_mul_f32 v[62:63], v[184:185], v[60:61]
  v_pk_fma_f32 v[44:45], v[174:175], v[40:41], v[44:45]
  v_pk_fma_f32 v[50:51], v[178:179], v[46:47], v[50:51]
  v_pk_fma_f32 v[56:57], v[182:183], v[52:53], v[56:57]
  v_pk_fma_f32 v[62:63], v[186:187], v[58:59], v[62:63]
  v_pk_mul_f32 v[40:41], v[40:41], v[42:43]
  v_pk_mul_f32 v[46:47], v[46:47], v[48:49]
  v_pk_mul_f32 v[52:53], v[52:53], v[54:55]
  v_pk_mul_f32 v[58:59], v[58:59], v[60:61]
  v_rcp_f32 v40, v40
  v_rcp_f32 v41, v41
  v_rcp_f32 v46, v46
  v_rcp_f32 v47, v47
  v_rcp_f32 v52, v52
  v_rcp_f32 v53, v53
  v_rcp_f32 v58, v58
  v_rcp_f32 v59, v59
  v_pk_fma_f32 v[16:17], v[40:41], v[44:45], v[16:17]
  v_pk_fma_f32 v[18:19], v[46:47], v[50:51], v[18:19]
  v_pk_fma_f32 v[20:21], v[52:53], v[56:57], v[20:21]
  v_pk_fma_f32 v[22:23], v[58:59], v[62:63], v[22:23]
  v_pk_mul_f32 v[64:65], v[188:189], v[188:189]
  v_pk_mul_f32 v[66:67], v[190:191], v[190:191]
  v_pk_mul_f32 v[70:71], v[192:193], v[192:193]
  v_pk_mul_f32 v[72:73], v[194:195], v[194:195]
  v_pk_mul_f32 v[76:77], v[196:197], v[196:197]
  v_pk_mul_f32 v[78:79], v[198:199], v[198:199]
  v_pk_mul_f32 v[82:83], v[200:201], v[200:201]
  v_pk_mul_f32 v[84:85], v[202:203], v[202:203]
  v_pk_fma_f32 v[64:65], v[64:65], v[234:235], v[232:233]
  v_pk_fma_f32 v[66:67], v[66:67], v[234:235], v[232:233]
  v_pk_fma_f32 v[70:71], v[70:71], v[234:235], v[232:233]
  v_pk_fma_f32 v[72:73], v[72:73], v[234:235], v[232:233]
  v_pk_fma_f32 v[76:77], v[76:77], v[234:235], v[232:233]
  v_pk_fma_f32 v[78:79], v[78:79], v[234:235], v[232:233]
  v_pk_fma_f32 v[82:83], v[82:83], v[234:235], v[232:233]
  v_pk_fma_f32 v[84:85], v[84:85], v[234:235], v[232:233]
  v_pk_fma_f32 v[64:65], v[64:65], v[188:189], v[236:237]
  v_pk_fma_f32 v[66:67], v[66:67], v[190:191], v[236:237]
  v_pk_fma_f32 v[70:71], v[70:71], v[192:193], v[236:237]
  v_pk_fma_f32 v[72:73], v[72:73], v[194:195], v[236:237]
  v_pk_fma_f32 v[76:77], v[76:77], v[196:197], v[236:237]
  v_pk_fma_f32 v[78:79], v[78:79], v[198:199], v[236:237]
  v_pk_fma_f32 v[82:83], v[82:83], v[200:201], v[236:237]
  v_pk_fma_f32 v[84:85], v[84:85], v[202:203], v[236:237]
  v_exp_f32 v64, v64 clamp
  v_exp_f32 v65, v65 clamp
  v_exp_f32 v66, v66 clamp
  v_exp_f32 v67, v67 clamp
  v_exp_f32 v70, v70 clamp
  v_exp_f32 v71, v71 clamp
  v_exp_f32 v72, v72 clamp
  v_exp_f32 v73, v73 clamp
  v_exp_f32 v76, v76 clamp
  v_exp_f32 v77, v77 clamp
  v_exp_f32 v78, v78 clamp
  v_exp_f32 v79, v79 clamp
  v_exp_f32 v82, v82 clamp
  v_exp_f32 v83, v83 clamp
  v_exp_f32 v84, v84 clamp
  v_exp_f32 v85, v85 clamp
  v_pk_fma_f32 v[64:65], v[64:65], v[224:225], v[124:125]
  v_pk_fma_f32 v[66:67], v[66:67], v[226:227], v[126:127]
  v_pk_fma_f32 v[70:71], v[70:71], v[224:225], v[124:125]
  v_pk_fma_f32 v[72:73], v[72:73], v[226:227], v[126:127]
  v_pk_fma_f32 v[76:77], v[76:77], v[224:225], v[124:125]
  v_pk_fma_f32 v[78:79], v[78:79], v[226:227], v[126:127]
  v_pk_fma_f32 v[82:83], v[82:83], v[224:225], v[124:125]
  v_pk_fma_f32 v[84:85], v[84:85], v[226:227], v[126:127]
  v_pk_mul_f32 v[68:69], v[188:189], v[66:67]
  v_pk_mul_f32 v[74:75], v[192:193], v[72:73]
  v_pk_mul_f32 v[80:81], v[196:197], v[78:79]
  v_pk_mul_f32 v[86:87], v[200:201], v[84:85]
  v_pk_fma_f32 v[68:69], v[190:191], v[64:65], v[68:69]
  v_pk_fma_f32 v[74:75], v[194:195], v[70:71], v[74:75]
  v_pk_fma_f32 v[80:81], v[198:199], v[76:77], v[80:81]
  v_pk_fma_f32 v[86:87], v[202:203], v[82:83], v[86:87]
  v_pk_mul_f32 v[64:65], v[64:65], v[66:67]
  v_pk_mul_f32 v[70:71], v[70:71], v[72:73]
  v_pk_mul_f32 v[76:77], v[76:77], v[78:79]
  v_pk_mul_f32 v[82:83], v[82:83], v[84:85]
  v_rcp_f32 v64, v64
  v_rcp_f32 v65, v65
  v_rcp_f32 v70, v70
  v_rcp_f32 v71, v71
  v_rcp_f32 v76, v76
  v_rcp_f32 v77, v77
  v_rcp_f32 v82, v82
  v_rcp_f32 v83, v83
  v_pk_fma_f32 v[16:17], v[64:65], v[68:69], v[16:17]
  v_pk_fma_f32 v[18:19], v[70:71], v[74:75], v[18:19]
  v_pk_fma_f32 v[20:21], v[76:77], v[80:81], v[20:21]
  v_pk_fma_f32 v[22:23], v[82:83], v[86:87], v[22:23]
  v_pk_mul_f32 v[40:41], v[204:205], v[204:205]
  v_pk_mul_f32 v[42:43], v[206:207], v[206:207]
  v_pk_mul_f32 v[46:47], v[208:209], v[208:209]
  v_pk_mul_f32 v[48:49], v[210:211], v[210:211]
  v_pk_mul_f32 v[52:53], v[212:213], v[212:213]
  v_pk_mul_f32 v[54:55], v[214:215], v[214:215]
  v_pk_mul_f32 v[58:59], v[216:217], v[216:217]
  v_pk_mul_f32 v[60:61], v[218:219], v[218:219]
  v_pk_fma_f32 v[40:41], v[40:41], v[234:235], v[232:233]
  v_pk_fma_f32 v[42:43], v[42:43], v[234:235], v[232:233]
  v_pk_fma_f32 v[46:47], v[46:47], v[234:235], v[232:233]
  v_pk_fma_f32 v[48:49], v[48:49], v[234:235], v[232:233]
  v_pk_fma_f32 v[52:53], v[52:53], v[234:235], v[232:233]
  v_pk_fma_f32 v[54:55], v[54:55], v[234:235], v[232:233]
  v_pk_fma_f32 v[58:59], v[58:59], v[234:235], v[232:233]
  v_pk_fma_f32 v[60:61], v[60:61], v[234:235], v[232:233]
  v_pk_fma_f32 v[40:41], v[40:41], v[204:205], v[236:237]
  v_pk_fma_f32 v[42:43], v[42:43], v[206:207], v[236:237]
  v_pk_fma_f32 v[46:47], v[46:47], v[208:209], v[236:237]
  v_pk_fma_f32 v[48:49], v[48:49], v[210:211], v[236:237]
  v_pk_fma_f32 v[52:53], v[52:53], v[212:213], v[236:237]
  v_pk_fma_f32 v[54:55], v[54:55], v[214:215], v[236:237]
  v_pk_fma_f32 v[58:59], v[58:59], v[216:217], v[236:237]
  v_pk_fma_f32 v[60:61], v[60:61], v[218:219], v[236:237]
  v_exp_f32 v40, v40 clamp
  v_exp_f32 v41, v41 clamp
  v_exp_f32 v42, v42 clamp
  v_exp_f32 v43, v43 clamp
  v_exp_f32 v46, v46 clamp
  v_exp_f32 v47, v47 clamp
  v_exp_f32 v48, v48 clamp
  v_exp_f32 v49, v49 clamp
  v_exp_f32 v52, v52 clamp
  v_exp_f32 v53, v53 clamp
  v_exp_f32 v54, v54 clamp
  v_exp_f32 v55, v55 clamp
  v_exp_f32 v58, v58 clamp
  v_exp_f32 v59, v59 clamp
  v_exp_f32 v60, v60 clamp
  v_exp_f32 v61, v61 clamp
  v_pk_fma_f32 v[40:41], v[40:41], v[228:229], v[128:129]
  v_pk_fma_f32 v[42:43], v[42:43], v[230:231], v[130:131]
  v_pk_fma_f32 v[46:47], v[46:47], v[228:229], v[128:129]
  v_pk_fma_f32 v[48:49], v[48:49], v[230:231], v[130:131]
  v_pk_fma_f32 v[52:53], v[52:53], v[228:229], v[128:129]
  v_pk_fma_f32 v[54:55], v[54:55], v[230:231], v[130:131]
  v_pk_fma_f32 v[58:59], v[58:59], v[228:229], v[128:129]
  v_pk_fma_f32 v[60:61], v[60:61], v[230:231], v[130:131]
  v_pk_mul_f32 v[44:45], v[204:205], v[42:43]
  v_pk_mul_f32 v[50:51], v[208:209], v[48:49]
  v_pk_mul_f32 v[56:57], v[212:213], v[54:55]
  v_pk_mul_f32 v[62:63], v[216:217], v[60:61]
  v_pk_fma_f32 v[44:45], v[206:207], v[40:41], v[44:45]
  v_pk_fma_f32 v[50:51], v[210:211], v[46:47], v[50:51]
  v_pk_fma_f32 v[56:57], v[214:215], v[52:53], v[56:57]
  v_pk_fma_f32 v[62:63], v[218:219], v[58:59], v[62:63]
  v_pk_mul_f32 v[40:41], v[40:41], v[42:43]
  v_pk_mul_f32 v[46:47], v[46:47], v[48:49]
  v_pk_mul_f32 v[52:53], v[52:53], v[54:55]
  v_pk_mul_f32 v[58:59], v[58:59], v[60:61]
  v_rcp_f32 v40, v40
  v_rcp_f32 v41, v41
  v_rcp_f32 v46, v46
  v_rcp_f32 v47, v47
  v_rcp_f32 v52, v52
  v_rcp_f32 v53, v53
  v_rcp_f32 v58, v58
  v_rcp_f32 v59, v59
  v_pk_fma_f32 v[16:17], v[40:41], v[44:45], v[16:17]
  v_pk_fma_f32 v[18:19], v[46:47], v[50:51], v[18:19]
  v_pk_fma_f32 v[20:21], v[52:53], v[56:57], v[20:21]
  v_pk_fma_f32 v[22:23], v[58:59], v[62:63], v[22:23]
  v_add_f32 v16, v16, v17
  v_add_f32 v18, v18, v19
  v_add_f32 v20, v20, v21
  v_add_f32 v22, v22, v23
  v_mul_f32 v16, v239, v16
  v_mul_f32 v18, v239, v18
  v_mul_f32 v20, v239, v20
  v_mul_f32 v22, v239, v22
  s_nop 0
  v_permlane32_swap_b32 v16, v20
  v_permlane32_swap_b32 v18, v22
  v_add_f32 v16, v16, v20
  v_add_f32 v18, v18, v22
  s_nop 1
  v_permlane16_swap_b32 v16, v18
  v_add_f32 v16, v16, v18
  ds_write_b32 v36, v16
  s_waitcnt lgkmcnt(0)
  s_cmp_eq_u32 s3, 0
  s_cbranch_scc1 L_dpub
  s_barrier
  s_endpgm
L_dpub:
  s_mov_b32 s60, s24
  s_and_b32 s61, s25, 0xffff
  s_mov_b32 s62, 268435456
  s_mov_b32 s63, 0x20000
  s_mov_b32 s64, s22
  s_and_b32 s65, s23, 0xffff
  s_mov_b32 s66, 256
  s_mov_b32 s67, 0x20000
  s_and_b32 s81, s2, 7
  s_waitcnt vmcnt(0)
  v_cmp_eq_u32 vcc, 0, v37
  s_nop 0
  s_bitcmp1_b32 vcc_lo, s81
  s_cbranch_scc0 L_dclr_ok
  s_mov_b32 s78, 0x40000
L_dclr:
  s_sub_u32 s78, s78, 1
  s_cbranch_scc1 L_dclr_ok
  v_lshlrev_b32 v37, 2, v0
  v_and_b32 v37, 31, v37
  buffer_load_dword v37, v37, s[64:67], 0 offen offset:128 sc1
  s_waitcnt vmcnt(0)
  v_cmp_eq_u32 vcc, 0, v37
  s_nop 0
  s_bitcmp1_b32 vcc_lo, s81
  s_cbranch_scc1 L_dclr
L_dclr_ok:
  s_barrier
  ds_read_b64 v[64:65], v2 offset:0
  ds_read_b64 v[66:67], v2 offset:512
  ds_read_b64 v[68:69], v2 offset:1024
  ds_read_b64 v[70:71], v2 offset:1536
  s_waitcnt lgkmcnt(2)
  v_pk_add_f32 v[64:65], v[64:65], v[66:67]
  s_waitcnt lgkmcnt(0)
  v_pk_add_f32 v[68:69], v[68:69], v[70:71]
  v_pk_add_f32 v[64:65], v[64:65], v[68:69]
  v_and_b32 v64, -2, v64
  v_and_b32 v65, -2, v65
  buffer_store_dwordx2 v[64:65], v3, s[60:63], s69 offen sc1
  s_endpgm
L_cin:
  s_and_b32 s68, s26, 3
  s_mul_i32 s68, s68, 3
  s_add_u32 s27, s68, s27
  s_sub_u32 s27, s27, 6
  s_and_b32 s79, s3, 3
  s_lshr_b32 s84, s3, 2
  s_lshl_b32 s100, s27, 3
  s_add_u32 s100, s100, s3
  s_mul_i32 s68, s100, 1280
  v_min_u32 v40, 9, v0
  v_lshlrev_b32 v40, 7, v40
  v_lshlrev_b32 v48, 4, v0
  s_lshl_b32 s95, s79, 10
  s_cmp_eq_u32 s79, 2
  s_cselect_b64 s[82:83], 0x3fffff, -1
  s_cmp_eq_u32 s79, 3
  s_cselect_b32 s96, 0, 32768
  s_add_u32 s96, s96, s95
  s_mul_i32 s69, s27, 2979
  s_lshr_b32 s69, s69, 6
  s_mul_i32 s98, s27, 44
  s_and_b32 s70, s2, 7
  s_add_u32 s85, s98, s3
  s_lshl_b32 s85, s85, 2
  s_lshl_b32 s98, s70, 14
  s_add_u32 s85, s85, s98
  s_add_u32 s85, s85, 10240
  s_mul_i32 s98, s27, 44
  s_lshl_b32 s77, s70, 9
  s_add_u32 s94, s77, s98
  s_add_u32 s77, s77, s69
  s_add_u32 s94, s94, s3
  s_mul_i32 s94, s94, 104
  s_lshl_b32 s98, s27, 2
  s_add_u32 s98, s98, s3
  s_add_u32 s98, s98, s70
  s_and_b32 s98, s98, 7
  s_mul_i32 s98, s98, 16640
  s_add_u32 s98, s98, 12288
  s_sub_u32 s72, 6, s84
  s_lshl_b32 s99, s84, 1
  s_mov_b32 s26, -1
  v_lshrrev_b32 v43, 3, v0
  v_min_u32 v43, 6, v43
  v_lshlrev_b32 v17, 4, v43
  s_mul_i32 s70, s70, 88
  s_add_u32 s70, s100, s70
  s_mov_b32 s71, 704
  v_mov_b32 v44, s70
  v_mad_u32_u24 v19, v0, s71, v44
  s_mul_i32 s70, s100, 104
  s_sub_u32 s70, s70, 313
  v_min_u32 v44, 16, v0
  v_mul_u32_u24 v45, 26, v44
  v_add_u32 v45, s70, v45
  v_cmp_lt_u32 vcc, 12, v44
  s_nop 1
  v_cndmask_b32 v19, v19, v45, vcc
  v_lshlrev_b32 v19, 7, v19
  s_mov_b32 s101, 638976
  v_mov_b32 v2, 110464
  v_lshlrev_b32 v1, 20, v0
  v_add_u32 v1, 110464, v1
  v_and_b32 v44, 7, v0
  v_lshlrev_b32 v18, 4, v44
  v_and_b32 v44, 15, v0
  v_lshl_add_u32 v44, v44, 2, v2
  v_mov_b32 v3, 0
  ds_write_b32 v44, v3
  v_lshrrev_b32 v41, 5, v0
  v_and_b32 v42, 31, v0
  s_waitcnt lgkmcnt(0)
  v_mov_b32 v3, 1
  s_mov_b32 s32, s6
  s_and_b32 s33, s7, 0xffff
  s_mov_b32 s34, 12800000
  s_mov_b32 s35, 0x20000
  v_mov_b32 v45, s80
  buffer_load_dword v255, v45, s[32:35], 0 offen
  s_mov_b32 s36, s8
  s_and_b32 s37, s9, 0xffff
  s_mov_b32 s38, 105456
  s_mov_b32 s39, 0x20000
  buffer_load_dword v255, v40, s[36:39], s68 offen
  s_mov_b32 s44, s12
  s_and_b32 s45, s13, 0xffff
  s_mov_b32 s46, 5537792
  s_mov_b32 s47, 0x20000
  s_barrier
  s_mov_b32 s28, s4
  s_and_b32 s29, s5, 0xffff
  s_mov_b32 s30, 425984
  s_mov_b32 s31, 0x20000
  v_add_u32 v248, s95, v48
  v_cmp_gt_u32 vcc, 1152, v248
  s_nop 1
  v_cndmask_b32 v248, 0, 4, vcc
  v_add_u32 v248, v248, v48
  s_cmp_lg_u32 s84, 0
  s_cbranch_scc1 L_g1a
  s_mov_b32 s40, s10
  s_and_b32 s41, s11, 0xffff
  s_mov_b32 s42, 156
  s_mov_b32 s43, 0x20000
  s_mov_b32 m0, 110272
  s_mov_b64 exec, 0x7ff
  buffer_load_dwordx4 v48, s[40:43], 0 offen lds
  s_mov_b64 exec, -1
  s_add_u32 m0, s95, 71552
  s_add_u32 s81, s95, 70304
  buffer_load_dwordx4 v48, s[36:39], s81 offen lds
  s_add_u32 m0, s95, 75648
  s_add_u32 s81, s95, 74400
  buffer_load_dwordx4 v48, s[36:39], s81 offen lds
  s_add_u32 m0, s95, 79744
  s_add_u32 s81, s95, 78496
  buffer_load_dwordx4 v48, s[36:39], s81 offen lds
  s_add_u32 m0, s95, 83840
  s_add_u32 s81, s95, 82592
  buffer_load_dwordx4 v48, s[36:39], s81 offen lds
  s_add_u32 m0, s95, 87936
  s_add_u32 s81, s95, 86688
  buffer_load_dwordx4 v48, s[36:39], s81 offen lds
  s_add_u32 m0, s95, 92032
  s_add_u32 s81, s95, 90784
  buffer_load_dwordx4 v48, s[36:39], s81 offen lds
  s_add_u32 m0, s95, 96128
  s_add_u32 s81, s95, 94880
  buffer_load_dwordx4 v48, s[36:39], s81 offen lds
  s_add_u32 m0, s95, 100224
  s_add_u32 s81, s95, 98976
  buffer_load_dwordx4 v48, s[36:39], s81 offen lds
  s_add_u32 m0, s96, 71552
  s_add_u32 s81, s96, 70304
  s_mov_b64 exec, s[82:83]
  buffer_load_dwordx4 v48, s[36:39], s81 offen lds
  s_mov_b64 exec, -1
  s_add_u32 m0, s95, 36288
  s_add_u32 s81, s95, 35152
  buffer_load_dwordx4 v48, s[36:39], s81 offen lds
  s_add_u32 m0, s95, 40384
  s_add_u32 s81, s95, 39248
  buffer_load_dwordx4 v48, s[36:39], s81 offen lds
  s_add_u32 m0, s95, 44480
  s_add_u32 s81, s95, 43344
  buffer_load_dwordx4 v48, s[36:39], s81 offen lds
  s_add_u32 m0, s95, 48576
  s_add_u32 s81, s95, 47440
  buffer_load_dwordx4 v48, s[36:39], s81 offen lds
  s_waitcnt vmcnt(4) lgkmcnt(0)
  ds_add_u32 v1, v3 offset:0
  s_add_u32 m0, s95, 52672
  s_add_u32 s81, s95, 51536
  buffer_load_dwordx4 v48, s[36:39], s81 offen lds
  s_add_u32 m0, s95, 56768
  s_add_u32 s81, s95, 55632
  buffer_load_dwordx4 v48, s[36:39], s81 offen lds
  s_add_u32 m0, s95, 60864
  s_add_u32 s81, s95, 59728
  buffer_load_dwordx4 v48, s[36:39], s81 offen lds
  s_add_u32 m0, s95, 64960
  s_add_u32 s81, s95, 63824
  buffer_load_dwordx4 v48, s[36:39], s81 offen lds
  s_add_u32 m0, s96, 36288
  s_add_u32 s81, s96, 35152
  s_mov_b64 exec, s[82:83]
  buffer_load_dwordx4 v48, s[36:39], s81 offen lds
  s_mov_b64 exec, -1
  s_add_u32 m0, s95, 1024
  s_add_u32 s81, s95, 0
  buffer_load_dwordx4 v48, s[36:39], s81 offen lds
  s_add_u32 m0, s95, 5120
  s_add_u32 s81, s95, 4096
  buffer_load_dwordx4 v48, s[36:39], s81 offen lds
  s_add_u32 m0, s95, 9216
  s_add_u32 s81, s95, 8192
  buffer_load_dwordx4 v48, s[36:39], s81 offen lds
  s_add_u32 m0, s95, 13312
  s_add_u32 s81, s95, 12288
  buffer_load_dwordx4 v48, s[36:39], s81 offen lds
  s_waitcnt vmcnt(4) lgkmcnt(0)
  ds_add_u32 v1, v3 offset:4
  s_add_u32 m0, s95, 17408
  s_add_u32 s81, s95, 16384
  buffer_load_dwordx4 v48, s[36:39], s81 offen lds
  s_add_u32 m0, s95, 21504
  s_add_u32 s81, s95, 20476
  buffer_load_dwordx4 v248, s[36:39], s81 offen lds
  s_add_u32 m0, s95, 25600
  s_add_u32 s81, s95, 24572
  buffer_load_dwordx4 v48, s[36:39], s81 offen lds
  s_add_u32 m0, s95, 29696
  s_add_u32 s81, s95, 28668
  buffer_load_dwordx4 v48, s[36:39], s81 offen lds
  s_add_u32 m0, s96, 1024
  s_lshr_b32 s81, s96, 13
  s_sub_u32 s81, s96, s81
  s_mov_b64 exec, s[82:83]
  buffer_load_dwordx4 v48, s[36:39], s81 offen lds
  s_mov_b64 exec, -1
  s_branch L_addrc
L_g1a:
  s_setprio 1
  v_bfe_u32 v43, v0, 2, 2
  v_lshl_add_u32 v43, v41, 3, v43
  v_bfe_u32 v44, v0, 4, 1
  v_lshlrev_b32 v44, 5, v44
  v_and_b32 v45, 3, v0
  v_lshl_add_u32 v44, v45, 3, v44
  v_lshl_add_u32 v240, v43, 6, v44
  v_add_u32 v240, 106816, v240
  s_lshl_b32 s68, s79, 6
  s_add_u32 s68, s68, 36288
  v_add_u32 v44, s68, v44
  v_mul_u32_u24 v45, 1352, v43
  v_add_u32 v241, v44, v45
  v_add_u32 v45, 16, v43
  v_min_u32 v45, 25, v45
  v_mul_u32_u24 v45, 1352, v45
  v_add_u32 v242, v44, v45
  v_add_u32 v45, 20, v43
  v_min_u32 v45, 25, v45
  v_mul_u32_u24 v45, 1352, v45
  v_add_u32 v243, v44, v45
  s_lshl_b32 s68, s79, 5
  v_add_u32 v246, s68, v42
  v_mul_u32_u24 v43, 52, v246
  v_lshl_add_u32 v43, v41, 3, v43
  v_add_u32 v244, 71552, v43
  v_lshlrev_b32 v43, 1, v246
  v_add_u32 v245, 108864, v43
  v_mov_b32 v216, 0
  v_mov_b32 v217, 0
  v_lshlrev_b32 v43, 3, v0
  v_add_u32 v44, 106816, v43
  s_lshl_b32 s68, s79, 9
  v_add_u32 v44, s68, v44
  ds_write_b64 v44, v[216:217]
  v_lshl_add_u32 v43, v41, 7, v246
  s_mov_b32 s69, 2521
  s_mov_b32 s70, 106816
  v_mul_u32_u24 v44, s69, v43
  v_lshrrev_b32 v44, 16, v44
  v_mad_u32_u24 v44, v44, 12, s70
  v_lshl_add_u32 v68, v43, 1, v44
  v_add_u32 v43, 256, v43
  v_mul_u32_u24 v44, s69, v43
  v_lshrrev_b32 v44, 16, v44
  v_mad_u32_u24 v44, v44, 12, s70
  v_lshl_add_u32 v69, v43, 1, v44
  v_add_u32 v43, 256, v43
  v_mul_u32_u24 v44, s69, v43
  v_lshrrev_b32 v44, 16, v44
  v_mad_u32_u24 v44, v44, 12, s70
  v_lshl_add_u32 v70, v43, 1, v44
  v_mov_b32 v44, 676
  v_cmp_gt_u32 s[92:93], v44, v43
  v_add_u32 v43, 0, v246
  v_mul_u32_u24 v44, s69, v43
  v_lshrrev_b32 v44, 16, v44
  v_lshl_add_u32 v44, v44, 2, v244
  v_add_u32 v72, 0, v44
  v_add_u32 v43, 128, v246
  v_mul_u32_u24 v44, s69, v43
  v_lshrrev_b32 v44, 16, v44
  v_lshl_add_u32 v44, v44, 2, v244
  v_add_u32 v73, 6656, v44
  v_add_u32 v43, 256, v246
  v_mul_u32_u24 v44, s69, v43
  v_lshrrev_b32 v44, 16, v44
  v_lshl_add_u32 v44, v44, 2, v244
  v_add_u32 v74, 13312, v44
  v_add_u32 v43, 384, v246
  v_mul_u32_u24 v44, s69, v43
  v_lshrrev_b32 v44, 16, v44
  v_lshl_add_u32 v44, v44, 2, v244
  v_add_u32 v75, 19968, v44
  v_add_u32 v43, 512, v246
  v_mul_u32_u24 v44, s69, v43
  v_lshrrev_b32 v44, 16, v44
  v_lshl_add_u32 v44, v44, 2, v244
  v_add_u32 v76, 26624, v44
  v_add_u32 v43, 640, v246
  v_mul_u32_u24 v44, s69, v43
  v_lshrrev_b32 v44, 16, v44
  v_lshl_add_u32 v44, v44, 2, v244
  v_add_u32 v77, 33280, v44
  v_lshlrev_b32 v78, 4, v41
  v_add_u32 v78, 110376, v78
  v_lshlrev_b32 v79, 1, v0
  v_add_u32 v79, 110272, v79
  v_lshlrev_b32 v80, 6, v0
  v_add_u32 v80, 106868, v80
L_addrc:
  s_and_b32 s70, s3, 1
  s_lshl_b32 s70, s70, 1
  v_add_u32 v46, s70, v41
  v_min_u32 v43, 25, v42
  s_mul_i32 s68, s84, 4
  s_add_u32 s68, s68, 1352
  s_mul_i32 s69, s84, 70528
  s_add_u32 s69, s69, 1024
  v_mul_u32_u24 v44, s68, v43
  v_add_u32 v44, s69, v44
  v_lshlrev_b32 v247, 2, v43
  v_add_u32 v247, 70528, v247
  s_lshl_b32 s68, s84, 2
  s_xor_b32 s68, s68, 4
  v_lshrrev_b32 v45, 2, v43
  v_and_b32 v45, s68, v45
  v_add_u32 v44, v44, v45
  v_sub_u32 v247, v247, v45
  v_mul_u32_u24 v65, 52, v43
  v_lshl_add_u32 v65, v46, 1, v65
  v_add_u32 v65, 108864, v65
  v_lshlrev_b32 v67, 1, v43
  v_add_u32 v67, 110272, v67
  v_mad_u32_u24 v60, v46, 52, v44
  v_lshl_add_u32 v61, v46, 1, v44
  v_lshl_add_u32 v49, v46, 1, v60
  v_lshlrev_b32 v43, 3, v46
  s_mov_b32 s68, 0x01000100
  v_bfe_i32 v45, s68, v43, 8
  v_lshl_add_u32 v50, v45, 1, v60
  v_mad_i32_i24 v51, v45, 52, v61
  s_mov_b32 s68, 0xff00ff00
  v_bfe_i32 v45, s68, v43, 8
  v_lshl_add_u32 v52, v45, 1, v60
  v_mad_i32_i24 v53, v45, 52, v61
  s_mov_b32 s68, 0xff020100
  v_bfe_i32 v45, s68, v43, 8
  v_lshl_add_u32 v54, v45, 1, v60
  v_mad_i32_i24 v55, v45, 52, v61
  s_mov_b32 s68, 0x0b0a0100
  v_bfe_i32 v45, s68, v43, 8
  v_lshl_add_u32 v56, v45, 1, v60
  v_mad_i32_i24 v57, v45, 52, v61
  s_mov_b32 s68, 0xf3f20100
  v_bfe_i32 v45, s68, v43, 8
  v_lshl_add_u32 v58, v45, 1, v60
  v_mad_i32_i24 v59, v45, 52, v61
  s_mov_b32 s68, 0x00023600
  v_bfe_u32 v45, s68, v43, 8
  v_add_u32 v60, v45, v44
  v_add_u32 v61, 52, v44
  v_mov_b32 v47, 1048576
  v_cmp_eq_u32 vcc, 3, v46
  s_nop 1
  v_cndmask_b32 v60, v60, v47, vcc
  v_cndmask_b32 v67, v47, v67, vcc
  v_cmp_eq_u32 vcc, 2, v46
  s_nop 1
  v_cndmask_b32 v61, v47, v61, vcc
  v_cmp_gt_u32 vcc, 2, v46
  s_nop 1
  v_cndmask_b32 v64, v47, v65, vcc
  s_lshr_b32 s69, s79, 1
  s_mul_i32 s69, s69, 6144
  s_mul_i32 s68, s84, 6144
  v_lshlrev_b32 v45, 8, v46
  v_lshl_add_u32 v43, v42, 4, v45
  v_add_u32 v63, 1024, v43
  v_add_u32 v66, 36288, v43
  v_bfe_u32 v43, v0, 2, 2
  v_lshl_add_u32 v45, v43, 4, v45
  v_and_b32 v43, 3, v0
  v_lshl_add_u32 v44, v43, 6, v45
  v_add_u32 v44, 12288, v44
  v_cmp_lt_u32 vcc, 15, v42
  s_nop 1
  v_cndmask_b32 v63, v63, v44, vcc
  v_add_u32 v44, 16, v44
  v_cndmask_b32 v66, v66, v44, vcc
  v_lshl_add_u32 v44, v43, 5, v45
  v_add_u32 v44, 24560, v44
  v_cmp_lt_u32 vcc, 19, v42
  s_nop 1
  v_cndmask_b32 v63, v63, v44, vcc
  v_add_u32 v63, s69, v63
  v_add_u32 v66, s68, v66
  v_cmp_lt_u32 vcc, 25, v42
  s_nop 1
  v_cndmask_b32 v63, v63, v47, vcc
  v_cndmask_b32 v66, v66, v47, vcc
  v_mov_b32 v62, 0
  s_mul_i32 s74, s3, 4224
  s_add_u32 s74, s74, 111040
  s_mov_b32 s75, -39488
  v_add_u32 v28, 1024, v48
  v_and_b32 v43, 11, v0
  v_cmp_eq_u32 vcc, 11, v43
  s_nop 1
  v_cndmask_b32 v31, v28, v47, vcc
  v_and_b32 v43, 3, v0
  v_cmp_eq_u32 vcc, 0, v43
  s_nop 1
  v_cndmask_b32 v30, v31, v47, vcc
  v_lshrrev_b32 v46, 4, v0
  v_bfe_u32 v43, v0, 1, 3
  v_lshlrev_b32 v45, 4, v43
  v_add_u32 v45, 24576, v45
  v_and_b32 v43, 10, v0
  v_cmp_eq_u32 vcc, 10, v43
  s_nop 1
  v_cndmask_b32 v45, v45, v47, vcc
  v_and_b32 v44, 1, v0
  v_lshl_add_u32 v29, v46, 9, v45
  v_lshl_add_u32 v29, v44, 2, v29
  v_add_u32 v29, 1024, v29
  v_lshl_add_u32 v22, v46, 8, v45
  v_lshl_add_u32 v22, v44, 20, v22
  v_and_b32 v47, 15, v0
  s_mov_b32 s68, 1056
  v_lshlrev_b32 v43, 1, v47
  v_add_u32 v43, s74, v43
  v_mad_u32_u24 v7, v46, s68, v43
  s_lshl_b32 s68, s3, 10
  s_add_u32 s68, s68, 144832
  v_add_u32 v10, s68, v48
  v_add_u32 v43, 256, v48
  v_and_b32 v43, 1023, v43
  v_add_u32 v11, s68, v43
  v_xor_b32 v43, 512, v48
  v_add_u32 v12, s68, v43
  v_lshlrev_b32 v13, 4, v41
  v_mov_b32 v32, 0
  v_mov_b32 v33, 0
  v_mov_b32 v34, 0
  v_mov_b32 v35, 0
  v_mov_b32 v36, 0
  v_mov_b32 v37, 0
  v_mov_b32 v38, 0
  v_mov_b32 v39, 0
  v_mov_b32 v216, 0
  v_mov_b32 v217, 0
  v_mov_b32 v218, 0
  v_mov_b32 v219, 0
  v_mov_b32 v220, 0
  v_mov_b32 v221, 0
  v_mov_b32 v222, 0
  v_mov_b32 v223, 0
  v_mov_b32 v224, 0
  v_mov_b32 v225, 0
  v_mov_b32 v226, 0
  v_mov_b32 v227, 0
  v_mov_b32 v228, 0
  v_mov_b32 v229, 0
  v_mov_b32 v230, 0
  v_mov_b32 v231, 0
  v_mov_b32 v232, 0
  v_mov_b32 v233, 0
  v_mov_b32 v234, 0
  v_mov_b32 v235, 0
  v_mov_b32 v236, 0
  v_mov_b32 v237, 0
  v_mov_b32 v238, 0
  v_mov_b32 v239, 0
  v_mul_u32_u24 v44, 1056, v46
  v_bfe_u32 v45, v0, 2, 2
  v_lshl_add_u32 v44, v45, 7, v44
  v_and_b32 v45, 3, v0
  v_lshl_add_u32 v9, v45, 3, v44
  v_add_u32 v8, s74, v9
  v_and_b32 v45, 1, v0
  s_mov_b32 s68, 0xaaaaaaaa
  v_mul_lo_u32 v16, s68, v45
  v_or_b32 v16, 0x44444444, v16
  v_lshlrev_b32 v15, 1, v0
  v_add_u32 v15, s74, v15
  v_mov_b32 v14, 0x3f80
  ds_write_b16 v15, v14 offset:4064
  v_add_u32 v15, s75, v15
  s_mul_i32 s71, s3, 6
  s_add_u32 s77, s77, s71
  s_mul_i32 s77, s77, 104
  s_add_u32 s73, s77, 80
  s_add_u32 s77, s77, 16
  s_mov_b32 s71, 10923
  v_min_u32 v43, 35, v0
  v_mul_u32_u24 v44, s71, v43
  v_lshrrev_b32 v44, 16, v44
  v_mul_u32_u24 v44, 80, v44
  v_lshl_add_u32 v20, v43, 2, v44
  s_cmp_eq_u32 s84, 0
  s_cbranch_scc1 L_g0pf
  s_waitcnt lgkmcnt(0)
  ds_add_u32 v1, v3 offset:0
  s_sub_u32 s94, s94, 416
  buffer_load_dwordx4 v[204:207], v17, s[28:31], s94 offen offset:0
  s_add_u32 s94, s94, 416
  buffer_load_dwordx4 v[24:27], v17, s[28:31], s94 offen offset:0
  s_add_u32 s94, s94, 832
  s_sub_u32 s68, s77, 2496
  buffer_load_dword v208, v20, s[28:31], s68 offen
  buffer_load_dword v209, v20, s[28:31], s77 offen
  s_add_u32 s77, s77, 24
  buffer_load_dword v21, v20, s[28:31], s77 offen
  s_cmp_eq_u32 s77, s73
  s_cselect_b32 s73, 0x7000000, s73
  s_cselect_b32 s77, 0x7000000, s77
  s_add_u32 s77, s77, 24
  s_min_u32 s77, s77, s73
L_csync1:
  ds_read_b32 v4, v2 offset:0
  s_waitcnt lgkmcnt(0)
  v_cmp_gt_u32 vcc, 8, v4
  s_cbranch_vccnz L_csync1
  ds_read_b64 v[132:133], v78 offset:0
  ds_read_b64 v[134:135], v78 offset:8
  ds_read_b64 v[136:137], v78 offset:32
  ds_read_b64 v[138:139], v78 offset:40
  ds_read_u16 v45, v79 offset:52
  ds_read_b64_tr_b16 v[84:85], v241 offset:35264
  ds_read_b64_tr_b16 v[86:87], v241 offset:40672
  ds_read_b64_tr_b16 v[88:89], v242 offset:35264
  ds_read_b64_tr_b16 v[90:91], v243 offset:35264
  ds_read_b64_tr_b16 v[92:93], v241 offset:35520
  ds_read_b64_tr_b16 v[94:95], v241 offset:40928
  ds_read_b64_tr_b16 v[96:97], v242 offset:35520
  ds_read_b64_tr_b16 v[98:99], v243 offset:35520
  ds_read_b64_tr_b16 v[100:101], v241 offset:35776
  ds_read_b64_tr_b16 v[102:103], v241 offset:41184
  ds_read_b64_tr_b16 v[104:105], v242 offset:35776
  ds_read_b64_tr_b16 v[106:107], v243 offset:35776
  ds_read_b64_tr_b16 v[108:109], v241 offset:36032
  ds_read_b64_tr_b16 v[110:111], v241 offset:41440
  ds_read_b64_tr_b16 v[112:113], v242 offset:36032
  ds_read_b64_tr_b16 v[114:115], v243 offset:36032
  s_waitcnt lgkmcnt(14)
  v_mfma_f32_32x32x16_bf16 v[140:155], v[132:135], v[84:87], 0
  s_waitcnt lgkmcnt(12)
  v_mfma_f32_32x32x16_bf16 v[140:155], v[136:139], v[88:91], v[140:155]
  ds_read_b64_tr_b16 v[116:117], v241 offset:36288
  ds_read_b64_tr_b16 v[118:119], v241 offset:41696
  ds_read_b64_tr_b16 v[120:121], v242 offset:36288
  ds_read_b64_tr_b16 v[122:123], v243 offset:36288
  s_waitcnt lgkmcnt(14)
  v_mfma_f32_32x32x16_bf16 v[156:171], v[132:135], v[92:95], 0
  s_waitcnt lgkmcnt(12)
  v_mfma_f32_32x32x16_bf16 v[156:171], v[136:139], v[96:99], v[156:171]
  ds_read_b64_tr_b16 v[124:125], v241 offset:36544
  ds_read_b64_tr_b16 v[126:127], v241 offset:41952
  ds_read_b64_tr_b16 v[128:129], v242 offset:36544
  ds_read_b64_tr_b16 v[130:131], v243 offset:36544
  s_waitcnt lgkmcnt(14)
  v_mfma_f32_32x32x16_bf16 v[172:187], v[132:135], v[100:103], 0
  s_waitcnt lgkmcnt(12)
  v_mfma_f32_32x32x16_bf16 v[172:187], v[136:139], v[104:107], v[172:187]
  v_cvt_pk_bf16_f32 v81, v140, 0
  s_waitcnt lgkmcnt(10)
  v_mfma_f32_32x32x16_bf16 v[188:203], v[132:135], v[108:111], 0
  s_waitcnt lgkmcnt(8)
  v_mfma_f32_32x32x16_bf16 v[188:203], v[136:139], v[112:115], v[188:203]
  s_mov_b32 exec_lo, 0
  v_cvt_pk_bf16_f32 v81, v156, 0
  s_mov_b32 exec_lo, -1
  ds_write_b16 v68, v81
  s_waitcnt lgkmcnt(7)
  v_mfma_f32_32x32x16_bf16 v[140:155], v[132:135], v[116:119], 0
  s_waitcnt lgkmcnt(5)
  v_mfma_f32_32x32x16_bf16 v[140:155], v[136:139], v[120:123], v[140:155]
  v_cvt_pk_bf16_f32 v82, v172, 0
  s_waitcnt lgkmcnt(3)
  v_mfma_f32_32x32x16_bf16 v[156:171], v[132:135], v[124:127], 0
  s_waitcnt lgkmcnt(1)
  v_mfma_f32_32x32x16_bf16 v[156:171], v[136:139], v[128:131], v[156:171]
  s_mov_b32 exec_lo, 0
  v_cvt_pk_bf16_f32 v82, v188, 0
  s_mov_b32 exec_lo, -1
  ds_write_b16 v69, v82
  s_nop 2
  v_cvt_pk_bf16_f32 v83, v140, 0
  s_mov_b32 exec_lo, 0
  s_nop 2
  v_cvt_pk_bf16_f32 v83, v156, 0
  s_mov_b64 exec, s[92:93]
  ds_write_b16 v70, v83
  s_mov_b64 exec, 0x3ffffff
  ds_write_b16 v80, v45
  s_mov_b64 exec, -1
  s_waitcnt lgkmcnt(0)
  ds_add_u32 v1, v3 offset:32
  v_cmp_gt_u32 s[92:93], 36, v246
L_csync2:
  ds_read_b32 v4, v2 offset:4
  s_waitcnt lgkmcnt(0)
  v_cmp_gt_u32 vcc, 4, v4
  s_cbranch_vccnz L_csync2
  ds_read_b64_tr_b16 v[84:85], v241 offset:0
  ds_read_b64_tr_b16 v[86:87], v241 offset:5408
  ds_read_b64_tr_b16 v[88:89], v242 offset:0
  ds_read_b64_tr_b16 v[90:91], v243 offset:0
  ds_read_b64_tr_b16 v[92:93], v241 offset:256
  ds_read_b64_tr_b16 v[94:95], v241 offset:5664
  ds_read_b64_tr_b16 v[96:97], v242 offset:256
  ds_read_b64_tr_b16 v[98:99], v243 offset:256
  ds_read_b64_tr_b16 v[100:101], v241 offset:512
  ds_read_b64_tr_b16 v[102:103], v241 offset:5920
  ds_read_b64_tr_b16 v[104:105], v242 offset:512
  ds_read_b64_tr_b16 v[106:107], v243 offset:512
  ds_read_b64_tr_b16 v[108:109], v241 offset:768
  ds_read_b64_tr_b16 v[110:111], v241 offset:6176
  ds_read_b64_tr_b16 v[112:113], v242 offset:768
  ds_read_b64_tr_b16 v[114:115], v243 offset:768
  ds_read_b64_tr_b16 v[116:117], v241 offset:1024
  ds_read_b64_tr_b16 v[118:119], v241 offset:6432
  ds_read_b64_tr_b16 v[120:121], v242 offset:1024
  ds_read_b64_tr_b16 v[122:123], v243 offset:1024
  ds_read_b64_tr_b16 v[124:125], v241 offset:1280
  ds_read_b64_tr_b16 v[126:127], v241 offset:6688
  ds_read_b64_tr_b16 v[128:129], v242 offset:1280
  ds_read_b64_tr_b16 v[130:131], v243 offset:1280
L_csync3:
  ds_read_b32 v4, v2 offset:32
  s_waitcnt lgkmcnt(0)
  v_cmp_gt_u32 vcc, 4, v4
  s_cbranch_vccnz L_csync3
  s_setprio 0
  s_waitcnt vmcnt(2)
  v_lshlrev_b32 v208, 7, v208
  buffer_load_dword v255, v208, s[32:35], 0 offen
  s_waitcnt vmcnt(2)
  v_lshlrev_b32 v209, 7, v209
  buffer_load_dword v255, v209, s[32:35], 0 offen
  s_mov_b64 exec, 131071
  buffer_load_dword v255, v19, s[44:47], s101 offen
  s_mov_b64 exec, -1
  s_add_u32 s101, s101, 1171456
  ds_read_b64_tr_b16 v[132:133], v240 offset:0
  ds_read_b64_tr_b16 v[134:135], v240 offset:256
  ds_read_b64_tr_b16 v[136:137], v240 offset:1024
  ds_read_b64_tr_b16 v[138:139], v240 offset:1280
  s_waitcnt lgkmcnt(2)
  v_mfma_f32_32x32x16_bf16 v[140:155], v[132:135], v[84:87], 0
  s_waitcnt lgkmcnt(0)
  v_mfma_f32_32x32x16_bf16 v[140:155], v[136:139], v[88:91], v[140:155]
  v_mfma_f32_32x32x16_bf16 v[156:171], v[132:135], v[92:95], 0
  v_mfma_f32_32x32x16_bf16 v[156:171], v[136:139], v[96:99], v[156:171]
  v_mfma_f32_32x32x16_bf16 v[172:187], v[132:135], v[100:103], 0
  v_mfma_f32_32x32x16_bf16 v[172:187], v[136:139], v[104:107], v[172:187]
  s_nop 7
  v_cvt_pk_bf16_f32 v84, v140, v141
  v_cvt_pk_bf16_f32 v85, v142, v143
  v_cvt_pk_bf16_f32 v86, v144, v145
  v_cvt_pk_bf16_f32 v87, v146, v147
  v_cvt_pk_bf16_f32 v88, v148, v149
  v_cvt_pk_bf16_f32 v89, v150, v151
  v_cvt_pk_bf16_f32 v90, v152, v153
  v_cvt_pk_bf16_f32 v91, v154, v155
  ds_write2_b32 v72, v84, v85 offset0:0 offset1:1
  v_max3_f32 v62, v62, abs(v140), abs(v141)
  v_max3_f32 v62, v62, abs(v142), abs(v143)
  v_max3_f32 v62, v62, abs(v144), abs(v145)
  ds_write2_b32 v72, v86, v87 offset0:4 offset1:5
  v_max3_f32 v62, v62, abs(v146), abs(v147)
  v_max3_f32 v62, v62, abs(v148), abs(v149)
  ds_write2_b32 v72, v88, v89 offset0:8 offset1:9
  v_max3_f32 v62, v62, abs(v150), abs(v151)
  v_max3_f32 v62, v62, abs(v152), abs(v153)
  v_mfma_f32_32x32x16_bf16 v[188:203], v[132:135], v[108:111], 0
  v_mfma_f32_32x32x16_bf16 v[188:203], v[136:139], v[112:115], v[188:203]
  v_cvt_pk_bf16_f32 v92, v156, v157
  v_cvt_pk_bf16_f32 v93, v158, v159
  v_cvt_pk_bf16_f32 v94, v160, v161
  v_cvt_pk_bf16_f32 v95, v162, v163
  v_cvt_pk_bf16_f32 v96, v164, v165
  v_cvt_pk_bf16_f32 v97, v166, v167
  v_cvt_pk_bf16_f32 v98, v168, v169
  v_cvt_pk_bf16_f32 v99, v170, v171
  ds_write2_b32 v73, v92, v93 offset0:0 offset1:1
  v_max3_f32 v62, v62, abs(v156), abs(v157)
  v_max3_f32 v62, v62, abs(v158), abs(v159)
  v_max3_f32 v62, v62, abs(v160), abs(v161)
  ds_write2_b32 v73, v94, v95 offset0:4 offset1:5
  v_max3_f32 v62, v62, abs(v162), abs(v163)
  v_max3_f32 v62, v62, abs(v164), abs(v165)
  ds_write2_b32 v73, v96, v97 offset0:8 offset1:9
  v_max3_f32 v62, v62, abs(v166), abs(v167)
  v_max3_f32 v62, v62, abs(v168), abs(v169)
  v_mfma_f32_32x32x16_bf16 v[140:155], v[132:135], v[116:119], 0
  v_mfma_f32_32x32x16_bf16 v[140:155], v[136:139], v[120:123], v[140:155]
  v_cvt_pk_bf16_f32 v100, v172, v173
  v_cvt_pk_bf16_f32 v101, v174, v175
  v_cvt_pk_bf16_f32 v102, v176, v177
  v_cvt_pk_bf16_f32 v103, v178, v179
  v_cvt_pk_bf16_f32 v104, v180, v181
  v_cvt_pk_bf16_f32 v105, v182, v183
  v_cvt_pk_bf16_f32 v106, v184, v185
  v_cvt_pk_bf16_f32 v107, v186, v187
  ds_write2_b32 v74, v100, v101 offset0:0 offset1:1
  v_max3_f32 v62, v62, abs(v172), abs(v173)
  v_max3_f32 v62, v62, abs(v174), abs(v175)
  v_max3_f32 v62, v62, abs(v176), abs(v177)
  ds_write2_b32 v74, v102, v103 offset0:4 offset1:5
  v_max3_f32 v62, v62, abs(v178), abs(v179)
  v_max3_f32 v62, v62, abs(v180), abs(v181)
  ds_write2_b32 v74, v104, v105 offset0:8 offset1:9
  v_max3_f32 v62, v62, abs(v182), abs(v183)
  v_max3_f32 v62, v62, abs(v184), abs(v185)
  v_mfma_f32_32x32x16_bf16 v[156:171], v[132:135], v[124:127], 0
  v_mfma_f32_32x32x16_bf16 v[156:171], v[136:139], v[128:131], v[156:171]
  v_cvt_pk_bf16_f32 v108, v188, v189
  v_cvt_pk_bf16_f32 v109, v190, v191
  v_cvt_pk_bf16_f32 v110, v192, v193
  v_cvt_pk_bf16_f32 v111, v194, v195
  v_cvt_pk_bf16_f32 v112, v196, v197
  v_cvt_pk_bf16_f32 v113, v198, v199
  v_cvt_pk_bf16_f32 v114, v200, v201
  v_cvt_pk_bf16_f32 v115, v202, v203
  ds_write2_b32 v75, v108, v109 offset0:0 offset1:1
  v_max3_f32 v62, v62, abs(v188), abs(v189)
  v_max3_f32 v62, v62, abs(v190), abs(v191)
  v_max3_f32 v62, v62, abs(v192), abs(v193)
  ds_write2_b32 v75, v110, v111 offset0:4 offset1:5
  v_max3_f32 v62, v62, abs(v194), abs(v195)
  v_max3_f32 v62, v62, abs(v196), abs(v197)
  ds_write2_b32 v75, v112, v113 offset0:8 offset1:9
  v_max3_f32 v62, v62, abs(v198), abs(v199)
  v_max3_f32 v62, v62, abs(v200), abs(v201)
  v_cvt_pk_bf16_f32 v116, v140, v141
  v_cvt_pk_bf16_f32 v117, v142, v143
  v_cvt_pk_bf16_f32 v118, v144, v145
  v_cvt_pk_bf16_f32 v119, v146, v147
  v_cvt_pk_bf16_f32 v120, v148, v149
  v_cvt_pk_bf16_f32 v121, v150, v151
  v_cvt_pk_bf16_f32 v122, v152, v153
  v_cvt_pk_bf16_f32 v123, v154, v155
  ds_write2_b32 v76, v116, v117 offset0:0 offset1:1
  v_max3_f32 v62, v62, abs(v140), abs(v141)
  v_max3_f32 v62, v62, abs(v142), abs(v143)
  v_max3_f32 v62, v62, abs(v144), abs(v145)
  ds_write2_b32 v76, v118, v119 offset0:4 offset1:5
  v_max3_f32 v62, v62, abs(v146), abs(v147)
  v_max3_f32 v62, v62, abs(v148), abs(v149)
  ds_write2_b32 v76, v120, v121 offset0:8 offset1:9
  v_max3_f32 v62, v62, abs(v150), abs(v151)
  v_max3_f32 v62, v62, abs(v152), abs(v153)
  v_cvt_pk_bf16_f32 v124, v156, v157
  v_cvt_pk_bf16_f32 v125, v158, v159
  v_cvt_pk_bf16_f32 v126, v160, v161
  v_cvt_pk_bf16_f32 v127, v162, v163
  v_cvt_pk_bf16_f32 v128, v164, v165
  v_cvt_pk_bf16_f32 v129, v166, v167
  v_cvt_pk_bf16_f32 v130, v168, v169
  v_cvt_pk_bf16_f32 v131, v170, v171
  s_mov_b64 exec, s[92:93]
  ds_write2_b32 v77, v124, v125 offset0:0 offset1:1
  v_max3_f32 v62, v62, abs(v156), abs(v157)
  v_max3_f32 v62, v62, abs(v158), abs(v159)
  v_max3_f32 v62, v62, abs(v160), abs(v161)
  ds_write2_b32 v77, v126, v127 offset0:4 offset1:5
  v_max3_f32 v62, v62, abs(v162), abs(v163)
  v_max3_f32 v62, v62, abs(v164), abs(v165)
  ds_write2_b32 v77, v128, v129 offset0:8 offset1:9
  v_max3_f32 v62, v62, abs(v166), abs(v167)
  v_max3_f32 v62, v62, abs(v168), abs(v169)
  s_mov_b32 exec_hi, 0
  ds_write_b32 v77, v130 offset:48
  ds_write_b16 v245, v131 offset:1280
  s_mov_b32 exec_lo, -1
  ds_write_b32 v76, v122 offset:48
  ds_write_b16 v245, v123 offset:1024
  ds_write_b32 v75, v114 offset:48
  ds_write_b16 v245, v115 offset:768
  ds_write_b32 v74, v106 offset:48
  ds_write_b16 v245, v107 offset:512
  ds_write_b32 v73, v98 offset:48
  ds_write_b16 v245, v99 offset:256
  ds_write_b32 v72, v90 offset:48
  ds_write_b16 v245, v91 offset:0
  s_mov_b64 exec, -1
  v_max_u32_dpp v62, v62, v62 row_shr:1 row_mask:0xf bank_mask:0xf
  s_nop 1
  v_max_u32_dpp v62, v62, v62 row_shr:2 row_mask:0xf bank_mask:0xf
  s_nop 1
  v_max_u32_dpp v62, v62, v62 row_shr:4 row_mask:0xf bank_mask:0xf
  s_nop 1
  v_max_u32_dpp v62, v62, v62 row_shr:8 row_mask:0xf bank_mask:0xf
  s_nop 1
  v_max_u32_dpp v62, v62, v62 row_bcast:15 row_mask:0xa bank_mask:0xf
  s_nop 1
  v_max_u32_dpp v62, v62, v62 row_bcast:31 row_mask:0xc bank_mask:0xf
  s_nop 0
  v_readlane_b32 s68, v62, 63
  s_nop 1
  v_mov_b32 v62, s68
  ds_max_u32 v1, v62 offset:28
  ds_add_u32 v1, v3 offset:24
  s_setprio 0
  v_lshl_add_u32 v24, v24, 7, v18
  v_lshl_add_u32 v25, v25, 7, v18
  s_mov_b32 exec_hi, 0x0000ffff
  v_lshl_add_u32 v26, v26, 7, v18
  v_lshl_add_u32 v27, v27, 7, v18
  s_mov_b32 exec_lo, 0
  s_mov_b32 exec_hi, 0xffff0000
  v_mov_b32 v27, v25
  v_mov_b32 v26, v25
  s_mov_b32 exec_hi, 0x00ff0000
  v_mov_b32 v26, v24
  s_mov_b64 exec, -1
  s_add_u32 m0, s74, 0
  s_nop 0
  buffer_load_dwordx4 v24, s[32:35], 0 offen lds
  s_add_u32 m0, s74, 1056
  s_nop 0
  buffer_load_dwordx4 v25, s[32:35], 0 offen lds
  s_add_u32 m0, s74, 2112
  s_nop 0
  buffer_load_dwordx4 v26, s[32:35], 0 offen lds
  s_add_u32 m0, s74, 3168
  s_mov_b32 exec_hi, 0x00ffffff
  buffer_load_dwordx4 v27, s[32:35], 0 offen lds
  s_mov_b32 exec_hi, -1
  v_lshl_add_u32 v204, v204, 7, v18
  v_lshl_add_u32 v205, v205, 7, v18
  s_mov_b32 exec_hi, 0x0000ffff
  v_lshl_add_u32 v206, v206, 7, v18
  v_lshl_add_u32 v207, v207, 7, v18
  s_mov_b32 exec_lo, 0
  s_mov_b32 exec_hi, 0xffff0000
  v_mov_b32 v207, v205
  v_mov_b32 v206, v205
  s_mov_b32 exec_hi, 0x00ff0000
  v_mov_b32 v206, v204
  s_mov_b64 exec, -1
  s_add_u32 m0, s74, -16896
  s_nop 0
  buffer_load_dwordx4 v204, s[32:35], 0 offen lds
  s_add_u32 m0, s74, -15840
  s_nop 0
  buffer_load_dwordx4 v205, s[32:35], 0 offen lds
  s_add_u32 m0, s74, -14784
  s_nop 0
  buffer_load_dwordx4 v206, s[32:35], 0 offen lds
  s_add_u32 m0, s74, -13728
  s_mov_b32 exec_hi, 0x00ffffff
  buffer_load_dwordx4 v207, s[32:35], 0 offen lds
  s_mov_b32 exec_hi, -1
  buffer_load_dwordx4 v[24:27], v17, s[28:31], s94 offen offset:0
  s_add_u32 s94, s94, 832
  s_branch L_uph
L_g0pf:
  s_add_u32 s94, s94, 832
  s_add_u32 s77, s77, 24
  buffer_load_dwordx4 v[24:27], v17, s[28:31], s94 offen offset:0
  s_add_u32 s94, s94, 832
  buffer_load_dword v21, v20, s[28:31], s77 offen
  s_cmp_eq_u32 s77, s73
  s_cselect_b32 s73, 0x7000000, s73
  s_cselect_b32 s77, 0x7000000, s77
  s_add_u32 s77, s77, 24
  s_min_u32 s77, s77, s73
  s_mov_b64 exec, 131071
  buffer_load_dword v255, v19, s[44:47], s101 offen
  s_mov_b64 exec, -1
  s_add_u32 s101, s101, 1171456
  s_waitcnt vmcnt(3) lgkmcnt(0)
  ds_add_u32 v1, v3 offset:8
  s_mov_b32 s97, 0
L_csync4:
  ds_read_b32 v4, v2 offset:8
  s_waitcnt lgkmcnt(0)
  v_cmp_gt_u32 vcc, 4, v4
  s_cbranch_vccnz L_csync4
  s_cmp_ge_u32 s79, 2
  s_cbranch_scc1 L_chunk2
L_chunk0:
  ds_read_u16_d16_hi v216, v49 offset:0
  ds_read_u16_d16_hi v218, v49 offset:648
  ds_read_u16_d16_hi v220, v49 offset:216
  ds_read_u16_d16_hi v222, v49 offset:864
  ds_read_u16_d16_hi v224, v49 offset:432
  ds_read_u16_d16_hi v226, v49 offset:1080
  ds_read_u16_d16_hi v228, v49 offset:8
  ds_read_u16_d16_hi v229, v49 offset:208
  ds_read_u16_d16_hi v230, v49 offset:656
  ds_read_u16_d16_hi v231, v49 offset:856
  ds_read_u16_d16_hi v232, v49 offset:32
  ds_read_u16_d16_hi v233, v49 offset:832
  ds_read_u16_d16_hi v234, v49 offset:632
  ds_read_u16_d16_hi v235, v49 offset:232
  s_waitcnt lgkmcnt(12)
  v_mov_b32 v85, v218
  v_mov_b32 v84, v216
  v_max3_f32 v62, v62, abs(v84), abs(v85)
  ds_read_u16_d16_hi v236, v49 offset:16
  ds_read_u16_d16_hi v237, v49 offset:416
  ds_read_u16_d16_hi v238, v49 offset:664
  ds_read_u16_d16_hi v239, v49 offset:1064
  s_waitcnt lgkmcnt(14)
  v_mov_b32 v87, v222
  v_mov_b32 v86, v220
  v_max3_f32 v62, v62, abs(v86), abs(v87)
  ds_read_u16_d16_hi v216, v49 offset:40
  ds_read_u16_d16_hi v217, v49 offset:1040
  ds_read_u16_d16_hi v218, v49 offset:640
  ds_read_u16_d16_hi v219, v49 offset:440
  s_waitcnt lgkmcnt(14)
  v_mov_b32 v89, v226
  v_mov_b32 v88, v224
  v_max3_f32 v62, v62, abs(v88), abs(v89)
  ds_read_u16_d16_hi v220, v49 offset:224
  ds_read_u16_d16_hi v221, v49 offset:424
  ds_read_u16_d16_hi v222, v49 offset:872
  ds_read_u16_d16_hi v223, v49 offset:1072
  s_waitcnt lgkmcnt(14)
  v_add_f32 v91, v230, v231
  v_add_f32 v90, v228, v229
  v_max3_f32 v62, v62, abs(v90), abs(v91)
  ds_read_u16_d16_hi v224, v49 offset:248
  ds_read_u16_d16_hi v225, v49 offset:1048
  ds_read_u16_d16_hi v226, v49 offset:848
  ds_read_u16_d16_hi v227, v49 offset:448
  s_waitcnt lgkmcnt(14)
  v_add_f32 v93, v234, v235
  v_add_f32 v92, v232, v233
  v_max3_f32 v62, v62, abs(v92), abs(v93)
  ds_read_u16_d16_hi v228, v50 offset:48
  ds_read_u16_d16_hi v229, v51 offset:1248
  ds_read_u16_d16_hi v230, v50 offset:672
  ds_read_u16_d16_hi v231, v51 offset:1272
  s_waitcnt lgkmcnt(14)
  v_add_f32 v95, v238, v239
  v_add_f32 v94, v236, v237
  v_max3_f32 v62, v62, abs(v94), abs(v95)
  ds_read_u16_d16_hi v232, v50 offset:256
  ds_read_u16_d16_hi v233, v51 offset:1256
  ds_read_u16_d16_hi v234, v50 offset:880
  ds_read_u16_d16_hi v235, v51 offset:1280
  s_waitcnt lgkmcnt(14)
  v_add_f32 v97, v218, v219
  v_add_f32 v96, v216, v217
  v_max3_f32 v62, v62, abs(v96), abs(v97)
  ds_read_u16_d16_hi v236, v50 offset:464
  ds_read_u16_d16_hi v237, v51 offset:1264
  ds_read_u16_d16_hi v238, v50 offset:1088
  ds_read_u16_d16_hi v239, v51 offset:1288
  s_waitcnt lgkmcnt(14)
  v_add_f32 v99, v222, v223
  v_add_f32 v98, v220, v221
  v_max3_f32 v62, v62, abs(v98), abs(v99)
  s_waitcnt lgkmcnt(12)
  v_add_f32 v101, v226, v227
  v_add_f32 v100, v224, v225
  v_max3_f32 v62, v62, abs(v100), abs(v101)
  s_waitcnt lgkmcnt(8)
  v_add_f32 v103, v230, v231
  v_add_f32 v102, v228, v229
  v_max3_f32 v62, v62, abs(v102), abs(v103)
  s_waitcnt lgkmcnt(4)
  v_add_f32 v105, v234, v235
  v_add_f32 v104, v232, v233
  v_max3_f32 v62, v62, abs(v104), abs(v105)
  s_waitcnt lgkmcnt(0)
  v_add_f32 v107, v238, v239
  v_add_f32 v106, v236, v237
  v_max3_f32 v62, v62, abs(v106), abs(v107)
  s_cmp_lg_u32 s97, 0
  s_cbranch_scc1 L_uconv0
L_chunk1:
  ds_read_u16_d16_hi v216, v49 offset:24
  ds_read_u16_d16_hi v217, v49 offset:624
  ds_read_u16_d16_hi v218, v49 offset:240
  ds_read_u16_d16_hi v219, v49 offset:840
  ds_read_u16_d16_hi v220, v49 offset:456
  ds_read_u16_d16_hi v221, v49 offset:1056
  ds_read_u16_d16_hi v222, v60 offset:1296
  ds_read_u16_d16_hi v223, v61 offset:1296
  ds_read_u16_d16_hi v224, v52 offset:50
  ds_read_u16_d16_hi v225, v53 offset:1300
  ds_read_u16_d16_hi v226, v52 offset:674
  ds_read_u16_d16_hi v227, v53 offset:1324
  ds_read_u16_d16_hi v228, v52 offset:258
  ds_read_u16_d16_hi v229, v53 offset:1308
  ds_read_u16_d16_hi v230, v52 offset:882
  ds_read_u16_d16_hi v231, v53 offset:1332
  ds_read_u16_d16_hi v232, v52 offset:466
  ds_read_u16_d16_hi v233, v53 offset:1316
  ds_read_u16_d16_hi v234, v52 offset:1090
  ds_read_u16_d16_hi v235, v53 offset:1340
  s_waitcnt lgkmcnt(14)
  v_add_f32 v109, v218, v219
  v_add_f32 v108, v216, v217
  v_max3_f32 v62, v62, abs(v108), abs(v109)
  ds_read_u16_d16_hi v236, v54 offset:2
  ds_read_u16_d16_hi v237, v55 offset:52
  ds_read_u16_d16_hi v238, v54 offset:650
  ds_read_u16_d16_hi v239, v55 offset:700
  s_waitcnt lgkmcnt(14)
  v_add_f32 v111, v222, v223
  v_add_f32 v110, v220, v221
  v_max3_f32 v62, v62, abs(v110), abs(v111)
  ds_read_u16_d16_hi v216, v54 offset:26
  ds_read_u16_d16_hi v217, v55 offset:676
  ds_read_u16_d16_hi v218, v54 offset:626
  ds_read_u16_d16_hi v219, v55 offset:76
  s_waitcnt lgkmcnt(14)
  v_add_f32 v113, v226, v227
  v_add_f32 v112, v224, v225
  v_max3_f32 v62, v62, abs(v112), abs(v113)
  ds_read_u16_d16_hi v220, v54 offset:10
  ds_read_u16_d16_hi v221, v55 offset:260
  ds_read_u16_d16_hi v222, v54 offset:658
  ds_read_u16_d16_hi v223, v55 offset:908
  s_waitcnt lgkmcnt(14)
  v_add_f32 v115, v230, v231
  v_add_f32 v114, v228, v229
  v_max3_f32 v62, v62, abs(v114), abs(v115)
  ds_read_u16_d16_hi v224, v54 offset:34
  ds_read_u16_d16_hi v225, v55 offset:884
  ds_read_u16_d16_hi v226, v54 offset:634
  ds_read_u16_d16_hi v227, v55 offset:284
  s_waitcnt lgkmcnt(14)
  v_add_f32 v117, v234, v235
  v_add_f32 v116, v232, v233
  v_max3_f32 v62, v62, abs(v116), abs(v117)
  ds_read_u16_d16_hi v228, v54 offset:18
  ds_read_u16_d16_hi v229, v55 offset:468
  ds_read_u16_d16_hi v230, v54 offset:666
  ds_read_u16_d16_hi v231, v55 offset:1116
  s_waitcnt lgkmcnt(14)
  v_add_f32 v119, v238, v239
  v_add_f32 v118, v236, v237
  v_max3_f32 v62, v62, abs(v118), abs(v119)
  ds_read_u16_d16_hi v232, v54 offset:42
  ds_read_u16_d16_hi v233, v55 offset:1092
  ds_read_u16_d16_hi v234, v54 offset:642
  ds_read_u16_d16_hi v235, v55 offset:492
  s_waitcnt lgkmcnt(14)
  v_add_f32 v121, v218, v219
  v_add_f32 v120, v216, v217
  v_max3_f32 v62, v62, abs(v120), abs(v121)
  ds_read_u16_d16_hi v236, v54 offset:210
  ds_read_u16_d16_hi v237, v55 offset:60
  ds_read_u16_d16_hi v238, v54 offset:858
  ds_read_u16_d16_hi v239, v55 offset:708
  s_waitcnt lgkmcnt(14)
  v_add_f32 v123, v222, v223
  v_add_f32 v122, v220, v221
  v_max3_f32 v62, v62, abs(v122), abs(v123)
  s_waitcnt lgkmcnt(12)
  v_add_f32 v125, v226, v227
  v_add_f32 v124, v224, v225
  v_max3_f32 v62, v62, abs(v124), abs(v125)
  s_waitcnt lgkmcnt(8)
  v_add_f32 v127, v230, v231
  v_add_f32 v126, v228, v229
  v_max3_f32 v62, v62, abs(v126), abs(v127)
  s_waitcnt lgkmcnt(4)
  v_add_f32 v129, v234, v235
  v_add_f32 v128, v232, v233
  v_max3_f32 v62, v62, abs(v128), abs(v129)
  s_waitcnt lgkmcnt(0)
  v_add_f32 v131, v238, v239
  v_add_f32 v130, v236, v237
  v_max3_f32 v62, v62, abs(v130), abs(v131)
  s_cmp_lg_u32 s97, 0
  s_cbranch_scc1 L_uconv1
  s_branch L_w1conv
L_chunk2:
  ds_read_u16_d16_hi v216, v54 offset:234
  ds_read_u16_d16_hi v217, v55 offset:684
  ds_read_u16_d16_hi v218, v54 offset:834
  ds_read_u16_d16_hi v219, v55 offset:84
  ds_read_u16_d16_hi v220, v54 offset:218
  ds_read_u16_d16_hi v221, v55 offset:268
  ds_read_u16_d16_hi v222, v54 offset:866
  ds_read_u16_d16_hi v223, v55 offset:916
  ds_read_u16_d16_hi v224, v54 offset:242
  ds_read_u16_d16_hi v225, v55 offset:892
  ds_read_u16_d16_hi v226, v54 offset:842
  ds_read_u16_d16_hi v227, v55 offset:292
  ds_read_u16_d16_hi v228, v54 offset:226
  ds_read_u16_d16_hi v229, v55 offset:476
  ds_read_u16_d16_hi v230, v54 offset:874
  ds_read_u16_d16_hi v231, v55 offset:1124
  ds_read_u16_d16_hi v232, v54 offset:250
  ds_read_u16_d16_hi v233, v55 offset:1100
  ds_read_u16_d16_hi v234, v54 offset:850
  ds_read_u16_d16_hi v235, v55 offset:500
  s_waitcnt lgkmcnt(14)
  v_add_f32 v85, v218, v219
  v_add_f32 v84, v216, v217
  v_max3_f32 v62, v62, abs(v84), abs(v85)
  ds_read_u16_d16_hi v236, v54 offset:418
  ds_read_u16_d16_hi v237, v55 offset:68
  ds_read_u16_d16_hi v238, v54 offset:1066
  ds_read_u16_d16_hi v239, v55 offset:716
  s_waitcnt lgkmcnt(14)
  v_add_f32 v87, v222, v223
  v_add_f32 v86, v220, v221
  v_max3_f32 v62, v62, abs(v86), abs(v87)
  ds_read_u16_d16_hi v216, v54 offset:442
  ds_read_u16_d16_hi v217, v55 offset:692
  ds_read_u16_d16_hi v218, v54 offset:1042
  ds_read_u16_d16_hi v219, v55 offset:92
  s_waitcnt lgkmcnt(14)
  v_add_f32 v89, v226, v227
  v_add_f32 v88, v224, v225
  v_max3_f32 v62, v62, abs(v88), abs(v89)
  ds_read_u16_d16_hi v220, v54 offset:426
  ds_read_u16_d16_hi v221, v55 offset:276
  ds_read_u16_d16_hi v222, v54 offset:1074
  ds_read_u16_d16_hi v223, v55 offset:924
  s_waitcnt lgkmcnt(14)
  v_add_f32 v91, v230, v231
  v_add_f32 v90, v228, v229
  v_max3_f32 v62, v62, abs(v90), abs(v91)
  ds_read_u16_d16_hi v224, v54 offset:450
  ds_read_u16_d16_hi v225, v55 offset:900
  ds_read_u16_d16_hi v226, v54 offset:1050
  ds_read_u16_d16_hi v227, v55 offset:300
  s_waitcnt lgkmcnt(14)
  v_add_f32 v93, v234, v235
  v_add_f32 v92, v232, v233
  v_max3_f32 v62, v62, abs(v92), abs(v93)
  ds_read_u16_d16_hi v228, v54 offset:434
  ds_read_u16_d16_hi v229, v55 offset:484
  ds_read_u16_d16_hi v230, v54 offset:1082
  ds_read_u16_d16_hi v231, v55 offset:1132
  s_waitcnt lgkmcnt(14)
  v_add_f32 v95, v238, v239
  v_add_f32 v94, v236, v237
  v_max3_f32 v62, v62, abs(v94), abs(v95)
  ds_read_u16_d16_hi v232, v54 offset:458
  ds_read_u16_d16_hi v233, v55 offset:1108
  ds_read_u16_d16_hi v234, v54 offset:1058
  ds_read_u16_d16_hi v235, v55 offset:508
  s_waitcnt lgkmcnt(14)
  v_add_f32 v97, v218, v219
  v_add_f32 v96, v216, v217
  v_max3_f32 v62, v62, abs(v96), abs(v97)
  ds_read_u16_d16_hi v236, v56 offset:4
  ds_read_u16_d16_hi v237, v57 offset:104
  ds_read_u16_d16_hi v238, v58 offset:652
  ds_read_u16_d16_hi v239, v59 offset:752
  s_waitcnt lgkmcnt(14)
  v_add_f32 v99, v222, v223
  v_add_f32 v98, v220, v221
  v_max3_f32 v62, v62, abs(v98), abs(v99)
  s_waitcnt lgkmcnt(12)
  v_add_f32 v101, v226, v227
  v_add_f32 v100, v224, v225
  v_max3_f32 v62, v62, abs(v100), abs(v101)
  s_waitcnt lgkmcnt(8)
  v_add_f32 v103, v230, v231
  v_add_f32 v102, v228, v229
  v_max3_f32 v62, v62, abs(v102), abs(v103)
  s_waitcnt lgkmcnt(4)
  v_add_f32 v105, v234, v235
  v_add_f32 v104, v232, v233
  v_max3_f32 v62, v62, abs(v104), abs(v105)
  s_waitcnt lgkmcnt(0)
  v_add_f32 v107, v238, v239
  v_add_f32 v106, v236, v237
  v_max3_f32 v62, v62, abs(v106), abs(v107)
  s_cmp_lg_u32 s97, 0
  s_cbranch_scc1 L_uconv0
L_chunk3:
  ds_read_u16_d16_hi v216, v56 offset:220
  ds_read_u16_d16_hi v217, v57 offset:320
  ds_read_u16_d16_hi v218, v58 offset:868
  ds_read_u16_d16_hi v219, v59 offset:968
  ds_read_u16_d16_hi v220, v56 offset:436
  ds_read_u16_d16_hi v221, v57 offset:536
  ds_read_u16_d16_hi v222, v58 offset:1084
  ds_read_u16_d16_hi v223, v59 offset:1184
  ds_read_u16_d16_hi v224, v56 offset:12
  ds_read_u16_d16_hi v225, v57 offset:312
  ds_read_u16_d16_hi v226, v58 offset:660
  ds_read_u16_d16_hi v227, v59 offset:960
  ds_read_u16_d16_hi v228, v58 offset:36
  ds_read_u16_d16_hi v229, v59 offset:936
  ds_read_u16_d16_hi v230, v56 offset:636
  ds_read_u16_d16_hi v231, v57 offset:336
  ds_read_u16_d16_hi v232, v56 offset:20
  ds_read_u16_d16_hi v233, v57 offset:520
  ds_read_u16_d16_hi v234, v58 offset:668
  ds_read_u16_d16_hi v235, v59 offset:1168
  s_waitcnt lgkmcnt(14)
  v_add_f32 v109, v218, v219
  v_add_f32 v108, v216, v217
  v_max3_f32 v62, v62, abs(v108), abs(v109)
  ds_read_u16_d16_hi v236, v58 offset:44
  ds_read_u16_d16_hi v237, v59 offset:1144
  ds_read_u16_d16_hi v238, v56 offset:644
  ds_read_u16_d16_hi v239, v57 offset:544
  s_waitcnt lgkmcnt(14)
  v_add_f32 v111, v222, v223
  v_add_f32 v110, v220, v221
  v_max3_f32 v62, v62, abs(v110), abs(v111)
  ds_read_u16_d16_hi v216, v56 offset:228
  ds_read_u16_d16_hi v217, v57 offset:528
  ds_read_u16_d16_hi v218, v58 offset:876
  ds_read_u16_d16_hi v219, v59 offset:1176
  s_waitcnt lgkmcnt(14)
  v_add_f32 v113, v226, v227
  v_add_f32 v112, v224, v225
  v_max3_f32 v62, v62, abs(v112), abs(v113)
  ds_read_u16_d16_hi v220, v58 offset:252
  ds_read_u16_d16_hi v221, v59 offset:1152
  ds_read_u16_d16_hi v222, v56 offset:852
  ds_read_u16_d16_hi v223, v57 offset:552
  s_waitcnt lgkmcnt(14)
  v_add_f32 v115, v230, v231
  v_add_f32 v114, v228, v229
  v_max3_f32 v62, v62, abs(v114), abs(v115)
  ds_read_u16_d16_hi v224, v65 offset:0
  ds_read_u16_d16_hi v225, v65 offset:8
  ds_read_u16_d16_hi v226, v65 offset:16
  ds_read_u16_d16_hi v227, v65 offset:24
  ds_read_u16_d16_hi v228, v65 offset:32
  ds_read_u16_d16_hi v229, v65 offset:40
  ds_read_u16_d16_hi v230, v64 offset:48
  ds_read_u16_d16_hi v231, v67
  s_waitcnt lgkmcnt(14)
  v_add_f32 v117, v234, v235
  v_add_f32 v116, v232, v233
  v_max3_f32 v62, v62, abs(v116), abs(v117)
  v_add_f32 v119, v238, v239
  v_add_f32 v118, v236, v237
  v_max3_f32 v62, v62, abs(v118), abs(v119)
  s_waitcnt lgkmcnt(12)
  v_add_f32 v121, v218, v219
  v_add_f32 v120, v216, v217
  v_max3_f32 v62, v62, abs(v120), abs(v121)
  s_waitcnt lgkmcnt(8)
  v_add_f32 v123, v222, v223
  v_add_f32 v122, v220, v221
  v_max3_f32 v62, v62, abs(v122), abs(v123)
  s_cmp_lg_u32 s97, 0
  s_cbranch_scc1 L_uconv1
L_w1conv:
  v_max_u32_dpp v62, v62, v62 row_shr:1 row_mask:0xf bank_mask:0xf
  s_nop 1
  v_max_u32_dpp v62, v62, v62 row_shr:2 row_mask:0xf bank_mask:0xf
  s_nop 1
  v_max_u32_dpp v62, v62, v62 row_shr:4 row_mask:0xf bank_mask:0xf
  s_nop 1
  v_max_u32_dpp v62, v62, v62 row_shr:8 row_mask:0xf bank_mask:0xf
  s_nop 1
  v_max_u32_dpp v62, v62, v62 row_bcast:15 row_mask:0xa bank_mask:0xf
  s_nop 1
  v_max_u32_dpp v62, v62, v62 row_bcast:31 row_mask:0xc bank_mask:0xf
  s_nop 0
  v_readlane_b32 s68, v62, 63
  s_nop 1
  v_mov_b32 v62, s68
  ds_max_u32 v1, v62 offset:20
  ds_add_u32 v1, v3 offset:16
  v_add_u32 v49, v49, v247
  v_add_u32 v50, v50, v247
  v_add_u32 v51, v51, v247
  v_add_u32 v52, v52, v247
  v_add_u32 v53, v53, v247
  v_add_u32 v54, v54, v247
  v_add_u32 v55, v55, v247
  v_add_u32 v56, v56, v247
  v_add_u32 v57, v57, v247
  v_add_u32 v58, v58, v247
  v_add_u32 v59, v59, v247
  v_add_u32 v60, v60, v247
  v_add_u32 v61, v61, v247
L_csync5:
  ds_read_b64 v[40:41], v2 offset:16
  s_waitcnt lgkmcnt(0)
  v_cmp_gt_u32 vcc, 4, v40
  s_cbranch_vccnz L_csync5
  v_readfirstlane_b32 s70, v41
  s_nop 0
  s_lshr_b32 s70, s70, 23
  s_sub_i32 s70, 141, s70
  s_min_i32 s70, s70, 40
  s_add_i32 s51, s70, 127
  s_lshl_b32 s51, s51, 23
  v_fma_mixlo_f16 v132, v84, s51, 0
  v_fma_mixlo_f16 v133, v86, s51, 0
  v_fma_mixlo_f16 v134, v88, s51, 0
  v_fma_mixlo_f16 v135, v90, s51, 0
  v_fma_mixhi_f16 v132, v85, s51, 0
  v_fma_mixhi_f16 v133, v87, s51, 0
  v_fma_mixhi_f16 v134, v89, s51, 0
  v_fma_mixhi_f16 v135, v91, s51, 0
  v_fma_mixlo_f16 v136, v92, s51, 0
  v_fma_mixlo_f16 v137, v94, s51, 0
  v_fma_mixlo_f16 v138, v96, s51, 0
  v_fma_mixlo_f16 v139, v98, s51, 0
  v_fma_mixhi_f16 v136, v93, s51, 0
  v_fma_mixhi_f16 v137, v95, s51, 0
  v_fma_mixhi_f16 v138, v97, s51, 0
  v_fma_mixhi_f16 v139, v99, s51, 0
  ds_write_b128 v63, v[132:135] offset:0
  v_fma_mixlo_f16 v140, v100, s51, 0
  v_fma_mixlo_f16 v141, v102, s51, 0
  v_fma_mixlo_f16 v142, v104, s51, 0
  v_fma_mixlo_f16 v143, v106, s51, 0
  v_fma_mixhi_f16 v140, v101, s51, 0
  v_fma_mixhi_f16 v141, v103, s51, 0
  v_fma_mixhi_f16 v142, v105, s51, 0
  v_fma_mixhi_f16 v143, v107, s51, 0
  ds_write_b128 v63, v[136:139] offset:1024
  v_fma_mixlo_f16 v144, v108, s51, 0
  v_fma_mixlo_f16 v145, v110, s51, 0
  v_fma_mixlo_f16 v146, v112, s51, 0
  v_fma_mixlo_f16 v147, v114, s51, 0
  v_fma_mixhi_f16 v144, v109, s51, 0
  v_fma_mixhi_f16 v145, v111, s51, 0
  v_fma_mixhi_f16 v146, v113, s51, 0
  v_fma_mixhi_f16 v147, v115, s51, 0
  ds_write_b128 v63, v[140:143] offset:2048
  v_fma_mixlo_f16 v148, v116, s51, 0
  v_fma_mixlo_f16 v149, v118, s51, 0
  v_fma_mixlo_f16 v150, v120, s51, 0
  v_fma_mixlo_f16 v151, v122, s51, 0
  v_fma_mixhi_f16 v148, v117, s51, 0
  v_fma_mixhi_f16 v149, v119, s51, 0
  v_fma_mixhi_f16 v150, v121, s51, 0
  v_fma_mixhi_f16 v151, v123, s51, 0
  ds_write_b128 v63, v[144:147] offset:3072
  ds_write_b128 v63, v[148:151] offset:4096
  s_cmp_ge_u32 s79, 2
  s_cbranch_scc1 L_w1x
  v_fma_mixlo_f16 v152, v124, s51, 0
  v_fma_mixlo_f16 v153, v126, s51, 0
  v_fma_mixlo_f16 v154, v128, s51, 0
  v_fma_mixlo_f16 v155, v130, s51, 0
  v_fma_mixhi_f16 v152, v125, s51, 0
  v_fma_mixhi_f16 v153, v127, s51, 0
  v_fma_mixhi_f16 v154, v129, s51, 0
  v_fma_mixhi_f16 v155, v131, s51, 0
  ds_write_b128 v63, v[152:155] offset:5120
L_w1x:
L_uph:
L_csync6:
  ds_read_b64 v[40:41], v2 offset:24
  s_waitcnt lgkmcnt(0)
  v_cmp_gt_u32 vcc, 4, v40
  s_cbranch_vccnz L_csync6
  v_readfirstlane_b32 s71, v41
  s_nop 0
  s_lshr_b32 s71, s71, 23
  s_sub_i32 s71, 140, s71
  s_min_i32 s71, s71, 40
  s_add_i32 s51, s71, 127
  s_lshl_b32 s51, s51, 23
  s_mov_b32 s97, 1
  s_lshr_b32 s69, s3, 1
  s_cmp_eq_u32 s69, 0
  s_cbranch_scc1 L_chunk0
  s_cmp_eq_u32 s69, 1
  s_cbranch_scc1 L_chunk1
  s_cmp_eq_u32 s69, 2
  s_cbranch_scc1 L_chunk2
  s_branch L_chunk3
L_uconv0:
  v_fma_mixlo_f16 v132, v84, s51, 0
  v_fma_mixlo_f16 v133, v86, s51, 0
  v_fma_mixlo_f16 v134, v88, s51, 0
  v_fma_mixlo_f16 v135, v90, s51, 0
  v_fma_mixhi_f16 v132, v85, s51, 0
  v_fma_mixhi_f16 v133, v87, s51, 0
  v_fma_mixhi_f16 v134, v89, s51, 0
  v_fma_mixhi_f16 v135, v91, s51, 0
L_csync7:
  ds_read_b64 v[40:41], v2 offset:16
  s_waitcnt lgkmcnt(0)
  v_cmp_gt_u32 vcc, 4, v40
  s_cbranch_vccnz L_csync7
  v_readfirstlane_b32 s70, v41
  s_nop 0
  s_lshr_b32 s70, s70, 23
  s_sub_i32 s70, 141, s70
  s_min_i32 s70, s70, 40
  ds_write_b128 v66, v[132:135] offset:0
  v_fma_mixlo_f16 v136, v92, s51, 0
  v_fma_mixlo_f16 v137, v94, s51, 0
  v_fma_mixlo_f16 v138, v96, s51, 0
  v_fma_mixlo_f16 v139, v98, s51, 0
  v_fma_mixhi_f16 v136, v93, s51, 0
  v_fma_mixhi_f16 v137, v95, s51, 0
  v_fma_mixhi_f16 v138, v97, s51, 0
  v_fma_mixhi_f16 v139, v99, s51, 0
  ds_write_b128 v66, v[136:139] offset:1024
  v_fma_mixlo_f16 v140, v100, s51, 0
  v_fma_mixlo_f16 v141, v102, s51, 0
  v_fma_mixlo_f16 v142, v104, s51, 0
  v_fma_mixlo_f16 v143, v106, s51, 0
  v_fma_mixhi_f16 v140, v101, s51, 0
  v_fma_mixhi_f16 v141, v103, s51, 0
  v_fma_mixhi_f16 v142, v105, s51, 0
  v_fma_mixhi_f16 v143, v107, s51, 0
  ds_write_b128 v66, v[140:143] offset:2048
  s_branch L_built
L_uconv1:
  v_fma_mixlo_f16 v144, v108, s51, 0
  v_fma_mixlo_f16 v145, v110, s51, 0
  v_fma_mixlo_f16 v146, v112, s51, 0
  v_fma_mixlo_f16 v147, v114, s51, 0
  v_fma_mixhi_f16 v144, v109, s51, 0
  v_fma_mixhi_f16 v145, v111, s51, 0
  v_fma_mixhi_f16 v146, v113, s51, 0
  v_fma_mixhi_f16 v147, v115, s51, 0
L_csync8:
  ds_read_b64 v[40:41], v2 offset:16
  s_waitcnt lgkmcnt(0)
  v_cmp_gt_u32 vcc, 4, v40
  s_cbranch_vccnz L_csync8
  v_readfirstlane_b32 s70, v41
  s_nop 0
  s_lshr_b32 s70, s70, 23
  s_sub_i32 s70, 141, s70
  s_min_i32 s70, s70, 40
  ds_write_b128 v66, v[144:147] offset:3072
  v_fma_mixlo_f16 v148, v116, s51, 0
  v_fma_mixlo_f16 v149, v118, s51, 0
  v_fma_mixlo_f16 v150, v120, s51, 0
  v_fma_mixlo_f16 v151, v122, s51, 0
  v_fma_mixhi_f16 v148, v117, s51, 0
  v_fma_mixhi_f16 v149, v119, s51, 0
  v_fma_mixhi_f16 v150, v121, s51, 0
  v_fma_mixhi_f16 v151, v123, s51, 0
  ds_write_b128 v66, v[148:151] offset:4096
  s_cmp_lg_u32 s84, 0
  s_cbranch_scc1 L_ulin
  v_fma_mixlo_f16 v152, v124, s51, 0
  v_fma_mixlo_f16 v153, v126, s51, 0
  v_fma_mixlo_f16 v154, v128, s51, 0
  v_fma_mixlo_f16 v155, v130, s51, 0
  v_fma_mixhi_f16 v152, v125, s51, 0
  v_fma_mixhi_f16 v153, v127, s51, 0
  v_fma_mixhi_f16 v154, v129, s51, 0
  v_fma_mixhi_f16 v155, v131, s51, 0
  ds_write_b128 v66, v[152:155] offset:5120
  s_branch L_built
L_ulin:
  v_mul_f32 v224, s51, v224
  v_mul_f32 v225, s51, v225
  v_mul_f32 v226, s51, v226
  v_mul_f32 v227, s51, v227
  v_mul_f32 v228, s51, v228
  v_mul_f32 v229, s51, v229
  v_mul_f32 v230, s51, v230
  v_mul_f32 v231, s51, v231
  v_cvt_pk_bf16_f32 v152, v224, v225
  v_cvt_pk_bf16_f32 v153, v226, v227
  v_cvt_pk_bf16_f32 v154, v228, v229
  v_cvt_pk_bf16_f32 v155, v230, v231
  ds_write_b128 v66, v[152:155] offset:5120
L_built:
  s_waitcnt vmcnt(1)
  v_mov_b32 v4, s84
  ds_add_u32 v1, v4 offset:36
  s_mov_b32 s60, s24
  s_and_b32 s61, s25, 0xffff
  s_mov_b32 s62, 268435456
  s_mov_b32 s63, 0x20000
  s_mov_b32 s64, s22
  s_and_b32 s65, s23, 0xffff
  s_mov_b32 s66, 256
  s_mov_b32 s67, 0x20000
  v_lshlrev_b32 v251, 2, v0
  s_mov_b64 exec, 0xff
  s_mov_b32 s81, 0x80000
  buffer_load_dword v255, v251, s[60:63], s81 offen
  buffer_load_dword v249, v251, s[64:67], 0 offen offset:128 sc1
  s_mov_b64 exec, -1
  v_mov_b32 v251, 0
  s_add_i32 s48, s70, s71
L_csync9:
  ds_read_b32 v4, v2 offset:36
  s_waitcnt lgkmcnt(0)
  v_cmp_gt_u32 vcc, 4, v4
  s_cbranch_vccnz L_csync9
  ds_read_u16_d16_hi v32, v7 offset:0
  ds_read_u16_d16_hi v33, v7 offset:128
  ds_read_u16_d16_hi v34, v7 offset:256
  ds_read_u16_d16_hi v35, v7 offset:384
  ds_read_u16_d16_hi v36, v7 offset:512
  ds_read_u16_d16_hi v37, v7 offset:640
  ds_read_u16_d16_hi v38, v7 offset:768
  ds_read_u16_d16_hi v39, v7 offset:896
  s_waitcnt lgkmcnt(0)
  v_cvt_pk_f16_f32 v43, v38, v39
  v_cvt_pk_f16_f32 v40, v32, v35
  v_cvt_pk_f16_f32 v41, v33, v36
  v_cvt_pk_f16_f32 v42, v34, v37
  ds_write_b128 v10, v[40:43]
  ds_read_b128 v[44:47], v11
  ds_read_b128 v[48:51], v12
  ds_read_b64_tr_b16 v[52:53], v8 offset:0
  ds_read_b64_tr_b16 v[54:55], v8 offset:512
  v_pk_mul_f16 v56, v40, v40 op_sel:[0,0] op_sel_hi:[1,1]
  v_pk_mul_f16 v57, v41, v41 op_sel:[0,0] op_sel_hi:[1,1]
  v_pk_mul_f16 v58, v42, v42 op_sel:[0,0] op_sel_hi:[1,1]
  v_pk_mul_f16 v59, v40, v41 op_sel:[0,0] op_sel_hi:[1,1]
  ds_read_u16_d16_hi v32, v7 offset:32
  ds_read_u16_d16_hi v33, v7 offset:160
  s_waitcnt vmcnt(3)
  v_lshlrev_b32 v21, 7, v21
  buffer_load_dword v255, v21, s[32:35], 0 offen
  s_mov_b64 exec, 131071
  buffer_load_dword v255, v19, s[44:47], s101 offen
  s_mov_b64 exec, -1
  s_add_u32 s101, s101, 1171456
  s_waitcnt lgkmcnt(0)
  s_barrier
  s_setprio 1
  ds_read_b128 v[240:243], v28 offset:46528
  ds_read_b128 v[128:131], v28 offset:35264
  ds_read_b128 v[84:87], v28 offset:0
  ds_read_b128 v[216:219], v22
  ds_read_b128 v[244:247], v30 offset:22528
  ds_read_b128 v[172:175], v31 offset:11264
  ds_read_b128 v[176:179], v31 offset:12288
  ds_read_b128 v[180:183], v31 offset:13312
  ds_read2_b32 v[220:221], v29 offset0:0 offset1:2
  ds_read2_b32 v[222:223], v29 offset0:64 offset1:66
  v_add_u32 v29, 2048, v29
  ds_read_b128 v[88:91], v28 offset:1024
  ds_read_b128 v[92:95], v28 offset:2048
  ds_read_b128 v[132:135], v28 offset:36288
  ds_read_b128 v[136:139], v28 offset:37312
  ds_read_b128 v[140:143], v28 offset:38336
  ds_read_b128 v[144:147], v28 offset:39360
  ds_read2_b32 v[224:225], v29 offset0:0 offset1:2
  ds_read2_b32 v[226:227], v29 offset0:64 offset1:66
  v_add_u32 v29, 2048, v29
  s_cmp_lg_u32 s84, 0
  s_cbranch_scc1 L_prf
  s_setprio 2
L_prf:
  s_waitcnt lgkmcnt(14)
  v_mfma_f32_16x16x32_bf16 v[72:75], v[240:243], v[52:55], 0
  ds_read_b128 v[184:187], v31 offset:14336
  v_mfma_f32_16x16x32_f16 v[72:75], v[128:131], v[56:59], v[72:75]
  ds_read_b128 v[188:191], v31 offset:15360
  v_mfma_f32_16x16x32_f16 v[68:71], v[84:87], v[56:59], 0
  ds_read_b128 v[96:99], v28 offset:3072
  v_pk_mul_f16 v60, v40, v41 op_sel:[0,1] op_sel_hi:[1,0]
  v_mfma_f32_16x16x32_f16 v[80:83], v[216:219], v[56:59], 0
  ds_read_b128 v[100:103], v28 offset:4096
  v_pk_mul_f16 v61, v40, v42 op_sel:[0,0] op_sel_hi:[1,1]
  v_pk_mul_f16 v62, v40, v42 op_sel:[0,1] op_sel_hi:[1,0]
  s_waitcnt lgkmcnt(14)
  v_mfma_f32_16x16x32_bf16 v[76:79], v[244:247], v[52:55], 0
  ds_read_b128 v[104:107], v28 offset:5120
  v_pk_mul_f16 v63, v41, v42 op_sel:[0,0] op_sel_hi:[1,1]
  v_pk_mul_f16 v64, v41, v42 op_sel:[0,1] op_sel_hi:[1,0]
  v_mfma_f32_16x16x32_f16 v[76:79], v[172:175], v[56:59], v[76:79]
  ds_read_b128 v[108:111], v28 offset:6144
  v_pk_mul_f16 v65, v40, v43 op_sel:[0,0] op_sel_hi:[1,0]
  v_pk_mul_f16 v66, v41, v43 op_sel:[0,0] op_sel_hi:[1,0]
  v_pk_mul_f16 v67, v42, v43 op_sel:[0,0] op_sel_hi:[1,0]
  v_mfma_f32_16x16x32_f16 v[76:79], v[176:179], v[60:63], v[76:79]
  ds_read2_b32 v[228:229], v29 offset0:0 offset1:2
  ds_read2_b32 v[230:231], v29 offset0:64 offset1:66
  v_add_u32 v29, 2048, v29
  v_alignbit_b32 v48, v48, v48, v13
  v_mfma_f32_16x16x32_f16 v[76:79], v[180:183], v[64:67], v[76:79]
  ds_read_b128 v[148:151], v28 offset:40384
  v_mul_f16_sdwa v52, v40, v40 dst_sel:WORD_0 dst_unused:UNUSED_PAD src0_sel:WORD_0 src1_sel:WORD_1
  v_mul_f16_sdwa v53, v42, v42 dst_sel:WORD_0 dst_unused:UNUSED_PAD src0_sel:WORD_0 src1_sel:WORD_1
  s_waitcnt lgkmcnt(14)
  v_smfmac_f32_16x16x64_f16 v[80:83], v[220:223], v[60:67], v16
  ds_read_b128 v[152:155], v28 offset:41408
  v_alignbit_b32 v49, v49, v49, v13
  v_mfma_f32_16x16x32_f16 v[68:71], v[88:91], v[60:63], v[68:71]
  ds_read_b128 v[192:195], v31 offset:16384
  v_mul_f16_sdwa v52, v41, v41 dst_sel:WORD_1 dst_unused:UNUSED_PRESERVE src0_sel:WORD_0 src1_sel:WORD_1
  v_mul_f16_sdwa v53, v43, v43 dst_sel:WORD_1 dst_unused:UNUSED_PRESERVE src0_sel:WORD_0 src1_sel:WORD_1
  v_mfma_f32_16x16x32_f16 v[68:71], v[92:95], v[64:67], v[68:71]
  ds_read_b128 v[196:199], v31 offset:17408
  v_pk_mul_f16 v54, v40, v47 op_sel:[0,0] op_sel_hi:[1,0]
  v_mfma_f32_16x16x32_f16 v[72:75], v[132:135], v[60:63], v[72:75]
  ds_read_b128 v[200:203], v31 offset:18432
  v_pk_mul_f16 v55, v41, v47 op_sel:[0,0] op_sel_hi:[1,0]
  v_pk_mul_f16 v56, v42, v47 op_sel:[0,0] op_sel_hi:[1,0]
  s_waitcnt lgkmcnt(14)
  v_mfma_f32_16x16x32_f16 v[72:75], v[136:139], v[64:67], v[72:75]
  ds_read_b128 v[204:207], v31 offset:19456
  v_pk_mul_f16 v57, v40, v44 op_sel:[0,0] op_sel_hi:[1,1]
  v_pk_mul_f16 v58, v40, v44 op_sel:[0,1] op_sel_hi:[1,0]
  v_pk_mul_f16 v59, v40, v45 op_sel:[0,0] op_sel_hi:[1,1]
  v_mfma_f32_16x16x32_f16 v[72:75], v[140:143], v[52:55], v[72:75]
  ds_read2_b32 v[232:233], v29 offset0:0 offset1:2
  ds_read2_b32 v[234:235], v29 offset0:64 offset1:66
  v_add_u32 v29, 2048, v29
  v_pk_mul_f16 v60, v40, v45 op_sel:[0,1] op_sel_hi:[1,0]
  v_mfma_f32_16x16x32_f16 v[72:75], v[144:147], v[56:59], v[72:75]
  ds_read_b128 v[156:159], v28 offset:42432
  v_pk_mul_f16 v61, v40, v46 op_sel:[0,0] op_sel_hi:[1,1]
  v_pk_mul_f16 v62, v40, v46 op_sel:[0,1] op_sel_hi:[1,0]
  s_waitcnt lgkmcnt(14)
  v_smfmac_f32_16x16x64_f16 v[80:83], v[224:227], v[52:59], v16
  ds_read_b128 v[160:163], v28 offset:43456
  v_pk_mul_f16 v63, v41, v44 op_sel:[0,0] op_sel_hi:[1,1]
  v_mfma_f32_16x16x32_f16 v[76:79], v[184:187], v[52:55], v[76:79]
  ds_read_b128 v[112:115], v28 offset:7168
  v_pk_mul_f16 v64, v41, v44 op_sel:[0,1] op_sel_hi:[1,0]
  v_pk_mul_f16 v65, v41, v45 op_sel:[0,0] op_sel_hi:[1,1]
  v_mfma_f32_16x16x32_f16 v[76:79], v[188:191], v[56:59], v[76:79]
  ds_read_b128 v[116:119], v28 offset:8192
  v_pk_mul_f16 v66, v41, v45 op_sel:[0,1] op_sel_hi:[1,0]
  v_mfma_f32_16x16x32_f16 v[68:71], v[96:99], v[52:55], v[68:71]
  ds_read_b128 v[120:123], v28 offset:9216
  v_pk_mul_f16 v67, v41, v46 op_sel:[0,0] op_sel_hi:[1,1]
  ds_write_b16 v15, v14 offset:4064
  s_and_b32 s81, s2, 7
  s_waitcnt vmcnt(2)
  v_cmp_eq_u32 vcc, 0, v249
  s_nop 0
  s_bitcmp1_b32 vcc_lo, s81
  s_cbranch_scc0 L_cclr_ok
  s_mov_b32 s78, 0x40000
L_cclr:
  s_sub_u32 s78, s78, 1
  s_cbranch_scc1 L_cclr_ok
  v_lshlrev_b32 v249, 2, v0
  v_and_b32 v249, 31, v249
  buffer_load_dword v249, v249, s[64:67], 0 offen offset:128 sc1
  s_waitcnt vmcnt(0)
  v_cmp_eq_u32 vcc, 0, v249
  s_nop 0
  s_bitcmp1_b32 vcc_lo, s81
  s_cbranch_scc1 L_cclr
L_cclr_ok:
  v_lshl_add_u32 v24, v24, 7, v18
  v_lshl_add_u32 v25, v25, 7, v18
  s_mov_b32 exec_hi, 0x0000ffff
  v_lshl_add_u32 v26, v26, 7, v18
  v_lshl_add_u32 v27, v27, 7, v18
  s_mov_b32 exec_lo, 0
  s_mov_b32 exec_hi, 0xffff0000
  v_mov_b32 v27, v25
  v_mov_b32 v26, v25
  s_mov_b32 exec_hi, 0x00ff0000
  v_mov_b32 v26, v24
  s_mov_b64 exec, -1
  s_add_u32 m0, s74, -39488
  s_nop 0
  buffer_load_dwordx4 v24, s[32:35], 0 offen lds
  s_add_u32 m0, s74, -38432
  s_nop 0
  buffer_load_dwordx4 v25, s[32:35], 0 offen lds
  s_add_u32 m0, s74, -37376
  s_nop 0
  buffer_load_dwordx4 v26, s[32:35], 0 offen lds
  s_add_u32 m0, s74, -36320
  s_mov_b32 exec_hi, 0x00ffffff
  buffer_load_dwordx4 v27, s[32:35], 0 offen lds
  s_mov_b32 exec_hi, -1
  s_mov_b64 exec, 131071
  buffer_load_dword v255, v19, s[44:47], s101 offen
  s_mov_b64 exec, -1
  s_add_u32 s101, s101, 1171456
  s_sub_i32 s48, 0, s48
  s_mov_b32 s49, s48
  s_mov_b32 s97, 1
  s_mov_b32 s50, 1
  s_mov_b32 s96, 0
  s_cmp_lg_u32 s3, 7
  s_cbranch_scc1 L_nw0
  s_mov_b32 s52, s16
  s_and_b32 s53, s17, 0xffff
  s_mov_b32 s54, 3328
  s_mov_b32 s55, 0x20000
  v_lshlrev_b32 v22, 7, v0
  buffer_load_dword v255, v22, s[52:55], 0 offen
L_nw0:
  v_alignbit_b32 v50, v50, v50, v13
  s_waitcnt lgkmcnt(14)
  v_mfma_f32_16x16x32_f16 v[68:71], v[100:103], v[56:59], v[68:71]
  ds_read_b128 v[124:127], v28 offset:10240
  v_pk_mul_f16 v52, v41, v46 op_sel:[0,1] op_sel_hi:[1,0]
  v_pk_mul_f16 v53, v42, v44 op_sel:[0,0] op_sel_hi:[1,1]
  v_mfma_f32_16x16x32_f16 v[68:71], v[104:107], v[60:63], v[68:71]
  ds_read_b128 v[164:167], v28 offset:44480
  v_pk_mul_f16 v54, v42, v44 op_sel:[0,1] op_sel_hi:[1,0]
  v_pk_mul_f16 v55, v42, v45 op_sel:[0,0] op_sel_hi:[1,1]
  v_mfma_f32_16x16x32_f16 v[68:71], v[108:111], v[64:67], v[68:71]
  ds_read_b128 v[168:171], v28 offset:45504
  v_pk_mul_f16 v56, v42, v45 op_sel:[0,1] op_sel_hi:[1,0]
  v_pk_mul_f16 v57, v42, v46 op_sel:[0,0] op_sel_hi:[1,1]
  v_smfmac_f32_16x16x64_f16 v[80:83], v[228:231], v[60:67], v16
  ds_read2_b32 v[236:237], v29 offset0:0 offset1:2
  ds_read2_b32 v[238:239], v29 offset0:64 offset1:66
  v_add_u32 v29, 2048, v29
  v_pk_mul_f16 v58, v42, v46 op_sel:[0,1] op_sel_hi:[1,0]
  v_pk_mul_f16 v59, v40, v48 op_sel:[0,0] op_sel_hi:[1,1]
  s_waitcnt lgkmcnt(14)
  v_mfma_f32_16x16x32_f16 v[72:75], v[148:151], v[60:63], v[72:75]
  ds_read_b128 v[208:211], v31 offset:20480
  ds_read_u16_d16_hi v34, v7 offset:288
  ds_read_u16_d16_hi v35, v7 offset:416
  v_mfma_f32_16x16x32_f16 v[72:75], v[152:155], v[64:67], v[72:75]
  ds_read_b128 v[212:215], v31 offset:21504
  ds_read_u16_d16_hi v36, v7 offset:544
  ds_read_u16_d16_hi v37, v7 offset:672
  v_mfma_f32_16x16x32_f16 v[76:79], v[192:195], v[60:63], v[76:79]
  ds_read_u16_d16_hi v38, v7 offset:800
  ds_read_u16_d16_hi v39, v7 offset:928
  v_mfma_f32_16x16x32_f16 v[76:79], v[196:199], v[64:67], v[76:79]
  v_pk_mul_f16 v60, v41, v49 op_sel:[0,0] op_sel_hi:[1,1]
  v_pk_mul_f16 v61, v42, v50 op_sel:[0,0] op_sel_hi:[1,1]
  v_mfma_f32_16x16x32_f16 v[76:79], v[200:203], v[52:55], v[76:79]
  v_pk_mul_f16 v62, v40, v49 op_sel:[0,0] op_sel_hi:[1,1]
  v_pk_mul_f16 v63, v40, v49 op_sel:[0,1] op_sel_hi:[1,0]
  s_waitcnt lgkmcnt(14)
  v_mfma_f32_16x16x32_f16 v[76:79], v[204:207], v[56:59], v[76:79]
  v_pk_mul_f16 v64, v40, v50 op_sel:[0,0] op_sel_hi:[1,1]
  v_pk_mul_f16 v65, v40, v50 op_sel:[0,1] op_sel_hi:[1,0]
  v_smfmac_f32_16x16x64_f16 v[80:83], v[232:235], v[52:59], v16
  v_pk_mul_f16 v66, v41, v50 op_sel:[0,0] op_sel_hi:[1,1]
  v_pk_mul_f16 v67, v41, v50 op_sel:[0,1] op_sel_hi:[1,0]
  v_mfma_f32_16x16x32_f16 v[72:75], v[156:159], v[52:55], v[72:75]
  s_waitcnt lgkmcnt(0)
  v_cvt_pk_f16_f32 v43, v38, v39
  v_mfma_f32_16x16x32_f16 v[72:75], v[160:163], v[56:59], v[72:75]
  v_cvt_pk_f16_f32 v40, v32, v35
  v_cvt_pk_f16_f32 v41, v33, v36
  v_mfma_f32_16x16x32_f16 v[68:71], v[112:115], v[52:55], v[68:71]
  v_cvt_pk_f16_f32 v42, v34, v37
  v_mfma_f32_16x16x32_f16 v[68:71], v[116:119], v[56:59], v[68:71]
  ds_write_b128 v10, v[40:43]
  v_mfma_f32_16x16x32_f16 v[68:71], v[120:123], v[60:63], v[68:71]
  v_mfma_f32_16x16x32_f16 v[68:71], v[124:127], v[64:67], v[68:71]
  ds_read_b128 v[44:47], v11
  ds_read_b128 v[48:51], v12
  v_mfma_f32_16x16x32_f16 v[72:75], v[164:167], v[60:63], v[72:75]
  ds_read_b64_tr_b16 v[52:53], v8 offset:32
  ds_read_b64_tr_b16 v[54:55], v8 offset:544
  v_mfma_f32_16x16x32_f16 v[72:75], v[168:171], v[64:67], v[72:75]
  v_pk_mul_f16 v56, v40, v40 op_sel:[0,0] op_sel_hi:[1,1]
  v_pk_mul_f16 v57, v41, v41 op_sel:[0,0] op_sel_hi:[1,1]
  v_smfmac_f32_16x16x64_f16 v[80:83], v[236:239], v[60:67], v16
  v_pk_mul_f16 v58, v42, v42 op_sel:[0,0] op_sel_hi:[1,1]
  v_pk_mul_f16 v59, v40, v41 op_sel:[0,0] op_sel_hi:[1,1]
  v_mfma_f32_16x16x32_f16 v[76:79], v[208:211], v[60:63], v[76:79]
  s_nop 1
  v_mul_f32 v14, v68, v72
  v_fmac_f32 v14, v69, v73
  v_mfma_f32_16x16x32_f16 v[76:79], v[212:215], v[64:67], v[76:79]
  v_fmac_f32 v14, v70, v74
  v_fmac_f32 v14, v71, v75
  ds_add_u32 v1, v3 offset:12
  s_branch L_grp1
L_prime:
  v_mov_b32 v68, 0
  v_mov_b32 v69, 0
  v_mov_b32 v70, 0
  v_mov_b32 v71, 0
  v_mov_b32 v72, 0
  v_mov_b32 v73, 0
  v_mov_b32 v74, 0
  v_mov_b32 v75, 0
  v_mov_b32 v76, 0
  v_mov_b32 v77, 0
  v_mov_b32 v78, 0
  v_mov_b32 v79, 0
  v_mov_b32 v80, 0
  v_mov_b32 v81, 0
  v_mov_b32 v82, 0
  v_mov_b32 v83, 0
  v_mov_b32 v22, 0
  v_mov_b32 v23, 0
  ds_read_u16_d16_hi v32, v7 offset:0
  ds_read_u16_d16_hi v33, v7 offset:128
  ds_read_u16_d16_hi v34, v7 offset:256
  ds_read_u16_d16_hi v35, v7 offset:384
  ds_read_u16_d16_hi v36, v7 offset:512
  ds_read_u16_d16_hi v37, v7 offset:640
  ds_read_u16_d16_hi v38, v7 offset:768
  ds_read_u16_d16_hi v39, v7 offset:896
  s_waitcnt lgkmcnt(0)
  v_cvt_pk_f16_f32 v43, v38, v39
  v_cvt_pk_f16_f32 v40, v32, v35
  v_cvt_pk_f16_f32 v41, v33, v36
  v_cvt_pk_f16_f32 v42, v34, v37
  ds_write_b128 v10, v[40:43]
  ds_read_b128 v[44:47], v11
  ds_read_b128 v[48:51], v12
  ds_read_b64_tr_b16 v[52:53], v8 offset:0
  ds_read_b64_tr_b16 v[54:55], v8 offset:512
  v_pk_mul_f16 v56, v40, v40 op_sel:[0,0] op_sel_hi:[1,1]
  v_pk_mul_f16 v57, v41, v41 op_sel:[0,0] op_sel_hi:[1,1]
  v_pk_mul_f16 v58, v42, v42 op_sel:[0,0] op_sel_hi:[1,1]
  v_pk_mul_f16 v59, v40, v41 op_sel:[0,0] op_sel_hi:[1,1]
  ds_read_u16_d16_hi v32, v7 offset:32
  ds_read_u16_d16_hi v33, v7 offset:160
L_cin_loop:
  s_cmp_lg_u32 s84, 0
  s_cbranch_scc1 L_pr0
  s_setprio 2
L_pr0:
  s_waitcnt lgkmcnt(2)
  v_mfma_f32_16x16x32_bf16 v[72:75], v[240:243], v[52:55], 0
  v_add_f32 v22, v80, v81
  v_add_f32 v23, v82, v83
  v_mfma_f32_16x16x32_f16 v[72:75], v[128:131], v[56:59], v[72:75]
  v_fmac_f32 v14, v76, v77
  v_fmac_f32 v14, v22, v78
  v_mfma_f32_16x16x32_f16 v[68:71], v[84:87], v[56:59], 0
  v_fmac_f32 v14, v23, v79
  v_pk_mul_f16 v60, v40, v41 op_sel:[0,1] op_sel_hi:[1,0]
  v_mfma_f32_16x16x32_f16 v[80:83], v[216:219], v[56:59], 0
  v_pk_mul_f16 v61, v40, v42 op_sel:[0,0] op_sel_hi:[1,1]
  v_pk_mul_f16 v62, v40, v42 op_sel:[0,1] op_sel_hi:[1,0]
  v_mfma_f32_16x16x32_bf16 v[76:79], v[244:247], v[52:55], 0
  v_pk_mul_f16 v63, v41, v42 op_sel:[0,0] op_sel_hi:[1,1]
  v_pk_mul_f16 v64, v41, v42 op_sel:[0,1] op_sel_hi:[1,0]
  v_mfma_f32_16x16x32_f16 v[76:79], v[172:175], v[56:59], v[76:79]
  v_pk_mul_f16 v65, v40, v43 op_sel:[0,0] op_sel_hi:[1,0]
  v_pk_mul_f16 v66, v41, v43 op_sel:[0,0] op_sel_hi:[1,0]
  v_pk_mul_f16 v67, v42, v43 op_sel:[0,0] op_sel_hi:[1,0]
  v_mfma_f32_16x16x32_f16 v[76:79], v[176:179], v[60:63], v[76:79]
  v_add_f32_dpp v14, v14, v14 row_shr:1 row_mask:0xf bank_mask:0xf
  v_alignbit_b32 v48, v48, v48, v13
  v_mfma_f32_16x16x32_f16 v[76:79], v[180:183], v[64:67], v[76:79]
  v_mul_f16_sdwa v52, v40, v40 dst_sel:WORD_0 dst_unused:UNUSED_PAD src0_sel:WORD_0 src1_sel:WORD_1
  v_mul_f16_sdwa v53, v42, v42 dst_sel:WORD_0 dst_unused:UNUSED_PAD src0_sel:WORD_0 src1_sel:WORD_1
  v_smfmac_f32_16x16x64_f16 v[80:83], v[220:223], v[60:67], v16
  v_add_f32_dpp v14, v14, v14 row_shr:2 row_mask:0xf bank_mask:0xf
  v_alignbit_b32 v49, v49, v49, v13
  v_mfma_f32_16x16x32_f16 v[68:71], v[88:91], v[60:63], v[68:71]
  v_mul_f16_sdwa v52, v41, v41 dst_sel:WORD_1 dst_unused:UNUSED_PRESERVE src0_sel:WORD_0 src1_sel:WORD_1
  v_mul_f16_sdwa v53, v43, v43 dst_sel:WORD_1 dst_unused:UNUSED_PRESERVE src0_sel:WORD_0 src1_sel:WORD_1
  v_mfma_f32_16x16x32_f16 v[68:71], v[92:95], v[64:67], v[68:71]
  v_add_f32_dpp v14, v14, v14 row_shr:4 row_mask:0xf bank_mask:0xf
  v_pk_mul_f16 v54, v40, v47 op_sel:[0,0] op_sel_hi:[1,0]
  v_mfma_f32_16x16x32_f16 v[72:75], v[132:135], v[60:63], v[72:75]
  v_pk_mul_f16 v55, v41, v47 op_sel:[0,0] op_sel_hi:[1,0]
  v_pk_mul_f16 v56, v42, v47 op_sel:[0,0] op_sel_hi:[1,0]
  v_mfma_f32_16x16x32_f16 v[72:75], v[136:139], v[64:67], v[72:75]
  v_pk_mul_f16 v57, v40, v44 op_sel:[0,0] op_sel_hi:[1,1]
  v_pk_mul_f16 v58, v40, v44 op_sel:[0,1] op_sel_hi:[1,0]
  v_pk_mul_f16 v59, v40, v45 op_sel:[0,0] op_sel_hi:[1,1]
  v_mfma_f32_16x16x32_f16 v[72:75], v[140:143], v[52:55], v[72:75]
  v_add_f32_dpp v14, v14, v14 row_shr:8 row_mask:0xf bank_mask:0xf
  v_pk_mul_f16 v60, v40, v45 op_sel:[0,1] op_sel_hi:[1,0]
  v_mfma_f32_16x16x32_f16 v[72:75], v[144:147], v[56:59], v[72:75]
  v_pk_mul_f16 v61, v40, v46 op_sel:[0,0] op_sel_hi:[1,1]
  v_pk_mul_f16 v62, v40, v46 op_sel:[0,1] op_sel_hi:[1,0]
  v_smfmac_f32_16x16x64_f16 v[80:83], v[224:227], v[52:59], v16
  v_add_f32_dpp v14, v14, v14 row_bcast:15 row_mask:0xa bank_mask:0xf
  v_pk_mul_f16 v63, v41, v44 op_sel:[0,0] op_sel_hi:[1,1]
  v_mfma_f32_16x16x32_f16 v[76:79], v[184:187], v[52:55], v[76:79]
  v_pk_mul_f16 v64, v41, v44 op_sel:[0,1] op_sel_hi:[1,0]
  v_pk_mul_f16 v65, v41, v45 op_sel:[0,0] op_sel_hi:[1,1]
  v_mfma_f32_16x16x32_f16 v[76:79], v[188:191], v[56:59], v[76:79]
  v_add_f32_dpp v14, v14, v14 row_bcast:31 row_mask:0xc bank_mask:0xf
  v_pk_mul_f16 v66, v41, v45 op_sel:[0,1] op_sel_hi:[1,0]
  v_mfma_f32_16x16x32_f16 v[68:71], v[96:99], v[52:55], v[68:71]
  v_pk_mul_f16 v67, v41, v46 op_sel:[0,0] op_sel_hi:[1,1]
  s_waitcnt vmcnt(0)
L_blk:
  s_cmp_eq_u32 s50, 0
  s_cbranch_scc1 L_blkend
  v_readlane_b32 s81, v14, 63
  v_ldexp_f32 v14, v14, s49
  v_and_b32 v14, -2, v14
  s_cmp_ge_u32 s50, 2
  s_cbranch_scc1 L_good
  s_cmp_eq_u64 s[90:91], 0
  s_cbranch_scc1 L_slow
  s_bfe_u32 s81, s81, 0x80017
  s_cmp_eq_u32 s81, 255
  s_cbranch_scc1 L_slow
L_good:
  s_mov_b32 exec_lo, 0
  s_mov_b32 exec_hi, 0x80000000
  buffer_store_dword v14, v251, s[60:63], s85 offen sc1
  s_mov_b64 exec, -1
  s_add_u32 s85, s85, 32
  s_sub_u32 s72, s72, 1
  s_cmp_eq_u32 s72, 0
  s_cbranch_scc1 L_cin_done
  s_cmp_eq_u32 s72, 1
  s_cbranch_scc1 L_lastnext
  v_lshl_add_u32 v24, v24, 7, v18
  v_lshl_add_u32 v25, v25, 7, v18
  s_mov_b32 exec_hi, 0x0000ffff
  v_lshl_add_u32 v26, v26, 7, v18
  v_lshl_add_u32 v27, v27, 7, v18
  s_mov_b32 exec_lo, 0
  s_mov_b32 exec_hi, 0xffff0000
  v_mov_b32 v27, v25
  v_mov_b32 v26, v25
  s_mov_b32 exec_hi, 0x00ff0000
  v_mov_b32 v26, v24
  s_mov_b64 exec, -1
  s_add_u32 m0, s74, 0
  s_nop 0
  buffer_load_dwordx4 v24, s[32:35], 0 offen lds
  s_add_u32 m0, s74, 1056
  s_nop 0
  buffer_load_dwordx4 v25, s[32:35], 0 offen lds
  s_add_u32 m0, s74, 2112
  s_nop 0
  buffer_load_dwordx4 v26, s[32:35], 0 offen lds
  s_add_u32 m0, s74, 3168
  s_mov_b32 exec_hi, 0x00ffffff
  buffer_load_dwordx4 v27, s[32:35], 0 offen lds
  s_mov_b32 exec_hi, -1
  s_add_u32 s94, s94, 832
  s_cmp_lg_u32 s72, s99
  s_cbranch_scc1 L_nodma
  s_lshr_b32 s81, s98, 14
  v_cmp_eq_u32 vcc, 0, v249
  s_nop 0
  s_bitcmp1_b32 vcc_lo, s81
  s_cbranch_scc0 L_tclr_ok
  s_mov_b32 s78, 0x40000
L_tclr:
  s_sub_u32 s78, s78, 1
  s_cbranch_scc1 L_tclr_ok
  v_lshlrev_b32 v249, 2, v0
  v_and_b32 v249, 31, v249
  buffer_load_dword v249, v249, s[64:67], 0 offen offset:128 sc1
  s_waitcnt vmcnt(0)
  v_cmp_eq_u32 vcc, 0, v249
  s_nop 0
  s_bitcmp1_b32 vcc_lo, s81
  s_cbranch_scc1 L_tclr
L_tclr_ok:
  v_mov_b32 v250, 1
  s_mov_b64 exec, 1
  buffer_atomic_add v250, v251, s[60:63], s98 offen sc0
  s_mov_b64 exec, -1
  s_mov_b32 s99, 8
  s_branch L_nodma
L_lastnext:
  s_cmp_lt_i32 s26, 0
  s_cselect_b32 s85, s85, s26
L_nodma:
  s_add_u32 s74, s74, s75
  s_sub_u32 s75, 0, s75
  s_mov_b32 s49, s48
  s_mov_b32 s97, 1
  s_cmp_eq_u32 s50, 3
  s_cbranch_scc1 L_slow2
L_blkend:
  s_mov_b32 s50, s97
  s_cmp_ge_u32 s101, 5537792
  s_cbranch_scc1 L_npf
  s_mov_b64 exec, 131071
  buffer_load_dword v255, v19, s[44:47], s101 offen
  s_mov_b64 exec, -1
  s_add_u32 s101, s101, 1171456
L_npf:
  v_alignbit_b32 v50, v50, v50, v13
  v_mfma_f32_16x16x32_f16 v[68:71], v[100:103], v[56:59], v[68:71]
  v_pk_mul_f16 v52, v41, v46 op_sel:[0,1] op_sel_hi:[1,0]
  v_pk_mul_f16 v53, v42, v44 op_sel:[0,0] op_sel_hi:[1,1]
  v_mfma_f32_16x16x32_f16 v[68:71], v[104:107], v[60:63], v[68:71]
  v_pk_mul_f16 v54, v42, v44 op_sel:[0,1] op_sel_hi:[1,0]
  v_pk_mul_f16 v55, v42, v45 op_sel:[0,0] op_sel_hi:[1,1]
  v_mfma_f32_16x16x32_f16 v[68:71], v[108:111], v[64:67], v[68:71]
  v_pk_mul_f16 v56, v42, v45 op_sel:[0,1] op_sel_hi:[1,0]
  v_pk_mul_f16 v57, v42, v46 op_sel:[0,0] op_sel_hi:[1,1]
  v_smfmac_f32_16x16x64_f16 v[80:83], v[228:231], v[60:67], v16
  v_pk_mul_f16 v58, v42, v46 op_sel:[0,1] op_sel_hi:[1,0]
  v_pk_mul_f16 v59, v40, v48 op_sel:[0,0] op_sel_hi:[1,1]
  v_mfma_f32_16x16x32_f16 v[72:75], v[148:151], v[60:63], v[72:75]
  ds_read_u16_d16_hi v34, v7 offset:288
  ds_read_u16_d16_hi v35, v7 offset:416
  v_mfma_f32_16x16x32_f16 v[72:75], v[152:155], v[64:67], v[72:75]
  ds_read_u16_d16_hi v36, v7 offset:544
  ds_read_u16_d16_hi v37, v7 offset:672
  v_mfma_f32_16x16x32_f16 v[76:79], v[192:195], v[60:63], v[76:79]
  ds_read_u16_d16_hi v38, v7 offset:800
  ds_read_u16_d16_hi v39, v7 offset:928
  v_mfma_f32_16x16x32_f16 v[76:79], v[196:199], v[64:67], v[76:79]
  v_pk_mul_f16 v60, v41, v49 op_sel:[0,0] op_sel_hi:[1,1]
  v_pk_mul_f16 v61, v42, v50 op_sel:[0,0] op_sel_hi:[1,1]
  v_mfma_f32_16x16x32_f16 v[76:79], v[200:203], v[52:55], v[76:79]
  v_pk_mul_f16 v62, v40, v49 op_sel:[0,0] op_sel_hi:[1,1]
  v_pk_mul_f16 v63, v40, v49 op_sel:[0,1] op_sel_hi:[1,0]
  v_mfma_f32_16x16x32_f16 v[76:79], v[204:207], v[56:59], v[76:79]
  v_pk_mul_f16 v64, v40, v50 op_sel:[0,0] op_sel_hi:[1,1]
  v_pk_mul_f16 v65, v40, v50 op_sel:[0,1] op_sel_hi:[1,0]
  v_smfmac_f32_16x16x64_f16 v[80:83], v[232:235], v[52:59], v16
  v_pk_mul_f16 v66, v41, v50 op_sel:[0,0] op_sel_hi:[1,1]
  v_pk_mul_f16 v67, v41, v50 op_sel:[0,1] op_sel_hi:[1,0]
  v_mfma_f32_16x16x32_f16 v[72:75], v[156:159], v[52:55], v[72:75]
  s_waitcnt lgkmcnt(0)
  v_cvt_pk_f16_f32 v43, v38, v39
  v_mfma_f32_16x16x32_f16 v[72:75], v[160:163], v[56:59], v[72:75]
  v_cvt_pk_f16_f32 v40, v32, v35
  v_cvt_pk_f16_f32 v41, v33, v36
  v_mfma_f32_16x16x32_f16 v[68:71], v[112:115], v[52:55], v[68:71]
  v_cvt_pk_f16_f32 v42, v34, v37
  v_mfma_f32_16x16x32_f16 v[68:71], v[116:119], v[56:59], v[68:71]
  ds_write_b128 v10, v[40:43]
  v_mfma_f32_16x16x32_f16 v[68:71], v[120:123], v[60:63], v[68:71]
  v_mfma_f32_16x16x32_f16 v[68:71], v[124:127], v[64:67], v[68:71]
  ds_read_b128 v[44:47], v11
  ds_read_b128 v[48:51], v12
  v_mfma_f32_16x16x32_f16 v[72:75], v[164:167], v[60:63], v[72:75]
  ds_read_b64_tr_b16 v[52:53], v8 offset:32
  ds_read_b64_tr_b16 v[54:55], v8 offset:544
  v_mfma_f32_16x16x32_f16 v[72:75], v[168:171], v[64:67], v[72:75]
  v_pk_mul_f16 v56, v40, v40 op_sel:[0,0] op_sel_hi:[1,1]
  v_pk_mul_f16 v57, v41, v41 op_sel:[0,0] op_sel_hi:[1,1]
  v_smfmac_f32_16x16x64_f16 v[80:83], v[236:239], v[60:67], v16
  v_pk_mul_f16 v58, v42, v42 op_sel:[0,0] op_sel_hi:[1,1]
  v_pk_mul_f16 v59, v40, v41 op_sel:[0,0] op_sel_hi:[1,1]
  v_mfma_f32_16x16x32_f16 v[76:79], v[208:211], v[60:63], v[76:79]
  s_nop 1
  v_mul_f32 v14, v68, v72
  v_fmac_f32 v14, v69, v73
  v_mfma_f32_16x16x32_f16 v[76:79], v[212:215], v[64:67], v[76:79]
  v_fmac_f32 v14, v70, v74
  v_fmac_f32 v14, v71, v75
L_grp1:
  s_waitcnt lgkmcnt(0)
  v_mfma_f32_16x16x32_bf16 v[72:75], v[240:243], v[52:55], 0
  v_add_f32 v22, v80, v81
  v_add_f32 v23, v82, v83
  v_mfma_f32_16x16x32_f16 v[72:75], v[128:131], v[56:59], v[72:75]
  s_nop 0
  v_fmac_f32 v14, v76, v77
  v_fmac_f32 v14, v22, v78
  v_mfma_f32_16x16x32_f16 v[68:71], v[84:87], v[56:59], 0
  v_fmac_f32 v14, v23, v79
  v_pk_mul_f16 v60, v40, v41 op_sel:[0,1] op_sel_hi:[1,0]
  v_mfma_f32_16x16x32_f16 v[80:83], v[216:219], v[56:59], 0
  v_pk_mul_f16 v61, v40, v42 op_sel:[0,0] op_sel_hi:[1,1]
  v_pk_mul_f16 v62, v40, v42 op_sel:[0,1] op_sel_hi:[1,0]
  v_mfma_f32_16x16x32_bf16 v[76:79], v[244:247], v[52:55], 0
  v_pk_mul_f16 v63, v41, v42 op_sel:[0,0] op_sel_hi:[1,1]
  v_pk_mul_f16 v64, v41, v42 op_sel:[0,1] op_sel_hi:[1,0]
  v_mfma_f32_16x16x32_f16 v[76:79], v[172:175], v[56:59], v[76:79]
  v_pk_mul_f16 v65, v40, v43 op_sel:[0,0] op_sel_hi:[1,0]
  v_pk_mul_f16 v66, v41, v43 op_sel:[0,0] op_sel_hi:[1,0]
  v_pk_mul_f16 v67, v42, v43 op_sel:[0,0] op_sel_hi:[1,0]
  v_mfma_f32_16x16x32_f16 v[76:79], v[176:179], v[60:63], v[76:79]
  v_or3_b32 v15, v56, v57, v58
  v_alignbit_b32 v48, v48, v48, v13
  v_mfma_f32_16x16x32_f16 v[76:79], v[180:183], v[64:67], v[76:79]
  v_mul_f16_sdwa v52, v40, v40 dst_sel:WORD_0 dst_unused:UNUSED_PAD src0_sel:WORD_0 src1_sel:WORD_1
  v_mul_f16_sdwa v53, v42, v42 dst_sel:WORD_0 dst_unused:UNUSED_PAD src0_sel:WORD_0 src1_sel:WORD_1
  v_smfmac_f32_16x16x64_f16 v[80:83], v[220:223], v[60:67], v16
  v_mul_f16_sdwa v52, v41, v41 dst_sel:WORD_1 dst_unused:UNUSED_PRESERVE src0_sel:WORD_0 src1_sel:WORD_1
  v_mul_f16_sdwa v53, v43, v43 dst_sel:WORD_1 dst_unused:UNUSED_PRESERVE src0_sel:WORD_0 src1_sel:WORD_1
  v_mfma_f32_16x16x32_f16 v[68:71], v[88:91], v[60:63], v[68:71]
  v_pk_mul_f16 v54, v40, v47 op_sel:[0,0] op_sel_hi:[1,0]
  v_pk_mul_f16 v55, v41, v47 op_sel:[0,0] op_sel_hi:[1,0]
  v_mfma_f32_16x16x32_f16 v[68:71], v[92:95], v[64:67], v[68:71]
  v_pk_mul_f16 v56, v42, v47 op_sel:[0,0] op_sel_hi:[1,0]
  v_pk_mul_f16 v57, v40, v44 op_sel:[0,0] op_sel_hi:[1,1]
  v_mfma_f32_16x16x32_f16 v[72:75], v[132:135], v[60:63], v[72:75]
  v_pk_mul_f16 v58, v40, v44 op_sel:[0,1] op_sel_hi:[1,0]
  v_pk_mul_f16 v59, v40, v45 op_sel:[0,0] op_sel_hi:[1,1]
  v_mfma_f32_16x16x32_f16 v[72:75], v[136:139], v[64:67], v[72:75]
  v_pk_mul_f16 v60, v40, v45 op_sel:[0,1] op_sel_hi:[1,0]
  v_pk_mul_f16 v61, v40, v46 op_sel:[0,0] op_sel_hi:[1,1]
  v_mfma_f32_16x16x32_f16 v[72:75], v[140:143], v[52:55], v[72:75]
  v_pk_mul_f16 v62, v40, v46 op_sel:[0,1] op_sel_hi:[1,0]
  v_pk_mul_f16 v63, v41, v44 op_sel:[0,0] op_sel_hi:[1,1]
  v_mfma_f32_16x16x32_f16 v[72:75], v[144:147], v[56:59], v[72:75]
  v_pk_mul_f16 v64, v41, v44 op_sel:[0,1] op_sel_hi:[1,0]
  v_pk_mul_f16 v65, v41, v45 op_sel:[0,0] op_sel_hi:[1,1]
  v_smfmac_f32_16x16x64_f16 v[80:83], v[224:227], v[52:59], v16
  v_pk_mul_f16 v66, v41, v45 op_sel:[0,1] op_sel_hi:[1,0]
  v_pk_mul_f16 v67, v41, v46 op_sel:[0,0] op_sel_hi:[1,1]
  v_mfma_f32_16x16x32_f16 v[76:79], v[184:187], v[52:55], v[76:79]
  v_alignbit_b32 v49, v49, v49, v13
  v_alignbit_b32 v50, v50, v50, v13
  v_mfma_f32_16x16x32_f16 v[76:79], v[188:191], v[56:59], v[76:79]
  ds_read_u16_d16_hi v32, v7 offset:64
  ds_read_u16_d16_hi v33, v7 offset:192
  v_mfma_f32_16x16x32_f16 v[68:71], v[96:99], v[52:55], v[68:71]
  v_pk_mul_f16 v52, v41, v46 op_sel:[0,1] op_sel_hi:[1,0]
  v_pk_mul_f16 v53, v42, v44 op_sel:[0,0] op_sel_hi:[1,1]
  v_mfma_f32_16x16x32_f16 v[68:71], v[100:103], v[56:59], v[68:71]
  v_pk_mul_f16 v54, v42, v44 op_sel:[0,1] op_sel_hi:[1,0]
  v_pk_mul_f16 v55, v42, v45 op_sel:[0,0] op_sel_hi:[1,1]
  v_mfma_f32_16x16x32_f16 v[68:71], v[104:107], v[60:63], v[68:71]
  v_pk_mul_f16 v56, v42, v45 op_sel:[0,1] op_sel_hi:[1,0]
  v_pk_mul_f16 v57, v42, v46 op_sel:[0,0] op_sel_hi:[1,1]
  v_mfma_f32_16x16x32_f16 v[68:71], v[108:111], v[64:67], v[68:71]
  v_pk_mul_f16 v58, v42, v46 op_sel:[0,1] op_sel_hi:[1,0]
  v_pk_mul_f16 v59, v40, v48 op_sel:[0,0] op_sel_hi:[1,1]
  v_smfmac_f32_16x16x64_f16 v[80:83], v[228:231], v[60:67], v16
  ds_read_u16_d16_hi v34, v7 offset:320
  ds_read_u16_d16_hi v35, v7 offset:448
  v_mfma_f32_16x16x32_f16 v[72:75], v[148:151], v[60:63], v[72:75]
  ds_read_u16_d16_hi v36, v7 offset:576
  ds_read_u16_d16_hi v37, v7 offset:704
  v_mfma_f32_16x16x32_f16 v[72:75], v[152:155], v[64:67], v[72:75]
  ds_read_u16_d16_hi v38, v7 offset:832
  ds_read_u16_d16_hi v39, v7 offset:960
  v_mfma_f32_16x16x32_f16 v[76:79], v[192:195], v[60:63], v[76:79]
  v_and_b32 v15, 0x60006000, v15
  v_cmp_ne_u32 s[90:91], 0, v15
  v_mfma_f32_16x16x32_f16 v[76:79], v[196:199], v[64:67], v[76:79]
  v_pk_mul_f16 v60, v41, v49 op_sel:[0,0] op_sel_hi:[1,1]
  v_pk_mul_f16 v61, v42, v50 op_sel:[0,0] op_sel_hi:[1,1]
  v_mfma_f32_16x16x32_f16 v[76:79], v[200:203], v[52:55], v[76:79]
  v_pk_mul_f16 v62, v40, v49 op_sel:[0,0] op_sel_hi:[1,1]
  v_pk_mul_f16 v63, v40, v49 op_sel:[0,1] op_sel_hi:[1,0]
  v_mfma_f32_16x16x32_f16 v[76:79], v[204:207], v[56:59], v[76:79]
  v_pk_mul_f16 v64, v40, v50 op_sel:[0,0] op_sel_hi:[1,1]
  v_pk_mul_f16 v65, v40, v50 op_sel:[0,1] op_sel_hi:[1,0]
  v_smfmac_f32_16x16x64_f16 v[80:83], v[232:235], v[52:59], v16
  v_pk_mul_f16 v66, v41, v50 op_sel:[0,0] op_sel_hi:[1,1]
  v_pk_mul_f16 v67, v41, v50 op_sel:[0,1] op_sel_hi:[1,0]
  v_mfma_f32_16x16x32_f16 v[72:75], v[156:159], v[52:55], v[72:75]
  s_waitcnt lgkmcnt(0)
  v_cvt_pk_f16_f32 v43, v38, v39
  v_mfma_f32_16x16x32_f16 v[72:75], v[160:163], v[56:59], v[72:75]
  v_cvt_pk_f16_f32 v40, v32, v35
  v_cvt_pk_f16_f32 v41, v33, v36
  v_mfma_f32_16x16x32_f16 v[68:71], v[112:115], v[52:55], v[68:71]
  v_cvt_pk_f16_f32 v42, v34, v37
  v_mfma_f32_16x16x32_f16 v[68:71], v[116:119], v[56:59], v[68:71]
  ds_write_b128 v10, v[40:43]
  v_mfma_f32_16x16x32_f16 v[68:71], v[120:123], v[60:63], v[68:71]
  v_mfma_f32_16x16x32_f16 v[68:71], v[124:127], v[64:67], v[68:71]
  ds_read_b128 v[44:47], v11
  ds_read_b128 v[48:51], v12
  v_mfma_f32_16x16x32_f16 v[72:75], v[164:167], v[60:63], v[72:75]
  ds_read_b64_tr_b16 v[52:53], v8 offset:64
  ds_read_b64_tr_b16 v[54:55], v8 offset:576
  v_mfma_f32_16x16x32_f16 v[72:75], v[168:171], v[64:67], v[72:75]
  v_pk_mul_f16 v56, v40, v40 op_sel:[0,0] op_sel_hi:[1,1]
  v_pk_mul_f16 v57, v41, v41 op_sel:[0,0] op_sel_hi:[1,1]
  v_smfmac_f32_16x16x64_f16 v[80:83], v[236:239], v[60:67], v16
  v_pk_mul_f16 v58, v42, v42 op_sel:[0,0] op_sel_hi:[1,1]
  v_pk_mul_f16 v59, v40, v41 op_sel:[0,0] op_sel_hi:[1,1]
  v_mfma_f32_16x16x32_f16 v[76:79], v[208:211], v[60:63], v[76:79]
  s_nop 1
  v_fmac_f32 v14, v68, v72
  v_fmac_f32 v14, v69, v73
  v_mfma_f32_16x16x32_f16 v[76:79], v[212:215], v[64:67], v[76:79]
  v_fmac_f32 v14, v70, v74
  v_fmac_f32 v14, v71, v75
  s_cmp_eq_u32 s72, s96
  s_cbranch_scc1 L_htail
  s_waitcnt lgkmcnt(0)
  v_mfma_f32_16x16x32_bf16 v[72:75], v[240:243], v[52:55], 0
  v_add_f32 v22, v80, v81
  v_add_f32 v23, v82, v83
  v_mfma_f32_16x16x32_f16 v[72:75], v[128:131], v[56:59], v[72:75]
  v_fmac_f32 v14, v76, v77
  v_fmac_f32 v14, v22, v78
  v_mfma_f32_16x16x32_f16 v[68:71], v[84:87], v[56:59], 0
  v_fmac_f32 v14, v23, v79
  v_pk_mul_f16 v60, v40, v41 op_sel:[0,1] op_sel_hi:[1,0]
  v_mfma_f32_16x16x32_f16 v[80:83], v[216:219], v[56:59], 0
  v_pk_mul_f16 v61, v40, v42 op_sel:[0,0] op_sel_hi:[1,1]
  v_pk_mul_f16 v62, v40, v42 op_sel:[0,1] op_sel_hi:[1,0]
  v_mfma_f32_16x16x32_bf16 v[76:79], v[244:247], v[52:55], 0
  v_pk_mul_f16 v63, v41, v42 op_sel:[0,0] op_sel_hi:[1,1]
  v_pk_mul_f16 v64, v41, v42 op_sel:[0,1] op_sel_hi:[1,0]
  v_mfma_f32_16x16x32_f16 v[76:79], v[172:175], v[56:59], v[76:79]
  v_pk_mul_f16 v65, v40, v43 op_sel:[0,0] op_sel_hi:[1,0]
  v_pk_mul_f16 v66, v41, v43 op_sel:[0,0] op_sel_hi:[1,0]
  v_pk_mul_f16 v67, v42, v43 op_sel:[0,0] op_sel_hi:[1,0]
  v_mfma_f32_16x16x32_f16 v[76:79], v[176:179], v[60:63], v[76:79]
  v_mul_f16_sdwa v52, v40, v40 dst_sel:WORD_0 dst_unused:UNUSED_PAD src0_sel:WORD_0 src1_sel:WORD_1
  v_mul_f16_sdwa v53, v42, v42 dst_sel:WORD_0 dst_unused:UNUSED_PAD src0_sel:WORD_0 src1_sel:WORD_1
  v_mfma_f32_16x16x32_f16 v[76:79], v[180:183], v[64:67], v[76:79]
  v_mul_f16_sdwa v52, v41, v41 dst_sel:WORD_1 dst_unused:UNUSED_PRESERVE src0_sel:WORD_0 src1_sel:WORD_1
  v_mul_f16_sdwa v53, v43, v43 dst_sel:WORD_1 dst_unused:UNUSED_PRESERVE src0_sel:WORD_0 src1_sel:WORD_1
  v_smfmac_f32_16x16x64_f16 v[80:83], v[220:223], v[60:67], v16
  v_pk_mul_f16 v54, v40, v47 op_sel:[0,0] op_sel_hi:[1,0]
  v_pk_mul_f16 v55, v41, v47 op_sel:[0,0] op_sel_hi:[1,0]
  v_mfma_f32_16x16x32_f16 v[68:71], v[88:91], v[60:63], v[68:71]
  v_pk_mul_f16 v56, v42, v47 op_sel:[0,0] op_sel_hi:[1,0]
  v_pk_mul_f16 v57, v40, v44 op_sel:[0,0] op_sel_hi:[1,1]
  v_mfma_f32_16x16x32_f16 v[68:71], v[92:95], v[64:67], v[68:71]
  v_pk_mul_f16 v58, v40, v44 op_sel:[0,1] op_sel_hi:[1,0]
  v_pk_mul_f16 v59, v40, v45 op_sel:[0,0] op_sel_hi:[1,1]
  v_mfma_f32_16x16x32_f16 v[72:75], v[132:135], v[60:63], v[72:75]
  v_pk_mul_f16 v60, v40, v45 op_sel:[0,1] op_sel_hi:[1,0]
  v_pk_mul_f16 v61, v40, v46 op_sel:[0,0] op_sel_hi:[1,1]
  v_mfma_f32_16x16x32_f16 v[72:75], v[136:139], v[64:67], v[72:75]
  v_pk_mul_f16 v62, v40, v46 op_sel:[0,1] op_sel_hi:[1,0]
  v_pk_mul_f16 v63, v41, v44 op_sel:[0,0] op_sel_hi:[1,1]
  v_mfma_f32_16x16x32_f16 v[72:75], v[140:143], v[52:55], v[72:75]
  v_pk_mul_f16 v64, v41, v44 op_sel:[0,1] op_sel_hi:[1,0]
  v_pk_mul_f16 v65, v41, v45 op_sel:[0,0] op_sel_hi:[1,1]
  v_mfma_f32_16x16x32_f16 v[72:75], v[144:147], v[56:59], v[72:75]
  v_pk_mul_f16 v66, v41, v45 op_sel:[0,1] op_sel_hi:[1,0]
  v_pk_mul_f16 v67, v41, v46 op_sel:[0,0] op_sel_hi:[1,1]
  v_smfmac_f32_16x16x64_f16 v[80:83], v[224:227], v[52:59], v16
  v_alignbit_b32 v48, v48, v48, v13
  v_alignbit_b32 v49, v49, v49, v13
  v_mfma_f32_16x16x32_f16 v[76:79], v[184:187], v[52:55], v[76:79]
  v_alignbit_b32 v50, v50, v50, v13
  ds_read_u16_d16_hi v32, v7 offset:96
  v_mfma_f32_16x16x32_f16 v[76:79], v[188:191], v[56:59], v[76:79]
  ds_read_u16_d16_hi v33, v7 offset:224
  ds_read_u16_d16_hi v34, v7 offset:352
  s_cmp_lg_u32 s99, 8
  s_cbranch_scc1 L_hk
  s_waitcnt vmcnt(0)
  v_readfirstlane_b32 s81, v250
  s_mov_b32 s99, 0
  s_add_u32 s81, s81, 1
  s_cmp_ge_u32 s81, 36
  s_cbranch_scc1 L_hk
  s_add_u32 s72, s72, 1
  s_mov_b32 s26, 10240
  s_cmp_lt_u32 s81, 20
  s_cbranch_scc1 L_hkf
  s_add_u32 s81, s81, 20
  s_and_b32 s94, s81, 1
  s_lshr_b32 s81, s81, 1
  s_mov_b32 s96, 1
  s_lshl_b32 s94, s94, 6
  v_xor_b32 v18, s94, v18
  s_lshl_b32 s94, s94, 5
  s_add_u32 s26, s26, s94
L_hkf:
  s_add_u32 s81, s81, 484
  s_lshl_b32 s94, s81, 2
  s_add_u32 s26, s26, s94
  s_andn2_b32 s94, s98, 0x3fff
  s_add_u32 s26, s26, s94
  s_lshr_b32 s94, s94, 5
  s_add_u32 s94, s94, s81
  s_mul_i32 s94, s94, 104
L_hk:
  buffer_load_dwordx4 v[24:27], v17, s[28:31], s94 offen offset:0
  v_mfma_f32_16x16x32_f16 v[68:71], v[96:99], v[52:55], v[68:71]
  v_pk_mul_f16 v52, v41, v46 op_sel:[0,1] op_sel_hi:[1,0]
  v_pk_mul_f16 v53, v42, v44 op_sel:[0,0] op_sel_hi:[1,1]
  v_mfma_f32_16x16x32_f16 v[68:71], v[100:103], v[56:59], v[68:71]
  v_pk_mul_f16 v54, v42, v44 op_sel:[0,1] op_sel_hi:[1,0]
  v_pk_mul_f16 v55, v42, v45 op_sel:[0,0] op_sel_hi:[1,1]
  v_mfma_f32_16x16x32_f16 v[68:71], v[104:107], v[60:63], v[68:71]
  v_pk_mul_f16 v56, v42, v45 op_sel:[0,1] op_sel_hi:[1,0]
  v_pk_mul_f16 v57, v42, v46 op_sel:[0,0] op_sel_hi:[1,1]
  v_mfma_f32_16x16x32_f16 v[68:71], v[108:111], v[64:67], v[68:71]
  v_pk_mul_f16 v58, v42, v46 op_sel:[0,1] op_sel_hi:[1,0]
  v_pk_mul_f16 v59, v40, v48 op_sel:[0,0] op_sel_hi:[1,1]
  v_smfmac_f32_16x16x64_f16 v[80:83], v[228:231], v[60:67], v16
  ds_read_u16_d16_hi v35, v7 offset:480
  ds_read_u16_d16_hi v36, v7 offset:608
  v_mfma_f32_16x16x32_f16 v[72:75], v[148:151], v[60:63], v[72:75]
  ds_read_u16_d16_hi v37, v7 offset:736
  ds_read_u16_d16_hi v38, v7 offset:864
  v_mfma_f32_16x16x32_f16 v[72:75], v[152:155], v[64:67], v[72:75]
  ds_read_u16_d16_hi v39, v7 offset:992
  v_mfma_f32_16x16x32_f16 v[76:79], v[192:195], v[60:63], v[76:79]
  v_pk_mul_f16 v60, v41, v49 op_sel:[0,0] op_sel_hi:[1,1]
  v_pk_mul_f16 v61, v42, v50 op_sel:[0,0] op_sel_hi:[1,1]
  v_mfma_f32_16x16x32_f16 v[76:79], v[196:199], v[64:67], v[76:79]
  v_pk_mul_f16 v62, v40, v49 op_sel:[0,0] op_sel_hi:[1,1]
  v_pk_mul_f16 v63, v40, v49 op_sel:[0,1] op_sel_hi:[1,0]
  v_mfma_f32_16x16x32_f16 v[76:79], v[200:203], v[52:55], v[76:79]
  v_pk_mul_f16 v64, v40, v50 op_sel:[0,0] op_sel_hi:[1,1]
  v_pk_mul_f16 v65, v40, v50 op_sel:[0,1] op_sel_hi:[1,0]
  s_cmp_lg_u32 s84, 0
  s_cbranch_scc1 L_pr110
  s_setprio 0
L_pr110:
  v_mfma_f32_16x16x32_f16 v[76:79], v[204:207], v[56:59], v[76:79]
  v_pk_mul_f16 v66, v41, v50 op_sel:[0,0] op_sel_hi:[1,1]
  v_pk_mul_f16 v67, v41, v50 op_sel:[0,1] op_sel_hi:[1,0]
  v_smfmac_f32_16x16x64_f16 v[80:83], v[232:235], v[52:59], v16
  s_waitcnt lgkmcnt(0)
  v_cvt_pk_f16_f32 v43, v38, v39
  v_mfma_f32_16x16x32_f16 v[72:75], v[156:159], v[52:55], v[72:75]
  v_cvt_pk_f16_f32 v40, v32, v35
  v_cvt_pk_f16_f32 v41, v33, v36
  v_mfma_f32_16x16x32_f16 v[72:75], v[160:163], v[56:59], v[72:75]
  v_cvt_pk_f16_f32 v42, v34, v37
  v_mfma_f32_16x16x32_f16 v[68:71], v[112:115], v[52:55], v[68:71]
  ds_write_b128 v10, v[40:43]
  v_mfma_f32_16x16x32_f16 v[68:71], v[116:119], v[56:59], v[68:71]
  v_add_u32 v7, s75, v7
  s_waitcnt vmcnt(1)
  v_mfma_f32_16x16x32_f16 v[68:71], v[120:123], v[60:63], v[68:71]
  ds_read_b128 v[44:47], v11
  ds_read_b128 v[48:51], v12
  v_mfma_f32_16x16x32_f16 v[68:71], v[124:127], v[64:67], v[68:71]
  ds_read_b64_tr_b16 v[52:53], v8 offset:96
  ds_read_b64_tr_b16 v[54:55], v8 offset:608
  v_mfma_f32_16x16x32_f16 v[72:75], v[164:167], v[60:63], v[72:75]
  v_pk_mul_f16 v56, v40, v40 op_sel:[0,0] op_sel_hi:[1,1]
  v_pk_mul_f16 v57, v41, v41 op_sel:[0,0] op_sel_hi:[1,1]
  v_mfma_f32_16x16x32_f16 v[72:75], v[168:171], v[64:67], v[72:75]
  v_pk_mul_f16 v58, v42, v42 op_sel:[0,0] op_sel_hi:[1,1]
  v_pk_mul_f16 v59, v40, v41 op_sel:[0,0] op_sel_hi:[1,1]
  v_smfmac_f32_16x16x64_f16 v[80:83], v[236:239], v[60:67], v16
  ds_read_u16_d16_hi v32, v7 offset:0
  ds_read_u16_d16_hi v33, v7 offset:128
  v_mfma_f32_16x16x32_f16 v[76:79], v[208:211], v[60:63], v[76:79]
  s_nop 1
  v_fmac_f32 v14, v68, v72
  v_fmac_f32 v14, v69, v73
  v_mfma_f32_16x16x32_f16 v[76:79], v[212:215], v[64:67], v[76:79]
  v_fmac_f32 v14, v70, v74
  v_fmac_f32 v14, v71, v75
  s_waitcnt lgkmcnt(2)
  v_mfma_f32_16x16x32_bf16 v[72:75], v[240:243], v[52:55], 0
  v_add_f32 v22, v80, v81
  v_add_f32 v23, v82, v83
  v_mfma_f32_16x16x32_f16 v[72:75], v[128:131], v[56:59], v[72:75]
  s_nop 0
  v_fmac_f32 v14, v76, v77
  v_fmac_f32 v14, v22, v78
  v_mfma_f32_16x16x32_f16 v[68:71], v[84:87], v[56:59], 0
  v_fmac_f32 v14, v23, v79
  v_pk_mul_f16 v60, v40, v41 op_sel:[0,1] op_sel_hi:[1,0]
  v_mfma_f32_16x16x32_f16 v[80:83], v[216:219], v[56:59], 0
  v_pk_mul_f16 v61, v40, v42 op_sel:[0,0] op_sel_hi:[1,1]
  v_pk_mul_f16 v62, v40, v42 op_sel:[0,1] op_sel_hi:[1,0]
  v_mfma_f32_16x16x32_bf16 v[76:79], v[244:247], v[52:55], 0
  v_pk_mul_f16 v63, v41, v42 op_sel:[0,0] op_sel_hi:[1,1]
  v_pk_mul_f16 v64, v41, v42 op_sel:[0,1] op_sel_hi:[1,0]
  v_mfma_f32_16x16x32_f16 v[76:79], v[172:175], v[56:59], v[76:79]
  v_pk_mul_f16 v65, v40, v43 op_sel:[0,0] op_sel_hi:[1,0]
  v_pk_mul_f16 v66, v41, v43 op_sel:[0,0] op_sel_hi:[1,0]
  v_pk_mul_f16 v67, v42, v43 op_sel:[0,0] op_sel_hi:[1,0]
  v_mfma_f32_16x16x32_f16 v[76:79], v[176:179], v[60:63], v[76:79]
  v_mul_f16_sdwa v52, v40, v40 dst_sel:WORD_0 dst_unused:UNUSED_PAD src0_sel:WORD_0 src1_sel:WORD_1
  v_mul_f16_sdwa v53, v42, v42 dst_sel:WORD_0 dst_unused:UNUSED_PAD src0_sel:WORD_0 src1_sel:WORD_1
  v_mfma_f32_16x16x32_f16 v[76:79], v[180:183], v[64:67], v[76:79]
  v_mul_f16_sdwa v52, v41, v41 dst_sel:WORD_1 dst_unused:UNUSED_PRESERVE src0_sel:WORD_0 src1_sel:WORD_1
  v_mul_f16_sdwa v53, v43, v43 dst_sel:WORD_1 dst_unused:UNUSED_PRESERVE src0_sel:WORD_0 src1_sel:WORD_1
  v_smfmac_f32_16x16x64_f16 v[80:83], v[220:223], v[60:67], v16
  v_pk_mul_f16 v54, v40, v47 op_sel:[0,0] op_sel_hi:[1,0]
  v_pk_mul_f16 v55, v41, v47 op_sel:[0,0] op_sel_hi:[1,0]
  v_mfma_f32_16x16x32_f16 v[68:71], v[88:91], v[60:63], v[68:71]
  v_pk_mul_f16 v56, v42, v47 op_sel:[0,0] op_sel_hi:[1,0]
  v_pk_mul_f16 v57, v40, v44 op_sel:[0,0] op_sel_hi:[1,1]
  v_mfma_f32_16x16x32_f16 v[68:71], v[92:95], v[64:67], v[68:71]
  v_pk_mul_f16 v58, v40, v44 op_sel:[0,1] op_sel_hi:[1,0]
  v_pk_mul_f16 v59, v40, v45 op_sel:[0,0] op_sel_hi:[1,1]
  v_mfma_f32_16x16x32_f16 v[72:75], v[132:135], v[60:63], v[72:75]
  v_pk_mul_f16 v60, v40, v45 op_sel:[0,1] op_sel_hi:[1,0]
  v_pk_mul_f16 v61, v40, v46 op_sel:[0,0] op_sel_hi:[1,1]
  v_mfma_f32_16x16x32_f16 v[72:75], v[136:139], v[64:67], v[72:75]
  v_pk_mul_f16 v62, v40, v46 op_sel:[0,1] op_sel_hi:[1,0]
  v_pk_mul_f16 v63, v41, v44 op_sel:[0,0] op_sel_hi:[1,1]
  v_mfma_f32_16x16x32_f16 v[72:75], v[140:143], v[52:55], v[72:75]
  v_pk_mul_f16 v64, v41, v44 op_sel:[0,1] op_sel_hi:[1,0]
  v_pk_mul_f16 v65, v41, v45 op_sel:[0,0] op_sel_hi:[1,1]
  v_mfma_f32_16x16x32_f16 v[72:75], v[144:147], v[56:59], v[72:75]
  v_pk_mul_f16 v66, v41, v45 op_sel:[0,1] op_sel_hi:[1,0]
  v_pk_mul_f16 v67, v41, v46 op_sel:[0,0] op_sel_hi:[1,1]
  v_smfmac_f32_16x16x64_f16 v[80:83], v[224:227], v[52:59], v16
  v_alignbit_b32 v48, v48, v48, v13
  v_alignbit_b32 v49, v49, v49, v13
  v_mfma_f32_16x16x32_f16 v[76:79], v[184:187], v[52:55], v[76:79]
  v_alignbit_b32 v50, v50, v50, v13
  ds_read_u16_d16_hi v34, v7 offset:256
  v_mfma_f32_16x16x32_f16 v[76:79], v[188:191], v[56:59], v[76:79]
  ds_read_u16_d16_hi v35, v7 offset:384
  ds_read_u16_d16_hi v36, v7 offset:512
  v_mfma_f32_16x16x32_f16 v[68:71], v[96:99], v[52:55], v[68:71]
  v_pk_mul_f16 v52, v41, v46 op_sel:[0,1] op_sel_hi:[1,0]
  v_pk_mul_f16 v53, v42, v44 op_sel:[0,0] op_sel_hi:[1,1]
  v_mfma_f32_16x16x32_f16 v[68:71], v[100:103], v[56:59], v[68:71]
  v_pk_mul_f16 v54, v42, v44 op_sel:[0,1] op_sel_hi:[1,0]
  v_pk_mul_f16 v55, v42, v45 op_sel:[0,0] op_sel_hi:[1,1]
  v_mfma_f32_16x16x32_f16 v[68:71], v[104:107], v[60:63], v[68:71]
  v_pk_mul_f16 v56, v42, v45 op_sel:[0,1] op_sel_hi:[1,0]
  v_pk_mul_f16 v57, v42, v46 op_sel:[0,0] op_sel_hi:[1,1]
  v_mfma_f32_16x16x32_f16 v[68:71], v[108:111], v[64:67], v[68:71]
  v_pk_mul_f16 v58, v42, v46 op_sel:[0,1] op_sel_hi:[1,0]
  v_pk_mul_f16 v59, v40, v48 op_sel:[0,0] op_sel_hi:[1,1]
  v_smfmac_f32_16x16x64_f16 v[80:83], v[228:231], v[60:67], v16
  ds_read_u16_d16_hi v37, v7 offset:640
  ds_read_u16_d16_hi v38, v7 offset:768
  v_mfma_f32_16x16x32_f16 v[72:75], v[148:151], v[60:63], v[72:75]
  ds_read_u16_d16_hi v39, v7 offset:896
  s_add_u32 s81, s74, s75
  v_add_u32 v8, s81, v9
  v_mfma_f32_16x16x32_f16 v[72:75], v[152:155], v[64:67], v[72:75]
  v_mfma_f32_16x16x32_f16 v[76:79], v[192:195], v[60:63], v[76:79]
  v_pk_mul_f16 v60, v41, v49 op_sel:[0,0] op_sel_hi:[1,1]
  v_pk_mul_f16 v61, v42, v50 op_sel:[0,0] op_sel_hi:[1,1]
  v_mfma_f32_16x16x32_f16 v[76:79], v[196:199], v[64:67], v[76:79]
  v_pk_mul_f16 v62, v40, v49 op_sel:[0,0] op_sel_hi:[1,1]
  v_pk_mul_f16 v63, v40, v49 op_sel:[0,1] op_sel_hi:[1,0]
  v_mfma_f32_16x16x32_f16 v[76:79], v[200:203], v[52:55], v[76:79]
  v_pk_mul_f16 v64, v40, v50 op_sel:[0,0] op_sel_hi:[1,1]
  v_pk_mul_f16 v65, v40, v50 op_sel:[0,1] op_sel_hi:[1,0]
  v_mfma_f32_16x16x32_f16 v[76:79], v[204:207], v[56:59], v[76:79]
  v_pk_mul_f16 v66, v41, v50 op_sel:[0,0] op_sel_hi:[1,1]
  v_pk_mul_f16 v67, v41, v50 op_sel:[0,1] op_sel_hi:[1,0]
  v_smfmac_f32_16x16x64_f16 v[80:83], v[232:235], v[52:59], v16
  s_waitcnt lgkmcnt(0)
  v_cvt_pk_f16_f32 v43, v38, v39
  v_mfma_f32_16x16x32_f16 v[72:75], v[156:159], v[52:55], v[72:75]
  v_cvt_pk_f16_f32 v40, v32, v35
  v_cvt_pk_f16_f32 v41, v33, v36
  v_mfma_f32_16x16x32_f16 v[72:75], v[160:163], v[56:59], v[72:75]
  v_cvt_pk_f16_f32 v42, v34, v37
  v_mfma_f32_16x16x32_f16 v[68:71], v[112:115], v[52:55], v[68:71]
  ds_write_b128 v10, v[40:43]
  v_mfma_f32_16x16x32_f16 v[68:71], v[116:119], v[56:59], v[68:71]
  v_mfma_f32_16x16x32_f16 v[68:71], v[120:123], v[60:63], v[68:71]
  ds_read_b128 v[44:47], v11
  ds_read_b128 v[48:51], v12
  v_mfma_f32_16x16x32_f16 v[68:71], v[124:127], v[64:67], v[68:71]
  ds_read_b64_tr_b16 v[52:53], v8 offset:0
  ds_read_b64_tr_b16 v[54:55], v8 offset:512
  v_mfma_f32_16x16x32_f16 v[72:75], v[164:167], v[60:63], v[72:75]
  v_pk_mul_f16 v56, v40, v40 op_sel:[0,0] op_sel_hi:[1,1]
  v_pk_mul_f16 v57, v41, v41 op_sel:[0,0] op_sel_hi:[1,1]
  v_mfma_f32_16x16x32_f16 v[72:75], v[168:171], v[64:67], v[72:75]
  v_pk_mul_f16 v58, v42, v42 op_sel:[0,0] op_sel_hi:[1,1]
  v_pk_mul_f16 v59, v40, v41 op_sel:[0,0] op_sel_hi:[1,1]
  v_smfmac_f32_16x16x64_f16 v[80:83], v[236:239], v[60:67], v16
  ds_read_u16_d16_hi v32, v7 offset:32
  ds_read_u16_d16_hi v33, v7 offset:160
  v_mfma_f32_16x16x32_f16 v[76:79], v[208:211], v[60:63], v[76:79]
  s_nop 1
  v_fmac_f32 v14, v68, v72
  v_fmac_f32 v14, v69, v73
  v_mfma_f32_16x16x32_f16 v[76:79], v[212:215], v[64:67], v[76:79]
  v_fmac_f32 v14, v70, v74
  v_fmac_f32 v14, v71, v75
  s_cmp_lg_u32 s72, 1
  s_cbranch_scc1 L_cin_loop
  v_add_f32 v22, v80, v81
  v_add_f32 v23, v82, v83
  s_nop 1
  v_fmac_f32 v14, v76, v77
  v_fmac_f32 v14, v22, v78
  v_fmac_f32 v14, v23, v79
  s_nop 1
  v_add_f32_dpp v14, v14, v14 row_shr:1 row_mask:0xf bank_mask:0xf
  s_nop 1
  v_add_f32_dpp v14, v14, v14 row_shr:2 row_mask:0xf bank_mask:0xf
  s_nop 1
  v_add_f32_dpp v14, v14, v14 row_shr:4 row_mask:0xf bank_mask:0xf
  s_nop 1
  v_add_f32_dpp v14, v14, v14 row_shr:8 row_mask:0xf bank_mask:0xf
  s_nop 1
  v_add_f32_dpp v14, v14, v14 row_bcast:15 row_mask:0xa bank_mask:0xf
  s_nop 1
  v_add_f32_dpp v14, v14, v14 row_bcast:31 row_mask:0xc bank_mask:0xf
  s_branch L_blk
L_htail:
  v_add_f32 v22, v80, v81
  v_add_f32 v23, v82, v83
  s_nop 1
  v_fmac_f32 v14, v76, v77
  v_fmac_f32 v14, v22, v78
  v_fmac_f32 v14, v23, v79
  s_nop 1
  v_add_f32_dpp v14, v14, v14 row_shr:1 row_mask:0xf bank_mask:0xf
  s_nop 1
  v_add_f32_dpp v14, v14, v14 row_shr:2 row_mask:0xf bank_mask:0xf
  s_nop 1
  v_add_f32_dpp v14, v14, v14 row_shr:4 row_mask:0xf bank_mask:0xf
  s_nop 1
  v_add_f32_dpp v14, v14, v14 row_shr:8 row_mask:0xf bank_mask:0xf
  s_nop 1
  v_add_f32_dpp v14, v14, v14 row_bcast:15 row_mask:0xa bank_mask:0xf
  s_nop 1
  v_add_f32_dpp v14, v14, v14 row_bcast:31 row_mask:0xc bank_mask:0xf
  v_add_u32 v7, s75, v7
  s_branch L_blk
L_slow:
  v_subrev_u32 v7, s75, v7
L_slow2:
  v_lshlrev_b32 v22, 1, v0
  v_add_u32 v23, s74, v22
  s_mul_i32 s81, s3, 4224
  s_add_u32 s81, s81, 1024
  v_add_u32 v22, s81, v22
  v_add_u32 v8, s81, v9
L_csync10:
  ds_read_b32 v4, v2 offset:12
  s_waitcnt lgkmcnt(0)
  v_cmp_gt_u32 vcc, 8, v4
  s_cbranch_vccnz L_csync10
  ds_read_u16 v52, v23 offset:0
  ds_read_u16 v53, v23 offset:128
  ds_read_u16 v54, v23 offset:256
  ds_read_u16 v55, v23 offset:384
  ds_read_u16 v56, v23 offset:512
  ds_read_u16 v57, v23 offset:640
  ds_read_u16 v58, v23 offset:768
  ds_read_u16 v59, v23 offset:896
  ds_read_u16 v60, v23 offset:1056
  ds_read_u16 v61, v23 offset:1184
  ds_read_u16 v62, v23 offset:1312
  ds_read_u16 v63, v23 offset:1440
  ds_read_u16 v64, v23 offset:1568
  ds_read_u16 v65, v23 offset:1696
  ds_read_u16 v66, v23 offset:1824
  ds_read_u16 v67, v23 offset:1952
  ds_read_u16 v68, v23 offset:2112
  ds_read_u16 v69, v23 offset:2240
  ds_read_u16 v70, v23 offset:2368
  ds_read_u16 v71, v23 offset:2496
  ds_read_u16 v72, v23 offset:2624
  ds_read_u16 v73, v23 offset:2752
  ds_read_u16 v74, v23 offset:2880
  ds_read_u16 v75, v23 offset:3008
  ds_read_u16 v76, v23 offset:3168
  ds_read_u16 v77, v23 offset:3296
  ds_read_u16 v78, v23 offset:3424
  ds_read_u16 v79, v23 offset:3552
  ds_read_u16 v80, v23 offset:3680
  ds_read_u16 v81, v23 offset:3808
  ds_read_u16 v82, v23 offset:3936
  s_waitcnt lgkmcnt(14)
  v_lshlrev_b32 v52, 16, v52
  v_lshlrev_b32 v53, 16, v53
  v_lshlrev_b32 v54, 16, v54
  v_lshlrev_b32 v55, 16, v55
  v_lshlrev_b32 v56, 16, v56
  v_lshlrev_b32 v57, 16, v57
  v_lshlrev_b32 v58, 16, v58
  v_lshlrev_b32 v59, 16, v59
  v_lshlrev_b32 v60, 16, v60
  v_lshlrev_b32 v61, 16, v61
  v_lshlrev_b32 v62, 16, v62
  v_lshlrev_b32 v63, 16, v63
  v_lshlrev_b32 v64, 16, v64
  v_lshlrev_b32 v65, 16, v65
  v_lshlrev_b32 v66, 16, v66
  v_lshlrev_b32 v67, 16, v67
  v_lshlrev_b32 v68, 16, v68
  s_waitcnt lgkmcnt(13)
  v_lshlrev_b32 v69, 16, v69
  s_waitcnt lgkmcnt(12)
  v_lshlrev_b32 v70, 16, v70
  s_waitcnt lgkmcnt(11)
  v_lshlrev_b32 v71, 16, v71
  s_waitcnt lgkmcnt(10)
  v_lshlrev_b32 v72, 16, v72
  s_waitcnt lgkmcnt(9)
  v_lshlrev_b32 v73, 16, v73
  s_waitcnt lgkmcnt(8)
  v_lshlrev_b32 v74, 16, v74
  s_waitcnt lgkmcnt(7)
  v_lshlrev_b32 v75, 16, v75
  s_waitcnt lgkmcnt(6)
  v_lshlrev_b32 v76, 16, v76
  s_waitcnt lgkmcnt(5)
  v_lshlrev_b32 v77, 16, v77
  s_waitcnt lgkmcnt(4)
  v_lshlrev_b32 v78, 16, v78
  s_waitcnt lgkmcnt(3)
  v_lshlrev_b32 v79, 16, v79
  s_waitcnt lgkmcnt(2)
  v_lshlrev_b32 v80, 16, v80
  s_waitcnt lgkmcnt(1)
  v_lshlrev_b32 v81, 16, v81
  s_waitcnt lgkmcnt(0)
  v_lshlrev_b32 v82, 16, v82
  v_max3_f32 v14, abs(v52), abs(v53), abs(v54)
  v_max3_f32 v14, v14, abs(v55), abs(v56)
  v_max3_f32 v14, v14, abs(v57), abs(v58)
  v_max3_f32 v14, v14, abs(v59), abs(v60)
  v_max3_f32 v14, v14, abs(v61), abs(v62)
  v_max3_f32 v14, v14, abs(v63), abs(v64)
  v_max3_f32 v14, v14, abs(v65), abs(v66)
  v_max3_f32 v14, v14, abs(v67), abs(v68)
  v_max3_f32 v14, v14, abs(v69), abs(v70)
  v_max3_f32 v14, v14, abs(v71), abs(v72)
  v_max3_f32 v14, v14, abs(v73), abs(v74)
  v_max3_f32 v14, v14, abs(v75), abs(v76)
  v_max3_f32 v14, v14, abs(v77), abs(v78)
  v_max3_f32 v14, v14, abs(v79), abs(v80)
  v_max3_f32 v14, v14, abs(v81), abs(v82)
  s_nop 1
  v_max_u32_dpp v14, v14, v14 row_shr:1 row_mask:0xf bank_mask:0xf
  s_nop 1
  v_max_u32_dpp v14, v14, v14 row_shr:2 row_mask:0xf bank_mask:0xf
  s_nop 1
  v_max_u32_dpp v14, v14, v14 row_shr:4 row_mask:0xf bank_mask:0xf
  s_nop 1
  v_max_u32_dpp v14, v14, v14 row_shr:8 row_mask:0xf bank_mask:0xf
  s_nop 1
  v_max_u32_dpp v14, v14, v14 row_bcast:15 row_mask:0xa bank_mask:0xf
  s_nop 1
  v_max_u32_dpp v14, v14, v14 row_bcast:31 row_mask:0xc bank_mask:0xf
  s_nop 0
  v_readlane_b32 s81, v14, 63
  s_nop 0
  s_lshr_b32 s81, s81, 23
  s_sub_i32 s81, 134, s81
  s_cmp_le_u32 s81, 9
  s_cselect_b32 s97, 2, 3
  s_min_i32 s81, s81, 16
  s_lshl_b32 s49, s81, 2
  s_sub_i32 s49, s48, s49
  s_add_i32 s81, s81, 127
  s_lshl_b32 s81, s81, 23
  v_mov_b32 v83, s81
  v_mul_f32 v52, s81, v52
  v_mul_f32 v53, s81, v53
  v_mul_f32 v54, s81, v54
  v_mul_f32 v55, s81, v55
  v_mul_f32 v56, s81, v56
  v_mul_f32 v57, s81, v57
  v_mul_f32 v58, s81, v58
  v_mul_f32 v59, s81, v59
  v_mul_f32 v60, s81, v60
  v_mul_f32 v61, s81, v61
  v_mul_f32 v62, s81, v62
  v_mul_f32 v63, s81, v63
  v_mul_f32 v64, s81, v64
  v_mul_f32 v65, s81, v65
  v_mul_f32 v66, s81, v66
  v_mul_f32 v67, s81, v67
  v_mul_f32 v68, s81, v68
  v_mul_f32 v69, s81, v69
  v_mul_f32 v70, s81, v70
  v_mul_f32 v71, s81, v71
  v_mul_f32 v72, s81, v72
  v_mul_f32 v73, s81, v73
  v_mul_f32 v74, s81, v74
  v_mul_f32 v75, s81, v75
  v_mul_f32 v76, s81, v76
  v_mul_f32 v77, s81, v77
  v_mul_f32 v78, s81, v78
  v_mul_f32 v79, s81, v79
  v_mul_f32 v80, s81, v80
  v_mul_f32 v81, s81, v81
  v_mul_f32 v82, s81, v82
  ds_write_b16_d16_hi v23, v52 offset:0
  ds_write_b16_d16_hi v23, v53 offset:128
  ds_write_b16_d16_hi v23, v54 offset:256
  ds_write_b16_d16_hi v23, v55 offset:384
  ds_write_b16_d16_hi v23, v56 offset:512
  ds_write_b16_d16_hi v23, v57 offset:640
  ds_write_b16_d16_hi v23, v58 offset:768
  ds_write_b16_d16_hi v23, v59 offset:896
  ds_write_b16_d16_hi v23, v60 offset:1056
  ds_write_b16_d16_hi v23, v61 offset:1184
  ds_write_b16_d16_hi v23, v62 offset:1312
  ds_write_b16_d16_hi v23, v63 offset:1440
  ds_write_b16_d16_hi v23, v64 offset:1568
  ds_write_b16_d16_hi v23, v65 offset:1696
  ds_write_b16_d16_hi v23, v66 offset:1824
  ds_write_b16_d16_hi v23, v67 offset:1952
  ds_write_b16_d16_hi v23, v68 offset:2112
  ds_write_b16_d16_hi v23, v69 offset:2240
  ds_write_b16_d16_hi v23, v70 offset:2368
  ds_write_b16_d16_hi v23, v71 offset:2496
  ds_write_b16_d16_hi v23, v72 offset:2624
  ds_write_b16_d16_hi v23, v73 offset:2752
  ds_write_b16_d16_hi v23, v74 offset:2880
  ds_write_b16_d16_hi v23, v75 offset:3008
  ds_write_b16_d16_hi v23, v76 offset:3168
  ds_write_b16_d16_hi v23, v77 offset:3296
  ds_write_b16_d16_hi v23, v78 offset:3424
  ds_write_b16_d16_hi v23, v79 offset:3552
  ds_write_b16_d16_hi v23, v80 offset:3680
  ds_write_b16_d16_hi v23, v81 offset:3808
  ds_write_b16_d16_hi v23, v82 offset:3936
  v_mul_f32 v52, s81, v52
  v_mul_f32 v53, s81, v53
  v_mul_f32 v54, s81, v54
  v_mul_f32 v55, s81, v55
  v_mul_f32 v56, s81, v56
  v_mul_f32 v57, s81, v57
  v_mul_f32 v58, s81, v58
  v_mul_f32 v59, s81, v59
  v_mul_f32 v60, s81, v60
  v_mul_f32 v61, s81, v61
  v_mul_f32 v62, s81, v62
  v_mul_f32 v63, s81, v63
  v_mul_f32 v64, s81, v64
  v_mul_f32 v65, s81, v65
  v_mul_f32 v66, s81, v66
  v_mul_f32 v67, s81, v67
  v_mul_f32 v68, s81, v68
  v_mul_f32 v69, s81, v69
  v_mul_f32 v70, s81, v70
  v_mul_f32 v71, s81, v71
  v_mul_f32 v72, s81, v72
  v_mul_f32 v73, s81, v73
  v_mul_f32 v74, s81, v74
  v_mul_f32 v75, s81, v75
  v_mul_f32 v76, s81, v76
  v_mul_f32 v77, s81, v77
  v_mul_f32 v78, s81, v78
  v_mul_f32 v79, s81, v79
  v_mul_f32 v80, s81, v80
  v_mul_f32 v81, s81, v81
  v_mul_f32 v82, s81, v82
  v_mul_f32 v83, s81, v83
  ds_write_b16_d16_hi v22, v52 offset:0
  ds_write_b16_d16_hi v22, v53 offset:128
  ds_write_b16_d16_hi v22, v54 offset:256
  ds_write_b16_d16_hi v22, v55 offset:384
  ds_write_b16_d16_hi v22, v56 offset:512
  ds_write_b16_d16_hi v22, v57 offset:640
  ds_write_b16_d16_hi v22, v58 offset:768
  ds_write_b16_d16_hi v22, v59 offset:896
  ds_write_b16_d16_hi v22, v60 offset:1056
  ds_write_b16_d16_hi v22, v61 offset:1184
  ds_write_b16_d16_hi v22, v62 offset:1312
  ds_write_b16_d16_hi v22, v63 offset:1440
  ds_write_b16_d16_hi v22, v64 offset:1568
  ds_write_b16_d16_hi v22, v65 offset:1696
  ds_write_b16_d16_hi v22, v66 offset:1824
  ds_write_b16_d16_hi v22, v67 offset:1952
  ds_write_b16_d16_hi v22, v68 offset:2112
  ds_write_b16_d16_hi v22, v69 offset:2240
  ds_write_b16_d16_hi v22, v70 offset:2368
  ds_write_b16_d16_hi v22, v71 offset:2496
  ds_write_b16_d16_hi v22, v72 offset:2624
  ds_write_b16_d16_hi v22, v73 offset:2752
  ds_write_b16_d16_hi v22, v74 offset:2880
  ds_write_b16_d16_hi v22, v75 offset:3008
  ds_write_b16_d16_hi v22, v76 offset:3168
  ds_write_b16_d16_hi v22, v77 offset:3296
  ds_write_b16_d16_hi v22, v78 offset:3424
  ds_write_b16_d16_hi v22, v79 offset:3552
  ds_write_b16_d16_hi v22, v80 offset:3680
  ds_write_b16_d16_hi v22, v81 offset:3808
  ds_write_b16_d16_hi v22, v82 offset:3936
  ds_write_b16_d16_hi v22, v83 offset:4064
  s_mov_b32 s50, 0
  s_waitcnt lgkmcnt(0)
  s_branch L_prime
L_cin_done:
  s_endpgm
L_rem:
  s_lshr_b32 s84, s3, 2
  s_and_b32 s68, s2, 7
  s_lshl_b32 s68, s68, 3
  s_add_u32 s68, s68, s3
  s_mul_i32 s68, s68, 6656
  s_lshl_b32 s76, s3, 14
  v_lshlrev_b32 v248, 4, v0
  v_lshrrev_b32 v246, 4, v0
  v_lshrrev_b32 v247, 3, v0
  v_mul_u32_u24 v13, 3328, v247
  v_and_b32 v247, 2, v247
  s_and_b32 s69, s3, 1
  s_lshl_b32 s69, s69, 2
  v_or_b32 v247, s69, v247
  v_and_b32 v9, 7, v0
  v_xor_b32 v247, v247, v9
  v_lshl_add_u32 v13, v247, 4, v13
  s_mul_i32 s74, s3, 26624
  s_add_u32 s74, s74, 3200
  s_lshl_b32 s75, s3, 10
  s_add_u32 s75, s75, 131072
  s_waitcnt lgkmcnt(0)
  s_load_dword s80, s[18:19], 0
  s_mov_b32 s28, s4
  s_and_b32 s29, s5, 0xffff
  s_mov_b32 s30, 425984
  s_mov_b32 s31, 0x20000
  s_add_u32 m0, s76, 8192
  s_nop 0
  buffer_load_dwordx4 v248, s[28:31], s68 offen lds
  s_add_u32 s68, s68, 1024
  s_add_u32 m0, s76, 9216
  s_nop 0
  buffer_load_dwordx4 v248, s[28:31], s68 offen lds
  s_add_u32 s68, s68, 1024
  s_add_u32 m0, s76, 10240
  s_nop 0
  buffer_load_dwordx4 v248, s[28:31], s68 offen lds
  s_add_u32 s68, s68, 1024
  s_add_u32 m0, s76, 11264
  s_nop 0
  buffer_load_dwordx4 v248, s[28:31], s68 offen lds
  s_add_u32 s68, s68, 1024
  s_add_u32 m0, s76, 12288
  s_nop 0
  buffer_load_dwordx4 v248, s[28:31], s68 offen lds
  s_add_u32 s68, s68, 1024
  s_add_u32 m0, s76, 13312
  s_nop 0
  buffer_load_dwordx4 v248, s[28:31], s68 offen lds
  s_add_u32 s68, s68, 1024
  s_add_u32 m0, s76, 14336
  s_nop 0
  buffer_load_dwordx4 v248, s[28:31], s68 offen lds
  s_add_u32 s68, s68, 1024
  s_mov_b32 s44, s12
  s_and_b32 s45, s13, 0xffff
  s_mov_b32 s46, 5537792
  s_mov_b32 s47, 0x20000
  s_add_u32 m0, s75, 0
  s_nop 0
  buffer_load_dwordx4 v13, s[44:47], s74 offen lds
  s_add_u32 s74, s74, 212992
  s_mov_b32 s60, s24
  s_and_b32 s61, s25, 0xffff
  s_mov_b32 s62, 268435456
  s_mov_b32 s63, 0x20000
  s_mov_b32 s64, s22
  s_and_b32 s65, s23, 0xffff
  s_mov_b32 s66, 256
  s_mov_b32 s67, 0x20000
  v_mov_b32 v64, -1
  v_mov_b32 v65, -1
  v_mov_b32 v66, -1
  v_mov_b32 v67, -1
  s_and_b32 s70, s2, 7
  s_lshl_b32 s68, s70, 3
  s_add_u32 s68, s68, s3
  s_lshl_b32 s68, s68, 11
  s_lshl_b32 s70, s70, 2
  buffer_store_dwordx4 v[64:67], v248, s[60:63], s68 offen sc1
  buffer_store_dwordx4 v[64:67], v248, s[60:63], s68 offen offset:1024 sc1
  s_mov_b32 s48, s14
  s_and_b32 s49, s15, 0xffff
  s_mov_b32 s50, 3328
  s_mov_b32 s51, 0x20000
  s_mov_b32 s52, s16
  s_and_b32 s53, s17, 0xffff
  s_mov_b32 s54, 3328
  s_mov_b32 s55, 0x20000
  s_mov_b32 s32, s6
  s_and_b32 s33, s7, 0xffff
  s_mov_b32 s34, 12800000
  s_mov_b32 s35, 0x20000
  v_xor_b32 v248, v9, v246
  v_lshlrev_b32 v14, 4, v248
  v_xor_b32 v15, 64, v14
  v_bfe_u32 v247, v0, 2, 2
  v_lshl_add_u32 v248, v246, 3, v247
  v_lshlrev_b32 v248, 7, v248
  v_and_b32 v247, 3, v0
  v_lshl_add_u32 v248, v247, 3, v248
  v_add_u32 v248, 131072, v248
  v_bfe_u32 v247, v0, 3, 2
  v_lshl_add_u32 v1, v247, 5, v248
  v_xor_b32 v2, 32, v1
  v_xor_b32 v7, 64, v1
  v_xor_b32 v8, 96, v1
  v_and_b32 v248, 15, v0
  v_lshlrev_b32 v248, 7, v248
  v_bfe_u32 v247, v0, 1, 3
  v_xor_b32 v247, v247, v246
  v_lshl_add_u32 v248, v247, 4, v248
  v_add_u32 v11, s76, v248
  v_xor_b32 v12, 64, v11
  v_lshrrev_b32 v247, 3, v0
  v_lshl_add_u32 v248, v9, 3, v247
  v_mul_u32_u24 v248, 104, v248
  v_add_u32 v248, s76, v248
  s_mov_b32 s56, s20
  s_and_b32 s57, s21, 0xffff
  s_mov_b32 s58, 8192
  s_mov_b32 s59, 0x20000
  s_and_b32 s77, s2, 7
  s_lshl_b32 s68, s77, 14
  s_lshl_b32 s69, s3, 8
  s_add_u32 s68, s68, s69
  s_add_u32 s69, s68, 4096
  s_add_u32 s71, s68, 8192
  s_lshl_b32 s77, s77, 3
  s_add_u32 s77, s77, s3
  s_lshl_b32 s77, s77, 7
  v_lshlrev_b32 v3, 2, v0
  v_lshlrev_b32 v4, 1, v0
  s_lshl_b32 s81, s3, 6
  v_add_u32 v5, s81, v0
  v_cmp_lt_u32 vcc, 503, v5
  v_add_u32 v5, 4096, v3
  v_mov_b32 v6, 0x7f000000
  v_cndmask_b32 v5, v6, v5, vcc
  v_mov_b32 v240, 0xc0135761
  v_mov_b32 v241, 0xc0135761
  v_mov_b32 v242, 0xbdd2d3e8
  v_mov_b32 v243, 0xbdd2d3e8
  v_mov_b32 v244, 0x71800000
  v_mov_b32 v160, 0
  v_mov_b32 v161, 0
  v_mov_b32 v162, 0
  v_mov_b32 v163, 0
  v_mov_b32 v164, 0
  v_mov_b32 v165, 0
  v_mov_b32 v166, 0
  v_mov_b32 v167, 0
  v_mov_b32 v168, 0
  v_mov_b32 v169, 0
  v_mov_b32 v170, 0
  v_mov_b32 v171, 0
  v_mov_b32 v172, 0
  v_mov_b32 v173, 0
  v_mov_b32 v174, 0
  v_mov_b32 v175, 0
  v_mov_b32 v176, 0
  v_mov_b32 v177, 0
  v_mov_b32 v178, 0
  v_mov_b32 v179, 0
  v_mov_b32 v180, 0
  v_mov_b32 v181, 0
  v_mov_b32 v182, 0
  v_mov_b32 v183, 0
  v_mov_b32 v184, 0
  v_mov_b32 v185, 0
  v_mov_b32 v186, 0
  v_mov_b32 v187, 0
  v_mov_b32 v188, 0
  v_mov_b32 v189, 0
  v_mov_b32 v190, 0
  v_mov_b32 v191, 0
  v_mov_b32 v192, 0
  v_mov_b32 v193, 0
  v_mov_b32 v194, 0
  v_mov_b32 v195, 0
  v_mov_b32 v196, 0
  v_mov_b32 v197, 0
  v_mov_b32 v198, 0
  v_mov_b32 v199, 0
  v_mov_b32 v200, 0
  v_mov_b32 v201, 0
  v_mov_b32 v202, 0
  v_mov_b32 v203, 0
  v_mov_b32 v204, 0
  v_mov_b32 v205, 0
  v_mov_b32 v206, 0
  v_mov_b32 v207, 0
  v_mov_b32 v208, 0
  v_mov_b32 v209, 0
  v_mov_b32 v210, 0
  v_mov_b32 v211, 0
  v_mov_b32 v212, 0
  v_mov_b32 v213, 0
  v_mov_b32 v214, 0
  v_mov_b32 v215, 0
  v_mov_b32 v216, 0
  v_mov_b32 v217, 0
  v_mov_b32 v218, 0
  v_mov_b32 v219, 0
  v_mov_b32 v220, 0
  v_mov_b32 v221, 0
  v_mov_b32 v222, 0
  v_mov_b32 v223, 0
  s_waitcnt vmcnt(0) lgkmcnt(0)
  s_lshl_b32 s80, s80, 16
  ds_read_b64 v[32:33], v248 offset:8192
  ds_read_b64 v[34:35], v248 offset:8200
  ds_read_b64 v[36:37], v248 offset:8208
  ds_read_b64 v[38:39], v248 offset:8216
  ds_read_b64 v[40:41], v248 offset:8224
  ds_read_b64 v[42:43], v248 offset:8232
  ds_read_b64 v[44:45], v248 offset:8240
  ds_read_b64 v[46:47], v248 offset:8248
  ds_read_b64 v[48:49], v248 offset:8256
  ds_read_b64 v[50:51], v248 offset:8264
  ds_read_b64 v[52:53], v248 offset:8272
  ds_read_b64 v[54:55], v248 offset:8280
  ds_read_b64 v[56:57], v248 offset:8288
  v_mov_b32 v24, 0
  v_mov_b32 v25, 0
  v_mov_b32 v26, 0
  v_mov_b32 v27, 0
  v_mov_b32 v28, 0
  v_mov_b32 v29, 0
  v_mov_b32 v30, 0
  v_mov_b32 v31, 0
  v_mov_b32 v58, 0x7f000000
  v_mov_b32 v59, 0x7f000000
  s_waitcnt lgkmcnt(12)
  v_lshlrev_b32 v32, 7, v32
  s_nop 1
  v_add_u32_dpp v24, v32, v14 row_newbcast:0 row_mask:0xf bank_mask:0x3
  v_add_u32_dpp v25, v32, v15 row_newbcast:1 row_mask:0xf bank_mask:0x3
  v_add_u32_dpp v26, v32, v14 row_newbcast:2 row_mask:0xf bank_mask:0x3
  v_add_u32_dpp v27, v32, v15 row_newbcast:3 row_mask:0xf bank_mask:0x3
  v_add_u32_dpp v24, v32, v14 row_newbcast:8 row_mask:0xf bank_mask:0xc
  v_add_u32_dpp v25, v32, v15 row_newbcast:9 row_mask:0xf bank_mask:0xc
  v_add_u32_dpp v26, v32, v14 row_newbcast:10 row_mask:0xf bank_mask:0xc
  v_add_u32_dpp v27, v32, v15 row_newbcast:11 row_mask:0xf bank_mask:0xc
  s_add_u32 m0, s76, 0
  s_nop 0
  buffer_load_dwordx4 v24, s[32:35], 0 offen lds
  s_add_u32 m0, s76, 1024
  s_nop 0
  buffer_load_dwordx4 v25, s[32:35], 0 offen lds
  s_add_u32 m0, s76, 2048
  s_nop 0
  buffer_load_dwordx4 v26, s[32:35], 0 offen lds
  s_add_u32 m0, s76, 3072
  s_nop 0
  buffer_load_dwordx4 v27, s[32:35], 0 offen lds
  v_add_u32_dpp v28, v32, v14 row_newbcast:4 row_mask:0xf bank_mask:0x3
  v_add_u32_dpp v29, v32, v15 row_newbcast:5 row_mask:0xf bank_mask:0x3
  v_add_u32_dpp v30, v32, v14 row_newbcast:6 row_mask:0xf bank_mask:0x3
  v_add_u32_dpp v31, v32, v15 row_newbcast:7 row_mask:0xf bank_mask:0x3
  v_add_u32_dpp v28, v32, v14 row_newbcast:12 row_mask:0xf bank_mask:0xc
  v_add_u32_dpp v29, v32, v15 row_newbcast:13 row_mask:0xf bank_mask:0xc
  v_add_u32_dpp v30, v32, v14 row_newbcast:14 row_mask:0xf bank_mask:0xc
  v_add_u32_dpp v31, v32, v15 row_newbcast:15 row_mask:0xf bank_mask:0xc
  s_add_u32 m0, s76, 4096
  s_nop 0
  buffer_load_dwordx4 v28, s[32:35], 0 offen lds
  s_add_u32 m0, s76, 5120
  s_nop 0
  buffer_load_dwordx4 v29, s[32:35], 0 offen lds
  s_add_u32 m0, s76, 6144
  s_nop 0
  buffer_load_dwordx4 v30, s[32:35], 0 offen lds
  s_add_u32 m0, s76, 7168
  s_nop 0
  buffer_load_dwordx4 v31, s[32:35], 0 offen lds
  s_add_u32 m0, s75, 8192
  s_nop 0
  buffer_load_dwordx4 v13, s[44:47], s74 offen lds
  s_add_u32 s74, s74, 212992
  s_waitcnt lgkmcnt(0)
  v_lshlrev_b32 v57, 7, v57
  v_lshlrev_b32 v56, 7, v56
  v_lshlrev_b32 v55, 7, v55
  v_lshlrev_b32 v54, 7, v54
  v_lshlrev_b32 v53, 7, v53
  v_lshlrev_b32 v52, 7, v52
  v_lshlrev_b32 v51, 7, v51
  v_lshlrev_b32 v50, 7, v50
  v_lshlrev_b32 v49, 7, v49
  v_lshlrev_b32 v48, 7, v48
  v_lshlrev_b32 v47, 7, v47
  v_lshlrev_b32 v46, 7, v46
  v_lshlrev_b32 v45, 7, v45
  v_lshlrev_b32 v44, 7, v44
  v_lshlrev_b32 v43, 7, v43
  v_lshlrev_b32 v42, 7, v42
  v_lshlrev_b32 v41, 7, v41
  v_lshlrev_b32 v40, 7, v40
  v_lshlrev_b32 v39, 7, v39
  v_lshlrev_b32 v38, 7, v38
  v_lshlrev_b32 v37, 7, v37
  v_lshlrev_b32 v36, 7, v36
  v_lshlrev_b32 v35, 7, v35
  v_lshlrev_b32 v34, 7, v34
  v_lshlrev_b32 v33, 7, v33
  s_nop 1
  v_add_u32_dpp v24, v33, v14 row_newbcast:0 row_mask:0xf bank_mask:0x3
  v_add_u32_dpp v25, v33, v15 row_newbcast:1 row_mask:0xf bank_mask:0x3
  v_add_u32_dpp v26, v33, v14 row_newbcast:2 row_mask:0xf bank_mask:0x3
  v_add_u32_dpp v27, v33, v15 row_newbcast:3 row_mask:0xf bank_mask:0x3
  v_add_u32_dpp v24, v33, v14 row_newbcast:8 row_mask:0xf bank_mask:0xc
  v_add_u32_dpp v25, v33, v15 row_newbcast:9 row_mask:0xf bank_mask:0xc
  v_add_u32_dpp v26, v33, v14 row_newbcast:10 row_mask:0xf bank_mask:0xc
  v_add_u32_dpp v27, v33, v15 row_newbcast:11 row_mask:0xf bank_mask:0xc
  s_add_u32 m0, s76, 8192
  s_nop 0
  buffer_load_dwordx4 v24, s[32:35], 0 offen lds
  s_add_u32 m0, s76, 9216
  s_nop 0
  buffer_load_dwordx4 v25, s[32:35], 0 offen lds
  s_add_u32 m0, s76, 10240
  s_nop 0
  buffer_load_dwordx4 v26, s[32:35], 0 offen lds
  s_add_u32 m0, s76, 11264
  s_nop 0
  buffer_load_dwordx4 v27, s[32:35], 0 offen lds
  v_add_u32_dpp v28, v33, v14 row_newbcast:4 row_mask:0xf bank_mask:0x3
  v_add_u32_dpp v29, v33, v15 row_newbcast:5 row_mask:0xf bank_mask:0x3
  v_add_u32_dpp v30, v33, v14 row_newbcast:6 row_mask:0xf bank_mask:0x3
  v_add_u32_dpp v31, v33, v15 row_newbcast:7 row_mask:0xf bank_mask:0x3
  v_add_u32_dpp v28, v33, v14 row_newbcast:12 row_mask:0xf bank_mask:0xc
  v_add_u32_dpp v29, v33, v15 row_newbcast:13 row_mask:0xf bank_mask:0xc
  v_add_u32_dpp v30, v33, v14 row_newbcast:14 row_mask:0xf bank_mask:0xc
  v_add_u32_dpp v31, v33, v15 row_newbcast:15 row_mask:0xf bank_mask:0xc
  s_add_u32 m0, s76, 12288
  s_nop 0
  buffer_load_dwordx4 v28, s[32:35], 0 offen lds
  s_add_u32 m0, s76, 13312
  s_nop 0
  buffer_load_dwordx4 v29, s[32:35], 0 offen lds
  s_add_u32 m0, s76, 14336
  s_nop 0
  buffer_load_dwordx4 v30, s[32:35], 0 offen lds
  s_add_u32 m0, s76, 15360
  s_nop 0
  buffer_load_dwordx4 v31, s[32:35], 0 offen lds
  s_add_u32 m0, s75, 16384
  s_nop 0
  buffer_load_dwordx4 v13, s[44:47], s74 offen lds
  s_add_u32 s74, s74, 212992
  v_lshlrev_b32 v248, 3, v246
  s_mov_b32 s73, 3
  v_mov_b32 v9, v34
  s_nop 1
  v_add_u32_dpp v24, v9, v14 row_newbcast:0 row_mask:0xf bank_mask:0x3
  v_add_u32_dpp v25, v9, v15 row_newbcast:1 row_mask:0xf bank_mask:0x3
  v_add_u32_dpp v26, v9, v14 row_newbcast:2 row_mask:0xf bank_mask:0x3
  v_add_u32_dpp v27, v9, v15 row_newbcast:3 row_mask:0xf bank_mask:0x3
  v_add_u32_dpp v24, v9, v14 row_newbcast:8 row_mask:0xf bank_mask:0xc
  v_add_u32_dpp v25, v9, v15 row_newbcast:9 row_mask:0xf bank_mask:0xc
  v_add_u32_dpp v26, v9, v14 row_newbcast:10 row_mask:0xf bank_mask:0xc
  v_add_u32_dpp v27, v9, v15 row_newbcast:11 row_mask:0xf bank_mask:0xc
  s_waitcnt vmcnt(14)
  s_barrier
  ds_read_b128 v[76:79], v12 offset:2048
  ds_read_b128 v[72:75], v11 offset:2048
  ds_read_b128 v[68:71], v12 offset:0
  ds_read_b128 v[64:67], v11 offset:0
  ds_read_b64_tr_b16 v[96:97], v1 offset:0
  ds_read_b64_tr_b16 v[98:99], v1 offset:512
  ds_read_b64_tr_b16 v[100:101], v1 offset:4096
  ds_read_b64_tr_b16 v[102:103], v1 offset:4608
  ds_read_b64_tr_b16 v[104:105], v2 offset:0
  ds_read_b64_tr_b16 v[106:107], v2 offset:512
  ds_read_b64_tr_b16 v[108:109], v2 offset:4096
  ds_read_b64_tr_b16 v[110:111], v2 offset:4608
  ds_read_b64_tr_b16 v[112:113], v7 offset:0
  ds_read_b64_tr_b16 v[114:115], v7 offset:512
  ds_read_b64_tr_b16 v[116:117], v7 offset:4096
  ds_read_b64_tr_b16 v[118:119], v7 offset:4608
  ds_read_b64_tr_b16 v[120:121], v8 offset:0
  ds_read_b64_tr_b16 v[122:123], v8 offset:512
  ds_read_b64_tr_b16 v[124:125], v8 offset:4096
  ds_read_b64_tr_b16 v[126:127], v8 offset:4608
  s_cmp_lg_u32 s3, 7
  s_cbranch_scc1 L_rem_loop
  s_mov_b64 exec, 1
  buffer_store_dword v240, v14, s[64:67], s70 offen offset:128 sc1
  s_mov_b64 exec, -1
L_rem_loop:
  s_waitcnt vmcnt(9)
  s_barrier
  s_waitcnt lgkmcnt(8)
  v_mfma_f32_16x16x32_bf16 v[160:163], v[96:99], v[64:67], v[160:163]
  ds_read_b128 v[92:95], v12 offset:6144
  ds_read_b128 v[88:91], v11 offset:6144
  s_waitcnt lgkmcnt(14)
  v_mfma_f32_16x16x32_bf16 v[160:163], v[100:103], v[68:71], v[160:163]
  ds_read_b128 v[84:87], v12 offset:4096
  s_add_u32 m0, s76, 0
  s_nop 0
  buffer_load_dwordx4 v24, s[32:35], 0 offen lds
  v_mfma_f32_16x16x32_bf16 v[164:167], v[96:99], v[72:75], v[164:167]
  ds_read_b128 v[80:83], v11 offset:4096
  v_mfma_f32_16x16x32_bf16 v[164:167], v[100:103], v[76:79], v[164:167]
  ds_read_b64_tr_b16 v[128:129], v1 offset:8192
  s_waitcnt lgkmcnt(14)
  v_mfma_f32_16x16x32_bf16 v[176:179], v[104:107], v[64:67], v[176:179]
  ds_read_b64_tr_b16 v[130:131], v1 offset:8704
  s_add_u32 m0, s76, 1024
  s_nop 0
  buffer_load_dwordx4 v25, s[32:35], 0 offen lds
  s_waitcnt lgkmcnt(14)
  v_mfma_f32_16x16x32_bf16 v[176:179], v[108:111], v[68:71], v[176:179]
  ds_read_b64_tr_b16 v[132:133], v1 offset:12288
  v_mfma_f32_16x16x32_bf16 v[180:183], v[104:107], v[72:75], v[180:183]
  ds_read_b64_tr_b16 v[134:135], v1 offset:12800
  v_mfma_f32_16x16x32_bf16 v[180:183], v[108:111], v[76:79], v[180:183]
  ds_read_b64_tr_b16 v[136:137], v2 offset:8192
  s_waitcnt lgkmcnt(14)
  v_mfma_f32_16x16x32_bf16 v[192:195], v[112:115], v[64:67], v[192:195]
  ds_read_b64_tr_b16 v[138:139], v2 offset:8704
  s_add_u32 m0, s76, 2048
  s_nop 0
  buffer_load_dwordx4 v26, s[32:35], 0 offen lds
  s_waitcnt lgkmcnt(14)
  v_mfma_f32_16x16x32_bf16 v[192:195], v[116:119], v[68:71], v[192:195]
  ds_read_b64_tr_b16 v[140:141], v2 offset:12288
  v_mfma_f32_16x16x32_bf16 v[196:199], v[112:115], v[72:75], v[196:199]
  ds_read_b64_tr_b16 v[142:143], v2 offset:12800
  v_mfma_f32_16x16x32_bf16 v[196:199], v[116:119], v[76:79], v[196:199]
  v_add_u32_dpp v28, v9, v14 row_newbcast:4 row_mask:0xf bank_mask:0x3
  v_add_u32_dpp v29, v9, v15 row_newbcast:5 row_mask:0xf bank_mask:0x3
  s_waitcnt lgkmcnt(14)
  v_mfma_f32_16x16x32_bf16 v[208:211], v[120:123], v[64:67], v[208:211]
  s_add_u32 m0, s76, 3072
  s_nop 0
  buffer_load_dwordx4 v27, s[32:35], 0 offen lds
  v_add_u32_dpp v30, v9, v14 row_newbcast:6 row_mask:0xf bank_mask:0x3
  v_add_u32_dpp v31, v9, v15 row_newbcast:7 row_mask:0xf bank_mask:0x3
  s_waitcnt lgkmcnt(12)
  v_mfma_f32_16x16x32_bf16 v[208:211], v[124:127], v[68:71], v[208:211]
  v_add_u32_dpp v28, v9, v14 row_newbcast:12 row_mask:0xf bank_mask:0xc
  v_mfma_f32_16x16x32_bf16 v[212:215], v[120:123], v[72:75], v[212:215]
  v_add_u32_dpp v29, v9, v15 row_newbcast:13 row_mask:0xf bank_mask:0xc
  v_add_u32_dpp v30, v9, v14 row_newbcast:14 row_mask:0xf bank_mask:0xc
  v_mfma_f32_16x16x32_bf16 v[212:215], v[124:127], v[76:79], v[212:215]
  v_add_u32_dpp v31, v9, v15 row_newbcast:15 row_mask:0xf bank_mask:0xc
  s_waitcnt vmcnt(9)
  s_waitcnt lgkmcnt(8)
  v_mfma_f32_16x16x32_bf16 v[168:171], v[96:99], v[80:83], v[168:171]
  ds_read_b128 v[76:79], v12 offset:10240
  ds_read_b128 v[72:75], v11 offset:10240
  v_mfma_f32_16x16x32_bf16 v[168:171], v[100:103], v[84:87], v[168:171]
  ds_read_b128 v[68:71], v12 offset:8192
  s_add_u32 m0, s76, 4096
  s_nop 0
  buffer_load_dwordx4 v28, s[32:35], 0 offen lds
  v_mfma_f32_16x16x32_bf16 v[172:175], v[96:99], v[88:91], v[172:175]
  ds_read_b128 v[64:67], v11 offset:8192
  v_mfma_f32_16x16x32_bf16 v[172:175], v[100:103], v[92:95], v[172:175]
  ds_read_b64_tr_b16 v[144:145], v7 offset:8192
  v_mfma_f32_16x16x32_bf16 v[184:187], v[104:107], v[80:83], v[184:187]
  ds_read_b64_tr_b16 v[146:147], v7 offset:8704
  s_add_u32 m0, s76, 5120
  s_nop 0
  buffer_load_dwordx4 v29, s[32:35], 0 offen lds
  v_mfma_f32_16x16x32_bf16 v[184:187], v[108:111], v[84:87], v[184:187]
  ds_read_b64_tr_b16 v[148:149], v7 offset:12288
  v_mfma_f32_16x16x32_bf16 v[188:191], v[104:107], v[88:91], v[188:191]
  ds_read_b64_tr_b16 v[150:151], v7 offset:12800
  v_mfma_f32_16x16x32_bf16 v[188:191], v[108:111], v[92:95], v[188:191]
  ds_read_b64_tr_b16 v[152:153], v8 offset:8192
  s_add_u32 m0, s76, 6144
  s_nop 0
  buffer_load_dwordx4 v30, s[32:35], 0 offen lds
  v_mfma_f32_16x16x32_bf16 v[200:203], v[112:115], v[80:83], v[200:203]
  ds_read_b64_tr_b16 v[154:155], v8 offset:8704
  v_mfma_f32_16x16x32_bf16 v[200:203], v[116:119], v[84:87], v[200:203]
  ds_read_b64_tr_b16 v[156:157], v8 offset:12288
  v_mfma_f32_16x16x32_bf16 v[204:207], v[112:115], v[88:91], v[204:207]
  ds_read_b64_tr_b16 v[158:159], v8 offset:12800
  s_add_u32 m0, s76, 7168
  s_nop 0
  buffer_load_dwordx4 v31, s[32:35], 0 offen lds
  v_mfma_f32_16x16x32_bf16 v[204:207], v[116:119], v[92:95], v[204:207]
  s_set_gpr_idx_on s73, gpr_idx(SRC0)
  s_nop 0
  v_mov_b32 v9, v32
  s_set_gpr_idx_off
  s_add_u32 s73, s73, 1
  v_add_u32_dpp v24, v9, v14 row_newbcast:0 row_mask:0xf bank_mask:0x3
  v_mfma_f32_16x16x32_bf16 v[216:219], v[120:123], v[80:83], v[216:219]
  v_add_u32_dpp v25, v9, v15 row_newbcast:1 row_mask:0xf bank_mask:0x3
  v_add_u32_dpp v26, v9, v14 row_newbcast:2 row_mask:0xf bank_mask:0x3
  v_mfma_f32_16x16x32_bf16 v[216:219], v[124:127], v[84:87], v[216:219]
  s_xor_b32 s75, s75, 16384
  s_add_u32 m0, s75, 8192
  s_nop 0
  buffer_load_dwordx4 v13, s[44:47], s74 offen lds
  s_add_u32 s74, s74, 212992
  s_xor_b32 s75, s75, 16384
  v_add_u32_dpp v27, v9, v15 row_newbcast:3 row_mask:0xf bank_mask:0x3
  v_add_u32_dpp v24, v9, v14 row_newbcast:8 row_mask:0xf bank_mask:0xc
  v_mfma_f32_16x16x32_bf16 v[220:223], v[120:123], v[88:91], v[220:223]
  v_add_u32_dpp v25, v9, v15 row_newbcast:9 row_mask:0xf bank_mask:0xc
  v_add_u32_dpp v26, v9, v14 row_newbcast:10 row_mask:0xf bank_mask:0xc
  v_mfma_f32_16x16x32_bf16 v[220:223], v[124:127], v[92:95], v[220:223]
  v_add_u32_dpp v27, v9, v15 row_newbcast:11 row_mask:0xf bank_mask:0xc
L_rnv:
  s_waitcnt vmcnt(9)
  s_barrier
  v_xor_b32 v1, 16384, v1
  v_xor_b32 v2, 16384, v2
  v_xor_b32 v7, 16384, v7
  v_xor_b32 v8, 16384, v8
  s_waitcnt lgkmcnt(8)
  v_mfma_f32_16x16x32_bf16 v[160:163], v[128:131], v[64:67], v[160:163]
  ds_read_b128 v[92:95], v12 offset:14336
  ds_read_b128 v[88:91], v11 offset:14336
  v_mfma_f32_16x16x32_bf16 v[160:163], v[132:135], v[68:71], v[160:163]
  ds_read_b128 v[84:87], v12 offset:12288
  s_add_u32 m0, s76, 8192
  s_nop 0
  buffer_load_dwordx4 v24, s[32:35], 0 offen lds
  v_mfma_f32_16x16x32_bf16 v[164:167], v[128:131], v[72:75], v[164:167]
  ds_read_b128 v[80:83], v11 offset:12288
  v_mfma_f32_16x16x32_bf16 v[164:167], v[132:135], v[76:79], v[164:167]
  ds_read_b64_tr_b16 v[96:97], v1 offset:0
  v_mfma_f32_16x16x32_bf16 v[176:179], v[136:139], v[64:67], v[176:179]
  ds_read_b64_tr_b16 v[98:99], v1 offset:512
  s_add_u32 m0, s76, 9216
  s_nop 0
  buffer_load_dwordx4 v25, s[32:35], 0 offen lds
  v_mfma_f32_16x16x32_bf16 v[176:179], v[140:143], v[68:71], v[176:179]
  ds_read_b64_tr_b16 v[100:101], v1 offset:4096
  v_mfma_f32_16x16x32_bf16 v[180:183], v[136:139], v[72:75], v[180:183]
  ds_read_b64_tr_b16 v[102:103], v1 offset:4608
  v_mfma_f32_16x16x32_bf16 v[180:183], v[140:143], v[76:79], v[180:183]
  ds_read_b64_tr_b16 v[104:105], v2 offset:0
  s_waitcnt lgkmcnt(14)
  v_mfma_f32_16x16x32_bf16 v[192:195], v[144:147], v[64:67], v[192:195]
  ds_read_b64_tr_b16 v[106:107], v2 offset:512
  s_add_u32 m0, s76, 10240
  s_nop 0
  buffer_load_dwordx4 v26, s[32:35], 0 offen lds
  s_waitcnt lgkmcnt(14)
  v_mfma_f32_16x16x32_bf16 v[192:195], v[148:151], v[68:71], v[192:195]
  ds_read_b64_tr_b16 v[108:109], v2 offset:4096
  v_mfma_f32_16x16x32_bf16 v[196:199], v[144:147], v[72:75], v[196:199]
  ds_read_b64_tr_b16 v[110:111], v2 offset:4608
  v_mfma_f32_16x16x32_bf16 v[196:199], v[148:151], v[76:79], v[196:199]
  v_add_u32_dpp v28, v9, v14 row_newbcast:4 row_mask:0xf bank_mask:0x3
  v_add_u32_dpp v29, v9, v15 row_newbcast:5 row_mask:0xf bank_mask:0x3
  s_waitcnt lgkmcnt(14)
  v_mfma_f32_16x16x32_bf16 v[208:211], v[152:155], v[64:67], v[208:211]
  s_add_u32 m0, s76, 11264
  s_nop 0
  buffer_load_dwordx4 v27, s[32:35], 0 offen lds
  v_add_u32_dpp v30, v9, v14 row_newbcast:6 row_mask:0xf bank_mask:0x3
  v_add_u32_dpp v31, v9, v15 row_newbcast:7 row_mask:0xf bank_mask:0x3
  s_waitcnt lgkmcnt(12)
  v_mfma_f32_16x16x32_bf16 v[208:211], v[156:159], v[68:71], v[208:211]
  v_add_u32_dpp v28, v9, v14 row_newbcast:12 row_mask:0xf bank_mask:0xc
  v_mfma_f32_16x16x32_bf16 v[212:215], v[152:155], v[72:75], v[212:215]
  v_add_u32_dpp v29, v9, v15 row_newbcast:13 row_mask:0xf bank_mask:0xc
  v_add_u32_dpp v30, v9, v14 row_newbcast:14 row_mask:0xf bank_mask:0xc
  v_mfma_f32_16x16x32_bf16 v[212:215], v[156:159], v[76:79], v[212:215]
  v_add_u32_dpp v31, v9, v15 row_newbcast:15 row_mask:0xf bank_mask:0xc
  s_waitcnt vmcnt(9)
  s_waitcnt lgkmcnt(8)
  v_mfma_f32_16x16x32_bf16 v[168:171], v[128:131], v[80:83], v[168:171]
  ds_read_b128 v[76:79], v12 offset:2048
  ds_read_b128 v[72:75], v11 offset:2048
  v_mfma_f32_16x16x32_bf16 v[168:171], v[132:135], v[84:87], v[168:171]
  ds_read_b128 v[68:71], v12 offset:0
  s_add_u32 m0, s76, 12288
  s_nop 0
  buffer_load_dwordx4 v28, s[32:35], 0 offen lds
  v_mfma_f32_16x16x32_bf16 v[172:175], v[128:131], v[88:91], v[172:175]
  ds_read_b128 v[64:67], v11 offset:0
  v_mfma_f32_16x16x32_bf16 v[172:175], v[132:135], v[92:95], v[172:175]
  ds_read_b64_tr_b16 v[112:113], v7 offset:0
  v_mfma_f32_16x16x32_bf16 v[184:187], v[136:139], v[80:83], v[184:187]
  ds_read_b64_tr_b16 v[114:115], v7 offset:512
  s_add_u32 m0, s76, 13312
  s_nop 0
  buffer_load_dwordx4 v29, s[32:35], 0 offen lds
  v_mfma_f32_16x16x32_bf16 v[184:187], v[140:143], v[84:87], v[184:187]
  ds_read_b64_tr_b16 v[116:117], v7 offset:4096
  v_mfma_f32_16x16x32_bf16 v[188:191], v[136:139], v[88:91], v[188:191]
  ds_read_b64_tr_b16 v[118:119], v7 offset:4608
  v_mfma_f32_16x16x32_bf16 v[188:191], v[140:143], v[92:95], v[188:191]
  ds_read_b64_tr_b16 v[120:121], v8 offset:0
  s_add_u32 m0, s76, 14336
  s_nop 0
  buffer_load_dwordx4 v30, s[32:35], 0 offen lds
  v_mfma_f32_16x16x32_bf16 v[200:203], v[144:147], v[80:83], v[200:203]
  ds_read_b64_tr_b16 v[122:123], v8 offset:512
  v_mfma_f32_16x16x32_bf16 v[200:203], v[148:151], v[84:87], v[200:203]
  ds_read_b64_tr_b16 v[124:125], v8 offset:4096
  v_mfma_f32_16x16x32_bf16 v[204:207], v[144:147], v[88:91], v[204:207]
  ds_read_b64_tr_b16 v[126:127], v8 offset:4608
  s_add_u32 m0, s76, 15360
  s_nop 0
  buffer_load_dwordx4 v31, s[32:35], 0 offen lds
  v_mfma_f32_16x16x32_bf16 v[204:207], v[148:151], v[92:95], v[204:207]
  s_set_gpr_idx_on s73, gpr_idx(SRC0)
  s_nop 0
  v_mov_b32 v9, v32
  s_set_gpr_idx_off
  s_add_u32 s73, s73, 1
  v_add_u32_dpp v24, v9, v14 row_newbcast:0 row_mask:0xf bank_mask:0x3
  v_mfma_f32_16x16x32_bf16 v[216:219], v[152:155], v[80:83], v[216:219]
  v_add_u32_dpp v25, v9, v15 row_newbcast:1 row_mask:0xf bank_mask:0x3
  v_add_u32_dpp v26, v9, v14 row_newbcast:2 row_mask:0xf bank_mask:0x3
  v_mfma_f32_16x16x32_bf16 v[216:219], v[156:159], v[84:87], v[216:219]
  s_add_u32 m0, s75, 0
  s_nop 0
  buffer_load_dwordx4 v13, s[44:47], s74 offen lds
  s_add_u32 s74, s74, 212992
  s_xor_b32 s75, s75, 16384
  v_add_u32_dpp v27, v9, v15 row_newbcast:3 row_mask:0xf bank_mask:0x3
  v_add_u32_dpp v24, v9, v14 row_newbcast:8 row_mask:0xf bank_mask:0xc
  v_mfma_f32_16x16x32_bf16 v[220:223], v[152:155], v[88:91], v[220:223]
  v_add_u32_dpp v25, v9, v15 row_newbcast:9 row_mask:0xf bank_mask:0xc
  v_add_u32_dpp v26, v9, v14 row_newbcast:10 row_mask:0xf bank_mask:0xc
  v_mfma_f32_16x16x32_bf16 v[220:223], v[156:159], v[92:95], v[220:223]
  v_add_u32_dpp v27, v9, v15 row_newbcast:11 row_mask:0xf bank_mask:0xc
  s_cmp_lt_u32 s73, 27
  s_cbranch_scc1 L_rem_loop
  s_waitcnt vmcnt(9)
  s_barrier
  s_waitcnt lgkmcnt(8)
  v_mfma_f32_16x16x32_bf16 v[160:163], v[96:99], v[64:67], v[160:163]
  ds_read_b128 v[92:95], v12 offset:6144
  ds_read_b128 v[88:91], v11 offset:6144
  v_mfma_f32_16x16x32_bf16 v[160:163], v[100:103], v[68:71], v[160:163]
  ds_read_b128 v[84:87], v12 offset:4096
  buffer_load_dwordx2 v[224:225], v248, s[48:51], 0 offen offset:3200
  v_mfma_f32_16x16x32_bf16 v[164:167], v[96:99], v[72:75], v[164:167]
  ds_read_b128 v[80:83], v11 offset:4096
  buffer_load_dwordx2 v[226:227], v248, s[48:51], 0 offen offset:3232
  v_mfma_f32_16x16x32_bf16 v[164:167], v[100:103], v[76:79], v[164:167]
  ds_read_b64_tr_b16 v[128:129], v1 offset:8192
  v_mfma_f32_16x16x32_bf16 v[176:179], v[104:107], v[64:67], v[176:179]
  ds_read_b64_tr_b16 v[130:131], v1 offset:8704
  buffer_load_dwordx2 v[228:229], v248, s[48:51], 0 offen offset:3264
  v_mfma_f32_16x16x32_bf16 v[176:179], v[108:111], v[68:71], v[176:179]
  ds_read_b64_tr_b16 v[132:133], v1 offset:12288
  v_mfma_f32_16x16x32_bf16 v[180:183], v[104:107], v[72:75], v[180:183]
  ds_read_b64_tr_b16 v[134:135], v1 offset:12800
  buffer_load_dwordx2 v[230:231], v248, s[48:51], 0 offen offset:3296
  v_mfma_f32_16x16x32_bf16 v[180:183], v[108:111], v[76:79], v[180:183]
  ds_read_b64_tr_b16 v[136:137], v2 offset:8192
  buffer_load_dwordx2 v[232:233], v248, s[52:55], 0 offen offset:3200
  s_waitcnt lgkmcnt(14)
  v_mfma_f32_16x16x32_bf16 v[192:195], v[112:115], v[64:67], v[192:195]
  ds_read_b64_tr_b16 v[138:139], v2 offset:8704
  s_waitcnt lgkmcnt(14)
  v_mfma_f32_16x16x32_bf16 v[192:195], v[116:119], v[68:71], v[192:195]
  ds_read_b64_tr_b16 v[140:141], v2 offset:12288
  buffer_load_dwordx2 v[234:235], v248, s[52:55], 0 offen offset:3232
  v_mfma_f32_16x16x32_bf16 v[196:199], v[112:115], v[72:75], v[196:199]
  ds_read_b64_tr_b16 v[142:143], v2 offset:12800
  v_mfma_f32_16x16x32_bf16 v[196:199], v[116:119], v[76:79], v[196:199]
  buffer_load_dwordx2 v[236:237], v248, s[52:55], 0 offen offset:3264
  s_waitcnt lgkmcnt(14)
  v_mfma_f32_16x16x32_bf16 v[208:211], v[120:123], v[64:67], v[208:211]
  buffer_load_dwordx2 v[238:239], v248, s[52:55], 0 offen offset:3296
  s_waitcnt lgkmcnt(12)
  v_mfma_f32_16x16x32_bf16 v[208:211], v[124:127], v[68:71], v[208:211]
  v_mfma_f32_16x16x32_bf16 v[212:215], v[120:123], v[72:75], v[212:215]
  buffer_load_dword v255, v3, s[56:59], s77 offen
  v_mfma_f32_16x16x32_bf16 v[212:215], v[124:127], v[76:79], v[212:215]
  s_waitcnt vmcnt(14)
  s_waitcnt lgkmcnt(8)
  v_mfma_f32_16x16x32_bf16 v[168:171], v[96:99], v[80:83], v[168:171]
  ds_read_b128 v[76:79], v12 offset:10240
  ds_read_b128 v[72:75], v11 offset:10240
  v_mfma_f32_16x16x32_bf16 v[168:171], v[100:103], v[84:87], v[168:171]
  ds_read_b128 v[68:71], v12 offset:8192
  v_mfma_f32_16x16x32_bf16 v[172:175], v[96:99], v[88:91], v[172:175]
  ds_read_b128 v[64:67], v11 offset:8192
  v_mfma_f32_16x16x32_bf16 v[172:175], v[100:103], v[92:95], v[172:175]
  ds_read_b64_tr_b16 v[144:145], v7 offset:8192
  v_mfma_f32_16x16x32_bf16 v[184:187], v[104:107], v[80:83], v[184:187]
  ds_read_b64_tr_b16 v[146:147], v7 offset:8704
  v_mfma_f32_16x16x32_bf16 v[184:187], v[108:111], v[84:87], v[184:187]
  ds_read_b64_tr_b16 v[148:149], v7 offset:12288
  v_mfma_f32_16x16x32_bf16 v[188:191], v[104:107], v[88:91], v[188:191]
  ds_read_b64_tr_b16 v[150:151], v7 offset:12800
  v_mfma_f32_16x16x32_bf16 v[188:191], v[108:111], v[92:95], v[188:191]
  ds_read_b64_tr_b16 v[152:153], v8 offset:8192
  v_mfma_f32_16x16x32_bf16 v[200:203], v[112:115], v[80:83], v[200:203]
  ds_read_b64_tr_b16 v[154:155], v8 offset:8704
  v_mfma_f32_16x16x32_bf16 v[200:203], v[116:119], v[84:87], v[200:203]
  ds_read_b64_tr_b16 v[156:157], v8 offset:12288
  v_mfma_f32_16x16x32_bf16 v[204:207], v[112:115], v[88:91], v[204:207]
  ds_read_b64_tr_b16 v[158:159], v8 offset:12800
  v_mfma_f32_16x16x32_bf16 v[204:207], v[116:119], v[92:95], v[204:207]
  v_mfma_f32_16x16x32_bf16 v[216:219], v[120:123], v[80:83], v[216:219]
  v_mfma_f32_16x16x32_bf16 v[216:219], v[124:127], v[84:87], v[216:219]
  v_mfma_f32_16x16x32_bf16 v[220:223], v[120:123], v[88:91], v[220:223]
  v_mfma_f32_16x16x32_bf16 v[220:223], v[124:127], v[92:95], v[220:223]
  s_waitcnt vmcnt(10)
  s_waitcnt lgkmcnt(8)
  v_mfma_f32_16x16x32_bf16 v[160:163], v[128:131], v[64:67], v[160:163]
  ds_read_b128 v[92:95], v12 offset:14336
  v_mfma_f32_16x16x32_bf16 v[160:163], v[132:135], v[68:71], v[160:163]
  v_mfma_f32_16x16x32_bf16 v[164:167], v[128:131], v[72:75], v[164:167]
  ds_read_b128 v[88:91], v11 offset:14336
  v_mfma_f32_16x16x32_bf16 v[164:167], v[132:135], v[76:79], v[164:167]
  s_waitcnt vmcnt(4)
  v_lshlrev_b32 v48, 16, v232
  v_and_b32 v49, 0xffff0000, v232
  v_mfma_f32_16x16x32_bf16 v[176:179], v[136:139], v[64:67], v[176:179]
  v_lshlrev_b32 v50, 16, v233
  v_and_b32 v51, 0xffff0000, v233
  v_mfma_f32_16x16x32_bf16 v[176:179], v[140:143], v[68:71], v[176:179]
  ds_read_b128 v[84:87], v12 offset:12288
  s_waitcnt vmcnt(3)
  v_lshlrev_b32 v52, 16, v234
  v_and_b32 v53, 0xffff0000, v234
  v_mfma_f32_16x16x32_bf16 v[180:183], v[136:139], v[72:75], v[180:183]
  v_lshlrev_b32 v54, 16, v235
  v_and_b32 v55, 0xffff0000, v235
  v_mfma_f32_16x16x32_bf16 v[180:183], v[140:143], v[76:79], v[180:183]
  s_waitcnt vmcnt(2)
  v_lshlrev_b32 v56, 16, v236
  v_and_b32 v57, 0xffff0000, v236
  s_waitcnt lgkmcnt(9)
  v_mfma_f32_16x16x32_bf16 v[192:195], v[144:147], v[64:67], v[192:195]
  ds_read_b128 v[80:83], v11 offset:12288
  v_lshlrev_b32 v58, 16, v237
  s_waitcnt lgkmcnt(8)
  v_mfma_f32_16x16x32_bf16 v[192:195], v[148:151], v[68:71], v[192:195]
  v_and_b32 v59, 0xffff0000, v237
  s_waitcnt vmcnt(1)
  v_lshlrev_b32 v60, 16, v238
  v_mfma_f32_16x16x32_bf16 v[196:199], v[144:147], v[72:75], v[196:199]
  v_and_b32 v61, 0xffff0000, v238
  v_lshlrev_b32 v62, 16, v239
  v_mfma_f32_16x16x32_bf16 v[196:199], v[148:151], v[76:79], v[196:199]
  v_and_b32 v63, 0xffff0000, v239
  v_lshlrev_b32 v32, 16, v224
  s_waitcnt lgkmcnt(6)
  v_mfma_f32_16x16x32_bf16 v[208:211], v[152:155], v[64:67], v[208:211]
  v_and_b32 v33, 0xffff0000, v224
  v_lshlrev_b32 v34, 16, v225
  s_waitcnt lgkmcnt(4)
  v_mfma_f32_16x16x32_bf16 v[208:211], v[156:159], v[68:71], v[208:211]
  v_and_b32 v35, 0xffff0000, v225
  v_lshlrev_b32 v36, 16, v226
  v_mfma_f32_16x16x32_bf16 v[212:215], v[152:155], v[72:75], v[212:215]
  v_and_b32 v37, 0xffff0000, v226
  v_mfma_f32_16x16x32_bf16 v[212:215], v[156:159], v[76:79], v[212:215]
  s_waitcnt lgkmcnt(0)
  v_mfma_f32_16x16x32_bf16 v[168:171], v[128:131], v[80:83], v[168:171]
  v_lshlrev_b32 v38, 16, v227
  v_and_b32 v39, 0xffff0000, v227
  v_mfma_f32_16x16x32_bf16 v[168:171], v[132:135], v[84:87], v[168:171]
  v_lshlrev_b32 v40, 16, v228
  v_mfma_f32_16x16x32_bf16 v[172:175], v[128:131], v[88:91], v[172:175]
  v_and_b32 v41, 0xffff0000, v228
  v_mfma_f32_16x16x32_bf16 v[172:175], v[132:135], v[92:95], v[172:175]
  v_lshlrev_b32 v42, 16, v229
  v_mfma_f32_16x16x32_bf16 v[184:187], v[136:139], v[80:83], v[184:187]
  v_and_b32 v43, 0xffff0000, v229
  v_lshlrev_b32 v44, 16, v230
  v_mfma_f32_16x16x32_bf16 v[184:187], v[140:143], v[84:87], v[184:187]
  v_and_b32 v45, 0xffff0000, v230
  v_mfma_f32_16x16x32_bf16 v[188:191], v[136:139], v[88:91], v[188:191]
  v_lshlrev_b32 v46, 16, v231
  v_mfma_f32_16x16x32_bf16 v[188:191], v[140:143], v[92:95], v[188:191]
  v_and_b32 v47, 0xffff0000, v231
  v_mfma_f32_16x16x32_bf16 v[200:203], v[144:147], v[80:83], v[200:203]
  v_rcp_f32 v48, v48
  v_rcp_f32 v49, v49
  v_mfma_f32_16x16x32_bf16 v[200:203], v[148:151], v[84:87], v[200:203]
  v_rcp_f32 v50, v50
  v_mfma_f32_16x16x32_bf16 v[204:207], v[144:147], v[88:91], v[204:207]
  v_rcp_f32 v51, v51
  v_mfma_f32_16x16x32_bf16 v[204:207], v[148:151], v[92:95], v[204:207]
  v_rcp_f32 v52, v52
  v_mfma_f32_16x16x32_bf16 v[216:219], v[152:155], v[80:83], v[216:219]
  v_rcp_f32 v53, v53
  v_rcp_f32 v54, v54
  v_mfma_f32_16x16x32_bf16 v[216:219], v[156:159], v[84:87], v[216:219]
  v_rcp_f32 v55, v55
  v_mfma_f32_16x16x32_bf16 v[220:223], v[152:155], v[88:91], v[220:223]
  v_rcp_f32 v56, v56
  v_mfma_f32_16x16x32_bf16 v[220:223], v[156:159], v[92:95], v[220:223]
  v_rcp_f32 v57, v57
L_repi:
  v_rcp_f32 v58, v58
  v_rcp_f32 v59, v59
  v_rcp_f32 v60, v60
  v_rcp_f32 v61, v61
  v_rcp_f32 v62, v62
  v_rcp_f32 v63, v63
  v_med3_f32 v48, v48, -v244, v244
  v_med3_f32 v49, v49, -v244, v244
  v_med3_f32 v50, v50, -v244, v244
  v_med3_f32 v51, v51, -v244, v244
  v_med3_f32 v52, v52, -v244, v244
  v_med3_f32 v53, v53, -v244, v244
  v_med3_f32 v54, v54, -v244, v244
  v_med3_f32 v55, v55, -v244, v244
  v_med3_f32 v56, v56, -v244, v244
  v_med3_f32 v57, v57, -v244, v244
  v_med3_f32 v58, v58, -v244, v244
  v_med3_f32 v59, v59, -v244, v244
  v_med3_f32 v60, v60, -v244, v244
  v_med3_f32 v61, v61, -v244, v244
  v_med3_f32 v62, v62, -v244, v244
  v_med3_f32 v63, v63, -v244, v244
  v_pk_add_f32 v[160:161], v[160:161], v[32:33]
  v_pk_add_f32 v[162:163], v[162:163], v[34:35]
  v_pk_add_f32 v[164:165], v[164:165], v[32:33]
  v_pk_add_f32 v[166:167], v[166:167], v[34:35]
  v_pk_add_f32 v[168:169], v[168:169], v[32:33]
  v_pk_add_f32 v[170:171], v[170:171], v[34:35]
  v_pk_add_f32 v[172:173], v[172:173], v[32:33]
  v_pk_add_f32 v[174:175], v[174:175], v[34:35]
  v_pk_add_f32 v[176:177], v[176:177], v[36:37]
  v_pk_add_f32 v[178:179], v[178:179], v[38:39]
  v_pk_add_f32 v[180:181], v[180:181], v[36:37]
  v_pk_add_f32 v[182:183], v[182:183], v[38:39]
  v_pk_add_f32 v[184:185], v[184:185], v[36:37]
  v_pk_add_f32 v[186:187], v[186:187], v[38:39]
  v_pk_add_f32 v[188:189], v[188:189], v[36:37]
  v_pk_add_f32 v[190:191], v[190:191], v[38:39]
  v_pk_add_f32 v[192:193], v[192:193], v[40:41]
  v_pk_add_f32 v[194:195], v[194:195], v[42:43]
  v_pk_add_f32 v[196:197], v[196:197], v[40:41]
  v_pk_add_f32 v[198:199], v[198:199], v[42:43]
  v_pk_add_f32 v[200:201], v[200:201], v[40:41]
  v_pk_add_f32 v[202:203], v[202:203], v[42:43]
  v_pk_add_f32 v[204:205], v[204:205], v[40:41]
  v_pk_add_f32 v[206:207], v[206:207], v[42:43]
  v_pk_add_f32 v[208:209], v[208:209], v[44:45]
  v_pk_add_f32 v[210:211], v[210:211], v[46:47]
  v_pk_add_f32 v[212:213], v[212:213], v[44:45]
  v_pk_add_f32 v[214:215], v[214:215], v[46:47]
  v_pk_add_f32 v[216:217], v[216:217], v[44:45]
  v_pk_add_f32 v[218:219], v[218:219], v[46:47]
  v_pk_add_f32 v[220:221], v[220:221], v[44:45]
  v_pk_add_f32 v[222:223], v[222:223], v[46:47]
  v_pk_mul_f32 v[64:65], v[160:161], v[160:161]
  v_pk_mul_f32 v[68:69], v[164:165], v[164:165]
  v_pk_mul_f32 v[72:73], v[168:169], v[168:169]
  v_pk_mul_f32 v[76:77], v[172:173], v[172:173]
  v_pk_fma_f32 v[64:65], v[64:65], v[242:243], v[240:241]
  v_pk_fma_f32 v[68:69], v[68:69], v[242:243], v[240:241]
  v_pk_fma_f32 v[72:73], v[72:73], v[242:243], v[240:241]
  v_pk_fma_f32 v[76:77], v[76:77], v[242:243], v[240:241]
  v_pk_mul_f32 v[64:65], v[64:65], v[160:161]
  v_pk_mul_f32 v[68:69], v[68:69], v[164:165]
  v_pk_mul_f32 v[72:73], v[72:73], v[168:169]
  v_pk_mul_f32 v[76:77], v[76:77], v[172:173]
  v_exp_f32 v64, v64
  v_exp_f32 v65, v65
  v_exp_f32 v68, v68
  v_exp_f32 v69, v69
  v_exp_f32 v72, v72
  v_exp_f32 v73, v73
  v_exp_f32 v76, v76
  v_exp_f32 v77, v77
  v_pk_fma_f32 v[64:65], v[64:65], v[48:49], v[48:49]
  v_pk_fma_f32 v[68:69], v[68:69], v[48:49], v[48:49]
  v_pk_fma_f32 v[72:73], v[72:73], v[48:49], v[48:49]
  v_pk_fma_f32 v[76:77], v[76:77], v[48:49], v[48:49]
  v_rcp_f32 v64, v64
  v_rcp_f32 v65, v65
  v_rcp_f32 v68, v68
  v_rcp_f32 v69, v69
  v_rcp_f32 v72, v72
  v_rcp_f32 v73, v73
  v_rcp_f32 v76, v76
  v_rcp_f32 v77, v77
  v_pk_mul_f32 v[16:17], v[64:65], v[160:161]
  v_pk_mul_f32 v[18:19], v[68:69], v[164:165]
  v_pk_mul_f32 v[20:21], v[72:73], v[168:169]
  v_pk_mul_f32 v[22:23], v[76:77], v[172:173]
  v_pk_mul_f32 v[80:81], v[162:163], v[162:163]
  v_pk_mul_f32 v[84:85], v[166:167], v[166:167]
  v_pk_mul_f32 v[88:89], v[170:171], v[170:171]
  v_pk_mul_f32 v[92:93], v[174:175], v[174:175]
  v_pk_fma_f32 v[80:81], v[80:81], v[242:243], v[240:241]
  v_pk_fma_f32 v[84:85], v[84:85], v[242:243], v[240:241]
  v_pk_fma_f32 v[88:89], v[88:89], v[242:243], v[240:241]
  v_pk_fma_f32 v[92:93], v[92:93], v[242:243], v[240:241]
  v_pk_mul_f32 v[80:81], v[80:81], v[162:163]
  v_pk_mul_f32 v[84:85], v[84:85], v[166:167]
  v_pk_mul_f32 v[88:89], v[88:89], v[170:171]
  v_pk_mul_f32 v[92:93], v[92:93], v[174:175]
  v_exp_f32 v80, v80
  v_exp_f32 v81, v81
  v_exp_f32 v84, v84
  v_exp_f32 v85, v85
  v_exp_f32 v88, v88
  v_exp_f32 v89, v89
  v_exp_f32 v92, v92
  v_exp_f32 v93, v93
  v_pk_fma_f32 v[80:81], v[80:81], v[50:51], v[50:51]
  v_pk_fma_f32 v[84:85], v[84:85], v[50:51], v[50:51]
  v_pk_fma_f32 v[88:89], v[88:89], v[50:51], v[50:51]
  v_pk_fma_f32 v[92:93], v[92:93], v[50:51], v[50:51]
  v_rcp_f32 v80, v80
  v_rcp_f32 v81, v81
  v_rcp_f32 v84, v84
  v_rcp_f32 v85, v85
  v_rcp_f32 v88, v88
  v_rcp_f32 v89, v89
  v_rcp_f32 v92, v92
  v_rcp_f32 v93, v93
  v_pk_fma_f32 v[16:17], v[80:81], v[162:163], v[16:17]
  v_pk_fma_f32 v[18:19], v[84:85], v[166:167], v[18:19]
  v_pk_fma_f32 v[20:21], v[88:89], v[170:171], v[20:21]
  v_pk_fma_f32 v[22:23], v[92:93], v[174:175], v[22:23]
  v_pk_mul_f32 v[64:65], v[176:177], v[176:177]
  v_pk_mul_f32 v[68:69], v[180:181], v[180:181]
  v_pk_mul_f32 v[72:73], v[184:185], v[184:185]
  v_pk_mul_f32 v[76:77], v[188:189], v[188:189]
  v_pk_fma_f32 v[64:65], v[64:65], v[242:243], v[240:241]
  v_pk_fma_f32 v[68:69], v[68:69], v[242:243], v[240:241]
  v_pk_fma_f32 v[72:73], v[72:73], v[242:243], v[240:241]
  v_pk_fma_f32 v[76:77], v[76:77], v[242:243], v[240:241]
  v_pk_mul_f32 v[64:65], v[64:65], v[176:177]
  v_pk_mul_f32 v[68:69], v[68:69], v[180:181]
  v_pk_mul_f32 v[72:73], v[72:73], v[184:185]
  v_pk_mul_f32 v[76:77], v[76:77], v[188:189]
  v_exp_f32 v64, v64
  v_exp_f32 v65, v65
  v_exp_f32 v68, v68
  v_exp_f32 v69, v69
  v_exp_f32 v72, v72
  v_exp_f32 v73, v73
  v_exp_f32 v76, v76
  v_exp_f32 v77, v77
  v_pk_fma_f32 v[64:65], v[64:65], v[52:53], v[52:53]
  v_pk_fma_f32 v[68:69], v[68:69], v[52:53], v[52:53]
  v_pk_fma_f32 v[72:73], v[72:73], v[52:53], v[52:53]
  v_pk_fma_f32 v[76:77], v[76:77], v[52:53], v[52:53]
  v_rcp_f32 v64, v64
  v_rcp_f32 v65, v65
  v_rcp_f32 v68, v68
  v_rcp_f32 v69, v69
  v_rcp_f32 v72, v72
  v_rcp_f32 v73, v73
  v_rcp_f32 v76, v76
  v_rcp_f32 v77, v77
  v_pk_fma_f32 v[16:17], v[64:65], v[176:177], v[16:17]
  v_pk_fma_f32 v[18:19], v[68:69], v[180:181], v[18:19]
  v_pk_fma_f32 v[20:21], v[72:73], v[184:185], v[20:21]
  v_pk_fma_f32 v[22:23], v[76:77], v[188:189], v[22:23]
  v_pk_mul_f32 v[80:81], v[178:179], v[178:179]
  v_pk_mul_f32 v[84:85], v[182:183], v[182:183]
  v_pk_mul_f32 v[88:89], v[186:187], v[186:187]
  v_pk_mul_f32 v[92:93], v[190:191], v[190:191]
  v_pk_fma_f32 v[80:81], v[80:81], v[242:243], v[240:241]
  v_pk_fma_f32 v[84:85], v[84:85], v[242:243], v[240:241]
  v_pk_fma_f32 v[88:89], v[88:89], v[242:243], v[240:241]
  v_pk_fma_f32 v[92:93], v[92:93], v[242:243], v[240:241]
  v_pk_mul_f32 v[80:81], v[80:81], v[178:179]
  v_pk_mul_f32 v[84:85], v[84:85], v[182:183]
  v_pk_mul_f32 v[88:89], v[88:89], v[186:187]
  v_pk_mul_f32 v[92:93], v[92:93], v[190:191]
  v_exp_f32 v80, v80
  v_exp_f32 v81, v81
  v_exp_f32 v84, v84
  v_exp_f32 v85, v85
  v_exp_f32 v88, v88
  v_exp_f32 v89, v89
  v_exp_f32 v92, v92
  v_exp_f32 v93, v93
  v_pk_fma_f32 v[80:81], v[80:81], v[54:55], v[54:55]
  v_pk_fma_f32 v[84:85], v[84:85], v[54:55], v[54:55]
  v_pk_fma_f32 v[88:89], v[88:89], v[54:55], v[54:55]
  v_pk_fma_f32 v[92:93], v[92:93], v[54:55], v[54:55]
  v_rcp_f32 v80, v80
  v_rcp_f32 v81, v81
  v_rcp_f32 v84, v84
  v_rcp_f32 v85, v85
  v_rcp_f32 v88, v88
  v_rcp_f32 v89, v89
  v_rcp_f32 v92, v92
  v_rcp_f32 v93, v93
  v_pk_fma_f32 v[16:17], v[80:81], v[178:179], v[16:17]
  v_pk_fma_f32 v[18:19], v[84:85], v[182:183], v[18:19]
  v_pk_fma_f32 v[20:21], v[88:89], v[186:187], v[20:21]
  v_pk_fma_f32 v[22:23], v[92:93], v[190:191], v[22:23]
  v_pk_mul_f32 v[64:65], v[192:193], v[192:193]
  v_pk_mul_f32 v[68:69], v[196:197], v[196:197]
  v_pk_mul_f32 v[72:73], v[200:201], v[200:201]
  v_pk_mul_f32 v[76:77], v[204:205], v[204:205]
  v_pk_fma_f32 v[64:65], v[64:65], v[242:243], v[240:241]
  v_pk_fma_f32 v[68:69], v[68:69], v[242:243], v[240:241]
  v_pk_fma_f32 v[72:73], v[72:73], v[242:243], v[240:241]
  v_pk_fma_f32 v[76:77], v[76:77], v[242:243], v[240:241]
  v_pk_mul_f32 v[64:65], v[64:65], v[192:193]
  v_pk_mul_f32 v[68:69], v[68:69], v[196:197]
  v_pk_mul_f32 v[72:73], v[72:73], v[200:201]
  v_pk_mul_f32 v[76:77], v[76:77], v[204:205]
  v_exp_f32 v64, v64
  v_exp_f32 v65, v65
  v_exp_f32 v68, v68
  v_exp_f32 v69, v69
  v_exp_f32 v72, v72
  v_exp_f32 v73, v73
  v_exp_f32 v76, v76
  v_exp_f32 v77, v77
  v_pk_fma_f32 v[64:65], v[64:65], v[56:57], v[56:57]
  v_pk_fma_f32 v[68:69], v[68:69], v[56:57], v[56:57]
  v_pk_fma_f32 v[72:73], v[72:73], v[56:57], v[56:57]
  v_pk_fma_f32 v[76:77], v[76:77], v[56:57], v[56:57]
  v_rcp_f32 v64, v64
  v_rcp_f32 v65, v65
  v_rcp_f32 v68, v68
  v_rcp_f32 v69, v69
  v_rcp_f32 v72, v72
  v_rcp_f32 v73, v73
  v_rcp_f32 v76, v76
  v_rcp_f32 v77, v77
  v_pk_fma_f32 v[16:17], v[64:65], v[192:193], v[16:17]
  v_pk_fma_f32 v[18:19], v[68:69], v[196:197], v[18:19]
  v_pk_fma_f32 v[20:21], v[72:73], v[200:201], v[20:21]
  v_pk_fma_f32 v[22:23], v[76:77], v[204:205], v[22:23]
  v_pk_mul_f32 v[80:81], v[194:195], v[194:195]
  v_pk_mul_f32 v[84:85], v[198:199], v[198:199]
  v_pk_mul_f32 v[88:89], v[202:203], v[202:203]
  v_pk_mul_f32 v[92:93], v[206:207], v[206:207]
  v_pk_fma_f32 v[80:81], v[80:81], v[242:243], v[240:241]
  v_pk_fma_f32 v[84:85], v[84:85], v[242:243], v[240:241]
  v_pk_fma_f32 v[88:89], v[88:89], v[242:243], v[240:241]
  v_pk_fma_f32 v[92:93], v[92:93], v[242:243], v[240:241]
  v_pk_mul_f32 v[80:81], v[80:81], v[194:195]
  v_pk_mul_f32 v[84:85], v[84:85], v[198:199]
  v_pk_mul_f32 v[88:89], v[88:89], v[202:203]
  v_pk_mul_f32 v[92:93], v[92:93], v[206:207]
  v_exp_f32 v80, v80
  v_exp_f32 v81, v81
  v_exp_f32 v84, v84
  v_exp_f32 v85, v85
  v_exp_f32 v88, v88
  v_exp_f32 v89, v89
  v_exp_f32 v92, v92
  v_exp_f32 v93, v93
  v_pk_fma_f32 v[80:81], v[80:81], v[58:59], v[58:59]
  v_pk_fma_f32 v[84:85], v[84:85], v[58:59], v[58:59]
  v_pk_fma_f32 v[88:89], v[88:89], v[58:59], v[58:59]
  v_pk_fma_f32 v[92:93], v[92:93], v[58:59], v[58:59]
  v_rcp_f32 v80, v80
  v_rcp_f32 v81, v81
  v_rcp_f32 v84, v84
  v_rcp_f32 v85, v85
  v_rcp_f32 v88, v88
  v_rcp_f32 v89, v89
  v_rcp_f32 v92, v92
  v_rcp_f32 v93, v93
  v_pk_fma_f32 v[16:17], v[80:81], v[194:195], v[16:17]
  v_pk_fma_f32 v[18:19], v[84:85], v[198:199], v[18:19]
  v_pk_fma_f32 v[20:21], v[88:89], v[202:203], v[20:21]
  v_pk_fma_f32 v[22:23], v[92:93], v[206:207], v[22:23]
  buffer_load_dword v128, v3, s[60:63], s68 offen offset:0 sc1
  buffer_load_dword v129, v3, s[60:63], s68 offen offset:2048 sc1
  buffer_load_dword v130, v3, s[60:63], s69 offen offset:0 sc1
  buffer_load_dword v131, v3, s[60:63], s69 offen offset:2048 sc1
  buffer_load_dword v132, v3, s[60:63], s71 offen offset:0 sc1
  buffer_load_dword v133, v3, s[60:63], s71 offen offset:2048 sc1
  buffer_load_dword v134, v5, s[60:63], s71 offen sc1
  v_pk_mul_f32 v[64:65], v[208:209], v[208:209]
  v_pk_mul_f32 v[68:69], v[212:213], v[212:213]
  v_pk_mul_f32 v[72:73], v[216:217], v[216:217]
  v_pk_mul_f32 v[76:77], v[220:221], v[220:221]
  v_pk_fma_f32 v[64:65], v[64:65], v[242:243], v[240:241]
  v_pk_fma_f32 v[68:69], v[68:69], v[242:243], v[240:241]
  v_pk_fma_f32 v[72:73], v[72:73], v[242:243], v[240:241]
  v_pk_fma_f32 v[76:77], v[76:77], v[242:243], v[240:241]
  v_pk_mul_f32 v[64:65], v[64:65], v[208:209]
  v_pk_mul_f32 v[68:69], v[68:69], v[212:213]
  v_pk_mul_f32 v[72:73], v[72:73], v[216:217]
  v_pk_mul_f32 v[76:77], v[76:77], v[220:221]
  v_exp_f32 v64, v64
  v_exp_f32 v65, v65
  v_exp_f32 v68, v68
  v_exp_f32 v69, v69
  v_exp_f32 v72, v72
  v_exp_f32 v73, v73
  v_exp_f32 v76, v76
  v_exp_f32 v77, v77
  v_pk_fma_f32 v[64:65], v[64:65], v[60:61], v[60:61]
  v_pk_fma_f32 v[68:69], v[68:69], v[60:61], v[60:61]
  v_pk_fma_f32 v[72:73], v[72:73], v[60:61], v[60:61]
  v_pk_fma_f32 v[76:77], v[76:77], v[60:61], v[60:61]
  v_rcp_f32 v64, v64
  v_rcp_f32 v65, v65
  v_rcp_f32 v68, v68
  v_rcp_f32 v69, v69
  v_rcp_f32 v72, v72
  v_rcp_f32 v73, v73
  v_rcp_f32 v76, v76
  v_rcp_f32 v77, v77
  v_pk_fma_f32 v[16:17], v[64:65], v[208:209], v[16:17]
  v_pk_fma_f32 v[18:19], v[68:69], v[212:213], v[18:19]
  v_pk_fma_f32 v[20:21], v[72:73], v[216:217], v[20:21]
  v_pk_fma_f32 v[22:23], v[76:77], v[220:221], v[22:23]
  v_pk_mul_f32 v[80:81], v[210:211], v[210:211]
  v_pk_mul_f32 v[84:85], v[214:215], v[214:215]
  v_pk_mul_f32 v[88:89], v[218:219], v[218:219]
  v_pk_mul_f32 v[92:93], v[222:223], v[222:223]
  v_pk_fma_f32 v[80:81], v[80:81], v[242:243], v[240:241]
  v_pk_fma_f32 v[84:85], v[84:85], v[242:243], v[240:241]
  v_pk_fma_f32 v[88:89], v[88:89], v[242:243], v[240:241]
  v_pk_fma_f32 v[92:93], v[92:93], v[242:243], v[240:241]
  v_pk_mul_f32 v[80:81], v[80:81], v[210:211]
  v_pk_mul_f32 v[84:85], v[84:85], v[214:215]
  v_pk_mul_f32 v[88:89], v[88:89], v[218:219]
  v_pk_mul_f32 v[92:93], v[92:93], v[222:223]
  v_exp_f32 v80, v80
  v_exp_f32 v81, v81
  v_exp_f32 v84, v84
  v_exp_f32 v85, v85
  v_exp_f32 v88, v88
  v_exp_f32 v89, v89
  v_exp_f32 v92, v92
  v_exp_f32 v93, v93
  v_pk_fma_f32 v[80:81], v[80:81], v[62:63], v[62:63]
  v_pk_fma_f32 v[84:85], v[84:85], v[62:63], v[62:63]
  v_pk_fma_f32 v[88:89], v[88:89], v[62:63], v[62:63]
  v_pk_fma_f32 v[92:93], v[92:93], v[62:63], v[62:63]
  v_rcp_f32 v80, v80
  v_rcp_f32 v81, v81
  v_rcp_f32 v84, v84
  v_rcp_f32 v85, v85
  v_rcp_f32 v88, v88
  v_rcp_f32 v89, v89
  v_rcp_f32 v92, v92
  v_rcp_f32 v93, v93
  v_pk_fma_f32 v[16:17], v[80:81], v[210:211], v[16:17]
  v_pk_fma_f32 v[18:19], v[84:85], v[214:215], v[18:19]
  v_pk_fma_f32 v[20:21], v[88:89], v[218:219], v[20:21]
  v_pk_fma_f32 v[22:23], v[92:93], v[222:223], v[22:23]
  v_add_f32 v16, v16, v17
  v_add_f32 v18, v18, v19
  v_add_f32 v20, v20, v21
  v_add_f32 v22, v22, v23
  s_nop 0
  v_permlane32_swap_b32 v16, v20
  v_permlane32_swap_b32 v18, v22
  v_add_f32 v16, v16, v20
  v_add_f32 v18, v18, v22
  s_nop 1
  v_permlane16_swap_b32 v16, v18
  v_add_f32 v16, v16, v18
  v_add_f32 v16, s80, v16
L_rclr:
  s_mov_b32 s72, 0x40000
  s_branch L_pchk
L_poll:
  s_sub_u32 s72, s72, 1
  s_cbranch_scc1 L_pollx
  buffer_load_dword v128, v3, s[60:63], s68 offen offset:0 sc1
  buffer_load_dword v129, v3, s[60:63], s68 offen offset:2048 sc1
  buffer_load_dword v130, v3, s[60:63], s69 offen offset:0 sc1
  buffer_load_dword v131, v3, s[60:63], s69 offen offset:2048 sc1
  buffer_load_dword v132, v3, s[60:63], s71 offen offset:0 sc1
  buffer_load_dword v133, v3, s[60:63], s71 offen offset:2048 sc1
  buffer_load_dword v134, v5, s[60:63], s71 offen sc1
L_pchk:
  s_waitcnt vmcnt(0)
  v_max3_u32 v136, v128, v129, v130
  v_max3_u32 v137, v131, v132, v133
  v_max3_u32 v136, v136, v137, v134
  v_cmp_eq_u32 vcc, -1, v136
  s_cbranch_vccnz L_poll
L_pollx:
  v_add_f32 v128, v128, v129
  v_add_f32 v130, v130, v131
  v_add_f32 v132, v132, v133
  v_add_f32 v16, v16, v134
  v_add_f32 v128, v128, v130
  v_add_f32 v132, v132, v16
  v_add_f32 v128, v128, v132
  v_cvt_pk_bf16_f32 v128, v128, v128
  buffer_store_short v128, v4, s[56:59], s77 offen
  s_endpgm
L_end:
  s_endpgm
.section .rodata,"a"
.p2align 6
.amdhsa_kernel standalone__deep_cross_xdeepfm__recsys_kernel
  .amdhsa_next_free_vgpr 256
  .amdhsa_next_free_sgpr 102
  .amdhsa_accum_offset 256
  .amdhsa_group_segment_fixed_size 0
  .amdhsa_kernarg_size 88
  .amdhsa_user_sgpr_count 2
  .amdhsa_user_sgpr_kernarg_segment_ptr 1
  .amdhsa_system_sgpr_workgroup_id_x 1
  .amdhsa_float_denorm_mode_32 3
.end_amdhsa_kernel
```

```asm
; @launch grid=(256,1,1) block=(512,1,1) lds=163840
.amdgcn_target "amdgcn-amd-amdhsa--gfx950"
.text
.globl standalone__deep_cross_xdeepfm__recsys_kernel
.p2align 8
.type standalone__deep_cross_xdeepfm__recsys_kernel,@function
standalone__deep_cross_xdeepfm__recsys_kernel:
  s_cmp_ge_u32 s2, 256
  s_cbranch_scc1 L_end
  s_load_dwordx16 s[4:19], s[0:1], 0
  s_load_dwordx4 s[20:23], s[0:1], 64
  s_load_dwordx2 s[24:25], s[0:1], 80
  v_lshrrev_b32 v1, 6, v0
  s_getpc_b64 s[92:93]
L_pc:
  s_and_b32 s68, s2, 0xf8
  v_add_u32 v2, s68, v1
  v_lshlrev_b32 v2, 7, v2
  v_and_b32 v3, 1, v0
  v_lshl_add_u32 v2, v3, 15, v2
  v_min_u32 v2, L_end-L_pc, v2
  v_mov_b32 v3, s93
  v_add_co_u32 v2, vcc, s92, v2
  s_nop 1
  v_addc_co_u32 v3, vcc, 0, v3, vcc
  global_load_dword v255, v[2:3], off
  v_and_b32 v0, 63, v0
  v_readfirstlane_b32 s3, v1
  s_and_b32 s68, s2, 7
  s_lshl_b32 s68, s68, 2
  s_lshr_b32 s26, s2, 6
  s_add_u32 s26, s26, s68
  s_bfe_u32 s27, s2, 0x30003
  s_and_b32 s80, s2, 0xf8
  s_add_u32 s80, s80, s3
  s_lshl_b32 s80, s80, 21
  s_lshr_b32 s68, s2, 3
  s_cmp_eq_u32 s68, 5
  s_cbranch_scc1 L_rem
  s_cmp_ge_u32 s27, 5
  s_cbranch_scc1 L_cin
  s_mul_i32 s77, s27, 640
  s_mul_i32 s70, s3, 7
  v_min_u32 v64, 6, v0
  v_add_u32 v64, s70, v64
  v_min_u32 v64, 51, v64
  v_lshrrev_b32 v62, 1, v64
  v_mul_u32_u24 v62, 96, v62
  v_lshl_add_u32 v64, v64, 2, v62
  s_mul_i32 s78, s27, 26
  s_min_u32 s78, s78, 102
  s_lshl_b32 s71, s26, 7
  s_add_u32 s78, s78, s71
  s_mul_i32 s78, s78, 104
  s_and_b32 s70, s26, 3
  s_lshl_b32 s70, s70, 3
  s_add_u32 s70, s70, s3
  s_mul_i32 s70, s70, 3328
  s_add_u32 s81, s70, s77
  v_min_u32 v56, 15, v0
  v_lshrrev_b32 v62, 3, v56
  s_mov_b32 s70, 106496
  v_mul_u32_u24 v62, s70, v62
  v_and_b32 v56, 7, v56
  v_min_u32 v56, 4, v56
  v_lshl_add_u32 v56, v56, 7, v62
  s_xor_b32 s70, s3, 4
  s_lshl_b32 s70, s70, 4
  s_add_u32 s70, s70, s71
  v_lshrrev_b32 v60, 3, v0
  v_add_u32 v60, s70, v60
  v_mul_u32_u24 v13, 104, v60
  s_waitcnt lgkmcnt(0)
  s_mov_b32 s28, s4
  s_and_b32 s29, s5, 0xffff
  s_mov_b32 s30, 425984
  s_mov_b32 s31, 0x20000
  buffer_load_dwordx3 v[52:54], v64, s[28:31], s78 offen
  buffer_load_dwordx2 v[44:45], v13, s[28:31], 0 offen offset:0
  buffer_load_dwordx2 v[48:49], v13, s[28:31], 0 offen offset:832
  s_mov_b32 s32, s6
  s_and_b32 s33, s7, 0xffff
  s_mov_b32 s34, 12800000
  s_mov_b32 s35, 0x20000
  v_mov_b32 v68, s80
  buffer_load_dword v255, v68, s[32:35], 0 offen
  v_lshlrev_b32 v37, 4, v0
  s_mov_b32 s48, s14
  s_and_b32 s49, s15, 0xffff
  s_mov_b32 s50, 3328
  s_mov_b32 s51, 0x20000
  s_mov_b32 s44, s12
  s_and_b32 s45, s13, 0xffff
  s_mov_b32 s46, 5537792
  s_mov_b32 s47, 0x20000
  buffer_load_dword v255, v56, s[44:47], s81 offen
  s_mov_b32 m0, 155648
  s_mov_b32 exec_hi, 0xff
  buffer_load_dwordx4 v37, s[48:51], s77 offen lds
  s_mov_b64 exec, -1
  s_mul_i32 s81, s26, 5
  s_add_u32 s81, s81, s27
  s_lshl_b32 s81, s81, 3
  s_add_u32 s81, s81, s3
  s_add_u32 s81, s81, 1664
  s_lshl_b32 s81, s81, 7
  v_min_u32 v56, 2, v0
  v_mul_u32_u24 v56, 163840, v56
  buffer_load_dword v255, v56, s[44:47], s81 offen
  s_lshr_b32 s68, s3, 2
  s_and_b32 s69, s3, 3
  s_mov_b32 s70, 1639
  s_and_b32 s78, s69, 1
  s_lshl_b32 s78, s78, 2
  s_mov_b32 s81, 3328
  v_mov_b32 v60, v0
  v_mul_u32_u24 v61, s70, v60
  v_lshrrev_b32 v61, 16, v61
  v_mul_u32_u24 v64, 40, v61
  v_sub_u32 v64, v60, v64
  v_and_b32 v63, 2, v61
  v_or_b32 v63, s78, v63
  v_xor_b32 v64, v64, v63
  v_mul_u32_u24 v61, s81, v61
  v_lshl_add_u32 v29, v64, 4, v61
  v_add_u32 v60, 64, v60
  v_mul_u32_u24 v61, s70, v60
  v_lshrrev_b32 v61, 16, v61
  v_mul_u32_u24 v64, 40, v61
  v_sub_u32 v64, v60, v64
  v_and_b32 v63, 2, v61
  v_or_b32 v63, s78, v63
  v_xor_b32 v64, v64, v63
  v_mul_u32_u24 v61, s81, v61
  v_lshl_add_u32 v30, v64, 4, v61
  v_subrev_u32 v30, 1024, v30
  v_add_u32 v60, 64, v60
  v_mul_u32_u24 v61, s70, v60
  v_lshrrev_b32 v61, 16, v61
  v_mul_u32_u24 v64, 40, v61
  v_sub_u32 v64, v60, v64
  v_and_b32 v63, 2, v61
  v_or_b32 v63, s78, v63
  v_xor_b32 v64, v64, v63
  v_mul_u32_u24 v61, s81, v61
  v_lshl_add_u32 v31, v64, 4, v61
  v_subrev_u32 v31, 2048, v31
  v_add_u32 v60, 64, v60
  v_mul_u32_u24 v61, s70, v60
  v_lshrrev_b32 v61, 16, v61
  v_mul_u32_u24 v64, 40, v61
  v_sub_u32 v64, v60, v64
  v_and_b32 v63, 2, v61
  v_or_b32 v63, s78, v63
  v_xor_b32 v64, v64, v63
  v_mul_u32_u24 v61, s81, v61
  v_lshl_add_u32 v32, v64, 4, v61
  v_subrev_u32 v32, 3072, v32
  v_add_u32 v60, 64, v60
  v_mul_u32_u24 v61, s70, v60
  v_lshrrev_b32 v61, 16, v61
  v_mul_u32_u24 v64, 40, v61
  v_sub_u32 v64, v60, v64
  v_and_b32 v63, 2, v61
  v_or_b32 v63, s78, v63
  v_xor_b32 v64, v64, v63
  v_mul_u32_u24 v61, s81, v61
  v_lshl_add_u32 v33, v64, 4, v61
  s_mul_i32 s70, s3, 26624
  s_add_u32 s74, s70, s77
  s_mul_i32 s75, s3, 5120
  s_add_u32 s75, s75, 32768
  s_lshl_b32 s71, s68, 14
  s_lshl_b32 s76, s69, 11
  s_add_u32 s76, s76, s71
  s_xor_b32 s76, s76, 16384
  v_and_b32 v64, 7, v0
  v_lshrrev_b32 v62, 4, v0
  v_xor_b32 v64, v64, v62
  v_lshlrev_b32 v14, 4, v64
  v_xor_b32 v15, 64, v14
  v_and_b32 v64, 15, v0
  v_lshlrev_b32 v64, 7, v64
  s_lshl_b32 s71, s68, 14
  v_bfe_u32 v63, v0, 1, 3
  v_xor_b32 v63, v63, v62
  v_lshl_add_u32 v64, v63, 4, v64
  v_add_u32 v11, s71, v64
  v_xor_b32 v12, 64, v11
  s_mov_b32 s52, s16
  s_and_b32 s53, s17, 0xffff
  s_mov_b32 s54, 3328
  s_mov_b32 s55, 0x20000
  s_mul_i32 s71, s69, 5
  v_bfe_u32 v63, v0, 2, 2
  v_lshl_add_u32 v64, v62, 3, v63
  v_mul_u32_u24 v64, 640, v64
  v_and_b32 v63, 3, v0
  v_lshl_add_u32 v64, v63, 3, v64
  v_add_u32 v64, 32768, v64
  v_bfe_u32 v63, v0, 3, 2
  v_xor_b32 v60, s71, v63
  v_lshl_add_u32 v1, v60, 5, v64
  v_add_u32 v6, 61440, v1
  s_add_u32 s71, s71, 1
  v_xor_b32 v60, s71, v63
  v_lshl_add_u32 v2, v60, 5, v64
  v_add_u32 v7, 61440, v2
  s_add_u32 s71, s71, 1
  v_xor_b32 v60, s71, v63
  v_lshl_add_u32 v3, v60, 5, v64
  v_add_u32 v8, 61440, v3
  s_add_u32 s71, s71, 1
  v_xor_b32 v60, s71, v63
  v_lshl_add_u32 v4, v60, 5, v64
  v_add_u32 v9, 61440, v4
  s_add_u32 s71, s71, 1
  v_xor_b32 v60, s71, v63
  v_lshl_add_u32 v5, v60, 5, v64
  v_add_u32 v10, 61440, v5
  s_add_u32 s71, s71, 1
  s_mul_i32 s71, s69, 160
  s_add_u32 s71, s71, 155648
  v_lshlrev_b32 v64, 3, v62
  v_add_u32 v35, s71, v64
  s_lshl_b32 s70, s69, 1
  s_add_u32 s70, s70, s68
  s_lshl_b32 s70, s70, 8
  s_add_u32 s70, s70, 156928
  v_lshlrev_b32 v36, 2, v0
  v_add_u32 v36, s70, v36
  s_add_u32 m0, s75, 0
  s_nop 0
  buffer_load_dwordx4 v29, s[44:47], s74 offen offset:0 lds
  buffer_load_dwordx4 v30, s[44:47], s74 offen offset:1024 lds
  buffer_load_dwordx4 v31, s[44:47], s74 offen offset:2048 lds
  buffer_load_dwordx4 v32, s[44:47], s74 offen offset:3072 lds
  s_add_u32 m0, m0, 4096
  s_nop 0
  buffer_load_dwordx4 v33, s[44:47], s74 offen offset:0 lds
  s_add_u32 s74, s74, 212992
  s_waitcnt vmcnt(11)
  v_lshlrev_b32 v52, 7, v52
  s_barrier
  buffer_load_dword v255, v52, s[32:35], 0 offen
  s_waitcnt vmcnt(10)
  v_lshl_add_u32 v34, v48, 7, v15
  v_lshl_add_u32 v28, v44, 7, v14
  s_add_u32 m0, s76, 0
  s_nop 0
  buffer_load_dwordx4 v28, s[32:35], 0 offen lds
  s_add_u32 m0, m0, 1024
  s_nop 0
  buffer_load_dwordx4 v34, s[32:35], 0 offen lds
  v_lshlrev_b32 v54, 7, v54
  buffer_load_dword v255, v54, s[32:35], 0 offen
  s_barrier
  s_waitcnt vmcnt(10)
  ds_read_b64 v[220:221], v35 offset:0
  ds_read_b64 v[222:223], v35 offset:32
  ds_read_b64 v[224:225], v35 offset:64
  ds_read_b64 v[226:227], v35 offset:96
  ds_read_b64 v[228:229], v35 offset:128
  s_waitcnt lgkmcnt(4)
  v_lshlrev_b32 v140, 16, v220
  v_and_b32 v141, 0xffff0000, v220
  v_lshlrev_b32 v142, 16, v221
  v_and_b32 v143, 0xffff0000, v221
  s_waitcnt lgkmcnt(3)
  v_lshlrev_b32 v156, 16, v222
  v_and_b32 v157, 0xffff0000, v222
  v_lshlrev_b32 v158, 16, v223
  v_and_b32 v159, 0xffff0000, v223
  s_waitcnt lgkmcnt(2)
  v_lshlrev_b32 v172, 16, v224
  v_and_b32 v173, 0xffff0000, v224
  v_lshlrev_b32 v174, 16, v225
  v_and_b32 v175, 0xffff0000, v225
  s_waitcnt lgkmcnt(1)
  v_lshlrev_b32 v188, 16, v226
  v_and_b32 v189, 0xffff0000, v226
  v_lshlrev_b32 v190, 16, v227
  v_and_b32 v191, 0xffff0000, v227
  s_waitcnt lgkmcnt(0)
  v_lshlrev_b32 v204, 16, v228
  v_and_b32 v205, 0xffff0000, v228
  v_lshlrev_b32 v206, 16, v229
  v_and_b32 v207, 0xffff0000, v229
  v_mov_b64 v[144:145], v[140:141]
  v_mov_b64 v[146:147], v[142:143]
  v_mov_b64 v[148:149], v[140:141]
  v_mov_b64 v[150:151], v[142:143]
  v_mov_b64 v[152:153], v[140:141]
  v_mov_b64 v[154:155], v[142:143]
  v_mov_b64 v[160:161], v[156:157]
  v_mov_b64 v[162:163], v[158:159]
  v_mov_b64 v[164:165], v[156:157]
  v_mov_b64 v[166:167], v[158:159]
  v_mov_b64 v[168:169], v[156:157]
  v_mov_b64 v[170:171], v[158:159]
  v_mov_b64 v[176:177], v[172:173]
  v_mov_b64 v[178:179], v[174:175]
  v_mov_b64 v[180:181], v[172:173]
  v_mov_b64 v[182:183], v[174:175]
  v_mov_b64 v[184:185], v[172:173]
  v_mov_b64 v[186:187], v[174:175]
  v_mov_b64 v[192:193], v[188:189]
  v_mov_b64 v[194:195], v[190:191]
  v_mov_b64 v[196:197], v[188:189]
  v_mov_b64 v[198:199], v[190:191]
  v_mov_b64 v[200:201], v[188:189]
  v_mov_b64 v[202:203], v[190:191]
  v_mov_b64 v[208:209], v[204:205]
  v_mov_b64 v[210:211], v[206:207]
  v_mov_b64 v[212:213], v[204:205]
  v_mov_b64 v[214:215], v[206:207]
  v_mov_b64 v[216:217], v[204:205]
  v_mov_b64 v[218:219], v[206:207]
  s_lshl_b32 s73, s68, 2
  s_add_u32 s73, s73, 4
  buffer_load_dwordx3 v[16:18], v13, s[28:31], s73 offen offset:0
  buffer_load_dwordx3 v[20:22], v13, s[28:31], s73 offen offset:832
  s_add_u32 s73, s73, 12
  s_mov_b32 s72, 0
  s_cmp_lg_u32 s68, 0
  s_cbranch_scc1 L_dnn_h1
L_dnn_h0:
  s_add_u32 m0, s75, 40960
  s_nop 0
  buffer_load_dwordx4 v29, s[44:47], s74 offen offset:0 lds
  buffer_load_dwordx4 v30, s[44:47], s74 offen offset:1024 lds
  buffer_load_dwordx4 v31, s[44:47], s74 offen offset:2048 lds
  buffer_load_dwordx4 v32, s[44:47], s74 offen offset:3072 lds
  s_add_u32 m0, m0, 4096
  s_nop 0
  buffer_load_dwordx4 v33, s[44:47], s74 offen offset:0 lds
  s_add_u32 s74, s74, 212992
  s_waitcnt vmcnt(11) lgkmcnt(0)
  s_barrier
  buffer_load_dwordx3 v[24:26], v13, s[28:31], s73 offen offset:0
  buffer_load_dwordx3 v[240:242], v13, s[28:31], s73 offen offset:832
  s_add_u32 s73, s73, 12
L_dnn_loop0:
  ds_read_b64_tr_b16 v[40:41], v1 offset:0
  s_add_u32 m0, s75, 81920
  s_nop 0
  buffer_load_dwordx4 v29, s[44:47], s74 offen offset:0 lds
  ds_read_b64_tr_b16 v[42:43], v1 offset:2560
  ds_read_b64_tr_b16 v[44:45], v1 offset:20480
  ds_read_b64_tr_b16 v[46:47], v1 offset:23040
  ds_read_b64_tr_b16 v[48:49], v2 offset:0
  buffer_load_dwordx4 v30, s[44:47], s74 offen offset:1024 lds
  ds_read_b64_tr_b16 v[50:51], v2 offset:2560
  ds_read_b64_tr_b16 v[52:53], v2 offset:20480
  ds_read_b64_tr_b16 v[54:55], v2 offset:23040
  ds_read_b64_tr_b16 v[56:57], v3 offset:0
  buffer_load_dwordx4 v31, s[44:47], s74 offen offset:2048 lds
  ds_read_b64_tr_b16 v[58:59], v3 offset:2560
  ds_read_b64_tr_b16 v[60:61], v3 offset:20480
  ds_read_b64_tr_b16 v[62:63], v3 offset:23040
  ds_read_b64_tr_b16 v[64:65], v4 offset:0
  buffer_load_dwordx4 v32, s[44:47], s74 offen offset:3072 lds
  ds_read_b64_tr_b16 v[66:67], v4 offset:2560
  ds_read_b64_tr_b16 v[68:69], v4 offset:20480
  ds_read_b64_tr_b16 v[70:71], v4 offset:23040
  ds_read_b128 v[80:83], v11 offset:0
  s_add_u32 m0, m0, 4096
  s_nop 0
  buffer_load_dwordx4 v33, s[44:47], s74 offen offset:0 lds
  s_add_u32 s74, s74, 212992
  ds_read_b128 v[84:87], v12 offset:0
  ds_read_b128 v[88:91], v11 offset:2048
  ds_read_b128 v[92:95], v12 offset:2048
  ds_read_b128 v[96:99], v11 offset:4096
  s_waitcnt vmcnt(12)
  v_lshl_add_u32 v34, v20, 7, v15
  v_lshl_add_u32 v28, v16, 7, v14
  s_add_u32 m0, s76, 8192
  s_nop 0
  buffer_load_dwordx4 v28, s[32:35], 0 offen lds
  ds_read_b128 v[100:103], v12 offset:4096
  ds_read_b128 v[104:107], v11 offset:6144
  ds_read_b128 v[108:111], v12 offset:6144
  ds_read_b64_tr_b16 v[72:73], v5 offset:0
  s_add_u32 m0, m0, 1024
  s_nop 0
  buffer_load_dwordx4 v34, s[32:35], 0 offen lds
  ds_read_b64_tr_b16 v[74:75], v5 offset:2560
  ds_read_b64_tr_b16 v[76:77], v5 offset:20480
  ds_read_b64_tr_b16 v[78:79], v5 offset:23040
  s_waitcnt vmcnt(9) lgkmcnt(0)
  s_barrier
  s_setprio 0
  v_mfma_f32_16x16x32_bf16 v[140:143], v[40:43], v[80:83], v[140:143]
  v_mfma_f32_16x16x32_bf16 v[140:143], v[44:47], v[84:87], v[140:143]
  v_mfma_f32_16x16x32_bf16 v[144:147], v[40:43], v[88:91], v[144:147]
  v_mfma_f32_16x16x32_bf16 v[144:147], v[44:47], v[92:95], v[144:147]
  v_mfma_f32_16x16x32_bf16 v[148:151], v[40:43], v[96:99], v[148:151]
  v_mfma_f32_16x16x32_bf16 v[148:151], v[44:47], v[100:103], v[148:151]
  v_mfma_f32_16x16x32_bf16 v[152:155], v[40:43], v[104:107], v[152:155]
  v_mfma_f32_16x16x32_bf16 v[152:155], v[44:47], v[108:111], v[152:155]
  v_mfma_f32_16x16x32_bf16 v[168:171], v[48:51], v[104:107], v[168:171]
  v_mfma_f32_16x16x32_bf16 v[168:171], v[52:55], v[108:111], v[168:171]
  v_mfma_f32_16x16x32_bf16 v[164:167], v[48:51], v[96:99], v[164:167]
  v_mfma_f32_16x16x32_bf16 v[164:167], v[52:55], v[100:103], v[164:167]
  v_mfma_f32_16x16x32_bf16 v[160:163], v[48:51], v[88:91], v[160:163]
  v_mfma_f32_16x16x32_bf16 v[160:163], v[52:55], v[92:95], v[160:163]
  v_mfma_f32_16x16x32_bf16 v[156:159], v[48:51], v[80:83], v[156:159]
  v_mfma_f32_16x16x32_bf16 v[156:159], v[52:55], v[84:87], v[156:159]
  v_mfma_f32_16x16x32_bf16 v[172:175], v[56:59], v[80:83], v[172:175]
  v_mfma_f32_16x16x32_bf16 v[172:175], v[60:63], v[84:87], v[172:175]
  v_mfma_f32_16x16x32_bf16 v[176:179], v[56:59], v[88:91], v[176:179]
  v_mfma_f32_16x16x32_bf16 v[176:179], v[60:63], v[92:95], v[176:179]
  v_mfma_f32_16x16x32_bf16 v[180:183], v[56:59], v[96:99], v[180:183]
  v_mfma_f32_16x16x32_bf16 v[180:183], v[60:63], v[100:103], v[180:183]
  v_mfma_f32_16x16x32_bf16 v[184:187], v[56:59], v[104:107], v[184:187]
  v_mfma_f32_16x16x32_bf16 v[184:187], v[60:63], v[108:111], v[184:187]
  v_mfma_f32_16x16x32_bf16 v[200:203], v[64:67], v[104:107], v[200:203]
  v_mfma_f32_16x16x32_bf16 v[200:203], v[68:71], v[108:111], v[200:203]
  v_mfma_f32_16x16x32_bf16 v[196:199], v[64:67], v[96:99], v[196:199]
  v_mfma_f32_16x16x32_bf16 v[196:199], v[68:71], v[100:103], v[196:199]
  v_mfma_f32_16x16x32_bf16 v[192:195], v[64:67], v[88:91], v[192:195]
  v_mfma_f32_16x16x32_bf16 v[192:195], v[68:71], v[92:95], v[192:195]
  v_mfma_f32_16x16x32_bf16 v[188:191], v[64:67], v[80:83], v[188:191]
  v_mfma_f32_16x16x32_bf16 v[188:191], v[68:71], v[84:87], v[188:191]
  v_mfma_f32_16x16x32_bf16 v[204:207], v[72:75], v[80:83], v[204:207]
  v_mfma_f32_16x16x32_bf16 v[204:207], v[76:79], v[84:87], v[204:207]
  v_mfma_f32_16x16x32_bf16 v[208:211], v[72:75], v[88:91], v[208:211]
  v_mfma_f32_16x16x32_bf16 v[208:211], v[76:79], v[92:95], v[208:211]
  v_mfma_f32_16x16x32_bf16 v[212:215], v[72:75], v[96:99], v[212:215]
  v_mfma_f32_16x16x32_bf16 v[212:215], v[76:79], v[100:103], v[212:215]
  v_mfma_f32_16x16x32_bf16 v[216:219], v[72:75], v[104:107], v[216:219]
  s_setprio 2
  s_waitcnt vmcnt(9)
  s_barrier
  v_mfma_f32_16x16x32_bf16 v[216:219], v[76:79], v[108:111], v[216:219]
  ds_read_b64_tr_b16 v[40:41], v1 offset:40960
  s_add_u32 m0, s75, 0
  s_nop 0
  buffer_load_dwordx4 v29, s[44:47], s74 offen offset:0 lds
  ds_read_b64_tr_b16 v[42:43], v1 offset:43520
  ds_read_b64_tr_b16 v[44:45], v6 offset:0
  ds_read_b64_tr_b16 v[46:47], v6 offset:2560
  ds_read_b64_tr_b16 v[48:49], v2 offset:40960
  buffer_load_dwordx4 v30, s[44:47], s74 offen offset:1024 lds
  ds_read_b64_tr_b16 v[50:51], v2 offset:43520
  ds_read_b64_tr_b16 v[52:53], v7 offset:0
  ds_read_b64_tr_b16 v[54:55], v7 offset:2560
  ds_read_b64_tr_b16 v[56:57], v3 offset:40960
  buffer_load_dwordx4 v31, s[44:47], s74 offen offset:2048 lds
  ds_read_b64_tr_b16 v[58:59], v3 offset:43520
  ds_read_b64_tr_b16 v[60:61], v8 offset:0
  ds_read_b64_tr_b16 v[62:63], v8 offset:2560
  ds_read_b64_tr_b16 v[64:65], v4 offset:40960
  buffer_load_dwordx4 v32, s[44:47], s74 offen offset:3072 lds
  ds_read_b64_tr_b16 v[66:67], v4 offset:43520
  ds_read_b64_tr_b16 v[68:69], v9 offset:0
  ds_read_b64_tr_b16 v[70:71], v9 offset:2560
  ds_read_b128 v[80:83], v11 offset:8192
  s_add_u32 m0, m0, 4096
  s_nop 0
  buffer_load_dwordx4 v33, s[44:47], s74 offen offset:0 lds
  s_add_u32 s74, s74, 212992
  ds_read_b128 v[84:87], v12 offset:8192
  ds_read_b128 v[88:91], v11 offset:10240
  ds_read_b128 v[92:95], v12 offset:10240
  ds_read_b128 v[96:99], v11 offset:12288
  v_lshl_add_u32 v34, v21, 7, v15
  v_lshl_add_u32 v28, v17, 7, v14
  s_add_u32 m0, s76, 0
  s_nop 0
  buffer_load_dwordx4 v28, s[32:35], 0 offen lds
  ds_read_b128 v[100:103], v12 offset:12288
  ds_read_b128 v[104:107], v11 offset:14336
  ds_read_b128 v[108:111], v12 offset:14336
  ds_read_b64_tr_b16 v[72:73], v5 offset:40960
  s_add_u32 m0, m0, 1024
  s_nop 0
  buffer_load_dwordx4 v34, s[32:35], 0 offen lds
  ds_read_b64_tr_b16 v[74:75], v5 offset:43520
  ds_read_b64_tr_b16 v[76:77], v10 offset:0
  ds_read_b64_tr_b16 v[78:79], v10 offset:2560
  s_waitcnt vmcnt(7) lgkmcnt(0)
  s_barrier
  s_setprio 0
  v_mfma_f32_16x16x32_bf16 v[140:143], v[40:43], v[80:83], v[140:143]
  v_mfma_f32_16x16x32_bf16 v[140:143], v[44:47], v[84:87], v[140:143]
  v_mfma_f32_16x16x32_bf16 v[144:147], v[40:43], v[88:91], v[144:147]
  v_mfma_f32_16x16x32_bf16 v[144:147], v[44:47], v[92:95], v[144:147]
  v_mfma_f32_16x16x32_bf16 v[148:151], v[40:43], v[96:99], v[148:151]
  v_mfma_f32_16x16x32_bf16 v[148:151], v[44:47], v[100:103], v[148:151]
  v_mfma_f32_16x16x32_bf16 v[152:155], v[40:43], v[104:107], v[152:155]
  v_mfma_f32_16x16x32_bf16 v[152:155], v[44:47], v[108:111], v[152:155]
  v_mfma_f32_16x16x32_bf16 v[168:171], v[48:51], v[104:107], v[168:171]
  v_mfma_f32_16x16x32_bf16 v[168:171], v[52:55], v[108:111], v[168:171]
  v_mfma_f32_16x16x32_bf16 v[164:167], v[48:51], v[96:99], v[164:167]
  v_mfma_f32_16x16x32_bf16 v[164:167], v[52:55], v[100:103], v[164:167]
  v_mfma_f32_16x16x32_bf16 v[160:163], v[48:51], v[88:91], v[160:163]
  v_mfma_f32_16x16x32_bf16 v[160:163], v[52:55], v[92:95], v[160:163]
  v_mfma_f32_16x16x32_bf16 v[156:159], v[48:51], v[80:83], v[156:159]
  v_mfma_f32_16x16x32_bf16 v[156:159], v[52:55], v[84:87], v[156:159]
  v_mfma_f32_16x16x32_bf16 v[172:175], v[56:59], v[80:83], v[172:175]
  v_mfma_f32_16x16x32_bf16 v[172:175], v[60:63], v[84:87], v[172:175]
  v_mfma_f32_16x16x32_bf16 v[176:179], v[56:59], v[88:91], v[176:179]
  v_mfma_f32_16x16x32_bf16 v[176:179], v[60:63], v[92:95], v[176:179]
  v_mfma_f32_16x16x32_bf16 v[180:183], v[56:59], v[96:99], v[180:183]
  v_mfma_f32_16x16x32_bf16 v[180:183], v[60:63], v[100:103], v[180:183]
  v_mfma_f32_16x16x32_bf16 v[184:187], v[56:59], v[104:107], v[184:187]
  v_mfma_f32_16x16x32_bf16 v[184:187], v[60:63], v[108:111], v[184:187]
  v_mfma_f32_16x16x32_bf16 v[200:203], v[64:67], v[104:107], v[200:203]
  v_mfma_f32_16x16x32_bf16 v[200:203], v[68:71], v[108:111], v[200:203]
  v_mfma_f32_16x16x32_bf16 v[196:199], v[64:67], v[96:99], v[196:199]
  v_mfma_f32_16x16x32_bf16 v[196:199], v[68:71], v[100:103], v[196:199]
  v_mfma_f32_16x16x32_bf16 v[192:195], v[64:67], v[88:91], v[192:195]
  v_mfma_f32_16x16x32_bf16 v[192:195], v[68:71], v[92:95], v[192:195]
  v_mfma_f32_16x16x32_bf16 v[188:191], v[64:67], v[80:83], v[188:191]
  v_mfma_f32_16x16x32_bf16 v[188:191], v[68:71], v[84:87], v[188:191]
  v_mfma_f32_16x16x32_bf16 v[204:207], v[72:75], v[80:83], v[204:207]
  v_mfma_f32_16x16x32_bf16 v[204:207], v[76:79], v[84:87], v[204:207]
  v_mfma_f32_16x16x32_bf16 v[208:211], v[72:75], v[88:91], v[208:211]
  v_mfma_f32_16x16x32_bf16 v[208:211], v[76:79], v[92:95], v[208:211]
  v_mfma_f32_16x16x32_bf16 v[212:215], v[72:75], v[96:99], v[212:215]
  v_mfma_f32_16x16x32_bf16 v[212:215], v[76:79], v[100:103], v[212:215]
  v_mfma_f32_16x16x32_bf16 v[216:219], v[72:75], v[104:107], v[216:219]
  s_setprio 2
  s_barrier
  v_mfma_f32_16x16x32_bf16 v[216:219], v[76:79], v[108:111], v[216:219]
  ds_read_b64_tr_b16 v[40:41], v6 offset:20480
  s_add_u32 m0, s75, 40960
  s_nop 0
  buffer_load_dwordx4 v29, s[44:47], s74 offen offset:0 lds
  ds_read_b64_tr_b16 v[42:43], v6 offset:23040
  ds_read_b64_tr_b16 v[44:45], v6 offset:40960
  ds_read_b64_tr_b16 v[46:47], v6 offset:43520
  ds_read_b64_tr_b16 v[48:49], v7 offset:20480
  buffer_load_dwordx4 v30, s[44:47], s74 offen offset:1024 lds
  ds_read_b64_tr_b16 v[50:51], v7 offset:23040
  ds_read_b64_tr_b16 v[52:53], v7 offset:40960
  ds_read_b64_tr_b16 v[54:55], v7 offset:43520
  ds_read_b64_tr_b16 v[56:57], v8 offset:20480
  buffer_load_dwordx4 v31, s[44:47], s74 offen offset:2048 lds
  ds_read_b64_tr_b16 v[58:59], v8 offset:23040
  ds_read_b64_tr_b16 v[60:61], v8 offset:40960
  ds_read_b64_tr_b16 v[62:63], v8 offset:43520
  ds_read_b64_tr_b16 v[64:65], v9 offset:20480
  buffer_load_dwordx4 v32, s[44:47], s74 offen offset:3072 lds
  ds_read_b64_tr_b16 v[66:67], v9 offset:23040
  ds_read_b64_tr_b16 v[68:69], v9 offset:40960
  ds_read_b64_tr_b16 v[70:71], v9 offset:43520
  ds_read_b128 v[80:83], v11 offset:0
  s_add_u32 m0, m0, 4096
  s_nop 0
  buffer_load_dwordx4 v33, s[44:47], s74 offen offset:0 lds
  s_add_u32 s74, s74, 212992
  ds_read_b128 v[84:87], v12 offset:0
  ds_read_b128 v[88:91], v11 offset:2048
  ds_read_b128 v[92:95], v12 offset:2048
  ds_read_b128 v[96:99], v11 offset:4096
  v_lshl_add_u32 v34, v22, 7, v15
  v_lshl_add_u32 v28, v18, 7, v14
  s_add_u32 m0, s76, 8192
  s_nop 0
  buffer_load_dwordx4 v28, s[32:35], 0 offen lds
  ds_read_b128 v[100:103], v12 offset:4096
  ds_read_b128 v[104:107], v11 offset:6144
  ds_read_b128 v[108:111], v12 offset:6144
  ds_read_b64_tr_b16 v[72:73], v10 offset:20480
  s_add_u32 m0, m0, 1024
  s_nop 0
  buffer_load_dwordx4 v34, s[32:35], 0 offen lds
  ds_read_b64_tr_b16 v[74:75], v10 offset:23040
  ds_read_b64_tr_b16 v[76:77], v10 offset:40960
  ds_read_b64_tr_b16 v[78:79], v10 offset:43520
  buffer_load_dwordx3 v[16:18], v13, s[28:31], s73 offen offset:0
  buffer_load_dwordx3 v[20:22], v13, s[28:31], s73 offen offset:832
  s_add_u32 s73, s73, 12
  s_waitcnt vmcnt(9) lgkmcnt(0)
  s_barrier
  s_setprio 0
  v_mfma_f32_16x16x32_bf16 v[140:143], v[40:43], v[80:83], v[140:143]
  v_mfma_f32_16x16x32_bf16 v[140:143], v[44:47], v[84:87], v[140:143]
  v_mfma_f32_16x16x32_bf16 v[144:147], v[40:43], v[88:91], v[144:147]
  v_mfma_f32_16x16x32_bf16 v[144:147], v[44:47], v[92:95], v[144:147]
  v_mfma_f32_16x16x32_bf16 v[148:151], v[40:43], v[96:99], v[148:151]
  v_mfma_f32_16x16x32_bf16 v[148:151], v[44:47], v[100:103], v[148:151]
  v_mfma_f32_16x16x32_bf16 v[152:155], v[40:43], v[104:107], v[152:155]
  v_mfma_f32_16x16x32_bf16 v[152:155], v[44:47], v[108:111], v[152:155]
  v_mfma_f32_16x16x32_bf16 v[168:171], v[48:51], v[104:107], v[168:171]
  v_mfma_f32_16x16x32_bf16 v[168:171], v[52:55], v[108:111], v[168:171]
  v_mfma_f32_16x16x32_bf16 v[164:167], v[48:51], v[96:99], v[164:167]
  v_mfma_f32_16x16x32_bf16 v[164:167], v[52:55], v[100:103], v[164:167]
  v_mfma_f32_16x16x32_bf16 v[160:163], v[48:51], v[88:91], v[160:163]
  v_mfma_f32_16x16x32_bf16 v[160:163], v[52:55], v[92:95], v[160:163]
  v_mfma_f32_16x16x32_bf16 v[156:159], v[48:51], v[80:83], v[156:159]
  v_mfma_f32_16x16x32_bf16 v[156:159], v[52:55], v[84:87], v[156:159]
  v_mfma_f32_16x16x32_bf16 v[172:175], v[56:59], v[80:83], v[172:175]
  v_mfma_f32_16x16x32_bf16 v[172:175], v[60:63], v[84:87], v[172:175]
  v_mfma_f32_16x16x32_bf16 v[176:179], v[56:59], v[88:91], v[176:179]
  v_mfma_f32_16x16x32_bf16 v[176:179], v[60:63], v[92:95], v[176:179]
  v_mfma_f32_16x16x32_bf16 v[180:183], v[56:59], v[96:99], v[180:183]
  v_mfma_f32_16x16x32_bf16 v[180:183], v[60:63], v[100:103], v[180:183]
  v_mfma_f32_16x16x32_bf16 v[184:187], v[56:59], v[104:107], v[184:187]
  v_mfma_f32_16x16x32_bf16 v[184:187], v[60:63], v[108:111], v[184:187]
  v_mfma_f32_16x16x32_bf16 v[200:203], v[64:67], v[104:107], v[200:203]
  v_mfma_f32_16x16x32_bf16 v[200:203], v[68:71], v[108:111], v[200:203]
  v_mfma_f32_16x16x32_bf16 v[196:199], v[64:67], v[96:99], v[196:199]
  v_mfma_f32_16x16x32_bf16 v[196:199], v[68:71], v[100:103], v[196:199]
  v_mfma_f32_16x16x32_bf16 v[192:195], v[64:67], v[88:91], v[192:195]
  v_mfma_f32_16x16x32_bf16 v[192:195], v[68:71], v[92:95], v[192:195]
  v_mfma_f32_16x16x32_bf16 v[188:191], v[64:67], v[80:83], v[188:191]
  v_mfma_f32_16x16x32_bf16 v[188:191], v[68:71], v[84:87], v[188:191]
  v_mfma_f32_16x16x32_bf16 v[204:207], v[72:75], v[80:83], v[204:207]
  v_mfma_f32_16x16x32_bf16 v[204:207], v[76:79], v[84:87], v[204:207]
  v_mfma_f32_16x16x32_bf16 v[208:211], v[72:75], v[88:91], v[208:211]
  v_mfma_f32_16x16x32_bf16 v[208:211], v[76:79], v[92:95], v[208:211]
  v_mfma_f32_16x16x32_bf16 v[212:215], v[72:75], v[96:99], v[212:215]
  v_mfma_f32_16x16x32_bf16 v[212:215], v[76:79], v[100:103], v[212:215]
  v_mfma_f32_16x16x32_bf16 v[216:219], v[72:75], v[104:107], v[216:219]
  s_setprio 2
  s_barrier
  v_mfma_f32_16x16x32_bf16 v[216:219], v[76:79], v[108:111], v[216:219]
  ds_read_b64_tr_b16 v[40:41], v1 offset:0
  s_add_u32 m0, s75, 81920
  s_nop 0
  buffer_load_dwordx4 v29, s[44:47], s74 offen offset:0 lds
  ds_read_b64_tr_b16 v[42:43], v1 offset:2560
  ds_read_b64_tr_b16 v[44:45], v1 offset:20480
  ds_read_b64_tr_b16 v[46:47], v1 offset:23040
  ds_read_b64_tr_b16 v[48:49], v2 offset:0
  buffer_load_dwordx4 v30, s[44:47], s74 offen offset:1024 lds
  ds_read_b64_tr_b16 v[50:51], v2 offset:2560
  ds_read_b64_tr_b16 v[52:53], v2 offset:20480
  ds_read_b64_tr_b16 v[54:55], v2 offset:23040
  ds_read_b64_tr_b16 v[56:57], v3 offset:0
  buffer_load_dwordx4 v31, s[44:47], s74 offen offset:2048 lds
  ds_read_b64_tr_b16 v[58:59], v3 offset:2560
  ds_read_b64_tr_b16 v[60:61], v3 offset:20480
  ds_read_b64_tr_b16 v[62:63], v3 offset:23040
  ds_read_b64_tr_b16 v[64:65], v4 offset:0
  buffer_load_dwordx4 v32, s[44:47], s74 offen offset:3072 lds
  ds_read_b64_tr_b16 v[66:67], v4 offset:2560
  ds_read_b64_tr_b16 v[68:69], v4 offset:20480
  ds_read_b64_tr_b16 v[70:71], v4 offset:23040
  ds_read_b128 v[80:83], v11 offset:8192
  s_add_u32 m0, m0, 4096
  s_nop 0
  buffer_load_dwordx4 v33, s[44:47], s74 offen offset:0 lds
  s_add_u32 s74, s74, 212992
  ds_read_b128 v[84:87], v12 offset:8192
  ds_read_b128 v[88:91], v11 offset:10240
  ds_read_b128 v[92:95], v12 offset:10240
  ds_read_b128 v[96:99], v11 offset:12288
  v_lshl_add_u32 v34, v240, 7, v15
  v_lshl_add_u32 v28, v24, 7, v14
  s_add_u32 m0, s76, 0
  s_nop 0
  buffer_load_dwordx4 v28, s[32:35], 0 offen lds
  ds_read_b128 v[100:103], v12 offset:12288
  ds_read_b128 v[104:107], v11 offset:14336
  ds_read_b128 v[108:111], v12 offset:14336
  ds_read_b64_tr_b16 v[72:73], v5 offset:0
  s_add_u32 m0, m0, 1024
  s_nop 0
  buffer_load_dwordx4 v34, s[32:35], 0 offen lds
  ds_read_b64_tr_b16 v[74:75], v5 offset:2560
  ds_read_b64_tr_b16 v[76:77], v5 offset:20480
  ds_read_b64_tr_b16 v[78:79], v5 offset:23040
  s_waitcnt vmcnt(9) lgkmcnt(0)
  s_barrier
  s_setprio 0
  v_mfma_f32_16x16x32_bf16 v[140:143], v[40:43], v[80:83], v[140:143]
  v_mfma_f32_16x16x32_bf16 v[140:143], v[44:47], v[84:87], v[140:143]
  v_mfma_f32_16x16x32_bf16 v[144:147], v[40:43], v[88:91], v[144:147]
  v_mfma_f32_16x16x32_bf16 v[144:147], v[44:47], v[92:95], v[144:147]
  v_mfma_f32_16x16x32_bf16 v[148:151], v[40:43], v[96:99], v[148:151]
  v_mfma_f32_16x16x32_bf16 v[148:151], v[44:47], v[100:103], v[148:151]
  v_mfma_f32_16x16x32_bf16 v[152:155], v[40:43], v[104:107], v[152:155]
  v_mfma_f32_16x16x32_bf16 v[152:155], v[44:47], v[108:111], v[152:155]
  v_mfma_f32_16x16x32_bf16 v[168:171], v[48:51], v[104:107], v[168:171]
  v_mfma_f32_16x16x32_bf16 v[168:171], v[52:55], v[108:111], v[168:171]
  v_mfma_f32_16x16x32_bf16 v[164:167], v[48:51], v[96:99], v[164:167]
  v_mfma_f32_16x16x32_bf16 v[164:167], v[52:55], v[100:103], v[164:167]
  v_mfma_f32_16x16x32_bf16 v[160:163], v[48:51], v[88:91], v[160:163]
  v_mfma_f32_16x16x32_bf16 v[160:163], v[52:55], v[92:95], v[160:163]
  v_mfma_f32_16x16x32_bf16 v[156:159], v[48:51], v[80:83], v[156:159]
  v_mfma_f32_16x16x32_bf16 v[156:159], v[52:55], v[84:87], v[156:159]
  v_mfma_f32_16x16x32_bf16 v[172:175], v[56:59], v[80:83], v[172:175]
  v_mfma_f32_16x16x32_bf16 v[172:175], v[60:63], v[84:87], v[172:175]
  v_mfma_f32_16x16x32_bf16 v[176:179], v[56:59], v[88:91], v[176:179]
  v_mfma_f32_16x16x32_bf16 v[176:179], v[60:63], v[92:95], v[176:179]
  v_mfma_f32_16x16x32_bf16 v[180:183], v[56:59], v[96:99], v[180:183]
  v_mfma_f32_16x16x32_bf16 v[180:183], v[60:63], v[100:103], v[180:183]
  v_mfma_f32_16x16x32_bf16 v[184:187], v[56:59], v[104:107], v[184:187]
  v_mfma_f32_16x16x32_bf16 v[184:187], v[60:63], v[108:111], v[184:187]
  v_mfma_f32_16x16x32_bf16 v[200:203], v[64:67], v[104:107], v[200:203]
  v_mfma_f32_16x16x32_bf16 v[200:203], v[68:71], v[108:111], v[200:203]
  v_mfma_f32_16x16x32_bf16 v[196:199], v[64:67], v[96:99], v[196:199]
  v_mfma_f32_16x16x32_bf16 v[196:199], v[68:71], v[100:103], v[196:199]
  v_mfma_f32_16x16x32_bf16 v[192:195], v[64:67], v[88:91], v[192:195]
  v_mfma_f32_16x16x32_bf16 v[192:195], v[68:71], v[92:95], v[192:195]
  v_mfma_f32_16x16x32_bf16 v[188:191], v[64:67], v[80:83], v[188:191]
  v_mfma_f32_16x16x32_bf16 v[188:191], v[68:71], v[84:87], v[188:191]
  v_mfma_f32_16x16x32_bf16 v[204:207], v[72:75], v[80:83], v[204:207]
  v_mfma_f32_16x16x32_bf16 v[204:207], v[76:79], v[84:87], v[204:207]
  v_mfma_f32_16x16x32_bf16 v[208:211], v[72:75], v[88:91], v[208:211]
  v_mfma_f32_16x16x32_bf16 v[208:211], v[76:79], v[92:95], v[208:211]
  v_mfma_f32_16x16x32_bf16 v[212:215], v[72:75], v[96:99], v[212:215]
  v_mfma_f32_16x16x32_bf16 v[212:215], v[76:79], v[100:103], v[212:215]
  v_mfma_f32_16x16x32_bf16 v[216:219], v[72:75], v[104:107], v[216:219]
  s_setprio 2
  s_barrier
  v_mfma_f32_16x16x32_bf16 v[216:219], v[76:79], v[108:111], v[216:219]
  ds_read_b64_tr_b16 v[40:41], v1 offset:40960
  s_add_u32 m0, s75, 0
  s_nop 0
  buffer_load_dwordx4 v29, s[44:47], s74 offen offset:0 lds
  ds_read_b64_tr_b16 v[42:43], v1 offset:43520
  ds_read_b64_tr_b16 v[44:45], v6 offset:0
  ds_read_b64_tr_b16 v[46:47], v6 offset:2560
  ds_read_b64_tr_b16 v[48:49], v2 offset:40960
  buffer_load_dwordx4 v30, s[44:47], s74 offen offset:1024 lds
  ds_read_b64_tr_b16 v[50:51], v2 offset:43520
  ds_read_b64_tr_b16 v[52:53], v7 offset:0
  ds_read_b64_tr_b16 v[54:55], v7 offset:2560
  ds_read_b64_tr_b16 v[56:57], v3 offset:40960
  buffer_load_dwordx4 v31, s[44:47], s74 offen offset:2048 lds
  ds_read_b64_tr_b16 v[58:59], v3 offset:43520
  ds_read_b64_tr_b16 v[60:61], v8 offset:0
  ds_read_b64_tr_b16 v[62:63], v8 offset:2560
  ds_read_b64_tr_b16 v[64:65], v4 offset:40960
  buffer_load_dwordx4 v32, s[44:47], s74 offen offset:3072 lds
  ds_read_b64_tr_b16 v[66:67], v4 offset:43520
  ds_read_b64_tr_b16 v[68:69], v9 offset:0
  ds_read_b64_tr_b16 v[70:71], v9 offset:2560
  ds_read_b128 v[80:83], v11 offset:0
  s_add_u32 m0, m0, 4096
  s_nop 0
  buffer_load_dwordx4 v33, s[44:47], s74 offen offset:0 lds
  s_add_u32 s74, s74, 212992
  ds_read_b128 v[84:87], v12 offset:0
  ds_read_b128 v[88:91], v11 offset:2048
  ds_read_b128 v[92:95], v12 offset:2048
  ds_read_b128 v[96:99], v11 offset:4096
  v_lshl_add_u32 v34, v241, 7, v15
  v_lshl_add_u32 v28, v25, 7, v14
  s_add_u32 m0, s76, 8192
  s_nop 0
  buffer_load_dwordx4 v28, s[32:35], 0 offen lds
  ds_read_b128 v[100:103], v12 offset:4096
  ds_read_b128 v[104:107], v11 offset:6144
  ds_read_b128 v[108:111], v12 offset:6144
  ds_read_b64_tr_b16 v[72:73], v5 offset:40960
  s_add_u32 m0, m0, 1024
  s_nop 0
  buffer_load_dwordx4 v34, s[32:35], 0 offen lds
  ds_read_b64_tr_b16 v[74:75], v5 offset:43520
  ds_read_b64_tr_b16 v[76:77], v10 offset:0
  ds_read_b64_tr_b16 v[78:79], v10 offset:2560
  s_waitcnt vmcnt(7) lgkmcnt(0)
  s_barrier
  s_setprio 0
  v_mfma_f32_16x16x32_bf16 v[140:143], v[40:43], v[80:83], v[140:143]
  v_mfma_f32_16x16x32_bf16 v[140:143], v[44:47], v[84:87], v[140:143]
  v_mfma_f32_16x16x32_bf16 v[144:147], v[40:43], v[88:91], v[144:147]
  v_mfma_f32_16x16x32_bf16 v[144:147], v[44:47], v[92:95], v[144:147]
  v_mfma_f32_16x16x32_bf16 v[148:151], v[40:43], v[96:99], v[148:151]
  v_mfma_f32_16x16x32_bf16 v[148:151], v[44:47], v[100:103], v[148:151]
  v_mfma_f32_16x16x32_bf16 v[152:155], v[40:43], v[104:107], v[152:155]
  v_mfma_f32_16x16x32_bf16 v[152:155], v[44:47], v[108:111], v[152:155]
  v_mfma_f32_16x16x32_bf16 v[168:171], v[48:51], v[104:107], v[168:171]
  v_mfma_f32_16x16x32_bf16 v[168:171], v[52:55], v[108:111], v[168:171]
  v_mfma_f32_16x16x32_bf16 v[164:167], v[48:51], v[96:99], v[164:167]
  v_mfma_f32_16x16x32_bf16 v[164:167], v[52:55], v[100:103], v[164:167]
  v_mfma_f32_16x16x32_bf16 v[160:163], v[48:51], v[88:91], v[160:163]
  v_mfma_f32_16x16x32_bf16 v[160:163], v[52:55], v[92:95], v[160:163]
  v_mfma_f32_16x16x32_bf16 v[156:159], v[48:51], v[80:83], v[156:159]
  v_mfma_f32_16x16x32_bf16 v[156:159], v[52:55], v[84:87], v[156:159]
  v_mfma_f32_16x16x32_bf16 v[172:175], v[56:59], v[80:83], v[172:175]
  v_mfma_f32_16x16x32_bf16 v[172:175], v[60:63], v[84:87], v[172:175]
  v_mfma_f32_16x16x32_bf16 v[176:179], v[56:59], v[88:91], v[176:179]
  v_mfma_f32_16x16x32_bf16 v[176:179], v[60:63], v[92:95], v[176:179]
  v_mfma_f32_16x16x32_bf16 v[180:183], v[56:59], v[96:99], v[180:183]
  v_mfma_f32_16x16x32_bf16 v[180:183], v[60:63], v[100:103], v[180:183]
  v_mfma_f32_16x16x32_bf16 v[184:187], v[56:59], v[104:107], v[184:187]
  v_mfma_f32_16x16x32_bf16 v[184:187], v[60:63], v[108:111], v[184:187]
  v_mfma_f32_16x16x32_bf16 v[200:203], v[64:67], v[104:107], v[200:203]
  v_mfma_f32_16x16x32_bf16 v[200:203], v[68:71], v[108:111], v[200:203]
  v_mfma_f32_16x16x32_bf16 v[196:199], v[64:67], v[96:99], v[196:199]
  v_mfma_f32_16x16x32_bf16 v[196:199], v[68:71], v[100:103], v[196:199]
  v_mfma_f32_16x16x32_bf16 v[192:195], v[64:67], v[88:91], v[192:195]
  v_mfma_f32_16x16x32_bf16 v[192:195], v[68:71], v[92:95], v[192:195]
  v_mfma_f32_16x16x32_bf16 v[188:191], v[64:67], v[80:83], v[188:191]
  v_mfma_f32_16x16x32_bf16 v[188:191], v[68:71], v[84:87], v[188:191]
  v_mfma_f32_16x16x32_bf16 v[204:207], v[72:75], v[80:83], v[204:207]
  v_mfma_f32_16x16x32_bf16 v[204:207], v[76:79], v[84:87], v[204:207]
  v_mfma_f32_16x16x32_bf16 v[208:211], v[72:75], v[88:91], v[208:211]
  v_mfma_f32_16x16x32_bf16 v[208:211], v[76:79], v[92:95], v[208:211]
  v_mfma_f32_16x16x32_bf16 v[212:215], v[72:75], v[96:99], v[212:215]
  v_mfma_f32_16x16x32_bf16 v[212:215], v[76:79], v[100:103], v[212:215]
  v_mfma_f32_16x16x32_bf16 v[216:219], v[72:75], v[104:107], v[216:219]
  s_setprio 2
  s_barrier
  v_mfma_f32_16x16x32_bf16 v[216:219], v[76:79], v[108:111], v[216:219]
  ds_read_b64_tr_b16 v[40:41], v6 offset:20480
  s_add_u32 m0, s75, 40960
  s_nop 0
  buffer_load_dwordx4 v29, s[44:47], s74 offen offset:0 lds
  ds_read_b64_tr_b16 v[42:43], v6 offset:23040
  ds_read_b64_tr_b16 v[44:45], v6 offset:40960
  ds_read_b64_tr_b16 v[46:47], v6 offset:43520
  ds_read_b64_tr_b16 v[48:49], v7 offset:20480
  buffer_load_dwordx4 v30, s[44:47], s74 offen offset:1024 lds
  ds_read_b64_tr_b16 v[50:51], v7 offset:23040
  ds_read_b64_tr_b16 v[52:53], v7 offset:40960
  ds_read_b64_tr_b16 v[54:55], v7 offset:43520
  ds_read_b64_tr_b16 v[56:57], v8 offset:20480
  buffer_load_dwordx4 v31, s[44:47], s74 offen offset:2048 lds
  ds_read_b64_tr_b16 v[58:59], v8 offset:23040
  ds_read_b64_tr_b16 v[60:61], v8 offset:40960
  ds_read_b64_tr_b16 v[62:63], v8 offset:43520
  ds_read_b64_tr_b16 v[64:65], v9 offset:20480
  buffer_load_dwordx4 v32, s[44:47], s74 offen offset:3072 lds
  ds_read_b64_tr_b16 v[66:67], v9 offset:23040
  ds_read_b64_tr_b16 v[68:69], v9 offset:40960
  ds_read_b64_tr_b16 v[70:71], v9 offset:43520
  ds_read_b128 v[80:83], v11 offset:8192
  s_add_u32 m0, m0, 4096
  s_nop 0
  buffer_load_dwordx4 v33, s[44:47], s74 offen offset:0 lds
  s_add_u32 s74, s74, 212992
  ds_read_b128 v[84:87], v12 offset:8192
  ds_read_b128 v[88:91], v11 offset:10240
  ds_read_b128 v[92:95], v12 offset:10240
  ds_read_b128 v[96:99], v11 offset:12288
  v_lshl_add_u32 v34, v242, 7, v15
  v_lshl_add_u32 v28, v26, 7, v14
  s_add_u32 m0, s76, 0
  s_nop 0
  buffer_load_dwordx4 v28, s[32:35], 0 offen lds
  ds_read_b128 v[100:103], v12 offset:12288
  ds_read_b128 v[104:107], v11 offset:14336
  ds_read_b128 v[108:111], v12 offset:14336
  ds_read_b64_tr_b16 v[72:73], v10 offset:20480
  s_add_u32 m0, m0, 1024
  s_nop 0
  buffer_load_dwordx4 v34, s[32:35], 0 offen lds
  ds_read_b64_tr_b16 v[74:75], v10 offset:23040
  ds_read_b64_tr_b16 v[76:77], v10 offset:40960
  ds_read_b64_tr_b16 v[78:79], v10 offset:43520
  buffer_load_dwordx3 v[24:26], v13, s[28:31], s73 offen offset:0
  buffer_load_dwordx3 v[240:242], v13, s[28:31], s73 offen offset:832
  s_add_u32 s73, s73, 12
  s_waitcnt vmcnt(9) lgkmcnt(0)
  s_barrier
  s_setprio 0
  v_mfma_f32_16x16x32_bf16 v[140:143], v[40:43], v[80:83], v[140:143]
  s_add_u32 s72, s72, 1
  v_mfma_f32_16x16x32_bf16 v[140:143], v[44:47], v[84:87], v[140:143]
  v_mfma_f32_16x16x32_bf16 v[144:147], v[40:43], v[88:91], v[144:147]
  v_mfma_f32_16x16x32_bf16 v[144:147], v[44:47], v[92:95], v[144:147]
  v_mfma_f32_16x16x32_bf16 v[148:151], v[40:43], v[96:99], v[148:151]
  v_mfma_f32_16x16x32_bf16 v[148:151], v[44:47], v[100:103], v[148:151]
  v_mfma_f32_16x16x32_bf16 v[152:155], v[40:43], v[104:107], v[152:155]
  v_mfma_f32_16x16x32_bf16 v[152:155], v[44:47], v[108:111], v[152:155]
  v_mfma_f32_16x16x32_bf16 v[168:171], v[48:51], v[104:107], v[168:171]
  v_mfma_f32_16x16x32_bf16 v[168:171], v[52:55], v[108:111], v[168:171]
  v_mfma_f32_16x16x32_bf16 v[164:167], v[48:51], v[96:99], v[164:167]
  v_mfma_f32_16x16x32_bf16 v[164:167], v[52:55], v[100:103], v[164:167]
  v_mfma_f32_16x16x32_bf16 v[160:163], v[48:51], v[88:91], v[160:163]
  v_mfma_f32_16x16x32_bf16 v[160:163], v[52:55], v[92:95], v[160:163]
  v_mfma_f32_16x16x32_bf16 v[156:159], v[48:51], v[80:83], v[156:159]
  v_mfma_f32_16x16x32_bf16 v[156:159], v[52:55], v[84:87], v[156:159]
  v_mfma_f32_16x16x32_bf16 v[172:175], v[56:59], v[80:83], v[172:175]
  v_mfma_f32_16x16x32_bf16 v[172:175], v[60:63], v[84:87], v[172:175]
  v_mfma_f32_16x16x32_bf16 v[176:179], v[56:59], v[88:91], v[176:179]
  v_mfma_f32_16x16x32_bf16 v[176:179], v[60:63], v[92:95], v[176:179]
  s_cmp_lt_u32 s72, 4
  v_mfma_f32_16x16x32_bf16 v[180:183], v[56:59], v[96:99], v[180:183]
  v_mfma_f32_16x16x32_bf16 v[180:183], v[60:63], v[100:103], v[180:183]
  v_mfma_f32_16x16x32_bf16 v[184:187], v[56:59], v[104:107], v[184:187]
  v_mfma_f32_16x16x32_bf16 v[184:187], v[60:63], v[108:111], v[184:187]
  v_mfma_f32_16x16x32_bf16 v[200:203], v[64:67], v[104:107], v[200:203]
  v_mfma_f32_16x16x32_bf16 v[200:203], v[68:71], v[108:111], v[200:203]
  v_mfma_f32_16x16x32_bf16 v[196:199], v[64:67], v[96:99], v[196:199]
  v_mfma_f32_16x16x32_bf16 v[196:199], v[68:71], v[100:103], v[196:199]
  v_mfma_f32_16x16x32_bf16 v[192:195], v[64:67], v[88:91], v[192:195]
  v_mfma_f32_16x16x32_bf16 v[192:195], v[68:71], v[92:95], v[192:195]
  v_mfma_f32_16x16x32_bf16 v[188:191], v[64:67], v[80:83], v[188:191]
  v_mfma_f32_16x16x32_bf16 v[188:191], v[68:71], v[84:87], v[188:191]
  v_mfma_f32_16x16x32_bf16 v[204:207], v[72:75], v[80:83], v[204:207]
  v_mfma_f32_16x16x32_bf16 v[204:207], v[76:79], v[84:87], v[204:207]
  v_mfma_f32_16x16x32_bf16 v[208:211], v[72:75], v[88:91], v[208:211]
  v_mfma_f32_16x16x32_bf16 v[208:211], v[76:79], v[92:95], v[208:211]
  v_mfma_f32_16x16x32_bf16 v[212:215], v[72:75], v[96:99], v[212:215]
  v_mfma_f32_16x16x32_bf16 v[212:215], v[76:79], v[100:103], v[212:215]
  v_mfma_f32_16x16x32_bf16 v[216:219], v[72:75], v[104:107], v[216:219]
  s_setprio 2
  s_barrier
  v_mfma_f32_16x16x32_bf16 v[216:219], v[76:79], v[108:111], v[216:219]
  s_cbranch_scc1 L_dnn_loop0
  ds_read_b64_tr_b16 v[40:41], v1 offset:0
  v_lshl_add_u32 v34, v20, 7, v15
  v_lshl_add_u32 v28, v16, 7, v14
  s_add_u32 m0, s76, 8192
  s_nop 0
  buffer_load_dwordx4 v28, s[32:35], 0 offen lds
  ds_read_b64_tr_b16 v[42:43], v1 offset:2560
  ds_read_b64_tr_b16 v[44:45], v1 offset:20480
  ds_read_b64_tr_b16 v[46:47], v1 offset:23040
  ds_read_b64_tr_b16 v[48:49], v2 offset:0
  ds_read_b64_tr_b16 v[50:51], v2 offset:2560
  ds_read_b64_tr_b16 v[52:53], v2 offset:20480
  ds_read_b64_tr_b16 v[54:55], v2 offset:23040
  ds_read_b64_tr_b16 v[56:57], v3 offset:0
  ds_read_b64_tr_b16 v[58:59], v3 offset:2560
  ds_read_b64_tr_b16 v[60:61], v3 offset:20480
  ds_read_b64_tr_b16 v[62:63], v3 offset:23040
  ds_read_b64_tr_b16 v[64:65], v4 offset:0
  ds_read_b64_tr_b16 v[66:67], v4 offset:2560
  ds_read_b64_tr_b16 v[68:69], v4 offset:20480
  ds_read_b64_tr_b16 v[70:71], v4 offset:23040
  ds_read_b128 v[80:83], v11 offset:0
  s_add_u32 m0, m0, 1024
  s_nop 0
  buffer_load_dwordx4 v34, s[32:35], 0 offen lds
  ds_read_b128 v[84:87], v12 offset:0
  ds_read_b128 v[88:91], v11 offset:2048
  ds_read_b128 v[92:95], v12 offset:2048
  ds_read_b128 v[96:99], v11 offset:4096
  ds_read_b128 v[100:103], v12 offset:4096
  ds_read_b128 v[104:107], v11 offset:6144
  ds_read_b128 v[108:111], v12 offset:6144
  ds_read_b64_tr_b16 v[72:73], v5 offset:0
  ds_read_b64_tr_b16 v[74:75], v5 offset:2560
  ds_read_b64_tr_b16 v[76:77], v5 offset:20480
  ds_read_b64_tr_b16 v[78:79], v5 offset:23040
  ds_read_b64 v[220:221], v35 offset:640
  ds_read_b64 v[222:223], v35 offset:672
  ds_read_b64 v[224:225], v35 offset:704
  ds_read_b64 v[226:227], v35 offset:736
  ds_read_b64 v[228:229], v35 offset:768
  s_mov_b32 s60, s24
  s_and_b32 s61, s25, 0xffff
  s_mov_b32 s62, 268435456
  s_mov_b32 s63, 0x20000
  s_mov_b32 s64, s22
  s_and_b32 s65, s23, 0xffff
  s_mov_b32 s66, 256
  s_mov_b32 s67, 0x20000
  v_lshlrev_b32 v28, 2, v0
  s_mov_b64 exec, 0xff
  s_mov_b32 s81, 0x80000
  buffer_load_dword v255, v28, s[60:63], s81 offen
  buffer_load_dword v37, v28, s[64:67], 0 offen offset:128 sc1
  s_mov_b64 exec, -1
  v_mov_b32 v28, 0
  s_waitcnt vmcnt(6) lgkmcnt(0)
  s_barrier
  s_setprio 0
  v_mfma_f32_16x16x32_bf16 v[140:143], v[40:43], v[80:83], v[140:143]
  v_mov_b32 v232, 0xc0135761
  v_mov_b32 v233, 0xc0135761
  v_mfma_f32_16x16x32_bf16 v[140:143], v[44:47], v[84:87], v[140:143]
  v_mov_b32 v234, 0xbdd2d3e8
  v_mov_b32 v235, 0xbdd2d3e8
  v_mfma_f32_16x16x32_bf16 v[144:147], v[40:43], v[88:91], v[144:147]
  v_mov_b32 v236, 0xc2b40000
  v_mov_b32 v237, 0xc2b40000
  v_mfma_f32_16x16x32_bf16 v[144:147], v[44:47], v[92:95], v[144:147]
  v_lshlrev_b32 v112, 16, v220
  v_and_b32 v113, 0xffff0000, v220
  v_mfma_f32_16x16x32_bf16 v[148:151], v[40:43], v[96:99], v[148:151]
  v_lshlrev_b32 v114, 16, v221
  v_and_b32 v115, 0xffff0000, v221
  v_mfma_f32_16x16x32_bf16 v[148:151], v[44:47], v[100:103], v[148:151]
  v_lshlrev_b32 v116, 16, v222
  v_and_b32 v117, 0xffff0000, v222
  v_mfma_f32_16x16x32_bf16 v[152:155], v[40:43], v[104:107], v[152:155]
  v_lshlrev_b32 v118, 16, v223
  v_and_b32 v119, 0xffff0000, v223
  v_mfma_f32_16x16x32_bf16 v[152:155], v[44:47], v[108:111], v[152:155]
  v_lshlrev_b32 v120, 16, v224
  v_and_b32 v121, 0xffff0000, v224
  v_mfma_f32_16x16x32_bf16 v[168:171], v[48:51], v[104:107], v[168:171]
  v_lshlrev_b32 v122, 16, v225
  v_and_b32 v123, 0xffff0000, v225
  v_mfma_f32_16x16x32_bf16 v[168:171], v[52:55], v[108:111], v[168:171]
  v_lshlrev_b32 v124, 16, v226
  v_mfma_f32_16x16x32_bf16 v[164:167], v[48:51], v[96:99], v[164:167]
  v_and_b32 v125, 0xffff0000, v226
  v_lshlrev_b32 v126, 16, v227
  v_mfma_f32_16x16x32_bf16 v[164:167], v[52:55], v[100:103], v[164:167]
  v_and_b32 v127, 0xffff0000, v227
  v_lshlrev_b32 v128, 16, v228
  v_mfma_f32_16x16x32_bf16 v[160:163], v[48:51], v[88:91], v[160:163]
  v_and_b32 v129, 0xffff0000, v228
  v_lshlrev_b32 v130, 16, v229
  v_mfma_f32_16x16x32_bf16 v[160:163], v[52:55], v[92:95], v[160:163]
  v_and_b32 v131, 0xffff0000, v229
  v_mov_b32 v239, 0x21800000
  v_mfma_f32_16x16x32_bf16 v[156:159], v[48:51], v[80:83], v[156:159]
  v_mov_b32 v238, 0x30800000
  v_max3_f32 v239, v239, abs(v112), abs(v113)
  v_mfma_f32_16x16x32_bf16 v[156:159], v[52:55], v[84:87], v[156:159]
  v_max3_f32 v239, v239, abs(v114), abs(v115)
  v_max3_f32 v239, v239, abs(v116), abs(v117)
  v_mfma_f32_16x16x32_bf16 v[172:175], v[56:59], v[80:83], v[172:175]
  v_max3_f32 v239, v239, abs(v118), abs(v119)
  v_max3_f32 v239, v239, abs(v120), abs(v121)
  v_mfma_f32_16x16x32_bf16 v[172:175], v[60:63], v[84:87], v[172:175]
  v_max3_f32 v239, v239, abs(v122), abs(v123)
  v_max3_f32 v239, v239, abs(v124), abs(v125)
  v_mfma_f32_16x16x32_bf16 v[176:179], v[56:59], v[88:91], v[176:179]
  v_max3_f32 v239, v239, abs(v126), abs(v127)
  v_mfma_f32_16x16x32_bf16 v[176:179], v[60:63], v[92:95], v[176:179]
  v_max3_f32 v239, v239, abs(v128), abs(v129)
  v_max3_f32 v239, v239, abs(v130), abs(v131)
  v_mfma_f32_16x16x32_bf16 v[180:183], v[56:59], v[96:99], v[180:183]
  v_and_b32 v239, 0x7f800000, v239
  v_mul_f32 v239, 0x22000000, v239
  v_mfma_f32_16x16x32_bf16 v[180:183], v[60:63], v[100:103], v[180:183]
  v_rcp_f32 v112, v112
  v_mfma_f32_16x16x32_bf16 v[184:187], v[56:59], v[104:107], v[184:187]
  v_rcp_f32 v113, v113
  v_mfma_f32_16x16x32_bf16 v[184:187], v[60:63], v[108:111], v[184:187]
  v_rcp_f32 v114, v114
  v_mfma_f32_16x16x32_bf16 v[200:203], v[64:67], v[104:107], v[200:203]
  v_rcp_f32 v115, v115
  v_mfma_f32_16x16x32_bf16 v[200:203], v[68:71], v[108:111], v[200:203]
  v_rcp_f32 v116, v116
  v_mfma_f32_16x16x32_bf16 v[196:199], v[64:67], v[96:99], v[196:199]
  v_rcp_f32 v117, v117
  v_mfma_f32_16x16x32_bf16 v[196:199], v[68:71], v[100:103], v[196:199]
  v_rcp_f32 v118, v118
  v_mfma_f32_16x16x32_bf16 v[192:195], v[64:67], v[88:91], v[192:195]
  v_rcp_f32 v119, v119
  v_mfma_f32_16x16x32_bf16 v[192:195], v[68:71], v[92:95], v[192:195]
  v_rcp_f32 v120, v120
  v_mfma_f32_16x16x32_bf16 v[188:191], v[64:67], v[80:83], v[188:191]
  v_rcp_f32 v121, v121
  v_mfma_f32_16x16x32_bf16 v[188:191], v[68:71], v[84:87], v[188:191]
  v_rcp_f32 v122, v122
  v_mfma_f32_16x16x32_bf16 v[204:207], v[72:75], v[80:83], v[204:207]
  v_rcp_f32 v123, v123
  v_mfma_f32_16x16x32_bf16 v[204:207], v[76:79], v[84:87], v[204:207]
  v_rcp_f32 v124, v124
  v_mfma_f32_16x16x32_bf16 v[208:211], v[72:75], v[88:91], v[208:211]
  v_rcp_f32 v125, v125
  v_mfma_f32_16x16x32_bf16 v[208:211], v[76:79], v[92:95], v[208:211]
  v_rcp_f32 v126, v126
  v_mfma_f32_16x16x32_bf16 v[212:215], v[72:75], v[96:99], v[212:215]
  v_rcp_f32 v127, v127
  v_mfma_f32_16x16x32_bf16 v[212:215], v[76:79], v[100:103], v[212:215]
  v_mfma_f32_16x16x32_bf16 v[216:219], v[72:75], v[104:107], v[216:219]
  s_setprio 2
  s_barrier
  v_mfma_f32_16x16x32_bf16 v[216:219], v[76:79], v[108:111], v[216:219]
  ds_read_b64_tr_b16 v[40:41], v1 offset:40960
  ds_read_b64_tr_b16 v[42:43], v1 offset:43520
  ds_read_b64_tr_b16 v[44:45], v6 offset:0
  ds_read_b64_tr_b16 v[46:47], v6 offset:2560
  ds_read_b64_tr_b16 v[48:49], v2 offset:40960
  ds_read_b64_tr_b16 v[50:51], v2 offset:43520
  ds_read_b64_tr_b16 v[52:53], v7 offset:0
  ds_read_b64_tr_b16 v[54:55], v7 offset:2560
  ds_read_b64_tr_b16 v[56:57], v3 offset:40960
  ds_read_b64_tr_b16 v[58:59], v3 offset:43520
  ds_read_b64_tr_b16 v[60:61], v8 offset:0
  ds_read_b64_tr_b16 v[62:63], v8 offset:2560
  ds_read_b64_tr_b16 v[64:65], v4 offset:40960
  ds_read_b64_tr_b16 v[66:67], v4 offset:43520
  ds_read_b64_tr_b16 v[68:69], v9 offset:0
  ds_read_b64_tr_b16 v[70:71], v9 offset:2560
  ds_read_b128 v[80:83], v11 offset:8192
  ds_read_b128 v[84:87], v12 offset:8192
  ds_read_b128 v[88:91], v11 offset:10240
  ds_read_b128 v[92:95], v12 offset:10240
  ds_read_b128 v[96:99], v11 offset:12288
  ds_read_b128 v[100:103], v12 offset:12288
  ds_read_b128 v[104:107], v11 offset:14336
  ds_read_b128 v[108:111], v12 offset:14336
  ds_read_b64_tr_b16 v[72:73], v5 offset:40960
  ds_read_b64_tr_b16 v[74:75], v5 offset:43520
  ds_read_b64_tr_b16 v[76:77], v10 offset:0
  ds_read_b64_tr_b16 v[78:79], v10 offset:2560
  s_waitcnt vmcnt(2) lgkmcnt(0)
  s_barrier
  s_setprio 0
  v_mfma_f32_16x16x32_bf16 v[140:143], v[40:43], v[80:83], v[140:143]
  v_rcp_f32 v128, v128
  v_mfma_f32_16x16x32_bf16 v[140:143], v[44:47], v[84:87], v[140:143]
  v_rcp_f32 v129, v129
  v_mfma_f32_16x16x32_bf16 v[144:147], v[40:43], v[88:91], v[144:147]
  v_rcp_f32 v130, v130
  v_mfma_f32_16x16x32_bf16 v[144:147], v[44:47], v[92:95], v[144:147]
  v_rcp_f32 v131, v131
  v_mfma_f32_16x16x32_bf16 v[148:151], v[40:43], v[96:99], v[148:151]
  v_mul_f32 v112, v239, v112
  v_mfma_f32_16x16x32_bf16 v[148:151], v[44:47], v[100:103], v[148:151]
  v_mul_f32 v113, v239, v113
  v_mul_f32 v114, v239, v114
  v_mfma_f32_16x16x32_bf16 v[152:155], v[40:43], v[104:107], v[152:155]
  v_mul_f32 v115, v239, v115
  v_mul_f32 v116, v239, v116
  v_mfma_f32_16x16x32_bf16 v[152:155], v[44:47], v[108:111], v[152:155]
  v_mul_f32 v117, v239, v117
  v_mul_f32 v118, v239, v118
  v_mfma_f32_16x16x32_bf16 v[168:171], v[48:51], v[104:107], v[168:171]
  v_mul_f32 v119, v239, v119
  v_mul_f32 v120, v239, v120
  v_mfma_f32_16x16x32_bf16 v[168:171], v[52:55], v[108:111], v[168:171]
  v_mul_f32 v121, v239, v121
  v_mfma_f32_16x16x32_bf16 v[164:167], v[48:51], v[96:99], v[164:167]
  v_mul_f32 v122, v239, v122
  v_mul_f32 v123, v239, v123
  v_mfma_f32_16x16x32_bf16 v[164:167], v[52:55], v[100:103], v[164:167]
  v_mul_f32 v124, v239, v124
  v_mul_f32 v125, v239, v125
  v_mfma_f32_16x16x32_bf16 v[160:163], v[48:51], v[88:91], v[160:163]
  v_mul_f32 v126, v239, v126
  v_mul_f32 v127, v239, v127
  v_mfma_f32_16x16x32_bf16 v[160:163], v[52:55], v[92:95], v[160:163]
  v_mul_f32 v128, v239, v128
  v_mul_f32 v129, v239, v129
  v_mfma_f32_16x16x32_bf16 v[156:159], v[48:51], v[80:83], v[156:159]
  v_mul_f32 v130, v239, v130
  v_mfma_f32_16x16x32_bf16 v[156:159], v[52:55], v[84:87], v[156:159]
  v_mul_f32 v131, v239, v131
  v_med3_f32 v112, v112, -v238, v238
  v_mfma_f32_16x16x32_bf16 v[172:175], v[56:59], v[80:83], v[172:175]
  v_med3_f32 v113, v113, -v238, v238
  v_med3_f32 v114, v114, -v238, v238
  v_mfma_f32_16x16x32_bf16 v[172:175], v[60:63], v[84:87], v[172:175]
  v_med3_f32 v115, v115, -v238, v238
  v_med3_f32 v116, v116, -v238, v238
  v_mfma_f32_16x16x32_bf16 v[176:179], v[56:59], v[88:91], v[176:179]
  v_med3_f32 v117, v117, -v238, v238
  v_mfma_f32_16x16x32_bf16 v[176:179], v[60:63], v[92:95], v[176:179]
  v_med3_f32 v118, v118, -v238, v238
  v_med3_f32 v119, v119, -v238, v238
  v_mfma_f32_16x16x32_bf16 v[180:183], v[56:59], v[96:99], v[180:183]
  v_med3_f32 v120, v120, -v238, v238
  v_med3_f32 v121, v121, -v238, v238
  v_mfma_f32_16x16x32_bf16 v[180:183], v[60:63], v[100:103], v[180:183]
  v_med3_f32 v122, v122, -v238, v238
  v_med3_f32 v123, v123, -v238, v238
  v_mfma_f32_16x16x32_bf16 v[184:187], v[56:59], v[104:107], v[184:187]
  v_med3_f32 v124, v124, -v238, v238
  v_med3_f32 v125, v125, -v238, v238
  v_mfma_f32_16x16x32_bf16 v[184:187], v[60:63], v[108:111], v[184:187]
  v_med3_f32 v126, v126, -v238, v238
  v_mfma_f32_16x16x32_bf16 v[200:203], v[64:67], v[104:107], v[200:203]
  v_med3_f32 v127, v127, -v238, v238
  v_med3_f32 v128, v128, -v238, v238
  v_mfma_f32_16x16x32_bf16 v[200:203], v[68:71], v[108:111], v[200:203]
  v_med3_f32 v129, v129, -v238, v238
  v_med3_f32 v130, v130, -v238, v238
  v_mfma_f32_16x16x32_bf16 v[196:199], v[64:67], v[96:99], v[196:199]
  v_med3_f32 v131, v131, -v238, v238
  v_mul_f32 v132, 0x6c800000, v112
  v_mfma_f32_16x16x32_bf16 v[196:199], v[68:71], v[100:103], v[196:199]
  v_mul_f32 v133, 0x6c800000, v113
  v_mul_f32 v134, 0x6c800000, v114
  v_mfma_f32_16x16x32_bf16 v[192:195], v[64:67], v[88:91], v[192:195]
  v_mul_f32 v135, 0x6c800000, v115
  v_mfma_f32_16x16x32_bf16 v[192:195], v[68:71], v[92:95], v[192:195]
  v_mul_f32 v136, 0x6c800000, v116
  v_mul_f32 v137, 0x6c800000, v117
  v_mfma_f32_16x16x32_bf16 v[188:191], v[64:67], v[80:83], v[188:191]
  v_mul_f32 v138, 0x6c800000, v118
  v_mul_f32 v139, 0x6c800000, v119
  v_mfma_f32_16x16x32_bf16 v[188:191], v[68:71], v[84:87], v[188:191]
  v_mul_f32 v220, 0x6c800000, v120
  v_mul_f32 v221, 0x6c800000, v121
  v_mfma_f32_16x16x32_bf16 v[204:207], v[72:75], v[80:83], v[204:207]
  v_mul_f32 v222, 0x6c800000, v122
  v_mul_f32 v223, 0x6c800000, v123
  v_mfma_f32_16x16x32_bf16 v[204:207], v[76:79], v[84:87], v[204:207]
  v_mul_f32 v224, 0x6c800000, v124
  v_mfma_f32_16x16x32_bf16 v[208:211], v[72:75], v[88:91], v[208:211]
  v_mul_f32 v225, 0x6c800000, v125
  v_mul_f32 v226, 0x6c800000, v126
  v_mfma_f32_16x16x32_bf16 v[208:211], v[76:79], v[92:95], v[208:211]
  v_mul_f32 v227, 0x6c800000, v127
  v_mul_f32 v228, 0x6c800000, v128
  v_mfma_f32_16x16x32_bf16 v[212:215], v[72:75], v[96:99], v[212:215]
  v_mul_f32 v229, 0x6c800000, v129
  v_mul_f32 v230, 0x6c800000, v130
  v_mfma_f32_16x16x32_bf16 v[212:215], v[76:79], v[100:103], v[212:215]
  v_mul_f32 v231, 0x6c800000, v131
  v_mfma_f32_16x16x32_bf16 v[216:219], v[72:75], v[104:107], v[216:219]
  s_setprio 2
  s_barrier
  v_mfma_f32_16x16x32_bf16 v[216:219], v[76:79], v[108:111], v[216:219]
  s_setprio 0
  s_branch L_epi
L_dnn_h1:
  v_lshl_add_u32 v34, v49, 7, v15
  v_lshl_add_u32 v28, v45, 7, v14
  s_add_u32 m0, s76, 8192
  s_nop 0
  buffer_load_dwordx4 v28, s[32:35], 0 offen lds
  s_add_u32 m0, m0, 1024
  s_nop 0
  buffer_load_dwordx4 v34, s[32:35], 0 offen lds
  s_add_u32 m0, s75, 40960
  s_nop 0
  buffer_load_dwordx4 v29, s[44:47], s74 offen offset:0 lds
  buffer_load_dwordx4 v30, s[44:47], s74 offen offset:1024 lds
  buffer_load_dwordx4 v31, s[44:47], s74 offen offset:2048 lds
  buffer_load_dwordx4 v32, s[44:47], s74 offen offset:3072 lds
  s_add_u32 m0, m0, 4096
  s_nop 0
  buffer_load_dwordx4 v33, s[44:47], s74 offen offset:0 lds
  s_add_u32 s74, s74, 212992
  s_waitcnt vmcnt(13)
  s_waitcnt vmcnt(10) lgkmcnt(0)
  s_barrier
  buffer_load_dwordx3 v[24:26], v13, s[28:31], s73 offen offset:0
  buffer_load_dwordx3 v[240:242], v13, s[28:31], s73 offen offset:832
  s_add_u32 s73, s73, 12
  s_barrier
L_dnn_loop1:
  ds_read_b64_tr_b16 v[40:41], v1 offset:0
  s_add_u32 m0, s75, 81920
  s_nop 0
  buffer_load_dwordx4 v29, s[44:47], s74 offen offset:0 lds
  ds_read_b64_tr_b16 v[42:43], v1 offset:2560
  ds_read_b64_tr_b16 v[44:45], v1 offset:20480
  ds_read_b64_tr_b16 v[46:47], v1 offset:23040
  ds_read_b64_tr_b16 v[48:49], v2 offset:0
  buffer_load_dwordx4 v30, s[44:47], s74 offen offset:1024 lds
  ds_read_b64_tr_b16 v[50:51], v2 offset:2560
  ds_read_b64_tr_b16 v[52:53], v2 offset:20480
  ds_read_b64_tr_b16 v[54:55], v2 offset:23040
  ds_read_b64_tr_b16 v[56:57], v3 offset:0
  buffer_load_dwordx4 v31, s[44:47], s74 offen offset:2048 lds
  ds_read_b64_tr_b16 v[58:59], v3 offset:2560
  ds_read_b64_tr_b16 v[60:61], v3 offset:20480
  ds_read_b64_tr_b16 v[62:63], v3 offset:23040
  ds_read_b64_tr_b16 v[64:65], v4 offset:0
  buffer_load_dwordx4 v32, s[44:47], s74 offen offset:3072 lds
  ds_read_b64_tr_b16 v[66:67], v4 offset:2560
  ds_read_b64_tr_b16 v[68:69], v4 offset:20480
  ds_read_b64_tr_b16 v[70:71], v4 offset:23040
  ds_read_b128 v[80:83], v11 offset:0
  s_add_u32 m0, m0, 4096
  s_nop 0
  buffer_load_dwordx4 v33, s[44:47], s74 offen offset:0 lds
  s_add_u32 s74, s74, 212992
  ds_read_b128 v[84:87], v12 offset:0
  ds_read_b128 v[88:91], v11 offset:2048
  ds_read_b128 v[92:95], v12 offset:2048
  ds_read_b128 v[96:99], v11 offset:4096
  s_waitcnt vmcnt(14)
  v_lshl_add_u32 v34, v20, 7, v15
  v_lshl_add_u32 v28, v16, 7, v14
  s_add_u32 m0, s76, 0
  s_nop 0
  buffer_load_dwordx4 v28, s[32:35], 0 offen lds
  ds_read_b128 v[100:103], v12 offset:4096
  ds_read_b128 v[104:107], v11 offset:6144
  ds_read_b128 v[108:111], v12 offset:6144
  ds_read_b64_tr_b16 v[72:73], v5 offset:0
  s_add_u32 m0, m0, 1024
  s_nop 0
  buffer_load_dwordx4 v34, s[32:35], 0 offen lds
  ds_read_b64_tr_b16 v[74:75], v5 offset:2560
  ds_read_b64_tr_b16 v[76:77], v5 offset:20480
  ds_read_b64_tr_b16 v[78:79], v5 offset:23040
  s_waitcnt vmcnt(9) lgkmcnt(0)
  s_waitcnt vmcnt(9)
  s_barrier
  s_setprio 0
  v_mfma_f32_16x16x32_bf16 v[140:143], v[40:43], v[80:83], v[140:143]
  v_mfma_f32_16x16x32_bf16 v[140:143], v[44:47], v[84:87], v[140:143]
  v_mfma_f32_16x16x32_bf16 v[144:147], v[40:43], v[88:91], v[144:147]
  v_mfma_f32_16x16x32_bf16 v[144:147], v[44:47], v[92:95], v[144:147]
  v_mfma_f32_16x16x32_bf16 v[148:151], v[40:43], v[96:99], v[148:151]
  v_mfma_f32_16x16x32_bf16 v[148:151], v[44:47], v[100:103], v[148:151]
  v_mfma_f32_16x16x32_bf16 v[152:155], v[40:43], v[104:107], v[152:155]
  v_mfma_f32_16x16x32_bf16 v[152:155], v[44:47], v[108:111], v[152:155]
  v_mfma_f32_16x16x32_bf16 v[168:171], v[48:51], v[104:107], v[168:171]
  v_mfma_f32_16x16x32_bf16 v[168:171], v[52:55], v[108:111], v[168:171]
  v_mfma_f32_16x16x32_bf16 v[164:167], v[48:51], v[96:99], v[164:167]
  v_mfma_f32_16x16x32_bf16 v[164:167], v[52:55], v[100:103], v[164:167]
  v_mfma_f32_16x16x32_bf16 v[160:163], v[48:51], v[88:91], v[160:163]
  v_mfma_f32_16x16x32_bf16 v[160:163], v[52:55], v[92:95], v[160:163]
  v_mfma_f32_16x16x32_bf16 v[156:159], v[48:51], v[80:83], v[156:159]
  v_mfma_f32_16x16x32_bf16 v[156:159], v[52:55], v[84:87], v[156:159]
  v_mfma_f32_16x16x32_bf16 v[172:175], v[56:59], v[80:83], v[172:175]
  v_mfma_f32_16x16x32_bf16 v[172:175], v[60:63], v[84:87], v[172:175]
  v_mfma_f32_16x16x32_bf16 v[176:179], v[56:59], v[88:91], v[176:179]
  v_mfma_f32_16x16x32_bf16 v[176:179], v[60:63], v[92:95], v[176:179]
  v_mfma_f32_16x16x32_bf16 v[180:183], v[56:59], v[96:99], v[180:183]
  v_mfma_f32_16x16x32_bf16 v[180:183], v[60:63], v[100:103], v[180:183]
  v_mfma_f32_16x16x32_bf16 v[184:187], v[56:59], v[104:107], v[184:187]
  v_mfma_f32_16x16x32_bf16 v[184:187], v[60:63], v[108:111], v[184:187]
  v_mfma_f32_16x16x32_bf16 v[200:203], v[64:67], v[104:107], v[200:203]
  v_mfma_f32_16x16x32_bf16 v[200:203], v[68:71], v[108:111], v[200:203]
  v_mfma_f32_16x16x32_bf16 v[196:199], v[64:67], v[96:99], v[196:199]
  v_mfma_f32_16x16x32_bf16 v[196:199], v[68:71], v[100:103], v[196:199]
  v_mfma_f32_16x16x32_bf16 v[192:195], v[64:67], v[88:91], v[192:195]
  v_mfma_f32_16x16x32_bf16 v[192:195], v[68:71], v[92:95], v[192:195]
  v_mfma_f32_16x16x32_bf16 v[188:191], v[64:67], v[80:83], v[188:191]
  v_mfma_f32_16x16x32_bf16 v[188:191], v[68:71], v[84:87], v[188:191]
  v_mfma_f32_16x16x32_bf16 v[204:207], v[72:75], v[80:83], v[204:207]
  v_mfma_f32_16x16x32_bf16 v[204:207], v[76:79], v[84:87], v[204:207]
  v_mfma_f32_16x16x32_bf16 v[208:211], v[72:75], v[88:91], v[208:211]
  v_mfma_f32_16x16x32_bf16 v[208:211], v[76:79], v[92:95], v[208:211]
  v_mfma_f32_16x16x32_bf16 v[212:215], v[72:75], v[96:99], v[212:215]
  v_mfma_f32_16x16x32_bf16 v[212:215], v[76:79], v[100:103], v[212:215]
  v_mfma_f32_16x16x32_bf16 v[216:219], v[72:75], v[104:107], v[216:219]
  s_setprio 2
  s_barrier
  v_mfma_f32_16x16x32_bf16 v[216:219], v[76:79], v[108:111], v[216:219]
  ds_read_b64_tr_b16 v[40:41], v1 offset:40960
  s_add_u32 m0, s75, 0
  s_nop 0
  buffer_load_dwordx4 v29, s[44:47], s74 offen offset:0 lds
  ds_read_b64_tr_b16 v[42:43], v1 offset:43520
  ds_read_b64_tr_b16 v[44:45], v6 offset:0
  ds_read_b64_tr_b16 v[46:47], v6 offset:2560
  ds_read_b64_tr_b16 v[48:49], v2 offset:40960
  buffer_load_dwordx4 v30, s[44:47], s74 offen offset:1024 lds
  ds_read_b64_tr_b16 v[50:51], v2 offset:43520
  ds_read_b64_tr_b16 v[52:53], v7 offset:0
  ds_read_b64_tr_b16 v[54:55], v7 offset:2560
  ds_read_b64_tr_b16 v[56:57], v3 offset:40960
  buffer_load_dwordx4 v31, s[44:47], s74 offen offset:2048 lds
  ds_read_b64_tr_b16 v[58:59], v3 offset:43520
  ds_read_b64_tr_b16 v[60:61], v8 offset:0
  ds_read_b64_tr_b16 v[62:63], v8 offset:2560
  ds_read_b64_tr_b16 v[64:65], v4 offset:40960
  buffer_load_dwordx4 v32, s[44:47], s74 offen offset:3072 lds
  ds_read_b64_tr_b16 v[66:67], v4 offset:43520
  ds_read_b64_tr_b16 v[68:69], v9 offset:0
  ds_read_b64_tr_b16 v[70:71], v9 offset:2560
  ds_read_b128 v[80:83], v11 offset:8192
  s_add_u32 m0, m0, 4096
  s_nop 0
  buffer_load_dwordx4 v33, s[44:47], s74 offen offset:0 lds
  s_add_u32 s74, s74, 212992
  ds_read_b128 v[84:87], v12 offset:8192
  ds_read_b128 v[88:91], v11 offset:10240
  ds_read_b128 v[92:95], v12 offset:10240
  ds_read_b128 v[96:99], v11 offset:12288
  v_lshl_add_u32 v34, v21, 7, v15
  v_lshl_add_u32 v28, v17, 7, v14
  s_add_u32 m0, s76, 8192
  s_nop 0
  buffer_load_dwordx4 v28, s[32:35], 0 offen lds
  ds_read_b128 v[100:103], v12 offset:12288
  ds_read_b128 v[104:107], v11 offset:14336
  ds_read_b128 v[108:111], v12 offset:14336
  ds_read_b64_tr_b16 v[72:73], v5 offset:40960
  s_add_u32 m0, m0, 1024
  s_nop 0
  buffer_load_dwordx4 v34, s[32:35], 0 offen lds
  ds_read_b64_tr_b16 v[74:75], v5 offset:43520
  ds_read_b64_tr_b16 v[76:77], v10 offset:0
  ds_read_b64_tr_b16 v[78:79], v10 offset:2560
  s_waitcnt vmcnt(7) lgkmcnt(0)
  s_barrier
  s_setprio 0
  v_mfma_f32_16x16x32_bf16 v[140:143], v[40:43], v[80:83], v[140:143]
  v_mfma_f32_16x16x32_bf16 v[140:143], v[44:47], v[84:87], v[140:143]
  v_mfma_f32_16x16x32_bf16 v[144:147], v[40:43], v[88:91], v[144:147]
  v_mfma_f32_16x16x32_bf16 v[144:147], v[44:47], v[92:95], v[144:147]
  v_mfma_f32_16x16x32_bf16 v[148:151], v[40:43], v[96:99], v[148:151]
  v_mfma_f32_16x16x32_bf16 v[148:151], v[44:47], v[100:103], v[148:151]
  v_mfma_f32_16x16x32_bf16 v[152:155], v[40:43], v[104:107], v[152:155]
  v_mfma_f32_16x16x32_bf16 v[152:155], v[44:47], v[108:111], v[152:155]
  v_mfma_f32_16x16x32_bf16 v[168:171], v[48:51], v[104:107], v[168:171]
  v_mfma_f32_16x16x32_bf16 v[168:171], v[52:55], v[108:111], v[168:171]
  v_mfma_f32_16x16x32_bf16 v[164:167], v[48:51], v[96:99], v[164:167]
  v_mfma_f32_16x16x32_bf16 v[164:167], v[52:55], v[100:103], v[164:167]
  v_mfma_f32_16x16x32_bf16 v[160:163], v[48:51], v[88:91], v[160:163]
  v_mfma_f32_16x16x32_bf16 v[160:163], v[52:55], v[92:95], v[160:163]
  v_mfma_f32_16x16x32_bf16 v[156:159], v[48:51], v[80:83], v[156:159]
  v_mfma_f32_16x16x32_bf16 v[156:159], v[52:55], v[84:87], v[156:159]
  v_mfma_f32_16x16x32_bf16 v[172:175], v[56:59], v[80:83], v[172:175]
  v_mfma_f32_16x16x32_bf16 v[172:175], v[60:63], v[84:87], v[172:175]
  v_mfma_f32_16x16x32_bf16 v[176:179], v[56:59], v[88:91], v[176:179]
  v_mfma_f32_16x16x32_bf16 v[176:179], v[60:63], v[92:95], v[176:179]
  v_mfma_f32_16x16x32_bf16 v[180:183], v[56:59], v[96:99], v[180:183]
  v_mfma_f32_16x16x32_bf16 v[180:183], v[60:63], v[100:103], v[180:183]
  v_mfma_f32_16x16x32_bf16 v[184:187], v[56:59], v[104:107], v[184:187]
  v_mfma_f32_16x16x32_bf16 v[184:187], v[60:63], v[108:111], v[184:187]
  v_mfma_f32_16x16x32_bf16 v[200:203], v[64:67], v[104:107], v[200:203]
  v_mfma_f32_16x16x32_bf16 v[200:203], v[68:71], v[108:111], v[200:203]
  v_mfma_f32_16x16x32_bf16 v[196:199], v[64:67], v[96:99], v[196:199]
  v_mfma_f32_16x16x32_bf16 v[196:199], v[68:71], v[100:103], v[196:199]
  v_mfma_f32_16x16x32_bf16 v[192:195], v[64:67], v[88:91], v[192:195]
  v_mfma_f32_16x16x32_bf16 v[192:195], v[68:71], v[92:95], v[192:195]
  v_mfma_f32_16x16x32_bf16 v[188:191], v[64:67], v[80:83], v[188:191]
  v_mfma_f32_16x16x32_bf16 v[188:191], v[68:71], v[84:87], v[188:191]
  v_mfma_f32_16x16x32_bf16 v[204:207], v[72:75], v[80:83], v[204:207]
  v_mfma_f32_16x16x32_bf16 v[204:207], v[76:79], v[84:87], v[204:207]
  v_mfma_f32_16x16x32_bf16 v[208:211], v[72:75], v[88:91], v[208:211]
  v_mfma_f32_16x16x32_bf16 v[208:211], v[76:79], v[92:95], v[208:211]
  v_mfma_f32_16x16x32_bf16 v[212:215], v[72:75], v[96:99], v[212:215]
  v_mfma_f32_16x16x32_bf16 v[212:215], v[76:79], v[100:103], v[212:215]
  v_mfma_f32_16x16x32_bf16 v[216:219], v[72:75], v[104:107], v[216:219]
  s_setprio 2
  s_barrier
  v_mfma_f32_16x16x32_bf16 v[216:219], v[76:79], v[108:111], v[216:219]
  ds_read_b64_tr_b16 v[40:41], v6 offset:20480
  s_add_u32 m0, s75, 40960
  s_nop 0
  buffer_load_dwordx4 v29, s[44:47], s74 offen offset:0 lds
  ds_read_b64_tr_b16 v[42:43], v6 offset:23040
  ds_read_b64_tr_b16 v[44:45], v6 offset:40960
  ds_read_b64_tr_b16 v[46:47], v6 offset:43520
  ds_read_b64_tr_b16 v[48:49], v7 offset:20480
  buffer_load_dwordx4 v30, s[44:47], s74 offen offset:1024 lds
  ds_read_b64_tr_b16 v[50:51], v7 offset:23040
  ds_read_b64_tr_b16 v[52:53], v7 offset:40960
  ds_read_b64_tr_b16 v[54:55], v7 offset:43520
  ds_read_b64_tr_b16 v[56:57], v8 offset:20480
  buffer_load_dwordx4 v31, s[44:47], s74 offen offset:2048 lds
  ds_read_b64_tr_b16 v[58:59], v8 offset:23040
  ds_read_b64_tr_b16 v[60:61], v8 offset:40960
  ds_read_b64_tr_b16 v[62:63], v8 offset:43520
  ds_read_b64_tr_b16 v[64:65], v9 offset:20480
  buffer_load_dwordx4 v32, s[44:47], s74 offen offset:3072 lds
  ds_read_b64_tr_b16 v[66:67], v9 offset:23040
  ds_read_b64_tr_b16 v[68:69], v9 offset:40960
  ds_read_b64_tr_b16 v[70:71], v9 offset:43520
  ds_read_b128 v[80:83], v11 offset:0
  s_add_u32 m0, m0, 4096
  s_nop 0
  buffer_load_dwordx4 v33, s[44:47], s74 offen offset:0 lds
  s_add_u32 s74, s74, 212992
  ds_read_b128 v[84:87], v12 offset:0
  ds_read_b128 v[88:91], v11 offset:2048
  ds_read_b128 v[92:95], v12 offset:2048
  ds_read_b128 v[96:99], v11 offset:4096
  v_lshl_add_u32 v34, v22, 7, v15
  v_lshl_add_u32 v28, v18, 7, v14
  s_add_u32 m0, s76, 0
  s_nop 0
  buffer_load_dwordx4 v28, s[32:35], 0 offen lds
  ds_read_b128 v[100:103], v12 offset:4096
  ds_read_b128 v[104:107], v11 offset:6144
  ds_read_b128 v[108:111], v12 offset:6144
  ds_read_b64_tr_b16 v[72:73], v10 offset:20480
  s_add_u32 m0, m0, 1024
  s_nop 0
  buffer_load_dwordx4 v34, s[32:35], 0 offen lds
  ds_read_b64_tr_b16 v[74:75], v10 offset:23040
  ds_read_b64_tr_b16 v[76:77], v10 offset:40960
  ds_read_b64_tr_b16 v[78:79], v10 offset:43520
  buffer_load_dwordx3 v[16:18], v13, s[28:31], s73 offen offset:0
  buffer_load_dwordx3 v[20:22], v13, s[28:31], s73 offen offset:832
  s_add_u32 s73, s73, 12
  s_waitcnt vmcnt(9) lgkmcnt(0)
  s_barrier
  s_setprio 0
  v_mfma_f32_16x16x32_bf16 v[140:143], v[40:43], v[80:83], v[140:143]
  v_mfma_f32_16x16x32_bf16 v[140:143], v[44:47], v[84:87], v[140:143]
  v_mfma_f32_16x16x32_bf16 v[144:147], v[40:43], v[88:91], v[144:147]
  v_mfma_f32_16x16x32_bf16 v[144:147], v[44:47], v[92:95], v[144:147]
  v_mfma_f32_16x16x32_bf16 v[148:151], v[40:43], v[96:99], v[148:151]
  v_mfma_f32_16x16x32_bf16 v[148:151], v[44:47], v[100:103], v[148:151]
  v_mfma_f32_16x16x32_bf16 v[152:155], v[40:43], v[104:107], v[152:155]
  v_mfma_f32_16x16x32_bf16 v[152:155], v[44:47], v[108:111], v[152:155]
  v_mfma_f32_16x16x32_bf16 v[168:171], v[48:51], v[104:107], v[168:171]
  v_mfma_f32_16x16x32_bf16 v[168:171], v[52:55], v[108:111], v[168:171]
  v_mfma_f32_16x16x32_bf16 v[164:167], v[48:51], v[96:99], v[164:167]
  v_mfma_f32_16x16x32_bf16 v[164:167], v[52:55], v[100:103], v[164:167]
  v_mfma_f32_16x16x32_bf16 v[160:163], v[48:51], v[88:91], v[160:163]
  v_mfma_f32_16x16x32_bf16 v[160:163], v[52:55], v[92:95], v[160:163]
  v_mfma_f32_16x16x32_bf16 v[156:159], v[48:51], v[80:83], v[156:159]
  v_mfma_f32_16x16x32_bf16 v[156:159], v[52:55], v[84:87], v[156:159]
  v_mfma_f32_16x16x32_bf16 v[172:175], v[56:59], v[80:83], v[172:175]
  v_mfma_f32_16x16x32_bf16 v[172:175], v[60:63], v[84:87], v[172:175]
  v_mfma_f32_16x16x32_bf16 v[176:179], v[56:59], v[88:91], v[176:179]
  v_mfma_f32_16x16x32_bf16 v[176:179], v[60:63], v[92:95], v[176:179]
  v_mfma_f32_16x16x32_bf16 v[180:183], v[56:59], v[96:99], v[180:183]
  v_mfma_f32_16x16x32_bf16 v[180:183], v[60:63], v[100:103], v[180:183]
  v_mfma_f32_16x16x32_bf16 v[184:187], v[56:59], v[104:107], v[184:187]
  v_mfma_f32_16x16x32_bf16 v[184:187], v[60:63], v[108:111], v[184:187]
  v_mfma_f32_16x16x32_bf16 v[200:203], v[64:67], v[104:107], v[200:203]
  v_mfma_f32_16x16x32_bf16 v[200:203], v[68:71], v[108:111], v[200:203]
  v_mfma_f32_16x16x32_bf16 v[196:199], v[64:67], v[96:99], v[196:199]
  v_mfma_f32_16x16x32_bf16 v[196:199], v[68:71], v[100:103], v[196:199]
  v_mfma_f32_16x16x32_bf16 v[192:195], v[64:67], v[88:91], v[192:195]
  v_mfma_f32_16x16x32_bf16 v[192:195], v[68:71], v[92:95], v[192:195]
  v_mfma_f32_16x16x32_bf16 v[188:191], v[64:67], v[80:83], v[188:191]
  v_mfma_f32_16x16x32_bf16 v[188:191], v[68:71], v[84:87], v[188:191]
  v_mfma_f32_16x16x32_bf16 v[204:207], v[72:75], v[80:83], v[204:207]
  v_mfma_f32_16x16x32_bf16 v[204:207], v[76:79], v[84:87], v[204:207]
  v_mfma_f32_16x16x32_bf16 v[208:211], v[72:75], v[88:91], v[208:211]
  v_mfma_f32_16x16x32_bf16 v[208:211], v[76:79], v[92:95], v[208:211]
  v_mfma_f32_16x16x32_bf16 v[212:215], v[72:75], v[96:99], v[212:215]
  v_mfma_f32_16x16x32_bf16 v[212:215], v[76:79], v[100:103], v[212:215]
  v_mfma_f32_16x16x32_bf16 v[216:219], v[72:75], v[104:107], v[216:219]
  s_setprio 2
  s_barrier
  v_mfma_f32_16x16x32_bf16 v[216:219], v[76:79], v[108:111], v[216:219]
  ds_read_b64_tr_b16 v[40:41], v1 offset:0
  s_add_u32 m0, s75, 81920
  s_nop 0
  buffer_load_dwordx4 v29, s[44:47], s74 offen offset:0 lds
  ds_read_b64_tr_b16 v[42:43], v1 offset:2560
  ds_read_b64_tr_b16 v[44:45], v1 offset:20480
  ds_read_b64_tr_b16 v[46:47], v1 offset:23040
  ds_read_b64_tr_b16 v[48:49], v2 offset:0
  buffer_load_dwordx4 v30, s[44:47], s74 offen offset:1024 lds
  ds_read_b64_tr_b16 v[50:51], v2 offset:2560
  ds_read_b64_tr_b16 v[52:53], v2 offset:20480
  ds_read_b64_tr_b16 v[54:55], v2 offset:23040
  ds_read_b64_tr_b16 v[56:57], v3 offset:0
  buffer_load_dwordx4 v31, s[44:47], s74 offen offset:2048 lds
  ds_read_b64_tr_b16 v[58:59], v3 offset:2560
  ds_read_b64_tr_b16 v[60:61], v3 offset:20480
  ds_read_b64_tr_b16 v[62:63], v3 offset:23040
  ds_read_b64_tr_b16 v[64:65], v4 offset:0
  buffer_load_dwordx4 v32, s[44:47], s74 offen offset:3072 lds
  ds_read_b64_tr_b16 v[66:67], v4 offset:2560
  ds_read_b64_tr_b16 v[68:69], v4 offset:20480
  ds_read_b64_tr_b16 v[70:71], v4 offset:23040
  ds_read_b128 v[80:83], v11 offset:8192
  s_add_u32 m0, m0, 4096
  s_nop 0
  buffer_load_dwordx4 v33, s[44:47], s74 offen offset:0 lds
  s_add_u32 s74, s74, 212992
  ds_read_b128 v[84:87], v12 offset:8192
  ds_read_b128 v[88:91], v11 offset:10240
  ds_read_b128 v[92:95], v12 offset:10240
  ds_read_b128 v[96:99], v11 offset:12288
  v_lshl_add_u32 v34, v240, 7, v15
  v_lshl_add_u32 v28, v24, 7, v14
  s_add_u32 m0, s76, 8192
  s_nop 0
  buffer_load_dwordx4 v28, s[32:35], 0 offen lds
  ds_read_b128 v[100:103], v12 offset:12288
  ds_read_b128 v[104:107], v11 offset:14336
  ds_read_b128 v[108:111], v12 offset:14336
  ds_read_b64_tr_b16 v[72:73], v5 offset:0
  s_add_u32 m0, m0, 1024
  s_nop 0
  buffer_load_dwordx4 v34, s[32:35], 0 offen lds
  ds_read_b64_tr_b16 v[74:75], v5 offset:2560
  ds_read_b64_tr_b16 v[76:77], v5 offset:20480
  ds_read_b64_tr_b16 v[78:79], v5 offset:23040
  s_waitcnt vmcnt(9) lgkmcnt(0)
  s_barrier
  s_setprio 0
  v_mfma_f32_16x16x32_bf16 v[140:143], v[40:43], v[80:83], v[140:143]
  v_mfma_f32_16x16x32_bf16 v[140:143], v[44:47], v[84:87], v[140:143]
  v_mfma_f32_16x16x32_bf16 v[144:147], v[40:43], v[88:91], v[144:147]
  v_mfma_f32_16x16x32_bf16 v[144:147], v[44:47], v[92:95], v[144:147]
  v_mfma_f32_16x16x32_bf16 v[148:151], v[40:43], v[96:99], v[148:151]
  v_mfma_f32_16x16x32_bf16 v[148:151], v[44:47], v[100:103], v[148:151]
  v_mfma_f32_16x16x32_bf16 v[152:155], v[40:43], v[104:107], v[152:155]
  v_mfma_f32_16x16x32_bf16 v[152:155], v[44:47], v[108:111], v[152:155]
  v_mfma_f32_16x16x32_bf16 v[168:171], v[48:51], v[104:107], v[168:171]
  v_mfma_f32_16x16x32_bf16 v[168:171], v[52:55], v[108:111], v[168:171]
  v_mfma_f32_16x16x32_bf16 v[164:167], v[48:51], v[96:99], v[164:167]
  v_mfma_f32_16x16x32_bf16 v[164:167], v[52:55], v[100:103], v[164:167]
  v_mfma_f32_16x16x32_bf16 v[160:163], v[48:51], v[88:91], v[160:163]
  v_mfma_f32_16x16x32_bf16 v[160:163], v[52:55], v[92:95], v[160:163]
  v_mfma_f32_16x16x32_bf16 v[156:159], v[48:51], v[80:83], v[156:159]
  v_mfma_f32_16x16x32_bf16 v[156:159], v[52:55], v[84:87], v[156:159]
  v_mfma_f32_16x16x32_bf16 v[172:175], v[56:59], v[80:83], v[172:175]
  v_mfma_f32_16x16x32_bf16 v[172:175], v[60:63], v[84:87], v[172:175]
  v_mfma_f32_16x16x32_bf16 v[176:179], v[56:59], v[88:91], v[176:179]
  v_mfma_f32_16x16x32_bf16 v[176:179], v[60:63], v[92:95], v[176:179]
  v_mfma_f32_16x16x32_bf16 v[180:183], v[56:59], v[96:99], v[180:183]
  v_mfma_f32_16x16x32_bf16 v[180:183], v[60:63], v[100:103], v[180:183]
  v_mfma_f32_16x16x32_bf16 v[184:187], v[56:59], v[104:107], v[184:187]
  v_mfma_f32_16x16x32_bf16 v[184:187], v[60:63], v[108:111], v[184:187]
  v_mfma_f32_16x16x32_bf16 v[200:203], v[64:67], v[104:107], v[200:203]
  v_mfma_f32_16x16x32_bf16 v[200:203], v[68:71], v[108:111], v[200:203]
  v_mfma_f32_16x16x32_bf16 v[196:199], v[64:67], v[96:99], v[196:199]
  v_mfma_f32_16x16x32_bf16 v[196:199], v[68:71], v[100:103], v[196:199]
  v_mfma_f32_16x16x32_bf16 v[192:195], v[64:67], v[88:91], v[192:195]
  v_mfma_f32_16x16x32_bf16 v[192:195], v[68:71], v[92:95], v[192:195]
  v_mfma_f32_16x16x32_bf16 v[188:191], v[64:67], v[80:83], v[188:191]
  v_mfma_f32_16x16x32_bf16 v[188:191], v[68:71], v[84:87], v[188:191]
  v_mfma_f32_16x16x32_bf16 v[204:207], v[72:75], v[80:83], v[204:207]
  v_mfma_f32_16x16x32_bf16 v[204:207], v[76:79], v[84:87], v[204:207]
  v_mfma_f32_16x16x32_bf16 v[208:211], v[72:75], v[88:91], v[208:211]
  v_mfma_f32_16x16x32_bf16 v[208:211], v[76:79], v[92:95], v[208:211]
  v_mfma_f32_16x16x32_bf16 v[212:215], v[72:75], v[96:99], v[212:215]
  v_mfma_f32_16x16x32_bf16 v[212:215], v[76:79], v[100:103], v[212:215]
  v_mfma_f32_16x16x32_bf16 v[216:219], v[72:75], v[104:107], v[216:219]
  s_setprio 2
  s_barrier
  v_mfma_f32_16x16x32_bf16 v[216:219], v[76:79], v[108:111], v[216:219]
  ds_read_b64_tr_b16 v[40:41], v1 offset:40960
  s_add_u32 m0, s75, 0
  s_nop 0
  buffer_load_dwordx4 v29, s[44:47], s74 offen offset:0 lds
  ds_read_b64_tr_b16 v[42:43], v1 offset:43520
  ds_read_b64_tr_b16 v[44:45], v6 offset:0
  ds_read_b64_tr_b16 v[46:47], v6 offset:2560
  ds_read_b64_tr_b16 v[48:49], v2 offset:40960
  buffer_load_dwordx4 v30, s[44:47], s74 offen offset:1024 lds
  ds_read_b64_tr_b16 v[50:51], v2 offset:43520
  ds_read_b64_tr_b16 v[52:53], v7 offset:0
  ds_read_b64_tr_b16 v[54:55], v7 offset:2560
  ds_read_b64_tr_b16 v[56:57], v3 offset:40960
  buffer_load_dwordx4 v31, s[44:47], s74 offen offset:2048 lds
  ds_read_b64_tr_b16 v[58:59], v3 offset:43520
  ds_read_b64_tr_b16 v[60:61], v8 offset:0
  ds_read_b64_tr_b16 v[62:63], v8 offset:2560
  ds_read_b64_tr_b16 v[64:65], v4 offset:40960
  buffer_load_dwordx4 v32, s[44:47], s74 offen offset:3072 lds
  ds_read_b64_tr_b16 v[66:67], v4 offset:43520
  ds_read_b64_tr_b16 v[68:69], v9 offset:0
  ds_read_b64_tr_b16 v[70:71], v9 offset:2560
  ds_read_b128 v[80:83], v11 offset:0
  s_add_u32 m0, m0, 4096
  s_nop 0
  buffer_load_dwordx4 v33, s[44:47], s74 offen offset:0 lds
  s_add_u32 s74, s74, 212992
  ds_read_b128 v[84:87], v12 offset:0
  ds_read_b128 v[88:91], v11 offset:2048
  ds_read_b128 v[92:95], v12 offset:2048
  ds_read_b128 v[96:99], v11 offset:4096
  v_lshl_add_u32 v34, v241, 7, v15
  v_lshl_add_u32 v28, v25, 7, v14
  s_add_u32 m0, s76, 0
  s_nop 0
  buffer_load_dwordx4 v28, s[32:35], 0 offen lds
  ds_read_b128 v[100:103], v12 offset:4096
  ds_read_b128 v[104:107], v11 offset:6144
  ds_read_b128 v[108:111], v12 offset:6144
  ds_read_b64_tr_b16 v[72:73], v5 offset:40960
  s_add_u32 m0, m0, 1024
  s_nop 0
  buffer_load_dwordx4 v34, s[32:35], 0 offen lds
  ds_read_b64_tr_b16 v[74:75], v5 offset:43520
  ds_read_b64_tr_b16 v[76:77], v10 offset:0
  ds_read_b64_tr_b16 v[78:79], v10 offset:2560
  s_mov_b32 m0, 156288
  s_mov_b32 exec_hi, 0xff
  buffer_load_dwordx4 v37, s[52:55], s77 offen lds
  s_mov_b64 exec, -1
  s_waitcnt vmcnt(8) lgkmcnt(0)
  s_barrier
  s_setprio 0
  v_mfma_f32_16x16x32_bf16 v[140:143], v[40:43], v[80:83], v[140:143]
  v_mfma_f32_16x16x32_bf16 v[140:143], v[44:47], v[84:87], v[140:143]
  v_mfma_f32_16x16x32_bf16 v[144:147], v[40:43], v[88:91], v[144:147]
  v_mfma_f32_16x16x32_bf16 v[144:147], v[44:47], v[92:95], v[144:147]
  v_mfma_f32_16x16x32_bf16 v[148:151], v[40:43], v[96:99], v[148:151]
  v_mfma_f32_16x16x32_bf16 v[148:151], v[44:47], v[100:103], v[148:151]
  v_mfma_f32_16x16x32_bf16 v[152:155], v[40:43], v[104:107], v[152:155]
  v_mfma_f32_16x16x32_bf16 v[152:155], v[44:47], v[108:111], v[152:155]
  v_mfma_f32_16x16x32_bf16 v[168:171], v[48:51], v[104:107], v[168:171]
  v_mfma_f32_16x16x32_bf16 v[168:171], v[52:55], v[108:111], v[168:171]
  v_mfma_f32_16x16x32_bf16 v[164:167], v[48:51], v[96:99], v[164:167]
  v_mfma_f32_16x16x32_bf16 v[164:167], v[52:55], v[100:103], v[164:167]
  v_mfma_f32_16x16x32_bf16 v[160:163], v[48:51], v[88:91], v[160:163]
  v_mfma_f32_16x16x32_bf16 v[160:163], v[52:55], v[92:95], v[160:163]
  v_mfma_f32_16x16x32_bf16 v[156:159], v[48:51], v[80:83], v[156:159]
  v_mfma_f32_16x16x32_bf16 v[156:159], v[52:55], v[84:87], v[156:159]
  v_mfma_f32_16x16x32_bf16 v[172:175], v[56:59], v[80:83], v[172:175]
  v_mfma_f32_16x16x32_bf16 v[172:175], v[60:63], v[84:87], v[172:175]
  v_mfma_f32_16x16x32_bf16 v[176:179], v[56:59], v[88:91], v[176:179]
  v_mfma_f32_16x16x32_bf16 v[176:179], v[60:63], v[92:95], v[176:179]
  v_mfma_f32_16x16x32_bf16 v[180:183], v[56:59], v[96:99], v[180:183]
  v_mfma_f32_16x16x32_bf16 v[180:183], v[60:63], v[100:103], v[180:183]
  v_mfma_f32_16x16x32_bf16 v[184:187], v[56:59], v[104:107], v[184:187]
  v_mfma_f32_16x16x32_bf16 v[184:187], v[60:63], v[108:111], v[184:187]
  v_mfma_f32_16x16x32_bf16 v[200:203], v[64:67], v[104:107], v[200:203]
  v_mfma_f32_16x16x32_bf16 v[200:203], v[68:71], v[108:111], v[200:203]
  v_mfma_f32_16x16x32_bf16 v[196:199], v[64:67], v[96:99], v[196:199]
  v_mfma_f32_16x16x32_bf16 v[196:199], v[68:71], v[100:103], v[196:199]
  v_mfma_f32_16x16x32_bf16 v[192:195], v[64:67], v[88:91], v[192:195]
  v_mfma_f32_16x16x32_bf16 v[192:195], v[68:71], v[92:95], v[192:195]
  v_mfma_f32_16x16x32_bf16 v[188:191], v[64:67], v[80:83], v[188:191]
  v_mfma_f32_16x16x32_bf16 v[188:191], v[68:71], v[84:87], v[188:191]
  v_mfma_f32_16x16x32_bf16 v[204:207], v[72:75], v[80:83], v[204:207]
  v_mfma_f32_16x16x32_bf16 v[204:207], v[76:79], v[84:87], v[204:207]
  v_mfma_f32_16x16x32_bf16 v[208:211], v[72:75], v[88:91], v[208:211]
  v_mfma_f32_16x16x32_bf16 v[208:211], v[76:79], v[92:95], v[208:211]
  v_mfma_f32_16x16x32_bf16 v[212:215], v[72:75], v[96:99], v[212:215]
  v_mfma_f32_16x16x32_bf16 v[212:215], v[76:79], v[100:103], v[212:215]
  v_mfma_f32_16x16x32_bf16 v[216:219], v[72:75], v[104:107], v[216:219]
  s_setprio 2
  s_barrier
  v_mfma_f32_16x16x32_bf16 v[216:219], v[76:79], v[108:111], v[216:219]
  ds_read_b64_tr_b16 v[40:41], v6 offset:20480
  s_add_u32 m0, s75, 40960
  s_nop 0
  buffer_load_dwordx4 v29, s[44:47], s74 offen offset:0 lds
  ds_read_b64_tr_b16 v[42:43], v6 offset:23040
  ds_read_b64_tr_b16 v[44:45], v6 offset:40960
  ds_read_b64_tr_b16 v[46:47], v6 offset:43520
  ds_read_b64_tr_b16 v[48:49], v7 offset:20480
  buffer_load_dwordx4 v30, s[44:47], s74 offen offset:1024 lds
  ds_read_b64_tr_b16 v[50:51], v7 offset:23040
  ds_read_b64_tr_b16 v[52:53], v7 offset:40960
  ds_read_b64_tr_b16 v[54:55], v7 offset:43520
  ds_read_b64_tr_b16 v[56:57], v8 offset:20480
  buffer_load_dwordx4 v31, s[44:47], s74 offen offset:2048 lds
  ds_read_b64_tr_b16 v[58:59], v8 offset:23040
  ds_read_b64_tr_b16 v[60:61], v8 offset:40960
  ds_read_b64_tr_b16 v[62:63], v8 offset:43520
  ds_read_b64_tr_b16 v[64:65], v9 offset:20480
  buffer_load_dwordx4 v32, s[44:47], s74 offen offset:3072 lds
  ds_read_b64_tr_b16 v[66:67], v9 offset:23040
  ds_read_b64_tr_b16 v[68:69], v9 offset:40960
  ds_read_b64_tr_b16 v[70:71], v9 offset:43520
  ds_read_b128 v[80:83], v11 offset:8192
  s_add_u32 m0, m0, 4096
  s_nop 0
  buffer_load_dwordx4 v33, s[44:47], s74 offen offset:0 lds
  s_add_u32 s74, s74, 212992
  ds_read_b128 v[84:87], v12 offset:8192
  ds_read_b128 v[88:91], v11 offset:10240
  ds_read_b128 v[92:95], v12 offset:10240
  ds_read_b128 v[96:99], v11 offset:12288
  v_lshl_add_u32 v34, v242, 7, v15
  v_lshl_add_u32 v28, v26, 7, v14
  s_add_u32 m0, s76, 8192
  s_nop 0
  buffer_load_dwordx4 v28, s[32:35], 0 offen lds
  ds_read_b128 v[100:103], v12 offset:12288
  ds_read_b128 v[104:107], v11 offset:14336
  ds_read_b128 v[108:111], v12 offset:14336
  ds_read_b64_tr_b16 v[72:73], v10 offset:20480
  s_add_u32 m0, m0, 1024
  s_nop 0
  buffer_load_dwordx4 v34, s[32:35], 0 offen lds
  ds_read_b64_tr_b16 v[74:75], v10 offset:23040
  ds_read_b64_tr_b16 v[76:77], v10 offset:40960
  ds_read_b64_tr_b16 v[78:79], v10 offset:43520
  buffer_load_dwordx3 v[24:26], v13, s[28:31], s73 offen offset:0
  buffer_load_dwordx3 v[240:242], v13, s[28:31], s73 offen offset:832
  s_add_u32 s73, s73, 12
  s_waitcnt vmcnt(10) lgkmcnt(0)
  s_barrier
  s_setprio 0
  v_mfma_f32_16x16x32_bf16 v[140:143], v[40:43], v[80:83], v[140:143]
  s_add_u32 s72, s72, 1
  v_mfma_f32_16x16x32_bf16 v[140:143], v[44:47], v[84:87], v[140:143]
  v_mfma_f32_16x16x32_bf16 v[144:147], v[40:43], v[88:91], v[144:147]
  v_mfma_f32_16x16x32_bf16 v[144:147], v[44:47], v[92:95], v[144:147]
  v_mfma_f32_16x16x32_bf16 v[148:151], v[40:43], v[96:99], v[148:151]
  v_mfma_f32_16x16x32_bf16 v[148:151], v[44:47], v[100:103], v[148:151]
  v_mfma_f32_16x16x32_bf16 v[152:155], v[40:43], v[104:107], v[152:155]
  v_mfma_f32_16x16x32_bf16 v[152:155], v[44:47], v[108:111], v[152:155]
  v_mfma_f32_16x16x32_bf16 v[168:171], v[48:51], v[104:107], v[168:171]
  v_mfma_f32_16x16x32_bf16 v[168:171], v[52:55], v[108:111], v[168:171]
  v_mfma_f32_16x16x32_bf16 v[164:167], v[48:51], v[96:99], v[164:167]
  v_mfma_f32_16x16x32_bf16 v[164:167], v[52:55], v[100:103], v[164:167]
  v_mfma_f32_16x16x32_bf16 v[160:163], v[48:51], v[88:91], v[160:163]
  v_mfma_f32_16x16x32_bf16 v[160:163], v[52:55], v[92:95], v[160:163]
  v_mfma_f32_16x16x32_bf16 v[156:159], v[48:51], v[80:83], v[156:159]
  v_mfma_f32_16x16x32_bf16 v[156:159], v[52:55], v[84:87], v[156:159]
  v_mfma_f32_16x16x32_bf16 v[172:175], v[56:59], v[80:83], v[172:175]
  v_mfma_f32_16x16x32_bf16 v[172:175], v[60:63], v[84:87], v[172:175]
  v_mfma_f32_16x16x32_bf16 v[176:179], v[56:59], v[88:91], v[176:179]
  v_mfma_f32_16x16x32_bf16 v[176:179], v[60:63], v[92:95], v[176:179]
  s_cmp_lt_u32 s72, 4
  v_mfma_f32_16x16x32_bf16 v[180:183], v[56:59], v[96:99], v[180:183]
  v_mfma_f32_16x16x32_bf16 v[180:183], v[60:63], v[100:103], v[180:183]
  v_mfma_f32_16x16x32_bf16 v[184:187], v[56:59], v[104:107], v[184:187]
  v_mfma_f32_16x16x32_bf16 v[184:187], v[60:63], v[108:111], v[184:187]
  v_mfma_f32_16x16x32_bf16 v[200:203], v[64:67], v[104:107], v[200:203]
  v_mfma_f32_16x16x32_bf16 v[200:203], v[68:71], v[108:111], v[200:203]
  v_mfma_f32_16x16x32_bf16 v[196:199], v[64:67], v[96:99], v[196:199]
  v_mfma_f32_16x16x32_bf16 v[196:199], v[68:71], v[100:103], v[196:199]
  v_mfma_f32_16x16x32_bf16 v[192:195], v[64:67], v[88:91], v[192:195]
  v_mfma_f32_16x16x32_bf16 v[192:195], v[68:71], v[92:95], v[192:195]
  v_mfma_f32_16x16x32_bf16 v[188:191], v[64:67], v[80:83], v[188:191]
  v_mfma_f32_16x16x32_bf16 v[188:191], v[68:71], v[84:87], v[188:191]
  v_mfma_f32_16x16x32_bf16 v[204:207], v[72:75], v[80:83], v[204:207]
  v_mfma_f32_16x16x32_bf16 v[204:207], v[76:79], v[84:87], v[204:207]
  v_mfma_f32_16x16x32_bf16 v[208:211], v[72:75], v[88:91], v[208:211]
  v_mfma_f32_16x16x32_bf16 v[208:211], v[76:79], v[92:95], v[208:211]
  v_mfma_f32_16x16x32_bf16 v[212:215], v[72:75], v[96:99], v[212:215]
  v_mfma_f32_16x16x32_bf16 v[212:215], v[76:79], v[100:103], v[212:215]
  v_mfma_f32_16x16x32_bf16 v[216:219], v[72:75], v[104:107], v[216:219]
  s_setprio 2
  s_barrier
  v_mfma_f32_16x16x32_bf16 v[216:219], v[76:79], v[108:111], v[216:219]
  s_cbranch_scc1 L_dnn_loop1
  ds_read_b64_tr_b16 v[40:41], v1 offset:0
  ds_read_b64_tr_b16 v[42:43], v1 offset:2560
  ds_read_b64_tr_b16 v[44:45], v1 offset:20480
  ds_read_b64_tr_b16 v[46:47], v1 offset:23040
  ds_read_b64_tr_b16 v[48:49], v2 offset:0
  ds_read_b64_tr_b16 v[50:51], v2 offset:2560
  ds_read_b64_tr_b16 v[52:53], v2 offset:20480
  ds_read_b64_tr_b16 v[54:55], v2 offset:23040
  ds_read_b64_tr_b16 v[56:57], v3 offset:0
  ds_read_b64_tr_b16 v[58:59], v3 offset:2560
  ds_read_b64_tr_b16 v[60:61], v3 offset:20480
  ds_read_b64_tr_b16 v[62:63], v3 offset:23040
  ds_read_b64_tr_b16 v[64:65], v4 offset:0
  ds_read_b64_tr_b16 v[66:67], v4 offset:2560
  ds_read_b64_tr_b16 v[68:69], v4 offset:20480
  ds_read_b64_tr_b16 v[70:71], v4 offset:23040
  ds_read_b128 v[80:83], v11 offset:0
  ds_read_b128 v[84:87], v12 offset:0
  ds_read_b128 v[88:91], v11 offset:2048
  ds_read_b128 v[92:95], v12 offset:2048
  ds_read_b128 v[96:99], v11 offset:4096
  ds_read_b128 v[100:103], v12 offset:4096
  ds_read_b128 v[104:107], v11 offset:6144
  ds_read_b128 v[108:111], v12 offset:6144
  ds_read_b64_tr_b16 v[72:73], v5 offset:0
  ds_read_b64_tr_b16 v[74:75], v5 offset:2560
  ds_read_b64_tr_b16 v[76:77], v5 offset:20480
  ds_read_b64_tr_b16 v[78:79], v5 offset:23040
  ds_read_b64 v[220:221], v35 offset:640
  ds_read_b64 v[222:223], v35 offset:672
  ds_read_b64 v[224:225], v35 offset:704
  ds_read_b64 v[226:227], v35 offset:736
  ds_read_b64 v[228:229], v35 offset:768
  s_waitcnt vmcnt(2) lgkmcnt(0)
  s_barrier
  s_setprio 0
  v_mfma_f32_16x16x32_bf16 v[140:143], v[40:43], v[80:83], v[140:143]
  v_mov_b32 v232, 0xc0135761
  v_mov_b32 v233, 0xc0135761
  v_mfma_f32_16x16x32_bf16 v[140:143], v[44:47], v[84:87], v[140:143]
  v_mov_b32 v234, 0xbdd2d3e8
  v_mov_b32 v235, 0xbdd2d3e8
  v_mfma_f32_16x16x32_bf16 v[144:147], v[40:43], v[88:91], v[144:147]
  v_mov_b32 v236, 0xc2b40000
  v_mov_b32 v237, 0xc2b40000
  v_mfma_f32_16x16x32_bf16 v[144:147], v[44:47], v[92:95], v[144:147]
  v_lshlrev_b32 v112, 16, v220
  v_and_b32 v113, 0xffff0000, v220
  v_mfma_f32_16x16x32_bf16 v[148:151], v[40:43], v[96:99], v[148:151]
  v_lshlrev_b32 v114, 16, v221
  v_and_b32 v115, 0xffff0000, v221
  v_mfma_f32_16x16x32_bf16 v[148:151], v[44:47], v[100:103], v[148:151]
  v_lshlrev_b32 v116, 16, v222
  v_and_b32 v117, 0xffff0000, v222
  v_mfma_f32_16x16x32_bf16 v[152:155], v[40:43], v[104:107], v[152:155]
  v_lshlrev_b32 v118, 16, v223
  v_and_b32 v119, 0xffff0000, v223
  v_mfma_f32_16x16x32_bf16 v[152:155], v[44:47], v[108:111], v[152:155]
  v_lshlrev_b32 v120, 16, v224
  v_and_b32 v121, 0xffff0000, v224
  v_mfma_f32_16x16x32_bf16 v[168:171], v[48:51], v[104:107], v[168:171]
  v_lshlrev_b32 v122, 16, v225
  v_and_b32 v123, 0xffff0000, v225
  v_mfma_f32_16x16x32_bf16 v[168:171], v[52:55], v[108:111], v[168:171]
  v_lshlrev_b32 v124, 16, v226
  v_mfma_f32_16x16x32_bf16 v[164:167], v[48:51], v[96:99], v[164:167]
  v_and_b32 v125, 0xffff0000, v226
  v_lshlrev_b32 v126, 16, v227
  v_mfma_f32_16x16x32_bf16 v[164:167], v[52:55], v[100:103], v[164:167]
  v_and_b32 v127, 0xffff0000, v227
  v_lshlrev_b32 v128, 16, v228
  v_mfma_f32_16x16x32_bf16 v[160:163], v[48:51], v[88:91], v[160:163]
  v_and_b32 v129, 0xffff0000, v228
  v_lshlrev_b32 v130, 16, v229
  v_mfma_f32_16x16x32_bf16 v[160:163], v[52:55], v[92:95], v[160:163]
  v_and_b32 v131, 0xffff0000, v229
  v_mov_b32 v239, 0x21800000
  v_mfma_f32_16x16x32_bf16 v[156:159], v[48:51], v[80:83], v[156:159]
  v_mov_b32 v238, 0x30800000
  v_max3_f32 v239, v239, abs(v112), abs(v113)
  v_mfma_f32_16x16x32_bf16 v[156:159], v[52:55], v[84:87], v[156:159]
  v_max3_f32 v239, v239, abs(v114), abs(v115)
  v_max3_f32 v239, v239, abs(v116), abs(v117)
  v_mfma_f32_16x16x32_bf16 v[172:175], v[56:59], v[80:83], v[172:175]
  v_max3_f32 v239, v239, abs(v118), abs(v119)
  v_max3_f32 v239, v239, abs(v120), abs(v121)
  v_mfma_f32_16x16x32_bf16 v[172:175], v[60:63], v[84:87], v[172:175]
  v_max3_f32 v239, v239, abs(v122), abs(v123)
  v_max3_f32 v239, v239, abs(v124), abs(v125)
  v_mfma_f32_16x16x32_bf16 v[176:179], v[56:59], v[88:91], v[176:179]
  v_max3_f32 v239, v239, abs(v126), abs(v127)
  v_mfma_f32_16x16x32_bf16 v[176:179], v[60:63], v[92:95], v[176:179]
  v_max3_f32 v239, v239, abs(v128), abs(v129)
  v_max3_f32 v239, v239, abs(v130), abs(v131)
  v_mfma_f32_16x16x32_bf16 v[180:183], v[56:59], v[96:99], v[180:183]
  v_and_b32 v239, 0x7f800000, v239
  v_mul_f32 v239, 0x22000000, v239
  v_mfma_f32_16x16x32_bf16 v[180:183], v[60:63], v[100:103], v[180:183]
  v_rcp_f32 v112, v112
  v_mfma_f32_16x16x32_bf16 v[184:187], v[56:59], v[104:107], v[184:187]
  v_rcp_f32 v113, v113
  v_mfma_f32_16x16x32_bf16 v[184:187], v[60:63], v[108:111], v[184:187]
  v_rcp_f32 v114, v114
  v_mfma_f32_16x16x32_bf16 v[200:203], v[64:67], v[104:107], v[200:203]
  v_rcp_f32 v115, v115
  v_mfma_f32_16x16x32_bf16 v[200:203], v[68:71], v[108:111], v[200:203]
  v_rcp_f32 v116, v116
  v_mfma_f32_16x16x32_bf16 v[196:199], v[64:67], v[96:99], v[196:199]
  v_rcp_f32 v117, v117
  v_mfma_f32_16x16x32_bf16 v[196:199], v[68:71], v[100:103], v[196:199]
  v_rcp_f32 v118, v118
  v_mfma_f32_16x16x32_bf16 v[192:195], v[64:67], v[88:91], v[192:195]
  v_rcp_f32 v119, v119
  v_mfma_f32_16x16x32_bf16 v[192:195], v[68:71], v[92:95], v[192:195]
  v_rcp_f32 v120, v120
  v_mfma_f32_16x16x32_bf16 v[188:191], v[64:67], v[80:83], v[188:191]
  v_rcp_f32 v121, v121
  v_mfma_f32_16x16x32_bf16 v[188:191], v[68:71], v[84:87], v[188:191]
  v_rcp_f32 v122, v122
  v_mfma_f32_16x16x32_bf16 v[204:207], v[72:75], v[80:83], v[204:207]
  v_rcp_f32 v123, v123
  v_mfma_f32_16x16x32_bf16 v[204:207], v[76:79], v[84:87], v[204:207]
  v_rcp_f32 v124, v124
  v_mfma_f32_16x16x32_bf16 v[208:211], v[72:75], v[88:91], v[208:211]
  v_rcp_f32 v125, v125
  v_mfma_f32_16x16x32_bf16 v[208:211], v[76:79], v[92:95], v[208:211]
  v_rcp_f32 v126, v126
  v_mfma_f32_16x16x32_bf16 v[212:215], v[72:75], v[96:99], v[212:215]
  v_rcp_f32 v127, v127
  v_mfma_f32_16x16x32_bf16 v[212:215], v[76:79], v[100:103], v[212:215]
  v_mfma_f32_16x16x32_bf16 v[216:219], v[72:75], v[104:107], v[216:219]
  s_setprio 2
  s_barrier
  v_mfma_f32_16x16x32_bf16 v[216:219], v[76:79], v[108:111], v[216:219]
  ds_read_b64_tr_b16 v[40:41], v1 offset:40960
  ds_read_b64_tr_b16 v[42:43], v1 offset:43520
  ds_read_b64_tr_b16 v[44:45], v6 offset:0
  ds_read_b64_tr_b16 v[46:47], v6 offset:2560
  ds_read_b64_tr_b16 v[48:49], v2 offset:40960
  ds_read_b64_tr_b16 v[50:51], v2 offset:43520
  ds_read_b64_tr_b16 v[52:53], v7 offset:0
  ds_read_b64_tr_b16 v[54:55], v7 offset:2560
  ds_read_b64_tr_b16 v[56:57], v3 offset:40960
  ds_read_b64_tr_b16 v[58:59], v3 offset:43520
  ds_read_b64_tr_b16 v[60:61], v8 offset:0
  ds_read_b64_tr_b16 v[62:63], v8 offset:2560
  ds_read_b64_tr_b16 v[64:65], v4 offset:40960
  ds_read_b64_tr_b16 v[66:67], v4 offset:43520
  ds_read_b64_tr_b16 v[68:69], v9 offset:0
  ds_read_b64_tr_b16 v[70:71], v9 offset:2560
  ds_read_b128 v[80:83], v11 offset:8192
  ds_read_b128 v[84:87], v12 offset:8192
  ds_read_b128 v[88:91], v11 offset:10240
  ds_read_b128 v[92:95], v12 offset:10240
  ds_read_b128 v[96:99], v11 offset:12288
  ds_read_b128 v[100:103], v12 offset:12288
  ds_read_b128 v[104:107], v11 offset:14336
  ds_read_b128 v[108:111], v12 offset:14336
  ds_read_b64_tr_b16 v[72:73], v5 offset:40960
  ds_read_b64_tr_b16 v[74:75], v5 offset:43520
  ds_read_b64_tr_b16 v[76:77], v10 offset:0
  ds_read_b64_tr_b16 v[78:79], v10 offset:2560
  s_waitcnt lgkmcnt(0)
  s_barrier
  v_mfma_f32_16x16x32_bf16 v[140:143], v[40:43], v[80:83], v[140:143]
  v_rcp_f32 v128, v128
  v_mfma_f32_16x16x32_bf16 v[140:143], v[44:47], v[84:87], v[140:143]
  v_rcp_f32 v129, v129
  v_mfma_f32_16x16x32_bf16 v[144:147], v[40:43], v[88:91], v[144:147]
  v_rcp_f32 v130, v130
  v_mfma_f32_16x16x32_bf16 v[144:147], v[44:47], v[92:95], v[144:147]
  v_rcp_f32 v131, v131
  v_mfma_f32_16x16x32_bf16 v[148:151], v[40:43], v[96:99], v[148:151]
  v_mul_f32 v112, v239, v112
  v_mfma_f32_16x16x32_bf16 v[148:151], v[44:47], v[100:103], v[148:151]
  v_mul_f32 v113, v239, v113
  v_mul_f32 v114, v239, v114
  v_mfma_f32_16x16x32_bf16 v[152:155], v[40:43], v[104:107], v[152:155]
  v_mul_f32 v115, v239, v115
  v_mul_f32 v116, v239, v116
  v_mfma_f32_16x16x32_bf16 v[152:155], v[44:47], v[108:111], v[152:155]
  v_mul_f32 v117, v239, v117
  v_mul_f32 v118, v239, v118
  v_mfma_f32_16x16x32_bf16 v[168:171], v[48:51], v[104:107], v[168:171]
  v_mul_f32 v119, v239, v119
  v_mul_f32 v120, v239, v120
  v_mfma_f32_16x16x32_bf16 v[168:171], v[52:55], v[108:111], v[168:171]
  v_mul_f32 v121, v239, v121
  v_mfma_f32_16x16x32_bf16 v[164:167], v[48:51], v[96:99], v[164:167]
  v_mul_f32 v122, v239, v122
  v_mul_f32 v123, v239, v123
  v_mfma_f32_16x16x32_bf16 v[164:167], v[52:55], v[100:103], v[164:167]
  v_mul_f32 v124, v239, v124
  v_mul_f32 v125, v239, v125
  v_mfma_f32_16x16x32_bf16 v[160:163], v[48:51], v[88:91], v[160:163]
  v_mul_f32 v126, v239, v126
  v_mul_f32 v127, v239, v127
  v_mfma_f32_16x16x32_bf16 v[160:163], v[52:55], v[92:95], v[160:163]
  v_mul_f32 v128, v239, v128
  v_mul_f32 v129, v239, v129
  v_mfma_f32_16x16x32_bf16 v[156:159], v[48:51], v[80:83], v[156:159]
  v_mul_f32 v130, v239, v130
  v_mfma_f32_16x16x32_bf16 v[156:159], v[52:55], v[84:87], v[156:159]
  v_mul_f32 v131, v239, v131
  v_med3_f32 v112, v112, -v238, v238
  v_mfma_f32_16x16x32_bf16 v[172:175], v[56:59], v[80:83], v[172:175]
  v_med3_f32 v113, v113, -v238, v238
  v_med3_f32 v114, v114, -v238, v238
  v_mfma_f32_16x16x32_bf16 v[172:175], v[60:63], v[84:87], v[172:175]
  v_med3_f32 v115, v115, -v238, v238
  v_med3_f32 v116, v116, -v238, v238
  v_mfma_f32_16x16x32_bf16 v[176:179], v[56:59], v[88:91], v[176:179]
  v_med3_f32 v117, v117, -v238, v238
  v_mfma_f32_16x16x32_bf16 v[176:179], v[60:63], v[92:95], v[176:179]
  v_med3_f32 v118, v118, -v238, v238
  v_med3_f32 v119, v119, -v238, v238
  v_mfma_f32_16x16x32_bf16 v[180:183], v[56:59], v[96:99], v[180:183]
  v_med3_f32 v120, v120, -v238, v238
  v_med3_f32 v121, v121, -v238, v238
  v_mfma_f32_16x16x32_bf16 v[180:183], v[60:63], v[100:103], v[180:183]
  v_med3_f32 v122, v122, -v238, v238
  v_med3_f32 v123, v123, -v238, v238
  v_mfma_f32_16x16x32_bf16 v[184:187], v[56:59], v[104:107], v[184:187]
  v_med3_f32 v124, v124, -v238, v238
  v_med3_f32 v125, v125, -v238, v238
  v_mfma_f32_16x16x32_bf16 v[184:187], v[60:63], v[108:111], v[184:187]
  v_med3_f32 v126, v126, -v238, v238
  v_mfma_f32_16x16x32_bf16 v[200:203], v[64:67], v[104:107], v[200:203]
  v_med3_f32 v127, v127, -v238, v238
  v_med3_f32 v128, v128, -v238, v238
  v_mfma_f32_16x16x32_bf16 v[200:203], v[68:71], v[108:111], v[200:203]
  v_med3_f32 v129, v129, -v238, v238
  v_med3_f32 v130, v130, -v238, v238
  v_mfma_f32_16x16x32_bf16 v[196:199], v[64:67], v[96:99], v[196:199]
  v_med3_f32 v131, v131, -v238, v238
  v_mul_f32 v132, 0x6c800000, v112
  v_mfma_f32_16x16x32_bf16 v[196:199], v[68:71], v[100:103], v[196:199]
  v_mul_f32 v133, 0x6c800000, v113
  v_mul_f32 v134, 0x6c800000, v114
  v_mfma_f32_16x16x32_bf16 v[192:195], v[64:67], v[88:91], v[192:195]
  v_mul_f32 v135, 0x6c800000, v115
  v_mfma_f32_16x16x32_bf16 v[192:195], v[68:71], v[92:95], v[192:195]
  v_mul_f32 v136, 0x6c800000, v116
  v_mul_f32 v137, 0x6c800000, v117
  v_mfma_f32_16x16x32_bf16 v[188:191], v[64:67], v[80:83], v[188:191]
  v_mul_f32 v138, 0x6c800000, v118
  v_mul_f32 v139, 0x6c800000, v119
  v_mfma_f32_16x16x32_bf16 v[188:191], v[68:71], v[84:87], v[188:191]
  v_mul_f32 v220, 0x6c800000, v120
  v_mul_f32 v221, 0x6c800000, v121
  v_mfma_f32_16x16x32_bf16 v[204:207], v[72:75], v[80:83], v[204:207]
  v_mul_f32 v222, 0x6c800000, v122
  v_mul_f32 v223, 0x6c800000, v123
  v_mfma_f32_16x16x32_bf16 v[204:207], v[76:79], v[84:87], v[204:207]
  v_mul_f32 v224, 0x6c800000, v124
  v_mfma_f32_16x16x32_bf16 v[208:211], v[72:75], v[88:91], v[208:211]
  v_mul_f32 v225, 0x6c800000, v125
  v_mul_f32 v226, 0x6c800000, v126
  v_mfma_f32_16x16x32_bf16 v[208:211], v[76:79], v[92:95], v[208:211]
  v_mul_f32 v227, 0x6c800000, v127
  v_mul_f32 v228, 0x6c800000, v128
  v_mfma_f32_16x16x32_bf16 v[212:215], v[72:75], v[96:99], v[212:215]
  v_mul_f32 v229, 0x6c800000, v129
  v_mul_f32 v230, 0x6c800000, v130
  v_mfma_f32_16x16x32_bf16 v[212:215], v[76:79], v[100:103], v[212:215]
  v_mul_f32 v231, 0x6c800000, v131
  v_mfma_f32_16x16x32_bf16 v[216:219], v[72:75], v[104:107], v[216:219]
  v_mfma_f32_16x16x32_bf16 v[216:219], v[76:79], v[108:111], v[216:219]
  s_setprio 0
  s_nop 0
L_epi:
  s_lshl_b32 s69, s27, 11
  s_and_b32 s71, s26, 3
  s_lshl_b32 s71, s71, 9
  s_add_u32 s69, s69, s71
  s_lshr_b32 s68, s26, 2
  s_lshl_b32 s68, s68, 14
  s_add_u32 s69, s69, s68
  v_lshlrev_b32 v3, 3, v0
  v_add_u32 v2, 156928, v3
  v_pk_mul_f32 v[40:41], v[140:141], v[140:141]
  v_pk_mul_f32 v[42:43], v[142:143], v[142:143]
  v_pk_mul_f32 v[46:47], v[144:145], v[144:145]
  v_pk_mul_f32 v[48:49], v[146:147], v[146:147]
  v_pk_mul_f32 v[52:53], v[148:149], v[148:149]
  v_pk_mul_f32 v[54:55], v[150:151], v[150:151]
  v_pk_mul_f32 v[58:59], v[152:153], v[152:153]
  v_pk_mul_f32 v[60:61], v[154:155], v[154:155]
  v_pk_fma_f32 v[40:41], v[40:41], v[234:235], v[232:233]
  v_pk_fma_f32 v[42:43], v[42:43], v[234:235], v[232:233]
  v_pk_fma_f32 v[46:47], v[46:47], v[234:235], v[232:233]
  v_pk_fma_f32 v[48:49], v[48:49], v[234:235], v[232:233]
  v_pk_fma_f32 v[52:53], v[52:53], v[234:235], v[232:233]
  v_pk_fma_f32 v[54:55], v[54:55], v[234:235], v[232:233]
  v_pk_fma_f32 v[58:59], v[58:59], v[234:235], v[232:233]
  v_pk_fma_f32 v[60:61], v[60:61], v[234:235], v[232:233]
  v_pk_fma_f32 v[40:41], v[40:41], v[140:141], v[236:237]
  v_pk_fma_f32 v[42:43], v[42:43], v[142:143], v[236:237]
  v_pk_fma_f32 v[46:47], v[46:47], v[144:145], v[236:237]
  v_pk_fma_f32 v[48:49], v[48:49], v[146:147], v[236:237]
  v_pk_fma_f32 v[52:53], v[52:53], v[148:149], v[236:237]
  v_pk_fma_f32 v[54:55], v[54:55], v[150:151], v[236:237]
  v_pk_fma_f32 v[58:59], v[58:59], v[152:153], v[236:237]
  v_pk_fma_f32 v[60:61], v[60:61], v[154:155], v[236:237]
  v_exp_f32 v40, v40 clamp
  v_exp_f32 v41, v41 clamp
  v_exp_f32 v42, v42 clamp
  v_exp_f32 v43, v43 clamp
  v_exp_f32 v46, v46 clamp
  v_exp_f32 v47, v47 clamp
  v_exp_f32 v48, v48 clamp
  v_exp_f32 v49, v49 clamp
  v_exp_f32 v52, v52 clamp
  v_exp_f32 v53, v53 clamp
  v_exp_f32 v54, v54 clamp
  v_exp_f32 v55, v55 clamp
  v_exp_f32 v58, v58 clamp
  v_exp_f32 v59, v59 clamp
  v_exp_f32 v60, v60 clamp
  v_exp_f32 v61, v61 clamp
  v_pk_fma_f32 v[40:41], v[40:41], v[132:133], v[112:113]
  v_pk_fma_f32 v[42:43], v[42:43], v[134:135], v[114:115]
  v_pk_fma_f32 v[46:47], v[46:47], v[132:133], v[112:113]
  v_pk_fma_f32 v[48:49], v[48:49], v[134:135], v[114:115]
  v_pk_fma_f32 v[52:53], v[52:53], v[132:133], v[112:113]
  v_pk_fma_f32 v[54:55], v[54:55], v[134:135], v[114:115]
  v_pk_fma_f32 v[58:59], v[58:59], v[132:133], v[112:113]
  v_pk_fma_f32 v[60:61], v[60:61], v[134:135], v[114:115]
  v_pk_mul_f32 v[44:45], v[140:141], v[42:43]
  v_pk_mul_f32 v[50:51], v[144:145], v[48:49]
  v_pk_mul_f32 v[56:57], v[148:149], v[54:55]
  v_pk_mul_f32 v[62:63], v[152:153], v[60:61]
  v_pk_fma_f32 v[44:45], v[142:143], v[40:41], v[44:45]
  v_pk_fma_f32 v[50:51], v[146:147], v[46:47], v[50:51]
  v_pk_fma_f32 v[56:57], v[150:151], v[52:53], v[56:57]
  v_pk_fma_f32 v[62:63], v[154:155], v[58:59], v[62:63]
  v_pk_mul_f32 v[40:41], v[40:41], v[42:43]
  v_pk_mul_f32 v[46:47], v[46:47], v[48:49]
  v_pk_mul_f32 v[52:53], v[52:53], v[54:55]
  v_pk_mul_f32 v[58:59], v[58:59], v[60:61]
  v_rcp_f32 v40, v40
  v_rcp_f32 v41, v41
  v_rcp_f32 v46, v46
  v_rcp_f32 v47, v47
  v_rcp_f32 v52, v52
  v_rcp_f32 v53, v53
  v_rcp_f32 v58, v58
  v_rcp_f32 v59, v59
  v_pk_mul_f32 v[16:17], v[40:41], v[44:45]
  v_pk_mul_f32 v[18:19], v[46:47], v[50:51]
  v_pk_mul_f32 v[20:21], v[52:53], v[56:57]
  v_pk_mul_f32 v[22:23], v[58:59], v[62:63]
  v_pk_mul_f32 v[64:65], v[156:157], v[156:157]
  v_pk_mul_f32 v[66:67], v[158:159], v[158:159]
  v_pk_mul_f32 v[70:71], v[160:161], v[160:161]
  v_pk_mul_f32 v[72:73], v[162:163], v[162:163]
  v_pk_mul_f32 v[76:77], v[164:165], v[164:165]
  v_pk_mul_f32 v[78:79], v[166:167], v[166:167]
  v_pk_mul_f32 v[82:83], v[168:169], v[168:169]
  v_pk_mul_f32 v[84:85], v[170:171], v[170:171]
  v_pk_fma_f32 v[64:65], v[64:65], v[234:235], v[232:233]
  v_pk_fma_f32 v[66:67], v[66:67], v[234:235], v[232:233]
  v_pk_fma_f32 v[70:71], v[70:71], v[234:235], v[232:233]
  v_pk_fma_f32 v[72:73], v[72:73], v[234:235], v[232:233]
  v_pk_fma_f32 v[76:77], v[76:77], v[234:235], v[232:233]
  v_pk_fma_f32 v[78:79], v[78:79], v[234:235], v[232:233]
  v_pk_fma_f32 v[82:83], v[82:83], v[234:235], v[232:233]
  v_pk_fma_f32 v[84:85], v[84:85], v[234:235], v[232:233]
  v_pk_fma_f32 v[64:65], v[64:65], v[156:157], v[236:237]
  v_pk_fma_f32 v[66:67], v[66:67], v[158:159], v[236:237]
  v_pk_fma_f32 v[70:71], v[70:71], v[160:161], v[236:237]
  v_pk_fma_f32 v[72:73], v[72:73], v[162:163], v[236:237]
  v_pk_fma_f32 v[76:77], v[76:77], v[164:165], v[236:237]
  v_pk_fma_f32 v[78:79], v[78:79], v[166:167], v[236:237]
  v_pk_fma_f32 v[82:83], v[82:83], v[168:169], v[236:237]
  v_pk_fma_f32 v[84:85], v[84:85], v[170:171], v[236:237]
  v_exp_f32 v64, v64 clamp
  v_exp_f32 v65, v65 clamp
  v_exp_f32 v66, v66 clamp
  v_exp_f32 v67, v67 clamp
  v_exp_f32 v70, v70 clamp
  v_exp_f32 v71, v71 clamp
  v_exp_f32 v72, v72 clamp
  v_exp_f32 v73, v73 clamp
  v_exp_f32 v76, v76 clamp
  v_exp_f32 v77, v77 clamp
  v_exp_f32 v78, v78 clamp
  v_exp_f32 v79, v79 clamp
  v_exp_f32 v82, v82 clamp
  v_exp_f32 v83, v83 clamp
  v_exp_f32 v84, v84 clamp
  v_exp_f32 v85, v85 clamp
  v_pk_fma_f32 v[64:65], v[64:65], v[136:137], v[116:117]
  v_pk_fma_f32 v[66:67], v[66:67], v[138:139], v[118:119]
  v_pk_fma_f32 v[70:71], v[70:71], v[136:137], v[116:117]
  v_pk_fma_f32 v[72:73], v[72:73], v[138:139], v[118:119]
  v_pk_fma_f32 v[76:77], v[76:77], v[136:137], v[116:117]
  v_pk_fma_f32 v[78:79], v[78:79], v[138:139], v[118:119]
  v_pk_fma_f32 v[82:83], v[82:83], v[136:137], v[116:117]
  v_pk_fma_f32 v[84:85], v[84:85], v[138:139], v[118:119]
  v_pk_mul_f32 v[68:69], v[156:157], v[66:67]
  v_pk_mul_f32 v[74:75], v[160:161], v[72:73]
  v_pk_mul_f32 v[80:81], v[164:165], v[78:79]
  v_pk_mul_f32 v[86:87], v[168:169], v[84:85]
  v_pk_fma_f32 v[68:69], v[158:159], v[64:65], v[68:69]
  v_pk_fma_f32 v[74:75], v[162:163], v[70:71], v[74:75]
  v_pk_fma_f32 v[80:81], v[166:167], v[76:77], v[80:81]
  v_pk_fma_f32 v[86:87], v[170:171], v[82:83], v[86:87]
  v_pk_mul_f32 v[64:65], v[64:65], v[66:67]
  v_pk_mul_f32 v[70:71], v[70:71], v[72:73]
  v_pk_mul_f32 v[76:77], v[76:77], v[78:79]
  v_pk_mul_f32 v[82:83], v[82:83], v[84:85]
  v_rcp_f32 v64, v64
  v_rcp_f32 v65, v65
  v_rcp_f32 v70, v70
  v_rcp_f32 v71, v71
  v_rcp_f32 v76, v76
  v_rcp_f32 v77, v77
  v_rcp_f32 v82, v82
  v_rcp_f32 v83, v83
  v_pk_fma_f32 v[16:17], v[64:65], v[68:69], v[16:17]
  v_pk_fma_f32 v[18:19], v[70:71], v[74:75], v[18:19]
  v_pk_fma_f32 v[20:21], v[76:77], v[80:81], v[20:21]
  v_pk_fma_f32 v[22:23], v[82:83], v[86:87], v[22:23]
  v_pk_mul_f32 v[40:41], v[172:173], v[172:173]
  v_pk_mul_f32 v[42:43], v[174:175], v[174:175]
  v_pk_mul_f32 v[46:47], v[176:177], v[176:177]
  v_pk_mul_f32 v[48:49], v[178:179], v[178:179]
  v_pk_mul_f32 v[52:53], v[180:181], v[180:181]
  v_pk_mul_f32 v[54:55], v[182:183], v[182:183]
  v_pk_mul_f32 v[58:59], v[184:185], v[184:185]
  v_pk_mul_f32 v[60:61], v[186:187], v[186:187]
  v_pk_fma_f32 v[40:41], v[40:41], v[234:235], v[232:233]
  v_pk_fma_f32 v[42:43], v[42:43], v[234:235], v[232:233]
  v_pk_fma_f32 v[46:47], v[46:47], v[234:235], v[232:233]
  v_pk_fma_f32 v[48:49], v[48:49], v[234:235], v[232:233]
  v_pk_fma_f32 v[52:53], v[52:53], v[234:235], v[232:233]
  v_pk_fma_f32 v[54:55], v[54:55], v[234:235], v[232:233]
  v_pk_fma_f32 v[58:59], v[58:59], v[234:235], v[232:233]
  v_pk_fma_f32 v[60:61], v[60:61], v[234:235], v[232:233]
  v_pk_fma_f32 v[40:41], v[40:41], v[172:173], v[236:237]
  v_pk_fma_f32 v[42:43], v[42:43], v[174:175], v[236:237]
  v_pk_fma_f32 v[46:47], v[46:47], v[176:177], v[236:237]
  v_pk_fma_f32 v[48:49], v[48:49], v[178:179], v[236:237]
  v_pk_fma_f32 v[52:53], v[52:53], v[180:181], v[236:237]
  v_pk_fma_f32 v[54:55], v[54:55], v[182:183], v[236:237]
  v_pk_fma_f32 v[58:59], v[58:59], v[184:185], v[236:237]
  v_pk_fma_f32 v[60:61], v[60:61], v[186:187], v[236:237]
  v_exp_f32 v40, v40 clamp
  v_exp_f32 v41, v41 clamp
  v_exp_f32 v42, v42 clamp
  v_exp_f32 v43, v43 clamp
  v_exp_f32 v46, v46 clamp
  v_exp_f32 v47, v47 clamp
  v_exp_f32 v48, v48 clamp
  v_exp_f32 v49, v49 clamp
  v_exp_f32 v52, v52 clamp
  v_exp_f32 v53, v53 clamp
  v_exp_f32 v54, v54 clamp
  v_exp_f32 v55, v55 clamp
  v_exp_f32 v58, v58 clamp
  v_exp_f32 v59, v59 clamp
  v_exp_f32 v60, v60 clamp
  v_exp_f32 v61, v61 clamp
  v_pk_fma_f32 v[40:41], v[40:41], v[220:221], v[120:121]
  v_pk_fma_f32 v[42:43], v[42:43], v[222:223], v[122:123]
  v_pk_fma_f32 v[46:47], v[46:47], v[220:221], v[120:121]
  v_pk_fma_f32 v[48:49], v[48:49], v[222:223], v[122:123]
  v_pk_fma_f32 v[52:53], v[52:53], v[220:221], v[120:121]
  v_pk_fma_f32 v[54:55], v[54:55], v[222:223], v[122:123]
  v_pk_fma_f32 v[58:59], v[58:59], v[220:221], v[120:121]
  v_pk_fma_f32 v[60:61], v[60:61], v[222:223], v[122:123]
  v_pk_mul_f32 v[44:45], v[172:173], v[42:43]
  v_pk_mul_f32 v[50:51], v[176:177], v[48:49]
  v_pk_mul_f32 v[56:57], v[180:181], v[54:55]
  v_pk_mul_f32 v[62:63], v[184:185], v[60:61]
  v_pk_fma_f32 v[44:45], v[174:175], v[40:41], v[44:45]
  v_pk_fma_f32 v[50:51], v[178:179], v[46:47], v[50:51]
  v_pk_fma_f32 v[56:57], v[182:183], v[52:53], v[56:57]
  v_pk_fma_f32 v[62:63], v[186:187], v[58:59], v[62:63]
  v_pk_mul_f32 v[40:41], v[40:41], v[42:43]
  v_pk_mul_f32 v[46:47], v[46:47], v[48:49]
  v_pk_mul_f32 v[52:53], v[52:53], v[54:55]
  v_pk_mul_f32 v[58:59], v[58:59], v[60:61]
  v_rcp_f32 v40, v40
  v_rcp_f32 v41, v41
  v_rcp_f32 v46, v46
  v_rcp_f32 v47, v47
  v_rcp_f32 v52, v52
  v_rcp_f32 v53, v53
  v_rcp_f32 v58, v58
  v_rcp_f32 v59, v59
  v_pk_fma_f32 v[16:17], v[40:41], v[44:45], v[16:17]
  v_pk_fma_f32 v[18:19], v[46:47], v[50:51], v[18:19]
  v_pk_fma_f32 v[20:21], v[52:53], v[56:57], v[20:21]
  v_pk_fma_f32 v[22:23], v[58:59], v[62:63], v[22:23]
  v_pk_mul_f32 v[64:65], v[188:189], v[188:189]
  v_pk_mul_f32 v[66:67], v[190:191], v[190:191]
  v_pk_mul_f32 v[70:71], v[192:193], v[192:193]
  v_pk_mul_f32 v[72:73], v[194:195], v[194:195]
  v_pk_mul_f32 v[76:77], v[196:197], v[196:197]
  v_pk_mul_f32 v[78:79], v[198:199], v[198:199]
  v_pk_mul_f32 v[82:83], v[200:201], v[200:201]
  v_pk_mul_f32 v[84:85], v[202:203], v[202:203]
  v_pk_fma_f32 v[64:65], v[64:65], v[234:235], v[232:233]
  v_pk_fma_f32 v[66:67], v[66:67], v[234:235], v[232:233]
  v_pk_fma_f32 v[70:71], v[70:71], v[234:235], v[232:233]
  v_pk_fma_f32 v[72:73], v[72:73], v[234:235], v[232:233]
  v_pk_fma_f32 v[76:77], v[76:77], v[234:235], v[232:233]
  v_pk_fma_f32 v[78:79], v[78:79], v[234:235], v[232:233]
  v_pk_fma_f32 v[82:83], v[82:83], v[234:235], v[232:233]
  v_pk_fma_f32 v[84:85], v[84:85], v[234:235], v[232:233]
  v_pk_fma_f32 v[64:65], v[64:65], v[188:189], v[236:237]
  v_pk_fma_f32 v[66:67], v[66:67], v[190:191], v[236:237]
  v_pk_fma_f32 v[70:71], v[70:71], v[192:193], v[236:237]
  v_pk_fma_f32 v[72:73], v[72:73], v[194:195], v[236:237]
  v_pk_fma_f32 v[76:77], v[76:77], v[196:197], v[236:237]
  v_pk_fma_f32 v[78:79], v[78:79], v[198:199], v[236:237]
  v_pk_fma_f32 v[82:83], v[82:83], v[200:201], v[236:237]
  v_pk_fma_f32 v[84:85], v[84:85], v[202:203], v[236:237]
  v_exp_f32 v64, v64 clamp
  v_exp_f32 v65, v65 clamp
  v_exp_f32 v66, v66 clamp
  v_exp_f32 v67, v67 clamp
  v_exp_f32 v70, v70 clamp
  v_exp_f32 v71, v71 clamp
  v_exp_f32 v72, v72 clamp
  v_exp_f32 v73, v73 clamp
  v_exp_f32 v76, v76 clamp
  v_exp_f32 v77, v77 clamp
  v_exp_f32 v78, v78 clamp
  v_exp_f32 v79, v79 clamp
  v_exp_f32 v82, v82 clamp
  v_exp_f32 v83, v83 clamp
  v_exp_f32 v84, v84 clamp
  v_exp_f32 v85, v85 clamp
  v_pk_fma_f32 v[64:65], v[64:65], v[224:225], v[124:125]
  v_pk_fma_f32 v[66:67], v[66:67], v[226:227], v[126:127]
  v_pk_fma_f32 v[70:71], v[70:71], v[224:225], v[124:125]
  v_pk_fma_f32 v[72:73], v[72:73], v[226:227], v[126:127]
  v_pk_fma_f32 v[76:77], v[76:77], v[224:225], v[124:125]
  v_pk_fma_f32 v[78:79], v[78:79], v[226:227], v[126:127]
  v_pk_fma_f32 v[82:83], v[82:83], v[224:225], v[124:125]
  v_pk_fma_f32 v[84:85], v[84:85], v[226:227], v[126:127]
  v_pk_mul_f32 v[68:69], v[188:189], v[66:67]
  v_pk_mul_f32 v[74:75], v[192:193], v[72:73]
  v_pk_mul_f32 v[80:81], v[196:197], v[78:79]
  v_pk_mul_f32 v[86:87], v[200:201], v[84:85]
  v_pk_fma_f32 v[68:69], v[190:191], v[64:65], v[68:69]
  v_pk_fma_f32 v[74:75], v[194:195], v[70:71], v[74:75]
  v_pk_fma_f32 v[80:81], v[198:199], v[76:77], v[80:81]
  v_pk_fma_f32 v[86:87], v[202:203], v[82:83], v[86:87]
  v_pk_mul_f32 v[64:65], v[64:65], v[66:67]
  v_pk_mul_f32 v[70:71], v[70:71], v[72:73]
  v_pk_mul_f32 v[76:77], v[76:77], v[78:79]
  v_pk_mul_f32 v[82:83], v[82:83], v[84:85]
  v_rcp_f32 v64, v64
  v_rcp_f32 v65, v65
  v_rcp_f32 v70, v70
  v_rcp_f32 v71, v71
  v_rcp_f32 v76, v76
  v_rcp_f32 v77, v77
  v_rcp_f32 v82, v82
  v_rcp_f32 v83, v83
  v_pk_fma_f32 v[16:17], v[64:65], v[68:69], v[16:17]
  v_pk_fma_f32 v[18:19], v[70:71], v[74:75], v[18:19]
  v_pk_fma_f32 v[20:21], v[76:77], v[80:81], v[20:21]
  v_pk_fma_f32 v[22:23], v[82:83], v[86:87], v[22:23]
  v_pk_mul_f32 v[40:41], v[204:205], v[204:205]
  v_pk_mul_f32 v[42:43], v[206:207], v[206:207]
  v_pk_mul_f32 v[46:47], v[208:209], v[208:209]
  v_pk_mul_f32 v[48:49], v[210:211], v[210:211]
  v_pk_mul_f32 v[52:53], v[212:213], v[212:213]
  v_pk_mul_f32 v[54:55], v[214:215], v[214:215]
  v_pk_mul_f32 v[58:59], v[216:217], v[216:217]
  v_pk_mul_f32 v[60:61], v[218:219], v[218:219]
  v_pk_fma_f32 v[40:41], v[40:41], v[234:235], v[232:233]
  v_pk_fma_f32 v[42:43], v[42:43], v[234:235], v[232:233]
  v_pk_fma_f32 v[46:47], v[46:47], v[234:235], v[232:233]
  v_pk_fma_f32 v[48:49], v[48:49], v[234:235], v[232:233]
  v_pk_fma_f32 v[52:53], v[52:53], v[234:235], v[232:233]
  v_pk_fma_f32 v[54:55], v[54:55], v[234:235], v[232:233]
  v_pk_fma_f32 v[58:59], v[58:59], v[234:235], v[232:233]
  v_pk_fma_f32 v[60:61], v[60:61], v[234:235], v[232:233]
  v_pk_fma_f32 v[40:41], v[40:41], v[204:205], v[236:237]
  v_pk_fma_f32 v[42:43], v[42:43], v[206:207], v[236:237]
  v_pk_fma_f32 v[46:47], v[46:47], v[208:209], v[236:237]
  v_pk_fma_f32 v[48:49], v[48:49], v[210:211], v[236:237]
  v_pk_fma_f32 v[52:53], v[52:53], v[212:213], v[236:237]
  v_pk_fma_f32 v[54:55], v[54:55], v[214:215], v[236:237]
  v_pk_fma_f32 v[58:59], v[58:59], v[216:217], v[236:237]
  v_pk_fma_f32 v[60:61], v[60:61], v[218:219], v[236:237]
  v_exp_f32 v40, v40 clamp
  v_exp_f32 v41, v41 clamp
  v_exp_f32 v42, v42 clamp
  v_exp_f32 v43, v43 clamp
  v_exp_f32 v46, v46 clamp
  v_exp_f32 v47, v47 clamp
  v_exp_f32 v48, v48 clamp
  v_exp_f32 v49, v49 clamp
  v_exp_f32 v52, v52 clamp
  v_exp_f32 v53, v53 clamp
  v_exp_f32 v54, v54 clamp
  v_exp_f32 v55, v55 clamp
  v_exp_f32 v58, v58 clamp
  v_exp_f32 v59, v59 clamp
  v_exp_f32 v60, v60 clamp
  v_exp_f32 v61, v61 clamp
  v_pk_fma_f32 v[40:41], v[40:41], v[228:229], v[128:129]
  v_pk_fma_f32 v[42:43], v[42:43], v[230:231], v[130:131]
  v_pk_fma_f32 v[46:47], v[46:47], v[228:229], v[128:129]
  v_pk_fma_f32 v[48:49], v[48:49], v[230:231], v[130:131]
  v_pk_fma_f32 v[52:53], v[52:53], v[228:229], v[128:129]
  v_pk_fma_f32 v[54:55], v[54:55], v[230:231], v[130:131]
  v_pk_fma_f32 v[58:59], v[58:59], v[228:229], v[128:129]
  v_pk_fma_f32 v[60:61], v[60:61], v[230:231], v[130:131]
  v_pk_mul_f32 v[44:45], v[204:205], v[42:43]
  v_pk_mul_f32 v[50:51], v[208:209], v[48:49]
  v_pk_mul_f32 v[56:57], v[212:213], v[54:55]
  v_pk_mul_f32 v[62:63], v[216:217], v[60:61]
  v_pk_fma_f32 v[44:45], v[206:207], v[40:41], v[44:45]
  v_pk_fma_f32 v[50:51], v[210:211], v[46:47], v[50:51]
  v_pk_fma_f32 v[56:57], v[214:215], v[52:53], v[56:57]
  v_pk_fma_f32 v[62:63], v[218:219], v[58:59], v[62:63]
  v_pk_mul_f32 v[40:41], v[40:41], v[42:43]
  v_pk_mul_f32 v[46:47], v[46:47], v[48:49]
  v_pk_mul_f32 v[52:53], v[52:53], v[54:55]
  v_pk_mul_f32 v[58:59], v[58:59], v[60:61]
  v_rcp_f32 v40, v40
  v_rcp_f32 v41, v41
  v_rcp_f32 v46, v46
  v_rcp_f32 v47, v47
  v_rcp_f32 v52, v52
  v_rcp_f32 v53, v53
  v_rcp_f32 v58, v58
  v_rcp_f32 v59, v59
  v_pk_fma_f32 v[16:17], v[40:41], v[44:45], v[16:17]
  v_pk_fma_f32 v[18:19], v[46:47], v[50:51], v[18:19]
  v_pk_fma_f32 v[20:21], v[52:53], v[56:57], v[20:21]
  v_pk_fma_f32 v[22:23], v[58:59], v[62:63], v[22:23]
  v_add_f32 v16, v16, v17
  v_add_f32 v18, v18, v19
  v_add_f32 v20, v20, v21
  v_add_f32 v22, v22, v23
  v_mul_f32 v16, v239, v16
  v_mul_f32 v18, v239, v18
  v_mul_f32 v20, v239, v20
  v_mul_f32 v22, v239, v22
  s_nop 0
  v_permlane32_swap_b32 v16, v20
  v_permlane32_swap_b32 v18, v22
  v_add_f32 v16, v16, v20
  v_add_f32 v18, v18, v22
  s_nop 1
  v_permlane16_swap_b32 v16, v18
  v_add_f32 v16, v16, v18
  ds_write_b32 v36, v16
  s_waitcnt lgkmcnt(0)
  s_cmp_eq_u32 s3, 0
  s_cbranch_scc1 L_dpub
  s_barrier
  s_endpgm
L_dpub:
  s_mov_b32 s60, s24
  s_and_b32 s61, s25, 0xffff
  s_mov_b32 s62, 268435456
  s_mov_b32 s63, 0x20000
  s_mov_b32 s64, s22
  s_and_b32 s65, s23, 0xffff
  s_mov_b32 s66, 256
  s_mov_b32 s67, 0x20000
  s_and_b32 s81, s2, 7
  s_waitcnt vmcnt(0)
  v_cmp_eq_u32 vcc, 0, v37
  s_nop 0
  s_bitcmp1_b32 vcc_lo, s81
  s_cbranch_scc0 L_dclr_ok
  s_mov_b32 s78, 0x40000
L_dclr:
  s_sub_u32 s78, s78, 1
  s_cbranch_scc1 L_dclr_ok
  v_lshlrev_b32 v37, 2, v0
  v_and_b32 v37, 31, v37
  buffer_load_dword v37, v37, s[64:67], 0 offen offset:128 sc1
  s_waitcnt vmcnt(0)
  v_cmp_eq_u32 vcc, 0, v37
  s_nop 0
  s_bitcmp1_b32 vcc_lo, s81
  s_cbranch_scc1 L_dclr
L_dclr_ok:
  s_barrier
  ds_read_b64 v[64:65], v2 offset:0
  ds_read_b64 v[66:67], v2 offset:512
  ds_read_b64 v[68:69], v2 offset:1024
  ds_read_b64 v[70:71], v2 offset:1536
  s_waitcnt lgkmcnt(2)
  v_pk_add_f32 v[64:65], v[64:65], v[66:67]
  s_waitcnt lgkmcnt(0)
  v_pk_add_f32 v[68:69], v[68:69], v[70:71]
  v_pk_add_f32 v[64:65], v[64:65], v[68:69]
  v_and_b32 v64, -2, v64
  v_and_b32 v65, -2, v65
  buffer_store_dwordx2 v[64:65], v3, s[60:63], s69 offen sc1
  s_endpgm
L_cin:
  s_and_b32 s68, s26, 3
  s_mul_i32 s68, s68, 3
  s_add_u32 s27, s68, s27
  s_sub_u32 s27, s27, 6
  s_and_b32 s79, s3, 3
  s_lshr_b32 s84, s3, 2
  s_lshl_b32 s100, s27, 3
  s_add_u32 s100, s100, s3
  s_mul_i32 s68, s100, 1280
  v_min_u32 v40, 9, v0
  v_lshlrev_b32 v40, 7, v40
  v_lshlrev_b32 v48, 4, v0
  s_lshl_b32 s95, s79, 10
  s_cmp_eq_u32 s79, 2
  s_cselect_b64 s[82:83], 0x3fffff, -1
  s_cmp_eq_u32 s79, 3
  s_cselect_b32 s96, 0, 32768
  s_add_u32 s96, s96, s95
  v_mov_b32 v2, 110464
  v_lshlrev_b32 v1, 20, v0
  v_add_u32 v1, 110464, v1
  v_and_b32 v44, 7, v0
  v_lshlrev_b32 v18, 4, v44
  v_and_b32 v44, 15, v0
  v_lshl_add_u32 v44, v44, 2, v2
  v_mov_b32 v3, 0
  ds_write_b32 v44, v3
  v_lshrrev_b32 v41, 5, v0
  v_and_b32 v42, 31, v0
  s_waitcnt lgkmcnt(0)
  v_mov_b32 v3, 1
  s_mov_b32 s36, s8
  s_and_b32 s37, s9, 0xffff
  s_mov_b32 s38, 105456
  s_mov_b32 s39, 0x20000
  buffer_load_dword v255, v40, s[36:39], s68 offen
  s_barrier
  v_add_u32 v248, s95, v48
  v_cmp_gt_u32 vcc, 1152, v248
  s_nop 1
  v_cndmask_b32 v248, 0, 4, vcc
  v_add_u32 v248, v248, v48
  s_cmp_lg_u32 s84, 0
  s_cbranch_scc1 L_g1a
  s_mov_b32 s40, s10
  s_and_b32 s41, s11, 0xffff
  s_mov_b32 s42, 156
  s_mov_b32 s43, 0x20000
  s_mov_b32 m0, 110272
  s_mov_b64 exec, 0x7ff
  buffer_load_dwordx4 v48, s[40:43], 0 offen lds
  s_mov_b64 exec, -1
  s_add_u32 m0, s95, 71552
  s_add_u32 s81, s95, 70304
  buffer_load_dwordx4 v48, s[36:39], s81 offen lds
  s_add_u32 m0, s95, 75648
  s_add_u32 s81, s95, 74400
  buffer_load_dwordx4 v48, s[36:39], s81 offen lds
  s_add_u32 m0, s95, 79744
  s_add_u32 s81, s95, 78496
  buffer_load_dwordx4 v48, s[36:39], s81 offen lds
  s_add_u32 m0, s95, 83840
  s_add_u32 s81, s95, 82592
  buffer_load_dwordx4 v48, s[36:39], s81 offen lds
  s_add_u32 m0, s95, 87936
  s_add_u32 s81, s95, 86688
  buffer_load_dwordx4 v48, s[36:39], s81 offen lds
  s_add_u32 m0, s95, 92032
  s_add_u32 s81, s95, 90784
  buffer_load_dwordx4 v48, s[36:39], s81 offen lds
  s_add_u32 m0, s95, 96128
  s_add_u32 s81, s95, 94880
  buffer_load_dwordx4 v48, s[36:39], s81 offen lds
  s_add_u32 m0, s95, 100224
  s_add_u32 s81, s95, 98976
  buffer_load_dwordx4 v48, s[36:39], s81 offen lds
  s_add_u32 m0, s96, 71552
  s_add_u32 s81, s96, 70304
  s_mov_b64 exec, s[82:83]
  buffer_load_dwordx4 v48, s[36:39], s81 offen lds
  s_mov_b64 exec, -1
  s_add_u32 m0, s95, 36288
  s_add_u32 s81, s95, 35152
  buffer_load_dwordx4 v48, s[36:39], s81 offen lds
  s_add_u32 m0, s95, 40384
  s_add_u32 s81, s95, 39248
  buffer_load_dwordx4 v48, s[36:39], s81 offen lds
  s_add_u32 m0, s95, 44480
  s_add_u32 s81, s95, 43344
  buffer_load_dwordx4 v48, s[36:39], s81 offen lds
  s_add_u32 m0, s95, 48576
  s_add_u32 s81, s95, 47440
  buffer_load_dwordx4 v48, s[36:39], s81 offen lds
  s_add_u32 m0, s95, 52672
  s_add_u32 s81, s95, 51536
  buffer_load_dwordx4 v48, s[36:39], s81 offen lds
  s_add_u32 m0, s95, 56768
  s_add_u32 s81, s95, 55632
  buffer_load_dwordx4 v48, s[36:39], s81 offen lds
  s_waitcnt vmcnt(6) lgkmcnt(0)
  ds_add_u32 v1, v3 offset:0
  s_add_u32 m0, s95, 60864
  s_add_u32 s81, s95, 59728
  buffer_load_dwordx4 v48, s[36:39], s81 offen lds
  s_add_u32 m0, s95, 64960
  s_add_u32 s81, s95, 63824
  buffer_load_dwordx4 v48, s[36:39], s81 offen lds
  s_add_u32 m0, s96, 36288
  s_add_u32 s81, s96, 35152
  s_mov_b64 exec, s[82:83]
  buffer_load_dwordx4 v48, s[36:39], s81 offen lds
  s_mov_b64 exec, -1
  s_add_u32 m0, s95, 1024
  s_add_u32 s81, s95, 0
  buffer_load_dwordx4 v48, s[36:39], s81 offen lds
  s_add_u32 m0, s95, 5120
  s_add_u32 s81, s95, 4096
  buffer_load_dwordx4 v48, s[36:39], s81 offen lds
  s_add_u32 m0, s95, 9216
  s_add_u32 s81, s95, 8192
  buffer_load_dwordx4 v48, s[36:39], s81 offen lds
  s_add_u32 m0, s95, 13312
  s_add_u32 s81, s95, 12288
  buffer_load_dwordx4 v48, s[36:39], s81 offen lds
  s_add_u32 m0, s95, 17408
  s_add_u32 s81, s95, 16384
  buffer_load_dwordx4 v48, s[36:39], s81 offen lds
  s_add_u32 m0, s95, 21504
  s_add_u32 s81, s95, 20476
  buffer_load_dwordx4 v248, s[36:39], s81 offen lds
  s_waitcnt vmcnt(6) lgkmcnt(0)
  ds_add_u32 v1, v3 offset:4
  s_add_u32 m0, s95, 25600
  s_add_u32 s81, s95, 24572
  buffer_load_dwordx4 v48, s[36:39], s81 offen lds
  s_add_u32 m0, s95, 29696
  s_add_u32 s81, s95, 28668
  buffer_load_dwordx4 v48, s[36:39], s81 offen lds
  s_add_u32 m0, s96, 1024
  s_lshr_b32 s81, s96, 13
  s_sub_u32 s81, s96, s81
  s_mov_b64 exec, s[82:83]
  buffer_load_dwordx4 v48, s[36:39], s81 offen lds
  s_mov_b64 exec, -1
  s_branch L_addrc
L_g1a:
  s_setprio 1
  v_bfe_u32 v43, v0, 2, 2
  v_lshl_add_u32 v43, v41, 3, v43
  v_bfe_u32 v44, v0, 4, 1
  v_lshlrev_b32 v44, 5, v44
  v_and_b32 v45, 3, v0
  v_lshl_add_u32 v44, v45, 3, v44
  v_lshl_add_u32 v240, v43, 6, v44
  v_add_u32 v240, 106816, v240
  s_lshl_b32 s68, s79, 6
  s_add_u32 s68, s68, 36288
  v_add_u32 v44, s68, v44
  v_mul_u32_u24 v45, 1352, v43
  v_add_u32 v241, v44, v45
  v_add_u32 v45, 16, v43
  v_min_u32 v45, 25, v45
  v_mul_u32_u24 v45, 1352, v45
  v_add_u32 v242, v44, v45
  v_add_u32 v45, 20, v43
  v_min_u32 v45, 25, v45
  v_mul_u32_u24 v45, 1352, v45
  v_add_u32 v243, v44, v45
  s_lshl_b32 s68, s79, 5
  v_add_u32 v246, s68, v42
  v_mul_u32_u24 v43, 52, v246
  v_lshl_add_u32 v43, v41, 3, v43
  v_add_u32 v244, 71552, v43
  v_lshlrev_b32 v43, 1, v246
  v_add_u32 v245, 108864, v43
  v_mov_b32 v216, 0
  v_mov_b32 v217, 0
  v_lshlrev_b32 v43, 3, v0
  v_add_u32 v44, 106816, v43
  s_lshl_b32 s68, s79, 9
  v_add_u32 v44, s68, v44
  ds_write_b64 v44, v[216:217]
  v_lshl_add_u32 v43, v41, 7, v246
  s_mov_b32 s69, 2521
  s_mov_b32 s70, 106816
  v_mul_u32_u24 v44, s69, v43
  v_lshrrev_b32 v44, 16, v44
  v_mad_u32_u24 v44, v44, 12, s70
  v_lshl_add_u32 v68, v43, 1, v44
  v_add_u32 v43, 256, v43
  v_mul_u32_u24 v44, s69, v43
  v_lshrrev_b32 v44, 16, v44
  v_mad_u32_u24 v44, v44, 12, s70
  v_lshl_add_u32 v69, v43, 1, v44
  v_add_u32 v43, 256, v43
  v_mul_u32_u24 v44, s69, v43
  v_lshrrev_b32 v44, 16, v44
  v_mad_u32_u24 v44, v44, 12, s70
  v_lshl_add_u32 v70, v43, 1, v44
  v_mov_b32 v44, 676
  v_cmp_gt_u32 s[92:93], v44, v43
  v_add_u32 v43, 0, v246
  v_mul_u32_u24 v44, s69, v43
  v_lshrrev_b32 v44, 16, v44
  v_lshl_add_u32 v44, v44, 2, v244
  v_add_u32 v72, 0, v44
  v_add_u32 v43, 128, v246
  v_mul_u32_u24 v44, s69, v43
  v_lshrrev_b32 v44, 16, v44
  v_lshl_add_u32 v44, v44, 2, v244
  v_add_u32 v73, 6656, v44
  v_add_u32 v43, 256, v246
  v_mul_u32_u24 v44, s69, v43
  v_lshrrev_b32 v44, 16, v44
  v_lshl_add_u32 v44, v44, 2, v244
  v_add_u32 v74, 13312, v44
  v_add_u32 v43, 384, v246
  v_mul_u32_u24 v44, s69, v43
  v_lshrrev_b32 v44, 16, v44
  v_lshl_add_u32 v44, v44, 2, v244
  v_add_u32 v75, 19968, v44
  v_add_u32 v43, 512, v246
  v_mul_u32_u24 v44, s69, v43
  v_lshrrev_b32 v44, 16, v44
  v_lshl_add_u32 v44, v44, 2, v244
  v_add_u32 v76, 26624, v44
  v_add_u32 v43, 640, v246
  v_mul_u32_u24 v44, s69, v43
  v_lshrrev_b32 v44, 16, v44
  v_lshl_add_u32 v44, v44, 2, v244
  v_add_u32 v77, 33280, v44
  v_lshlrev_b32 v78, 4, v41
  v_add_u32 v78, 110376, v78
  v_lshlrev_b32 v79, 1, v0
  v_add_u32 v79, 110272, v79
  v_lshlrev_b32 v80, 6, v0
  v_add_u32 v80, 106868, v80
L_addrc:
  s_mul_i32 s69, s27, 2979
  s_lshr_b32 s69, s69, 6
  s_mul_i32 s98, s27, 44
  s_and_b32 s70, s2, 7
  s_add_u32 s85, s98, s3
  s_lshl_b32 s85, s85, 2
  s_lshl_b32 s98, s70, 14
  s_add_u32 s85, s85, s98
  s_add_u32 s85, s85, 10240
  s_mul_i32 s98, s27, 44
  s_lshl_b32 s77, s70, 9
  s_add_u32 s94, s77, s98
  s_add_u32 s77, s77, s69
  s_add_u32 s94, s94, s3
  s_mul_i32 s94, s94, 104
  s_lshl_b32 s98, s27, 2
  s_add_u32 s98, s98, s3
  s_add_u32 s98, s98, s70
  s_and_b32 s98, s98, 7
  s_mul_i32 s98, s98, 16640
  s_add_u32 s98, s98, 12288
  s_sub_u32 s72, 6, s84
  s_lshl_b32 s99, s84, 1
  s_mov_b32 s26, -1
  v_lshrrev_b32 v43, 3, v0
  v_min_u32 v43, 6, v43
  v_lshlrev_b32 v17, 4, v43
  s_mul_i32 s70, s70, 88
  s_add_u32 s70, s100, s70
  s_mov_b32 s71, 704
  v_mov_b32 v44, s70
  v_mad_u32_u24 v19, v0, s71, v44
  s_mul_i32 s70, s100, 104
  s_sub_u32 s70, s70, 313
  v_min_u32 v44, 16, v0
  v_mul_u32_u24 v45, 26, v44
  v_add_u32 v45, s70, v45
  v_cmp_lt_u32 vcc, 12, v44
  s_nop 1
  v_cndmask_b32 v19, v19, v45, vcc
  v_lshlrev_b32 v19, 7, v19
  s_mov_b32 s101, 638976
  s_mov_b32 s32, s6
  s_and_b32 s33, s7, 0xffff
  s_mov_b32 s34, 12800000
  s_mov_b32 s35, 0x20000
  s_mov_b32 s44, s12
  s_and_b32 s45, s13, 0xffff
  s_mov_b32 s46, 5537792
  s_mov_b32 s47, 0x20000
  s_mov_b32 s28, s4
  s_and_b32 s29, s5, 0xffff
  s_mov_b32 s30, 425984
  s_mov_b32 s31, 0x20000
  s_and_b32 s70, s3, 1
  s_lshl_b32 s70, s70, 1
  v_add_u32 v46, s70, v41
  v_min_u32 v43, 25, v42
  s_mul_i32 s68, s84, 4
  s_add_u32 s68, s68, 1352
  s_mul_i32 s69, s84, 70528
  s_add_u32 s69, s69, 1024
  v_mul_u32_u24 v44, s68, v43
  v_add_u32 v44, s69, v44
  v_lshlrev_b32 v247, 2, v43
  v_add_u32 v247, 70528, v247
  s_lshl_b32 s68, s84, 2
  s_xor_b32 s68, s68, 4
  v_lshrrev_b32 v45, 2, v43
  v_and_b32 v45, s68, v45
  v_add_u32 v44, v44, v45
  v_sub_u32 v247, v247, v45
  v_mul_u32_u24 v65, 52, v43
  v_lshl_add_u32 v65, v46, 1, v65
  v_add_u32 v65, 108864, v65
  v_lshlrev_b32 v67, 1, v43
  v_add_u32 v67, 110272, v67
  v_mad_u32_u24 v60, v46, 52, v44
  v_lshl_add_u32 v61, v46, 1, v44
  v_lshl_add_u32 v49, v46, 1, v60
  v_lshlrev_b32 v43, 3, v46
  s_mov_b32 s68, 0x01000100
  v_bfe_i32 v45, s68, v43, 8
  v_lshl_add_u32 v50, v45, 1, v60
  v_mad_i32_i24 v51, v45, 52, v61
  s_mov_b32 s68, 0xff00ff00
  v_bfe_i32 v45, s68, v43, 8
  v_lshl_add_u32 v52, v45, 1, v60
  v_mad_i32_i24 v53, v45, 52, v61
  s_mov_b32 s68, 0xff020100
  v_bfe_i32 v45, s68, v43, 8
  v_lshl_add_u32 v54, v45, 1, v60
  v_mad_i32_i24 v55, v45, 52, v61
  s_mov_b32 s68, 0x0b0a0100
  v_bfe_i32 v45, s68, v43, 8
  v_lshl_add_u32 v56, v45, 1, v60
  v_mad_i32_i24 v57, v45, 52, v61
  s_mov_b32 s68, 0xf3f20100
  v_bfe_i32 v45, s68, v43, 8
  v_lshl_add_u32 v58, v45, 1, v60
  v_mad_i32_i24 v59, v45, 52, v61
  s_mov_b32 s68, 0x00023600
  v_bfe_u32 v45, s68, v43, 8
  v_add_u32 v60, v45, v44
  v_add_u32 v61, 52, v44
  v_mov_b32 v47, 1048576
  v_cmp_eq_u32 vcc, 3, v46
  s_nop 1
  v_cndmask_b32 v60, v60, v47, vcc
  v_cndmask_b32 v67, v47, v67, vcc
  v_cmp_eq_u32 vcc, 2, v46
  s_nop 1
  v_cndmask_b32 v61, v47, v61, vcc
  v_cmp_gt_u32 vcc, 2, v46
  s_nop 1
  v_cndmask_b32 v64, v47, v65, vcc
  s_lshr_b32 s69, s79, 1
  s_mul_i32 s69, s69, 6144
  s_mul_i32 s68, s84, 6144
  v_lshlrev_b32 v45, 8, v46
  v_lshl_add_u32 v43, v42, 4, v45
  v_add_u32 v63, 1024, v43
  v_add_u32 v66, 36288, v43
  v_bfe_u32 v43, v0, 2, 2
  v_lshl_add_u32 v45, v43, 4, v45
  v_and_b32 v43, 3, v0
  v_lshl_add_u32 v44, v43, 6, v45
  v_add_u32 v44, 12288, v44
  v_cmp_lt_u32 vcc, 15, v42
  s_nop 1
  v_cndmask_b32 v63, v63, v44, vcc
  v_add_u32 v44, 16, v44
  v_cndmask_b32 v66, v66, v44, vcc
  v_lshl_add_u32 v44, v43, 5, v45
  v_add_u32 v44, 24560, v44
  v_cmp_lt_u32 vcc, 19, v42
  s_nop 1
  v_cndmask_b32 v63, v63, v44, vcc
  v_add_u32 v63, s69, v63
  v_add_u32 v66, s68, v66
  v_cmp_lt_u32 vcc, 25, v42
  s_nop 1
  v_cndmask_b32 v63, v63, v47, vcc
  v_cndmask_b32 v66, v66, v47, vcc
  v_mov_b32 v62, 0
  s_mul_i32 s74, s3, 4224
  s_add_u32 s74, s74, 111040
  s_mov_b32 s75, -39488
  v_add_u32 v28, 1024, v48
  v_and_b32 v43, 11, v0
  v_cmp_eq_u32 vcc, 11, v43
  s_nop 1
  v_cndmask_b32 v31, v28, v47, vcc
  v_and_b32 v43, 3, v0
  v_cmp_eq_u32 vcc, 0, v43
  s_nop 1
  v_cndmask_b32 v30, v31, v47, vcc
  v_lshrrev_b32 v46, 4, v0
  v_bfe_u32 v43, v0, 1, 3
  v_lshlrev_b32 v45, 4, v43
  v_add_u32 v45, 24576, v45
  v_and_b32 v43, 10, v0
  v_cmp_eq_u32 vcc, 10, v43
  s_nop 1
  v_cndmask_b32 v45, v45, v47, vcc
  v_and_b32 v44, 1, v0
  v_lshl_add_u32 v29, v46, 9, v45
  v_lshl_add_u32 v29, v44, 2, v29
  v_add_u32 v29, 1024, v29
  v_lshl_add_u32 v22, v46, 8, v45
  v_lshl_add_u32 v22, v44, 20, v22
  v_and_b32 v47, 15, v0
  s_mov_b32 s68, 1056
  v_lshlrev_b32 v43, 1, v47
  v_add_u32 v43, s74, v43
  v_mad_u32_u24 v7, v46, s68, v43
  s_lshl_b32 s68, s3, 10
  s_add_u32 s68, s68, 144832
  v_add_u32 v10, s68, v48
  v_add_u32 v43, 256, v48
  v_and_b32 v43, 1023, v43
  v_add_u32 v11, s68, v43
  v_xor_b32 v43, 512, v48
  v_add_u32 v12, s68, v43
  v_lshlrev_b32 v13, 4, v41
  v_mov_b32 v32, 0
  v_mov_b32 v33, 0
  v_mov_b32 v34, 0
  v_mov_b32 v35, 0
  v_mov_b32 v36, 0
  v_mov_b32 v37, 0
  v_mov_b32 v38, 0
  v_mov_b32 v39, 0
  v_mov_b32 v216, 0
  v_mov_b32 v217, 0
  v_mov_b32 v218, 0
  v_mov_b32 v219, 0
  v_mov_b32 v220, 0
  v_mov_b32 v221, 0
  v_mov_b32 v222, 0
  v_mov_b32 v223, 0
  v_mov_b32 v224, 0
  v_mov_b32 v225, 0
  v_mov_b32 v226, 0
  v_mov_b32 v227, 0
  v_mov_b32 v228, 0
  v_mov_b32 v229, 0
  v_mov_b32 v230, 0
  v_mov_b32 v231, 0
  v_mov_b32 v232, 0
  v_mov_b32 v233, 0
  v_mov_b32 v234, 0
  v_mov_b32 v235, 0
  v_mov_b32 v236, 0
  v_mov_b32 v237, 0
  v_mov_b32 v238, 0
  v_mov_b32 v239, 0
  v_mul_u32_u24 v44, 1056, v46
  v_bfe_u32 v45, v0, 2, 2
  v_lshl_add_u32 v44, v45, 7, v44
  v_and_b32 v45, 3, v0
  v_lshl_add_u32 v9, v45, 3, v44
  v_add_u32 v8, s74, v9
  v_and_b32 v45, 1, v0
  s_mov_b32 s68, 0xaaaaaaaa
  v_mul_lo_u32 v16, s68, v45
  v_or_b32 v16, 0x44444444, v16
  v_lshlrev_b32 v15, 1, v0
  v_add_u32 v15, s74, v15
  v_mov_b32 v14, 0x3f80
  ds_write_b16 v15, v14 offset:4064
  v_add_u32 v15, s75, v15
  s_mul_i32 s71, s3, 6
  s_add_u32 s77, s77, s71
  s_mul_i32 s77, s77, 104
  s_add_u32 s73, s77, 80
  s_add_u32 s77, s77, 16
  s_mov_b32 s71, 10923
  v_min_u32 v43, 35, v0
  v_mul_u32_u24 v44, s71, v43
  v_lshrrev_b32 v44, 16, v44
  v_mul_u32_u24 v44, 80, v44
  v_lshl_add_u32 v20, v43, 2, v44
  s_cmp_eq_u32 s84, 0
  s_cbranch_scc1 L_g0pf
  s_waitcnt lgkmcnt(0)
  ds_add_u32 v1, v3 offset:0
  s_sub_u32 s94, s94, 416
  buffer_load_dwordx4 v[204:207], v17, s[28:31], s94 offen offset:0
  s_add_u32 s94, s94, 416
  buffer_load_dwordx4 v[24:27], v17, s[28:31], s94 offen offset:0
  s_add_u32 s94, s94, 832
  s_sub_u32 s68, s77, 2496
  buffer_load_dword v208, v20, s[28:31], s68 offen
  buffer_load_dword v209, v20, s[28:31], s77 offen
  s_add_u32 s77, s77, 24
  buffer_load_dword v21, v20, s[28:31], s77 offen
  s_cmp_eq_u32 s77, s73
  s_cselect_b32 s73, 0x7000000, s73
  s_cselect_b32 s77, 0x7000000, s77
  s_add_u32 s77, s77, 24
  s_min_u32 s77, s77, s73
L_csync1:
  ds_read_b32 v4, v2 offset:0
  s_waitcnt lgkmcnt(0)
  v_cmp_gt_u32 vcc, 8, v4
  s_cbranch_vccnz L_csync1
  ds_read_b64 v[132:133], v78 offset:0
  ds_read_b64 v[134:135], v78 offset:8
  ds_read_b64 v[136:137], v78 offset:32
  ds_read_b64 v[138:139], v78 offset:40
  ds_read_u16 v45, v79 offset:52
  ds_read_b64_tr_b16 v[84:85], v241 offset:35264
  ds_read_b64_tr_b16 v[86:87], v241 offset:40672
  ds_read_b64_tr_b16 v[88:89], v242 offset:35264
  ds_read_b64_tr_b16 v[90:91], v243 offset:35264
  ds_read_b64_tr_b16 v[92:93], v241 offset:35520
  ds_read_b64_tr_b16 v[94:95], v241 offset:40928
  ds_read_b64_tr_b16 v[96:97], v242 offset:35520
  ds_read_b64_tr_b16 v[98:99], v243 offset:35520
  ds_read_b64_tr_b16 v[100:101], v241 offset:35776
  ds_read_b64_tr_b16 v[102:103], v241 offset:41184
  ds_read_b64_tr_b16 v[104:105], v242 offset:35776
  ds_read_b64_tr_b16 v[106:107], v243 offset:35776
  ds_read_b64_tr_b16 v[108:109], v241 offset:36032
  ds_read_b64_tr_b16 v[110:111], v241 offset:41440
  ds_read_b64_tr_b16 v[112:113], v242 offset:36032
  ds_read_b64_tr_b16 v[114:115], v243 offset:36032
  s_waitcnt lgkmcnt(14)
  v_mfma_f32_32x32x16_bf16 v[140:155], v[132:135], v[84:87], 0
  s_waitcnt lgkmcnt(12)
  v_mfma_f32_32x32x16_bf16 v[140:155], v[136:139], v[88:91], v[140:155]
  ds_read_b64_tr_b16 v[116:117], v241 offset:36288
  ds_read_b64_tr_b16 v[118:119], v241 offset:41696
  ds_read_b64_tr_b16 v[120:121], v242 offset:36288
  ds_read_b64_tr_b16 v[122:123], v243 offset:36288
  s_waitcnt lgkmcnt(14)
  v_mfma_f32_32x32x16_bf16 v[156:171], v[132:135], v[92:95], 0
  s_waitcnt lgkmcnt(12)
  v_mfma_f32_32x32x16_bf16 v[156:171], v[136:139], v[96:99], v[156:171]
  ds_read_b64_tr_b16 v[124:125], v241 offset:36544
  ds_read_b64_tr_b16 v[126:127], v241 offset:41952
  ds_read_b64_tr_b16 v[128:129], v242 offset:36544
  ds_read_b64_tr_b16 v[130:131], v243 offset:36544
  s_waitcnt lgkmcnt(14)
  v_mfma_f32_32x32x16_bf16 v[172:187], v[132:135], v[100:103], 0
  s_waitcnt lgkmcnt(12)
  v_mfma_f32_32x32x16_bf16 v[172:187], v[136:139], v[104:107], v[172:187]
  v_cvt_pk_bf16_f32 v81, v140, 0
  s_waitcnt lgkmcnt(10)
  v_mfma_f32_32x32x16_bf16 v[188:203], v[132:135], v[108:111], 0
  s_waitcnt lgkmcnt(8)
  v_mfma_f32_32x32x16_bf16 v[188:203], v[136:139], v[112:115], v[188:203]
  s_mov_b32 exec_lo, 0
  v_cvt_pk_bf16_f32 v81, v156, 0
  s_mov_b32 exec_lo, -1
  ds_write_b16 v68, v81
  s_waitcnt lgkmcnt(7)
  v_mfma_f32_32x32x16_bf16 v[140:155], v[132:135], v[116:119], 0
  s_waitcnt lgkmcnt(5)
  v_mfma_f32_32x32x16_bf16 v[140:155], v[136:139], v[120:123], v[140:155]
  v_cvt_pk_bf16_f32 v82, v172, 0
  s_waitcnt lgkmcnt(3)
  v_mfma_f32_32x32x16_bf16 v[156:171], v[132:135], v[124:127], 0
  s_waitcnt lgkmcnt(1)
  v_mfma_f32_32x32x16_bf16 v[156:171], v[136:139], v[128:131], v[156:171]
  s_mov_b32 exec_lo, 0
  v_cvt_pk_bf16_f32 v82, v188, 0
  s_mov_b32 exec_lo, -1
  ds_write_b16 v69, v82
  s_nop 2
  v_cvt_pk_bf16_f32 v83, v140, 0
  s_mov_b32 exec_lo, 0
  s_nop 2
  v_cvt_pk_bf16_f32 v83, v156, 0
  s_mov_b64 exec, s[92:93]
  ds_write_b16 v70, v83
  s_mov_b64 exec, 0x3ffffff
  ds_write_b16 v80, v45
  s_mov_b64 exec, -1
  s_waitcnt lgkmcnt(0)
  ds_add_u32 v1, v3 offset:32
  v_cmp_gt_u32 s[92:93], 36, v246
L_csync2:
  ds_read_b32 v4, v2 offset:4
  s_waitcnt lgkmcnt(0)
  v_cmp_gt_u32 vcc, 4, v4
  s_cbranch_vccnz L_csync2
  ds_read_b64_tr_b16 v[84:85], v241 offset:0
  ds_read_b64_tr_b16 v[86:87], v241 offset:5408
  ds_read_b64_tr_b16 v[88:89], v242 offset:0
  ds_read_b64_tr_b16 v[90:91], v243 offset:0
  ds_read_b64_tr_b16 v[92:93], v241 offset:256
  ds_read_b64_tr_b16 v[94:95], v241 offset:5664
  ds_read_b64_tr_b16 v[96:97], v242 offset:256
  ds_read_b64_tr_b16 v[98:99], v243 offset:256
  ds_read_b64_tr_b16 v[100:101], v241 offset:512
  ds_read_b64_tr_b16 v[102:103], v241 offset:5920
  ds_read_b64_tr_b16 v[104:105], v242 offset:512
  ds_read_b64_tr_b16 v[106:107], v243 offset:512
  ds_read_b64_tr_b16 v[108:109], v241 offset:768
  ds_read_b64_tr_b16 v[110:111], v241 offset:6176
  ds_read_b64_tr_b16 v[112:113], v242 offset:768
  ds_read_b64_tr_b16 v[114:115], v243 offset:768
  ds_read_b64_tr_b16 v[116:117], v241 offset:1024
  ds_read_b64_tr_b16 v[118:119], v241 offset:6432
  ds_read_b64_tr_b16 v[120:121], v242 offset:1024
  ds_read_b64_tr_b16 v[122:123], v243 offset:1024
  ds_read_b64_tr_b16 v[124:125], v241 offset:1280
  ds_read_b64_tr_b16 v[126:127], v241 offset:6688
  ds_read_b64_tr_b16 v[128:129], v242 offset:1280
  ds_read_b64_tr_b16 v[130:131], v243 offset:1280
L_csync3:
  ds_read_b32 v4, v2 offset:32
  s_waitcnt lgkmcnt(0)
  v_cmp_gt_u32 vcc, 4, v4
  s_cbranch_vccnz L_csync3
  s_setprio 0
  s_waitcnt vmcnt(2)
  v_lshlrev_b32 v208, 7, v208
  buffer_load_dword v255, v208, s[32:35], 0 offen
  s_waitcnt vmcnt(2)
  v_lshlrev_b32 v209, 7, v209
  buffer_load_dword v255, v209, s[32:35], 0 offen
  s_mov_b64 exec, 131071
  buffer_load_dword v255, v19, s[44:47], s101 offen
  s_mov_b64 exec, -1
  s_add_u32 s101, s101, 1171456
  ds_read_b64_tr_b16 v[132:133], v240 offset:0
  ds_read_b64_tr_b16 v[134:135], v240 offset:256
  ds_read_b64_tr_b16 v[136:137], v240 offset:1024
  ds_read_b64_tr_b16 v[138:139], v240 offset:1280
  s_waitcnt lgkmcnt(2)
  v_mfma_f32_32x32x16_bf16 v[140:155], v[132:135], v[84:87], 0
  s_waitcnt lgkmcnt(0)
  v_mfma_f32_32x32x16_bf16 v[140:155], v[136:139], v[88:91], v[140:155]
  v_mfma_f32_32x32x16_bf16 v[156:171], v[132:135], v[92:95], 0
  v_mfma_f32_32x32x16_bf16 v[156:171], v[136:139], v[96:99], v[156:171]
  v_mfma_f32_32x32x16_bf16 v[172:187], v[132:135], v[100:103], 0
  v_mfma_f32_32x32x16_bf16 v[172:187], v[136:139], v[104:107], v[172:187]
  s_nop 7
  v_cvt_pk_bf16_f32 v84, v140, v141
  v_cvt_pk_bf16_f32 v85, v142, v143
  v_cvt_pk_bf16_f32 v86, v144, v145
  v_cvt_pk_bf16_f32 v87, v146, v147
  v_cvt_pk_bf16_f32 v88, v148, v149
  v_cvt_pk_bf16_f32 v89, v150, v151
  v_cvt_pk_bf16_f32 v90, v152, v153
  v_cvt_pk_bf16_f32 v91, v154, v155
  ds_write2_b32 v72, v84, v85 offset0:0 offset1:1
  v_max3_f32 v62, v62, abs(v140), abs(v141)
  v_max3_f32 v62, v62, abs(v142), abs(v143)
  v_max3_f32 v62, v62, abs(v144), abs(v145)
  ds_write2_b32 v72, v86, v87 offset0:4 offset1:5
  v_max3_f32 v62, v62, abs(v146), abs(v147)
  v_max3_f32 v62, v62, abs(v148), abs(v149)
  ds_write2_b32 v72, v88, v89 offset0:8 offset1:9
  v_max3_f32 v62, v62, abs(v150), abs(v151)
  v_max3_f32 v62, v62, abs(v152), abs(v153)
  v_mfma_f32_32x32x16_bf16 v[188:203], v[132:135], v[108:111], 0
  v_mfma_f32_32x32x16_bf16 v[188:203], v[136:139], v[112:115], v[188:203]
  v_cvt_pk_bf16_f32 v92, v156, v157
  v_cvt_pk_bf16_f32 v93, v158, v159
  v_cvt_pk_bf16_f32 v94, v160, v161
  v_cvt_pk_bf16_f32 v95, v162, v163
  v_cvt_pk_bf16_f32 v96, v164, v165
  v_cvt_pk_bf16_f32 v97, v166, v167
  v_cvt_pk_bf16_f32 v98, v168, v169
  v_cvt_pk_bf16_f32 v99, v170, v171
  ds_write2_b32 v73, v92, v93 offset0:0 offset1:1
  v_max3_f32 v62, v62, abs(v156), abs(v157)
  v_max3_f32 v62, v62, abs(v158), abs(v159)
  v_max3_f32 v62, v62, abs(v160), abs(v161)
  ds_write2_b32 v73, v94, v95 offset0:4 offset1:5
  v_max3_f32 v62, v62, abs(v162), abs(v163)
  v_max3_f32 v62, v62, abs(v164), abs(v165)
  ds_write2_b32 v73, v96, v97 offset0:8 offset1:9
  v_max3_f32 v62, v62, abs(v166), abs(v167)
  v_max3_f32 v62, v62, abs(v168), abs(v169)
  v_mfma_f32_32x32x16_bf16 v[140:155], v[132:135], v[116:119], 0
  v_mfma_f32_32x32x16_bf16 v[140:155], v[136:139], v[120:123], v[140:155]
  v_cvt_pk_bf16_f32 v100, v172, v173
  v_cvt_pk_bf16_f32 v101, v174, v175
  v_cvt_pk_bf16_f32 v102, v176, v177
  v_cvt_pk_bf16_f32 v103, v178, v179
  v_cvt_pk_bf16_f32 v104, v180, v181
  v_cvt_pk_bf16_f32 v105, v182, v183
  v_cvt_pk_bf16_f32 v106, v184, v185
  v_cvt_pk_bf16_f32 v107, v186, v187
  ds_write2_b32 v74, v100, v101 offset0:0 offset1:1
  v_max3_f32 v62, v62, abs(v172), abs(v173)
  v_max3_f32 v62, v62, abs(v174), abs(v175)
  v_max3_f32 v62, v62, abs(v176), abs(v177)
  ds_write2_b32 v74, v102, v103 offset0:4 offset1:5
  v_max3_f32 v62, v62, abs(v178), abs(v179)
  v_max3_f32 v62, v62, abs(v180), abs(v181)
  ds_write2_b32 v74, v104, v105 offset0:8 offset1:9
  v_max3_f32 v62, v62, abs(v182), abs(v183)
  v_max3_f32 v62, v62, abs(v184), abs(v185)
  v_mfma_f32_32x32x16_bf16 v[156:171], v[132:135], v[124:127], 0
  v_mfma_f32_32x32x16_bf16 v[156:171], v[136:139], v[128:131], v[156:171]
  v_cvt_pk_bf16_f32 v108, v188, v189
  v_cvt_pk_bf16_f32 v109, v190, v191
  v_cvt_pk_bf16_f32 v110, v192, v193
  v_cvt_pk_bf16_f32 v111, v194, v195
  v_cvt_pk_bf16_f32 v112, v196, v197
  v_cvt_pk_bf16_f32 v113, v198, v199
  v_cvt_pk_bf16_f32 v114, v200, v201
  v_cvt_pk_bf16_f32 v115, v202, v203
  ds_write2_b32 v75, v108, v109 offset0:0 offset1:1
  v_max3_f32 v62, v62, abs(v188), abs(v189)
  v_max3_f32 v62, v62, abs(v190), abs(v191)
  v_max3_f32 v62, v62, abs(v192), abs(v193)
  ds_write2_b32 v75, v110, v111 offset0:4 offset1:5
  v_max3_f32 v62, v62, abs(v194), abs(v195)
  v_max3_f32 v62, v62, abs(v196), abs(v197)
  ds_write2_b32 v75, v112, v113 offset0:8 offset1:9
  v_max3_f32 v62, v62, abs(v198), abs(v199)
  v_max3_f32 v62, v62, abs(v200), abs(v201)
  v_cvt_pk_bf16_f32 v116, v140, v141
  v_cvt_pk_bf16_f32 v117, v142, v143
  v_cvt_pk_bf16_f32 v118, v144, v145
  v_cvt_pk_bf16_f32 v119, v146, v147
  v_cvt_pk_bf16_f32 v120, v148, v149
  v_cvt_pk_bf16_f32 v121, v150, v151
  v_cvt_pk_bf16_f32 v122, v152, v153
  v_cvt_pk_bf16_f32 v123, v154, v155
  ds_write2_b32 v76, v116, v117 offset0:0 offset1:1
  v_max3_f32 v62, v62, abs(v140), abs(v141)
  v_max3_f32 v62, v62, abs(v142), abs(v143)
  v_max3_f32 v62, v62, abs(v144), abs(v145)
  ds_write2_b32 v76, v118, v119 offset0:4 offset1:5
  v_max3_f32 v62, v62, abs(v146), abs(v147)
  v_max3_f32 v62, v62, abs(v148), abs(v149)
  ds_write2_b32 v76, v120, v121 offset0:8 offset1:9
  v_max3_f32 v62, v62, abs(v150), abs(v151)
  v_max3_f32 v62, v62, abs(v152), abs(v153)
  v_cvt_pk_bf16_f32 v124, v156, v157
  v_cvt_pk_bf16_f32 v125, v158, v159
  v_cvt_pk_bf16_f32 v126, v160, v161
  v_cvt_pk_bf16_f32 v127, v162, v163
  v_cvt_pk_bf16_f32 v128, v164, v165
  v_cvt_pk_bf16_f32 v129, v166, v167
  v_cvt_pk_bf16_f32 v130, v168, v169
  v_cvt_pk_bf16_f32 v131, v170, v171
  s_mov_b64 exec, s[92:93]
  ds_write2_b32 v77, v124, v125 offset0:0 offset1:1
  v_max3_f32 v62, v62, abs(v156), abs(v157)
  v_max3_f32 v62, v62, abs(v158), abs(v159)
  v_max3_f32 v62, v62, abs(v160), abs(v161)
  ds_write2_b32 v77, v126, v127 offset0:4 offset1:5
  v_max3_f32 v62, v62, abs(v162), abs(v163)
  v_max3_f32 v62, v62, abs(v164), abs(v165)
  ds_write2_b32 v77, v128, v129 offset0:8 offset1:9
  v_max3_f32 v62, v62, abs(v166), abs(v167)
  v_max3_f32 v62, v62, abs(v168), abs(v169)
  s_mov_b32 exec_hi, 0
  ds_write_b32 v77, v130 offset:48
  ds_write_b16 v245, v131 offset:1280
  s_mov_b32 exec_lo, -1
  ds_write_b32 v76, v122 offset:48
  ds_write_b16 v245, v123 offset:1024
  ds_write_b32 v75, v114 offset:48
  ds_write_b16 v245, v115 offset:768
  ds_write_b32 v74, v106 offset:48
  ds_write_b16 v245, v107 offset:512
  ds_write_b32 v73, v98 offset:48
  ds_write_b16 v245, v99 offset:256
  ds_write_b32 v72, v90 offset:48
  ds_write_b16 v245, v91 offset:0
  s_mov_b64 exec, -1
  v_max_u32_dpp v62, v62, v62 row_shr:1 row_mask:0xf bank_mask:0xf
  s_nop 1
  v_max_u32_dpp v62, v62, v62 row_shr:2 row_mask:0xf bank_mask:0xf
  s_nop 1
  v_max_u32_dpp v62, v62, v62 row_shr:4 row_mask:0xf bank_mask:0xf
  s_nop 1
  v_max_u32_dpp v62, v62, v62 row_shr:8 row_mask:0xf bank_mask:0xf
  s_nop 1
  v_max_u32_dpp v62, v62, v62 row_bcast:15 row_mask:0xa bank_mask:0xf
  s_nop 1
  v_max_u32_dpp v62, v62, v62 row_bcast:31 row_mask:0xc bank_mask:0xf
  s_nop 0
  v_readlane_b32 s68, v62, 63
  s_nop 1
  v_mov_b32 v62, s68
  ds_max_u32 v1, v62 offset:28
  ds_add_u32 v1, v3 offset:24
  s_setprio 0
  v_lshl_add_u32 v24, v24, 7, v18
  v_lshl_add_u32 v25, v25, 7, v18
  s_mov_b32 exec_hi, 0x0000ffff
  v_lshl_add_u32 v26, v26, 7, v18
  v_lshl_add_u32 v27, v27, 7, v18
  s_mov_b32 exec_lo, 0
  s_mov_b32 exec_hi, 0xffff0000
  v_mov_b32 v27, v25
  v_mov_b32 v26, v25
  s_mov_b32 exec_hi, 0x00ff0000
  v_mov_b32 v26, v24
  s_mov_b64 exec, -1
  s_add_u32 m0, s74, 0
  s_nop 0
  buffer_load_dwordx4 v24, s[32:35], 0 offen lds
  s_add_u32 m0, s74, 1056
  s_nop 0
  buffer_load_dwordx4 v25, s[32:35], 0 offen lds
  s_add_u32 m0, s74, 2112
  s_nop 0
  buffer_load_dwordx4 v26, s[32:35], 0 offen lds
  s_add_u32 m0, s74, 3168
  s_mov_b32 exec_hi, 0x00ffffff
  buffer_load_dwordx4 v27, s[32:35], 0 offen lds
  s_mov_b32 exec_hi, -1
  v_lshl_add_u32 v204, v204, 7, v18
  v_lshl_add_u32 v205, v205, 7, v18
  s_mov_b32 exec_hi, 0x0000ffff
  v_lshl_add_u32 v206, v206, 7, v18
  v_lshl_add_u32 v207, v207, 7, v18
  s_mov_b32 exec_lo, 0
  s_mov_b32 exec_hi, 0xffff0000
  v_mov_b32 v207, v205
  v_mov_b32 v206, v205
  s_mov_b32 exec_hi, 0x00ff0000
  v_mov_b32 v206, v204
  s_mov_b64 exec, -1
  s_add_u32 m0, s74, -16896
  s_nop 0
  buffer_load_dwordx4 v204, s[32:35], 0 offen lds
  s_add_u32 m0, s74, -15840
  s_nop 0
  buffer_load_dwordx4 v205, s[32:35], 0 offen lds
  s_add_u32 m0, s74, -14784
  s_nop 0
  buffer_load_dwordx4 v206, s[32:35], 0 offen lds
  s_add_u32 m0, s74, -13728
  s_mov_b32 exec_hi, 0x00ffffff
  buffer_load_dwordx4 v207, s[32:35], 0 offen lds
  s_mov_b32 exec_hi, -1
  buffer_load_dwordx4 v[24:27], v17, s[28:31], s94 offen offset:0
  s_add_u32 s94, s94, 832
  s_branch L_uph
L_g0pf:
  s_add_u32 s94, s94, 832
  s_add_u32 s77, s77, 24
  buffer_load_dwordx4 v[24:27], v17, s[28:31], s94 offen offset:0
  s_add_u32 s94, s94, 832
  buffer_load_dword v21, v20, s[28:31], s77 offen
  s_cmp_eq_u32 s77, s73
  s_cselect_b32 s73, 0x7000000, s73
  s_cselect_b32 s77, 0x7000000, s77
  s_add_u32 s77, s77, 24
  s_min_u32 s77, s77, s73
  s_mov_b64 exec, 131071
  buffer_load_dword v255, v19, s[44:47], s101 offen
  s_mov_b64 exec, -1
  s_add_u32 s101, s101, 1171456
  s_waitcnt vmcnt(3) lgkmcnt(0)
  ds_add_u32 v1, v3 offset:8
  s_mov_b32 s97, 0
L_csync4:
  ds_read_b32 v4, v2 offset:8
  s_waitcnt lgkmcnt(0)
  v_cmp_gt_u32 vcc, 4, v4
  s_cbranch_vccnz L_csync4
  s_cmp_ge_u32 s79, 2
  s_cbranch_scc1 L_chunk2
L_chunk0:
  ds_read_u16_d16_hi v216, v49 offset:0
  ds_read_u16_d16_hi v218, v49 offset:648
  ds_read_u16_d16_hi v220, v49 offset:216
  ds_read_u16_d16_hi v222, v49 offset:864
  ds_read_u16_d16_hi v224, v49 offset:432
  ds_read_u16_d16_hi v226, v49 offset:1080
  ds_read_u16_d16_hi v228, v49 offset:8
  ds_read_u16_d16_hi v229, v49 offset:208
  ds_read_u16_d16_hi v230, v49 offset:656
  ds_read_u16_d16_hi v231, v49 offset:856
  ds_read_u16_d16_hi v232, v49 offset:32
  ds_read_u16_d16_hi v233, v49 offset:832
  ds_read_u16_d16_hi v234, v49 offset:632
  ds_read_u16_d16_hi v235, v49 offset:232
  s_waitcnt lgkmcnt(12)
  v_mov_b32 v85, v218
  v_mov_b32 v84, v216
  v_max3_f32 v62, v62, abs(v84), abs(v85)
  ds_read_u16_d16_hi v236, v49 offset:16
  ds_read_u16_d16_hi v237, v49 offset:416
  ds_read_u16_d16_hi v238, v49 offset:664
  ds_read_u16_d16_hi v239, v49 offset:1064
  s_waitcnt lgkmcnt(14)
  v_mov_b32 v87, v222
  v_mov_b32 v86, v220
  v_max3_f32 v62, v62, abs(v86), abs(v87)
  ds_read_u16_d16_hi v216, v49 offset:40
  ds_read_u16_d16_hi v217, v49 offset:1040
  ds_read_u16_d16_hi v218, v49 offset:640
  ds_read_u16_d16_hi v219, v49 offset:440
  s_waitcnt lgkmcnt(14)
  v_mov_b32 v89, v226
  v_mov_b32 v88, v224
  v_max3_f32 v62, v62, abs(v88), abs(v89)
  ds_read_u16_d16_hi v220, v49 offset:224
  ds_read_u16_d16_hi v221, v49 offset:424
  ds_read_u16_d16_hi v222, v49 offset:872
  ds_read_u16_d16_hi v223, v49 offset:1072
  s_waitcnt lgkmcnt(14)
  v_add_f32 v91, v230, v231
  v_add_f32 v90, v228, v229
  v_max3_f32 v62, v62, abs(v90), abs(v91)
  ds_read_u16_d16_hi v224, v49 offset:248
  ds_read_u16_d16_hi v225, v49 offset:1048
  ds_read_u16_d16_hi v226, v49 offset:848
  ds_read_u16_d16_hi v227, v49 offset:448
  s_waitcnt lgkmcnt(14)
  v_add_f32 v93, v234, v235
  v_add_f32 v92, v232, v233
  v_max3_f32 v62, v62, abs(v92), abs(v93)
  ds_read_u16_d16_hi v228, v50 offset:48
  ds_read_u16_d16_hi v229, v51 offset:1248
  ds_read_u16_d16_hi v230, v50 offset:672
  ds_read_u16_d16_hi v231, v51 offset:1272
  s_waitcnt lgkmcnt(14)
  v_add_f32 v95, v238, v239
  v_add_f32 v94, v236, v237
  v_max3_f32 v62, v62, abs(v94), abs(v95)
  ds_read_u16_d16_hi v232, v50 offset:256
  ds_read_u16_d16_hi v233, v51 offset:1256
  ds_read_u16_d16_hi v234, v50 offset:880
  ds_read_u16_d16_hi v235, v51 offset:1280
  s_waitcnt lgkmcnt(14)
  v_add_f32 v97, v218, v219
  v_add_f32 v96, v216, v217
  v_max3_f32 v62, v62, abs(v96), abs(v97)
  ds_read_u16_d16_hi v236, v50 offset:464
  ds_read_u16_d16_hi v237, v51 offset:1264
  ds_read_u16_d16_hi v238, v50 offset:1088
  ds_read_u16_d16_hi v239, v51 offset:1288
  s_waitcnt lgkmcnt(14)
  v_add_f32 v99, v222, v223
  v_add_f32 v98, v220, v221
  v_max3_f32 v62, v62, abs(v98), abs(v99)
  s_waitcnt lgkmcnt(12)
  v_add_f32 v101, v226, v227
  v_add_f32 v100, v224, v225
  v_max3_f32 v62, v62, abs(v100), abs(v101)
  s_waitcnt lgkmcnt(8)
  v_add_f32 v103, v230, v231
  v_add_f32 v102, v228, v229
  v_max3_f32 v62, v62, abs(v102), abs(v103)
  s_waitcnt lgkmcnt(4)
  v_add_f32 v105, v234, v235
  v_add_f32 v104, v232, v233
  v_max3_f32 v62, v62, abs(v104), abs(v105)
  s_waitcnt lgkmcnt(0)
  v_add_f32 v107, v238, v239
  v_add_f32 v106, v236, v237
  v_max3_f32 v62, v62, abs(v106), abs(v107)
  s_cmp_lg_u32 s97, 0
  s_cbranch_scc1 L_uconv0
L_chunk1:
  ds_read_u16_d16_hi v216, v49 offset:24
  ds_read_u16_d16_hi v217, v49 offset:624
  ds_read_u16_d16_hi v218, v49 offset:240
  ds_read_u16_d16_hi v219, v49 offset:840
  ds_read_u16_d16_hi v220, v49 offset:456
  ds_read_u16_d16_hi v221, v49 offset:1056
  ds_read_u16_d16_hi v222, v60 offset:1296
  ds_read_u16_d16_hi v223, v61 offset:1296
  ds_read_u16_d16_hi v224, v52 offset:50
  ds_read_u16_d16_hi v225, v53 offset:1300
  ds_read_u16_d16_hi v226, v52 offset:674
  ds_read_u16_d16_hi v227, v53 offset:1324
  ds_read_u16_d16_hi v228, v52 offset:258
  ds_read_u16_d16_hi v229, v53 offset:1308
  ds_read_u16_d16_hi v230, v52 offset:882
  ds_read_u16_d16_hi v231, v53 offset:1332
  ds_read_u16_d16_hi v232, v52 offset:466
  ds_read_u16_d16_hi v233, v53 offset:1316
  ds_read_u16_d16_hi v234, v52 offset:1090
  ds_read_u16_d16_hi v235, v53 offset:1340
  s_waitcnt lgkmcnt(14)
  v_add_f32 v109, v218, v219
  v_add_f32 v108, v216, v217
  v_max3_f32 v62, v62, abs(v108), abs(v109)
  ds_read_u16_d16_hi v236, v54 offset:2
  ds_read_u16_d16_hi v237, v55 offset:52
  ds_read_u16_d16_hi v238, v54 offset:650
  ds_read_u16_d16_hi v239, v55 offset:700
  s_waitcnt lgkmcnt(14)
  v_add_f32 v111, v222, v223
  v_add_f32 v110, v220, v221
  v_max3_f32 v62, v62, abs(v110), abs(v111)
  ds_read_u16_d16_hi v216, v54 offset:26
  ds_read_u16_d16_hi v217, v55 offset:676
  ds_read_u16_d16_hi v218, v54 offset:626
  ds_read_u16_d16_hi v219, v55 offset:76
  s_waitcnt lgkmcnt(14)
  v_add_f32 v113, v226, v227
  v_add_f32 v112, v224, v225
  v_max3_f32 v62, v62, abs(v112), abs(v113)
  ds_read_u16_d16_hi v220, v54 offset:10
  ds_read_u16_d16_hi v221, v55 offset:260
  ds_read_u16_d16_hi v222, v54 offset:658
  ds_read_u16_d16_hi v223, v55 offset:908
  s_waitcnt lgkmcnt(14)
  v_add_f32 v115, v230, v231
  v_add_f32 v114, v228, v229
  v_max3_f32 v62, v62, abs(v114), abs(v115)
  ds_read_u16_d16_hi v224, v54 offset:34
  ds_read_u16_d16_hi v225, v55 offset:884
  ds_read_u16_d16_hi v226, v54 offset:634
  ds_read_u16_d16_hi v227, v55 offset:284
  s_waitcnt lgkmcnt(14)
  v_add_f32 v117, v234, v235
  v_add_f32 v116, v232, v233
  v_max3_f32 v62, v62, abs(v116), abs(v117)
  ds_read_u16_d16_hi v228, v54 offset:18
  ds_read_u16_d16_hi v229, v55 offset:468
  ds_read_u16_d16_hi v230, v54 offset:666
  ds_read_u16_d16_hi v231, v55 offset:1116
  s_waitcnt lgkmcnt(14)
  v_add_f32 v119, v238, v239
  v_add_f32 v118, v236, v237
  v_max3_f32 v62, v62, abs(v118), abs(v119)
  ds_read_u16_d16_hi v232, v54 offset:42
  ds_read_u16_d16_hi v233, v55 offset:1092
  ds_read_u16_d16_hi v234, v54 offset:642
  ds_read_u16_d16_hi v235, v55 offset:492
  s_waitcnt lgkmcnt(14)
  v_add_f32 v121, v218, v219
  v_add_f32 v120, v216, v217
  v_max3_f32 v62, v62, abs(v120), abs(v121)
  ds_read_u16_d16_hi v236, v54 offset:210
  ds_read_u16_d16_hi v237, v55 offset:60
  ds_read_u16_d16_hi v238, v54 offset:858
  ds_read_u16_d16_hi v239, v55 offset:708
  s_waitcnt lgkmcnt(14)
  v_add_f32 v123, v222, v223
  v_add_f32 v122, v220, v221
  v_max3_f32 v62, v62, abs(v122), abs(v123)
  s_waitcnt lgkmcnt(12)
  v_add_f32 v125, v226, v227
  v_add_f32 v124, v224, v225
  v_max3_f32 v62, v62, abs(v124), abs(v125)
  s_waitcnt lgkmcnt(8)
  v_add_f32 v127, v230, v231
  v_add_f32 v126, v228, v229
  v_max3_f32 v62, v62, abs(v126), abs(v127)
  s_waitcnt lgkmcnt(4)
  v_add_f32 v129, v234, v235
  v_add_f32 v128, v232, v233
  v_max3_f32 v62, v62, abs(v128), abs(v129)
  s_waitcnt lgkmcnt(0)
  v_add_f32 v131, v238, v239
  v_add_f32 v130, v236, v237
  v_max3_f32 v62, v62, abs(v130), abs(v131)
  s_cmp_lg_u32 s97, 0
  s_cbranch_scc1 L_uconv1
  s_branch L_w1conv
L_chunk2:
  ds_read_u16_d16_hi v216, v54 offset:234
  ds_read_u16_d16_hi v217, v55 offset:684
  ds_read_u16_d16_hi v218, v54 offset:834
  ds_read_u16_d16_hi v219, v55 offset:84
  ds_read_u16_d16_hi v220, v54 offset:218
  ds_read_u16_d16_hi v221, v55 offset:268
  ds_read_u16_d16_hi v222, v54 offset:866
  ds_read_u16_d16_hi v223, v55 offset:916
  ds_read_u16_d16_hi v224, v54 offset:242
  ds_read_u16_d16_hi v225, v55 offset:892
  ds_read_u16_d16_hi v226, v54 offset:842
  ds_read_u16_d16_hi v227, v55 offset:292
  ds_read_u16_d16_hi v228, v54 offset:226
  ds_read_u16_d16_hi v229, v55 offset:476
  ds_read_u16_d16_hi v230, v54 offset:874
  ds_read_u16_d16_hi v231, v55 offset:1124
  ds_read_u16_d16_hi v232, v54 offset:250
  ds_read_u16_d16_hi v233, v55 offset:1100
  ds_read_u16_d16_hi v234, v54 offset:850
  ds_read_u16_d16_hi v235, v55 offset:500
  s_waitcnt lgkmcnt(14)
  v_add_f32 v85, v218, v219
  v_add_f32 v84, v216, v217
  v_max3_f32 v62, v62, abs(v84), abs(v85)
  ds_read_u16_d16_hi v236, v54 offset:418
  ds_read_u16_d16_hi v237, v55 offset:68
  ds_read_u16_d16_hi v238, v54 offset:1066
  ds_read_u16_d16_hi v239, v55 offset:716
  s_waitcnt lgkmcnt(14)
  v_add_f32 v87, v222, v223
  v_add_f32 v86, v220, v221
  v_max3_f32 v62, v62, abs(v86), abs(v87)
  ds_read_u16_d16_hi v216, v54 offset:442
  ds_read_u16_d16_hi v217, v55 offset:692
  ds_read_u16_d16_hi v218, v54 offset:1042
  ds_read_u16_d16_hi v219, v55 offset:92
  s_waitcnt lgkmcnt(14)
  v_add_f32 v89, v226, v227
  v_add_f32 v88, v224, v225
  v_max3_f32 v62, v62, abs(v88), abs(v89)
  ds_read_u16_d16_hi v220, v54 offset:426
  ds_read_u16_d16_hi v221, v55 offset:276
  ds_read_u16_d16_hi v222, v54 offset:1074
  ds_read_u16_d16_hi v223, v55 offset:924
  s_waitcnt lgkmcnt(14)
  v_add_f32 v91, v230, v231
  v_add_f32 v90, v228, v229
  v_max3_f32 v62, v62, abs(v90), abs(v91)
  ds_read_u16_d16_hi v224, v54 offset:450
  ds_read_u16_d16_hi v225, v55 offset:900
  ds_read_u16_d16_hi v226, v54 offset:1050
  ds_read_u16_d16_hi v227, v55 offset:300
  s_waitcnt lgkmcnt(14)
  v_add_f32 v93, v234, v235
  v_add_f32 v92, v232, v233
  v_max3_f32 v62, v62, abs(v92), abs(v93)
  ds_read_u16_d16_hi v228, v54 offset:434
  ds_read_u16_d16_hi v229, v55 offset:484
  ds_read_u16_d16_hi v230, v54 offset:1082
  ds_read_u16_d16_hi v231, v55 offset:1132
  s_waitcnt lgkmcnt(14)
  v_add_f32 v95, v238, v239
  v_add_f32 v94, v236, v237
  v_max3_f32 v62, v62, abs(v94), abs(v95)
  ds_read_u16_d16_hi v232, v54 offset:458
  ds_read_u16_d16_hi v233, v55 offset:1108
  ds_read_u16_d16_hi v234, v54 offset:1058
  ds_read_u16_d16_hi v235, v55 offset:508
  s_waitcnt lgkmcnt(14)
  v_add_f32 v97, v218, v219
  v_add_f32 v96, v216, v217
  v_max3_f32 v62, v62, abs(v96), abs(v97)
  ds_read_u16_d16_hi v236, v56 offset:4
  ds_read_u16_d16_hi v237, v57 offset:104
  ds_read_u16_d16_hi v238, v58 offset:652
  ds_read_u16_d16_hi v239, v59 offset:752
  s_waitcnt lgkmcnt(14)
  v_add_f32 v99, v222, v223
  v_add_f32 v98, v220, v221
  v_max3_f32 v62, v62, abs(v98), abs(v99)
  s_waitcnt lgkmcnt(12)
  v_add_f32 v101, v226, v227
  v_add_f32 v100, v224, v225
  v_max3_f32 v62, v62, abs(v100), abs(v101)
  s_waitcnt lgkmcnt(8)
  v_add_f32 v103, v230, v231
  v_add_f32 v102, v228, v229
  v_max3_f32 v62, v62, abs(v102), abs(v103)
  s_waitcnt lgkmcnt(4)
  v_add_f32 v105, v234, v235
  v_add_f32 v104, v232, v233
  v_max3_f32 v62, v62, abs(v104), abs(v105)
  s_waitcnt lgkmcnt(0)
  v_add_f32 v107, v238, v239
  v_add_f32 v106, v236, v237
  v_max3_f32 v62, v62, abs(v106), abs(v107)
  s_cmp_lg_u32 s97, 0
  s_cbranch_scc1 L_uconv0
L_chunk3:
  ds_read_u16_d16_hi v216, v56 offset:220
  ds_read_u16_d16_hi v217, v57 offset:320
  ds_read_u16_d16_hi v218, v58 offset:868
  ds_read_u16_d16_hi v219, v59 offset:968
  ds_read_u16_d16_hi v220, v56 offset:436
  ds_read_u16_d16_hi v221, v57 offset:536
  ds_read_u16_d16_hi v222, v58 offset:1084
  ds_read_u16_d16_hi v223, v59 offset:1184
  ds_read_u16_d16_hi v224, v56 offset:12
  ds_read_u16_d16_hi v225, v57 offset:312
  ds_read_u16_d16_hi v226, v58 offset:660
  ds_read_u16_d16_hi v227, v59 offset:960
  ds_read_u16_d16_hi v228, v58 offset:36
  ds_read_u16_d16_hi v229, v59 offset:936
  ds_read_u16_d16_hi v230, v56 offset:636
  ds_read_u16_d16_hi v231, v57 offset:336
  ds_read_u16_d16_hi v232, v56 offset:20
  ds_read_u16_d16_hi v233, v57 offset:520
  ds_read_u16_d16_hi v234, v58 offset:668
  ds_read_u16_d16_hi v235, v59 offset:1168
  s_waitcnt lgkmcnt(14)
  v_add_f32 v109, v218, v219
  v_add_f32 v108, v216, v217
  v_max3_f32 v62, v62, abs(v108), abs(v109)
  ds_read_u16_d16_hi v236, v58 offset:44
  ds_read_u16_d16_hi v237, v59 offset:1144
  ds_read_u16_d16_hi v238, v56 offset:644
  ds_read_u16_d16_hi v239, v57 offset:544
  s_waitcnt lgkmcnt(14)
  v_add_f32 v111, v222, v223
  v_add_f32 v110, v220, v221
  v_max3_f32 v62, v62, abs(v110), abs(v111)
  ds_read_u16_d16_hi v216, v56 offset:228
  ds_read_u16_d16_hi v217, v57 offset:528
  ds_read_u16_d16_hi v218, v58 offset:876
  ds_read_u16_d16_hi v219, v59 offset:1176
  s_waitcnt lgkmcnt(14)
  v_add_f32 v113, v226, v227
  v_add_f32 v112, v224, v225
  v_max3_f32 v62, v62, abs(v112), abs(v113)
  ds_read_u16_d16_hi v220, v58 offset:252
  ds_read_u16_d16_hi v221, v59 offset:1152
  ds_read_u16_d16_hi v222, v56 offset:852
  ds_read_u16_d16_hi v223, v57 offset:552
  s_waitcnt lgkmcnt(14)
  v_add_f32 v115, v230, v231
  v_add_f32 v114, v228, v229
  v_max3_f32 v62, v62, abs(v114), abs(v115)
  ds_read_u16_d16_hi v224, v65 offset:0
  ds_read_u16_d16_hi v225, v65 offset:8
  ds_read_u16_d16_hi v226, v65 offset:16
  ds_read_u16_d16_hi v227, v65 offset:24
  ds_read_u16_d16_hi v228, v65 offset:32
  ds_read_u16_d16_hi v229, v65 offset:40
  ds_read_u16_d16_hi v230, v64 offset:48
  ds_read_u16_d16_hi v231, v67
  s_waitcnt lgkmcnt(14)
  v_add_f32 v117, v234, v235
  v_add_f32 v116, v232, v233
  v_max3_f32 v62, v62, abs(v116), abs(v117)
  v_add_f32 v119, v238, v239
  v_add_f32 v118, v236, v237
  v_max3_f32 v62, v62, abs(v118), abs(v119)
  s_waitcnt lgkmcnt(12)
  v_add_f32 v121, v218, v219
  v_add_f32 v120, v216, v217
  v_max3_f32 v62, v62, abs(v120), abs(v121)
  s_waitcnt lgkmcnt(8)
  v_add_f32 v123, v222, v223
  v_add_f32 v122, v220, v221
  v_max3_f32 v62, v62, abs(v122), abs(v123)
  s_cmp_lg_u32 s97, 0
  s_cbranch_scc1 L_uconv1
L_w1conv:
  v_max_u32_dpp v62, v62, v62 row_shr:1 row_mask:0xf bank_mask:0xf
  s_nop 1
  v_max_u32_dpp v62, v62, v62 row_shr:2 row_mask:0xf bank_mask:0xf
  s_nop 1
  v_max_u32_dpp v62, v62, v62 row_shr:4 row_mask:0xf bank_mask:0xf
  s_nop 1
  v_max_u32_dpp v62, v62, v62 row_shr:8 row_mask:0xf bank_mask:0xf
  s_nop 1
  v_max_u32_dpp v62, v62, v62 row_bcast:15 row_mask:0xa bank_mask:0xf
  s_nop 1
  v_max_u32_dpp v62, v62, v62 row_bcast:31 row_mask:0xc bank_mask:0xf
  s_nop 0
  v_readlane_b32 s68, v62, 63
  s_nop 1
  v_mov_b32 v62, s68
  ds_max_u32 v1, v62 offset:20
  ds_add_u32 v1, v3 offset:16
  v_add_u32 v49, v49, v247
  v_add_u32 v50, v50, v247
  v_add_u32 v51, v51, v247
  v_add_u32 v52, v52, v247
  v_add_u32 v53, v53, v247
  v_add_u32 v54, v54, v247
  v_add_u32 v55, v55, v247
  v_add_u32 v56, v56, v247
  v_add_u32 v57, v57, v247
  v_add_u32 v58, v58, v247
  v_add_u32 v59, v59, v247
  v_add_u32 v60, v60, v247
  v_add_u32 v61, v61, v247
L_csync5:
  ds_read_b64 v[40:41], v2 offset:16
  s_waitcnt lgkmcnt(0)
  v_cmp_gt_u32 vcc, 4, v40
  s_cbranch_vccnz L_csync5
  v_readfirstlane_b32 s70, v41
  s_nop 0
  s_lshr_b32 s70, s70, 23
  s_sub_i32 s70, 141, s70
  s_min_i32 s70, s70, 40
  s_add_i32 s51, s70, 127
  s_lshl_b32 s51, s51, 23
  v_fma_mixlo_f16 v132, v84, s51, 0
  v_fma_mixlo_f16 v133, v86, s51, 0
  v_fma_mixlo_f16 v134, v88, s51, 0
  v_fma_mixlo_f16 v135, v90, s51, 0
  v_fma_mixhi_f16 v132, v85, s51, 0
  v_fma_mixhi_f16 v133, v87, s51, 0
  v_fma_mixhi_f16 v134, v89, s51, 0
  v_fma_mixhi_f16 v135, v91, s51, 0
  v_fma_mixlo_f16 v136, v92, s51, 0
  v_fma_mixlo_f16 v137, v94, s51, 0
  v_fma_mixlo_f16 v138, v96, s51, 0
  v_fma_mixlo_f16 v139, v98, s51, 0
  v_fma_mixhi_f16 v136, v93, s51, 0
  v_fma_mixhi_f16 v137, v95, s51, 0
  v_fma_mixhi_f16 v138, v97, s51, 0
  v_fma_mixhi_f16 v139, v99, s51, 0
  ds_write_b128 v63, v[132:135] offset:0
  v_fma_mixlo_f16 v140, v100, s51, 0
  v_fma_mixlo_f16 v141, v102, s51, 0
  v_fma_mixlo_f16 v142, v104, s51, 0
  v_fma_mixlo_f16 v143, v106, s51, 0
  v_fma_mixhi_f16 v140, v101, s51, 0
  v_fma_mixhi_f16 v141, v103, s51, 0
  v_fma_mixhi_f16 v142, v105, s51, 0
  v_fma_mixhi_f16 v143, v107, s51, 0
  ds_write_b128 v63, v[136:139] offset:1024
  v_fma_mixlo_f16 v144, v108, s51, 0
  v_fma_mixlo_f16 v145, v110, s51, 0
  v_fma_mixlo_f16 v146, v112, s51, 0
  v_fma_mixlo_f16 v147, v114, s51, 0
  v_fma_mixhi_f16 v144, v109, s51, 0
  v_fma_mixhi_f16 v145, v111, s51, 0
  v_fma_mixhi_f16 v146, v113, s51, 0
  v_fma_mixhi_f16 v147, v115, s51, 0
  ds_write_b128 v63, v[140:143] offset:2048
  v_fma_mixlo_f16 v148, v116, s51, 0
  v_fma_mixlo_f16 v149, v118, s51, 0
  v_fma_mixlo_f16 v150, v120, s51, 0
  v_fma_mixlo_f16 v151, v122, s51, 0
  v_fma_mixhi_f16 v148, v117, s51, 0
  v_fma_mixhi_f16 v149, v119, s51, 0
  v_fma_mixhi_f16 v150, v121, s51, 0
  v_fma_mixhi_f16 v151, v123, s51, 0
  ds_write_b128 v63, v[144:147] offset:3072
  ds_write_b128 v63, v[148:151] offset:4096
  s_cmp_ge_u32 s79, 2
  s_cbranch_scc1 L_w1x
  v_fma_mixlo_f16 v152, v124, s51, 0
  v_fma_mixlo_f16 v153, v126, s51, 0
  v_fma_mixlo_f16 v154, v128, s51, 0
  v_fma_mixlo_f16 v155, v130, s51, 0
  v_fma_mixhi_f16 v152, v125, s51, 0
  v_fma_mixhi_f16 v153, v127, s51, 0
  v_fma_mixhi_f16 v154, v129, s51, 0
  v_fma_mixhi_f16 v155, v131, s51, 0
  ds_write_b128 v63, v[152:155] offset:5120
L_w1x:
L_uph:
L_csync6:
  ds_read_b64 v[40:41], v2 offset:24
  s_waitcnt lgkmcnt(0)
  v_cmp_gt_u32 vcc, 4, v40
  s_cbranch_vccnz L_csync6
  v_readfirstlane_b32 s71, v41
  s_nop 0
  s_lshr_b32 s71, s71, 23
  s_sub_i32 s71, 140, s71
  s_min_i32 s71, s71, 40
  s_add_i32 s51, s71, 127
  s_lshl_b32 s51, s51, 23
  s_mov_b32 s97, 1
  s_lshr_b32 s69, s3, 1
  s_cmp_eq_u32 s69, 0
  s_cbranch_scc1 L_chunk0
  s_cmp_eq_u32 s69, 1
  s_cbranch_scc1 L_chunk1
  s_cmp_eq_u32 s69, 2
  s_cbranch_scc1 L_chunk2
  s_branch L_chunk3
L_uconv0:
  v_fma_mixlo_f16 v132, v84, s51, 0
  v_fma_mixlo_f16 v133, v86, s51, 0
  v_fma_mixlo_f16 v134, v88, s51, 0
  v_fma_mixlo_f16 v135, v90, s51, 0
  v_fma_mixhi_f16 v132, v85, s51, 0
  v_fma_mixhi_f16 v133, v87, s51, 0
  v_fma_mixhi_f16 v134, v89, s51, 0
  v_fma_mixhi_f16 v135, v91, s51, 0
L_csync7:
  ds_read_b64 v[40:41], v2 offset:16
  s_waitcnt lgkmcnt(0)
  v_cmp_gt_u32 vcc, 4, v40
  s_cbranch_vccnz L_csync7
  v_readfirstlane_b32 s70, v41
  s_nop 0
  s_lshr_b32 s70, s70, 23
  s_sub_i32 s70, 141, s70
  s_min_i32 s70, s70, 40
  ds_write_b128 v66, v[132:135] offset:0
  v_fma_mixlo_f16 v136, v92, s51, 0
  v_fma_mixlo_f16 v137, v94, s51, 0
  v_fma_mixlo_f16 v138, v96, s51, 0
  v_fma_mixlo_f16 v139, v98, s51, 0
  v_fma_mixhi_f16 v136, v93, s51, 0
  v_fma_mixhi_f16 v137, v95, s51, 0
  v_fma_mixhi_f16 v138, v97, s51, 0
  v_fma_mixhi_f16 v139, v99, s51, 0
  ds_write_b128 v66, v[136:139] offset:1024
  v_fma_mixlo_f16 v140, v100, s51, 0
  v_fma_mixlo_f16 v141, v102, s51, 0
  v_fma_mixlo_f16 v142, v104, s51, 0
  v_fma_mixlo_f16 v143, v106, s51, 0
  v_fma_mixhi_f16 v140, v101, s51, 0
  v_fma_mixhi_f16 v141, v103, s51, 0
  v_fma_mixhi_f16 v142, v105, s51, 0
  v_fma_mixhi_f16 v143, v107, s51, 0
  ds_write_b128 v66, v[140:143] offset:2048
  s_branch L_built
L_uconv1:
  v_fma_mixlo_f16 v144, v108, s51, 0
  v_fma_mixlo_f16 v145, v110, s51, 0
  v_fma_mixlo_f16 v146, v112, s51, 0
  v_fma_mixlo_f16 v147, v114, s51, 0
  v_fma_mixhi_f16 v144, v109, s51, 0
  v_fma_mixhi_f16 v145, v111, s51, 0
  v_fma_mixhi_f16 v146, v113, s51, 0
  v_fma_mixhi_f16 v147, v115, s51, 0
L_csync8:
  ds_read_b64 v[40:41], v2 offset:16
  s_waitcnt lgkmcnt(0)
  v_cmp_gt_u32 vcc, 4, v40
  s_cbranch_vccnz L_csync8
  v_readfirstlane_b32 s70, v41
  s_nop 0
  s_lshr_b32 s70, s70, 23
  s_sub_i32 s70, 141, s70
  s_min_i32 s70, s70, 40
  ds_write_b128 v66, v[144:147] offset:3072
  v_fma_mixlo_f16 v148, v116, s51, 0
  v_fma_mixlo_f16 v149, v118, s51, 0
  v_fma_mixlo_f16 v150, v120, s51, 0
  v_fma_mixlo_f16 v151, v122, s51, 0
  v_fma_mixhi_f16 v148, v117, s51, 0
  v_fma_mixhi_f16 v149, v119, s51, 0
  v_fma_mixhi_f16 v150, v121, s51, 0
  v_fma_mixhi_f16 v151, v123, s51, 0
  ds_write_b128 v66, v[148:151] offset:4096
  s_cmp_lg_u32 s84, 0
  s_cbranch_scc1 L_ulin
  v_fma_mixlo_f16 v152, v124, s51, 0
  v_fma_mixlo_f16 v153, v126, s51, 0
  v_fma_mixlo_f16 v154, v128, s51, 0
  v_fma_mixlo_f16 v155, v130, s51, 0
  v_fma_mixhi_f16 v152, v125, s51, 0
  v_fma_mixhi_f16 v153, v127, s51, 0
  v_fma_mixhi_f16 v154, v129, s51, 0
  v_fma_mixhi_f16 v155, v131, s51, 0
  ds_write_b128 v66, v[152:155] offset:5120
  s_branch L_built
L_ulin:
  v_mul_f32 v224, s51, v224
  v_mul_f32 v225, s51, v225
  v_mul_f32 v226, s51, v226
  v_mul_f32 v227, s51, v227
  v_mul_f32 v228, s51, v228
  v_mul_f32 v229, s51, v229
  v_mul_f32 v230, s51, v230
  v_mul_f32 v231, s51, v231
  v_cvt_pk_bf16_f32 v152, v224, v225
  v_cvt_pk_bf16_f32 v153, v226, v227
  v_cvt_pk_bf16_f32 v154, v228, v229
  v_cvt_pk_bf16_f32 v155, v230, v231
  ds_write_b128 v66, v[152:155] offset:5120
L_built:
  s_waitcnt vmcnt(1)
  v_mov_b32 v4, s84
  ds_add_u32 v1, v4 offset:36
  s_mov_b32 s60, s24
  s_and_b32 s61, s25, 0xffff
  s_mov_b32 s62, 268435456
  s_mov_b32 s63, 0x20000
  s_mov_b32 s64, s22
  s_and_b32 s65, s23, 0xffff
  s_mov_b32 s66, 256
  s_mov_b32 s67, 0x20000
  v_lshlrev_b32 v251, 2, v0
  s_mov_b64 exec, 0xff
  s_mov_b32 s81, 0x80000
  buffer_load_dword v255, v251, s[60:63], s81 offen
  buffer_load_dword v249, v251, s[64:67], 0 offen offset:128 sc1
  s_mov_b64 exec, -1
  v_mov_b32 v251, 0
  s_add_i32 s48, s70, s71
L_csync9:
  ds_read_b32 v4, v2 offset:36
  s_waitcnt lgkmcnt(0)
  v_cmp_gt_u32 vcc, 4, v4
  s_cbranch_vccnz L_csync9
  ds_read_u16_d16_hi v32, v7 offset:0
  ds_read_u16_d16_hi v33, v7 offset:128
  ds_read_u16_d16_hi v34, v7 offset:256
  ds_read_u16_d16_hi v35, v7 offset:384
  ds_read_u16_d16_hi v36, v7 offset:512
  ds_read_u16_d16_hi v37, v7 offset:640
  ds_read_u16_d16_hi v38, v7 offset:768
  ds_read_u16_d16_hi v39, v7 offset:896
  s_waitcnt lgkmcnt(0)
  v_cvt_pk_f16_f32 v43, v38, v39
  v_cvt_pk_f16_f32 v40, v32, v35
  v_cvt_pk_f16_f32 v41, v33, v36
  v_cvt_pk_f16_f32 v42, v34, v37
  ds_write_b128 v10, v[40:43]
  ds_read_b128 v[44:47], v11
  ds_read_b128 v[48:51], v12
  ds_read_b64_tr_b16 v[52:53], v8 offset:0
  ds_read_b64_tr_b16 v[54:55], v8 offset:512
  v_pk_mul_f16 v56, v40, v40 op_sel:[0,0] op_sel_hi:[1,1]
  v_pk_mul_f16 v57, v41, v41 op_sel:[0,0] op_sel_hi:[1,1]
  v_pk_mul_f16 v58, v42, v42 op_sel:[0,0] op_sel_hi:[1,1]
  v_pk_mul_f16 v59, v40, v41 op_sel:[0,0] op_sel_hi:[1,1]
  ds_read_u16_d16_hi v32, v7 offset:32
  ds_read_u16_d16_hi v33, v7 offset:160
  s_waitcnt vmcnt(3)
  v_lshlrev_b32 v21, 7, v21
  buffer_load_dword v255, v21, s[32:35], 0 offen
  s_mov_b64 exec, 131071
  buffer_load_dword v255, v19, s[44:47], s101 offen
  s_mov_b64 exec, -1
  s_add_u32 s101, s101, 1171456
  s_waitcnt lgkmcnt(0)
  s_barrier
  s_setprio 1
  ds_read_b128 v[240:243], v28 offset:46528
  ds_read_b128 v[128:131], v28 offset:35264
  ds_read_b128 v[84:87], v28 offset:0
  ds_read_b128 v[216:219], v22
  ds_read_b128 v[244:247], v30 offset:22528
  ds_read_b128 v[172:175], v31 offset:11264
  ds_read_b128 v[176:179], v31 offset:12288
  ds_read_b128 v[180:183], v31 offset:13312
  ds_read2_b32 v[220:221], v29 offset0:0 offset1:2
  ds_read2_b32 v[222:223], v29 offset0:64 offset1:66
  v_add_u32 v29, 2048, v29
  ds_read_b128 v[88:91], v28 offset:1024
  ds_read_b128 v[92:95], v28 offset:2048
  ds_read_b128 v[132:135], v28 offset:36288
  ds_read_b128 v[136:139], v28 offset:37312
  ds_read_b128 v[140:143], v28 offset:38336
  ds_read_b128 v[144:147], v28 offset:39360
  ds_read2_b32 v[224:225], v29 offset0:0 offset1:2
  ds_read2_b32 v[226:227], v29 offset0:64 offset1:66
  v_add_u32 v29, 2048, v29
  s_cmp_lg_u32 s84, 0
  s_cbranch_scc1 L_prf
  s_setprio 2
L_prf:
  s_waitcnt lgkmcnt(14)
  v_mfma_f32_16x16x32_bf16 v[72:75], v[240:243], v[52:55], 0
  ds_read_b128 v[184:187], v31 offset:14336
  v_mfma_f32_16x16x32_f16 v[72:75], v[128:131], v[56:59], v[72:75]
  ds_read_b128 v[188:191], v31 offset:15360
  v_mfma_f32_16x16x32_f16 v[68:71], v[84:87], v[56:59], 0
  ds_read_b128 v[96:99], v28 offset:3072
  v_pk_mul_f16 v60, v40, v41 op_sel:[0,1] op_sel_hi:[1,0]
  v_mfma_f32_16x16x32_f16 v[80:83], v[216:219], v[56:59], 0
  ds_read_b128 v[100:103], v28 offset:4096
  v_pk_mul_f16 v61, v40, v42 op_sel:[0,0] op_sel_hi:[1,1]
  v_pk_mul_f16 v62, v40, v42 op_sel:[0,1] op_sel_hi:[1,0]
  s_waitcnt lgkmcnt(14)
  v_mfma_f32_16x16x32_bf16 v[76:79], v[244:247], v[52:55], 0
  ds_read_b128 v[104:107], v28 offset:5120
  v_pk_mul_f16 v63, v41, v42 op_sel:[0,0] op_sel_hi:[1,1]
  v_pk_mul_f16 v64, v41, v42 op_sel:[0,1] op_sel_hi:[1,0]
  v_mfma_f32_16x16x32_f16 v[76:79], v[172:175], v[56:59], v[76:79]
  ds_read_b128 v[108:111], v28 offset:6144
  v_pk_mul_f16 v65, v40, v43 op_sel:[0,0] op_sel_hi:[1,0]
  v_pk_mul_f16 v66, v41, v43 op_sel:[0,0] op_sel_hi:[1,0]
  v_pk_mul_f16 v67, v42, v43 op_sel:[0,0] op_sel_hi:[1,0]
  v_mfma_f32_16x16x32_f16 v[76:79], v[176:179], v[60:63], v[76:79]
  ds_read2_b32 v[228:229], v29 offset0:0 offset1:2
  ds_read2_b32 v[230:231], v29 offset0:64 offset1:66
  v_add_u32 v29, 2048, v29
  v_alignbit_b32 v48, v48, v48, v13
  v_mfma_f32_16x16x32_f16 v[76:79], v[180:183], v[64:67], v[76:79]
  ds_read_b128 v[148:151], v28 offset:40384
  v_mul_f16_sdwa v52, v40, v40 dst_sel:WORD_0 dst_unused:UNUSED_PAD src0_sel:WORD_0 src1_sel:WORD_1
  v_mul_f16_sdwa v53, v42, v42 dst_sel:WORD_0 dst_unused:UNUSED_PAD src0_sel:WORD_0 src1_sel:WORD_1
  s_waitcnt lgkmcnt(14)
  v_smfmac_f32_16x16x64_f16 v[80:83], v[220:223], v[60:67], v16
  ds_read_b128 v[152:155], v28 offset:41408
  v_alignbit_b32 v49, v49, v49, v13
  v_mfma_f32_16x16x32_f16 v[68:71], v[88:91], v[60:63], v[68:71]
  ds_read_b128 v[192:195], v31 offset:16384
  v_mul_f16_sdwa v52, v41, v41 dst_sel:WORD_1 dst_unused:UNUSED_PRESERVE src0_sel:WORD_0 src1_sel:WORD_1
  v_mul_f16_sdwa v53, v43, v43 dst_sel:WORD_1 dst_unused:UNUSED_PRESERVE src0_sel:WORD_0 src1_sel:WORD_1
  v_mfma_f32_16x16x32_f16 v[68:71], v[92:95], v[64:67], v[68:71]
  ds_read_b128 v[196:199], v31 offset:17408
  v_pk_mul_f16 v54, v40, v47 op_sel:[0,0] op_sel_hi:[1,0]
  v_mfma_f32_16x16x32_f16 v[72:75], v[132:135], v[60:63], v[72:75]
  ds_read_b128 v[200:203], v31 offset:18432
  v_pk_mul_f16 v55, v41, v47 op_sel:[0,0] op_sel_hi:[1,0]
  v_pk_mul_f16 v56, v42, v47 op_sel:[0,0] op_sel_hi:[1,0]
  s_waitcnt lgkmcnt(14)
  v_mfma_f32_16x16x32_f16 v[72:75], v[136:139], v[64:67], v[72:75]
  ds_read_b128 v[204:207], v31 offset:19456
  v_pk_mul_f16 v57, v40, v44 op_sel:[0,0] op_sel_hi:[1,1]
  v_pk_mul_f16 v58, v40, v44 op_sel:[0,1] op_sel_hi:[1,0]
  v_pk_mul_f16 v59, v40, v45 op_sel:[0,0] op_sel_hi:[1,1]
  v_mfma_f32_16x16x32_f16 v[72:75], v[140:143], v[52:55], v[72:75]
  ds_read2_b32 v[232:233], v29 offset0:0 offset1:2
  ds_read2_b32 v[234:235], v29 offset0:64 offset1:66
  v_add_u32 v29, 2048, v29
  v_pk_mul_f16 v60, v40, v45 op_sel:[0,1] op_sel_hi:[1,0]
  v_mfma_f32_16x16x32_f16 v[72:75], v[144:147], v[56:59], v[72:75]
  ds_read_b128 v[156:159], v28 offset:42432
  v_pk_mul_f16 v61, v40, v46 op_sel:[0,0] op_sel_hi:[1,1]
  v_pk_mul_f16 v62, v40, v46 op_sel:[0,1] op_sel_hi:[1,0]
  s_waitcnt lgkmcnt(14)
  v_smfmac_f32_16x16x64_f16 v[80:83], v[224:227], v[52:59], v16
  ds_read_b128 v[160:163], v28 offset:43456
  v_pk_mul_f16 v63, v41, v44 op_sel:[0,0] op_sel_hi:[1,1]
  v_mfma_f32_16x16x32_f16 v[76:79], v[184:187], v[52:55], v[76:79]
  ds_read_b128 v[112:115], v28 offset:7168
  v_pk_mul_f16 v64, v41, v44 op_sel:[0,1] op_sel_hi:[1,0]
  v_pk_mul_f16 v65, v41, v45 op_sel:[0,0] op_sel_hi:[1,1]
  v_mfma_f32_16x16x32_f16 v[76:79], v[188:191], v[56:59], v[76:79]
  ds_read_b128 v[116:119], v28 offset:8192
  v_pk_mul_f16 v66, v41, v45 op_sel:[0,1] op_sel_hi:[1,0]
  v_mfma_f32_16x16x32_f16 v[68:71], v[96:99], v[52:55], v[68:71]
  ds_read_b128 v[120:123], v28 offset:9216
  v_pk_mul_f16 v67, v41, v46 op_sel:[0,0] op_sel_hi:[1,1]
  ds_write_b16 v15, v14 offset:4064
  s_and_b32 s81, s2, 7
  s_waitcnt vmcnt(2)
  v_cmp_eq_u32 vcc, 0, v249
  s_nop 0
  s_bitcmp1_b32 vcc_lo, s81
  s_cbranch_scc0 L_cclr_ok
  s_mov_b32 s78, 0x40000
L_cclr:
  s_sub_u32 s78, s78, 1
  s_cbranch_scc1 L_cclr_ok
  v_lshlrev_b32 v249, 2, v0
  v_and_b32 v249, 31, v249
  buffer_load_dword v249, v249, s[64:67], 0 offen offset:128 sc1
  s_waitcnt vmcnt(0)
  v_cmp_eq_u32 vcc, 0, v249
  s_nop 0
  s_bitcmp1_b32 vcc_lo, s81
  s_cbranch_scc1 L_cclr
L_cclr_ok:
  v_lshl_add_u32 v24, v24, 7, v18
  v_lshl_add_u32 v25, v25, 7, v18
  s_mov_b32 exec_hi, 0x0000ffff
  v_lshl_add_u32 v26, v26, 7, v18
  v_lshl_add_u32 v27, v27, 7, v18
  s_mov_b32 exec_lo, 0
  s_mov_b32 exec_hi, 0xffff0000
  v_mov_b32 v27, v25
  v_mov_b32 v26, v25
  s_mov_b32 exec_hi, 0x00ff0000
  v_mov_b32 v26, v24
  s_mov_b64 exec, -1
  s_add_u32 m0, s74, -39488
  s_nop 0
  buffer_load_dwordx4 v24, s[32:35], 0 offen lds
  s_add_u32 m0, s74, -38432
  s_nop 0
  buffer_load_dwordx4 v25, s[32:35], 0 offen lds
  s_add_u32 m0, s74, -37376
  s_nop 0
  buffer_load_dwordx4 v26, s[32:35], 0 offen lds
  s_add_u32 m0, s74, -36320
  s_mov_b32 exec_hi, 0x00ffffff
  buffer_load_dwordx4 v27, s[32:35], 0 offen lds
  s_mov_b32 exec_hi, -1
  s_mov_b64 exec, 131071
  buffer_load_dword v255, v19, s[44:47], s101 offen
  s_mov_b64 exec, -1
  s_add_u32 s101, s101, 1171456
  s_sub_i32 s48, 0, s48
  s_mov_b32 s49, s48
  s_mov_b32 s97, 1
  s_mov_b32 s50, 1
  s_mov_b32 s96, 0
  s_cmp_lg_u32 s3, 7
  s_cbranch_scc1 L_nw0
  s_mov_b32 s52, s16
  s_and_b32 s53, s17, 0xffff
  s_mov_b32 s54, 3328
  s_mov_b32 s55, 0x20000
  v_lshlrev_b32 v22, 7, v0
  buffer_load_dword v255, v22, s[52:55], 0 offen
L_nw0:
  v_alignbit_b32 v50, v50, v50, v13
  s_waitcnt lgkmcnt(14)
  v_mfma_f32_16x16x32_f16 v[68:71], v[100:103], v[56:59], v[68:71]
  ds_read_b128 v[124:127], v28 offset:10240
  v_pk_mul_f16 v52, v41, v46 op_sel:[0,1] op_sel_hi:[1,0]
  v_pk_mul_f16 v53, v42, v44 op_sel:[0,0] op_sel_hi:[1,1]
  v_mfma_f32_16x16x32_f16 v[68:71], v[104:107], v[60:63], v[68:71]
  ds_read_b128 v[164:167], v28 offset:44480
  v_pk_mul_f16 v54, v42, v44 op_sel:[0,1] op_sel_hi:[1,0]
  v_pk_mul_f16 v55, v42, v45 op_sel:[0,0] op_sel_hi:[1,1]
  v_mfma_f32_16x16x32_f16 v[68:71], v[108:111], v[64:67], v[68:71]
  ds_read_b128 v[168:171], v28 offset:45504
  v_pk_mul_f16 v56, v42, v45 op_sel:[0,1] op_sel_hi:[1,0]
  v_pk_mul_f16 v57, v42, v46 op_sel:[0,0] op_sel_hi:[1,1]
  v_smfmac_f32_16x16x64_f16 v[80:83], v[228:231], v[60:67], v16
  ds_read2_b32 v[236:237], v29 offset0:0 offset1:2
  ds_read2_b32 v[238:239], v29 offset0:64 offset1:66
  v_add_u32 v29, 2048, v29
  v_pk_mul_f16 v58, v42, v46 op_sel:[0,1] op_sel_hi:[1,0]
  v_pk_mul_f16 v59, v40, v48 op_sel:[0,0] op_sel_hi:[1,1]
  s_waitcnt lgkmcnt(14)
  v_mfma_f32_16x16x32_f16 v[72:75], v[148:151], v[60:63], v[72:75]
  ds_read_b128 v[208:211], v31 offset:20480
  ds_read_u16_d16_hi v34, v7 offset:288
  ds_read_u16_d16_hi v35, v7 offset:416
  v_mfma_f32_16x16x32_f16 v[72:75], v[152:155], v[64:67], v[72:75]
  ds_read_b128 v[212:215], v31 offset:21504
  ds_read_u16_d16_hi v36, v7 offset:544
  ds_read_u16_d16_hi v37, v7 offset:672
  v_mfma_f32_16x16x32_f16 v[76:79], v[192:195], v[60:63], v[76:79]
  ds_read_u16_d16_hi v38, v7 offset:800
  ds_read_u16_d16_hi v39, v7 offset:928
  v_mfma_f32_16x16x32_f16 v[76:79], v[196:199], v[64:67], v[76:79]
  v_pk_mul_f16 v60, v41, v49 op_sel:[0,0] op_sel_hi:[1,1]
  v_pk_mul_f16 v61, v42, v50 op_sel:[0,0] op_sel_hi:[1,1]
  v_mfma_f32_16x16x32_f16 v[76:79], v[200:203], v[52:55], v[76:79]
  v_pk_mul_f16 v62, v40, v49 op_sel:[0,0] op_sel_hi:[1,1]
  v_pk_mul_f16 v63, v40, v49 op_sel:[0,1] op_sel_hi:[1,0]
  s_waitcnt lgkmcnt(14)
  v_mfma_f32_16x16x32_f16 v[76:79], v[204:207], v[56:59], v[76:79]
  v_pk_mul_f16 v64, v40, v50 op_sel:[0,0] op_sel_hi:[1,1]
  v_pk_mul_f16 v65, v40, v50 op_sel:[0,1] op_sel_hi:[1,0]
  v_smfmac_f32_16x16x64_f16 v[80:83], v[232:235], v[52:59], v16
  v_pk_mul_f16 v66, v41, v50 op_sel:[0,0] op_sel_hi:[1,1]
  v_pk_mul_f16 v67, v41, v50 op_sel:[0,1] op_sel_hi:[1,0]
  v_mfma_f32_16x16x32_f16 v[72:75], v[156:159], v[52:55], v[72:75]
  s_waitcnt lgkmcnt(0)
  v_cvt_pk_f16_f32 v43, v38, v39
  v_mfma_f32_16x16x32_f16 v[72:75], v[160:163], v[56:59], v[72:75]
  v_cvt_pk_f16_f32 v40, v32, v35
  v_cvt_pk_f16_f32 v41, v33, v36
  v_mfma_f32_16x16x32_f16 v[68:71], v[112:115], v[52:55], v[68:71]
  v_cvt_pk_f16_f32 v42, v34, v37
  v_mfma_f32_16x16x32_f16 v[68:71], v[116:119], v[56:59], v[68:71]
  ds_write_b128 v10, v[40:43]
  v_mfma_f32_16x16x32_f16 v[68:71], v[120:123], v[60:63], v[68:71]
  v_mfma_f32_16x16x32_f16 v[68:71], v[124:127], v[64:67], v[68:71]
  ds_read_b128 v[44:47], v11
  ds_read_b128 v[48:51], v12
  v_mfma_f32_16x16x32_f16 v[72:75], v[164:167], v[60:63], v[72:75]
  ds_read_b64_tr_b16 v[52:53], v8 offset:32
  ds_read_b64_tr_b16 v[54:55], v8 offset:544
  v_mfma_f32_16x16x32_f16 v[72:75], v[168:171], v[64:67], v[72:75]
  v_pk_mul_f16 v56, v40, v40 op_sel:[0,0] op_sel_hi:[1,1]
  v_pk_mul_f16 v57, v41, v41 op_sel:[0,0] op_sel_hi:[1,1]
  v_smfmac_f32_16x16x64_f16 v[80:83], v[236:239], v[60:67], v16
  v_pk_mul_f16 v58, v42, v42 op_sel:[0,0] op_sel_hi:[1,1]
  v_pk_mul_f16 v59, v40, v41 op_sel:[0,0] op_sel_hi:[1,1]
  v_mfma_f32_16x16x32_f16 v[76:79], v[208:211], v[60:63], v[76:79]
  s_nop 1
  v_mul_f32 v14, v68, v72
  v_fmac_f32 v14, v69, v73
  v_mfma_f32_16x16x32_f16 v[76:79], v[212:215], v[64:67], v[76:79]
  v_fmac_f32 v14, v70, v74
  v_fmac_f32 v14, v71, v75
  ds_add_u32 v1, v3 offset:12
  s_branch L_grp1
L_prime:
  v_mov_b32 v68, 0
  v_mov_b32 v69, 0
  v_mov_b32 v70, 0
  v_mov_b32 v71, 0
  v_mov_b32 v72, 0
  v_mov_b32 v73, 0
  v_mov_b32 v74, 0
  v_mov_b32 v75, 0
  v_mov_b32 v76, 0
  v_mov_b32 v77, 0
  v_mov_b32 v78, 0
  v_mov_b32 v79, 0
  v_mov_b32 v80, 0
  v_mov_b32 v81, 0
  v_mov_b32 v82, 0
  v_mov_b32 v83, 0
  v_mov_b32 v22, 0
  v_mov_b32 v23, 0
  ds_read_u16_d16_hi v32, v7 offset:0
  ds_read_u16_d16_hi v33, v7 offset:128
  ds_read_u16_d16_hi v34, v7 offset:256
  ds_read_u16_d16_hi v35, v7 offset:384
  ds_read_u16_d16_hi v36, v7 offset:512
  ds_read_u16_d16_hi v37, v7 offset:640
  ds_read_u16_d16_hi v38, v7 offset:768
  ds_read_u16_d16_hi v39, v7 offset:896
  s_waitcnt lgkmcnt(0)
  v_cvt_pk_f16_f32 v43, v38, v39
  v_cvt_pk_f16_f32 v40, v32, v35
  v_cvt_pk_f16_f32 v41, v33, v36
  v_cvt_pk_f16_f32 v42, v34, v37
  ds_write_b128 v10, v[40:43]
  ds_read_b128 v[44:47], v11
  ds_read_b128 v[48:51], v12
  ds_read_b64_tr_b16 v[52:53], v8 offset:0
  ds_read_b64_tr_b16 v[54:55], v8 offset:512
  v_pk_mul_f16 v56, v40, v40 op_sel:[0,0] op_sel_hi:[1,1]
  v_pk_mul_f16 v57, v41, v41 op_sel:[0,0] op_sel_hi:[1,1]
  v_pk_mul_f16 v58, v42, v42 op_sel:[0,0] op_sel_hi:[1,1]
  v_pk_mul_f16 v59, v40, v41 op_sel:[0,0] op_sel_hi:[1,1]
  ds_read_u16_d16_hi v32, v7 offset:32
  ds_read_u16_d16_hi v33, v7 offset:160
L_cin_loop:
  s_cmp_lg_u32 s84, 0
  s_cbranch_scc1 L_pr0
  s_setprio 2
L_pr0:
  s_waitcnt lgkmcnt(2)
  v_mfma_f32_16x16x32_bf16 v[72:75], v[240:243], v[52:55], 0
  v_add_f32 v22, v80, v81
  v_add_f32 v23, v82, v83
  v_mfma_f32_16x16x32_f16 v[72:75], v[128:131], v[56:59], v[72:75]
  v_fmac_f32 v14, v76, v77
  v_fmac_f32 v14, v22, v78
  v_mfma_f32_16x16x32_f16 v[68:71], v[84:87], v[56:59], 0
  v_fmac_f32 v14, v23, v79
  v_pk_mul_f16 v60, v40, v41 op_sel:[0,1] op_sel_hi:[1,0]
  v_mfma_f32_16x16x32_f16 v[80:83], v[216:219], v[56:59], 0
  v_pk_mul_f16 v61, v40, v42 op_sel:[0,0] op_sel_hi:[1,1]
  v_pk_mul_f16 v62, v40, v42 op_sel:[0,1] op_sel_hi:[1,0]
  v_mfma_f32_16x16x32_bf16 v[76:79], v[244:247], v[52:55], 0
  v_pk_mul_f16 v63, v41, v42 op_sel:[0,0] op_sel_hi:[1,1]
  v_pk_mul_f16 v64, v41, v42 op_sel:[0,1] op_sel_hi:[1,0]
  v_mfma_f32_16x16x32_f16 v[76:79], v[172:175], v[56:59], v[76:79]
  v_pk_mul_f16 v65, v40, v43 op_sel:[0,0] op_sel_hi:[1,0]
  v_pk_mul_f16 v66, v41, v43 op_sel:[0,0] op_sel_hi:[1,0]
  v_pk_mul_f16 v67, v42, v43 op_sel:[0,0] op_sel_hi:[1,0]
  v_mfma_f32_16x16x32_f16 v[76:79], v[176:179], v[60:63], v[76:79]
  v_add_f32_dpp v14, v14, v14 row_shr:1 row_mask:0xf bank_mask:0xf
  v_alignbit_b32 v48, v48, v48, v13
  v_mfma_f32_16x16x32_f16 v[76:79], v[180:183], v[64:67], v[76:79]
  v_mul_f16_sdwa v52, v40, v40 dst_sel:WORD_0 dst_unused:UNUSED_PAD src0_sel:WORD_0 src1_sel:WORD_1
  v_mul_f16_sdwa v53, v42, v42 dst_sel:WORD_0 dst_unused:UNUSED_PAD src0_sel:WORD_0 src1_sel:WORD_1
  v_smfmac_f32_16x16x64_f16 v[80:83], v[220:223], v[60:67], v16
  v_add_f32_dpp v14, v14, v14 row_shr:2 row_mask:0xf bank_mask:0xf
  v_alignbit_b32 v49, v49, v49, v13
  v_mfma_f32_16x16x32_f16 v[68:71], v[88:91], v[60:63], v[68:71]
  v_mul_f16_sdwa v52, v41, v41 dst_sel:WORD_1 dst_unused:UNUSED_PRESERVE src0_sel:WORD_0 src1_sel:WORD_1
  v_mul_f16_sdwa v53, v43, v43 dst_sel:WORD_1 dst_unused:UNUSED_PRESERVE src0_sel:WORD_0 src1_sel:WORD_1
  v_mfma_f32_16x16x32_f16 v[68:71], v[92:95], v[64:67], v[68:71]
  v_add_f32_dpp v14, v14, v14 row_shr:4 row_mask:0xf bank_mask:0xf
  v_pk_mul_f16 v54, v40, v47 op_sel:[0,0] op_sel_hi:[1,0]
  v_mfma_f32_16x16x32_f16 v[72:75], v[132:135], v[60:63], v[72:75]
  v_pk_mul_f16 v55, v41, v47 op_sel:[0,0] op_sel_hi:[1,0]
  v_pk_mul_f16 v56, v42, v47 op_sel:[0,0] op_sel_hi:[1,0]
  v_mfma_f32_16x16x32_f16 v[72:75], v[136:139], v[64:67], v[72:75]
  v_pk_mul_f16 v57, v40, v44 op_sel:[0,0] op_sel_hi:[1,1]
  v_pk_mul_f16 v58, v40, v44 op_sel:[0,1] op_sel_hi:[1,0]
  v_pk_mul_f16 v59, v40, v45 op_sel:[0,0] op_sel_hi:[1,1]
  v_mfma_f32_16x16x32_f16 v[72:75], v[140:143], v[52:55], v[72:75]
  v_add_f32_dpp v14, v14, v14 row_shr:8 row_mask:0xf bank_mask:0xf
  v_pk_mul_f16 v60, v40, v45 op_sel:[0,1] op_sel_hi:[1,0]
  v_mfma_f32_16x16x32_f16 v[72:75], v[144:147], v[56:59], v[72:75]
  v_pk_mul_f16 v61, v40, v46 op_sel:[0,0] op_sel_hi:[1,1]
  v_pk_mul_f16 v62, v40, v46 op_sel:[0,1] op_sel_hi:[1,0]
  v_smfmac_f32_16x16x64_f16 v[80:83], v[224:227], v[52:59], v16
  v_add_f32_dpp v14, v14, v14 row_bcast:15 row_mask:0xa bank_mask:0xf
  v_pk_mul_f16 v63, v41, v44 op_sel:[0,0] op_sel_hi:[1,1]
  v_mfma_f32_16x16x32_f16 v[76:79], v[184:187], v[52:55], v[76:79]
  v_pk_mul_f16 v64, v41, v44 op_sel:[0,1] op_sel_hi:[1,0]
  v_pk_mul_f16 v65, v41, v45 op_sel:[0,0] op_sel_hi:[1,1]
  v_mfma_f32_16x16x32_f16 v[76:79], v[188:191], v[56:59], v[76:79]
  v_add_f32_dpp v14, v14, v14 row_bcast:31 row_mask:0xc bank_mask:0xf
  v_pk_mul_f16 v66, v41, v45 op_sel:[0,1] op_sel_hi:[1,0]
  v_mfma_f32_16x16x32_f16 v[68:71], v[96:99], v[52:55], v[68:71]
  v_pk_mul_f16 v67, v41, v46 op_sel:[0,0] op_sel_hi:[1,1]
  s_waitcnt vmcnt(0)
L_blk:
  s_cmp_eq_u32 s50, 0
  s_cbranch_scc1 L_blkend
  v_readlane_b32 s81, v14, 63
  v_ldexp_f32 v14, v14, s49
  v_and_b32 v14, -2, v14
  s_cmp_ge_u32 s50, 2
  s_cbranch_scc1 L_good
  s_cmp_eq_u64 s[90:91], 0
  s_cbranch_scc1 L_slow
  s_bfe_u32 s81, s81, 0x80017
  s_cmp_eq_u32 s81, 255
  s_cbranch_scc1 L_slow
L_good:
  s_mov_b32 exec_lo, 0
  s_mov_b32 exec_hi, 0x80000000
  buffer_store_dword v14, v251, s[60:63], s85 offen sc1
  s_mov_b64 exec, -1
  s_add_u32 s85, s85, 32
  s_sub_u32 s72, s72, 1
  s_cmp_eq_u32 s72, 0
  s_cbranch_scc1 L_cin_done
  s_cmp_eq_u32 s72, 1
  s_cbranch_scc1 L_lastnext
  v_lshl_add_u32 v24, v24, 7, v18
  v_lshl_add_u32 v25, v25, 7, v18
  s_mov_b32 exec_hi, 0x0000ffff
  v_lshl_add_u32 v26, v26, 7, v18
  v_lshl_add_u32 v27, v27, 7, v18
  s_mov_b32 exec_lo, 0
  s_mov_b32 exec_hi, 0xffff0000
  v_mov_b32 v27, v25
  v_mov_b32 v26, v25
  s_mov_b32 exec_hi, 0x00ff0000
  v_mov_b32 v26, v24
  s_mov_b64 exec, -1
  s_add_u32 m0, s74, 0
  s_nop 0
  buffer_load_dwordx4 v24, s[32:35], 0 offen lds
  s_add_u32 m0, s74, 1056
  s_nop 0
  buffer_load_dwordx4 v25, s[32:35], 0 offen lds
  s_add_u32 m0, s74, 2112
  s_nop 0
  buffer_load_dwordx4 v26, s[32:35], 0 offen lds
  s_add_u32 m0, s74, 3168
  s_mov_b32 exec_hi, 0x00ffffff
  buffer_load_dwordx4 v27, s[32:35], 0 offen lds
  s_mov_b32 exec_hi, -1
  s_add_u32 s94, s94, 832
  s_cmp_lg_u32 s72, s99
  s_cbranch_scc1 L_nodma
  s_lshr_b32 s81, s98, 14
  v_cmp_eq_u32 vcc, 0, v249
  s_nop 0
  s_bitcmp1_b32 vcc_lo, s81
  s_cbranch_scc0 L_tclr_ok
  s_mov_b32 s78, 0x40000
L_tclr:
  s_sub_u32 s78, s78, 1
  s_cbranch_scc1 L_tclr_ok
  v_lshlrev_b32 v249, 2, v0
  v_and_b32 v249, 31, v249
  buffer_load_dword v249, v249, s[64:67], 0 offen offset:128 sc1
  s_waitcnt vmcnt(0)
  v_cmp_eq_u32 vcc, 0, v249
  s_nop 0
  s_bitcmp1_b32 vcc_lo, s81
  s_cbranch_scc1 L_tclr
L_tclr_ok:
  v_mov_b32 v250, 1
  s_mov_b64 exec, 1
  buffer_atomic_add v250, v251, s[60:63], s98 offen sc0
  s_mov_b64 exec, -1
  s_mov_b32 s99, 8
  s_branch L_nodma
L_lastnext:
  s_cmp_lt_i32 s26, 0
  s_cselect_b32 s85, s85, s26
L_nodma:
  s_add_u32 s74, s74, s75
  s_sub_u32 s75, 0, s75
  s_mov_b32 s49, s48
  s_mov_b32 s97, 1
  s_cmp_eq_u32 s50, 3
  s_cbranch_scc1 L_slow2
L_blkend:
  s_mov_b32 s50, s97
  s_cmp_ge_u32 s101, 5537792
  s_cbranch_scc1 L_npf
  s_mov_b64 exec, 131071
  buffer_load_dword v255, v19, s[44:47], s101 offen
  s_mov_b64 exec, -1
  s_add_u32 s101, s101, 1171456
L_npf:
  v_alignbit_b32 v50, v50, v50, v13
  v_mfma_f32_16x16x32_f16 v[68:71], v[100:103], v[56:59], v[68:71]
  v_pk_mul_f16 v52, v41, v46 op_sel:[0,1] op_sel_hi:[1,0]
  v_pk_mul_f16 v53, v42, v44 op_sel:[0,0] op_sel_hi:[1,1]
  v_mfma_f32_16x16x32_f16 v[68:71], v[104:107], v[60:63], v[68:71]
  v_pk_mul_f16 v54, v42, v44 op_sel:[0,1] op_sel_hi:[1,0]
  v_pk_mul_f16 v55, v42, v45 op_sel:[0,0] op_sel_hi:[1,1]
  v_mfma_f32_16x16x32_f16 v[68:71], v[108:111], v[64:67], v[68:71]
  v_pk_mul_f16 v56, v42, v45 op_sel:[0,1] op_sel_hi:[1,0]
  v_pk_mul_f16 v57, v42, v46 op_sel:[0,0] op_sel_hi:[1,1]
  v_smfmac_f32_16x16x64_f16 v[80:83], v[228:231], v[60:67], v16
  v_pk_mul_f16 v58, v42, v46 op_sel:[0,1] op_sel_hi:[1,0]
  v_pk_mul_f16 v59, v40, v48 op_sel:[0,0] op_sel_hi:[1,1]
  v_mfma_f32_16x16x32_f16 v[72:75], v[148:151], v[60:63], v[72:75]
  ds_read_u16_d16_hi v34, v7 offset:288
  ds_read_u16_d16_hi v35, v7 offset:416
  v_mfma_f32_16x16x32_f16 v[72:75], v[152:155], v[64:67], v[72:75]
  ds_read_u16_d16_hi v36, v7 offset:544
  ds_read_u16_d16_hi v37, v7 offset:672
  v_mfma_f32_16x16x32_f16 v[76:79], v[192:195], v[60:63], v[76:79]
  ds_read_u16_d16_hi v38, v7 offset:800
  ds_read_u16_d16_hi v39, v7 offset:928
  v_mfma_f32_16x16x32_f16 v[76:79], v[196:199], v[64:67], v[76:79]
  v_pk_mul_f16 v60, v41, v49 op_sel:[0,0] op_sel_hi:[1,1]
  v_pk_mul_f16 v61, v42, v50 op_sel:[0,0] op_sel_hi:[1,1]
  v_mfma_f32_16x16x32_f16 v[76:79], v[200:203], v[52:55], v[76:79]
  v_pk_mul_f16 v62, v40, v49 op_sel:[0,0] op_sel_hi:[1,1]
  v_pk_mul_f16 v63, v40, v49 op_sel:[0,1] op_sel_hi:[1,0]
  v_mfma_f32_16x16x32_f16 v[76:79], v[204:207], v[56:59], v[76:79]
  v_pk_mul_f16 v64, v40, v50 op_sel:[0,0] op_sel_hi:[1,1]
  v_pk_mul_f16 v65, v40, v50 op_sel:[0,1] op_sel_hi:[1,0]
  v_smfmac_f32_16x16x64_f16 v[80:83], v[232:235], v[52:59], v16
  v_pk_mul_f16 v66, v41, v50 op_sel:[0,0] op_sel_hi:[1,1]
  v_pk_mul_f16 v67, v41, v50 op_sel:[0,1] op_sel_hi:[1,0]
  v_mfma_f32_16x16x32_f16 v[72:75], v[156:159], v[52:55], v[72:75]
  s_waitcnt lgkmcnt(0)
  v_cvt_pk_f16_f32 v43, v38, v39
  v_mfma_f32_16x16x32_f16 v[72:75], v[160:163], v[56:59], v[72:75]
  v_cvt_pk_f16_f32 v40, v32, v35
  v_cvt_pk_f16_f32 v41, v33, v36
  v_mfma_f32_16x16x32_f16 v[68:71], v[112:115], v[52:55], v[68:71]
  v_cvt_pk_f16_f32 v42, v34, v37
  v_mfma_f32_16x16x32_f16 v[68:71], v[116:119], v[56:59], v[68:71]
  ds_write_b128 v10, v[40:43]
  v_mfma_f32_16x16x32_f16 v[68:71], v[120:123], v[60:63], v[68:71]
  v_mfma_f32_16x16x32_f16 v[68:71], v[124:127], v[64:67], v[68:71]
  ds_read_b128 v[44:47], v11
  ds_read_b128 v[48:51], v12
  v_mfma_f32_16x16x32_f16 v[72:75], v[164:167], v[60:63], v[72:75]
  ds_read_b64_tr_b16 v[52:53], v8 offset:32
  ds_read_b64_tr_b16 v[54:55], v8 offset:544
  v_mfma_f32_16x16x32_f16 v[72:75], v[168:171], v[64:67], v[72:75]
  v_pk_mul_f16 v56, v40, v40 op_sel:[0,0] op_sel_hi:[1,1]
  v_pk_mul_f16 v57, v41, v41 op_sel:[0,0] op_sel_hi:[1,1]
  v_smfmac_f32_16x16x64_f16 v[80:83], v[236:239], v[60:67], v16
  v_pk_mul_f16 v58, v42, v42 op_sel:[0,0] op_sel_hi:[1,1]
  v_pk_mul_f16 v59, v40, v41 op_sel:[0,0] op_sel_hi:[1,1]
  v_mfma_f32_16x16x32_f16 v[76:79], v[208:211], v[60:63], v[76:79]
  s_nop 1
  v_mul_f32 v14, v68, v72
  v_fmac_f32 v14, v69, v73
  v_mfma_f32_16x16x32_f16 v[76:79], v[212:215], v[64:67], v[76:79]
  v_fmac_f32 v14, v70, v74
  v_fmac_f32 v14, v71, v75
L_grp1:
  s_waitcnt lgkmcnt(0)
  v_mfma_f32_16x16x32_bf16 v[72:75], v[240:243], v[52:55], 0
  v_add_f32 v22, v80, v81
  v_add_f32 v23, v82, v83
  v_mfma_f32_16x16x32_f16 v[72:75], v[128:131], v[56:59], v[72:75]
  s_nop 0
  v_fmac_f32 v14, v76, v77
  v_fmac_f32 v14, v22, v78
  v_mfma_f32_16x16x32_f16 v[68:71], v[84:87], v[56:59], 0
  v_fmac_f32 v14, v23, v79
  v_pk_mul_f16 v60, v40, v41 op_sel:[0,1] op_sel_hi:[1,0]
  v_mfma_f32_16x16x32_f16 v[80:83], v[216:219], v[56:59], 0
  v_pk_mul_f16 v61, v40, v42 op_sel:[0,0] op_sel_hi:[1,1]
  v_pk_mul_f16 v62, v40, v42 op_sel:[0,1] op_sel_hi:[1,0]
  v_mfma_f32_16x16x32_bf16 v[76:79], v[244:247], v[52:55], 0
  v_pk_mul_f16 v63, v41, v42 op_sel:[0,0] op_sel_hi:[1,1]
  v_pk_mul_f16 v64, v41, v42 op_sel:[0,1] op_sel_hi:[1,0]
  v_mfma_f32_16x16x32_f16 v[76:79], v[172:175], v[56:59], v[76:79]
  v_pk_mul_f16 v65, v40, v43 op_sel:[0,0] op_sel_hi:[1,0]
  v_pk_mul_f16 v66, v41, v43 op_sel:[0,0] op_sel_hi:[1,0]
  v_pk_mul_f16 v67, v42, v43 op_sel:[0,0] op_sel_hi:[1,0]
  v_mfma_f32_16x16x32_f16 v[76:79], v[176:179], v[60:63], v[76:79]
  v_or3_b32 v15, v56, v57, v58
  v_alignbit_b32 v48, v48, v48, v13
  v_mfma_f32_16x16x32_f16 v[76:79], v[180:183], v[64:67], v[76:79]
  v_mul_f16_sdwa v52, v40, v40 dst_sel:WORD_0 dst_unused:UNUSED_PAD src0_sel:WORD_0 src1_sel:WORD_1
  v_mul_f16_sdwa v53, v42, v42 dst_sel:WORD_0 dst_unused:UNUSED_PAD src0_sel:WORD_0 src1_sel:WORD_1
  v_smfmac_f32_16x16x64_f16 v[80:83], v[220:223], v[60:67], v16
  v_mul_f16_sdwa v52, v41, v41 dst_sel:WORD_1 dst_unused:UNUSED_PRESERVE src0_sel:WORD_0 src1_sel:WORD_1
  v_mul_f16_sdwa v53, v43, v43 dst_sel:WORD_1 dst_unused:UNUSED_PRESERVE src0_sel:WORD_0 src1_sel:WORD_1
  v_mfma_f32_16x16x32_f16 v[68:71], v[88:91], v[60:63], v[68:71]
  v_pk_mul_f16 v54, v40, v47 op_sel:[0,0] op_sel_hi:[1,0]
  v_pk_mul_f16 v55, v41, v47 op_sel:[0,0] op_sel_hi:[1,0]
  v_mfma_f32_16x16x32_f16 v[68:71], v[92:95], v[64:67], v[68:71]
  v_pk_mul_f16 v56, v42, v47 op_sel:[0,0] op_sel_hi:[1,0]
  v_pk_mul_f16 v57, v40, v44 op_sel:[0,0] op_sel_hi:[1,1]
  v_mfma_f32_16x16x32_f16 v[72:75], v[132:135], v[60:63], v[72:75]
  v_pk_mul_f16 v58, v40, v44 op_sel:[0,1] op_sel_hi:[1,0]
  v_pk_mul_f16 v59, v40, v45 op_sel:[0,0] op_sel_hi:[1,1]
  v_mfma_f32_16x16x32_f16 v[72:75], v[136:139], v[64:67], v[72:75]
  v_pk_mul_f16 v60, v40, v45 op_sel:[0,1] op_sel_hi:[1,0]
  v_pk_mul_f16 v61, v40, v46 op_sel:[0,0] op_sel_hi:[1,1]
  v_mfma_f32_16x16x32_f16 v[72:75], v[140:143], v[52:55], v[72:75]
  v_pk_mul_f16 v62, v40, v46 op_sel:[0,1] op_sel_hi:[1,0]
  v_pk_mul_f16 v63, v41, v44 op_sel:[0,0] op_sel_hi:[1,1]
  v_mfma_f32_16x16x32_f16 v[72:75], v[144:147], v[56:59], v[72:75]
  v_pk_mul_f16 v64, v41, v44 op_sel:[0,1] op_sel_hi:[1,0]
  v_pk_mul_f16 v65, v41, v45 op_sel:[0,0] op_sel_hi:[1,1]
  v_smfmac_f32_16x16x64_f16 v[80:83], v[224:227], v[52:59], v16
  v_pk_mul_f16 v66, v41, v45 op_sel:[0,1] op_sel_hi:[1,0]
  v_pk_mul_f16 v67, v41, v46 op_sel:[0,0] op_sel_hi:[1,1]
  v_mfma_f32_16x16x32_f16 v[76:79], v[184:187], v[52:55], v[76:79]
  v_alignbit_b32 v49, v49, v49, v13
  v_alignbit_b32 v50, v50, v50, v13
  v_mfma_f32_16x16x32_f16 v[76:79], v[188:191], v[56:59], v[76:79]
  ds_read_u16_d16_hi v32, v7 offset:64
  ds_read_u16_d16_hi v33, v7 offset:192
  v_mfma_f32_16x16x32_f16 v[68:71], v[96:99], v[52:55], v[68:71]
  v_pk_mul_f16 v52, v41, v46 op_sel:[0,1] op_sel_hi:[1,0]
  v_pk_mul_f16 v53, v42, v44 op_sel:[0,0] op_sel_hi:[1,1]
  v_mfma_f32_16x16x32_f16 v[68:71], v[100:103], v[56:59], v[68:71]
  v_pk_mul_f16 v54, v42, v44 op_sel:[0,1] op_sel_hi:[1,0]
  v_pk_mul_f16 v55, v42, v45 op_sel:[0,0] op_sel_hi:[1,1]
  v_mfma_f32_16x16x32_f16 v[68:71], v[104:107], v[60:63], v[68:71]
  v_pk_mul_f16 v56, v42, v45 op_sel:[0,1] op_sel_hi:[1,0]
  v_pk_mul_f16 v57, v42, v46 op_sel:[0,0] op_sel_hi:[1,1]
  v_mfma_f32_16x16x32_f16 v[68:71], v[108:111], v[64:67], v[68:71]
  v_pk_mul_f16 v58, v42, v46 op_sel:[0,1] op_sel_hi:[1,0]
  v_pk_mul_f16 v59, v40, v48 op_sel:[0,0] op_sel_hi:[1,1]
  v_smfmac_f32_16x16x64_f16 v[80:83], v[228:231], v[60:67], v16
  ds_read_u16_d16_hi v34, v7 offset:320
  ds_read_u16_d16_hi v35, v7 offset:448
  v_mfma_f32_16x16x32_f16 v[72:75], v[148:151], v[60:63], v[72:75]
  ds_read_u16_d16_hi v36, v7 offset:576
  ds_read_u16_d16_hi v37, v7 offset:704
  v_mfma_f32_16x16x32_f16 v[72:75], v[152:155], v[64:67], v[72:75]
  ds_read_u16_d16_hi v38, v7 offset:832
  ds_read_u16_d16_hi v39, v7 offset:960
  v_mfma_f32_16x16x32_f16 v[76:79], v[192:195], v[60:63], v[76:79]
  v_and_b32 v15, 0x60006000, v15
  v_cmp_ne_u32 s[90:91], 0, v15
  v_mfma_f32_16x16x32_f16 v[76:79], v[196:199], v[64:67], v[76:79]
  v_pk_mul_f16 v60, v41, v49 op_sel:[0,0] op_sel_hi:[1,1]
  v_pk_mul_f16 v61, v42, v50 op_sel:[0,0] op_sel_hi:[1,1]
  v_mfma_f32_16x16x32_f16 v[76:79], v[200:203], v[52:55], v[76:79]
  v_pk_mul_f16 v62, v40, v49 op_sel:[0,0] op_sel_hi:[1,1]
  v_pk_mul_f16 v63, v40, v49 op_sel:[0,1] op_sel_hi:[1,0]
  v_mfma_f32_16x16x32_f16 v[76:79], v[204:207], v[56:59], v[76:79]
  v_pk_mul_f16 v64, v40, v50 op_sel:[0,0] op_sel_hi:[1,1]
  v_pk_mul_f16 v65, v40, v50 op_sel:[0,1] op_sel_hi:[1,0]
  v_smfmac_f32_16x16x64_f16 v[80:83], v[232:235], v[52:59], v16
  v_pk_mul_f16 v66, v41, v50 op_sel:[0,0] op_sel_hi:[1,1]
  v_pk_mul_f16 v67, v41, v50 op_sel:[0,1] op_sel_hi:[1,0]
  v_mfma_f32_16x16x32_f16 v[72:75], v[156:159], v[52:55], v[72:75]
  s_waitcnt lgkmcnt(0)
  v_cvt_pk_f16_f32 v43, v38, v39
  v_mfma_f32_16x16x32_f16 v[72:75], v[160:163], v[56:59], v[72:75]
  v_cvt_pk_f16_f32 v40, v32, v35
  v_cvt_pk_f16_f32 v41, v33, v36
  v_mfma_f32_16x16x32_f16 v[68:71], v[112:115], v[52:55], v[68:71]
  v_cvt_pk_f16_f32 v42, v34, v37
  v_mfma_f32_16x16x32_f16 v[68:71], v[116:119], v[56:59], v[68:71]
  ds_write_b128 v10, v[40:43]
  v_mfma_f32_16x16x32_f16 v[68:71], v[120:123], v[60:63], v[68:71]
  v_mfma_f32_16x16x32_f16 v[68:71], v[124:127], v[64:67], v[68:71]
  ds_read_b128 v[44:47], v11
  ds_read_b128 v[48:51], v12
  v_mfma_f32_16x16x32_f16 v[72:75], v[164:167], v[60:63], v[72:75]
  ds_read_b64_tr_b16 v[52:53], v8 offset:64
  ds_read_b64_tr_b16 v[54:55], v8 offset:576
  v_mfma_f32_16x16x32_f16 v[72:75], v[168:171], v[64:67], v[72:75]
  v_pk_mul_f16 v56, v40, v40 op_sel:[0,0] op_sel_hi:[1,1]
  v_pk_mul_f16 v57, v41, v41 op_sel:[0,0] op_sel_hi:[1,1]
  v_smfmac_f32_16x16x64_f16 v[80:83], v[236:239], v[60:67], v16
  v_pk_mul_f16 v58, v42, v42 op_sel:[0,0] op_sel_hi:[1,1]
  v_pk_mul_f16 v59, v40, v41 op_sel:[0,0] op_sel_hi:[1,1]
  v_mfma_f32_16x16x32_f16 v[76:79], v[208:211], v[60:63], v[76:79]
  s_nop 1
  v_fmac_f32 v14, v68, v72
  v_fmac_f32 v14, v69, v73
  v_mfma_f32_16x16x32_f16 v[76:79], v[212:215], v[64:67], v[76:79]
  v_fmac_f32 v14, v70, v74
  v_fmac_f32 v14, v71, v75
  s_cmp_eq_u32 s72, s96
  s_cbranch_scc1 L_htail
  s_waitcnt lgkmcnt(0)
  v_mfma_f32_16x16x32_bf16 v[72:75], v[240:243], v[52:55], 0
  v_add_f32 v22, v80, v81
  v_add_f32 v23, v82, v83
  v_mfma_f32_16x16x32_f16 v[72:75], v[128:131], v[56:59], v[72:75]
  v_fmac_f32 v14, v76, v77
  v_fmac_f32 v14, v22, v78
  v_mfma_f32_16x16x32_f16 v[68:71], v[84:87], v[56:59], 0
  v_fmac_f32 v14, v23, v79
  v_pk_mul_f16 v60, v40, v41 op_sel:[0,1] op_sel_hi:[1,0]
  v_mfma_f32_16x16x32_f16 v[80:83], v[216:219], v[56:59], 0
  v_pk_mul_f16 v61, v40, v42 op_sel:[0,0] op_sel_hi:[1,1]
  v_pk_mul_f16 v62, v40, v42 op_sel:[0,1] op_sel_hi:[1,0]
  v_mfma_f32_16x16x32_bf16 v[76:79], v[244:247], v[52:55], 0
  v_pk_mul_f16 v63, v41, v42 op_sel:[0,0] op_sel_hi:[1,1]
  v_pk_mul_f16 v64, v41, v42 op_sel:[0,1] op_sel_hi:[1,0]
  v_mfma_f32_16x16x32_f16 v[76:79], v[172:175], v[56:59], v[76:79]
  v_pk_mul_f16 v65, v40, v43 op_sel:[0,0] op_sel_hi:[1,0]
  v_pk_mul_f16 v66, v41, v43 op_sel:[0,0] op_sel_hi:[1,0]
  v_pk_mul_f16 v67, v42, v43 op_sel:[0,0] op_sel_hi:[1,0]
  v_mfma_f32_16x16x32_f16 v[76:79], v[176:179], v[60:63], v[76:79]
  v_mul_f16_sdwa v52, v40, v40 dst_sel:WORD_0 dst_unused:UNUSED_PAD src0_sel:WORD_0 src1_sel:WORD_1
  v_mul_f16_sdwa v53, v42, v42 dst_sel:WORD_0 dst_unused:UNUSED_PAD src0_sel:WORD_0 src1_sel:WORD_1
  v_mfma_f32_16x16x32_f16 v[76:79], v[180:183], v[64:67], v[76:79]
  v_mul_f16_sdwa v52, v41, v41 dst_sel:WORD_1 dst_unused:UNUSED_PRESERVE src0_sel:WORD_0 src1_sel:WORD_1
  v_mul_f16_sdwa v53, v43, v43 dst_sel:WORD_1 dst_unused:UNUSED_PRESERVE src0_sel:WORD_0 src1_sel:WORD_1
  v_smfmac_f32_16x16x64_f16 v[80:83], v[220:223], v[60:67], v16
  v_pk_mul_f16 v54, v40, v47 op_sel:[0,0] op_sel_hi:[1,0]
  v_pk_mul_f16 v55, v41, v47 op_sel:[0,0] op_sel_hi:[1,0]
  v_mfma_f32_16x16x32_f16 v[68:71], v[88:91], v[60:63], v[68:71]
  v_pk_mul_f16 v56, v42, v47 op_sel:[0,0] op_sel_hi:[1,0]
  v_pk_mul_f16 v57, v40, v44 op_sel:[0,0] op_sel_hi:[1,1]
  v_mfma_f32_16x16x32_f16 v[68:71], v[92:95], v[64:67], v[68:71]
  v_pk_mul_f16 v58, v40, v44 op_sel:[0,1] op_sel_hi:[1,0]
  v_pk_mul_f16 v59, v40, v45 op_sel:[0,0] op_sel_hi:[1,1]
  v_mfma_f32_16x16x32_f16 v[72:75], v[132:135], v[60:63], v[72:75]
  v_pk_mul_f16 v60, v40, v45 op_sel:[0,1] op_sel_hi:[1,0]
  v_pk_mul_f16 v61, v40, v46 op_sel:[0,0] op_sel_hi:[1,1]
  v_mfma_f32_16x16x32_f16 v[72:75], v[136:139], v[64:67], v[72:75]
  v_pk_mul_f16 v62, v40, v46 op_sel:[0,1] op_sel_hi:[1,0]
  v_pk_mul_f16 v63, v41, v44 op_sel:[0,0] op_sel_hi:[1,1]
  v_mfma_f32_16x16x32_f16 v[72:75], v[140:143], v[52:55], v[72:75]
  v_pk_mul_f16 v64, v41, v44 op_sel:[0,1] op_sel_hi:[1,0]
  v_pk_mul_f16 v65, v41, v45 op_sel:[0,0] op_sel_hi:[1,1]
  v_mfma_f32_16x16x32_f16 v[72:75], v[144:147], v[56:59], v[72:75]
  v_pk_mul_f16 v66, v41, v45 op_sel:[0,1] op_sel_hi:[1,0]
  v_pk_mul_f16 v67, v41, v46 op_sel:[0,0] op_sel_hi:[1,1]
  v_smfmac_f32_16x16x64_f16 v[80:83], v[224:227], v[52:59], v16
  v_alignbit_b32 v48, v48, v48, v13
  v_alignbit_b32 v49, v49, v49, v13
  v_mfma_f32_16x16x32_f16 v[76:79], v[184:187], v[52:55], v[76:79]
  v_alignbit_b32 v50, v50, v50, v13
  ds_read_u16_d16_hi v32, v7 offset:96
  v_mfma_f32_16x16x32_f16 v[76:79], v[188:191], v[56:59], v[76:79]
  ds_read_u16_d16_hi v33, v7 offset:224
  ds_read_u16_d16_hi v34, v7 offset:352
  s_cmp_lg_u32 s99, 8
  s_cbranch_scc1 L_hk
  s_waitcnt vmcnt(0)
  v_readfirstlane_b32 s81, v250
  s_mov_b32 s99, 0
  s_add_u32 s81, s81, 1
  s_cmp_ge_u32 s81, 36
  s_cbranch_scc1 L_hk
  s_add_u32 s72, s72, 1
  s_mov_b32 s26, 10240
  s_cmp_lt_u32 s81, 20
  s_cbranch_scc1 L_hkf
  s_add_u32 s81, s81, 20
  s_and_b32 s94, s81, 1
  s_lshr_b32 s81, s81, 1
  s_mov_b32 s96, 1
  s_lshl_b32 s94, s94, 6
  v_xor_b32 v18, s94, v18
  s_lshl_b32 s94, s94, 5
  s_add_u32 s26, s26, s94
L_hkf:
  s_add_u32 s81, s81, 484
  s_lshl_b32 s94, s81, 2
  s_add_u32 s26, s26, s94
  s_andn2_b32 s94, s98, 0x3fff
  s_add_u32 s26, s26, s94
  s_lshr_b32 s94, s94, 5
  s_add_u32 s94, s94, s81
  s_mul_i32 s94, s94, 104
L_hk:
  buffer_load_dwordx4 v[24:27], v17, s[28:31], s94 offen offset:0
  v_mfma_f32_16x16x32_f16 v[68:71], v[96:99], v[52:55], v[68:71]
  v_pk_mul_f16 v52, v41, v46 op_sel:[0,1] op_sel_hi:[1,0]
  v_pk_mul_f16 v53, v42, v44 op_sel:[0,0] op_sel_hi:[1,1]
  v_mfma_f32_16x16x32_f16 v[68:71], v[100:103], v[56:59], v[68:71]
  v_pk_mul_f16 v54, v42, v44 op_sel:[0,1] op_sel_hi:[1,0]
  v_pk_mul_f16 v55, v42, v45 op_sel:[0,0] op_sel_hi:[1,1]
  v_mfma_f32_16x16x32_f16 v[68:71], v[104:107], v[60:63], v[68:71]
  v_pk_mul_f16 v56, v42, v45 op_sel:[0,1] op_sel_hi:[1,0]
  v_pk_mul_f16 v57, v42, v46 op_sel:[0,0] op_sel_hi:[1,1]
  v_mfma_f32_16x16x32_f16 v[68:71], v[108:111], v[64:67], v[68:71]
  v_pk_mul_f16 v58, v42, v46 op_sel:[0,1] op_sel_hi:[1,0]
  v_pk_mul_f16 v59, v40, v48 op_sel:[0,0] op_sel_hi:[1,1]
  v_smfmac_f32_16x16x64_f16 v[80:83], v[228:231], v[60:67], v16
  ds_read_u16_d16_hi v35, v7 offset:480
  ds_read_u16_d16_hi v36, v7 offset:608
  v_mfma_f32_16x16x32_f16 v[72:75], v[148:151], v[60:63], v[72:75]
  ds_read_u16_d16_hi v37, v7 offset:736
  ds_read_u16_d16_hi v38, v7 offset:864
  v_mfma_f32_16x16x32_f16 v[72:75], v[152:155], v[64:67], v[72:75]
  ds_read_u16_d16_hi v39, v7 offset:992
  v_mfma_f32_16x16x32_f16 v[76:79], v[192:195], v[60:63], v[76:79]
  v_pk_mul_f16 v60, v41, v49 op_sel:[0,0] op_sel_hi:[1,1]
  v_pk_mul_f16 v61, v42, v50 op_sel:[0,0] op_sel_hi:[1,1]
  v_mfma_f32_16x16x32_f16 v[76:79], v[196:199], v[64:67], v[76:79]
  v_pk_mul_f16 v62, v40, v49 op_sel:[0,0] op_sel_hi:[1,1]
  v_pk_mul_f16 v63, v40, v49 op_sel:[0,1] op_sel_hi:[1,0]
  v_mfma_f32_16x16x32_f16 v[76:79], v[200:203], v[52:55], v[76:79]
  v_pk_mul_f16 v64, v40, v50 op_sel:[0,0] op_sel_hi:[1,1]
  v_pk_mul_f16 v65, v40, v50 op_sel:[0,1] op_sel_hi:[1,0]
  s_cmp_lg_u32 s84, 0
  s_cbranch_scc1 L_pr110
  s_setprio 0
L_pr110:
  v_mfma_f32_16x16x32_f16 v[76:79], v[204:207], v[56:59], v[76:79]
  v_pk_mul_f16 v66, v41, v50 op_sel:[0,0] op_sel_hi:[1,1]
  v_pk_mul_f16 v67, v41, v50 op_sel:[0,1] op_sel_hi:[1,0]
  v_smfmac_f32_16x16x64_f16 v[80:83], v[232:235], v[52:59], v16
  s_waitcnt lgkmcnt(0)
  v_cvt_pk_f16_f32 v43, v38, v39
  v_mfma_f32_16x16x32_f16 v[72:75], v[156:159], v[52:55], v[72:75]
  v_cvt_pk_f16_f32 v40, v32, v35
  v_cvt_pk_f16_f32 v41, v33, v36
  v_mfma_f32_16x16x32_f16 v[72:75], v[160:163], v[56:59], v[72:75]
  v_cvt_pk_f16_f32 v42, v34, v37
  v_mfma_f32_16x16x32_f16 v[68:71], v[112:115], v[52:55], v[68:71]
  ds_write_b128 v10, v[40:43]
  v_mfma_f32_16x16x32_f16 v[68:71], v[116:119], v[56:59], v[68:71]
  v_add_u32 v7, s75, v7
  s_waitcnt vmcnt(1)
  v_mfma_f32_16x16x32_f16 v[68:71], v[120:123], v[60:63], v[68:71]
  ds_read_b128 v[44:47], v11
  ds_read_b128 v[48:51], v12
  v_mfma_f32_16x16x32_f16 v[68:71], v[124:127], v[64:67], v[68:71]
  ds_read_b64_tr_b16 v[52:53], v8 offset:96
  ds_read_b64_tr_b16 v[54:55], v8 offset:608
  v_mfma_f32_16x16x32_f16 v[72:75], v[164:167], v[60:63], v[72:75]
  v_pk_mul_f16 v56, v40, v40 op_sel:[0,0] op_sel_hi:[1,1]
  v_pk_mul_f16 v57, v41, v41 op_sel:[0,0] op_sel_hi:[1,1]
  v_mfma_f32_16x16x32_f16 v[72:75], v[168:171], v[64:67], v[72:75]
  v_pk_mul_f16 v58, v42, v42 op_sel:[0,0] op_sel_hi:[1,1]
  v_pk_mul_f16 v59, v40, v41 op_sel:[0,0] op_sel_hi:[1,1]
  v_smfmac_f32_16x16x64_f16 v[80:83], v[236:239], v[60:67], v16
  ds_read_u16_d16_hi v32, v7 offset:0
  ds_read_u16_d16_hi v33, v7 offset:128
  v_mfma_f32_16x16x32_f16 v[76:79], v[208:211], v[60:63], v[76:79]
  s_nop 1
  v_fmac_f32 v14, v68, v72
  v_fmac_f32 v14, v69, v73
  v_mfma_f32_16x16x32_f16 v[76:79], v[212:215], v[64:67], v[76:79]
  v_fmac_f32 v14, v70, v74
  v_fmac_f32 v14, v71, v75
  s_waitcnt lgkmcnt(2)
  v_mfma_f32_16x16x32_bf16 v[72:75], v[240:243], v[52:55], 0
  v_add_f32 v22, v80, v81
  v_add_f32 v23, v82, v83
  v_mfma_f32_16x16x32_f16 v[72:75], v[128:131], v[56:59], v[72:75]
  s_nop 0
  v_fmac_f32 v14, v76, v77
  v_fmac_f32 v14, v22, v78
  v_mfma_f32_16x16x32_f16 v[68:71], v[84:87], v[56:59], 0
  v_fmac_f32 v14, v23, v79
  v_pk_mul_f16 v60, v40, v41 op_sel:[0,1] op_sel_hi:[1,0]
  v_mfma_f32_16x16x32_f16 v[80:83], v[216:219], v[56:59], 0
  v_pk_mul_f16 v61, v40, v42 op_sel:[0,0] op_sel_hi:[1,1]
  v_pk_mul_f16 v62, v40, v42 op_sel:[0,1] op_sel_hi:[1,0]
  v_mfma_f32_16x16x32_bf16 v[76:79], v[244:247], v[52:55], 0
  v_pk_mul_f16 v63, v41, v42 op_sel:[0,0] op_sel_hi:[1,1]
  v_pk_mul_f16 v64, v41, v42 op_sel:[0,1] op_sel_hi:[1,0]
  v_mfma_f32_16x16x32_f16 v[76:79], v[172:175], v[56:59], v[76:79]
  v_pk_mul_f16 v65, v40, v43 op_sel:[0,0] op_sel_hi:[1,0]
  v_pk_mul_f16 v66, v41, v43 op_sel:[0,0] op_sel_hi:[1,0]
  v_pk_mul_f16 v67, v42, v43 op_sel:[0,0] op_sel_hi:[1,0]
  v_mfma_f32_16x16x32_f16 v[76:79], v[176:179], v[60:63], v[76:79]
  v_mul_f16_sdwa v52, v40, v40 dst_sel:WORD_0 dst_unused:UNUSED_PAD src0_sel:WORD_0 src1_sel:WORD_1
  v_mul_f16_sdwa v53, v42, v42 dst_sel:WORD_0 dst_unused:UNUSED_PAD src0_sel:WORD_0 src1_sel:WORD_1
  v_mfma_f32_16x16x32_f16 v[76:79], v[180:183], v[64:67], v[76:79]
  v_mul_f16_sdwa v52, v41, v41 dst_sel:WORD_1 dst_unused:UNUSED_PRESERVE src0_sel:WORD_0 src1_sel:WORD_1
  v_mul_f16_sdwa v53, v43, v43 dst_sel:WORD_1 dst_unused:UNUSED_PRESERVE src0_sel:WORD_0 src1_sel:WORD_1
  v_smfmac_f32_16x16x64_f16 v[80:83], v[220:223], v[60:67], v16
  v_pk_mul_f16 v54, v40, v47 op_sel:[0,0] op_sel_hi:[1,0]
  v_pk_mul_f16 v55, v41, v47 op_sel:[0,0] op_sel_hi:[1,0]
  v_mfma_f32_16x16x32_f16 v[68:71], v[88:91], v[60:63], v[68:71]
  v_pk_mul_f16 v56, v42, v47 op_sel:[0,0] op_sel_hi:[1,0]
  v_pk_mul_f16 v57, v40, v44 op_sel:[0,0] op_sel_hi:[1,1]
  v_mfma_f32_16x16x32_f16 v[68:71], v[92:95], v[64:67], v[68:71]
  v_pk_mul_f16 v58, v40, v44 op_sel:[0,1] op_sel_hi:[1,0]
  v_pk_mul_f16 v59, v40, v45 op_sel:[0,0] op_sel_hi:[1,1]
  v_mfma_f32_16x16x32_f16 v[72:75], v[132:135], v[60:63], v[72:75]
  v_pk_mul_f16 v60, v40, v45 op_sel:[0,1] op_sel_hi:[1,0]
  v_pk_mul_f16 v61, v40, v46 op_sel:[0,0] op_sel_hi:[1,1]
  v_mfma_f32_16x16x32_f16 v[72:75], v[136:139], v[64:67], v[72:75]
  v_pk_mul_f16 v62, v40, v46 op_sel:[0,1] op_sel_hi:[1,0]
  v_pk_mul_f16 v63, v41, v44 op_sel:[0,0] op_sel_hi:[1,1]
  v_mfma_f32_16x16x32_f16 v[72:75], v[140:143], v[52:55], v[72:75]
  v_pk_mul_f16 v64, v41, v44 op_sel:[0,1] op_sel_hi:[1,0]
  v_pk_mul_f16 v65, v41, v45 op_sel:[0,0] op_sel_hi:[1,1]
  v_mfma_f32_16x16x32_f16 v[72:75], v[144:147], v[56:59], v[72:75]
  v_pk_mul_f16 v66, v41, v45 op_sel:[0,1] op_sel_hi:[1,0]
  v_pk_mul_f16 v67, v41, v46 op_sel:[0,0] op_sel_hi:[1,1]
  v_smfmac_f32_16x16x64_f16 v[80:83], v[224:227], v[52:59], v16
  v_alignbit_b32 v48, v48, v48, v13
  v_alignbit_b32 v49, v49, v49, v13
  v_mfma_f32_16x16x32_f16 v[76:79], v[184:187], v[52:55], v[76:79]
  v_alignbit_b32 v50, v50, v50, v13
  ds_read_u16_d16_hi v34, v7 offset:256
  v_mfma_f32_16x16x32_f16 v[76:79], v[188:191], v[56:59], v[76:79]
  ds_read_u16_d16_hi v35, v7 offset:384
  ds_read_u16_d16_hi v36, v7 offset:512
  v_mfma_f32_16x16x32_f16 v[68:71], v[96:99], v[52:55], v[68:71]
  v_pk_mul_f16 v52, v41, v46 op_sel:[0,1] op_sel_hi:[1,0]
  v_pk_mul_f16 v53, v42, v44 op_sel:[0,0] op_sel_hi:[1,1]
  v_mfma_f32_16x16x32_f16 v[68:71], v[100:103], v[56:59], v[68:71]
  v_pk_mul_f16 v54, v42, v44 op_sel:[0,1] op_sel_hi:[1,0]
  v_pk_mul_f16 v55, v42, v45 op_sel:[0,0] op_sel_hi:[1,1]
  v_mfma_f32_16x16x32_f16 v[68:71], v[104:107], v[60:63], v[68:71]
  v_pk_mul_f16 v56, v42, v45 op_sel:[0,1] op_sel_hi:[1,0]
  v_pk_mul_f16 v57, v42, v46 op_sel:[0,0] op_sel_hi:[1,1]
  v_mfma_f32_16x16x32_f16 v[68:71], v[108:111], v[64:67], v[68:71]
  v_pk_mul_f16 v58, v42, v46 op_sel:[0,1] op_sel_hi:[1,0]
  v_pk_mul_f16 v59, v40, v48 op_sel:[0,0] op_sel_hi:[1,1]
  v_smfmac_f32_16x16x64_f16 v[80:83], v[228:231], v[60:67], v16
  ds_read_u16_d16_hi v37, v7 offset:640
  ds_read_u16_d16_hi v38, v7 offset:768
  v_mfma_f32_16x16x32_f16 v[72:75], v[148:151], v[60:63], v[72:75]
  ds_read_u16_d16_hi v39, v7 offset:896
  s_add_u32 s81, s74, s75
  v_add_u32 v8, s81, v9
  v_mfma_f32_16x16x32_f16 v[72:75], v[152:155], v[64:67], v[72:75]
  v_mfma_f32_16x16x32_f16 v[76:79], v[192:195], v[60:63], v[76:79]
  v_pk_mul_f16 v60, v41, v49 op_sel:[0,0] op_sel_hi:[1,1]
  v_pk_mul_f16 v61, v42, v50 op_sel:[0,0] op_sel_hi:[1,1]
  v_mfma_f32_16x16x32_f16 v[76:79], v[196:199], v[64:67], v[76:79]
  v_pk_mul_f16 v62, v40, v49 op_sel:[0,0] op_sel_hi:[1,1]
  v_pk_mul_f16 v63, v40, v49 op_sel:[0,1] op_sel_hi:[1,0]
  v_mfma_f32_16x16x32_f16 v[76:79], v[200:203], v[52:55], v[76:79]
  v_pk_mul_f16 v64, v40, v50 op_sel:[0,0] op_sel_hi:[1,1]
  v_pk_mul_f16 v65, v40, v50 op_sel:[0,1] op_sel_hi:[1,0]
  v_mfma_f32_16x16x32_f16 v[76:79], v[204:207], v[56:59], v[76:79]
  v_pk_mul_f16 v66, v41, v50 op_sel:[0,0] op_sel_hi:[1,1]
  v_pk_mul_f16 v67, v41, v50 op_sel:[0,1] op_sel_hi:[1,0]
  v_smfmac_f32_16x16x64_f16 v[80:83], v[232:235], v[52:59], v16
  s_waitcnt lgkmcnt(0)
  v_cvt_pk_f16_f32 v43, v38, v39
  v_mfma_f32_16x16x32_f16 v[72:75], v[156:159], v[52:55], v[72:75]
  v_cvt_pk_f16_f32 v40, v32, v35
  v_cvt_pk_f16_f32 v41, v33, v36
  v_mfma_f32_16x16x32_f16 v[72:75], v[160:163], v[56:59], v[72:75]
  v_cvt_pk_f16_f32 v42, v34, v37
  v_mfma_f32_16x16x32_f16 v[68:71], v[112:115], v[52:55], v[68:71]
  ds_write_b128 v10, v[40:43]
  v_mfma_f32_16x16x32_f16 v[68:71], v[116:119], v[56:59], v[68:71]
  v_mfma_f32_16x16x32_f16 v[68:71], v[120:123], v[60:63], v[68:71]
  ds_read_b128 v[44:47], v11
  ds_read_b128 v[48:51], v12
  v_mfma_f32_16x16x32_f16 v[68:71], v[124:127], v[64:67], v[68:71]
  ds_read_b64_tr_b16 v[52:53], v8 offset:0
  ds_read_b64_tr_b16 v[54:55], v8 offset:512
  v_mfma_f32_16x16x32_f16 v[72:75], v[164:167], v[60:63], v[72:75]
  v_pk_mul_f16 v56, v40, v40 op_sel:[0,0] op_sel_hi:[1,1]
  v_pk_mul_f16 v57, v41, v41 op_sel:[0,0] op_sel_hi:[1,1]
  v_mfma_f32_16x16x32_f16 v[72:75], v[168:171], v[64:67], v[72:75]
  v_pk_mul_f16 v58, v42, v42 op_sel:[0,0] op_sel_hi:[1,1]
  v_pk_mul_f16 v59, v40, v41 op_sel:[0,0] op_sel_hi:[1,1]
  v_smfmac_f32_16x16x64_f16 v[80:83], v[236:239], v[60:67], v16
  ds_read_u16_d16_hi v32, v7 offset:32
  ds_read_u16_d16_hi v33, v7 offset:160
  v_mfma_f32_16x16x32_f16 v[76:79], v[208:211], v[60:63], v[76:79]
  s_nop 1
  v_fmac_f32 v14, v68, v72
  v_fmac_f32 v14, v69, v73
  v_mfma_f32_16x16x32_f16 v[76:79], v[212:215], v[64:67], v[76:79]
  v_fmac_f32 v14, v70, v74
  v_fmac_f32 v14, v71, v75
  s_cmp_lg_u32 s72, 1
  s_cbranch_scc1 L_cin_loop
  v_add_f32 v22, v80, v81
  v_add_f32 v23, v82, v83
  s_nop 1
  v_fmac_f32 v14, v76, v77
  v_fmac_f32 v14, v22, v78
  v_fmac_f32 v14, v23, v79
  s_nop 1
  v_add_f32_dpp v14, v14, v14 row_shr:1 row_mask:0xf bank_mask:0xf
  s_nop 1
  v_add_f32_dpp v14, v14, v14 row_shr:2 row_mask:0xf bank_mask:0xf
  s_nop 1
  v_add_f32_dpp v14, v14, v14 row_shr:4 row_mask:0xf bank_mask:0xf
  s_nop 1
  v_add_f32_dpp v14, v14, v14 row_shr:8 row_mask:0xf bank_mask:0xf
  s_nop 1
  v_add_f32_dpp v14, v14, v14 row_bcast:15 row_mask:0xa bank_mask:0xf
  s_nop 1
  v_add_f32_dpp v14, v14, v14 row_bcast:31 row_mask:0xc bank_mask:0xf
  s_branch L_blk
L_htail:
  v_add_f32 v22, v80, v81
  v_add_f32 v23, v82, v83
  s_nop 1
  v_fmac_f32 v14, v76, v77
  v_fmac_f32 v14, v22, v78
  v_fmac_f32 v14, v23, v79
  s_nop 1
  v_add_f32_dpp v14, v14, v14 row_shr:1 row_mask:0xf bank_mask:0xf
  s_nop 1
  v_add_f32_dpp v14, v14, v14 row_shr:2 row_mask:0xf bank_mask:0xf
  s_nop 1
  v_add_f32_dpp v14, v14, v14 row_shr:4 row_mask:0xf bank_mask:0xf
  s_nop 1
  v_add_f32_dpp v14, v14, v14 row_shr:8 row_mask:0xf bank_mask:0xf
  s_nop 1
  v_add_f32_dpp v14, v14, v14 row_bcast:15 row_mask:0xa bank_mask:0xf
  s_nop 1
  v_add_f32_dpp v14, v14, v14 row_bcast:31 row_mask:0xc bank_mask:0xf
  v_add_u32 v7, s75, v7
  s_branch L_blk
L_slow:
  v_subrev_u32 v7, s75, v7
L_slow2:
  v_lshlrev_b32 v22, 1, v0
  v_add_u32 v23, s74, v22
  s_mul_i32 s81, s3, 4224
  s_add_u32 s81, s81, 1024
  v_add_u32 v22, s81, v22
  v_add_u32 v8, s81, v9
L_csync10:
  ds_read_b32 v4, v2 offset:12
  s_waitcnt lgkmcnt(0)
  v_cmp_gt_u32 vcc, 8, v4
  s_cbranch_vccnz L_csync10
  ds_read_u16 v52, v23 offset:0
  ds_read_u16 v53, v23 offset:128
  ds_read_u16 v54, v23 offset:256
  ds_read_u16 v55, v23 offset:384
  ds_read_u16 v56, v23 offset:512
  ds_read_u16 v57, v23 offset:640
  ds_read_u16 v58, v23 offset:768
  ds_read_u16 v59, v23 offset:896
  ds_read_u16 v60, v23 offset:1056
  ds_read_u16 v61, v23 offset:1184
  ds_read_u16 v62, v23 offset:1312
  ds_read_u16 v63, v23 offset:1440
  ds_read_u16 v64, v23 offset:1568
  ds_read_u16 v65, v23 offset:1696
  ds_read_u16 v66, v23 offset:1824
  ds_read_u16 v67, v23 offset:1952
  ds_read_u16 v68, v23 offset:2112
  ds_read_u16 v69, v23 offset:2240
  ds_read_u16 v70, v23 offset:2368
  ds_read_u16 v71, v23 offset:2496
  ds_read_u16 v72, v23 offset:2624
  ds_read_u16 v73, v23 offset:2752
  ds_read_u16 v74, v23 offset:2880
  ds_read_u16 v75, v23 offset:3008
  ds_read_u16 v76, v23 offset:3168
  ds_read_u16 v77, v23 offset:3296
  ds_read_u16 v78, v23 offset:3424
  ds_read_u16 v79, v23 offset:3552
  ds_read_u16 v80, v23 offset:3680
  ds_read_u16 v81, v23 offset:3808
  ds_read_u16 v82, v23 offset:3936
  s_waitcnt lgkmcnt(14)
  v_lshlrev_b32 v52, 16, v52
  v_lshlrev_b32 v53, 16, v53
  v_lshlrev_b32 v54, 16, v54
  v_lshlrev_b32 v55, 16, v55
  v_lshlrev_b32 v56, 16, v56
  v_lshlrev_b32 v57, 16, v57
  v_lshlrev_b32 v58, 16, v58
  v_lshlrev_b32 v59, 16, v59
  v_lshlrev_b32 v60, 16, v60
  v_lshlrev_b32 v61, 16, v61
  v_lshlrev_b32 v62, 16, v62
  v_lshlrev_b32 v63, 16, v63
  v_lshlrev_b32 v64, 16, v64
  v_lshlrev_b32 v65, 16, v65
  v_lshlrev_b32 v66, 16, v66
  v_lshlrev_b32 v67, 16, v67
  v_lshlrev_b32 v68, 16, v68
  s_waitcnt lgkmcnt(13)
  v_lshlrev_b32 v69, 16, v69
  s_waitcnt lgkmcnt(12)
  v_lshlrev_b32 v70, 16, v70
  s_waitcnt lgkmcnt(11)
  v_lshlrev_b32 v71, 16, v71
  s_waitcnt lgkmcnt(10)
  v_lshlrev_b32 v72, 16, v72
  s_waitcnt lgkmcnt(9)
  v_lshlrev_b32 v73, 16, v73
  s_waitcnt lgkmcnt(8)
  v_lshlrev_b32 v74, 16, v74
  s_waitcnt lgkmcnt(7)
  v_lshlrev_b32 v75, 16, v75
  s_waitcnt lgkmcnt(6)
  v_lshlrev_b32 v76, 16, v76
  s_waitcnt lgkmcnt(5)
  v_lshlrev_b32 v77, 16, v77
  s_waitcnt lgkmcnt(4)
  v_lshlrev_b32 v78, 16, v78
  s_waitcnt lgkmcnt(3)
  v_lshlrev_b32 v79, 16, v79
  s_waitcnt lgkmcnt(2)
  v_lshlrev_b32 v80, 16, v80
  s_waitcnt lgkmcnt(1)
  v_lshlrev_b32 v81, 16, v81
  s_waitcnt lgkmcnt(0)
  v_lshlrev_b32 v82, 16, v82
  v_max3_f32 v14, abs(v52), abs(v53), abs(v54)
  v_max3_f32 v14, v14, abs(v55), abs(v56)
  v_max3_f32 v14, v14, abs(v57), abs(v58)
  v_max3_f32 v14, v14, abs(v59), abs(v60)
  v_max3_f32 v14, v14, abs(v61), abs(v62)
  v_max3_f32 v14, v14, abs(v63), abs(v64)
  v_max3_f32 v14, v14, abs(v65), abs(v66)
  v_max3_f32 v14, v14, abs(v67), abs(v68)
  v_max3_f32 v14, v14, abs(v69), abs(v70)
  v_max3_f32 v14, v14, abs(v71), abs(v72)
  v_max3_f32 v14, v14, abs(v73), abs(v74)
  v_max3_f32 v14, v14, abs(v75), abs(v76)
  v_max3_f32 v14, v14, abs(v77), abs(v78)
  v_max3_f32 v14, v14, abs(v79), abs(v80)
  v_max3_f32 v14, v14, abs(v81), abs(v82)
  s_nop 1
  v_max_u32_dpp v14, v14, v14 row_shr:1 row_mask:0xf bank_mask:0xf
  s_nop 1
  v_max_u32_dpp v14, v14, v14 row_shr:2 row_mask:0xf bank_mask:0xf
  s_nop 1
  v_max_u32_dpp v14, v14, v14 row_shr:4 row_mask:0xf bank_mask:0xf
  s_nop 1
  v_max_u32_dpp v14, v14, v14 row_shr:8 row_mask:0xf bank_mask:0xf
  s_nop 1
  v_max_u32_dpp v14, v14, v14 row_bcast:15 row_mask:0xa bank_mask:0xf
  s_nop 1
  v_max_u32_dpp v14, v14, v14 row_bcast:31 row_mask:0xc bank_mask:0xf
  s_nop 0
  v_readlane_b32 s81, v14, 63
  s_nop 0
  s_lshr_b32 s81, s81, 23
  s_sub_i32 s81, 134, s81
  s_cmp_le_u32 s81, 9
  s_cselect_b32 s97, 2, 3
  s_min_i32 s81, s81, 16
  s_lshl_b32 s49, s81, 2
  s_sub_i32 s49, s48, s49
  s_add_i32 s81, s81, 127
  s_lshl_b32 s81, s81, 23
  v_mov_b32 v83, s81
  v_mul_f32 v52, s81, v52
  v_mul_f32 v53, s81, v53
  v_mul_f32 v54, s81, v54
  v_mul_f32 v55, s81, v55
  v_mul_f32 v56, s81, v56
  v_mul_f32 v57, s81, v57
  v_mul_f32 v58, s81, v58
  v_mul_f32 v59, s81, v59
  v_mul_f32 v60, s81, v60
  v_mul_f32 v61, s81, v61
  v_mul_f32 v62, s81, v62
  v_mul_f32 v63, s81, v63
  v_mul_f32 v64, s81, v64
  v_mul_f32 v65, s81, v65
  v_mul_f32 v66, s81, v66
  v_mul_f32 v67, s81, v67
  v_mul_f32 v68, s81, v68
  v_mul_f32 v69, s81, v69
  v_mul_f32 v70, s81, v70
  v_mul_f32 v71, s81, v71
  v_mul_f32 v72, s81, v72
  v_mul_f32 v73, s81, v73
  v_mul_f32 v74, s81, v74
  v_mul_f32 v75, s81, v75
  v_mul_f32 v76, s81, v76
  v_mul_f32 v77, s81, v77
  v_mul_f32 v78, s81, v78
  v_mul_f32 v79, s81, v79
  v_mul_f32 v80, s81, v80
  v_mul_f32 v81, s81, v81
  v_mul_f32 v82, s81, v82
  ds_write_b16_d16_hi v23, v52 offset:0
  ds_write_b16_d16_hi v23, v53 offset:128
  ds_write_b16_d16_hi v23, v54 offset:256
  ds_write_b16_d16_hi v23, v55 offset:384
  ds_write_b16_d16_hi v23, v56 offset:512
  ds_write_b16_d16_hi v23, v57 offset:640
  ds_write_b16_d16_hi v23, v58 offset:768
  ds_write_b16_d16_hi v23, v59 offset:896
  ds_write_b16_d16_hi v23, v60 offset:1056
  ds_write_b16_d16_hi v23, v61 offset:1184
  ds_write_b16_d16_hi v23, v62 offset:1312
  ds_write_b16_d16_hi v23, v63 offset:1440
  ds_write_b16_d16_hi v23, v64 offset:1568
  ds_write_b16_d16_hi v23, v65 offset:1696
  ds_write_b16_d16_hi v23, v66 offset:1824
  ds_write_b16_d16_hi v23, v67 offset:1952
  ds_write_b16_d16_hi v23, v68 offset:2112
  ds_write_b16_d16_hi v23, v69 offset:2240
  ds_write_b16_d16_hi v23, v70 offset:2368
  ds_write_b16_d16_hi v23, v71 offset:2496
  ds_write_b16_d16_hi v23, v72 offset:2624
  ds_write_b16_d16_hi v23, v73 offset:2752
  ds_write_b16_d16_hi v23, v74 offset:2880
  ds_write_b16_d16_hi v23, v75 offset:3008
  ds_write_b16_d16_hi v23, v76 offset:3168
  ds_write_b16_d16_hi v23, v77 offset:3296
  ds_write_b16_d16_hi v23, v78 offset:3424
  ds_write_b16_d16_hi v23, v79 offset:3552
  ds_write_b16_d16_hi v23, v80 offset:3680
  ds_write_b16_d16_hi v23, v81 offset:3808
  ds_write_b16_d16_hi v23, v82 offset:3936
  v_mul_f32 v52, s81, v52
  v_mul_f32 v53, s81, v53
  v_mul_f32 v54, s81, v54
  v_mul_f32 v55, s81, v55
  v_mul_f32 v56, s81, v56
  v_mul_f32 v57, s81, v57
  v_mul_f32 v58, s81, v58
  v_mul_f32 v59, s81, v59
  v_mul_f32 v60, s81, v60
  v_mul_f32 v61, s81, v61
  v_mul_f32 v62, s81, v62
  v_mul_f32 v63, s81, v63
  v_mul_f32 v64, s81, v64
  v_mul_f32 v65, s81, v65
  v_mul_f32 v66, s81, v66
  v_mul_f32 v67, s81, v67
  v_mul_f32 v68, s81, v68
  v_mul_f32 v69, s81, v69
  v_mul_f32 v70, s81, v70
  v_mul_f32 v71, s81, v71
  v_mul_f32 v72, s81, v72
  v_mul_f32 v73, s81, v73
  v_mul_f32 v74, s81, v74
  v_mul_f32 v75, s81, v75
  v_mul_f32 v76, s81, v76
  v_mul_f32 v77, s81, v77
  v_mul_f32 v78, s81, v78
  v_mul_f32 v79, s81, v79
  v_mul_f32 v80, s81, v80
  v_mul_f32 v81, s81, v81
  v_mul_f32 v82, s81, v82
  v_mul_f32 v83, s81, v83
  ds_write_b16_d16_hi v22, v52 offset:0
  ds_write_b16_d16_hi v22, v53 offset:128
  ds_write_b16_d16_hi v22, v54 offset:256
  ds_write_b16_d16_hi v22, v55 offset:384
  ds_write_b16_d16_hi v22, v56 offset:512
  ds_write_b16_d16_hi v22, v57 offset:640
  ds_write_b16_d16_hi v22, v58 offset:768
  ds_write_b16_d16_hi v22, v59 offset:896
  ds_write_b16_d16_hi v22, v60 offset:1056
  ds_write_b16_d16_hi v22, v61 offset:1184
  ds_write_b16_d16_hi v22, v62 offset:1312
  ds_write_b16_d16_hi v22, v63 offset:1440
  ds_write_b16_d16_hi v22, v64 offset:1568
  ds_write_b16_d16_hi v22, v65 offset:1696
  ds_write_b16_d16_hi v22, v66 offset:1824
  ds_write_b16_d16_hi v22, v67 offset:1952
  ds_write_b16_d16_hi v22, v68 offset:2112
  ds_write_b16_d16_hi v22, v69 offset:2240
  ds_write_b16_d16_hi v22, v70 offset:2368
  ds_write_b16_d16_hi v22, v71 offset:2496
  ds_write_b16_d16_hi v22, v72 offset:2624
  ds_write_b16_d16_hi v22, v73 offset:2752
  ds_write_b16_d16_hi v22, v74 offset:2880
  ds_write_b16_d16_hi v22, v75 offset:3008
  ds_write_b16_d16_hi v22, v76 offset:3168
  ds_write_b16_d16_hi v22, v77 offset:3296
  ds_write_b16_d16_hi v22, v78 offset:3424
  ds_write_b16_d16_hi v22, v79 offset:3552
  ds_write_b16_d16_hi v22, v80 offset:3680
  ds_write_b16_d16_hi v22, v81 offset:3808
  ds_write_b16_d16_hi v22, v82 offset:3936
  ds_write_b16_d16_hi v22, v83 offset:4064
  s_mov_b32 s50, 0
  s_waitcnt lgkmcnt(0)
  s_branch L_prime
L_cin_done:
  s_endpgm
L_rem:
  s_lshr_b32 s84, s3, 2
  s_and_b32 s68, s2, 7
  s_lshl_b32 s68, s68, 3
  s_add_u32 s68, s68, s3
  s_mul_i32 s68, s68, 6656
  s_lshl_b32 s76, s3, 14
  v_lshlrev_b32 v248, 4, v0
  v_lshrrev_b32 v246, 4, v0
  v_lshrrev_b32 v247, 3, v0
  v_mul_u32_u24 v13, 3328, v247
  v_and_b32 v247, 2, v247
  s_and_b32 s69, s3, 1
  s_lshl_b32 s69, s69, 2
  v_or_b32 v247, s69, v247
  v_and_b32 v9, 7, v0
  v_xor_b32 v247, v247, v9
  v_lshl_add_u32 v13, v247, 4, v13
  s_mul_i32 s74, s3, 26624
  s_add_u32 s74, s74, 3200
  s_lshl_b32 s75, s3, 10
  s_add_u32 s75, s75, 131072
  s_waitcnt lgkmcnt(0)
  s_load_dword s80, s[18:19], 0
  s_mov_b32 s28, s4
  s_and_b32 s29, s5, 0xffff
  s_mov_b32 s30, 425984
  s_mov_b32 s31, 0x20000
  s_add_u32 m0, s76, 8192
  s_nop 0
  buffer_load_dwordx4 v248, s[28:31], s68 offen lds
  s_add_u32 s68, s68, 1024
  s_add_u32 m0, s76, 9216
  s_nop 0
  buffer_load_dwordx4 v248, s[28:31], s68 offen lds
  s_add_u32 s68, s68, 1024
  s_add_u32 m0, s76, 10240
  s_nop 0
  buffer_load_dwordx4 v248, s[28:31], s68 offen lds
  s_add_u32 s68, s68, 1024
  s_add_u32 m0, s76, 11264
  s_nop 0
  buffer_load_dwordx4 v248, s[28:31], s68 offen lds
  s_add_u32 s68, s68, 1024
  s_add_u32 m0, s76, 12288
  s_nop 0
  buffer_load_dwordx4 v248, s[28:31], s68 offen lds
  s_add_u32 s68, s68, 1024
  s_add_u32 m0, s76, 13312
  s_nop 0
  buffer_load_dwordx4 v248, s[28:31], s68 offen lds
  s_add_u32 s68, s68, 1024
  s_add_u32 m0, s76, 14336
  s_nop 0
  buffer_load_dwordx4 v248, s[28:31], s68 offen lds
  s_add_u32 s68, s68, 1024
  s_mov_b32 s44, s12
  s_and_b32 s45, s13, 0xffff
  s_mov_b32 s46, 5537792
  s_mov_b32 s47, 0x20000
  s_add_u32 m0, s75, 0
  s_nop 0
  buffer_load_dwordx4 v13, s[44:47], s74 offen lds
  s_add_u32 s74, s74, 212992
  s_mov_b32 s60, s24
  s_and_b32 s61, s25, 0xffff
  s_mov_b32 s62, 268435456
  s_mov_b32 s63, 0x20000
  s_mov_b32 s64, s22
  s_and_b32 s65, s23, 0xffff
  s_mov_b32 s66, 256
  s_mov_b32 s67, 0x20000
  v_mov_b32 v64, -1
  v_mov_b32 v65, -1
  v_mov_b32 v66, -1
  v_mov_b32 v67, -1
  s_and_b32 s70, s2, 7
  s_lshl_b32 s68, s70, 3
  s_add_u32 s68, s68, s3
  s_lshl_b32 s68, s68, 11
  s_lshl_b32 s70, s70, 2
  buffer_store_dwordx4 v[64:67], v248, s[60:63], s68 offen sc1
  buffer_store_dwordx4 v[64:67], v248, s[60:63], s68 offen offset:1024 sc1
  s_mov_b32 s48, s14
  s_and_b32 s49, s15, 0xffff
  s_mov_b32 s50, 3328
  s_mov_b32 s51, 0x20000
  s_mov_b32 s52, s16
  s_and_b32 s53, s17, 0xffff
  s_mov_b32 s54, 3328
  s_mov_b32 s55, 0x20000
  s_mov_b32 s32, s6
  s_and_b32 s33, s7, 0xffff
  s_mov_b32 s34, 12800000
  s_mov_b32 s35, 0x20000
  v_xor_b32 v248, v9, v246
  v_lshlrev_b32 v14, 4, v248
  v_xor_b32 v15, 64, v14
  v_bfe_u32 v247, v0, 2, 2
  v_lshl_add_u32 v248, v246, 3, v247
  v_lshlrev_b32 v248, 7, v248
  v_and_b32 v247, 3, v0
  v_lshl_add_u32 v248, v247, 3, v248
  v_add_u32 v248, 131072, v248
  v_bfe_u32 v247, v0, 3, 2
  v_lshl_add_u32 v1, v247, 5, v248
  v_xor_b32 v2, 32, v1
  v_xor_b32 v7, 64, v1
  v_xor_b32 v8, 96, v1
  v_and_b32 v248, 15, v0
  v_lshlrev_b32 v248, 7, v248
  v_bfe_u32 v247, v0, 1, 3
  v_xor_b32 v247, v247, v246
  v_lshl_add_u32 v248, v247, 4, v248
  v_add_u32 v11, s76, v248
  v_xor_b32 v12, 64, v11
  v_lshrrev_b32 v247, 3, v0
  v_lshl_add_u32 v248, v9, 3, v247
  v_mul_u32_u24 v248, 104, v248
  v_add_u32 v248, s76, v248
  s_mov_b32 s56, s20
  s_and_b32 s57, s21, 0xffff
  s_mov_b32 s58, 8192
  s_mov_b32 s59, 0x20000
  s_and_b32 s77, s2, 7
  s_lshl_b32 s68, s77, 14
  s_lshl_b32 s69, s3, 8
  s_add_u32 s68, s68, s69
  s_add_u32 s69, s68, 4096
  s_add_u32 s71, s68, 8192
  s_lshl_b32 s77, s77, 3
  s_add_u32 s77, s77, s3
  s_lshl_b32 s77, s77, 7
  v_lshlrev_b32 v3, 2, v0
  v_lshlrev_b32 v4, 1, v0
  s_lshl_b32 s81, s3, 6
  v_add_u32 v5, s81, v0
  v_cmp_lt_u32 vcc, 503, v5
  v_add_u32 v5, 4096, v3
  v_mov_b32 v6, 0x7f000000
  v_cndmask_b32 v5, v6, v5, vcc
  v_mov_b32 v240, 0xc0135761
  v_mov_b32 v241, 0xc0135761
  v_mov_b32 v242, 0xbdd2d3e8
  v_mov_b32 v243, 0xbdd2d3e8
  v_mov_b32 v244, 0x71800000
  v_mov_b32 v160, 0
  v_mov_b32 v161, 0
  v_mov_b32 v162, 0
  v_mov_b32 v163, 0
  v_mov_b32 v164, 0
  v_mov_b32 v165, 0
  v_mov_b32 v166, 0
  v_mov_b32 v167, 0
  v_mov_b32 v168, 0
  v_mov_b32 v169, 0
  v_mov_b32 v170, 0
  v_mov_b32 v171, 0
  v_mov_b32 v172, 0
  v_mov_b32 v173, 0
  v_mov_b32 v174, 0
  v_mov_b32 v175, 0
  v_mov_b32 v176, 0
  v_mov_b32 v177, 0
  v_mov_b32 v178, 0
  v_mov_b32 v179, 0
  v_mov_b32 v180, 0
  v_mov_b32 v181, 0
  v_mov_b32 v182, 0
  v_mov_b32 v183, 0
  v_mov_b32 v184, 0
  v_mov_b32 v185, 0
  v_mov_b32 v186, 0
  v_mov_b32 v187, 0
  v_mov_b32 v188, 0
  v_mov_b32 v189, 0
  v_mov_b32 v190, 0
  v_mov_b32 v191, 0
  v_mov_b32 v192, 0
  v_mov_b32 v193, 0
  v_mov_b32 v194, 0
  v_mov_b32 v195, 0
  v_mov_b32 v196, 0
  v_mov_b32 v197, 0
  v_mov_b32 v198, 0
  v_mov_b32 v199, 0
  v_mov_b32 v200, 0
  v_mov_b32 v201, 0
  v_mov_b32 v202, 0
  v_mov_b32 v203, 0
  v_mov_b32 v204, 0
  v_mov_b32 v205, 0
  v_mov_b32 v206, 0
  v_mov_b32 v207, 0
  v_mov_b32 v208, 0
  v_mov_b32 v209, 0
  v_mov_b32 v210, 0
  v_mov_b32 v211, 0
  v_mov_b32 v212, 0
  v_mov_b32 v213, 0
  v_mov_b32 v214, 0
  v_mov_b32 v215, 0
  v_mov_b32 v216, 0
  v_mov_b32 v217, 0
  v_mov_b32 v218, 0
  v_mov_b32 v219, 0
  v_mov_b32 v220, 0
  v_mov_b32 v221, 0
  v_mov_b32 v222, 0
  v_mov_b32 v223, 0
  s_waitcnt vmcnt(0) lgkmcnt(0)
  s_lshl_b32 s80, s80, 16
  ds_read_b64 v[32:33], v248 offset:8192
  ds_read_b64 v[34:35], v248 offset:8200
  ds_read_b64 v[36:37], v248 offset:8208
  ds_read_b64 v[38:39], v248 offset:8216
  ds_read_b64 v[40:41], v248 offset:8224
  ds_read_b64 v[42:43], v248 offset:8232
  ds_read_b64 v[44:45], v248 offset:8240
  ds_read_b64 v[46:47], v248 offset:8248
  ds_read_b64 v[48:49], v248 offset:8256
  ds_read_b64 v[50:51], v248 offset:8264
  ds_read_b64 v[52:53], v248 offset:8272
  ds_read_b64 v[54:55], v248 offset:8280
  ds_read_b64 v[56:57], v248 offset:8288
  v_mov_b32 v24, 0
  v_mov_b32 v25, 0
  v_mov_b32 v26, 0
  v_mov_b32 v27, 0
  v_mov_b32 v28, 0
  v_mov_b32 v29, 0
  v_mov_b32 v30, 0
  v_mov_b32 v31, 0
  v_mov_b32 v58, 0x7f000000
  v_mov_b32 v59, 0x7f000000
  s_waitcnt lgkmcnt(12)
  v_lshlrev_b32 v32, 7, v32
  s_nop 1
  v_add_u32_dpp v24, v32, v14 row_newbcast:0 row_mask:0xf bank_mask:0x3
  v_add_u32_dpp v25, v32, v15 row_newbcast:1 row_mask:0xf bank_mask:0x3
  v_add_u32_dpp v26, v32, v14 row_newbcast:2 row_mask:0xf bank_mask:0x3
  v_add_u32_dpp v27, v32, v15 row_newbcast:3 row_mask:0xf bank_mask:0x3
  v_add_u32_dpp v24, v32, v14 row_newbcast:8 row_mask:0xf bank_mask:0xc
  v_add_u32_dpp v25, v32, v15 row_newbcast:9 row_mask:0xf bank_mask:0xc
  v_add_u32_dpp v26, v32, v14 row_newbcast:10 row_mask:0xf bank_mask:0xc
  v_add_u32_dpp v27, v32, v15 row_newbcast:11 row_mask:0xf bank_mask:0xc
  s_add_u32 m0, s76, 0
  s_nop 0
  buffer_load_dwordx4 v24, s[32:35], 0 offen lds
  s_add_u32 m0, s76, 1024
  s_nop 0
  buffer_load_dwordx4 v25, s[32:35], 0 offen lds
  s_add_u32 m0, s76, 2048
  s_nop 0
  buffer_load_dwordx4 v26, s[32:35], 0 offen lds
  s_add_u32 m0, s76, 3072
  s_nop 0
  buffer_load_dwordx4 v27, s[32:35], 0 offen lds
  v_add_u32_dpp v28, v32, v14 row_newbcast:4 row_mask:0xf bank_mask:0x3
  v_add_u32_dpp v29, v32, v15 row_newbcast:5 row_mask:0xf bank_mask:0x3
  v_add_u32_dpp v30, v32, v14 row_newbcast:6 row_mask:0xf bank_mask:0x3
  v_add_u32_dpp v31, v32, v15 row_newbcast:7 row_mask:0xf bank_mask:0x3
  v_add_u32_dpp v28, v32, v14 row_newbcast:12 row_mask:0xf bank_mask:0xc
  v_add_u32_dpp v29, v32, v15 row_newbcast:13 row_mask:0xf bank_mask:0xc
  v_add_u32_dpp v30, v32, v14 row_newbcast:14 row_mask:0xf bank_mask:0xc
  v_add_u32_dpp v31, v32, v15 row_newbcast:15 row_mask:0xf bank_mask:0xc
  s_add_u32 m0, s76, 4096
  s_nop 0
  buffer_load_dwordx4 v28, s[32:35], 0 offen lds
  s_add_u32 m0, s76, 5120
  s_nop 0
  buffer_load_dwordx4 v29, s[32:35], 0 offen lds
  s_add_u32 m0, s76, 6144
  s_nop 0
  buffer_load_dwordx4 v30, s[32:35], 0 offen lds
  s_add_u32 m0, s76, 7168
  s_nop 0
  buffer_load_dwordx4 v31, s[32:35], 0 offen lds
  s_add_u32 m0, s75, 8192
  s_nop 0
  buffer_load_dwordx4 v13, s[44:47], s74 offen lds
  s_add_u32 s74, s74, 212992
  s_waitcnt lgkmcnt(0)
  v_lshlrev_b32 v57, 7, v57
  v_lshlrev_b32 v56, 7, v56
  v_lshlrev_b32 v55, 7, v55
  v_lshlrev_b32 v54, 7, v54
  v_lshlrev_b32 v53, 7, v53
  v_lshlrev_b32 v52, 7, v52
  v_lshlrev_b32 v51, 7, v51
  v_lshlrev_b32 v50, 7, v50
  v_lshlrev_b32 v49, 7, v49
  v_lshlrev_b32 v48, 7, v48
  v_lshlrev_b32 v47, 7, v47
  v_lshlrev_b32 v46, 7, v46
  v_lshlrev_b32 v45, 7, v45
  v_lshlrev_b32 v44, 7, v44
  v_lshlrev_b32 v43, 7, v43
  v_lshlrev_b32 v42, 7, v42
  v_lshlrev_b32 v41, 7, v41
  v_lshlrev_b32 v40, 7, v40
  v_lshlrev_b32 v39, 7, v39
  v_lshlrev_b32 v38, 7, v38
  v_lshlrev_b32 v37, 7, v37
  v_lshlrev_b32 v36, 7, v36
  v_lshlrev_b32 v35, 7, v35
  v_lshlrev_b32 v34, 7, v34
  v_lshlrev_b32 v33, 7, v33
  s_nop 1
  v_add_u32_dpp v24, v33, v14 row_newbcast:0 row_mask:0xf bank_mask:0x3
  v_add_u32_dpp v25, v33, v15 row_newbcast:1 row_mask:0xf bank_mask:0x3
  v_add_u32_dpp v26, v33, v14 row_newbcast:2 row_mask:0xf bank_mask:0x3
  v_add_u32_dpp v27, v33, v15 row_newbcast:3 row_mask:0xf bank_mask:0x3
  v_add_u32_dpp v24, v33, v14 row_newbcast:8 row_mask:0xf bank_mask:0xc
  v_add_u32_dpp v25, v33, v15 row_newbcast:9 row_mask:0xf bank_mask:0xc
  v_add_u32_dpp v26, v33, v14 row_newbcast:10 row_mask:0xf bank_mask:0xc
  v_add_u32_dpp v27, v33, v15 row_newbcast:11 row_mask:0xf bank_mask:0xc
  s_add_u32 m0, s76, 8192
  s_nop 0
  buffer_load_dwordx4 v24, s[32:35], 0 offen lds
  s_add_u32 m0, s76, 9216
  s_nop 0
  buffer_load_dwordx4 v25, s[32:35], 0 offen lds
  s_add_u32 m0, s76, 10240
  s_nop 0
  buffer_load_dwordx4 v26, s[32:35], 0 offen lds
  s_add_u32 m0, s76, 11264
  s_nop 0
  buffer_load_dwordx4 v27, s[32:35], 0 offen lds
  v_add_u32_dpp v28, v33, v14 row_newbcast:4 row_mask:0xf bank_mask:0x3
  v_add_u32_dpp v29, v33, v15 row_newbcast:5 row_mask:0xf bank_mask:0x3
  v_add_u32_dpp v30, v33, v14 row_newbcast:6 row_mask:0xf bank_mask:0x3
  v_add_u32_dpp v31, v33, v15 row_newbcast:7 row_mask:0xf bank_mask:0x3
  v_add_u32_dpp v28, v33, v14 row_newbcast:12 row_mask:0xf bank_mask:0xc
  v_add_u32_dpp v29, v33, v15 row_newbcast:13 row_mask:0xf bank_mask:0xc
  v_add_u32_dpp v30, v33, v14 row_newbcast:14 row_mask:0xf bank_mask:0xc
  v_add_u32_dpp v31, v33, v15 row_newbcast:15 row_mask:0xf bank_mask:0xc
  s_add_u32 m0, s76, 12288
  s_nop 0
  buffer_load_dwordx4 v28, s[32:35], 0 offen lds
  s_add_u32 m0, s76, 13312
  s_nop 0
  buffer_load_dwordx4 v29, s[32:35], 0 offen lds
  s_add_u32 m0, s76, 14336
  s_nop 0
  buffer_load_dwordx4 v30, s[32:35], 0 offen lds
  s_add_u32 m0, s76, 15360
  s_nop 0
  buffer_load_dwordx4 v31, s[32:35], 0 offen lds
  s_add_u32 m0, s75, 16384
  s_nop 0
  buffer_load_dwordx4 v13, s[44:47], s74 offen lds
  s_add_u32 s74, s74, 212992
  v_lshlrev_b32 v248, 3, v246
  s_mov_b32 s73, 3
  v_mov_b32 v9, v34
  s_nop 1
  v_add_u32_dpp v24, v9, v14 row_newbcast:0 row_mask:0xf bank_mask:0x3
  v_add_u32_dpp v25, v9, v15 row_newbcast:1 row_mask:0xf bank_mask:0x3
  v_add_u32_dpp v26, v9, v14 row_newbcast:2 row_mask:0xf bank_mask:0x3
  v_add_u32_dpp v27, v9, v15 row_newbcast:3 row_mask:0xf bank_mask:0x3
  v_add_u32_dpp v24, v9, v14 row_newbcast:8 row_mask:0xf bank_mask:0xc
  v_add_u32_dpp v25, v9, v15 row_newbcast:9 row_mask:0xf bank_mask:0xc
  v_add_u32_dpp v26, v9, v14 row_newbcast:10 row_mask:0xf bank_mask:0xc
  v_add_u32_dpp v27, v9, v15 row_newbcast:11 row_mask:0xf bank_mask:0xc
  s_waitcnt vmcnt(14)
  s_barrier
  ds_read_b128 v[76:79], v12 offset:2048
  ds_read_b128 v[72:75], v11 offset:2048
  ds_read_b128 v[68:71], v12 offset:0
  ds_read_b128 v[64:67], v11 offset:0
  ds_read_b64_tr_b16 v[96:97], v1 offset:0
  ds_read_b64_tr_b16 v[98:99], v1 offset:512
  ds_read_b64_tr_b16 v[100:101], v1 offset:4096
  ds_read_b64_tr_b16 v[102:103], v1 offset:4608
  ds_read_b64_tr_b16 v[104:105], v2 offset:0
  ds_read_b64_tr_b16 v[106:107], v2 offset:512
  ds_read_b64_tr_b16 v[108:109], v2 offset:4096
  ds_read_b64_tr_b16 v[110:111], v2 offset:4608
  ds_read_b64_tr_b16 v[112:113], v7 offset:0
  ds_read_b64_tr_b16 v[114:115], v7 offset:512
  ds_read_b64_tr_b16 v[116:117], v7 offset:4096
  ds_read_b64_tr_b16 v[118:119], v7 offset:4608
  ds_read_b64_tr_b16 v[120:121], v8 offset:0
  ds_read_b64_tr_b16 v[122:123], v8 offset:512
  ds_read_b64_tr_b16 v[124:125], v8 offset:4096
  ds_read_b64_tr_b16 v[126:127], v8 offset:4608
  s_cmp_lg_u32 s3, 7
  s_cbranch_scc1 L_rem_loop
  s_mov_b64 exec, 1
  buffer_store_dword v240, v14, s[64:67], s70 offen offset:128 sc1
  s_mov_b64 exec, -1
L_rem_loop:
  s_waitcnt vmcnt(9)
  s_barrier
  s_waitcnt lgkmcnt(8)
  v_mfma_f32_16x16x32_bf16 v[160:163], v[96:99], v[64:67], v[160:163]
  ds_read_b128 v[92:95], v12 offset:6144
  ds_read_b128 v[88:91], v11 offset:6144
  s_waitcnt lgkmcnt(14)
  v_mfma_f32_16x16x32_bf16 v[160:163], v[100:103], v[68:71], v[160:163]
  ds_read_b128 v[84:87], v12 offset:4096
  s_add_u32 m0, s76, 0
  s_nop 0
  buffer_load_dwordx4 v24, s[32:35], 0 offen lds
  v_mfma_f32_16x16x32_bf16 v[164:167], v[96:99], v[72:75], v[164:167]
  ds_read_b128 v[80:83], v11 offset:4096
  v_mfma_f32_16x16x32_bf16 v[164:167], v[100:103], v[76:79], v[164:167]
  ds_read_b64_tr_b16 v[128:129], v1 offset:8192
  s_waitcnt lgkmcnt(14)
  v_mfma_f32_16x16x32_bf16 v[176:179], v[104:107], v[64:67], v[176:179]
  ds_read_b64_tr_b16 v[130:131], v1 offset:8704
  s_add_u32 m0, s76, 1024
  s_nop 0
  buffer_load_dwordx4 v25, s[32:35], 0 offen lds
  s_waitcnt lgkmcnt(14)
  v_mfma_f32_16x16x32_bf16 v[176:179], v[108:111], v[68:71], v[176:179]
  ds_read_b64_tr_b16 v[132:133], v1 offset:12288
  v_mfma_f32_16x16x32_bf16 v[180:183], v[104:107], v[72:75], v[180:183]
  ds_read_b64_tr_b16 v[134:135], v1 offset:12800
  v_mfma_f32_16x16x32_bf16 v[180:183], v[108:111], v[76:79], v[180:183]
  ds_read_b64_tr_b16 v[136:137], v2 offset:8192
  s_waitcnt lgkmcnt(14)
  v_mfma_f32_16x16x32_bf16 v[192:195], v[112:115], v[64:67], v[192:195]
  ds_read_b64_tr_b16 v[138:139], v2 offset:8704
  s_add_u32 m0, s76, 2048
  s_nop 0
  buffer_load_dwordx4 v26, s[32:35], 0 offen lds
  s_waitcnt lgkmcnt(14)
  v_mfma_f32_16x16x32_bf16 v[192:195], v[116:119], v[68:71], v[192:195]
  ds_read_b64_tr_b16 v[140:141], v2 offset:12288
  v_mfma_f32_16x16x32_bf16 v[196:199], v[112:115], v[72:75], v[196:199]
  ds_read_b64_tr_b16 v[142:143], v2 offset:12800
  v_mfma_f32_16x16x32_bf16 v[196:199], v[116:119], v[76:79], v[196:199]
  v_add_u32_dpp v28, v9, v14 row_newbcast:4 row_mask:0xf bank_mask:0x3
  v_add_u32_dpp v29, v9, v15 row_newbcast:5 row_mask:0xf bank_mask:0x3
  s_waitcnt lgkmcnt(14)
  v_mfma_f32_16x16x32_bf16 v[208:211], v[120:123], v[64:67], v[208:211]
  s_add_u32 m0, s76, 3072
  s_nop 0
  buffer_load_dwordx4 v27, s[32:35], 0 offen lds
  v_add_u32_dpp v30, v9, v14 row_newbcast:6 row_mask:0xf bank_mask:0x3
  v_add_u32_dpp v31, v9, v15 row_newbcast:7 row_mask:0xf bank_mask:0x3
  s_waitcnt lgkmcnt(12)
  v_mfma_f32_16x16x32_bf16 v[208:211], v[124:127], v[68:71], v[208:211]
  v_add_u32_dpp v28, v9, v14 row_newbcast:12 row_mask:0xf bank_mask:0xc
  v_mfma_f32_16x16x32_bf16 v[212:215], v[120:123], v[72:75], v[212:215]
  v_add_u32_dpp v29, v9, v15 row_newbcast:13 row_mask:0xf bank_mask:0xc
  v_add_u32_dpp v30, v9, v14 row_newbcast:14 row_mask:0xf bank_mask:0xc
  v_mfma_f32_16x16x32_bf16 v[212:215], v[124:127], v[76:79], v[212:215]
  v_add_u32_dpp v31, v9, v15 row_newbcast:15 row_mask:0xf bank_mask:0xc
  s_waitcnt vmcnt(9)
  s_waitcnt lgkmcnt(8)
  v_mfma_f32_16x16x32_bf16 v[168:171], v[96:99], v[80:83], v[168:171]
  ds_read_b128 v[76:79], v12 offset:10240
  ds_read_b128 v[72:75], v11 offset:10240
  v_mfma_f32_16x16x32_bf16 v[168:171], v[100:103], v[84:87], v[168:171]
  ds_read_b128 v[68:71], v12 offset:8192
  s_add_u32 m0, s76, 4096
  s_nop 0
  buffer_load_dwordx4 v28, s[32:35], 0 offen lds
  v_mfma_f32_16x16x32_bf16 v[172:175], v[96:99], v[88:91], v[172:175]
  ds_read_b128 v[64:67], v11 offset:8192
  v_mfma_f32_16x16x32_bf16 v[172:175], v[100:103], v[92:95], v[172:175]
  ds_read_b64_tr_b16 v[144:145], v7 offset:8192
  v_mfma_f32_16x16x32_bf16 v[184:187], v[104:107], v[80:83], v[184:187]
  ds_read_b64_tr_b16 v[146:147], v7 offset:8704
  s_add_u32 m0, s76, 5120
  s_nop 0
  buffer_load_dwordx4 v29, s[32:35], 0 offen lds
  v_mfma_f32_16x16x32_bf16 v[184:187], v[108:111], v[84:87], v[184:187]
  ds_read_b64_tr_b16 v[148:149], v7 offset:12288
  v_mfma_f32_16x16x32_bf16 v[188:191], v[104:107], v[88:91], v[188:191]
  ds_read_b64_tr_b16 v[150:151], v7 offset:12800
  v_mfma_f32_16x16x32_bf16 v[188:191], v[108:111], v[92:95], v[188:191]
  ds_read_b64_tr_b16 v[152:153], v8 offset:8192
  s_add_u32 m0, s76, 6144
  s_nop 0
  buffer_load_dwordx4 v30, s[32:35], 0 offen lds
  v_mfma_f32_16x16x32_bf16 v[200:203], v[112:115], v[80:83], v[200:203]
  ds_read_b64_tr_b16 v[154:155], v8 offset:8704
  v_mfma_f32_16x16x32_bf16 v[200:203], v[116:119], v[84:87], v[200:203]
  ds_read_b64_tr_b16 v[156:157], v8 offset:12288
  v_mfma_f32_16x16x32_bf16 v[204:207], v[112:115], v[88:91], v[204:207]
  ds_read_b64_tr_b16 v[158:159], v8 offset:12800
  s_add_u32 m0, s76, 7168
  s_nop 0
  buffer_load_dwordx4 v31, s[32:35], 0 offen lds
  v_mfma_f32_16x16x32_bf16 v[204:207], v[116:119], v[92:95], v[204:207]
  s_set_gpr_idx_on s73, gpr_idx(SRC0)
  s_nop 0
  v_mov_b32 v9, v32
  s_set_gpr_idx_off
  s_add_u32 s73, s73, 1
  v_add_u32_dpp v24, v9, v14 row_newbcast:0 row_mask:0xf bank_mask:0x3
  v_mfma_f32_16x16x32_bf16 v[216:219], v[120:123], v[80:83], v[216:219]
  v_add_u32_dpp v25, v9, v15 row_newbcast:1 row_mask:0xf bank_mask:0x3
  v_add_u32_dpp v26, v9, v14 row_newbcast:2 row_mask:0xf bank_mask:0x3
  v_mfma_f32_16x16x32_bf16 v[216:219], v[124:127], v[84:87], v[216:219]
  s_xor_b32 s75, s75, 16384
  s_add_u32 m0, s75, 8192
  s_nop 0
  buffer_load_dwordx4 v13, s[44:47], s74 offen lds
  s_add_u32 s74, s74, 212992
  s_xor_b32 s75, s75, 16384
  v_add_u32_dpp v27, v9, v15 row_newbcast:3 row_mask:0xf bank_mask:0x3
  v_add_u32_dpp v24, v9, v14 row_newbcast:8 row_mask:0xf bank_mask:0xc
  v_mfma_f32_16x16x32_bf16 v[220:223], v[120:123], v[88:91], v[220:223]
  v_add_u32_dpp v25, v9, v15 row_newbcast:9 row_mask:0xf bank_mask:0xc
  v_add_u32_dpp v26, v9, v14 row_newbcast:10 row_mask:0xf bank_mask:0xc
  v_mfma_f32_16x16x32_bf16 v[220:223], v[124:127], v[92:95], v[220:223]
  v_add_u32_dpp v27, v9, v15 row_newbcast:11 row_mask:0xf bank_mask:0xc
L_rnv:
  s_waitcnt vmcnt(9)
  s_barrier
  v_xor_b32 v1, 16384, v1
  v_xor_b32 v2, 16384, v2
  v_xor_b32 v7, 16384, v7
  v_xor_b32 v8, 16384, v8
  s_waitcnt lgkmcnt(8)
  v_mfma_f32_16x16x32_bf16 v[160:163], v[128:131], v[64:67], v[160:163]
  ds_read_b128 v[92:95], v12 offset:14336
  ds_read_b128 v[88:91], v11 offset:14336
  v_mfma_f32_16x16x32_bf16 v[160:163], v[132:135], v[68:71], v[160:163]
  ds_read_b128 v[84:87], v12 offset:12288
  s_add_u32 m0, s76, 8192
  s_nop 0
  buffer_load_dwordx4 v24, s[32:35], 0 offen lds
  v_mfma_f32_16x16x32_bf16 v[164:167], v[128:131], v[72:75], v[164:167]
  ds_read_b128 v[80:83], v11 offset:12288
  v_mfma_f32_16x16x32_bf16 v[164:167], v[132:135], v[76:79], v[164:167]
  ds_read_b64_tr_b16 v[96:97], v1 offset:0
  v_mfma_f32_16x16x32_bf16 v[176:179], v[136:139], v[64:67], v[176:179]
  ds_read_b64_tr_b16 v[98:99], v1 offset:512
  s_add_u32 m0, s76, 9216
  s_nop 0
  buffer_load_dwordx4 v25, s[32:35], 0 offen lds
  v_mfma_f32_16x16x32_bf16 v[176:179], v[140:143], v[68:71], v[176:179]
  ds_read_b64_tr_b16 v[100:101], v1 offset:4096
  v_mfma_f32_16x16x32_bf16 v[180:183], v[136:139], v[72:75], v[180:183]
  ds_read_b64_tr_b16 v[102:103], v1 offset:4608
  v_mfma_f32_16x16x32_bf16 v[180:183], v[140:143], v[76:79], v[180:183]
  ds_read_b64_tr_b16 v[104:105], v2 offset:0
  s_waitcnt lgkmcnt(14)
  v_mfma_f32_16x16x32_bf16 v[192:195], v[144:147], v[64:67], v[192:195]
  ds_read_b64_tr_b16 v[106:107], v2 offset:512
  s_add_u32 m0, s76, 10240
  s_nop 0
  buffer_load_dwordx4 v26, s[32:35], 0 offen lds
  s_waitcnt lgkmcnt(14)
  v_mfma_f32_16x16x32_bf16 v[192:195], v[148:151], v[68:71], v[192:195]
  ds_read_b64_tr_b16 v[108:109], v2 offset:4096
  v_mfma_f32_16x16x32_bf16 v[196:199], v[144:147], v[72:75], v[196:199]
  ds_read_b64_tr_b16 v[110:111], v2 offset:4608
  v_mfma_f32_16x16x32_bf16 v[196:199], v[148:151], v[76:79], v[196:199]
  v_add_u32_dpp v28, v9, v14 row_newbcast:4 row_mask:0xf bank_mask:0x3
  v_add_u32_dpp v29, v9, v15 row_newbcast:5 row_mask:0xf bank_mask:0x3
  s_waitcnt lgkmcnt(14)
  v_mfma_f32_16x16x32_bf16 v[208:211], v[152:155], v[64:67], v[208:211]
  s_add_u32 m0, s76, 11264
  s_nop 0
  buffer_load_dwordx4 v27, s[32:35], 0 offen lds
  v_add_u32_dpp v30, v9, v14 row_newbcast:6 row_mask:0xf bank_mask:0x3
  v_add_u32_dpp v31, v9, v15 row_newbcast:7 row_mask:0xf bank_mask:0x3
  s_waitcnt lgkmcnt(12)
  v_mfma_f32_16x16x32_bf16 v[208:211], v[156:159], v[68:71], v[208:211]
  v_add_u32_dpp v28, v9, v14 row_newbcast:12 row_mask:0xf bank_mask:0xc
  v_mfma_f32_16x16x32_bf16 v[212:215], v[152:155], v[72:75], v[212:215]
  v_add_u32_dpp v29, v9, v15 row_newbcast:13 row_mask:0xf bank_mask:0xc
  v_add_u32_dpp v30, v9, v14 row_newbcast:14 row_mask:0xf bank_mask:0xc
  v_mfma_f32_16x16x32_bf16 v[212:215], v[156:159], v[76:79], v[212:215]
  v_add_u32_dpp v31, v9, v15 row_newbcast:15 row_mask:0xf bank_mask:0xc
  s_waitcnt vmcnt(9)
  s_waitcnt lgkmcnt(8)
  v_mfma_f32_16x16x32_bf16 v[168:171], v[128:131], v[80:83], v[168:171]
  ds_read_b128 v[76:79], v12 offset:2048
  ds_read_b128 v[72:75], v11 offset:2048
  v_mfma_f32_16x16x32_bf16 v[168:171], v[132:135], v[84:87], v[168:171]
  ds_read_b128 v[68:71], v12 offset:0
  s_add_u32 m0, s76, 12288
  s_nop 0
  buffer_load_dwordx4 v28, s[32:35], 0 offen lds
  v_mfma_f32_16x16x32_bf16 v[172:175], v[128:131], v[88:91], v[172:175]
  ds_read_b128 v[64:67], v11 offset:0
  v_mfma_f32_16x16x32_bf16 v[172:175], v[132:135], v[92:95], v[172:175]
  ds_read_b64_tr_b16 v[112:113], v7 offset:0
  v_mfma_f32_16x16x32_bf16 v[184:187], v[136:139], v[80:83], v[184:187]
  ds_read_b64_tr_b16 v[114:115], v7 offset:512
  s_add_u32 m0, s76, 13312
  s_nop 0
  buffer_load_dwordx4 v29, s[32:35], 0 offen lds
  v_mfma_f32_16x16x32_bf16 v[184:187], v[140:143], v[84:87], v[184:187]
  ds_read_b64_tr_b16 v[116:117], v7 offset:4096
  v_mfma_f32_16x16x32_bf16 v[188:191], v[136:139], v[88:91], v[188:191]
  ds_read_b64_tr_b16 v[118:119], v7 offset:4608
  v_mfma_f32_16x16x32_bf16 v[188:191], v[140:143], v[92:95], v[188:191]
  ds_read_b64_tr_b16 v[120:121], v8 offset:0
  s_add_u32 m0, s76, 14336
  s_nop 0
  buffer_load_dwordx4 v30, s[32:35], 0 offen lds
  v_mfma_f32_16x16x32_bf16 v[200:203], v[144:147], v[80:83], v[200:203]
  ds_read_b64_tr_b16 v[122:123], v8 offset:512
  v_mfma_f32_16x16x32_bf16 v[200:203], v[148:151], v[84:87], v[200:203]
  ds_read_b64_tr_b16 v[124:125], v8 offset:4096
  v_mfma_f32_16x16x32_bf16 v[204:207], v[144:147], v[88:91], v[204:207]
  ds_read_b64_tr_b16 v[126:127], v8 offset:4608
  s_add_u32 m0, s76, 15360
  s_nop 0
  buffer_load_dwordx4 v31, s[32:35], 0 offen lds
  v_mfma_f32_16x16x32_bf16 v[204:207], v[148:151], v[92:95], v[204:207]
  s_set_gpr_idx_on s73, gpr_idx(SRC0)
  s_nop 0
  v_mov_b32 v9, v32
  s_set_gpr_idx_off
  s_add_u32 s73, s73, 1
  v_add_u32_dpp v24, v9, v14 row_newbcast:0 row_mask:0xf bank_mask:0x3
  v_mfma_f32_16x16x32_bf16 v[216:219], v[152:155], v[80:83], v[216:219]
  v_add_u32_dpp v25, v9, v15 row_newbcast:1 row_mask:0xf bank_mask:0x3
  v_add_u32_dpp v26, v9, v14 row_newbcast:2 row_mask:0xf bank_mask:0x3
  v_mfma_f32_16x16x32_bf16 v[216:219], v[156:159], v[84:87], v[216:219]
  s_add_u32 m0, s75, 0
  s_nop 0
  buffer_load_dwordx4 v13, s[44:47], s74 offen lds
  s_add_u32 s74, s74, 212992
  s_xor_b32 s75, s75, 16384
  v_add_u32_dpp v27, v9, v15 row_newbcast:3 row_mask:0xf bank_mask:0x3
  v_add_u32_dpp v24, v9, v14 row_newbcast:8 row_mask:0xf bank_mask:0xc
  v_mfma_f32_16x16x32_bf16 v[220:223], v[152:155], v[88:91], v[220:223]
  v_add_u32_dpp v25, v9, v15 row_newbcast:9 row_mask:0xf bank_mask:0xc
  v_add_u32_dpp v26, v9, v14 row_newbcast:10 row_mask:0xf bank_mask:0xc
  v_mfma_f32_16x16x32_bf16 v[220:223], v[156:159], v[92:95], v[220:223]
  v_add_u32_dpp v27, v9, v15 row_newbcast:11 row_mask:0xf bank_mask:0xc
  s_cmp_lt_u32 s73, 27
  s_cbranch_scc1 L_rem_loop
  s_waitcnt vmcnt(9)
  s_barrier
  s_waitcnt lgkmcnt(8)
  v_mfma_f32_16x16x32_bf16 v[160:163], v[96:99], v[64:67], v[160:163]
  ds_read_b128 v[92:95], v12 offset:6144
  ds_read_b128 v[88:91], v11 offset:6144
  v_mfma_f32_16x16x32_bf16 v[160:163], v[100:103], v[68:71], v[160:163]
  ds_read_b128 v[84:87], v12 offset:4096
  buffer_load_dwordx2 v[224:225], v248, s[48:51], 0 offen offset:3200
  v_mfma_f32_16x16x32_bf16 v[164:167], v[96:99], v[72:75], v[164:167]
  ds_read_b128 v[80:83], v11 offset:4096
  buffer_load_dwordx2 v[226:227], v248, s[48:51], 0 offen offset:3232
  v_mfma_f32_16x16x32_bf16 v[164:167], v[100:103], v[76:79], v[164:167]
  ds_read_b64_tr_b16 v[128:129], v1 offset:8192
  v_mfma_f32_16x16x32_bf16 v[176:179], v[104:107], v[64:67], v[176:179]
  ds_read_b64_tr_b16 v[130:131], v1 offset:8704
  buffer_load_dwordx2 v[228:229], v248, s[48:51], 0 offen offset:3264
  v_mfma_f32_16x16x32_bf16 v[176:179], v[108:111], v[68:71], v[176:179]
  ds_read_b64_tr_b16 v[132:133], v1 offset:12288
  v_mfma_f32_16x16x32_bf16 v[180:183], v[104:107], v[72:75], v[180:183]
  ds_read_b64_tr_b16 v[134:135], v1 offset:12800
  buffer_load_dwordx2 v[230:231], v248, s[48:51], 0 offen offset:3296
  v_mfma_f32_16x16x32_bf16 v[180:183], v[108:111], v[76:79], v[180:183]
  ds_read_b64_tr_b16 v[136:137], v2 offset:8192
  buffer_load_dwordx2 v[232:233], v248, s[52:55], 0 offen offset:3200
  s_waitcnt lgkmcnt(14)
  v_mfma_f32_16x16x32_bf16 v[192:195], v[112:115], v[64:67], v[192:195]
  ds_read_b64_tr_b16 v[138:139], v2 offset:8704
  s_waitcnt lgkmcnt(14)
  v_mfma_f32_16x16x32_bf16 v[192:195], v[116:119], v[68:71], v[192:195]
  ds_read_b64_tr_b16 v[140:141], v2 offset:12288
  buffer_load_dwordx2 v[234:235], v248, s[52:55], 0 offen offset:3232
  v_mfma_f32_16x16x32_bf16 v[196:199], v[112:115], v[72:75], v[196:199]
  ds_read_b64_tr_b16 v[142:143], v2 offset:12800
  v_mfma_f32_16x16x32_bf16 v[196:199], v[116:119], v[76:79], v[196:199]
  buffer_load_dwordx2 v[236:237], v248, s[52:55], 0 offen offset:3264
  s_waitcnt lgkmcnt(14)
  v_mfma_f32_16x16x32_bf16 v[208:211], v[120:123], v[64:67], v[208:211]
  buffer_load_dwordx2 v[238:239], v248, s[52:55], 0 offen offset:3296
  s_waitcnt lgkmcnt(12)
  v_mfma_f32_16x16x32_bf16 v[208:211], v[124:127], v[68:71], v[208:211]
  v_mfma_f32_16x16x32_bf16 v[212:215], v[120:123], v[72:75], v[212:215]
  buffer_load_dword v255, v3, s[56:59], s77 offen
  v_mfma_f32_16x16x32_bf16 v[212:215], v[124:127], v[76:79], v[212:215]
  s_waitcnt vmcnt(14)
  s_waitcnt lgkmcnt(8)
  v_mfma_f32_16x16x32_bf16 v[168:171], v[96:99], v[80:83], v[168:171]
  ds_read_b128 v[76:79], v12 offset:10240
  ds_read_b128 v[72:75], v11 offset:10240
  v_mfma_f32_16x16x32_bf16 v[168:171], v[100:103], v[84:87], v[168:171]
  ds_read_b128 v[68:71], v12 offset:8192
  v_mfma_f32_16x16x32_bf16 v[172:175], v[96:99], v[88:91], v[172:175]
  ds_read_b128 v[64:67], v11 offset:8192
  v_mfma_f32_16x16x32_bf16 v[172:175], v[100:103], v[92:95], v[172:175]
  ds_read_b64_tr_b16 v[144:145], v7 offset:8192
  v_mfma_f32_16x16x32_bf16 v[184:187], v[104:107], v[80:83], v[184:187]
  ds_read_b64_tr_b16 v[146:147], v7 offset:8704
  v_mfma_f32_16x16x32_bf16 v[184:187], v[108:111], v[84:87], v[184:187]
  ds_read_b64_tr_b16 v[148:149], v7 offset:12288
  v_mfma_f32_16x16x32_bf16 v[188:191], v[104:107], v[88:91], v[188:191]
  ds_read_b64_tr_b16 v[150:151], v7 offset:12800
  v_mfma_f32_16x16x32_bf16 v[188:191], v[108:111], v[92:95], v[188:191]
  ds_read_b64_tr_b16 v[152:153], v8 offset:8192
  v_mfma_f32_16x16x32_bf16 v[200:203], v[112:115], v[80:83], v[200:203]
  ds_read_b64_tr_b16 v[154:155], v8 offset:8704
  v_mfma_f32_16x16x32_bf16 v[200:203], v[116:119], v[84:87], v[200:203]
  ds_read_b64_tr_b16 v[156:157], v8 offset:12288
  v_mfma_f32_16x16x32_bf16 v[204:207], v[112:115], v[88:91], v[204:207]
  ds_read_b64_tr_b16 v[158:159], v8 offset:12800
  v_mfma_f32_16x16x32_bf16 v[204:207], v[116:119], v[92:95], v[204:207]
  v_mfma_f32_16x16x32_bf16 v[216:219], v[120:123], v[80:83], v[216:219]
  v_mfma_f32_16x16x32_bf16 v[216:219], v[124:127], v[84:87], v[216:219]
  v_mfma_f32_16x16x32_bf16 v[220:223], v[120:123], v[88:91], v[220:223]
  v_mfma_f32_16x16x32_bf16 v[220:223], v[124:127], v[92:95], v[220:223]
  s_waitcnt vmcnt(10)
  s_waitcnt lgkmcnt(8)
  v_mfma_f32_16x16x32_bf16 v[160:163], v[128:131], v[64:67], v[160:163]
  ds_read_b128 v[92:95], v12 offset:14336
  v_mfma_f32_16x16x32_bf16 v[160:163], v[132:135], v[68:71], v[160:163]
  v_mfma_f32_16x16x32_bf16 v[164:167], v[128:131], v[72:75], v[164:167]
  ds_read_b128 v[88:91], v11 offset:14336
  v_mfma_f32_16x16x32_bf16 v[164:167], v[132:135], v[76:79], v[164:167]
  s_waitcnt vmcnt(4)
  v_lshlrev_b32 v48, 16, v232
  v_and_b32 v49, 0xffff0000, v232
  v_mfma_f32_16x16x32_bf16 v[176:179], v[136:139], v[64:67], v[176:179]
  v_lshlrev_b32 v50, 16, v233
  v_and_b32 v51, 0xffff0000, v233
  v_mfma_f32_16x16x32_bf16 v[176:179], v[140:143], v[68:71], v[176:179]
  ds_read_b128 v[84:87], v12 offset:12288
  s_waitcnt vmcnt(3)
  v_lshlrev_b32 v52, 16, v234
  v_and_b32 v53, 0xffff0000, v234
  v_mfma_f32_16x16x32_bf16 v[180:183], v[136:139], v[72:75], v[180:183]
  v_lshlrev_b32 v54, 16, v235
  v_and_b32 v55, 0xffff0000, v235
  v_mfma_f32_16x16x32_bf16 v[180:183], v[140:143], v[76:79], v[180:183]
  s_waitcnt vmcnt(2)
  v_lshlrev_b32 v56, 16, v236
  v_and_b32 v57, 0xffff0000, v236
  s_waitcnt lgkmcnt(9)
  v_mfma_f32_16x16x32_bf16 v[192:195], v[144:147], v[64:67], v[192:195]
  ds_read_b128 v[80:83], v11 offset:12288
  v_lshlrev_b32 v58, 16, v237
  s_waitcnt lgkmcnt(8)
  v_mfma_f32_16x16x32_bf16 v[192:195], v[148:151], v[68:71], v[192:195]
  v_and_b32 v59, 0xffff0000, v237
  s_waitcnt vmcnt(1)
  v_lshlrev_b32 v60, 16, v238
  v_mfma_f32_16x16x32_bf16 v[196:199], v[144:147], v[72:75], v[196:199]
  v_and_b32 v61, 0xffff0000, v238
  v_lshlrev_b32 v62, 16, v239
  v_mfma_f32_16x16x32_bf16 v[196:199], v[148:151], v[76:79], v[196:199]
  v_and_b32 v63, 0xffff0000, v239
  v_lshlrev_b32 v32, 16, v224
  s_waitcnt lgkmcnt(6)
  v_mfma_f32_16x16x32_bf16 v[208:211], v[152:155], v[64:67], v[208:211]
  v_and_b32 v33, 0xffff0000, v224
  v_lshlrev_b32 v34, 16, v225
  s_waitcnt lgkmcnt(4)
  v_mfma_f32_16x16x32_bf16 v[208:211], v[156:159], v[68:71], v[208:211]
  v_and_b32 v35, 0xffff0000, v225
  v_lshlrev_b32 v36, 16, v226
  v_mfma_f32_16x16x32_bf16 v[212:215], v[152:155], v[72:75], v[212:215]
  v_and_b32 v37, 0xffff0000, v226
  v_mfma_f32_16x16x32_bf16 v[212:215], v[156:159], v[76:79], v[212:215]
  s_waitcnt lgkmcnt(0)
  v_mfma_f32_16x16x32_bf16 v[168:171], v[128:131], v[80:83], v[168:171]
  v_lshlrev_b32 v38, 16, v227
  v_and_b32 v39, 0xffff0000, v227
  v_mfma_f32_16x16x32_bf16 v[168:171], v[132:135], v[84:87], v[168:171]
  v_lshlrev_b32 v40, 16, v228
  v_mfma_f32_16x16x32_bf16 v[172:175], v[128:131], v[88:91], v[172:175]
  v_and_b32 v41, 0xffff0000, v228
  v_mfma_f32_16x16x32_bf16 v[172:175], v[132:135], v[92:95], v[172:175]
  v_lshlrev_b32 v42, 16, v229
  v_mfma_f32_16x16x32_bf16 v[184:187], v[136:139], v[80:83], v[184:187]
  v_and_b32 v43, 0xffff0000, v229
  v_lshlrev_b32 v44, 16, v230
  v_mfma_f32_16x16x32_bf16 v[184:187], v[140:143], v[84:87], v[184:187]
  v_and_b32 v45, 0xffff0000, v230
  v_mfma_f32_16x16x32_bf16 v[188:191], v[136:139], v[88:91], v[188:191]
  v_lshlrev_b32 v46, 16, v231
  v_mfma_f32_16x16x32_bf16 v[188:191], v[140:143], v[92:95], v[188:191]
  v_and_b32 v47, 0xffff0000, v231
  v_mfma_f32_16x16x32_bf16 v[200:203], v[144:147], v[80:83], v[200:203]
  v_rcp_f32 v48, v48
  v_rcp_f32 v49, v49
  v_mfma_f32_16x16x32_bf16 v[200:203], v[148:151], v[84:87], v[200:203]
  v_rcp_f32 v50, v50
  v_mfma_f32_16x16x32_bf16 v[204:207], v[144:147], v[88:91], v[204:207]
  v_rcp_f32 v51, v51
  v_mfma_f32_16x16x32_bf16 v[204:207], v[148:151], v[92:95], v[204:207]
  v_rcp_f32 v52, v52
  v_mfma_f32_16x16x32_bf16 v[216:219], v[152:155], v[80:83], v[216:219]
  v_rcp_f32 v53, v53
  v_rcp_f32 v54, v54
  v_mfma_f32_16x16x32_bf16 v[216:219], v[156:159], v[84:87], v[216:219]
  v_rcp_f32 v55, v55
  v_mfma_f32_16x16x32_bf16 v[220:223], v[152:155], v[88:91], v[220:223]
  v_rcp_f32 v56, v56
  v_mfma_f32_16x16x32_bf16 v[220:223], v[156:159], v[92:95], v[220:223]
  v_rcp_f32 v57, v57
  s_nop 0
L_repi:
  v_rcp_f32 v58, v58
  v_rcp_f32 v59, v59
  v_rcp_f32 v60, v60
  v_rcp_f32 v61, v61
  v_rcp_f32 v62, v62
  v_rcp_f32 v63, v63
  v_med3_f32 v48, v48, -v244, v244
  v_med3_f32 v49, v49, -v244, v244
  v_med3_f32 v50, v50, -v244, v244
  v_med3_f32 v51, v51, -v244, v244
  v_med3_f32 v52, v52, -v244, v244
  v_med3_f32 v53, v53, -v244, v244
  v_med3_f32 v54, v54, -v244, v244
  v_med3_f32 v55, v55, -v244, v244
  v_med3_f32 v56, v56, -v244, v244
  v_med3_f32 v57, v57, -v244, v244
  v_med3_f32 v58, v58, -v244, v244
  v_med3_f32 v59, v59, -v244, v244
  v_med3_f32 v60, v60, -v244, v244
  v_med3_f32 v61, v61, -v244, v244
  v_med3_f32 v62, v62, -v244, v244
  v_med3_f32 v63, v63, -v244, v244
  v_pk_add_f32 v[160:161], v[160:161], v[32:33]
  v_pk_add_f32 v[162:163], v[162:163], v[34:35]
  v_pk_add_f32 v[164:165], v[164:165], v[32:33]
  v_pk_add_f32 v[166:167], v[166:167], v[34:35]
  v_pk_add_f32 v[168:169], v[168:169], v[32:33]
  v_pk_add_f32 v[170:171], v[170:171], v[34:35]
  v_pk_add_f32 v[172:173], v[172:173], v[32:33]
  v_pk_add_f32 v[174:175], v[174:175], v[34:35]
  v_pk_add_f32 v[176:177], v[176:177], v[36:37]
  v_pk_add_f32 v[178:179], v[178:179], v[38:39]
  v_pk_add_f32 v[180:181], v[180:181], v[36:37]
  v_pk_add_f32 v[182:183], v[182:183], v[38:39]
  v_pk_add_f32 v[184:185], v[184:185], v[36:37]
  v_pk_add_f32 v[186:187], v[186:187], v[38:39]
  v_pk_add_f32 v[188:189], v[188:189], v[36:37]
  v_pk_add_f32 v[190:191], v[190:191], v[38:39]
  v_pk_add_f32 v[192:193], v[192:193], v[40:41]
  v_pk_add_f32 v[194:195], v[194:195], v[42:43]
  v_pk_add_f32 v[196:197], v[196:197], v[40:41]
  v_pk_add_f32 v[198:199], v[198:199], v[42:43]
  v_pk_add_f32 v[200:201], v[200:201], v[40:41]
  v_pk_add_f32 v[202:203], v[202:203], v[42:43]
  v_pk_add_f32 v[204:205], v[204:205], v[40:41]
  v_pk_add_f32 v[206:207], v[206:207], v[42:43]
  v_pk_add_f32 v[208:209], v[208:209], v[44:45]
  v_pk_add_f32 v[210:211], v[210:211], v[46:47]
  v_pk_add_f32 v[212:213], v[212:213], v[44:45]
  v_pk_add_f32 v[214:215], v[214:215], v[46:47]
  v_pk_add_f32 v[216:217], v[216:217], v[44:45]
  v_pk_add_f32 v[218:219], v[218:219], v[46:47]
  v_pk_add_f32 v[220:221], v[220:221], v[44:45]
  v_pk_add_f32 v[222:223], v[222:223], v[46:47]
  v_pk_mul_f32 v[64:65], v[160:161], v[160:161]
  v_pk_mul_f32 v[68:69], v[164:165], v[164:165]
  v_pk_mul_f32 v[72:73], v[168:169], v[168:169]
  v_pk_mul_f32 v[76:77], v[172:173], v[172:173]
  v_pk_fma_f32 v[64:65], v[64:65], v[242:243], v[240:241]
  v_pk_fma_f32 v[68:69], v[68:69], v[242:243], v[240:241]
  v_pk_fma_f32 v[72:73], v[72:73], v[242:243], v[240:241]
  v_pk_fma_f32 v[76:77], v[76:77], v[242:243], v[240:241]
  v_pk_mul_f32 v[64:65], v[64:65], v[160:161]
  v_pk_mul_f32 v[68:69], v[68:69], v[164:165]
  v_pk_mul_f32 v[72:73], v[72:73], v[168:169]
  v_pk_mul_f32 v[76:77], v[76:77], v[172:173]
  v_exp_f32 v64, v64
  v_exp_f32 v65, v65
  v_exp_f32 v68, v68
  v_exp_f32 v69, v69
  v_exp_f32 v72, v72
  v_exp_f32 v73, v73
  v_exp_f32 v76, v76
  v_exp_f32 v77, v77
  v_pk_fma_f32 v[64:65], v[64:65], v[48:49], v[48:49]
  v_pk_fma_f32 v[68:69], v[68:69], v[48:49], v[48:49]
  v_pk_fma_f32 v[72:73], v[72:73], v[48:49], v[48:49]
  v_pk_fma_f32 v[76:77], v[76:77], v[48:49], v[48:49]
  v_rcp_f32 v64, v64
  v_rcp_f32 v65, v65
  v_rcp_f32 v68, v68
  v_rcp_f32 v69, v69
  v_rcp_f32 v72, v72
  v_rcp_f32 v73, v73
  v_rcp_f32 v76, v76
  v_rcp_f32 v77, v77
  v_pk_mul_f32 v[16:17], v[64:65], v[160:161]
  v_pk_mul_f32 v[18:19], v[68:69], v[164:165]
  v_pk_mul_f32 v[20:21], v[72:73], v[168:169]
  v_pk_mul_f32 v[22:23], v[76:77], v[172:173]
  v_pk_mul_f32 v[80:81], v[162:163], v[162:163]
  v_pk_mul_f32 v[84:85], v[166:167], v[166:167]
  v_pk_mul_f32 v[88:89], v[170:171], v[170:171]
  v_pk_mul_f32 v[92:93], v[174:175], v[174:175]
  v_pk_fma_f32 v[80:81], v[80:81], v[242:243], v[240:241]
  v_pk_fma_f32 v[84:85], v[84:85], v[242:243], v[240:241]
  v_pk_fma_f32 v[88:89], v[88:89], v[242:243], v[240:241]
  v_pk_fma_f32 v[92:93], v[92:93], v[242:243], v[240:241]
  v_pk_mul_f32 v[80:81], v[80:81], v[162:163]
  v_pk_mul_f32 v[84:85], v[84:85], v[166:167]
  v_pk_mul_f32 v[88:89], v[88:89], v[170:171]
  v_pk_mul_f32 v[92:93], v[92:93], v[174:175]
  v_exp_f32 v80, v80
  v_exp_f32 v81, v81
  v_exp_f32 v84, v84
  v_exp_f32 v85, v85
  v_exp_f32 v88, v88
  v_exp_f32 v89, v89
  v_exp_f32 v92, v92
  v_exp_f32 v93, v93
  v_pk_fma_f32 v[80:81], v[80:81], v[50:51], v[50:51]
  v_pk_fma_f32 v[84:85], v[84:85], v[50:51], v[50:51]
  v_pk_fma_f32 v[88:89], v[88:89], v[50:51], v[50:51]
  v_pk_fma_f32 v[92:93], v[92:93], v[50:51], v[50:51]
  v_rcp_f32 v80, v80
  v_rcp_f32 v81, v81
  v_rcp_f32 v84, v84
  v_rcp_f32 v85, v85
  v_rcp_f32 v88, v88
  v_rcp_f32 v89, v89
  v_rcp_f32 v92, v92
  v_rcp_f32 v93, v93
  v_pk_fma_f32 v[16:17], v[80:81], v[162:163], v[16:17]
  v_pk_fma_f32 v[18:19], v[84:85], v[166:167], v[18:19]
  v_pk_fma_f32 v[20:21], v[88:89], v[170:171], v[20:21]
  v_pk_fma_f32 v[22:23], v[92:93], v[174:175], v[22:23]
  v_pk_mul_f32 v[64:65], v[176:177], v[176:177]
  v_pk_mul_f32 v[68:69], v[180:181], v[180:181]
  v_pk_mul_f32 v[72:73], v[184:185], v[184:185]
  v_pk_mul_f32 v[76:77], v[188:189], v[188:189]
  v_pk_fma_f32 v[64:65], v[64:65], v[242:243], v[240:241]
  v_pk_fma_f32 v[68:69], v[68:69], v[242:243], v[240:241]
  v_pk_fma_f32 v[72:73], v[72:73], v[242:243], v[240:241]
  v_pk_fma_f32 v[76:77], v[76:77], v[242:243], v[240:241]
  v_pk_mul_f32 v[64:65], v[64:65], v[176:177]
  v_pk_mul_f32 v[68:69], v[68:69], v[180:181]
  v_pk_mul_f32 v[72:73], v[72:73], v[184:185]
  v_pk_mul_f32 v[76:77], v[76:77], v[188:189]
  v_exp_f32 v64, v64
  v_exp_f32 v65, v65
  v_exp_f32 v68, v68
  v_exp_f32 v69, v69
  v_exp_f32 v72, v72
  v_exp_f32 v73, v73
  v_exp_f32 v76, v76
  v_exp_f32 v77, v77
  v_pk_fma_f32 v[64:65], v[64:65], v[52:53], v[52:53]
  v_pk_fma_f32 v[68:69], v[68:69], v[52:53], v[52:53]
  v_pk_fma_f32 v[72:73], v[72:73], v[52:53], v[52:53]
  v_pk_fma_f32 v[76:77], v[76:77], v[52:53], v[52:53]
  v_rcp_f32 v64, v64
  v_rcp_f32 v65, v65
  v_rcp_f32 v68, v68
  v_rcp_f32 v69, v69
  v_rcp_f32 v72, v72
  v_rcp_f32 v73, v73
  v_rcp_f32 v76, v76
  v_rcp_f32 v77, v77
  v_pk_fma_f32 v[16:17], v[64:65], v[176:177], v[16:17]
  v_pk_fma_f32 v[18:19], v[68:69], v[180:181], v[18:19]
  v_pk_fma_f32 v[20:21], v[72:73], v[184:185], v[20:21]
  v_pk_fma_f32 v[22:23], v[76:77], v[188:189], v[22:23]
  v_pk_mul_f32 v[80:81], v[178:179], v[178:179]
  v_pk_mul_f32 v[84:85], v[182:183], v[182:183]
  v_pk_mul_f32 v[88:89], v[186:187], v[186:187]
  v_pk_mul_f32 v[92:93], v[190:191], v[190:191]
  v_pk_fma_f32 v[80:81], v[80:81], v[242:243], v[240:241]
  v_pk_fma_f32 v[84:85], v[84:85], v[242:243], v[240:241]
  v_pk_fma_f32 v[88:89], v[88:89], v[242:243], v[240:241]
  v_pk_fma_f32 v[92:93], v[92:93], v[242:243], v[240:241]
  v_pk_mul_f32 v[80:81], v[80:81], v[178:179]
  v_pk_mul_f32 v[84:85], v[84:85], v[182:183]
  v_pk_mul_f32 v[88:89], v[88:89], v[186:187]
  v_pk_mul_f32 v[92:93], v[92:93], v[190:191]
  v_exp_f32 v80, v80
  v_exp_f32 v81, v81
  v_exp_f32 v84, v84
  v_exp_f32 v85, v85
  v_exp_f32 v88, v88
  v_exp_f32 v89, v89
  v_exp_f32 v92, v92
  v_exp_f32 v93, v93
  v_pk_fma_f32 v[80:81], v[80:81], v[54:55], v[54:55]
  v_pk_fma_f32 v[84:85], v[84:85], v[54:55], v[54:55]
  v_pk_fma_f32 v[88:89], v[88:89], v[54:55], v[54:55]
  v_pk_fma_f32 v[92:93], v[92:93], v[54:55], v[54:55]
  v_rcp_f32 v80, v80
  v_rcp_f32 v81, v81
  v_rcp_f32 v84, v84
  v_rcp_f32 v85, v85
  v_rcp_f32 v88, v88
  v_rcp_f32 v89, v89
  v_rcp_f32 v92, v92
  v_rcp_f32 v93, v93
  v_pk_fma_f32 v[16:17], v[80:81], v[178:179], v[16:17]
  v_pk_fma_f32 v[18:19], v[84:85], v[182:183], v[18:19]
  v_pk_fma_f32 v[20:21], v[88:89], v[186:187], v[20:21]
  v_pk_fma_f32 v[22:23], v[92:93], v[190:191], v[22:23]
  v_pk_mul_f32 v[64:65], v[192:193], v[192:193]
  v_pk_mul_f32 v[68:69], v[196:197], v[196:197]
  v_pk_mul_f32 v[72:73], v[200:201], v[200:201]
  v_pk_mul_f32 v[76:77], v[204:205], v[204:205]
  v_pk_fma_f32 v[64:65], v[64:65], v[242:243], v[240:241]
  v_pk_fma_f32 v[68:69], v[68:69], v[242:243], v[240:241]
  v_pk_fma_f32 v[72:73], v[72:73], v[242:243], v[240:241]
  v_pk_fma_f32 v[76:77], v[76:77], v[242:243], v[240:241]
  v_pk_mul_f32 v[64:65], v[64:65], v[192:193]
  v_pk_mul_f32 v[68:69], v[68:69], v[196:197]
  v_pk_mul_f32 v[72:73], v[72:73], v[200:201]
  v_pk_mul_f32 v[76:77], v[76:77], v[204:205]
  v_exp_f32 v64, v64
  v_exp_f32 v65, v65
  v_exp_f32 v68, v68
  v_exp_f32 v69, v69
  v_exp_f32 v72, v72
  v_exp_f32 v73, v73
  v_exp_f32 v76, v76
  v_exp_f32 v77, v77
  v_pk_fma_f32 v[64:65], v[64:65], v[56:57], v[56:57]
  v_pk_fma_f32 v[68:69], v[68:69], v[56:57], v[56:57]
  v_pk_fma_f32 v[72:73], v[72:73], v[56:57], v[56:57]
  v_pk_fma_f32 v[76:77], v[76:77], v[56:57], v[56:57]
  v_rcp_f32 v64, v64
  v_rcp_f32 v65, v65
  v_rcp_f32 v68, v68
  v_rcp_f32 v69, v69
  v_rcp_f32 v72, v72
  v_rcp_f32 v73, v73
  v_rcp_f32 v76, v76
  v_rcp_f32 v77, v77
  v_pk_fma_f32 v[16:17], v[64:65], v[192:193], v[16:17]
  v_pk_fma_f32 v[18:19], v[68:69], v[196:197], v[18:19]
  v_pk_fma_f32 v[20:21], v[72:73], v[200:201], v[20:21]
  v_pk_fma_f32 v[22:23], v[76:77], v[204:205], v[22:23]
  v_pk_mul_f32 v[80:81], v[194:195], v[194:195]
  v_pk_mul_f32 v[84:85], v[198:199], v[198:199]
  v_pk_mul_f32 v[88:89], v[202:203], v[202:203]
  v_pk_mul_f32 v[92:93], v[206:207], v[206:207]
  v_pk_fma_f32 v[80:81], v[80:81], v[242:243], v[240:241]
  v_pk_fma_f32 v[84:85], v[84:85], v[242:243], v[240:241]
  v_pk_fma_f32 v[88:89], v[88:89], v[242:243], v[240:241]
  v_pk_fma_f32 v[92:93], v[92:93], v[242:243], v[240:241]
  v_pk_mul_f32 v[80:81], v[80:81], v[194:195]
  v_pk_mul_f32 v[84:85], v[84:85], v[198:199]
  v_pk_mul_f32 v[88:89], v[88:89], v[202:203]
  v_pk_mul_f32 v[92:93], v[92:93], v[206:207]
  v_exp_f32 v80, v80
  v_exp_f32 v81, v81
  v_exp_f32 v84, v84
  v_exp_f32 v85, v85
  v_exp_f32 v88, v88
  v_exp_f32 v89, v89
  v_exp_f32 v92, v92
  v_exp_f32 v93, v93
  v_pk_fma_f32 v[80:81], v[80:81], v[58:59], v[58:59]
  v_pk_fma_f32 v[84:85], v[84:85], v[58:59], v[58:59]
  v_pk_fma_f32 v[88:89], v[88:89], v[58:59], v[58:59]
  v_pk_fma_f32 v[92:93], v[92:93], v[58:59], v[58:59]
  v_rcp_f32 v80, v80
  v_rcp_f32 v81, v81
  v_rcp_f32 v84, v84
  v_rcp_f32 v85, v85
  v_rcp_f32 v88, v88
  v_rcp_f32 v89, v89
  v_rcp_f32 v92, v92
  v_rcp_f32 v93, v93
  v_pk_fma_f32 v[16:17], v[80:81], v[194:195], v[16:17]
  v_pk_fma_f32 v[18:19], v[84:85], v[198:199], v[18:19]
  v_pk_fma_f32 v[20:21], v[88:89], v[202:203], v[20:21]
  v_pk_fma_f32 v[22:23], v[92:93], v[206:207], v[22:23]
  buffer_load_dword v128, v3, s[60:63], s68 offen offset:0 sc1
  buffer_load_dword v129, v3, s[60:63], s68 offen offset:2048 sc1
  buffer_load_dword v130, v3, s[60:63], s69 offen offset:0 sc1
  buffer_load_dword v131, v3, s[60:63], s69 offen offset:2048 sc1
  buffer_load_dword v132, v3, s[60:63], s71 offen offset:0 sc1
  buffer_load_dword v133, v3, s[60:63], s71 offen offset:2048 sc1
  buffer_load_dword v134, v5, s[60:63], s71 offen sc1
  v_pk_mul_f32 v[64:65], v[208:209], v[208:209]
  v_pk_mul_f32 v[68:69], v[212:213], v[212:213]
  v_pk_mul_f32 v[72:73], v[216:217], v[216:217]
  v_pk_mul_f32 v[76:77], v[220:221], v[220:221]
  v_pk_fma_f32 v[64:65], v[64:65], v[242:243], v[240:241]
  v_pk_fma_f32 v[68:69], v[68:69], v[242:243], v[240:241]
  v_pk_fma_f32 v[72:73], v[72:73], v[242:243], v[240:241]
  v_pk_fma_f32 v[76:77], v[76:77], v[242:243], v[240:241]
  v_pk_mul_f32 v[64:65], v[64:65], v[208:209]
  v_pk_mul_f32 v[68:69], v[68:69], v[212:213]
  v_pk_mul_f32 v[72:73], v[72:73], v[216:217]
  v_pk_mul_f32 v[76:77], v[76:77], v[220:221]
  v_exp_f32 v64, v64
  v_exp_f32 v65, v65
  v_exp_f32 v68, v68
  v_exp_f32 v69, v69
  v_exp_f32 v72, v72
  v_exp_f32 v73, v73
  v_exp_f32 v76, v76
  v_exp_f32 v77, v77
  v_pk_fma_f32 v[64:65], v[64:65], v[60:61], v[60:61]
  v_pk_fma_f32 v[68:69], v[68:69], v[60:61], v[60:61]
  v_pk_fma_f32 v[72:73], v[72:73], v[60:61], v[60:61]
  v_pk_fma_f32 v[76:77], v[76:77], v[60:61], v[60:61]
  v_rcp_f32 v64, v64
  v_rcp_f32 v65, v65
  v_rcp_f32 v68, v68
  v_rcp_f32 v69, v69
  v_rcp_f32 v72, v72
  v_rcp_f32 v73, v73
  v_rcp_f32 v76, v76
  v_rcp_f32 v77, v77
  v_pk_fma_f32 v[16:17], v[64:65], v[208:209], v[16:17]
  v_pk_fma_f32 v[18:19], v[68:69], v[212:213], v[18:19]
  v_pk_fma_f32 v[20:21], v[72:73], v[216:217], v[20:21]
  v_pk_fma_f32 v[22:23], v[76:77], v[220:221], v[22:23]
  v_pk_mul_f32 v[80:81], v[210:211], v[210:211]
  v_pk_mul_f32 v[84:85], v[214:215], v[214:215]
  v_pk_mul_f32 v[88:89], v[218:219], v[218:219]
  v_pk_mul_f32 v[92:93], v[222:223], v[222:223]
  v_pk_fma_f32 v[80:81], v[80:81], v[242:243], v[240:241]
  v_pk_fma_f32 v[84:85], v[84:85], v[242:243], v[240:241]
  v_pk_fma_f32 v[88:89], v[88:89], v[242:243], v[240:241]
  v_pk_fma_f32 v[92:93], v[92:93], v[242:243], v[240:241]
  v_pk_mul_f32 v[80:81], v[80:81], v[210:211]
  v_pk_mul_f32 v[84:85], v[84:85], v[214:215]
  v_pk_mul_f32 v[88:89], v[88:89], v[218:219]
  v_pk_mul_f32 v[92:93], v[92:93], v[222:223]
  v_exp_f32 v80, v80
  v_exp_f32 v81, v81
  v_exp_f32 v84, v84
  v_exp_f32 v85, v85
  v_exp_f32 v88, v88
  v_exp_f32 v89, v89
  v_exp_f32 v92, v92
  v_exp_f32 v93, v93
  v_pk_fma_f32 v[80:81], v[80:81], v[62:63], v[62:63]
  v_pk_fma_f32 v[84:85], v[84:85], v[62:63], v[62:63]
  v_pk_fma_f32 v[88:89], v[88:89], v[62:63], v[62:63]
  v_pk_fma_f32 v[92:93], v[92:93], v[62:63], v[62:63]
  v_rcp_f32 v80, v80
  v_rcp_f32 v81, v81
  v_rcp_f32 v84, v84
  v_rcp_f32 v85, v85
  v_rcp_f32 v88, v88
  v_rcp_f32 v89, v89
  v_rcp_f32 v92, v92
  v_rcp_f32 v93, v93
  v_pk_fma_f32 v[16:17], v[80:81], v[210:211], v[16:17]
  v_pk_fma_f32 v[18:19], v[84:85], v[214:215], v[18:19]
  v_pk_fma_f32 v[20:21], v[88:89], v[218:219], v[20:21]
  v_pk_fma_f32 v[22:23], v[92:93], v[222:223], v[22:23]
  v_add_f32 v16, v16, v17
  v_add_f32 v18, v18, v19
  v_add_f32 v20, v20, v21
  v_add_f32 v22, v22, v23
  s_nop 0
  v_permlane32_swap_b32 v16, v20
  v_permlane32_swap_b32 v18, v22
  v_add_f32 v16, v16, v20
  v_add_f32 v18, v18, v22
  s_nop 1
  v_permlane16_swap_b32 v16, v18
  v_add_f32 v16, v16, v18
  v_add_f32 v16, s80, v16
L_rclr:
  s_mov_b32 s72, 0x40000
  s_branch L_pchk
L_poll:
  s_sub_u32 s72, s72, 1
  s_cbranch_scc1 L_pollx
  buffer_load_dword v128, v3, s[60:63], s68 offen offset:0 sc1
  buffer_load_dword v129, v3, s[60:63], s68 offen offset:2048 sc1
  buffer_load_dword v130, v3, s[60:63], s69 offen offset:0 sc1
  buffer_load_dword v131, v3, s[60:63], s69 offen offset:2048 sc1
  buffer_load_dword v132, v3, s[60:63], s71 offen offset:0 sc1
  buffer_load_dword v133, v3, s[60:63], s71 offen offset:2048 sc1
  buffer_load_dword v134, v5, s[60:63], s71 offen sc1
L_pchk:
  s_waitcnt vmcnt(0)
  v_max3_u32 v136, v128, v129, v130
  v_max3_u32 v137, v131, v132, v133
  v_max3_u32 v136, v136, v137, v134
  v_cmp_eq_u32 vcc, -1, v136
  s_cbranch_vccnz L_poll
L_pollx:
  v_add_f32 v128, v128, v129
  v_add_f32 v130, v130, v131
  v_add_f32 v132, v132, v133
  v_add_f32 v16, v16, v134
  v_add_f32 v128, v128, v130
  v_add_f32 v132, v132, v16
  v_add_f32 v128, v128, v132
  v_cvt_pk_bf16_f32 v128, v128, v128
  buffer_store_short v128, v4, s[56:59], s77 offen
  s_endpgm
L_end:
  s_endpgm
.section .rodata,"a"
.p2align 6
.amdhsa_kernel standalone__deep_cross_xdeepfm__recsys_kernel
  .amdhsa_next_free_vgpr 256
  .amdhsa_next_free_sgpr 102
  .amdhsa_accum_offset 256
  .amdhsa_group_segment_fixed_size 0
  .amdhsa_kernarg_size 88
  .amdhsa_user_sgpr_count 2
  .amdhsa_user_sgpr_kernarg_segment_ptr 1
  .amdhsa_system_sgpr_workgroup_id_x 1
  .amdhsa_float_denorm_mode_32 3
.end_amdhsa_kernel
```

```asm
; @launch grid=(256,1,1) block=(512,1,1) lds=163840
.amdgcn_target "amdgcn-amd-amdhsa--gfx950"
.text
.globl standalone__deep_cross_xdeepfm__recsys_kernel
.p2align 8
.type standalone__deep_cross_xdeepfm__recsys_kernel,@function
standalone__deep_cross_xdeepfm__recsys_kernel:
  s_cmp_ge_u32 s2, 256
  s_cbranch_scc1 L_end
  s_load_dwordx16 s[4:19], s[0:1], 0
  s_load_dwordx4 s[20:23], s[0:1], 64
  s_load_dwordx2 s[24:25], s[0:1], 80
  v_lshrrev_b32 v1, 6, v0
  s_getpc_b64 s[92:93]
L_pc:
  s_and_b32 s68, s2, 0xf8
  v_add_u32 v2, s68, v1
  v_lshlrev_b32 v2, 7, v2
  v_and_b32 v3, 1, v0
  v_lshl_add_u32 v2, v3, 15, v2
  v_min_u32 v2, L_end-L_pc, v2
  v_mov_b32 v3, s93
  v_add_co_u32 v2, vcc, s92, v2
  s_nop 1
  v_addc_co_u32 v3, vcc, 0, v3, vcc
  global_load_dword v255, v[2:3], off
  v_and_b32 v0, 63, v0
  v_readfirstlane_b32 s3, v1
  s_and_b32 s68, s2, 7
  s_lshl_b32 s68, s68, 2
  s_lshr_b32 s26, s2, 6
  s_add_u32 s26, s26, s68
  s_bfe_u32 s27, s2, 0x30003
  s_and_b32 s80, s2, 0xf8
  s_add_u32 s80, s80, s3
  s_lshl_b32 s80, s80, 21
  s_lshr_b32 s68, s2, 3
  s_cmp_eq_u32 s68, 5
  s_cbranch_scc1 L_rem
  s_cmp_ge_u32 s27, 5
  s_cbranch_scc1 L_cin
  s_mul_i32 s77, s27, 640
  s_mul_i32 s70, s3, 7
  v_min_u32 v64, 6, v0
  v_add_u32 v64, s70, v64
  v_min_u32 v64, 51, v64
  v_lshrrev_b32 v62, 1, v64
  v_mul_u32_u24 v62, 96, v62
  v_lshl_add_u32 v64, v64, 2, v62
  s_mul_i32 s78, s27, 26
  s_min_u32 s78, s78, 102
  s_lshl_b32 s71, s26, 7
  s_add_u32 s78, s78, s71
  s_mul_i32 s78, s78, 104
  s_and_b32 s70, s26, 3
  s_lshl_b32 s70, s70, 3
  s_add_u32 s70, s70, s3
  s_mul_i32 s70, s70, 3328
  s_add_u32 s81, s70, s77
  v_min_u32 v56, 15, v0
  v_lshrrev_b32 v62, 3, v56
  s_mov_b32 s70, 106496
  v_mul_u32_u24 v62, s70, v62
  v_and_b32 v56, 7, v56
  v_min_u32 v56, 4, v56
  v_lshl_add_u32 v56, v56, 7, v62
  s_xor_b32 s70, s3, 4
  s_lshl_b32 s70, s70, 4
  s_add_u32 s70, s70, s71
  v_lshrrev_b32 v60, 3, v0
  v_add_u32 v60, s70, v60
  v_mul_u32_u24 v13, 104, v60
  s_waitcnt lgkmcnt(0)
  s_mov_b32 s28, s4
  s_and_b32 s29, s5, 0xffff
  s_mov_b32 s30, 425984
  s_mov_b32 s31, 0x20000
  buffer_load_dwordx3 v[52:54], v64, s[28:31], s78 offen
  buffer_load_dwordx2 v[44:45], v13, s[28:31], 0 offen offset:0
  buffer_load_dwordx2 v[48:49], v13, s[28:31], 0 offen offset:832
  s_mov_b32 s32, s6
  s_and_b32 s33, s7, 0xffff
  s_mov_b32 s34, 12800000
  s_mov_b32 s35, 0x20000
  v_mov_b32 v68, s80
  buffer_load_dword v255, v68, s[32:35], 0 offen
  v_lshlrev_b32 v37, 4, v0
  s_mov_b32 s48, s14
  s_and_b32 s49, s15, 0xffff
  s_mov_b32 s50, 3328
  s_mov_b32 s51, 0x20000
  s_mov_b32 s44, s12
  s_and_b32 s45, s13, 0xffff
  s_mov_b32 s46, 5537792
  s_mov_b32 s47, 0x20000
  buffer_load_dword v255, v56, s[44:47], s81 offen
  v_mov_b32 v57, v56
  s_add_u32 s85, s81, 212992
  s_mov_b32 m0, 155648
  s_mov_b32 exec_hi, 0xff
  buffer_load_dwordx4 v37, s[48:51], s77 offen lds
  s_mov_b64 exec, -1
  s_mul_i32 s81, s26, 5
  s_add_u32 s81, s81, s27
  s_lshl_b32 s81, s81, 3
  s_add_u32 s81, s81, s3
  s_add_u32 s81, s81, 1664
  s_lshl_b32 s81, s81, 7
  v_min_u32 v56, 2, v0
  v_mul_u32_u24 v56, 163840, v56
  buffer_load_dword v255, v56, s[44:47], s81 offen
  s_lshr_b32 s68, s3, 2
  s_and_b32 s69, s3, 3
  s_mov_b32 s70, 1639
  s_and_b32 s78, s69, 1
  s_lshl_b32 s78, s78, 2
  s_mov_b32 s81, 3328
  v_mov_b32 v60, v0
  v_mul_u32_u24 v61, s70, v60
  v_lshrrev_b32 v61, 16, v61
  v_mul_u32_u24 v64, 40, v61
  v_sub_u32 v64, v60, v64
  v_and_b32 v63, 2, v61
  v_or_b32 v63, s78, v63
  v_xor_b32 v64, v64, v63
  v_mul_u32_u24 v61, s81, v61
  v_lshl_add_u32 v29, v64, 4, v61
  v_add_u32 v60, 64, v60
  v_mul_u32_u24 v61, s70, v60
  v_lshrrev_b32 v61, 16, v61
  v_mul_u32_u24 v64, 40, v61
  v_sub_u32 v64, v60, v64
  v_and_b32 v63, 2, v61
  v_or_b32 v63, s78, v63
  v_xor_b32 v64, v64, v63
  v_mul_u32_u24 v61, s81, v61
  v_lshl_add_u32 v30, v64, 4, v61
  v_subrev_u32 v30, 1024, v30
  v_add_u32 v60, 64, v60
  v_mul_u32_u24 v61, s70, v60
  v_lshrrev_b32 v61, 16, v61
  v_mul_u32_u24 v64, 40, v61
  v_sub_u32 v64, v60, v64
  v_and_b32 v63, 2, v61
  v_or_b32 v63, s78, v63
  v_xor_b32 v64, v64, v63
  v_mul_u32_u24 v61, s81, v61
  v_lshl_add_u32 v31, v64, 4, v61
  v_subrev_u32 v31, 2048, v31
  v_add_u32 v60, 64, v60
  v_mul_u32_u24 v61, s70, v60
  v_lshrrev_b32 v61, 16, v61
  v_mul_u32_u24 v64, 40, v61
  v_sub_u32 v64, v60, v64
  v_and_b32 v63, 2, v61
  v_or_b32 v63, s78, v63
  v_xor_b32 v64, v64, v63
  v_mul_u32_u24 v61, s81, v61
  v_lshl_add_u32 v32, v64, 4, v61
  v_subrev_u32 v32, 3072, v32
  v_add_u32 v60, 64, v60
  v_mul_u32_u24 v61, s70, v60
  v_lshrrev_b32 v61, 16, v61
  v_mul_u32_u24 v64, 40, v61
  v_sub_u32 v64, v60, v64
  v_and_b32 v63, 2, v61
  v_or_b32 v63, s78, v63
  v_xor_b32 v64, v64, v63
  v_mul_u32_u24 v61, s81, v61
  v_lshl_add_u32 v33, v64, 4, v61
  s_mul_i32 s70, s3, 26624
  s_add_u32 s74, s70, s77
  s_mul_i32 s75, s3, 5120
  s_add_u32 s75, s75, 32768
  s_lshl_b32 s71, s68, 14
  s_lshl_b32 s76, s69, 11
  s_add_u32 s76, s76, s71
  s_xor_b32 s76, s76, 16384
  v_and_b32 v64, 7, v0
  v_lshrrev_b32 v62, 4, v0
  v_xor_b32 v64, v64, v62
  v_lshlrev_b32 v14, 4, v64
  v_xor_b32 v15, 64, v14
  v_and_b32 v64, 15, v0
  v_lshlrev_b32 v64, 7, v64
  s_lshl_b32 s71, s68, 14
  v_bfe_u32 v63, v0, 1, 3
  v_xor_b32 v63, v63, v62
  v_lshl_add_u32 v64, v63, 4, v64
  v_add_u32 v11, s71, v64
  v_xor_b32 v12, 64, v11
  s_mov_b32 s52, s16
  s_and_b32 s53, s17, 0xffff
  s_mov_b32 s54, 3328
  s_mov_b32 s55, 0x20000
  s_mul_i32 s71, s69, 5
  v_bfe_u32 v63, v0, 2, 2
  v_lshl_add_u32 v64, v62, 3, v63
  v_mul_u32_u24 v64, 640, v64
  v_and_b32 v63, 3, v0
  v_lshl_add_u32 v64, v63, 3, v64
  v_add_u32 v64, 32768, v64
  v_bfe_u32 v63, v0, 3, 2
  v_xor_b32 v60, s71, v63
  v_lshl_add_u32 v1, v60, 5, v64
  v_add_u32 v6, 61440, v1
  s_add_u32 s71, s71, 1
  v_xor_b32 v60, s71, v63
  v_lshl_add_u32 v2, v60, 5, v64
  v_add_u32 v7, 61440, v2
  s_add_u32 s71, s71, 1
  v_xor_b32 v60, s71, v63
  v_lshl_add_u32 v3, v60, 5, v64
  v_add_u32 v8, 61440, v3
  s_add_u32 s71, s71, 1
  v_xor_b32 v60, s71, v63
  v_lshl_add_u32 v4, v60, 5, v64
  v_add_u32 v9, 61440, v4
  s_add_u32 s71, s71, 1
  v_xor_b32 v60, s71, v63
  v_lshl_add_u32 v5, v60, 5, v64
  v_add_u32 v10, 61440, v5
  s_add_u32 s71, s71, 1
  s_mul_i32 s71, s69, 160
  s_add_u32 s71, s71, 155648
  v_lshlrev_b32 v64, 3, v62
  v_add_u32 v35, s71, v64
  s_lshl_b32 s70, s69, 1
  s_add_u32 s70, s70, s68
  s_lshl_b32 s70, s70, 8
  s_add_u32 s70, s70, 156928
  v_lshlrev_b32 v36, 2, v0
  v_add_u32 v36, s70, v36
  s_add_u32 m0, s75, 0
  s_nop 0
  buffer_load_dwordx4 v29, s[44:47], s74 offen offset:0 lds
  buffer_load_dwordx4 v30, s[44:47], s74 offen offset:1024 lds
  buffer_load_dwordx4 v31, s[44:47], s74 offen offset:2048 lds
  buffer_load_dwordx4 v32, s[44:47], s74 offen offset:3072 lds
  s_add_u32 m0, m0, 4096
  s_nop 0
  buffer_load_dwordx4 v33, s[44:47], s74 offen offset:0 lds
  s_add_u32 s74, s74, 212992
  buffer_load_dword v255, v57, s[44:47], s85 offen
  s_add_u32 s85, s85, 212992
  s_waitcnt vmcnt(12)
  v_lshlrev_b32 v52, 7, v52
  s_barrier
  buffer_load_dword v255, v52, s[32:35], 0 offen
  s_waitcnt vmcnt(11)
  v_lshl_add_u32 v34, v48, 7, v15
  v_lshl_add_u32 v28, v44, 7, v14
  s_add_u32 m0, s76, 0
  s_nop 0
  buffer_load_dwordx4 v28, s[32:35], 0 offen lds
  s_add_u32 m0, m0, 1024
  s_nop 0
  buffer_load_dwordx4 v34, s[32:35], 0 offen lds
  v_lshlrev_b32 v54, 7, v54
  buffer_load_dword v255, v54, s[32:35], 0 offen
  s_barrier
  s_waitcnt vmcnt(11)
  ds_read_b64 v[220:221], v35 offset:0
  ds_read_b64 v[222:223], v35 offset:32
  ds_read_b64 v[224:225], v35 offset:64
  ds_read_b64 v[226:227], v35 offset:96
  ds_read_b64 v[228:229], v35 offset:128
  s_waitcnt lgkmcnt(4)
  v_lshlrev_b32 v140, 16, v220
  v_and_b32 v141, 0xffff0000, v220
  v_lshlrev_b32 v142, 16, v221
  v_and_b32 v143, 0xffff0000, v221
  s_waitcnt lgkmcnt(3)
  v_lshlrev_b32 v156, 16, v222
  v_and_b32 v157, 0xffff0000, v222
  v_lshlrev_b32 v158, 16, v223
  v_and_b32 v159, 0xffff0000, v223
  s_waitcnt lgkmcnt(2)
  v_lshlrev_b32 v172, 16, v224
  v_and_b32 v173, 0xffff0000, v224
  v_lshlrev_b32 v174, 16, v225
  v_and_b32 v175, 0xffff0000, v225
  s_waitcnt lgkmcnt(1)
  v_lshlrev_b32 v188, 16, v226
  v_and_b32 v189, 0xffff0000, v226
  v_lshlrev_b32 v190, 16, v227
  v_and_b32 v191, 0xffff0000, v227
  s_waitcnt lgkmcnt(0)
  v_lshlrev_b32 v204, 16, v228
  v_and_b32 v205, 0xffff0000, v228
  v_lshlrev_b32 v206, 16, v229
  v_and_b32 v207, 0xffff0000, v229
  v_mov_b64 v[144:145], v[140:141]
  v_mov_b64 v[146:147], v[142:143]
  v_mov_b64 v[148:149], v[140:141]
  v_mov_b64 v[150:151], v[142:143]
  v_mov_b64 v[152:153], v[140:141]
  v_mov_b64 v[154:155], v[142:143]
  v_mov_b64 v[160:161], v[156:157]
  v_mov_b64 v[162:163], v[158:159]
  v_mov_b64 v[164:165], v[156:157]
  v_mov_b64 v[166:167], v[158:159]
  v_mov_b64 v[168:169], v[156:157]
  v_mov_b64 v[170:171], v[158:159]
  v_mov_b64 v[176:177], v[172:173]
  v_mov_b64 v[178:179], v[174:175]
  v_mov_b64 v[180:181], v[172:173]
  v_mov_b64 v[182:183], v[174:175]
  v_mov_b64 v[184:185], v[172:173]
  v_mov_b64 v[186:187], v[174:175]
  v_mov_b64 v[192:193], v[188:189]
  v_mov_b64 v[194:195], v[190:191]
  v_mov_b64 v[196:197], v[188:189]
  v_mov_b64 v[198:199], v[190:191]
  v_mov_b64 v[200:201], v[188:189]
  v_mov_b64 v[202:203], v[190:191]
  v_mov_b64 v[208:209], v[204:205]
  v_mov_b64 v[210:211], v[206:207]
  v_mov_b64 v[212:213], v[204:205]
  v_mov_b64 v[214:215], v[206:207]
  v_mov_b64 v[216:217], v[204:205]
  v_mov_b64 v[218:219], v[206:207]
  s_lshl_b32 s73, s68, 2
  s_add_u32 s73, s73, 4
  buffer_load_dwordx3 v[16:18], v13, s[28:31], s73 offen offset:0
  buffer_load_dwordx3 v[20:22], v13, s[28:31], s73 offen offset:832
  s_add_u32 s73, s73, 12
  s_mov_b32 s72, 0
  s_cmp_lg_u32 s68, 0
  s_cbranch_scc1 L_dnn_h1
L_dnn_h0:
  s_add_u32 m0, s75, 40960
  s_nop 0
  buffer_load_dwordx4 v29, s[44:47], s74 offen offset:0 lds
  buffer_load_dwordx4 v30, s[44:47], s74 offen offset:1024 lds
  buffer_load_dwordx4 v31, s[44:47], s74 offen offset:2048 lds
  buffer_load_dwordx4 v32, s[44:47], s74 offen offset:3072 lds
  s_add_u32 m0, m0, 4096
  s_nop 0
  buffer_load_dwordx4 v33, s[44:47], s74 offen offset:0 lds
  s_add_u32 s74, s74, 212992
  s_waitcnt vmcnt(12) lgkmcnt(0)
  s_barrier
  buffer_load_dwordx3 v[24:26], v13, s[28:31], s73 offen offset:0
  buffer_load_dwordx3 v[240:242], v13, s[28:31], s73 offen offset:832
  s_add_u32 s73, s73, 12
L_dnn_loop0:
  ds_read_b64_tr_b16 v[40:41], v1 offset:0
  s_add_u32 m0, s75, 81920
  s_nop 0
  buffer_load_dwordx4 v29, s[44:47], s74 offen offset:0 lds
  ds_read_b64_tr_b16 v[42:43], v1 offset:2560
  ds_read_b64_tr_b16 v[44:45], v1 offset:20480
  ds_read_b64_tr_b16 v[46:47], v1 offset:23040
  ds_read_b64_tr_b16 v[48:49], v2 offset:0
  buffer_load_dwordx4 v30, s[44:47], s74 offen offset:1024 lds
  ds_read_b64_tr_b16 v[50:51], v2 offset:2560
  ds_read_b64_tr_b16 v[52:53], v2 offset:20480
  ds_read_b64_tr_b16 v[54:55], v2 offset:23040
  ds_read_b64_tr_b16 v[56:57], v3 offset:0
  buffer_load_dwordx4 v31, s[44:47], s74 offen offset:2048 lds
  ds_read_b64_tr_b16 v[58:59], v3 offset:2560
  ds_read_b64_tr_b16 v[60:61], v3 offset:20480
  ds_read_b64_tr_b16 v[62:63], v3 offset:23040
  ds_read_b64_tr_b16 v[64:65], v4 offset:0
  buffer_load_dwordx4 v32, s[44:47], s74 offen offset:3072 lds
  ds_read_b64_tr_b16 v[66:67], v4 offset:2560
  ds_read_b64_tr_b16 v[68:69], v4 offset:20480
  ds_read_b64_tr_b16 v[70:71], v4 offset:23040
  ds_read_b128 v[80:83], v11 offset:0
  s_add_u32 m0, m0, 4096
  s_nop 0
  buffer_load_dwordx4 v33, s[44:47], s74 offen offset:0 lds
  s_add_u32 s74, s74, 212992
  ds_read_b128 v[84:87], v12 offset:0
  ds_read_b128 v[88:91], v11 offset:2048
  ds_read_b128 v[92:95], v12 offset:2048
  ds_read_b128 v[96:99], v11 offset:4096
  s_waitcnt vmcnt(12)
  v_lshl_add_u32 v34, v20, 7, v15
  v_lshl_add_u32 v28, v16, 7, v14
  s_add_u32 m0, s76, 8192
  s_nop 0
  buffer_load_dwordx4 v28, s[32:35], 0 offen lds
  ds_read_b128 v[100:103], v12 offset:4096
  ds_read_b128 v[104:107], v11 offset:6144
  ds_read_b128 v[108:111], v12 offset:6144
  ds_read_b64_tr_b16 v[72:73], v5 offset:0
  s_add_u32 m0, m0, 1024
  s_nop 0
  buffer_load_dwordx4 v34, s[32:35], 0 offen lds
  ds_read_b64_tr_b16 v[74:75], v5 offset:2560
  ds_read_b64_tr_b16 v[76:77], v5 offset:20480
  ds_read_b64_tr_b16 v[78:79], v5 offset:23040
L_dnn_in0:
  s_waitcnt vmcnt(9) lgkmcnt(0)
  s_barrier
  s_setprio 0
  v_mfma_f32_16x16x32_bf16 v[140:143], v[40:43], v[80:83], v[140:143]
  v_mfma_f32_16x16x32_bf16 v[140:143], v[44:47], v[84:87], v[140:143]
  v_mfma_f32_16x16x32_bf16 v[144:147], v[40:43], v[88:91], v[144:147]
  v_mfma_f32_16x16x32_bf16 v[144:147], v[44:47], v[92:95], v[144:147]
  v_mfma_f32_16x16x32_bf16 v[148:151], v[40:43], v[96:99], v[148:151]
  v_mfma_f32_16x16x32_bf16 v[148:151], v[44:47], v[100:103], v[148:151]
  v_mfma_f32_16x16x32_bf16 v[152:155], v[40:43], v[104:107], v[152:155]
  v_mfma_f32_16x16x32_bf16 v[152:155], v[44:47], v[108:111], v[152:155]
  v_mfma_f32_16x16x32_bf16 v[168:171], v[48:51], v[104:107], v[168:171]
  v_mfma_f32_16x16x32_bf16 v[168:171], v[52:55], v[108:111], v[168:171]
  v_mfma_f32_16x16x32_bf16 v[164:167], v[48:51], v[96:99], v[164:167]
  v_mfma_f32_16x16x32_bf16 v[164:167], v[52:55], v[100:103], v[164:167]
  v_mfma_f32_16x16x32_bf16 v[160:163], v[48:51], v[88:91], v[160:163]
  v_mfma_f32_16x16x32_bf16 v[160:163], v[52:55], v[92:95], v[160:163]
  v_mfma_f32_16x16x32_bf16 v[156:159], v[48:51], v[80:83], v[156:159]
  v_mfma_f32_16x16x32_bf16 v[156:159], v[52:55], v[84:87], v[156:159]
  v_mfma_f32_16x16x32_bf16 v[172:175], v[56:59], v[80:83], v[172:175]
  v_mfma_f32_16x16x32_bf16 v[172:175], v[60:63], v[84:87], v[172:175]
  v_mfma_f32_16x16x32_bf16 v[176:179], v[56:59], v[88:91], v[176:179]
  v_mfma_f32_16x16x32_bf16 v[176:179], v[60:63], v[92:95], v[176:179]
  v_mfma_f32_16x16x32_bf16 v[180:183], v[56:59], v[96:99], v[180:183]
  v_mfma_f32_16x16x32_bf16 v[180:183], v[60:63], v[100:103], v[180:183]
  v_mfma_f32_16x16x32_bf16 v[184:187], v[56:59], v[104:107], v[184:187]
  v_mfma_f32_16x16x32_bf16 v[184:187], v[60:63], v[108:111], v[184:187]
  v_mfma_f32_16x16x32_bf16 v[200:203], v[64:67], v[104:107], v[200:203]
  v_mfma_f32_16x16x32_bf16 v[200:203], v[68:71], v[108:111], v[200:203]
  v_mfma_f32_16x16x32_bf16 v[196:199], v[64:67], v[96:99], v[196:199]
  v_mfma_f32_16x16x32_bf16 v[196:199], v[68:71], v[100:103], v[196:199]
  v_mfma_f32_16x16x32_bf16 v[192:195], v[64:67], v[88:91], v[192:195]
  v_mfma_f32_16x16x32_bf16 v[192:195], v[68:71], v[92:95], v[192:195]
  v_mfma_f32_16x16x32_bf16 v[188:191], v[64:67], v[80:83], v[188:191]
  v_mfma_f32_16x16x32_bf16 v[188:191], v[68:71], v[84:87], v[188:191]
  v_mfma_f32_16x16x32_bf16 v[204:207], v[72:75], v[80:83], v[204:207]
  v_mfma_f32_16x16x32_bf16 v[204:207], v[76:79], v[84:87], v[204:207]
  v_mfma_f32_16x16x32_bf16 v[208:211], v[72:75], v[88:91], v[208:211]
  v_mfma_f32_16x16x32_bf16 v[208:211], v[76:79], v[92:95], v[208:211]
  v_mfma_f32_16x16x32_bf16 v[212:215], v[72:75], v[96:99], v[212:215]
  v_mfma_f32_16x16x32_bf16 v[212:215], v[76:79], v[100:103], v[212:215]
  v_mfma_f32_16x16x32_bf16 v[216:219], v[72:75], v[104:107], v[216:219]
  s_setprio 2
  s_waitcnt vmcnt(9)
  s_barrier
  v_mfma_f32_16x16x32_bf16 v[216:219], v[76:79], v[108:111], v[216:219]
  ds_read_b64_tr_b16 v[40:41], v1 offset:40960
  s_add_u32 m0, s75, 0
  s_nop 0
  buffer_load_dwordx4 v29, s[44:47], s74 offen offset:0 lds
  ds_read_b64_tr_b16 v[42:43], v1 offset:43520
  ds_read_b64_tr_b16 v[44:45], v6 offset:0
  ds_read_b64_tr_b16 v[46:47], v6 offset:2560
  ds_read_b64_tr_b16 v[48:49], v2 offset:40960
  buffer_load_dwordx4 v30, s[44:47], s74 offen offset:1024 lds
  ds_read_b64_tr_b16 v[50:51], v2 offset:43520
  ds_read_b64_tr_b16 v[52:53], v7 offset:0
  ds_read_b64_tr_b16 v[54:55], v7 offset:2560
  ds_read_b64_tr_b16 v[56:57], v3 offset:40960
  buffer_load_dwordx4 v31, s[44:47], s74 offen offset:2048 lds
  ds_read_b64_tr_b16 v[58:59], v3 offset:43520
  ds_read_b64_tr_b16 v[60:61], v8 offset:0
  ds_read_b64_tr_b16 v[62:63], v8 offset:2560
  ds_read_b64_tr_b16 v[64:65], v4 offset:40960
  buffer_load_dwordx4 v32, s[44:47], s74 offen offset:3072 lds
  ds_read_b64_tr_b16 v[66:67], v4 offset:43520
  ds_read_b64_tr_b16 v[68:69], v9 offset:0
  ds_read_b64_tr_b16 v[70:71], v9 offset:2560
  ds_read_b128 v[80:83], v11 offset:8192
  s_add_u32 m0, m0, 4096
  s_nop 0
  buffer_load_dwordx4 v33, s[44:47], s74 offen offset:0 lds
  s_add_u32 s74, s74, 212992
  ds_read_b128 v[84:87], v12 offset:8192
  ds_read_b128 v[88:91], v11 offset:10240
  ds_read_b128 v[92:95], v12 offset:10240
  ds_read_b128 v[96:99], v11 offset:12288
  v_lshl_add_u32 v34, v21, 7, v15
  v_lshl_add_u32 v28, v17, 7, v14
  s_add_u32 m0, s76, 0
  s_nop 0
  buffer_load_dwordx4 v28, s[32:35], 0 offen lds
  ds_read_b128 v[100:103], v12 offset:12288
  ds_read_b128 v[104:107], v11 offset:14336
  ds_read_b128 v[108:111], v12 offset:14336
  ds_read_b64_tr_b16 v[72:73], v5 offset:40960
  s_add_u32 m0, m0, 1024
  s_nop 0
  buffer_load_dwordx4 v34, s[32:35], 0 offen lds
  ds_read_b64_tr_b16 v[74:75], v5 offset:43520
  ds_read_b64_tr_b16 v[76:77], v10 offset:0
  ds_read_b64_tr_b16 v[78:79], v10 offset:2560
  s_waitcnt vmcnt(7) lgkmcnt(0)
  s_barrier
  s_setprio 0
  v_mfma_f32_16x16x32_bf16 v[140:143], v[40:43], v[80:83], v[140:143]
  v_mfma_f32_16x16x32_bf16 v[140:143], v[44:47], v[84:87], v[140:143]
  v_mfma_f32_16x16x32_bf16 v[144:147], v[40:43], v[88:91], v[144:147]
  v_mfma_f32_16x16x32_bf16 v[144:147], v[44:47], v[92:95], v[144:147]
  v_mfma_f32_16x16x32_bf16 v[148:151], v[40:43], v[96:99], v[148:151]
  v_mfma_f32_16x16x32_bf16 v[148:151], v[44:47], v[100:103], v[148:151]
  v_mfma_f32_16x16x32_bf16 v[152:155], v[40:43], v[104:107], v[152:155]
  v_mfma_f32_16x16x32_bf16 v[152:155], v[44:47], v[108:111], v[152:155]
  v_mfma_f32_16x16x32_bf16 v[168:171], v[48:51], v[104:107], v[168:171]
  v_mfma_f32_16x16x32_bf16 v[168:171], v[52:55], v[108:111], v[168:171]
  v_mfma_f32_16x16x32_bf16 v[164:167], v[48:51], v[96:99], v[164:167]
  v_mfma_f32_16x16x32_bf16 v[164:167], v[52:55], v[100:103], v[164:167]
  v_mfma_f32_16x16x32_bf16 v[160:163], v[48:51], v[88:91], v[160:163]
  v_mfma_f32_16x16x32_bf16 v[160:163], v[52:55], v[92:95], v[160:163]
  v_mfma_f32_16x16x32_bf16 v[156:159], v[48:51], v[80:83], v[156:159]
  v_mfma_f32_16x16x32_bf16 v[156:159], v[52:55], v[84:87], v[156:159]
  v_mfma_f32_16x16x32_bf16 v[172:175], v[56:59], v[80:83], v[172:175]
  v_mfma_f32_16x16x32_bf16 v[172:175], v[60:63], v[84:87], v[172:175]
  v_mfma_f32_16x16x32_bf16 v[176:179], v[56:59], v[88:91], v[176:179]
  v_mfma_f32_16x16x32_bf16 v[176:179], v[60:63], v[92:95], v[176:179]
  v_mfma_f32_16x16x32_bf16 v[180:183], v[56:59], v[96:99], v[180:183]
  v_mfma_f32_16x16x32_bf16 v[180:183], v[60:63], v[100:103], v[180:183]
  v_mfma_f32_16x16x32_bf16 v[184:187], v[56:59], v[104:107], v[184:187]
  v_mfma_f32_16x16x32_bf16 v[184:187], v[60:63], v[108:111], v[184:187]
  v_mfma_f32_16x16x32_bf16 v[200:203], v[64:67], v[104:107], v[200:203]
  v_mfma_f32_16x16x32_bf16 v[200:203], v[68:71], v[108:111], v[200:203]
  v_mfma_f32_16x16x32_bf16 v[196:199], v[64:67], v[96:99], v[196:199]
  v_mfma_f32_16x16x32_bf16 v[196:199], v[68:71], v[100:103], v[196:199]
  v_mfma_f32_16x16x32_bf16 v[192:195], v[64:67], v[88:91], v[192:195]
  v_mfma_f32_16x16x32_bf16 v[192:195], v[68:71], v[92:95], v[192:195]
  v_mfma_f32_16x16x32_bf16 v[188:191], v[64:67], v[80:83], v[188:191]
  v_mfma_f32_16x16x32_bf16 v[188:191], v[68:71], v[84:87], v[188:191]
  v_mfma_f32_16x16x32_bf16 v[204:207], v[72:75], v[80:83], v[204:207]
  v_mfma_f32_16x16x32_bf16 v[204:207], v[76:79], v[84:87], v[204:207]
  v_mfma_f32_16x16x32_bf16 v[208:211], v[72:75], v[88:91], v[208:211]
  v_mfma_f32_16x16x32_bf16 v[208:211], v[76:79], v[92:95], v[208:211]
  v_mfma_f32_16x16x32_bf16 v[212:215], v[72:75], v[96:99], v[212:215]
  v_mfma_f32_16x16x32_bf16 v[212:215], v[76:79], v[100:103], v[212:215]
  v_mfma_f32_16x16x32_bf16 v[216:219], v[72:75], v[104:107], v[216:219]
  s_setprio 2
  s_barrier
  v_mfma_f32_16x16x32_bf16 v[216:219], v[76:79], v[108:111], v[216:219]
  ds_read_b64_tr_b16 v[40:41], v6 offset:20480
  s_add_u32 m0, s75, 40960
  s_nop 0
  buffer_load_dwordx4 v29, s[44:47], s74 offen offset:0 lds
  ds_read_b64_tr_b16 v[42:43], v6 offset:23040
  ds_read_b64_tr_b16 v[44:45], v6 offset:40960
  ds_read_b64_tr_b16 v[46:47], v6 offset:43520
  ds_read_b64_tr_b16 v[48:49], v7 offset:20480
  buffer_load_dwordx4 v30, s[44:47], s74 offen offset:1024 lds
  ds_read_b64_tr_b16 v[50:51], v7 offset:23040
  ds_read_b64_tr_b16 v[52:53], v7 offset:40960
  ds_read_b64_tr_b16 v[54:55], v7 offset:43520
  ds_read_b64_tr_b16 v[56:57], v8 offset:20480
  buffer_load_dwordx4 v31, s[44:47], s74 offen offset:2048 lds
  ds_read_b64_tr_b16 v[58:59], v8 offset:23040
  ds_read_b64_tr_b16 v[60:61], v8 offset:40960
  ds_read_b64_tr_b16 v[62:63], v8 offset:43520
  ds_read_b64_tr_b16 v[64:65], v9 offset:20480
  buffer_load_dwordx4 v32, s[44:47], s74 offen offset:3072 lds
  ds_read_b64_tr_b16 v[66:67], v9 offset:23040
  ds_read_b64_tr_b16 v[68:69], v9 offset:40960
  ds_read_b64_tr_b16 v[70:71], v9 offset:43520
  ds_read_b128 v[80:83], v11 offset:0
  s_add_u32 m0, m0, 4096
  s_nop 0
  buffer_load_dwordx4 v33, s[44:47], s74 offen offset:0 lds
  s_add_u32 s74, s74, 212992
  ds_read_b128 v[84:87], v12 offset:0
  ds_read_b128 v[88:91], v11 offset:2048
  ds_read_b128 v[92:95], v12 offset:2048
  ds_read_b128 v[96:99], v11 offset:4096
  v_lshl_add_u32 v34, v22, 7, v15
  v_lshl_add_u32 v28, v18, 7, v14
  s_add_u32 m0, s76, 8192
  s_nop 0
  buffer_load_dwordx4 v28, s[32:35], 0 offen lds
  ds_read_b128 v[100:103], v12 offset:4096
  ds_read_b128 v[104:107], v11 offset:6144
  ds_read_b128 v[108:111], v12 offset:6144
  ds_read_b64_tr_b16 v[72:73], v10 offset:20480
  s_add_u32 m0, m0, 1024
  s_nop 0
  buffer_load_dwordx4 v34, s[32:35], 0 offen lds
  ds_read_b64_tr_b16 v[74:75], v10 offset:23040
  ds_read_b64_tr_b16 v[76:77], v10 offset:40960
  ds_read_b64_tr_b16 v[78:79], v10 offset:43520
  buffer_load_dwordx3 v[16:18], v13, s[28:31], s73 offen offset:0
  buffer_load_dwordx3 v[20:22], v13, s[28:31], s73 offen offset:832
  s_add_u32 s73, s73, 12
  s_waitcnt vmcnt(9) lgkmcnt(0)
  s_barrier
  s_setprio 0
  v_mfma_f32_16x16x32_bf16 v[140:143], v[40:43], v[80:83], v[140:143]
  v_mfma_f32_16x16x32_bf16 v[140:143], v[44:47], v[84:87], v[140:143]
  v_mfma_f32_16x16x32_bf16 v[144:147], v[40:43], v[88:91], v[144:147]
  v_mfma_f32_16x16x32_bf16 v[144:147], v[44:47], v[92:95], v[144:147]
  v_mfma_f32_16x16x32_bf16 v[148:151], v[40:43], v[96:99], v[148:151]
  v_mfma_f32_16x16x32_bf16 v[148:151], v[44:47], v[100:103], v[148:151]
  v_mfma_f32_16x16x32_bf16 v[152:155], v[40:43], v[104:107], v[152:155]
  v_mfma_f32_16x16x32_bf16 v[152:155], v[44:47], v[108:111], v[152:155]
  v_mfma_f32_16x16x32_bf16 v[168:171], v[48:51], v[104:107], v[168:171]
  v_mfma_f32_16x16x32_bf16 v[168:171], v[52:55], v[108:111], v[168:171]
  v_mfma_f32_16x16x32_bf16 v[164:167], v[48:51], v[96:99], v[164:167]
  v_mfma_f32_16x16x32_bf16 v[164:167], v[52:55], v[100:103], v[164:167]
  v_mfma_f32_16x16x32_bf16 v[160:163], v[48:51], v[88:91], v[160:163]
  v_mfma_f32_16x16x32_bf16 v[160:163], v[52:55], v[92:95], v[160:163]
  v_mfma_f32_16x16x32_bf16 v[156:159], v[48:51], v[80:83], v[156:159]
  v_mfma_f32_16x16x32_bf16 v[156:159], v[52:55], v[84:87], v[156:159]
  v_mfma_f32_16x16x32_bf16 v[172:175], v[56:59], v[80:83], v[172:175]
  v_mfma_f32_16x16x32_bf16 v[172:175], v[60:63], v[84:87], v[172:175]
  v_mfma_f32_16x16x32_bf16 v[176:179], v[56:59], v[88:91], v[176:179]
  v_mfma_f32_16x16x32_bf16 v[176:179], v[60:63], v[92:95], v[176:179]
  v_mfma_f32_16x16x32_bf16 v[180:183], v[56:59], v[96:99], v[180:183]
  v_mfma_f32_16x16x32_bf16 v[180:183], v[60:63], v[100:103], v[180:183]
  v_mfma_f32_16x16x32_bf16 v[184:187], v[56:59], v[104:107], v[184:187]
  v_mfma_f32_16x16x32_bf16 v[184:187], v[60:63], v[108:111], v[184:187]
  v_mfma_f32_16x16x32_bf16 v[200:203], v[64:67], v[104:107], v[200:203]
  v_mfma_f32_16x16x32_bf16 v[200:203], v[68:71], v[108:111], v[200:203]
  v_mfma_f32_16x16x32_bf16 v[196:199], v[64:67], v[96:99], v[196:199]
  v_mfma_f32_16x16x32_bf16 v[196:199], v[68:71], v[100:103], v[196:199]
  v_mfma_f32_16x16x32_bf16 v[192:195], v[64:67], v[88:91], v[192:195]
  v_mfma_f32_16x16x32_bf16 v[192:195], v[68:71], v[92:95], v[192:195]
  v_mfma_f32_16x16x32_bf16 v[188:191], v[64:67], v[80:83], v[188:191]
  v_mfma_f32_16x16x32_bf16 v[188:191], v[68:71], v[84:87], v[188:191]
  v_mfma_f32_16x16x32_bf16 v[204:207], v[72:75], v[80:83], v[204:207]
  v_mfma_f32_16x16x32_bf16 v[204:207], v[76:79], v[84:87], v[204:207]
  v_mfma_f32_16x16x32_bf16 v[208:211], v[72:75], v[88:91], v[208:211]
  v_mfma_f32_16x16x32_bf16 v[208:211], v[76:79], v[92:95], v[208:211]
  v_mfma_f32_16x16x32_bf16 v[212:215], v[72:75], v[96:99], v[212:215]
  v_mfma_f32_16x16x32_bf16 v[212:215], v[76:79], v[100:103], v[212:215]
  v_mfma_f32_16x16x32_bf16 v[216:219], v[72:75], v[104:107], v[216:219]
  s_setprio 2
  s_barrier
  v_mfma_f32_16x16x32_bf16 v[216:219], v[76:79], v[108:111], v[216:219]
  ds_read_b64_tr_b16 v[40:41], v1 offset:0
  s_add_u32 m0, s75, 81920
  s_nop 0
  buffer_load_dwordx4 v29, s[44:47], s74 offen offset:0 lds
  ds_read_b64_tr_b16 v[42:43], v1 offset:2560
  ds_read_b64_tr_b16 v[44:45], v1 offset:20480
  ds_read_b64_tr_b16 v[46:47], v1 offset:23040
  ds_read_b64_tr_b16 v[48:49], v2 offset:0
  buffer_load_dwordx4 v30, s[44:47], s74 offen offset:1024 lds
  ds_read_b64_tr_b16 v[50:51], v2 offset:2560
  ds_read_b64_tr_b16 v[52:53], v2 offset:20480
  ds_read_b64_tr_b16 v[54:55], v2 offset:23040
  ds_read_b64_tr_b16 v[56:57], v3 offset:0
  buffer_load_dwordx4 v31, s[44:47], s74 offen offset:2048 lds
  ds_read_b64_tr_b16 v[58:59], v3 offset:2560
  ds_read_b64_tr_b16 v[60:61], v3 offset:20480
  ds_read_b64_tr_b16 v[62:63], v3 offset:23040
  ds_read_b64_tr_b16 v[64:65], v4 offset:0
  buffer_load_dwordx4 v32, s[44:47], s74 offen offset:3072 lds
  ds_read_b64_tr_b16 v[66:67], v4 offset:2560
  ds_read_b64_tr_b16 v[68:69], v4 offset:20480
  ds_read_b64_tr_b16 v[70:71], v4 offset:23040
  ds_read_b128 v[80:83], v11 offset:8192
  s_add_u32 m0, m0, 4096
  s_nop 0
  buffer_load_dwordx4 v33, s[44:47], s74 offen offset:0 lds
  s_add_u32 s74, s74, 212992
  ds_read_b128 v[84:87], v12 offset:8192
  ds_read_b128 v[88:91], v11 offset:10240
  ds_read_b128 v[92:95], v12 offset:10240
  ds_read_b128 v[96:99], v11 offset:12288
  v_lshl_add_u32 v34, v240, 7, v15
  v_lshl_add_u32 v28, v24, 7, v14
  s_add_u32 m0, s76, 0
  s_nop 0
  buffer_load_dwordx4 v28, s[32:35], 0 offen lds
  ds_read_b128 v[100:103], v12 offset:12288
  ds_read_b128 v[104:107], v11 offset:14336
  ds_read_b128 v[108:111], v12 offset:14336
  ds_read_b64_tr_b16 v[72:73], v5 offset:0
  s_add_u32 m0, m0, 1024
  s_nop 0
  buffer_load_dwordx4 v34, s[32:35], 0 offen lds
  ds_read_b64_tr_b16 v[74:75], v5 offset:2560
  ds_read_b64_tr_b16 v[76:77], v5 offset:20480
  ds_read_b64_tr_b16 v[78:79], v5 offset:23040
  s_waitcnt vmcnt(9) lgkmcnt(0)
  s_barrier
  s_setprio 0
  v_mfma_f32_16x16x32_bf16 v[140:143], v[40:43], v[80:83], v[140:143]
  v_mfma_f32_16x16x32_bf16 v[140:143], v[44:47], v[84:87], v[140:143]
  v_mfma_f32_16x16x32_bf16 v[144:147], v[40:43], v[88:91], v[144:147]
  v_mfma_f32_16x16x32_bf16 v[144:147], v[44:47], v[92:95], v[144:147]
  v_mfma_f32_16x16x32_bf16 v[148:151], v[40:43], v[96:99], v[148:151]
  v_mfma_f32_16x16x32_bf16 v[148:151], v[44:47], v[100:103], v[148:151]
  v_mfma_f32_16x16x32_bf16 v[152:155], v[40:43], v[104:107], v[152:155]
  v_mfma_f32_16x16x32_bf16 v[152:155], v[44:47], v[108:111], v[152:155]
  v_mfma_f32_16x16x32_bf16 v[168:171], v[48:51], v[104:107], v[168:171]
  v_mfma_f32_16x16x32_bf16 v[168:171], v[52:55], v[108:111], v[168:171]
  v_mfma_f32_16x16x32_bf16 v[164:167], v[48:51], v[96:99], v[164:167]
  v_mfma_f32_16x16x32_bf16 v[164:167], v[52:55], v[100:103], v[164:167]
  v_mfma_f32_16x16x32_bf16 v[160:163], v[48:51], v[88:91], v[160:163]
  v_mfma_f32_16x16x32_bf16 v[160:163], v[52:55], v[92:95], v[160:163]
  v_mfma_f32_16x16x32_bf16 v[156:159], v[48:51], v[80:83], v[156:159]
  v_mfma_f32_16x16x32_bf16 v[156:159], v[52:55], v[84:87], v[156:159]
  v_mfma_f32_16x16x32_bf16 v[172:175], v[56:59], v[80:83], v[172:175]
  v_mfma_f32_16x16x32_bf16 v[172:175], v[60:63], v[84:87], v[172:175]
  v_mfma_f32_16x16x32_bf16 v[176:179], v[56:59], v[88:91], v[176:179]
  v_mfma_f32_16x16x32_bf16 v[176:179], v[60:63], v[92:95], v[176:179]
  v_mfma_f32_16x16x32_bf16 v[180:183], v[56:59], v[96:99], v[180:183]
  v_mfma_f32_16x16x32_bf16 v[180:183], v[60:63], v[100:103], v[180:183]
  v_mfma_f32_16x16x32_bf16 v[184:187], v[56:59], v[104:107], v[184:187]
  v_mfma_f32_16x16x32_bf16 v[184:187], v[60:63], v[108:111], v[184:187]
  v_mfma_f32_16x16x32_bf16 v[200:203], v[64:67], v[104:107], v[200:203]
  v_mfma_f32_16x16x32_bf16 v[200:203], v[68:71], v[108:111], v[200:203]
  v_mfma_f32_16x16x32_bf16 v[196:199], v[64:67], v[96:99], v[196:199]
  v_mfma_f32_16x16x32_bf16 v[196:199], v[68:71], v[100:103], v[196:199]
  v_mfma_f32_16x16x32_bf16 v[192:195], v[64:67], v[88:91], v[192:195]
  v_mfma_f32_16x16x32_bf16 v[192:195], v[68:71], v[92:95], v[192:195]
  v_mfma_f32_16x16x32_bf16 v[188:191], v[64:67], v[80:83], v[188:191]
  v_mfma_f32_16x16x32_bf16 v[188:191], v[68:71], v[84:87], v[188:191]
  v_mfma_f32_16x16x32_bf16 v[204:207], v[72:75], v[80:83], v[204:207]
  v_mfma_f32_16x16x32_bf16 v[204:207], v[76:79], v[84:87], v[204:207]
  v_mfma_f32_16x16x32_bf16 v[208:211], v[72:75], v[88:91], v[208:211]
  v_mfma_f32_16x16x32_bf16 v[208:211], v[76:79], v[92:95], v[208:211]
  v_mfma_f32_16x16x32_bf16 v[212:215], v[72:75], v[96:99], v[212:215]
  v_mfma_f32_16x16x32_bf16 v[212:215], v[76:79], v[100:103], v[212:215]
  v_mfma_f32_16x16x32_bf16 v[216:219], v[72:75], v[104:107], v[216:219]
  s_setprio 2
  s_barrier
  v_mfma_f32_16x16x32_bf16 v[216:219], v[76:79], v[108:111], v[216:219]
  ds_read_b64_tr_b16 v[40:41], v1 offset:40960
  s_add_u32 m0, s75, 0
  s_nop 0
  buffer_load_dwordx4 v29, s[44:47], s74 offen offset:0 lds
  ds_read_b64_tr_b16 v[42:43], v1 offset:43520
  ds_read_b64_tr_b16 v[44:45], v6 offset:0
  ds_read_b64_tr_b16 v[46:47], v6 offset:2560
  ds_read_b64_tr_b16 v[48:49], v2 offset:40960
  buffer_load_dwordx4 v30, s[44:47], s74 offen offset:1024 lds
  ds_read_b64_tr_b16 v[50:51], v2 offset:43520
  ds_read_b64_tr_b16 v[52:53], v7 offset:0
  ds_read_b64_tr_b16 v[54:55], v7 offset:2560
  ds_read_b64_tr_b16 v[56:57], v3 offset:40960
  buffer_load_dwordx4 v31, s[44:47], s74 offen offset:2048 lds
  ds_read_b64_tr_b16 v[58:59], v3 offset:43520
  ds_read_b64_tr_b16 v[60:61], v8 offset:0
  ds_read_b64_tr_b16 v[62:63], v8 offset:2560
  ds_read_b64_tr_b16 v[64:65], v4 offset:40960
  buffer_load_dwordx4 v32, s[44:47], s74 offen offset:3072 lds
  ds_read_b64_tr_b16 v[66:67], v4 offset:43520
  ds_read_b64_tr_b16 v[68:69], v9 offset:0
  ds_read_b64_tr_b16 v[70:71], v9 offset:2560
  ds_read_b128 v[80:83], v11 offset:0
  s_add_u32 m0, m0, 4096
  s_nop 0
  buffer_load_dwordx4 v33, s[44:47], s74 offen offset:0 lds
  s_add_u32 s74, s74, 212992
  ds_read_b128 v[84:87], v12 offset:0
  ds_read_b128 v[88:91], v11 offset:2048
  ds_read_b128 v[92:95], v12 offset:2048
  ds_read_b128 v[96:99], v11 offset:4096
  v_lshl_add_u32 v34, v241, 7, v15
  v_lshl_add_u32 v28, v25, 7, v14
  s_add_u32 m0, s76, 8192
  s_nop 0
  buffer_load_dwordx4 v28, s[32:35], 0 offen lds
  ds_read_b128 v[100:103], v12 offset:4096
  ds_read_b128 v[104:107], v11 offset:6144
  ds_read_b128 v[108:111], v12 offset:6144
  ds_read_b64_tr_b16 v[72:73], v5 offset:40960
  s_add_u32 m0, m0, 1024
  s_nop 0
  buffer_load_dwordx4 v34, s[32:35], 0 offen lds
  ds_read_b64_tr_b16 v[74:75], v5 offset:43520
  ds_read_b64_tr_b16 v[76:77], v10 offset:0
  ds_read_b64_tr_b16 v[78:79], v10 offset:2560
  s_waitcnt vmcnt(7) lgkmcnt(0)
  s_barrier
  s_setprio 0
  v_mfma_f32_16x16x32_bf16 v[140:143], v[40:43], v[80:83], v[140:143]
  v_mfma_f32_16x16x32_bf16 v[140:143], v[44:47], v[84:87], v[140:143]
  v_mfma_f32_16x16x32_bf16 v[144:147], v[40:43], v[88:91], v[144:147]
  v_mfma_f32_16x16x32_bf16 v[144:147], v[44:47], v[92:95], v[144:147]
  v_mfma_f32_16x16x32_bf16 v[148:151], v[40:43], v[96:99], v[148:151]
  v_mfma_f32_16x16x32_bf16 v[148:151], v[44:47], v[100:103], v[148:151]
  v_mfma_f32_16x16x32_bf16 v[152:155], v[40:43], v[104:107], v[152:155]
  v_mfma_f32_16x16x32_bf16 v[152:155], v[44:47], v[108:111], v[152:155]
  v_mfma_f32_16x16x32_bf16 v[168:171], v[48:51], v[104:107], v[168:171]
  v_mfma_f32_16x16x32_bf16 v[168:171], v[52:55], v[108:111], v[168:171]
  v_mfma_f32_16x16x32_bf16 v[164:167], v[48:51], v[96:99], v[164:167]
  v_mfma_f32_16x16x32_bf16 v[164:167], v[52:55], v[100:103], v[164:167]
  v_mfma_f32_16x16x32_bf16 v[160:163], v[48:51], v[88:91], v[160:163]
  v_mfma_f32_16x16x32_bf16 v[160:163], v[52:55], v[92:95], v[160:163]
  v_mfma_f32_16x16x32_bf16 v[156:159], v[48:51], v[80:83], v[156:159]
  v_mfma_f32_16x16x32_bf16 v[156:159], v[52:55], v[84:87], v[156:159]
  v_mfma_f32_16x16x32_bf16 v[172:175], v[56:59], v[80:83], v[172:175]
  v_mfma_f32_16x16x32_bf16 v[172:175], v[60:63], v[84:87], v[172:175]
  v_mfma_f32_16x16x32_bf16 v[176:179], v[56:59], v[88:91], v[176:179]
  v_mfma_f32_16x16x32_bf16 v[176:179], v[60:63], v[92:95], v[176:179]
  v_mfma_f32_16x16x32_bf16 v[180:183], v[56:59], v[96:99], v[180:183]
  v_mfma_f32_16x16x32_bf16 v[180:183], v[60:63], v[100:103], v[180:183]
  v_mfma_f32_16x16x32_bf16 v[184:187], v[56:59], v[104:107], v[184:187]
  v_mfma_f32_16x16x32_bf16 v[184:187], v[60:63], v[108:111], v[184:187]
  v_mfma_f32_16x16x32_bf16 v[200:203], v[64:67], v[104:107], v[200:203]
  v_mfma_f32_16x16x32_bf16 v[200:203], v[68:71], v[108:111], v[200:203]
  v_mfma_f32_16x16x32_bf16 v[196:199], v[64:67], v[96:99], v[196:199]
  v_mfma_f32_16x16x32_bf16 v[196:199], v[68:71], v[100:103], v[196:199]
  v_mfma_f32_16x16x32_bf16 v[192:195], v[64:67], v[88:91], v[192:195]
  v_mfma_f32_16x16x32_bf16 v[192:195], v[68:71], v[92:95], v[192:195]
  v_mfma_f32_16x16x32_bf16 v[188:191], v[64:67], v[80:83], v[188:191]
  v_mfma_f32_16x16x32_bf16 v[188:191], v[68:71], v[84:87], v[188:191]
  v_mfma_f32_16x16x32_bf16 v[204:207], v[72:75], v[80:83], v[204:207]
  v_mfma_f32_16x16x32_bf16 v[204:207], v[76:79], v[84:87], v[204:207]
  v_mfma_f32_16x16x32_bf16 v[208:211], v[72:75], v[88:91], v[208:211]
  v_mfma_f32_16x16x32_bf16 v[208:211], v[76:79], v[92:95], v[208:211]
  v_mfma_f32_16x16x32_bf16 v[212:215], v[72:75], v[96:99], v[212:215]
  v_mfma_f32_16x16x32_bf16 v[212:215], v[76:79], v[100:103], v[212:215]
  v_mfma_f32_16x16x32_bf16 v[216:219], v[72:75], v[104:107], v[216:219]
  s_setprio 2
  s_barrier
  v_mfma_f32_16x16x32_bf16 v[216:219], v[76:79], v[108:111], v[216:219]
  ds_read_b64_tr_b16 v[40:41], v6 offset:20480
  s_add_u32 m0, s75, 40960
  s_nop 0
  buffer_load_dwordx4 v29, s[44:47], s74 offen offset:0 lds
  ds_read_b64_tr_b16 v[42:43], v6 offset:23040
  ds_read_b64_tr_b16 v[44:45], v6 offset:40960
  ds_read_b64_tr_b16 v[46:47], v6 offset:43520
  ds_read_b64_tr_b16 v[48:49], v7 offset:20480
  buffer_load_dwordx4 v30, s[44:47], s74 offen offset:1024 lds
  ds_read_b64_tr_b16 v[50:51], v7 offset:23040
  ds_read_b64_tr_b16 v[52:53], v7 offset:40960
  ds_read_b64_tr_b16 v[54:55], v7 offset:43520
  ds_read_b64_tr_b16 v[56:57], v8 offset:20480
  buffer_load_dwordx4 v31, s[44:47], s74 offen offset:2048 lds
  ds_read_b64_tr_b16 v[58:59], v8 offset:23040
  ds_read_b64_tr_b16 v[60:61], v8 offset:40960
  ds_read_b64_tr_b16 v[62:63], v8 offset:43520
  ds_read_b64_tr_b16 v[64:65], v9 offset:20480
  buffer_load_dwordx4 v32, s[44:47], s74 offen offset:3072 lds
  ds_read_b64_tr_b16 v[66:67], v9 offset:23040
  ds_read_b64_tr_b16 v[68:69], v9 offset:40960
  ds_read_b64_tr_b16 v[70:71], v9 offset:43520
  ds_read_b128 v[80:83], v11 offset:8192
  s_add_u32 m0, m0, 4096
  s_nop 0
  buffer_load_dwordx4 v33, s[44:47], s74 offen offset:0 lds
  s_add_u32 s74, s74, 212992
  ds_read_b128 v[84:87], v12 offset:8192
  ds_read_b128 v[88:91], v11 offset:10240
  ds_read_b128 v[92:95], v12 offset:10240
  ds_read_b128 v[96:99], v11 offset:12288
  v_lshl_add_u32 v34, v242, 7, v15
  v_lshl_add_u32 v28, v26, 7, v14
  s_add_u32 m0, s76, 0
  s_nop 0
  buffer_load_dwordx4 v28, s[32:35], 0 offen lds
  ds_read_b128 v[100:103], v12 offset:12288
  ds_read_b128 v[104:107], v11 offset:14336
  ds_read_b128 v[108:111], v12 offset:14336
  ds_read_b64_tr_b16 v[72:73], v10 offset:20480
  s_add_u32 m0, m0, 1024
  s_nop 0
  buffer_load_dwordx4 v34, s[32:35], 0 offen lds
  ds_read_b64_tr_b16 v[74:75], v10 offset:23040
  ds_read_b64_tr_b16 v[76:77], v10 offset:40960
  ds_read_b64_tr_b16 v[78:79], v10 offset:43520
  buffer_load_dwordx3 v[24:26], v13, s[28:31], s73 offen offset:0
  buffer_load_dwordx3 v[240:242], v13, s[28:31], s73 offen offset:832
  s_add_u32 s73, s73, 12
  s_waitcnt vmcnt(9) lgkmcnt(0)
  s_barrier
  s_setprio 0
  v_mfma_f32_16x16x32_bf16 v[140:143], v[40:43], v[80:83], v[140:143]
  s_add_u32 s72, s72, 1
  v_mfma_f32_16x16x32_bf16 v[140:143], v[44:47], v[84:87], v[140:143]
  v_mfma_f32_16x16x32_bf16 v[144:147], v[40:43], v[88:91], v[144:147]
  v_mfma_f32_16x16x32_bf16 v[144:147], v[44:47], v[92:95], v[144:147]
  v_mfma_f32_16x16x32_bf16 v[148:151], v[40:43], v[96:99], v[148:151]
  v_mfma_f32_16x16x32_bf16 v[148:151], v[44:47], v[100:103], v[148:151]
  v_mfma_f32_16x16x32_bf16 v[152:155], v[40:43], v[104:107], v[152:155]
  v_mfma_f32_16x16x32_bf16 v[152:155], v[44:47], v[108:111], v[152:155]
  v_mfma_f32_16x16x32_bf16 v[168:171], v[48:51], v[104:107], v[168:171]
  v_mfma_f32_16x16x32_bf16 v[168:171], v[52:55], v[108:111], v[168:171]
  v_mfma_f32_16x16x32_bf16 v[164:167], v[48:51], v[96:99], v[164:167]
  v_mfma_f32_16x16x32_bf16 v[164:167], v[52:55], v[100:103], v[164:167]
  v_mfma_f32_16x16x32_bf16 v[160:163], v[48:51], v[88:91], v[160:163]
  v_mfma_f32_16x16x32_bf16 v[160:163], v[52:55], v[92:95], v[160:163]
  v_mfma_f32_16x16x32_bf16 v[156:159], v[48:51], v[80:83], v[156:159]
  v_mfma_f32_16x16x32_bf16 v[156:159], v[52:55], v[84:87], v[156:159]
  v_mfma_f32_16x16x32_bf16 v[172:175], v[56:59], v[80:83], v[172:175]
  v_mfma_f32_16x16x32_bf16 v[172:175], v[60:63], v[84:87], v[172:175]
  v_mfma_f32_16x16x32_bf16 v[176:179], v[56:59], v[88:91], v[176:179]
  v_mfma_f32_16x16x32_bf16 v[176:179], v[60:63], v[92:95], v[176:179]
  s_cmp_lt_u32 s72, 4
  v_mfma_f32_16x16x32_bf16 v[180:183], v[56:59], v[96:99], v[180:183]
  v_mfma_f32_16x16x32_bf16 v[180:183], v[60:63], v[100:103], v[180:183]
  v_mfma_f32_16x16x32_bf16 v[184:187], v[56:59], v[104:107], v[184:187]
  v_mfma_f32_16x16x32_bf16 v[184:187], v[60:63], v[108:111], v[184:187]
  v_mfma_f32_16x16x32_bf16 v[200:203], v[64:67], v[104:107], v[200:203]
  v_mfma_f32_16x16x32_bf16 v[200:203], v[68:71], v[108:111], v[200:203]
  v_mfma_f32_16x16x32_bf16 v[196:199], v[64:67], v[96:99], v[196:199]
  v_mfma_f32_16x16x32_bf16 v[196:199], v[68:71], v[100:103], v[196:199]
  v_mfma_f32_16x16x32_bf16 v[192:195], v[64:67], v[88:91], v[192:195]
  v_mfma_f32_16x16x32_bf16 v[192:195], v[68:71], v[92:95], v[192:195]
  v_mfma_f32_16x16x32_bf16 v[188:191], v[64:67], v[80:83], v[188:191]
  v_mfma_f32_16x16x32_bf16 v[188:191], v[68:71], v[84:87], v[188:191]
  v_mfma_f32_16x16x32_bf16 v[204:207], v[72:75], v[80:83], v[204:207]
  v_mfma_f32_16x16x32_bf16 v[204:207], v[76:79], v[84:87], v[204:207]
  v_mfma_f32_16x16x32_bf16 v[208:211], v[72:75], v[88:91], v[208:211]
  v_mfma_f32_16x16x32_bf16 v[208:211], v[76:79], v[92:95], v[208:211]
  v_mfma_f32_16x16x32_bf16 v[212:215], v[72:75], v[96:99], v[212:215]
  v_mfma_f32_16x16x32_bf16 v[212:215], v[76:79], v[100:103], v[212:215]
  v_mfma_f32_16x16x32_bf16 v[216:219], v[72:75], v[104:107], v[216:219]
  s_setprio 2
  s_barrier
  v_mfma_f32_16x16x32_bf16 v[216:219], v[76:79], v[108:111], v[216:219]
  s_cbranch_scc1 L_dnn_loop0
  ds_read_b64_tr_b16 v[40:41], v1 offset:0
  v_lshl_add_u32 v34, v20, 7, v15
  v_lshl_add_u32 v28, v16, 7, v14
  s_add_u32 m0, s76, 8192
  s_nop 0
  buffer_load_dwordx4 v28, s[32:35], 0 offen lds
  ds_read_b64_tr_b16 v[42:43], v1 offset:2560
  ds_read_b64_tr_b16 v[44:45], v1 offset:20480
  ds_read_b64_tr_b16 v[46:47], v1 offset:23040
  ds_read_b64_tr_b16 v[48:49], v2 offset:0
  ds_read_b64_tr_b16 v[50:51], v2 offset:2560
  ds_read_b64_tr_b16 v[52:53], v2 offset:20480
  ds_read_b64_tr_b16 v[54:55], v2 offset:23040
  ds_read_b64_tr_b16 v[56:57], v3 offset:0
  ds_read_b64_tr_b16 v[58:59], v3 offset:2560
  ds_read_b64_tr_b16 v[60:61], v3 offset:20480
  ds_read_b64_tr_b16 v[62:63], v3 offset:23040
  ds_read_b64_tr_b16 v[64:65], v4 offset:0
  ds_read_b64_tr_b16 v[66:67], v4 offset:2560
  ds_read_b64_tr_b16 v[68:69], v4 offset:20480
  ds_read_b64_tr_b16 v[70:71], v4 offset:23040
  ds_read_b128 v[80:83], v11 offset:0
  s_add_u32 m0, m0, 1024
  s_nop 0
  buffer_load_dwordx4 v34, s[32:35], 0 offen lds
  ds_read_b128 v[84:87], v12 offset:0
  ds_read_b128 v[88:91], v11 offset:2048
  ds_read_b128 v[92:95], v12 offset:2048
  ds_read_b128 v[96:99], v11 offset:4096
  ds_read_b128 v[100:103], v12 offset:4096
  ds_read_b128 v[104:107], v11 offset:6144
  ds_read_b128 v[108:111], v12 offset:6144
  ds_read_b64_tr_b16 v[72:73], v5 offset:0
  ds_read_b64_tr_b16 v[74:75], v5 offset:2560
  ds_read_b64_tr_b16 v[76:77], v5 offset:20480
  ds_read_b64_tr_b16 v[78:79], v5 offset:23040
  ds_read_b64 v[220:221], v35 offset:640
  ds_read_b64 v[222:223], v35 offset:672
  ds_read_b64 v[224:225], v35 offset:704
  ds_read_b64 v[226:227], v35 offset:736
  ds_read_b64 v[228:229], v35 offset:768
  s_mov_b32 s60, s24
  s_and_b32 s61, s25, 0xffff
  s_mov_b32 s62, 268435456
  s_mov_b32 s63, 0x20000
  s_mov_b32 s64, s22
  s_and_b32 s65, s23, 0xffff
  s_mov_b32 s66, 256
  s_mov_b32 s67, 0x20000
  v_lshlrev_b32 v28, 2, v0
  s_mov_b64 exec, 0xff
  s_mov_b32 s81, 0x80000
  buffer_load_dword v255, v28, s[60:63], s81 offen
  buffer_load_dword v37, v28, s[64:67], 0 offen offset:128 sc1
  s_mov_b64 exec, -1
  v_mov_b32 v28, 0
  s_waitcnt vmcnt(6) lgkmcnt(0)
  s_barrier
  s_setprio 0
  v_mfma_f32_16x16x32_bf16 v[140:143], v[40:43], v[80:83], v[140:143]
  v_mov_b32 v232, 0xc0135761
  v_mov_b32 v233, 0xc0135761
  v_mfma_f32_16x16x32_bf16 v[140:143], v[44:47], v[84:87], v[140:143]
  v_mov_b32 v234, 0xbdd2d3e8
  v_mov_b32 v235, 0xbdd2d3e8
  v_mfma_f32_16x16x32_bf16 v[144:147], v[40:43], v[88:91], v[144:147]
  v_mov_b32 v236, 0xc2b40000
  v_mov_b32 v237, 0xc2b40000
  v_mfma_f32_16x16x32_bf16 v[144:147], v[44:47], v[92:95], v[144:147]
  v_lshlrev_b32 v112, 16, v220
  v_and_b32 v113, 0xffff0000, v220
  v_mfma_f32_16x16x32_bf16 v[148:151], v[40:43], v[96:99], v[148:151]
  v_lshlrev_b32 v114, 16, v221
  v_and_b32 v115, 0xffff0000, v221
  v_mfma_f32_16x16x32_bf16 v[148:151], v[44:47], v[100:103], v[148:151]
  v_lshlrev_b32 v116, 16, v222
  v_and_b32 v117, 0xffff0000, v222
  v_mfma_f32_16x16x32_bf16 v[152:155], v[40:43], v[104:107], v[152:155]
  v_lshlrev_b32 v118, 16, v223
  v_and_b32 v119, 0xffff0000, v223
  v_mfma_f32_16x16x32_bf16 v[152:155], v[44:47], v[108:111], v[152:155]
  v_lshlrev_b32 v120, 16, v224
  v_and_b32 v121, 0xffff0000, v224
  v_mfma_f32_16x16x32_bf16 v[168:171], v[48:51], v[104:107], v[168:171]
  v_lshlrev_b32 v122, 16, v225
  v_and_b32 v123, 0xffff0000, v225
  v_mfma_f32_16x16x32_bf16 v[168:171], v[52:55], v[108:111], v[168:171]
  v_lshlrev_b32 v124, 16, v226
  v_mfma_f32_16x16x32_bf16 v[164:167], v[48:51], v[96:99], v[164:167]
  v_and_b32 v125, 0xffff0000, v226
  v_lshlrev_b32 v126, 16, v227
  v_mfma_f32_16x16x32_bf16 v[164:167], v[52:55], v[100:103], v[164:167]
  v_and_b32 v127, 0xffff0000, v227
  v_lshlrev_b32 v128, 16, v228
  v_mfma_f32_16x16x32_bf16 v[160:163], v[48:51], v[88:91], v[160:163]
  v_and_b32 v129, 0xffff0000, v228
  v_lshlrev_b32 v130, 16, v229
  v_mfma_f32_16x16x32_bf16 v[160:163], v[52:55], v[92:95], v[160:163]
  v_and_b32 v131, 0xffff0000, v229
  v_mov_b32 v239, 0x21800000
  v_mfma_f32_16x16x32_bf16 v[156:159], v[48:51], v[80:83], v[156:159]
  v_mov_b32 v238, 0x30800000
  v_max3_f32 v239, v239, abs(v112), abs(v113)
  v_mfma_f32_16x16x32_bf16 v[156:159], v[52:55], v[84:87], v[156:159]
  v_max3_f32 v239, v239, abs(v114), abs(v115)
  v_max3_f32 v239, v239, abs(v116), abs(v117)
  v_mfma_f32_16x16x32_bf16 v[172:175], v[56:59], v[80:83], v[172:175]
  v_max3_f32 v239, v239, abs(v118), abs(v119)
  v_max3_f32 v239, v239, abs(v120), abs(v121)
  v_mfma_f32_16x16x32_bf16 v[172:175], v[60:63], v[84:87], v[172:175]
  v_max3_f32 v239, v239, abs(v122), abs(v123)
  v_max3_f32 v239, v239, abs(v124), abs(v125)
  v_mfma_f32_16x16x32_bf16 v[176:179], v[56:59], v[88:91], v[176:179]
  v_max3_f32 v239, v239, abs(v126), abs(v127)
  v_mfma_f32_16x16x32_bf16 v[176:179], v[60:63], v[92:95], v[176:179]
  v_max3_f32 v239, v239, abs(v128), abs(v129)
  v_max3_f32 v239, v239, abs(v130), abs(v131)
  v_mfma_f32_16x16x32_bf16 v[180:183], v[56:59], v[96:99], v[180:183]
  v_and_b32 v239, 0x7f800000, v239
  v_mul_f32 v239, 0x22000000, v239
  v_mfma_f32_16x16x32_bf16 v[180:183], v[60:63], v[100:103], v[180:183]
  v_rcp_f32 v112, v112
  v_mfma_f32_16x16x32_bf16 v[184:187], v[56:59], v[104:107], v[184:187]
  v_rcp_f32 v113, v113
  v_mfma_f32_16x16x32_bf16 v[184:187], v[60:63], v[108:111], v[184:187]
  v_rcp_f32 v114, v114
  v_mfma_f32_16x16x32_bf16 v[200:203], v[64:67], v[104:107], v[200:203]
  v_rcp_f32 v115, v115
  v_mfma_f32_16x16x32_bf16 v[200:203], v[68:71], v[108:111], v[200:203]
  v_rcp_f32 v116, v116
  v_mfma_f32_16x16x32_bf16 v[196:199], v[64:67], v[96:99], v[196:199]
  v_rcp_f32 v117, v117
  v_mfma_f32_16x16x32_bf16 v[196:199], v[68:71], v[100:103], v[196:199]
  v_rcp_f32 v118, v118
  v_mfma_f32_16x16x32_bf16 v[192:195], v[64:67], v[88:91], v[192:195]
  v_rcp_f32 v119, v119
  v_mfma_f32_16x16x32_bf16 v[192:195], v[68:71], v[92:95], v[192:195]
  v_rcp_f32 v120, v120
  v_mfma_f32_16x16x32_bf16 v[188:191], v[64:67], v[80:83], v[188:191]
  v_rcp_f32 v121, v121
  v_mfma_f32_16x16x32_bf16 v[188:191], v[68:71], v[84:87], v[188:191]
  v_rcp_f32 v122, v122
  v_mfma_f32_16x16x32_bf16 v[204:207], v[72:75], v[80:83], v[204:207]
  v_rcp_f32 v123, v123
  v_mfma_f32_16x16x32_bf16 v[204:207], v[76:79], v[84:87], v[204:207]
  v_rcp_f32 v124, v124
  v_mfma_f32_16x16x32_bf16 v[208:211], v[72:75], v[88:91], v[208:211]
  v_rcp_f32 v125, v125
  v_mfma_f32_16x16x32_bf16 v[208:211], v[76:79], v[92:95], v[208:211]
  v_rcp_f32 v126, v126
  v_mfma_f32_16x16x32_bf16 v[212:215], v[72:75], v[96:99], v[212:215]
  v_rcp_f32 v127, v127
  v_mfma_f32_16x16x32_bf16 v[212:215], v[76:79], v[100:103], v[212:215]
  v_mfma_f32_16x16x32_bf16 v[216:219], v[72:75], v[104:107], v[216:219]
  s_setprio 2
  s_barrier
  v_mfma_f32_16x16x32_bf16 v[216:219], v[76:79], v[108:111], v[216:219]
  ds_read_b64_tr_b16 v[40:41], v1 offset:40960
  ds_read_b64_tr_b16 v[42:43], v1 offset:43520
  ds_read_b64_tr_b16 v[44:45], v6 offset:0
  ds_read_b64_tr_b16 v[46:47], v6 offset:2560
  ds_read_b64_tr_b16 v[48:49], v2 offset:40960
  ds_read_b64_tr_b16 v[50:51], v2 offset:43520
  ds_read_b64_tr_b16 v[52:53], v7 offset:0
  ds_read_b64_tr_b16 v[54:55], v7 offset:2560
  ds_read_b64_tr_b16 v[56:57], v3 offset:40960
  ds_read_b64_tr_b16 v[58:59], v3 offset:43520
  ds_read_b64_tr_b16 v[60:61], v8 offset:0
  ds_read_b64_tr_b16 v[62:63], v8 offset:2560
  ds_read_b64_tr_b16 v[64:65], v4 offset:40960
  ds_read_b64_tr_b16 v[66:67], v4 offset:43520
  ds_read_b64_tr_b16 v[68:69], v9 offset:0
  ds_read_b64_tr_b16 v[70:71], v9 offset:2560
  ds_read_b128 v[80:83], v11 offset:8192
  ds_read_b128 v[84:87], v12 offset:8192
  ds_read_b128 v[88:91], v11 offset:10240
  ds_read_b128 v[92:95], v12 offset:10240
  ds_read_b128 v[96:99], v11 offset:12288
  ds_read_b128 v[100:103], v12 offset:12288
  ds_read_b128 v[104:107], v11 offset:14336
  ds_read_b128 v[108:111], v12 offset:14336
  ds_read_b64_tr_b16 v[72:73], v5 offset:40960
  ds_read_b64_tr_b16 v[74:75], v5 offset:43520
  ds_read_b64_tr_b16 v[76:77], v10 offset:0
  ds_read_b64_tr_b16 v[78:79], v10 offset:2560
  s_waitcnt vmcnt(2) lgkmcnt(0)
  s_barrier
  s_setprio 0
  v_mfma_f32_16x16x32_bf16 v[140:143], v[40:43], v[80:83], v[140:143]
  v_rcp_f32 v128, v128
  v_mfma_f32_16x16x32_bf16 v[140:143], v[44:47], v[84:87], v[140:143]
  v_rcp_f32 v129, v129
  v_mfma_f32_16x16x32_bf16 v[144:147], v[40:43], v[88:91], v[144:147]
  v_rcp_f32 v130, v130
  v_mfma_f32_16x16x32_bf16 v[144:147], v[44:47], v[92:95], v[144:147]
  v_rcp_f32 v131, v131
  v_mfma_f32_16x16x32_bf16 v[148:151], v[40:43], v[96:99], v[148:151]
  v_mul_f32 v112, v239, v112
  v_mfma_f32_16x16x32_bf16 v[148:151], v[44:47], v[100:103], v[148:151]
  v_mul_f32 v113, v239, v113
  v_mul_f32 v114, v239, v114
  v_mfma_f32_16x16x32_bf16 v[152:155], v[40:43], v[104:107], v[152:155]
  v_mul_f32 v115, v239, v115
  v_mul_f32 v116, v239, v116
  v_mfma_f32_16x16x32_bf16 v[152:155], v[44:47], v[108:111], v[152:155]
  v_mul_f32 v117, v239, v117
  v_mul_f32 v118, v239, v118
  v_mfma_f32_16x16x32_bf16 v[168:171], v[48:51], v[104:107], v[168:171]
  v_mul_f32 v119, v239, v119
  v_mul_f32 v120, v239, v120
  v_mfma_f32_16x16x32_bf16 v[168:171], v[52:55], v[108:111], v[168:171]
  v_mul_f32 v121, v239, v121
  v_mfma_f32_16x16x32_bf16 v[164:167], v[48:51], v[96:99], v[164:167]
  v_mul_f32 v122, v239, v122
  v_mul_f32 v123, v239, v123
  v_mfma_f32_16x16x32_bf16 v[164:167], v[52:55], v[100:103], v[164:167]
  v_mul_f32 v124, v239, v124
  v_mul_f32 v125, v239, v125
  v_mfma_f32_16x16x32_bf16 v[160:163], v[48:51], v[88:91], v[160:163]
  v_mul_f32 v126, v239, v126
  v_mul_f32 v127, v239, v127
  v_mfma_f32_16x16x32_bf16 v[160:163], v[52:55], v[92:95], v[160:163]
  v_mul_f32 v128, v239, v128
  v_mul_f32 v129, v239, v129
  v_mfma_f32_16x16x32_bf16 v[156:159], v[48:51], v[80:83], v[156:159]
  v_mul_f32 v130, v239, v130
  v_mfma_f32_16x16x32_bf16 v[156:159], v[52:55], v[84:87], v[156:159]
  v_mul_f32 v131, v239, v131
  v_med3_f32 v112, v112, -v238, v238
  v_mfma_f32_16x16x32_bf16 v[172:175], v[56:59], v[80:83], v[172:175]
  v_med3_f32 v113, v113, -v238, v238
  v_med3_f32 v114, v114, -v238, v238
  v_mfma_f32_16x16x32_bf16 v[172:175], v[60:63], v[84:87], v[172:175]
  v_med3_f32 v115, v115, -v238, v238
  v_med3_f32 v116, v116, -v238, v238
  v_mfma_f32_16x16x32_bf16 v[176:179], v[56:59], v[88:91], v[176:179]
  v_med3_f32 v117, v117, -v238, v238
  v_mfma_f32_16x16x32_bf16 v[176:179], v[60:63], v[92:95], v[176:179]
  v_med3_f32 v118, v118, -v238, v238
  v_med3_f32 v119, v119, -v238, v238
  v_mfma_f32_16x16x32_bf16 v[180:183], v[56:59], v[96:99], v[180:183]
  v_med3_f32 v120, v120, -v238, v238
  v_med3_f32 v121, v121, -v238, v238
  v_mfma_f32_16x16x32_bf16 v[180:183], v[60:63], v[100:103], v[180:183]
  v_med3_f32 v122, v122, -v238, v238
  v_med3_f32 v123, v123, -v238, v238
  v_mfma_f32_16x16x32_bf16 v[184:187], v[56:59], v[104:107], v[184:187]
  v_med3_f32 v124, v124, -v238, v238
  v_med3_f32 v125, v125, -v238, v238
  v_mfma_f32_16x16x32_bf16 v[184:187], v[60:63], v[108:111], v[184:187]
  v_med3_f32 v126, v126, -v238, v238
  v_mfma_f32_16x16x32_bf16 v[200:203], v[64:67], v[104:107], v[200:203]
  v_med3_f32 v127, v127, -v238, v238
  v_med3_f32 v128, v128, -v238, v238
  v_mfma_f32_16x16x32_bf16 v[200:203], v[68:71], v[108:111], v[200:203]
  v_med3_f32 v129, v129, -v238, v238
  v_med3_f32 v130, v130, -v238, v238
  v_mfma_f32_16x16x32_bf16 v[196:199], v[64:67], v[96:99], v[196:199]
  v_med3_f32 v131, v131, -v238, v238
  v_mul_f32 v132, 0x6c800000, v112
  v_mfma_f32_16x16x32_bf16 v[196:199], v[68:71], v[100:103], v[196:199]
  v_mul_f32 v133, 0x6c800000, v113
  v_mul_f32 v134, 0x6c800000, v114
  v_mfma_f32_16x16x32_bf16 v[192:195], v[64:67], v[88:91], v[192:195]
  v_mul_f32 v135, 0x6c800000, v115
  v_mfma_f32_16x16x32_bf16 v[192:195], v[68:71], v[92:95], v[192:195]
  v_mul_f32 v136, 0x6c800000, v116
  v_mul_f32 v137, 0x6c800000, v117
  v_mfma_f32_16x16x32_bf16 v[188:191], v[64:67], v[80:83], v[188:191]
  v_mul_f32 v138, 0x6c800000, v118
  v_mul_f32 v139, 0x6c800000, v119
  v_mfma_f32_16x16x32_bf16 v[188:191], v[68:71], v[84:87], v[188:191]
  v_mul_f32 v220, 0x6c800000, v120
  v_mul_f32 v221, 0x6c800000, v121
  v_mfma_f32_16x16x32_bf16 v[204:207], v[72:75], v[80:83], v[204:207]
  v_mul_f32 v222, 0x6c800000, v122
  v_mul_f32 v223, 0x6c800000, v123
  v_mfma_f32_16x16x32_bf16 v[204:207], v[76:79], v[84:87], v[204:207]
  v_mul_f32 v224, 0x6c800000, v124
  v_mfma_f32_16x16x32_bf16 v[208:211], v[72:75], v[88:91], v[208:211]
  v_mul_f32 v225, 0x6c800000, v125
  v_mul_f32 v226, 0x6c800000, v126
  v_mfma_f32_16x16x32_bf16 v[208:211], v[76:79], v[92:95], v[208:211]
  v_mul_f32 v227, 0x6c800000, v127
  v_mul_f32 v228, 0x6c800000, v128
  v_mfma_f32_16x16x32_bf16 v[212:215], v[72:75], v[96:99], v[212:215]
  v_mul_f32 v229, 0x6c800000, v129
  v_mul_f32 v230, 0x6c800000, v130
  v_mfma_f32_16x16x32_bf16 v[212:215], v[76:79], v[100:103], v[212:215]
  v_mul_f32 v231, 0x6c800000, v131
  v_mfma_f32_16x16x32_bf16 v[216:219], v[72:75], v[104:107], v[216:219]
  s_setprio 2
  s_barrier
  v_mfma_f32_16x16x32_bf16 v[216:219], v[76:79], v[108:111], v[216:219]
  s_setprio 0
  s_branch L_epi
L_dnn_h1:
  v_lshl_add_u32 v34, v49, 7, v15
  v_lshl_add_u32 v28, v45, 7, v14
  s_add_u32 m0, s76, 8192
  s_nop 0
  buffer_load_dwordx4 v28, s[32:35], 0 offen lds
  s_add_u32 m0, m0, 1024
  s_nop 0
  buffer_load_dwordx4 v34, s[32:35], 0 offen lds
  s_add_u32 m0, s75, 40960
  s_nop 0
  buffer_load_dwordx4 v29, s[44:47], s74 offen offset:0 lds
  buffer_load_dwordx4 v30, s[44:47], s74 offen offset:1024 lds
  buffer_load_dwordx4 v31, s[44:47], s74 offen offset:2048 lds
  buffer_load_dwordx4 v32, s[44:47], s74 offen offset:3072 lds
  s_add_u32 m0, m0, 4096
  s_nop 0
  buffer_load_dwordx4 v33, s[44:47], s74 offen offset:0 lds
  s_add_u32 s74, s74, 212992
  s_waitcnt vmcnt(14)
  s_waitcnt vmcnt(10) lgkmcnt(0)
  s_barrier
  buffer_load_dwordx3 v[24:26], v13, s[28:31], s73 offen offset:0
  buffer_load_dwordx3 v[240:242], v13, s[28:31], s73 offen offset:832
  s_add_u32 s73, s73, 12
  s_barrier
L_dnn_loop1:
  ds_read_b64_tr_b16 v[40:41], v1 offset:0
  s_add_u32 m0, s75, 81920
  s_nop 0
  buffer_load_dwordx4 v29, s[44:47], s74 offen offset:0 lds
  ds_read_b64_tr_b16 v[42:43], v1 offset:2560
  ds_read_b64_tr_b16 v[44:45], v1 offset:20480
  ds_read_b64_tr_b16 v[46:47], v1 offset:23040
  ds_read_b64_tr_b16 v[48:49], v2 offset:0
  buffer_load_dwordx4 v30, s[44:47], s74 offen offset:1024 lds
  ds_read_b64_tr_b16 v[50:51], v2 offset:2560
  ds_read_b64_tr_b16 v[52:53], v2 offset:20480
  ds_read_b64_tr_b16 v[54:55], v2 offset:23040
  ds_read_b64_tr_b16 v[56:57], v3 offset:0
  buffer_load_dwordx4 v31, s[44:47], s74 offen offset:2048 lds
  ds_read_b64_tr_b16 v[58:59], v3 offset:2560
  ds_read_b64_tr_b16 v[60:61], v3 offset:20480
  ds_read_b64_tr_b16 v[62:63], v3 offset:23040
  ds_read_b64_tr_b16 v[64:65], v4 offset:0
  buffer_load_dwordx4 v32, s[44:47], s74 offen offset:3072 lds
  ds_read_b64_tr_b16 v[66:67], v4 offset:2560
  ds_read_b64_tr_b16 v[68:69], v4 offset:20480
  ds_read_b64_tr_b16 v[70:71], v4 offset:23040
  ds_read_b128 v[80:83], v11 offset:0
  s_add_u32 m0, m0, 4096
  s_nop 0
  buffer_load_dwordx4 v33, s[44:47], s74 offen offset:0 lds
  s_add_u32 s74, s74, 212992
  ds_read_b128 v[84:87], v12 offset:0
  ds_read_b128 v[88:91], v11 offset:2048
  ds_read_b128 v[92:95], v12 offset:2048
  ds_read_b128 v[96:99], v11 offset:4096
  s_waitcnt vmcnt(14)
  v_lshl_add_u32 v34, v20, 7, v15
  v_lshl_add_u32 v28, v16, 7, v14
  s_add_u32 m0, s76, 0
  s_nop 0
  buffer_load_dwordx4 v28, s[32:35], 0 offen lds
  ds_read_b128 v[100:103], v12 offset:4096
  ds_read_b128 v[104:107], v11 offset:6144
  ds_read_b128 v[108:111], v12 offset:6144
  ds_read_b64_tr_b16 v[72:73], v5 offset:0
  s_add_u32 m0, m0, 1024
  s_nop 0
  buffer_load_dwordx4 v34, s[32:35], 0 offen lds
  ds_read_b64_tr_b16 v[74:75], v5 offset:2560
  ds_read_b64_tr_b16 v[76:77], v5 offset:20480
  ds_read_b64_tr_b16 v[78:79], v5 offset:23040
L_dnn_in1:
  s_waitcnt vmcnt(9) lgkmcnt(0)
  s_waitcnt vmcnt(9)
  s_barrier
  s_setprio 0
  v_mfma_f32_16x16x32_bf16 v[140:143], v[40:43], v[80:83], v[140:143]
  v_mfma_f32_16x16x32_bf16 v[140:143], v[44:47], v[84:87], v[140:143]
  v_mfma_f32_16x16x32_bf16 v[144:147], v[40:43], v[88:91], v[144:147]
  v_mfma_f32_16x16x32_bf16 v[144:147], v[44:47], v[92:95], v[144:147]
  v_mfma_f32_16x16x32_bf16 v[148:151], v[40:43], v[96:99], v[148:151]
  v_mfma_f32_16x16x32_bf16 v[148:151], v[44:47], v[100:103], v[148:151]
  v_mfma_f32_16x16x32_bf16 v[152:155], v[40:43], v[104:107], v[152:155]
  v_mfma_f32_16x16x32_bf16 v[152:155], v[44:47], v[108:111], v[152:155]
  v_mfma_f32_16x16x32_bf16 v[168:171], v[48:51], v[104:107], v[168:171]
  v_mfma_f32_16x16x32_bf16 v[168:171], v[52:55], v[108:111], v[168:171]
  v_mfma_f32_16x16x32_bf16 v[164:167], v[48:51], v[96:99], v[164:167]
  v_mfma_f32_16x16x32_bf16 v[164:167], v[52:55], v[100:103], v[164:167]
  v_mfma_f32_16x16x32_bf16 v[160:163], v[48:51], v[88:91], v[160:163]
  v_mfma_f32_16x16x32_bf16 v[160:163], v[52:55], v[92:95], v[160:163]
  v_mfma_f32_16x16x32_bf16 v[156:159], v[48:51], v[80:83], v[156:159]
  v_mfma_f32_16x16x32_bf16 v[156:159], v[52:55], v[84:87], v[156:159]
  v_mfma_f32_16x16x32_bf16 v[172:175], v[56:59], v[80:83], v[172:175]
  v_mfma_f32_16x16x32_bf16 v[172:175], v[60:63], v[84:87], v[172:175]
  v_mfma_f32_16x16x32_bf16 v[176:179], v[56:59], v[88:91], v[176:179]
  v_mfma_f32_16x16x32_bf16 v[176:179], v[60:63], v[92:95], v[176:179]
  v_mfma_f32_16x16x32_bf16 v[180:183], v[56:59], v[96:99], v[180:183]
  v_mfma_f32_16x16x32_bf16 v[180:183], v[60:63], v[100:103], v[180:183]
  v_mfma_f32_16x16x32_bf16 v[184:187], v[56:59], v[104:107], v[184:187]
  v_mfma_f32_16x16x32_bf16 v[184:187], v[60:63], v[108:111], v[184:187]
  v_mfma_f32_16x16x32_bf16 v[200:203], v[64:67], v[104:107], v[200:203]
  v_mfma_f32_16x16x32_bf16 v[200:203], v[68:71], v[108:111], v[200:203]
  v_mfma_f32_16x16x32_bf16 v[196:199], v[64:67], v[96:99], v[196:199]
  v_mfma_f32_16x16x32_bf16 v[196:199], v[68:71], v[100:103], v[196:199]
  v_mfma_f32_16x16x32_bf16 v[192:195], v[64:67], v[88:91], v[192:195]
  v_mfma_f32_16x16x32_bf16 v[192:195], v[68:71], v[92:95], v[192:195]
  v_mfma_f32_16x16x32_bf16 v[188:191], v[64:67], v[80:83], v[188:191]
  v_mfma_f32_16x16x32_bf16 v[188:191], v[68:71], v[84:87], v[188:191]
  v_mfma_f32_16x16x32_bf16 v[204:207], v[72:75], v[80:83], v[204:207]
  v_mfma_f32_16x16x32_bf16 v[204:207], v[76:79], v[84:87], v[204:207]
  v_mfma_f32_16x16x32_bf16 v[208:211], v[72:75], v[88:91], v[208:211]
  v_mfma_f32_16x16x32_bf16 v[208:211], v[76:79], v[92:95], v[208:211]
  v_mfma_f32_16x16x32_bf16 v[212:215], v[72:75], v[96:99], v[212:215]
  v_mfma_f32_16x16x32_bf16 v[212:215], v[76:79], v[100:103], v[212:215]
  v_mfma_f32_16x16x32_bf16 v[216:219], v[72:75], v[104:107], v[216:219]
  s_setprio 2
  s_barrier
  v_mfma_f32_16x16x32_bf16 v[216:219], v[76:79], v[108:111], v[216:219]
  ds_read_b64_tr_b16 v[40:41], v1 offset:40960
  s_add_u32 m0, s75, 0
  s_nop 0
  buffer_load_dwordx4 v29, s[44:47], s74 offen offset:0 lds
  ds_read_b64_tr_b16 v[42:43], v1 offset:43520
  ds_read_b64_tr_b16 v[44:45], v6 offset:0
  ds_read_b64_tr_b16 v[46:47], v6 offset:2560
  ds_read_b64_tr_b16 v[48:49], v2 offset:40960
  buffer_load_dwordx4 v30, s[44:47], s74 offen offset:1024 lds
  ds_read_b64_tr_b16 v[50:51], v2 offset:43520
  ds_read_b64_tr_b16 v[52:53], v7 offset:0
  ds_read_b64_tr_b16 v[54:55], v7 offset:2560
  ds_read_b64_tr_b16 v[56:57], v3 offset:40960
  buffer_load_dwordx4 v31, s[44:47], s74 offen offset:2048 lds
  ds_read_b64_tr_b16 v[58:59], v3 offset:43520
  ds_read_b64_tr_b16 v[60:61], v8 offset:0
  ds_read_b64_tr_b16 v[62:63], v8 offset:2560
  ds_read_b64_tr_b16 v[64:65], v4 offset:40960
  buffer_load_dwordx4 v32, s[44:47], s74 offen offset:3072 lds
  ds_read_b64_tr_b16 v[66:67], v4 offset:43520
  ds_read_b64_tr_b16 v[68:69], v9 offset:0
  ds_read_b64_tr_b16 v[70:71], v9 offset:2560
  ds_read_b128 v[80:83], v11 offset:8192
  s_add_u32 m0, m0, 4096
  s_nop 0
  buffer_load_dwordx4 v33, s[44:47], s74 offen offset:0 lds
  s_add_u32 s74, s74, 212992
  ds_read_b128 v[84:87], v12 offset:8192
  ds_read_b128 v[88:91], v11 offset:10240
  ds_read_b128 v[92:95], v12 offset:10240
  ds_read_b128 v[96:99], v11 offset:12288
  v_lshl_add_u32 v34, v21, 7, v15
  v_lshl_add_u32 v28, v17, 7, v14
  s_add_u32 m0, s76, 8192
  s_nop 0
  buffer_load_dwordx4 v28, s[32:35], 0 offen lds
  ds_read_b128 v[100:103], v12 offset:12288
  ds_read_b128 v[104:107], v11 offset:14336
  ds_read_b128 v[108:111], v12 offset:14336
  ds_read_b64_tr_b16 v[72:73], v5 offset:40960
  s_add_u32 m0, m0, 1024
  s_nop 0
  buffer_load_dwordx4 v34, s[32:35], 0 offen lds
  ds_read_b64_tr_b16 v[74:75], v5 offset:43520
  ds_read_b64_tr_b16 v[76:77], v10 offset:0
  ds_read_b64_tr_b16 v[78:79], v10 offset:2560
  s_waitcnt vmcnt(7) lgkmcnt(0)
  s_barrier
  s_setprio 0
  v_mfma_f32_16x16x32_bf16 v[140:143], v[40:43], v[80:83], v[140:143]
  v_mfma_f32_16x16x32_bf16 v[140:143], v[44:47], v[84:87], v[140:143]
  v_mfma_f32_16x16x32_bf16 v[144:147], v[40:43], v[88:91], v[144:147]
  v_mfma_f32_16x16x32_bf16 v[144:147], v[44:47], v[92:95], v[144:147]
  v_mfma_f32_16x16x32_bf16 v[148:151], v[40:43], v[96:99], v[148:151]
  v_mfma_f32_16x16x32_bf16 v[148:151], v[44:47], v[100:103], v[148:151]
  v_mfma_f32_16x16x32_bf16 v[152:155], v[40:43], v[104:107], v[152:155]
  v_mfma_f32_16x16x32_bf16 v[152:155], v[44:47], v[108:111], v[152:155]
  v_mfma_f32_16x16x32_bf16 v[168:171], v[48:51], v[104:107], v[168:171]
  v_mfma_f32_16x16x32_bf16 v[168:171], v[52:55], v[108:111], v[168:171]
  v_mfma_f32_16x16x32_bf16 v[164:167], v[48:51], v[96:99], v[164:167]
  v_mfma_f32_16x16x32_bf16 v[164:167], v[52:55], v[100:103], v[164:167]
  v_mfma_f32_16x16x32_bf16 v[160:163], v[48:51], v[88:91], v[160:163]
  v_mfma_f32_16x16x32_bf16 v[160:163], v[52:55], v[92:95], v[160:163]
  v_mfma_f32_16x16x32_bf16 v[156:159], v[48:51], v[80:83], v[156:159]
  v_mfma_f32_16x16x32_bf16 v[156:159], v[52:55], v[84:87], v[156:159]
  v_mfma_f32_16x16x32_bf16 v[172:175], v[56:59], v[80:83], v[172:175]
  v_mfma_f32_16x16x32_bf16 v[172:175], v[60:63], v[84:87], v[172:175]
  v_mfma_f32_16x16x32_bf16 v[176:179], v[56:59], v[88:91], v[176:179]
  v_mfma_f32_16x16x32_bf16 v[176:179], v[60:63], v[92:95], v[176:179]
  v_mfma_f32_16x16x32_bf16 v[180:183], v[56:59], v[96:99], v[180:183]
  v_mfma_f32_16x16x32_bf16 v[180:183], v[60:63], v[100:103], v[180:183]
  v_mfma_f32_16x16x32_bf16 v[184:187], v[56:59], v[104:107], v[184:187]
  v_mfma_f32_16x16x32_bf16 v[184:187], v[60:63], v[108:111], v[184:187]
  v_mfma_f32_16x16x32_bf16 v[200:203], v[64:67], v[104:107], v[200:203]
  v_mfma_f32_16x16x32_bf16 v[200:203], v[68:71], v[108:111], v[200:203]
  v_mfma_f32_16x16x32_bf16 v[196:199], v[64:67], v[96:99], v[196:199]
  v_mfma_f32_16x16x32_bf16 v[196:199], v[68:71], v[100:103], v[196:199]
  v_mfma_f32_16x16x32_bf16 v[192:195], v[64:67], v[88:91], v[192:195]
  v_mfma_f32_16x16x32_bf16 v[192:195], v[68:71], v[92:95], v[192:195]
  v_mfma_f32_16x16x32_bf16 v[188:191], v[64:67], v[80:83], v[188:191]
  v_mfma_f32_16x16x32_bf16 v[188:191], v[68:71], v[84:87], v[188:191]
  v_mfma_f32_16x16x32_bf16 v[204:207], v[72:75], v[80:83], v[204:207]
  v_mfma_f32_16x16x32_bf16 v[204:207], v[76:79], v[84:87], v[204:207]
  v_mfma_f32_16x16x32_bf16 v[208:211], v[72:75], v[88:91], v[208:211]
  v_mfma_f32_16x16x32_bf16 v[208:211], v[76:79], v[92:95], v[208:211]
  v_mfma_f32_16x16x32_bf16 v[212:215], v[72:75], v[96:99], v[212:215]
  v_mfma_f32_16x16x32_bf16 v[212:215], v[76:79], v[100:103], v[212:215]
  v_mfma_f32_16x16x32_bf16 v[216:219], v[72:75], v[104:107], v[216:219]
  s_setprio 2
  s_barrier
  v_mfma_f32_16x16x32_bf16 v[216:219], v[76:79], v[108:111], v[216:219]
  ds_read_b64_tr_b16 v[40:41], v6 offset:20480
  s_add_u32 m0, s75, 40960
  s_nop 0
  buffer_load_dwordx4 v29, s[44:47], s74 offen offset:0 lds
  ds_read_b64_tr_b16 v[42:43], v6 offset:23040
  ds_read_b64_tr_b16 v[44:45], v6 offset:40960
  ds_read_b64_tr_b16 v[46:47], v6 offset:43520
  ds_read_b64_tr_b16 v[48:49], v7 offset:20480
  buffer_load_dwordx4 v30, s[44:47], s74 offen offset:1024 lds
  ds_read_b64_tr_b16 v[50:51], v7 offset:23040
  ds_read_b64_tr_b16 v[52:53], v7 offset:40960
  ds_read_b64_tr_b16 v[54:55], v7 offset:43520
  ds_read_b64_tr_b16 v[56:57], v8 offset:20480
  buffer_load_dwordx4 v31, s[44:47], s74 offen offset:2048 lds
  ds_read_b64_tr_b16 v[58:59], v8 offset:23040
  ds_read_b64_tr_b16 v[60:61], v8 offset:40960
  ds_read_b64_tr_b16 v[62:63], v8 offset:43520
  ds_read_b64_tr_b16 v[64:65], v9 offset:20480
  buffer_load_dwordx4 v32, s[44:47], s74 offen offset:3072 lds
  ds_read_b64_tr_b16 v[66:67], v9 offset:23040
  ds_read_b64_tr_b16 v[68:69], v9 offset:40960
  ds_read_b64_tr_b16 v[70:71], v9 offset:43520
  ds_read_b128 v[80:83], v11 offset:0
  s_add_u32 m0, m0, 4096
  s_nop 0
  buffer_load_dwordx4 v33, s[44:47], s74 offen offset:0 lds
  s_add_u32 s74, s74, 212992
  ds_read_b128 v[84:87], v12 offset:0
  ds_read_b128 v[88:91], v11 offset:2048
  ds_read_b128 v[92:95], v12 offset:2048
  ds_read_b128 v[96:99], v11 offset:4096
  v_lshl_add_u32 v34, v22, 7, v15
  v_lshl_add_u32 v28, v18, 7, v14
  s_add_u32 m0, s76, 0
  s_nop 0
  buffer_load_dwordx4 v28, s[32:35], 0 offen lds
  ds_read_b128 v[100:103], v12 offset:4096
  ds_read_b128 v[104:107], v11 offset:6144
  ds_read_b128 v[108:111], v12 offset:6144
  ds_read_b64_tr_b16 v[72:73], v10 offset:20480
  s_add_u32 m0, m0, 1024
  s_nop 0
  buffer_load_dwordx4 v34, s[32:35], 0 offen lds
  ds_read_b64_tr_b16 v[74:75], v10 offset:23040
  ds_read_b64_tr_b16 v[76:77], v10 offset:40960
  ds_read_b64_tr_b16 v[78:79], v10 offset:43520
  buffer_load_dwordx3 v[16:18], v13, s[28:31], s73 offen offset:0
  buffer_load_dwordx3 v[20:22], v13, s[28:31], s73 offen offset:832
  s_add_u32 s73, s73, 12
  s_waitcnt vmcnt(9) lgkmcnt(0)
  s_barrier
  s_setprio 0
  v_mfma_f32_16x16x32_bf16 v[140:143], v[40:43], v[80:83], v[140:143]
  v_mfma_f32_16x16x32_bf16 v[140:143], v[44:47], v[84:87], v[140:143]
  v_mfma_f32_16x16x32_bf16 v[144:147], v[40:43], v[88:91], v[144:147]
  v_mfma_f32_16x16x32_bf16 v[144:147], v[44:47], v[92:95], v[144:147]
  v_mfma_f32_16x16x32_bf16 v[148:151], v[40:43], v[96:99], v[148:151]
  v_mfma_f32_16x16x32_bf16 v[148:151], v[44:47], v[100:103], v[148:151]
  v_mfma_f32_16x16x32_bf16 v[152:155], v[40:43], v[104:107], v[152:155]
  v_mfma_f32_16x16x32_bf16 v[152:155], v[44:47], v[108:111], v[152:155]
  v_mfma_f32_16x16x32_bf16 v[168:171], v[48:51], v[104:107], v[168:171]
  v_mfma_f32_16x16x32_bf16 v[168:171], v[52:55], v[108:111], v[168:171]
  v_mfma_f32_16x16x32_bf16 v[164:167], v[48:51], v[96:99], v[164:167]
  v_mfma_f32_16x16x32_bf16 v[164:167], v[52:55], v[100:103], v[164:167]
  v_mfma_f32_16x16x32_bf16 v[160:163], v[48:51], v[88:91], v[160:163]
  v_mfma_f32_16x16x32_bf16 v[160:163], v[52:55], v[92:95], v[160:163]
  v_mfma_f32_16x16x32_bf16 v[156:159], v[48:51], v[80:83], v[156:159]
  v_mfma_f32_16x16x32_bf16 v[156:159], v[52:55], v[84:87], v[156:159]
  v_mfma_f32_16x16x32_bf16 v[172:175], v[56:59], v[80:83], v[172:175]
  v_mfma_f32_16x16x32_bf16 v[172:175], v[60:63], v[84:87], v[172:175]
  v_mfma_f32_16x16x32_bf16 v[176:179], v[56:59], v[88:91], v[176:179]
  v_mfma_f32_16x16x32_bf16 v[176:179], v[60:63], v[92:95], v[176:179]
  v_mfma_f32_16x16x32_bf16 v[180:183], v[56:59], v[96:99], v[180:183]
  v_mfma_f32_16x16x32_bf16 v[180:183], v[60:63], v[100:103], v[180:183]
  v_mfma_f32_16x16x32_bf16 v[184:187], v[56:59], v[104:107], v[184:187]
  v_mfma_f32_16x16x32_bf16 v[184:187], v[60:63], v[108:111], v[184:187]
  v_mfma_f32_16x16x32_bf16 v[200:203], v[64:67], v[104:107], v[200:203]
  v_mfma_f32_16x16x32_bf16 v[200:203], v[68:71], v[108:111], v[200:203]
  v_mfma_f32_16x16x32_bf16 v[196:199], v[64:67], v[96:99], v[196:199]
  v_mfma_f32_16x16x32_bf16 v[196:199], v[68:71], v[100:103], v[196:199]
  v_mfma_f32_16x16x32_bf16 v[192:195], v[64:67], v[88:91], v[192:195]
  v_mfma_f32_16x16x32_bf16 v[192:195], v[68:71], v[92:95], v[192:195]
  v_mfma_f32_16x16x32_bf16 v[188:191], v[64:67], v[80:83], v[188:191]
  v_mfma_f32_16x16x32_bf16 v[188:191], v[68:71], v[84:87], v[188:191]
  v_mfma_f32_16x16x32_bf16 v[204:207], v[72:75], v[80:83], v[204:207]
  v_mfma_f32_16x16x32_bf16 v[204:207], v[76:79], v[84:87], v[204:207]
  v_mfma_f32_16x16x32_bf16 v[208:211], v[72:75], v[88:91], v[208:211]
  v_mfma_f32_16x16x32_bf16 v[208:211], v[76:79], v[92:95], v[208:211]
  v_mfma_f32_16x16x32_bf16 v[212:215], v[72:75], v[96:99], v[212:215]
  v_mfma_f32_16x16x32_bf16 v[212:215], v[76:79], v[100:103], v[212:215]
  v_mfma_f32_16x16x32_bf16 v[216:219], v[72:75], v[104:107], v[216:219]
  s_setprio 2
  s_barrier
  v_mfma_f32_16x16x32_bf16 v[216:219], v[76:79], v[108:111], v[216:219]
  ds_read_b64_tr_b16 v[40:41], v1 offset:0
  s_add_u32 m0, s75, 81920
  s_nop 0
  buffer_load_dwordx4 v29, s[44:47], s74 offen offset:0 lds
  ds_read_b64_tr_b16 v[42:43], v1 offset:2560
  ds_read_b64_tr_b16 v[44:45], v1 offset:20480
  ds_read_b64_tr_b16 v[46:47], v1 offset:23040
  ds_read_b64_tr_b16 v[48:49], v2 offset:0
  buffer_load_dwordx4 v30, s[44:47], s74 offen offset:1024 lds
  ds_read_b64_tr_b16 v[50:51], v2 offset:2560
  ds_read_b64_tr_b16 v[52:53], v2 offset:20480
  ds_read_b64_tr_b16 v[54:55], v2 offset:23040
  ds_read_b64_tr_b16 v[56:57], v3 offset:0
  buffer_load_dwordx4 v31, s[44:47], s74 offen offset:2048 lds
  ds_read_b64_tr_b16 v[58:59], v3 offset:2560
  ds_read_b64_tr_b16 v[60:61], v3 offset:20480
  ds_read_b64_tr_b16 v[62:63], v3 offset:23040
  ds_read_b64_tr_b16 v[64:65], v4 offset:0
  buffer_load_dwordx4 v32, s[44:47], s74 offen offset:3072 lds
  ds_read_b64_tr_b16 v[66:67], v4 offset:2560
  ds_read_b64_tr_b16 v[68:69], v4 offset:20480
  ds_read_b64_tr_b16 v[70:71], v4 offset:23040
  ds_read_b128 v[80:83], v11 offset:8192
  s_add_u32 m0, m0, 4096
  s_nop 0
  buffer_load_dwordx4 v33, s[44:47], s74 offen offset:0 lds
  s_add_u32 s74, s74, 212992
  ds_read_b128 v[84:87], v12 offset:8192
  ds_read_b128 v[88:91], v11 offset:10240
  ds_read_b128 v[92:95], v12 offset:10240
  ds_read_b128 v[96:99], v11 offset:12288
  v_lshl_add_u32 v34, v240, 7, v15
  v_lshl_add_u32 v28, v24, 7, v14
  s_add_u32 m0, s76, 8192
  s_nop 0
  buffer_load_dwordx4 v28, s[32:35], 0 offen lds
  ds_read_b128 v[100:103], v12 offset:12288
  ds_read_b128 v[104:107], v11 offset:14336
  ds_read_b128 v[108:111], v12 offset:14336
  ds_read_b64_tr_b16 v[72:73], v5 offset:0
  s_add_u32 m0, m0, 1024
  s_nop 0
  buffer_load_dwordx4 v34, s[32:35], 0 offen lds
  ds_read_b64_tr_b16 v[74:75], v5 offset:2560
  ds_read_b64_tr_b16 v[76:77], v5 offset:20480
  ds_read_b64_tr_b16 v[78:79], v5 offset:23040
  s_waitcnt vmcnt(9) lgkmcnt(0)
  s_barrier
  s_setprio 0
  v_mfma_f32_16x16x32_bf16 v[140:143], v[40:43], v[80:83], v[140:143]
  v_mfma_f32_16x16x32_bf16 v[140:143], v[44:47], v[84:87], v[140:143]
  v_mfma_f32_16x16x32_bf16 v[144:147], v[40:43], v[88:91], v[144:147]
  v_mfma_f32_16x16x32_bf16 v[144:147], v[44:47], v[92:95], v[144:147]
  v_mfma_f32_16x16x32_bf16 v[148:151], v[40:43], v[96:99], v[148:151]
  v_mfma_f32_16x16x32_bf16 v[148:151], v[44:47], v[100:103], v[148:151]
  v_mfma_f32_16x16x32_bf16 v[152:155], v[40:43], v[104:107], v[152:155]
  v_mfma_f32_16x16x32_bf16 v[152:155], v[44:47], v[108:111], v[152:155]
  v_mfma_f32_16x16x32_bf16 v[168:171], v[48:51], v[104:107], v[168:171]
  v_mfma_f32_16x16x32_bf16 v[168:171], v[52:55], v[108:111], v[168:171]
  v_mfma_f32_16x16x32_bf16 v[164:167], v[48:51], v[96:99], v[164:167]
  v_mfma_f32_16x16x32_bf16 v[164:167], v[52:55], v[100:103], v[164:167]
  v_mfma_f32_16x16x32_bf16 v[160:163], v[48:51], v[88:91], v[160:163]
  v_mfma_f32_16x16x32_bf16 v[160:163], v[52:55], v[92:95], v[160:163]
  v_mfma_f32_16x16x32_bf16 v[156:159], v[48:51], v[80:83], v[156:159]
  v_mfma_f32_16x16x32_bf16 v[156:159], v[52:55], v[84:87], v[156:159]
  v_mfma_f32_16x16x32_bf16 v[172:175], v[56:59], v[80:83], v[172:175]
  v_mfma_f32_16x16x32_bf16 v[172:175], v[60:63], v[84:87], v[172:175]
  v_mfma_f32_16x16x32_bf16 v[176:179], v[56:59], v[88:91], v[176:179]
  v_mfma_f32_16x16x32_bf16 v[176:179], v[60:63], v[92:95], v[176:179]
  v_mfma_f32_16x16x32_bf16 v[180:183], v[56:59], v[96:99], v[180:183]
  v_mfma_f32_16x16x32_bf16 v[180:183], v[60:63], v[100:103], v[180:183]
  v_mfma_f32_16x16x32_bf16 v[184:187], v[56:59], v[104:107], v[184:187]
  v_mfma_f32_16x16x32_bf16 v[184:187], v[60:63], v[108:111], v[184:187]
  v_mfma_f32_16x16x32_bf16 v[200:203], v[64:67], v[104:107], v[200:203]
  v_mfma_f32_16x16x32_bf16 v[200:203], v[68:71], v[108:111], v[200:203]
  v_mfma_f32_16x16x32_bf16 v[196:199], v[64:67], v[96:99], v[196:199]
  v_mfma_f32_16x16x32_bf16 v[196:199], v[68:71], v[100:103], v[196:199]
  v_mfma_f32_16x16x32_bf16 v[192:195], v[64:67], v[88:91], v[192:195]
  v_mfma_f32_16x16x32_bf16 v[192:195], v[68:71], v[92:95], v[192:195]
  v_mfma_f32_16x16x32_bf16 v[188:191], v[64:67], v[80:83], v[188:191]
  v_mfma_f32_16x16x32_bf16 v[188:191], v[68:71], v[84:87], v[188:191]
  v_mfma_f32_16x16x32_bf16 v[204:207], v[72:75], v[80:83], v[204:207]
  v_mfma_f32_16x16x32_bf16 v[204:207], v[76:79], v[84:87], v[204:207]
  v_mfma_f32_16x16x32_bf16 v[208:211], v[72:75], v[88:91], v[208:211]
  v_mfma_f32_16x16x32_bf16 v[208:211], v[76:79], v[92:95], v[208:211]
  v_mfma_f32_16x16x32_bf16 v[212:215], v[72:75], v[96:99], v[212:215]
  v_mfma_f32_16x16x32_bf16 v[212:215], v[76:79], v[100:103], v[212:215]
  v_mfma_f32_16x16x32_bf16 v[216:219], v[72:75], v[104:107], v[216:219]
  s_setprio 2
  s_barrier
  v_mfma_f32_16x16x32_bf16 v[216:219], v[76:79], v[108:111], v[216:219]
  ds_read_b64_tr_b16 v[40:41], v1 offset:40960
  s_add_u32 m0, s75, 0
  s_nop 0
  buffer_load_dwordx4 v29, s[44:47], s74 offen offset:0 lds
  ds_read_b64_tr_b16 v[42:43], v1 offset:43520
  ds_read_b64_tr_b16 v[44:45], v6 offset:0
  ds_read_b64_tr_b16 v[46:47], v6 offset:2560
  ds_read_b64_tr_b16 v[48:49], v2 offset:40960
  buffer_load_dwordx4 v30, s[44:47], s74 offen offset:1024 lds
  ds_read_b64_tr_b16 v[50:51], v2 offset:43520
  ds_read_b64_tr_b16 v[52:53], v7 offset:0
  ds_read_b64_tr_b16 v[54:55], v7 offset:2560
  ds_read_b64_tr_b16 v[56:57], v3 offset:40960
  buffer_load_dwordx4 v31, s[44:47], s74 offen offset:2048 lds
  ds_read_b64_tr_b16 v[58:59], v3 offset:43520
  ds_read_b64_tr_b16 v[60:61], v8 offset:0
  ds_read_b64_tr_b16 v[62:63], v8 offset:2560
  ds_read_b64_tr_b16 v[64:65], v4 offset:40960
  buffer_load_dwordx4 v32, s[44:47], s74 offen offset:3072 lds
  ds_read_b64_tr_b16 v[66:67], v4 offset:43520
  ds_read_b64_tr_b16 v[68:69], v9 offset:0
  ds_read_b64_tr_b16 v[70:71], v9 offset:2560
  ds_read_b128 v[80:83], v11 offset:0
  s_add_u32 m0, m0, 4096
  s_nop 0
  buffer_load_dwordx4 v33, s[44:47], s74 offen offset:0 lds
  s_add_u32 s74, s74, 212992
  ds_read_b128 v[84:87], v12 offset:0
  ds_read_b128 v[88:91], v11 offset:2048
  ds_read_b128 v[92:95], v12 offset:2048
  ds_read_b128 v[96:99], v11 offset:4096
  v_lshl_add_u32 v34, v241, 7, v15
  v_lshl_add_u32 v28, v25, 7, v14
  s_add_u32 m0, s76, 0
  s_nop 0
  buffer_load_dwordx4 v28, s[32:35], 0 offen lds
  ds_read_b128 v[100:103], v12 offset:4096
  ds_read_b128 v[104:107], v11 offset:6144
  ds_read_b128 v[108:111], v12 offset:6144
  ds_read_b64_tr_b16 v[72:73], v5 offset:40960
  s_add_u32 m0, m0, 1024
  s_nop 0
  buffer_load_dwordx4 v34, s[32:35], 0 offen lds
  ds_read_b64_tr_b16 v[74:75], v5 offset:43520
  ds_read_b64_tr_b16 v[76:77], v10 offset:0
  ds_read_b64_tr_b16 v[78:79], v10 offset:2560
  s_mov_b32 m0, 156288
  s_mov_b32 exec_hi, 0xff
  buffer_load_dwordx4 v37, s[52:55], s77 offen lds
  s_mov_b64 exec, -1
  s_waitcnt vmcnt(8) lgkmcnt(0)
  s_barrier
  s_setprio 0
  v_mfma_f32_16x16x32_bf16 v[140:143], v[40:43], v[80:83], v[140:143]
  v_mfma_f32_16x16x32_bf16 v[140:143], v[44:47], v[84:87], v[140:143]
  v_mfma_f32_16x16x32_bf16 v[144:147], v[40:43], v[88:91], v[144:147]
  v_mfma_f32_16x16x32_bf16 v[144:147], v[44:47], v[92:95], v[144:147]
  v_mfma_f32_16x16x32_bf16 v[148:151], v[40:43], v[96:99], v[148:151]
  v_mfma_f32_16x16x32_bf16 v[148:151], v[44:47], v[100:103], v[148:151]
  v_mfma_f32_16x16x32_bf16 v[152:155], v[40:43], v[104:107], v[152:155]
  v_mfma_f32_16x16x32_bf16 v[152:155], v[44:47], v[108:111], v[152:155]
  v_mfma_f32_16x16x32_bf16 v[168:171], v[48:51], v[104:107], v[168:171]
  v_mfma_f32_16x16x32_bf16 v[168:171], v[52:55], v[108:111], v[168:171]
  v_mfma_f32_16x16x32_bf16 v[164:167], v[48:51], v[96:99], v[164:167]
  v_mfma_f32_16x16x32_bf16 v[164:167], v[52:55], v[100:103], v[164:167]
  v_mfma_f32_16x16x32_bf16 v[160:163], v[48:51], v[88:91], v[160:163]
  v_mfma_f32_16x16x32_bf16 v[160:163], v[52:55], v[92:95], v[160:163]
  v_mfma_f32_16x16x32_bf16 v[156:159], v[48:51], v[80:83], v[156:159]
  v_mfma_f32_16x16x32_bf16 v[156:159], v[52:55], v[84:87], v[156:159]
  v_mfma_f32_16x16x32_bf16 v[172:175], v[56:59], v[80:83], v[172:175]
  v_mfma_f32_16x16x32_bf16 v[172:175], v[60:63], v[84:87], v[172:175]
  v_mfma_f32_16x16x32_bf16 v[176:179], v[56:59], v[88:91], v[176:179]
  v_mfma_f32_16x16x32_bf16 v[176:179], v[60:63], v[92:95], v[176:179]
  v_mfma_f32_16x16x32_bf16 v[180:183], v[56:59], v[96:99], v[180:183]
  v_mfma_f32_16x16x32_bf16 v[180:183], v[60:63], v[100:103], v[180:183]
  v_mfma_f32_16x16x32_bf16 v[184:187], v[56:59], v[104:107], v[184:187]
  v_mfma_f32_16x16x32_bf16 v[184:187], v[60:63], v[108:111], v[184:187]
  v_mfma_f32_16x16x32_bf16 v[200:203], v[64:67], v[104:107], v[200:203]
  v_mfma_f32_16x16x32_bf16 v[200:203], v[68:71], v[108:111], v[200:203]
  v_mfma_f32_16x16x32_bf16 v[196:199], v[64:67], v[96:99], v[196:199]
  v_mfma_f32_16x16x32_bf16 v[196:199], v[68:71], v[100:103], v[196:199]
  v_mfma_f32_16x16x32_bf16 v[192:195], v[64:67], v[88:91], v[192:195]
  v_mfma_f32_16x16x32_bf16 v[192:195], v[68:71], v[92:95], v[192:195]
  v_mfma_f32_16x16x32_bf16 v[188:191], v[64:67], v[80:83], v[188:191]
  v_mfma_f32_16x16x32_bf16 v[188:191], v[68:71], v[84:87], v[188:191]
  v_mfma_f32_16x16x32_bf16 v[204:207], v[72:75], v[80:83], v[204:207]
  v_mfma_f32_16x16x32_bf16 v[204:207], v[76:79], v[84:87], v[204:207]
  v_mfma_f32_16x16x32_bf16 v[208:211], v[72:75], v[88:91], v[208:211]
  v_mfma_f32_16x16x32_bf16 v[208:211], v[76:79], v[92:95], v[208:211]
  v_mfma_f32_16x16x32_bf16 v[212:215], v[72:75], v[96:99], v[212:215]
  v_mfma_f32_16x16x32_bf16 v[212:215], v[76:79], v[100:103], v[212:215]
  v_mfma_f32_16x16x32_bf16 v[216:219], v[72:75], v[104:107], v[216:219]
  s_setprio 2
  s_barrier
  v_mfma_f32_16x16x32_bf16 v[216:219], v[76:79], v[108:111], v[216:219]
  ds_read_b64_tr_b16 v[40:41], v6 offset:20480
  s_add_u32 m0, s75, 40960
  s_nop 0
  buffer_load_dwordx4 v29, s[44:47], s74 offen offset:0 lds
  ds_read_b64_tr_b16 v[42:43], v6 offset:23040
  ds_read_b64_tr_b16 v[44:45], v6 offset:40960
  ds_read_b64_tr_b16 v[46:47], v6 offset:43520
  ds_read_b64_tr_b16 v[48:49], v7 offset:20480
  buffer_load_dwordx4 v30, s[44:47], s74 offen offset:1024 lds
  ds_read_b64_tr_b16 v[50:51], v7 offset:23040
  ds_read_b64_tr_b16 v[52:53], v7 offset:40960
  ds_read_b64_tr_b16 v[54:55], v7 offset:43520
  ds_read_b64_tr_b16 v[56:57], v8 offset:20480
  buffer_load_dwordx4 v31, s[44:47], s74 offen offset:2048 lds
  ds_read_b64_tr_b16 v[58:59], v8 offset:23040
  ds_read_b64_tr_b16 v[60:61], v8 offset:40960
  ds_read_b64_tr_b16 v[62:63], v8 offset:43520
  ds_read_b64_tr_b16 v[64:65], v9 offset:20480
  buffer_load_dwordx4 v32, s[44:47], s74 offen offset:3072 lds
  ds_read_b64_tr_b16 v[66:67], v9 offset:23040
  ds_read_b64_tr_b16 v[68:69], v9 offset:40960
  ds_read_b64_tr_b16 v[70:71], v9 offset:43520
  ds_read_b128 v[80:83], v11 offset:8192
  s_add_u32 m0, m0, 4096
  s_nop 0
  buffer_load_dwordx4 v33, s[44:47], s74 offen offset:0 lds
  s_add_u32 s74, s74, 212992
  ds_read_b128 v[84:87], v12 offset:8192
  ds_read_b128 v[88:91], v11 offset:10240
  ds_read_b128 v[92:95], v12 offset:10240
  ds_read_b128 v[96:99], v11 offset:12288
  v_lshl_add_u32 v34, v242, 7, v15
  v_lshl_add_u32 v28, v26, 7, v14
  s_add_u32 m0, s76, 8192
  s_nop 0
  buffer_load_dwordx4 v28, s[32:35], 0 offen lds
  ds_read_b128 v[100:103], v12 offset:12288
  ds_read_b128 v[104:107], v11 offset:14336
  ds_read_b128 v[108:111], v12 offset:14336
  ds_read_b64_tr_b16 v[72:73], v10 offset:20480
  s_add_u32 m0, m0, 1024
  s_nop 0
  buffer_load_dwordx4 v34, s[32:35], 0 offen lds
  ds_read_b64_tr_b16 v[74:75], v10 offset:23040
  ds_read_b64_tr_b16 v[76:77], v10 offset:40960
  ds_read_b64_tr_b16 v[78:79], v10 offset:43520
  buffer_load_dwordx3 v[24:26], v13, s[28:31], s73 offen offset:0
  buffer_load_dwordx3 v[240:242], v13, s[28:31], s73 offen offset:832
  s_add_u32 s73, s73, 12
  s_waitcnt vmcnt(10) lgkmcnt(0)
  s_barrier
  s_setprio 0
  v_mfma_f32_16x16x32_bf16 v[140:143], v[40:43], v[80:83], v[140:143]
  s_add_u32 s72, s72, 1
  v_mfma_f32_16x16x32_bf16 v[140:143], v[44:47], v[84:87], v[140:143]
  v_mfma_f32_16x16x32_bf16 v[144:147], v[40:43], v[88:91], v[144:147]
  v_mfma_f32_16x16x32_bf16 v[144:147], v[44:47], v[92:95], v[144:147]
  v_mfma_f32_16x16x32_bf16 v[148:151], v[40:43], v[96:99], v[148:151]
  v_mfma_f32_16x16x32_bf16 v[148:151], v[44:47], v[100:103], v[148:151]
  v_mfma_f32_16x16x32_bf16 v[152:155], v[40:43], v[104:107], v[152:155]
  v_mfma_f32_16x16x32_bf16 v[152:155], v[44:47], v[108:111], v[152:155]
  v_mfma_f32_16x16x32_bf16 v[168:171], v[48:51], v[104:107], v[168:171]
  v_mfma_f32_16x16x32_bf16 v[168:171], v[52:55], v[108:111], v[168:171]
  v_mfma_f32_16x16x32_bf16 v[164:167], v[48:51], v[96:99], v[164:167]
  v_mfma_f32_16x16x32_bf16 v[164:167], v[52:55], v[100:103], v[164:167]
  v_mfma_f32_16x16x32_bf16 v[160:163], v[48:51], v[88:91], v[160:163]
  v_mfma_f32_16x16x32_bf16 v[160:163], v[52:55], v[92:95], v[160:163]
  v_mfma_f32_16x16x32_bf16 v[156:159], v[48:51], v[80:83], v[156:159]
  v_mfma_f32_16x16x32_bf16 v[156:159], v[52:55], v[84:87], v[156:159]
  v_mfma_f32_16x16x32_bf16 v[172:175], v[56:59], v[80:83], v[172:175]
  v_mfma_f32_16x16x32_bf16 v[172:175], v[60:63], v[84:87], v[172:175]
  v_mfma_f32_16x16x32_bf16 v[176:179], v[56:59], v[88:91], v[176:179]
  v_mfma_f32_16x16x32_bf16 v[176:179], v[60:63], v[92:95], v[176:179]
  s_cmp_lt_u32 s72, 4
  v_mfma_f32_16x16x32_bf16 v[180:183], v[56:59], v[96:99], v[180:183]
  v_mfma_f32_16x16x32_bf16 v[180:183], v[60:63], v[100:103], v[180:183]
  v_mfma_f32_16x16x32_bf16 v[184:187], v[56:59], v[104:107], v[184:187]
  v_mfma_f32_16x16x32_bf16 v[184:187], v[60:63], v[108:111], v[184:187]
  v_mfma_f32_16x16x32_bf16 v[200:203], v[64:67], v[104:107], v[200:203]
  v_mfma_f32_16x16x32_bf16 v[200:203], v[68:71], v[108:111], v[200:203]
  v_mfma_f32_16x16x32_bf16 v[196:199], v[64:67], v[96:99], v[196:199]
  v_mfma_f32_16x16x32_bf16 v[196:199], v[68:71], v[100:103], v[196:199]
  v_mfma_f32_16x16x32_bf16 v[192:195], v[64:67], v[88:91], v[192:195]
  v_mfma_f32_16x16x32_bf16 v[192:195], v[68:71], v[92:95], v[192:195]
  v_mfma_f32_16x16x32_bf16 v[188:191], v[64:67], v[80:83], v[188:191]
  v_mfma_f32_16x16x32_bf16 v[188:191], v[68:71], v[84:87], v[188:191]
  v_mfma_f32_16x16x32_bf16 v[204:207], v[72:75], v[80:83], v[204:207]
  v_mfma_f32_16x16x32_bf16 v[204:207], v[76:79], v[84:87], v[204:207]
  v_mfma_f32_16x16x32_bf16 v[208:211], v[72:75], v[88:91], v[208:211]
  v_mfma_f32_16x16x32_bf16 v[208:211], v[76:79], v[92:95], v[208:211]
  v_mfma_f32_16x16x32_bf16 v[212:215], v[72:75], v[96:99], v[212:215]
  v_mfma_f32_16x16x32_bf16 v[212:215], v[76:79], v[100:103], v[212:215]
  v_mfma_f32_16x16x32_bf16 v[216:219], v[72:75], v[104:107], v[216:219]
  s_setprio 2
  s_barrier
  v_mfma_f32_16x16x32_bf16 v[216:219], v[76:79], v[108:111], v[216:219]
  s_cbranch_scc1 L_dnn_loop1
  ds_read_b64_tr_b16 v[40:41], v1 offset:0
  ds_read_b64_tr_b16 v[42:43], v1 offset:2560
  ds_read_b64_tr_b16 v[44:45], v1 offset:20480
  ds_read_b64_tr_b16 v[46:47], v1 offset:23040
  ds_read_b64_tr_b16 v[48:49], v2 offset:0
  ds_read_b64_tr_b16 v[50:51], v2 offset:2560
  ds_read_b64_tr_b16 v[52:53], v2 offset:20480
  ds_read_b64_tr_b16 v[54:55], v2 offset:23040
  ds_read_b64_tr_b16 v[56:57], v3 offset:0
  ds_read_b64_tr_b16 v[58:59], v3 offset:2560
  ds_read_b64_tr_b16 v[60:61], v3 offset:20480
  ds_read_b64_tr_b16 v[62:63], v3 offset:23040
  ds_read_b64_tr_b16 v[64:65], v4 offset:0
  ds_read_b64_tr_b16 v[66:67], v4 offset:2560
  ds_read_b64_tr_b16 v[68:69], v4 offset:20480
  ds_read_b64_tr_b16 v[70:71], v4 offset:23040
  ds_read_b128 v[80:83], v11 offset:0
  ds_read_b128 v[84:87], v12 offset:0
  ds_read_b128 v[88:91], v11 offset:2048
  ds_read_b128 v[92:95], v12 offset:2048
  ds_read_b128 v[96:99], v11 offset:4096
  ds_read_b128 v[100:103], v12 offset:4096
  ds_read_b128 v[104:107], v11 offset:6144
  ds_read_b128 v[108:111], v12 offset:6144
  ds_read_b64_tr_b16 v[72:73], v5 offset:0
  ds_read_b64_tr_b16 v[74:75], v5 offset:2560
  ds_read_b64_tr_b16 v[76:77], v5 offset:20480
  ds_read_b64_tr_b16 v[78:79], v5 offset:23040
  ds_read_b64 v[220:221], v35 offset:640
  ds_read_b64 v[222:223], v35 offset:672
  ds_read_b64 v[224:225], v35 offset:704
  ds_read_b64 v[226:227], v35 offset:736
  ds_read_b64 v[228:229], v35 offset:768
  s_waitcnt vmcnt(2) lgkmcnt(0)
  s_barrier
  s_setprio 0
  v_mfma_f32_16x16x32_bf16 v[140:143], v[40:43], v[80:83], v[140:143]
  v_mov_b32 v232, 0xc0135761
  v_mov_b32 v233, 0xc0135761
  v_mfma_f32_16x16x32_bf16 v[140:143], v[44:47], v[84:87], v[140:143]
  v_mov_b32 v234, 0xbdd2d3e8
  v_mov_b32 v235, 0xbdd2d3e8
  v_mfma_f32_16x16x32_bf16 v[144:147], v[40:43], v[88:91], v[144:147]
  v_mov_b32 v236, 0xc2b40000
  v_mov_b32 v237, 0xc2b40000
  v_mfma_f32_16x16x32_bf16 v[144:147], v[44:47], v[92:95], v[144:147]
  v_lshlrev_b32 v112, 16, v220
  v_and_b32 v113, 0xffff0000, v220
  v_mfma_f32_16x16x32_bf16 v[148:151], v[40:43], v[96:99], v[148:151]
  v_lshlrev_b32 v114, 16, v221
  v_and_b32 v115, 0xffff0000, v221
  v_mfma_f32_16x16x32_bf16 v[148:151], v[44:47], v[100:103], v[148:151]
  v_lshlrev_b32 v116, 16, v222
  v_and_b32 v117, 0xffff0000, v222
  v_mfma_f32_16x16x32_bf16 v[152:155], v[40:43], v[104:107], v[152:155]
  v_lshlrev_b32 v118, 16, v223
  v_and_b32 v119, 0xffff0000, v223
  v_mfma_f32_16x16x32_bf16 v[152:155], v[44:47], v[108:111], v[152:155]
  v_lshlrev_b32 v120, 16, v224
  v_and_b32 v121, 0xffff0000, v224
  v_mfma_f32_16x16x32_bf16 v[168:171], v[48:51], v[104:107], v[168:171]
  v_lshlrev_b32 v122, 16, v225
  v_and_b32 v123, 0xffff0000, v225
  v_mfma_f32_16x16x32_bf16 v[168:171], v[52:55], v[108:111], v[168:171]
  v_lshlrev_b32 v124, 16, v226
  v_mfma_f32_16x16x32_bf16 v[164:167], v[48:51], v[96:99], v[164:167]
  v_and_b32 v125, 0xffff0000, v226
  v_lshlrev_b32 v126, 16, v227
  v_mfma_f32_16x16x32_bf16 v[164:167], v[52:55], v[100:103], v[164:167]
  v_and_b32 v127, 0xffff0000, v227
  v_lshlrev_b32 v128, 16, v228
  v_mfma_f32_16x16x32_bf16 v[160:163], v[48:51], v[88:91], v[160:163]
  v_and_b32 v129, 0xffff0000, v228
  v_lshlrev_b32 v130, 16, v229
  v_mfma_f32_16x16x32_bf16 v[160:163], v[52:55], v[92:95], v[160:163]
  v_and_b32 v131, 0xffff0000, v229
  v_mov_b32 v239, 0x21800000
  v_mfma_f32_16x16x32_bf16 v[156:159], v[48:51], v[80:83], v[156:159]
  v_mov_b32 v238, 0x30800000
  v_max3_f32 v239, v239, abs(v112), abs(v113)
  v_mfma_f32_16x16x32_bf16 v[156:159], v[52:55], v[84:87], v[156:159]
  v_max3_f32 v239, v239, abs(v114), abs(v115)
  v_max3_f32 v239, v239, abs(v116), abs(v117)
  v_mfma_f32_16x16x32_bf16 v[172:175], v[56:59], v[80:83], v[172:175]
  v_max3_f32 v239, v239, abs(v118), abs(v119)
  v_max3_f32 v239, v239, abs(v120), abs(v121)
  v_mfma_f32_16x16x32_bf16 v[172:175], v[60:63], v[84:87], v[172:175]
  v_max3_f32 v239, v239, abs(v122), abs(v123)
  v_max3_f32 v239, v239, abs(v124), abs(v125)
  v_mfma_f32_16x16x32_bf16 v[176:179], v[56:59], v[88:91], v[176:179]
  v_max3_f32 v239, v239, abs(v126), abs(v127)
  v_mfma_f32_16x16x32_bf16 v[176:179], v[60:63], v[92:95], v[176:179]
  v_max3_f32 v239, v239, abs(v128), abs(v129)
  v_max3_f32 v239, v239, abs(v130), abs(v131)
  v_mfma_f32_16x16x32_bf16 v[180:183], v[56:59], v[96:99], v[180:183]
  v_and_b32 v239, 0x7f800000, v239
  v_mul_f32 v239, 0x22000000, v239
  v_mfma_f32_16x16x32_bf16 v[180:183], v[60:63], v[100:103], v[180:183]
  v_rcp_f32 v112, v112
  v_mfma_f32_16x16x32_bf16 v[184:187], v[56:59], v[104:107], v[184:187]
  v_rcp_f32 v113, v113
  v_mfma_f32_16x16x32_bf16 v[184:187], v[60:63], v[108:111], v[184:187]
  v_rcp_f32 v114, v114
  v_mfma_f32_16x16x32_bf16 v[200:203], v[64:67], v[104:107], v[200:203]
  v_rcp_f32 v115, v115
  v_mfma_f32_16x16x32_bf16 v[200:203], v[68:71], v[108:111], v[200:203]
  v_rcp_f32 v116, v116
  v_mfma_f32_16x16x32_bf16 v[196:199], v[64:67], v[96:99], v[196:199]
  v_rcp_f32 v117, v117
  v_mfma_f32_16x16x32_bf16 v[196:199], v[68:71], v[100:103], v[196:199]
  v_rcp_f32 v118, v118
  v_mfma_f32_16x16x32_bf16 v[192:195], v[64:67], v[88:91], v[192:195]
  v_rcp_f32 v119, v119
  v_mfma_f32_16x16x32_bf16 v[192:195], v[68:71], v[92:95], v[192:195]
  v_rcp_f32 v120, v120
  v_mfma_f32_16x16x32_bf16 v[188:191], v[64:67], v[80:83], v[188:191]
  v_rcp_f32 v121, v121
  v_mfma_f32_16x16x32_bf16 v[188:191], v[68:71], v[84:87], v[188:191]
  v_rcp_f32 v122, v122
  v_mfma_f32_16x16x32_bf16 v[204:207], v[72:75], v[80:83], v[204:207]
  v_rcp_f32 v123, v123
  v_mfma_f32_16x16x32_bf16 v[204:207], v[76:79], v[84:87], v[204:207]
  v_rcp_f32 v124, v124
  v_mfma_f32_16x16x32_bf16 v[208:211], v[72:75], v[88:91], v[208:211]
  v_rcp_f32 v125, v125
  v_mfma_f32_16x16x32_bf16 v[208:211], v[76:79], v[92:95], v[208:211]
  v_rcp_f32 v126, v126
  v_mfma_f32_16x16x32_bf16 v[212:215], v[72:75], v[96:99], v[212:215]
  v_rcp_f32 v127, v127
  v_mfma_f32_16x16x32_bf16 v[212:215], v[76:79], v[100:103], v[212:215]
  v_mfma_f32_16x16x32_bf16 v[216:219], v[72:75], v[104:107], v[216:219]
  s_setprio 2
  s_barrier
  v_mfma_f32_16x16x32_bf16 v[216:219], v[76:79], v[108:111], v[216:219]
  ds_read_b64_tr_b16 v[40:41], v1 offset:40960
  ds_read_b64_tr_b16 v[42:43], v1 offset:43520
  ds_read_b64_tr_b16 v[44:45], v6 offset:0
  ds_read_b64_tr_b16 v[46:47], v6 offset:2560
  ds_read_b64_tr_b16 v[48:49], v2 offset:40960
  ds_read_b64_tr_b16 v[50:51], v2 offset:43520
  ds_read_b64_tr_b16 v[52:53], v7 offset:0
  ds_read_b64_tr_b16 v[54:55], v7 offset:2560
  ds_read_b64_tr_b16 v[56:57], v3 offset:40960
  ds_read_b64_tr_b16 v[58:59], v3 offset:43520
  ds_read_b64_tr_b16 v[60:61], v8 offset:0
  ds_read_b64_tr_b16 v[62:63], v8 offset:2560
  ds_read_b64_tr_b16 v[64:65], v4 offset:40960
  ds_read_b64_tr_b16 v[66:67], v4 offset:43520
  ds_read_b64_tr_b16 v[68:69], v9 offset:0
  ds_read_b64_tr_b16 v[70:71], v9 offset:2560
  ds_read_b128 v[80:83], v11 offset:8192
  ds_read_b128 v[84:87], v12 offset:8192
  ds_read_b128 v[88:91], v11 offset:10240
  ds_read_b128 v[92:95], v12 offset:10240
  ds_read_b128 v[96:99], v11 offset:12288
  ds_read_b128 v[100:103], v12 offset:12288
  ds_read_b128 v[104:107], v11 offset:14336
  ds_read_b128 v[108:111], v12 offset:14336
  ds_read_b64_tr_b16 v[72:73], v5 offset:40960
  ds_read_b64_tr_b16 v[74:75], v5 offset:43520
  ds_read_b64_tr_b16 v[76:77], v10 offset:0
  ds_read_b64_tr_b16 v[78:79], v10 offset:2560
  s_waitcnt lgkmcnt(0)
  s_barrier
  v_mfma_f32_16x16x32_bf16 v[140:143], v[40:43], v[80:83], v[140:143]
  v_rcp_f32 v128, v128
  v_mfma_f32_16x16x32_bf16 v[140:143], v[44:47], v[84:87], v[140:143]
  v_rcp_f32 v129, v129
  v_mfma_f32_16x16x32_bf16 v[144:147], v[40:43], v[88:91], v[144:147]
  v_rcp_f32 v130, v130
  v_mfma_f32_16x16x32_bf16 v[144:147], v[44:47], v[92:95], v[144:147]
  v_rcp_f32 v131, v131
  v_mfma_f32_16x16x32_bf16 v[148:151], v[40:43], v[96:99], v[148:151]
  v_mul_f32 v112, v239, v112
  v_mfma_f32_16x16x32_bf16 v[148:151], v[44:47], v[100:103], v[148:151]
  v_mul_f32 v113, v239, v113
  v_mul_f32 v114, v239, v114
  v_mfma_f32_16x16x32_bf16 v[152:155], v[40:43], v[104:107], v[152:155]
  v_mul_f32 v115, v239, v115
  v_mul_f32 v116, v239, v116
  v_mfma_f32_16x16x32_bf16 v[152:155], v[44:47], v[108:111], v[152:155]
  v_mul_f32 v117, v239, v117
  v_mul_f32 v118, v239, v118
  v_mfma_f32_16x16x32_bf16 v[168:171], v[48:51], v[104:107], v[168:171]
  v_mul_f32 v119, v239, v119
  v_mul_f32 v120, v239, v120
  v_mfma_f32_16x16x32_bf16 v[168:171], v[52:55], v[108:111], v[168:171]
  v_mul_f32 v121, v239, v121
  v_mfma_f32_16x16x32_bf16 v[164:167], v[48:51], v[96:99], v[164:167]
  v_mul_f32 v122, v239, v122
  v_mul_f32 v123, v239, v123
  v_mfma_f32_16x16x32_bf16 v[164:167], v[52:55], v[100:103], v[164:167]
  v_mul_f32 v124, v239, v124
  v_mul_f32 v125, v239, v125
  v_mfma_f32_16x16x32_bf16 v[160:163], v[48:51], v[88:91], v[160:163]
  v_mul_f32 v126, v239, v126
  v_mul_f32 v127, v239, v127
  v_mfma_f32_16x16x32_bf16 v[160:163], v[52:55], v[92:95], v[160:163]
  v_mul_f32 v128, v239, v128
  v_mul_f32 v129, v239, v129
  v_mfma_f32_16x16x32_bf16 v[156:159], v[48:51], v[80:83], v[156:159]
  v_mul_f32 v130, v239, v130
  v_mfma_f32_16x16x32_bf16 v[156:159], v[52:55], v[84:87], v[156:159]
  v_mul_f32 v131, v239, v131
  v_med3_f32 v112, v112, -v238, v238
  v_mfma_f32_16x16x32_bf16 v[172:175], v[56:59], v[80:83], v[172:175]
  v_med3_f32 v113, v113, -v238, v238
  v_med3_f32 v114, v114, -v238, v238
  v_mfma_f32_16x16x32_bf16 v[172:175], v[60:63], v[84:87], v[172:175]
  v_med3_f32 v115, v115, -v238, v238
  v_med3_f32 v116, v116, -v238, v238
  v_mfma_f32_16x16x32_bf16 v[176:179], v[56:59], v[88:91], v[176:179]
  v_med3_f32 v117, v117, -v238, v238
  v_mfma_f32_16x16x32_bf16 v[176:179], v[60:63], v[92:95], v[176:179]
  v_med3_f32 v118, v118, -v238, v238
  v_med3_f32 v119, v119, -v238, v238
  v_mfma_f32_16x16x32_bf16 v[180:183], v[56:59], v[96:99], v[180:183]
  v_med3_f32 v120, v120, -v238, v238
  v_med3_f32 v121, v121, -v238, v238
  v_mfma_f32_16x16x32_bf16 v[180:183], v[60:63], v[100:103], v[180:183]
  v_med3_f32 v122, v122, -v238, v238
  v_med3_f32 v123, v123, -v238, v238
  v_mfma_f32_16x16x32_bf16 v[184:187], v[56:59], v[104:107], v[184:187]
  v_med3_f32 v124, v124, -v238, v238
  v_med3_f32 v125, v125, -v238, v238
  v_mfma_f32_16x16x32_bf16 v[184:187], v[60:63], v[108:111], v[184:187]
  v_med3_f32 v126, v126, -v238, v238
  v_mfma_f32_16x16x32_bf16 v[200:203], v[64:67], v[104:107], v[200:203]
  v_med3_f32 v127, v127, -v238, v238
  v_med3_f32 v128, v128, -v238, v238
  v_mfma_f32_16x16x32_bf16 v[200:203], v[68:71], v[108:111], v[200:203]
  v_med3_f32 v129, v129, -v238, v238
  v_med3_f32 v130, v130, -v238, v238
  v_mfma_f32_16x16x32_bf16 v[196:199], v[64:67], v[96:99], v[196:199]
  v_med3_f32 v131, v131, -v238, v238
  v_mul_f32 v132, 0x6c800000, v112
  v_mfma_f32_16x16x32_bf16 v[196:199], v[68:71], v[100:103], v[196:199]
  v_mul_f32 v133, 0x6c800000, v113
  v_mul_f32 v134, 0x6c800000, v114
  v_mfma_f32_16x16x32_bf16 v[192:195], v[64:67], v[88:91], v[192:195]
  v_mul_f32 v135, 0x6c800000, v115
  v_mfma_f32_16x16x32_bf16 v[192:195], v[68:71], v[92:95], v[192:195]
  v_mul_f32 v136, 0x6c800000, v116
  v_mul_f32 v137, 0x6c800000, v117
  v_mfma_f32_16x16x32_bf16 v[188:191], v[64:67], v[80:83], v[188:191]
  v_mul_f32 v138, 0x6c800000, v118
  v_mul_f32 v139, 0x6c800000, v119
  v_mfma_f32_16x16x32_bf16 v[188:191], v[68:71], v[84:87], v[188:191]
  v_mul_f32 v220, 0x6c800000, v120
  v_mul_f32 v221, 0x6c800000, v121
  v_mfma_f32_16x16x32_bf16 v[204:207], v[72:75], v[80:83], v[204:207]
  v_mul_f32 v222, 0x6c800000, v122
  v_mul_f32 v223, 0x6c800000, v123
  v_mfma_f32_16x16x32_bf16 v[204:207], v[76:79], v[84:87], v[204:207]
  v_mul_f32 v224, 0x6c800000, v124
  v_mfma_f32_16x16x32_bf16 v[208:211], v[72:75], v[88:91], v[208:211]
  v_mul_f32 v225, 0x6c800000, v125
  v_mul_f32 v226, 0x6c800000, v126
  v_mfma_f32_16x16x32_bf16 v[208:211], v[76:79], v[92:95], v[208:211]
  v_mul_f32 v227, 0x6c800000, v127
  v_mul_f32 v228, 0x6c800000, v128
  v_mfma_f32_16x16x32_bf16 v[212:215], v[72:75], v[96:99], v[212:215]
  v_mul_f32 v229, 0x6c800000, v129
  v_mul_f32 v230, 0x6c800000, v130
  v_mfma_f32_16x16x32_bf16 v[212:215], v[76:79], v[100:103], v[212:215]
  v_mul_f32 v231, 0x6c800000, v131
  v_mfma_f32_16x16x32_bf16 v[216:219], v[72:75], v[104:107], v[216:219]
  v_mfma_f32_16x16x32_bf16 v[216:219], v[76:79], v[108:111], v[216:219]
  s_setprio 0
L_epi:
  s_lshl_b32 s69, s27, 11
  s_and_b32 s71, s26, 3
  s_lshl_b32 s71, s71, 9
  s_add_u32 s69, s69, s71
  s_lshr_b32 s68, s26, 2
  s_lshl_b32 s68, s68, 14
  s_add_u32 s69, s69, s68
  v_lshlrev_b32 v3, 3, v0
  v_add_u32 v2, 156928, v3
  v_pk_mul_f32 v[40:41], v[140:141], v[140:141]
  v_pk_mul_f32 v[42:43], v[142:143], v[142:143]
  v_pk_mul_f32 v[46:47], v[144:145], v[144:145]
  v_pk_mul_f32 v[48:49], v[146:147], v[146:147]
  v_pk_mul_f32 v[52:53], v[148:149], v[148:149]
  v_pk_mul_f32 v[54:55], v[150:151], v[150:151]
  v_pk_mul_f32 v[58:59], v[152:153], v[152:153]
  v_pk_mul_f32 v[60:61], v[154:155], v[154:155]
  v_pk_fma_f32 v[40:41], v[40:41], v[234:235], v[232:233]
  v_pk_fma_f32 v[42:43], v[42:43], v[234:235], v[232:233]
  v_pk_fma_f32 v[46:47], v[46:47], v[234:235], v[232:233]
  v_pk_fma_f32 v[48:49], v[48:49], v[234:235], v[232:233]
  v_pk_fma_f32 v[52:53], v[52:53], v[234:235], v[232:233]
  v_pk_fma_f32 v[54:55], v[54:55], v[234:235], v[232:233]
  v_pk_fma_f32 v[58:59], v[58:59], v[234:235], v[232:233]
  v_pk_fma_f32 v[60:61], v[60:61], v[234:235], v[232:233]
  v_pk_fma_f32 v[40:41], v[40:41], v[140:141], v[236:237]
  v_pk_fma_f32 v[42:43], v[42:43], v[142:143], v[236:237]
  v_pk_fma_f32 v[46:47], v[46:47], v[144:145], v[236:237]
  v_pk_fma_f32 v[48:49], v[48:49], v[146:147], v[236:237]
  v_pk_fma_f32 v[52:53], v[52:53], v[148:149], v[236:237]
  v_pk_fma_f32 v[54:55], v[54:55], v[150:151], v[236:237]
  v_pk_fma_f32 v[58:59], v[58:59], v[152:153], v[236:237]
  v_pk_fma_f32 v[60:61], v[60:61], v[154:155], v[236:237]
  v_exp_f32 v40, v40 clamp
  v_exp_f32 v41, v41 clamp
  v_exp_f32 v42, v42 clamp
  v_exp_f32 v43, v43 clamp
  v_exp_f32 v46, v46 clamp
  v_exp_f32 v47, v47 clamp
  v_exp_f32 v48, v48 clamp
  v_exp_f32 v49, v49 clamp
  v_exp_f32 v52, v52 clamp
  v_exp_f32 v53, v53 clamp
  v_exp_f32 v54, v54 clamp
  v_exp_f32 v55, v55 clamp
  v_exp_f32 v58, v58 clamp
  v_exp_f32 v59, v59 clamp
  v_exp_f32 v60, v60 clamp
  v_exp_f32 v61, v61 clamp
  v_pk_fma_f32 v[40:41], v[40:41], v[132:133], v[112:113]
  v_pk_fma_f32 v[42:43], v[42:43], v[134:135], v[114:115]
  v_pk_fma_f32 v[46:47], v[46:47], v[132:133], v[112:113]
  v_pk_fma_f32 v[48:49], v[48:49], v[134:135], v[114:115]
  v_pk_fma_f32 v[52:53], v[52:53], v[132:133], v[112:113]
  v_pk_fma_f32 v[54:55], v[54:55], v[134:135], v[114:115]
  v_pk_fma_f32 v[58:59], v[58:59], v[132:133], v[112:113]
  v_pk_fma_f32 v[60:61], v[60:61], v[134:135], v[114:115]
  v_pk_mul_f32 v[44:45], v[140:141], v[42:43]
  v_pk_mul_f32 v[50:51], v[144:145], v[48:49]
  v_pk_mul_f32 v[56:57], v[148:149], v[54:55]
  v_pk_mul_f32 v[62:63], v[152:153], v[60:61]
  v_pk_fma_f32 v[44:45], v[142:143], v[40:41], v[44:45]
  v_pk_fma_f32 v[50:51], v[146:147], v[46:47], v[50:51]
  v_pk_fma_f32 v[56:57], v[150:151], v[52:53], v[56:57]
  v_pk_fma_f32 v[62:63], v[154:155], v[58:59], v[62:63]
  v_pk_mul_f32 v[40:41], v[40:41], v[42:43]
  v_pk_mul_f32 v[46:47], v[46:47], v[48:49]
  v_pk_mul_f32 v[52:53], v[52:53], v[54:55]
  v_pk_mul_f32 v[58:59], v[58:59], v[60:61]
  v_rcp_f32 v40, v40
  v_rcp_f32 v41, v41
  v_rcp_f32 v46, v46
  v_rcp_f32 v47, v47
  v_rcp_f32 v52, v52
  v_rcp_f32 v53, v53
  v_rcp_f32 v58, v58
  v_rcp_f32 v59, v59
  v_pk_mul_f32 v[16:17], v[40:41], v[44:45]
  v_pk_mul_f32 v[18:19], v[46:47], v[50:51]
  v_pk_mul_f32 v[20:21], v[52:53], v[56:57]
  v_pk_mul_f32 v[22:23], v[58:59], v[62:63]
  v_pk_mul_f32 v[64:65], v[156:157], v[156:157]
  v_pk_mul_f32 v[66:67], v[158:159], v[158:159]
  v_pk_mul_f32 v[70:71], v[160:161], v[160:161]
  v_pk_mul_f32 v[72:73], v[162:163], v[162:163]
  v_pk_mul_f32 v[76:77], v[164:165], v[164:165]
  v_pk_mul_f32 v[78:79], v[166:167], v[166:167]
  v_pk_mul_f32 v[82:83], v[168:169], v[168:169]
  v_pk_mul_f32 v[84:85], v[170:171], v[170:171]
  v_pk_fma_f32 v[64:65], v[64:65], v[234:235], v[232:233]
  v_pk_fma_f32 v[66:67], v[66:67], v[234:235], v[232:233]
  v_pk_fma_f32 v[70:71], v[70:71], v[234:235], v[232:233]
  v_pk_fma_f32 v[72:73], v[72:73], v[234:235], v[232:233]
  v_pk_fma_f32 v[76:77], v[76:77], v[234:235], v[232:233]
  v_pk_fma_f32 v[78:79], v[78:79], v[234:235], v[232:233]
  v_pk_fma_f32 v[82:83], v[82:83], v[234:235], v[232:233]
  v_pk_fma_f32 v[84:85], v[84:85], v[234:235], v[232:233]
  v_pk_fma_f32 v[64:65], v[64:65], v[156:157], v[236:237]
  v_pk_fma_f32 v[66:67], v[66:67], v[158:159], v[236:237]
  v_pk_fma_f32 v[70:71], v[70:71], v[160:161], v[236:237]
  v_pk_fma_f32 v[72:73], v[72:73], v[162:163], v[236:237]
  v_pk_fma_f32 v[76:77], v[76:77], v[164:165], v[236:237]
  v_pk_fma_f32 v[78:79], v[78:79], v[166:167], v[236:237]
  v_pk_fma_f32 v[82:83], v[82:83], v[168:169], v[236:237]
  v_pk_fma_f32 v[84:85], v[84:85], v[170:171], v[236:237]
  v_exp_f32 v64, v64 clamp
  v_exp_f32 v65, v65 clamp
  v_exp_f32 v66, v66 clamp
  v_exp_f32 v67, v67 clamp
  v_exp_f32 v70, v70 clamp
  v_exp_f32 v71, v71 clamp
  v_exp_f32 v72, v72 clamp
  v_exp_f32 v73, v73 clamp
  v_exp_f32 v76, v76 clamp
  v_exp_f32 v77, v77 clamp
  v_exp_f32 v78, v78 clamp
  v_exp_f32 v79, v79 clamp
  v_exp_f32 v82, v82 clamp
  v_exp_f32 v83, v83 clamp
  v_exp_f32 v84, v84 clamp
  v_exp_f32 v85, v85 clamp
  v_pk_fma_f32 v[64:65], v[64:65], v[136:137], v[116:117]
  v_pk_fma_f32 v[66:67], v[66:67], v[138:139], v[118:119]
  v_pk_fma_f32 v[70:71], v[70:71], v[136:137], v[116:117]
  v_pk_fma_f32 v[72:73], v[72:73], v[138:139], v[118:119]
  v_pk_fma_f32 v[76:77], v[76:77], v[136:137], v[116:117]
  v_pk_fma_f32 v[78:79], v[78:79], v[138:139], v[118:119]
  v_pk_fma_f32 v[82:83], v[82:83], v[136:137], v[116:117]
  v_pk_fma_f32 v[84:85], v[84:85], v[138:139], v[118:119]
  v_pk_mul_f32 v[68:69], v[156:157], v[66:67]
  v_pk_mul_f32 v[74:75], v[160:161], v[72:73]
  v_pk_mul_f32 v[80:81], v[164:165], v[78:79]
  v_pk_mul_f32 v[86:87], v[168:169], v[84:85]
  v_pk_fma_f32 v[68:69], v[158:159], v[64:65], v[68:69]
  v_pk_fma_f32 v[74:75], v[162:163], v[70:71], v[74:75]
  v_pk_fma_f32 v[80:81], v[166:167], v[76:77], v[80:81]
  v_pk_fma_f32 v[86:87], v[170:171], v[82:83], v[86:87]
  v_pk_mul_f32 v[64:65], v[64:65], v[66:67]
  v_pk_mul_f32 v[70:71], v[70:71], v[72:73]
  v_pk_mul_f32 v[76:77], v[76:77], v[78:79]
  v_pk_mul_f32 v[82:83], v[82:83], v[84:85]
  v_rcp_f32 v64, v64
  v_rcp_f32 v65, v65
  v_rcp_f32 v70, v70
  v_rcp_f32 v71, v71
  v_rcp_f32 v76, v76
  v_rcp_f32 v77, v77
  v_rcp_f32 v82, v82
  v_rcp_f32 v83, v83
  v_pk_fma_f32 v[16:17], v[64:65], v[68:69], v[16:17]
  v_pk_fma_f32 v[18:19], v[70:71], v[74:75], v[18:19]
  v_pk_fma_f32 v[20:21], v[76:77], v[80:81], v[20:21]
  v_pk_fma_f32 v[22:23], v[82:83], v[86:87], v[22:23]
  v_pk_mul_f32 v[40:41], v[172:173], v[172:173]
  v_pk_mul_f32 v[42:43], v[174:175], v[174:175]
  v_pk_mul_f32 v[46:47], v[176:177], v[176:177]
  v_pk_mul_f32 v[48:49], v[178:179], v[178:179]
  v_pk_mul_f32 v[52:53], v[180:181], v[180:181]
  v_pk_mul_f32 v[54:55], v[182:183], v[182:183]
  v_pk_mul_f32 v[58:59], v[184:185], v[184:185]
  v_pk_mul_f32 v[60:61], v[186:187], v[186:187]
  v_pk_fma_f32 v[40:41], v[40:41], v[234:235], v[232:233]
  v_pk_fma_f32 v[42:43], v[42:43], v[234:235], v[232:233]
  v_pk_fma_f32 v[46:47], v[46:47], v[234:235], v[232:233]
  v_pk_fma_f32 v[48:49], v[48:49], v[234:235], v[232:233]
  v_pk_fma_f32 v[52:53], v[52:53], v[234:235], v[232:233]
  v_pk_fma_f32 v[54:55], v[54:55], v[234:235], v[232:233]
  v_pk_fma_f32 v[58:59], v[58:59], v[234:235], v[232:233]
  v_pk_fma_f32 v[60:61], v[60:61], v[234:235], v[232:233]
  v_pk_fma_f32 v[40:41], v[40:41], v[172:173], v[236:237]
  v_pk_fma_f32 v[42:43], v[42:43], v[174:175], v[236:237]
  v_pk_fma_f32 v[46:47], v[46:47], v[176:177], v[236:237]
  v_pk_fma_f32 v[48:49], v[48:49], v[178:179], v[236:237]
  v_pk_fma_f32 v[52:53], v[52:53], v[180:181], v[236:237]
  v_pk_fma_f32 v[54:55], v[54:55], v[182:183], v[236:237]
  v_pk_fma_f32 v[58:59], v[58:59], v[184:185], v[236:237]
  v_pk_fma_f32 v[60:61], v[60:61], v[186:187], v[236:237]
  v_exp_f32 v40, v40 clamp
  v_exp_f32 v41, v41 clamp
  v_exp_f32 v42, v42 clamp
  v_exp_f32 v43, v43 clamp
  v_exp_f32 v46, v46 clamp
  v_exp_f32 v47, v47 clamp
  v_exp_f32 v48, v48 clamp
  v_exp_f32 v49, v49 clamp
  v_exp_f32 v52, v52 clamp
  v_exp_f32 v53, v53 clamp
  v_exp_f32 v54, v54 clamp
  v_exp_f32 v55, v55 clamp
  v_exp_f32 v58, v58 clamp
  v_exp_f32 v59, v59 clamp
  v_exp_f32 v60, v60 clamp
  v_exp_f32 v61, v61 clamp
  v_pk_fma_f32 v[40:41], v[40:41], v[220:221], v[120:121]
  v_pk_fma_f32 v[42:43], v[42:43], v[222:223], v[122:123]
  v_pk_fma_f32 v[46:47], v[46:47], v[220:221], v[120:121]
  v_pk_fma_f32 v[48:49], v[48:49], v[222:223], v[122:123]
  v_pk_fma_f32 v[52:53], v[52:53], v[220:221], v[120:121]
  v_pk_fma_f32 v[54:55], v[54:55], v[222:223], v[122:123]
  v_pk_fma_f32 v[58:59], v[58:59], v[220:221], v[120:121]
  v_pk_fma_f32 v[60:61], v[60:61], v[222:223], v[122:123]
  v_pk_mul_f32 v[44:45], v[172:173], v[42:43]
  v_pk_mul_f32 v[50:51], v[176:177], v[48:49]
  v_pk_mul_f32 v[56:57], v[180:181], v[54:55]
  v_pk_mul_f32 v[62:63], v[184:185], v[60:61]
  v_pk_fma_f32 v[44:45], v[174:175], v[40:41], v[44:45]
  v_pk_fma_f32 v[50:51], v[178:179], v[46:47], v[50:51]
  v_pk_fma_f32 v[56:57], v[182:183], v[52:53], v[56:57]
  v_pk_fma_f32 v[62:63], v[186:187], v[58:59], v[62:63]
  v_pk_mul_f32 v[40:41], v[40:41], v[42:43]
  v_pk_mul_f32 v[46:47], v[46:47], v[48:49]
  v_pk_mul_f32 v[52:53], v[52:53], v[54:55]
  v_pk_mul_f32 v[58:59], v[58:59], v[60:61]
  v_rcp_f32 v40, v40
  v_rcp_f32 v41, v41
  v_rcp_f32 v46, v46
  v_rcp_f32 v47, v47
  v_rcp_f32 v52, v52
  v_rcp_f32 v53, v53
  v_rcp_f32 v58, v58
  v_rcp_f32 v59, v59
  v_pk_fma_f32 v[16:17], v[40:41], v[44:45], v[16:17]
  v_pk_fma_f32 v[18:19], v[46:47], v[50:51], v[18:19]
  v_pk_fma_f32 v[20:21], v[52:53], v[56:57], v[20:21]
  v_pk_fma_f32 v[22:23], v[58:59], v[62:63], v[22:23]
  v_pk_mul_f32 v[64:65], v[188:189], v[188:189]
  v_pk_mul_f32 v[66:67], v[190:191], v[190:191]
  v_pk_mul_f32 v[70:71], v[192:193], v[192:193]
  v_pk_mul_f32 v[72:73], v[194:195], v[194:195]
  v_pk_mul_f32 v[76:77], v[196:197], v[196:197]
  v_pk_mul_f32 v[78:79], v[198:199], v[198:199]
  v_pk_mul_f32 v[82:83], v[200:201], v[200:201]
  v_pk_mul_f32 v[84:85], v[202:203], v[202:203]
  v_pk_fma_f32 v[64:65], v[64:65], v[234:235], v[232:233]
  v_pk_fma_f32 v[66:67], v[66:67], v[234:235], v[232:233]
  v_pk_fma_f32 v[70:71], v[70:71], v[234:235], v[232:233]
  v_pk_fma_f32 v[72:73], v[72:73], v[234:235], v[232:233]
  v_pk_fma_f32 v[76:77], v[76:77], v[234:235], v[232:233]
  v_pk_fma_f32 v[78:79], v[78:79], v[234:235], v[232:233]
  v_pk_fma_f32 v[82:83], v[82:83], v[234:235], v[232:233]
  v_pk_fma_f32 v[84:85], v[84:85], v[234:235], v[232:233]
  v_pk_fma_f32 v[64:65], v[64:65], v[188:189], v[236:237]
  v_pk_fma_f32 v[66:67], v[66:67], v[190:191], v[236:237]
  v_pk_fma_f32 v[70:71], v[70:71], v[192:193], v[236:237]
  v_pk_fma_f32 v[72:73], v[72:73], v[194:195], v[236:237]
  v_pk_fma_f32 v[76:77], v[76:77], v[196:197], v[236:237]
  v_pk_fma_f32 v[78:79], v[78:79], v[198:199], v[236:237]
  v_pk_fma_f32 v[82:83], v[82:83], v[200:201], v[236:237]
  v_pk_fma_f32 v[84:85], v[84:85], v[202:203], v[236:237]
  v_exp_f32 v64, v64 clamp
  v_exp_f32 v65, v65 clamp
  v_exp_f32 v66, v66 clamp
  v_exp_f32 v67, v67 clamp
  v_exp_f32 v70, v70 clamp
  v_exp_f32 v71, v71 clamp
  v_exp_f32 v72, v72 clamp
  v_exp_f32 v73, v73 clamp
  v_exp_f32 v76, v76 clamp
  v_exp_f32 v77, v77 clamp
  v_exp_f32 v78, v78 clamp
  v_exp_f32 v79, v79 clamp
  v_exp_f32 v82, v82 clamp
  v_exp_f32 v83, v83 clamp
  v_exp_f32 v84, v84 clamp
  v_exp_f32 v85, v85 clamp
  v_pk_fma_f32 v[64:65], v[64:65], v[224:225], v[124:125]
  v_pk_fma_f32 v[66:67], v[66:67], v[226:227], v[126:127]
  v_pk_fma_f32 v[70:71], v[70:71], v[224:225], v[124:125]
  v_pk_fma_f32 v[72:73], v[72:73], v[226:227], v[126:127]
  v_pk_fma_f32 v[76:77], v[76:77], v[224:225], v[124:125]
  v_pk_fma_f32 v[78:79], v[78:79], v[226:227], v[126:127]
  v_pk_fma_f32 v[82:83], v[82:83], v[224:225], v[124:125]
  v_pk_fma_f32 v[84:85], v[84:85], v[226:227], v[126:127]
  v_pk_mul_f32 v[68:69], v[188:189], v[66:67]
  v_pk_mul_f32 v[74:75], v[192:193], v[72:73]
  v_pk_mul_f32 v[80:81], v[196:197], v[78:79]
  v_pk_mul_f32 v[86:87], v[200:201], v[84:85]
  v_pk_fma_f32 v[68:69], v[190:191], v[64:65], v[68:69]
  v_pk_fma_f32 v[74:75], v[194:195], v[70:71], v[74:75]
  v_pk_fma_f32 v[80:81], v[198:199], v[76:77], v[80:81]
  v_pk_fma_f32 v[86:87], v[202:203], v[82:83], v[86:87]
  v_pk_mul_f32 v[64:65], v[64:65], v[66:67]
  v_pk_mul_f32 v[70:71], v[70:71], v[72:73]
  v_pk_mul_f32 v[76:77], v[76:77], v[78:79]
  v_pk_mul_f32 v[82:83], v[82:83], v[84:85]
  v_rcp_f32 v64, v64
  v_rcp_f32 v65, v65
  v_rcp_f32 v70, v70
  v_rcp_f32 v71, v71
  v_rcp_f32 v76, v76
  v_rcp_f32 v77, v77
  v_rcp_f32 v82, v82
  v_rcp_f32 v83, v83
  v_pk_fma_f32 v[16:17], v[64:65], v[68:69], v[16:17]
  v_pk_fma_f32 v[18:19], v[70:71], v[74:75], v[18:19]
  v_pk_fma_f32 v[20:21], v[76:77], v[80:81], v[20:21]
  v_pk_fma_f32 v[22:23], v[82:83], v[86:87], v[22:23]
  v_pk_mul_f32 v[40:41], v[204:205], v[204:205]
  v_pk_mul_f32 v[42:43], v[206:207], v[206:207]
  v_pk_mul_f32 v[46:47], v[208:209], v[208:209]
  v_pk_mul_f32 v[48:49], v[210:211], v[210:211]
  v_pk_mul_f32 v[52:53], v[212:213], v[212:213]
  v_pk_mul_f32 v[54:55], v[214:215], v[214:215]
  v_pk_mul_f32 v[58:59], v[216:217], v[216:217]
  v_pk_mul_f32 v[60:61], v[218:219], v[218:219]
  v_pk_fma_f32 v[40:41], v[40:41], v[234:235], v[232:233]
  v_pk_fma_f32 v[42:43], v[42:43], v[234:235], v[232:233]
  v_pk_fma_f32 v[46:47], v[46:47], v[234:235], v[232:233]
  v_pk_fma_f32 v[48:49], v[48:49], v[234:235], v[232:233]
  v_pk_fma_f32 v[52:53], v[52:53], v[234:235], v[232:233]
  v_pk_fma_f32 v[54:55], v[54:55], v[234:235], v[232:233]
  v_pk_fma_f32 v[58:59], v[58:59], v[234:235], v[232:233]
  v_pk_fma_f32 v[60:61], v[60:61], v[234:235], v[232:233]
  v_pk_fma_f32 v[40:41], v[40:41], v[204:205], v[236:237]
  v_pk_fma_f32 v[42:43], v[42:43], v[206:207], v[236:237]
  v_pk_fma_f32 v[46:47], v[46:47], v[208:209], v[236:237]
  v_pk_fma_f32 v[48:49], v[48:49], v[210:211], v[236:237]
  v_pk_fma_f32 v[52:53], v[52:53], v[212:213], v[236:237]
  v_pk_fma_f32 v[54:55], v[54:55], v[214:215], v[236:237]
  v_pk_fma_f32 v[58:59], v[58:59], v[216:217], v[236:237]
  v_pk_fma_f32 v[60:61], v[60:61], v[218:219], v[236:237]
  v_exp_f32 v40, v40 clamp
  v_exp_f32 v41, v41 clamp
  v_exp_f32 v42, v42 clamp
  v_exp_f32 v43, v43 clamp
  v_exp_f32 v46, v46 clamp
  v_exp_f32 v47, v47 clamp
  v_exp_f32 v48, v48 clamp
  v_exp_f32 v49, v49 clamp
  v_exp_f32 v52, v52 clamp
  v_exp_f32 v53, v53 clamp
  v_exp_f32 v54, v54 clamp
  v_exp_f32 v55, v55 clamp
  v_exp_f32 v58, v58 clamp
  v_exp_f32 v59, v59 clamp
  v_exp_f32 v60, v60 clamp
  v_exp_f32 v61, v61 clamp
  v_pk_fma_f32 v[40:41], v[40:41], v[228:229], v[128:129]
  v_pk_fma_f32 v[42:43], v[42:43], v[230:231], v[130:131]
  v_pk_fma_f32 v[46:47], v[46:47], v[228:229], v[128:129]
  v_pk_fma_f32 v[48:49], v[48:49], v[230:231], v[130:131]
  v_pk_fma_f32 v[52:53], v[52:53], v[228:229], v[128:129]
  v_pk_fma_f32 v[54:55], v[54:55], v[230:231], v[130:131]
  v_pk_fma_f32 v[58:59], v[58:59], v[228:229], v[128:129]
  v_pk_fma_f32 v[60:61], v[60:61], v[230:231], v[130:131]
  v_pk_mul_f32 v[44:45], v[204:205], v[42:43]
  v_pk_mul_f32 v[50:51], v[208:209], v[48:49]
  v_pk_mul_f32 v[56:57], v[212:213], v[54:55]
  v_pk_mul_f32 v[62:63], v[216:217], v[60:61]
  v_pk_fma_f32 v[44:45], v[206:207], v[40:41], v[44:45]
  v_pk_fma_f32 v[50:51], v[210:211], v[46:47], v[50:51]
  v_pk_fma_f32 v[56:57], v[214:215], v[52:53], v[56:57]
  v_pk_fma_f32 v[62:63], v[218:219], v[58:59], v[62:63]
  v_pk_mul_f32 v[40:41], v[40:41], v[42:43]
  v_pk_mul_f32 v[46:47], v[46:47], v[48:49]
  v_pk_mul_f32 v[52:53], v[52:53], v[54:55]
  v_pk_mul_f32 v[58:59], v[58:59], v[60:61]
  v_rcp_f32 v40, v40
  v_rcp_f32 v41, v41
  v_rcp_f32 v46, v46
  v_rcp_f32 v47, v47
  v_rcp_f32 v52, v52
  v_rcp_f32 v53, v53
  v_rcp_f32 v58, v58
  v_rcp_f32 v59, v59
  v_pk_fma_f32 v[16:17], v[40:41], v[44:45], v[16:17]
  v_pk_fma_f32 v[18:19], v[46:47], v[50:51], v[18:19]
  v_pk_fma_f32 v[20:21], v[52:53], v[56:57], v[20:21]
  v_pk_fma_f32 v[22:23], v[58:59], v[62:63], v[22:23]
  v_add_f32 v16, v16, v17
  v_add_f32 v18, v18, v19
  v_add_f32 v20, v20, v21
  v_add_f32 v22, v22, v23
  v_mul_f32 v16, v239, v16
  v_mul_f32 v18, v239, v18
  v_mul_f32 v20, v239, v20
  v_mul_f32 v22, v239, v22
  s_nop 0
  v_permlane32_swap_b32 v16, v20
  v_permlane32_swap_b32 v18, v22
  v_add_f32 v16, v16, v20
  v_add_f32 v18, v18, v22
  s_nop 1
  v_permlane16_swap_b32 v16, v18
  v_add_f32 v16, v16, v18
  ds_write_b32 v36, v16
  s_waitcnt lgkmcnt(0)
  s_cmp_eq_u32 s3, 0
  s_cbranch_scc1 L_dpub
  s_barrier
  s_endpgm
L_dpub:
  s_mov_b32 s60, s24
  s_and_b32 s61, s25, 0xffff
  s_mov_b32 s62, 268435456
  s_mov_b32 s63, 0x20000
  s_mov_b32 s64, s22
  s_and_b32 s65, s23, 0xffff
  s_mov_b32 s66, 256
  s_mov_b32 s67, 0x20000
  s_and_b32 s81, s2, 7
  s_waitcnt vmcnt(0)
  v_cmp_eq_u32 vcc, 0, v37
  s_nop 0
  s_bitcmp1_b32 vcc_lo, s81
  s_cbranch_scc0 L_dclr_ok
  s_mov_b32 s78, 0x40000
L_dclr:
  s_sub_u32 s78, s78, 1
  s_cbranch_scc1 L_dclr_ok
  v_lshlrev_b32 v37, 2, v0
  v_and_b32 v37, 31, v37
  buffer_load_dword v37, v37, s[64:67], 0 offen offset:128 sc1
  s_waitcnt vmcnt(0)
  v_cmp_eq_u32 vcc, 0, v37
  s_nop 0
  s_bitcmp1_b32 vcc_lo, s81
  s_cbranch_scc1 L_dclr
L_dclr_ok:
  s_barrier
  ds_read_b64 v[64:65], v2 offset:0
  ds_read_b64 v[66:67], v2 offset:512
  ds_read_b64 v[68:69], v2 offset:1024
  ds_read_b64 v[70:71], v2 offset:1536
  s_waitcnt lgkmcnt(2)
  v_pk_add_f32 v[64:65], v[64:65], v[66:67]
  s_waitcnt lgkmcnt(0)
  v_pk_add_f32 v[68:69], v[68:69], v[70:71]
  v_pk_add_f32 v[64:65], v[64:65], v[68:69]
  v_and_b32 v64, -2, v64
  v_and_b32 v65, -2, v65
  buffer_store_dwordx2 v[64:65], v3, s[60:63], s69 offen sc1
  s_endpgm
L_cin:
  s_and_b32 s68, s26, 3
  s_mul_i32 s68, s68, 3
  s_add_u32 s27, s68, s27
  s_sub_u32 s27, s27, 6
  s_and_b32 s79, s3, 3
  s_lshr_b32 s84, s3, 2
  s_lshl_b32 s100, s27, 3
  s_add_u32 s100, s100, s3
  s_mul_i32 s68, s100, 1280
  v_min_u32 v40, 9, v0
  v_lshlrev_b32 v40, 7, v40
  v_lshlrev_b32 v48, 4, v0
  s_lshl_b32 s95, s79, 10
  s_cmp_eq_u32 s79, 2
  s_cselect_b64 s[82:83], 0x3fffff, -1
  s_cmp_eq_u32 s79, 3
  s_cselect_b32 s96, 0, 32768
  s_add_u32 s96, s96, s95
  v_mov_b32 v2, 110464
  v_lshlrev_b32 v1, 20, v0
  v_add_u32 v1, 110464, v1
  v_and_b32 v44, 7, v0
  v_lshlrev_b32 v18, 4, v44
  v_and_b32 v44, 15, v0
  v_lshl_add_u32 v44, v44, 2, v2
  v_mov_b32 v3, 0
  ds_write_b32 v44, v3
  v_lshrrev_b32 v41, 5, v0
  v_and_b32 v42, 31, v0
  s_waitcnt lgkmcnt(0)
  v_mov_b32 v3, 1
  s_mov_b32 s36, s8
  s_and_b32 s37, s9, 0xffff
  s_mov_b32 s38, 105456
  s_mov_b32 s39, 0x20000
  buffer_load_dword v255, v40, s[36:39], s68 offen
  s_barrier
  v_add_u32 v248, s95, v48
  v_cmp_gt_u32 vcc, 1152, v248
  s_nop 1
  v_cndmask_b32 v248, 0, 4, vcc
  v_add_u32 v248, v248, v48
  s_cmp_lg_u32 s84, 0
  s_cbranch_scc1 L_g1a
  s_mov_b32 s40, s10
  s_and_b32 s41, s11, 0xffff
  s_mov_b32 s42, 156
  s_mov_b32 s43, 0x20000
  s_mov_b32 m0, 110272
  s_mov_b64 exec, 0x7ff
  buffer_load_dwordx4 v48, s[40:43], 0 offen lds
  s_mov_b64 exec, -1
  s_add_u32 m0, s95, 71552
  s_add_u32 s81, s95, 70304
  buffer_load_dwordx4 v48, s[36:39], s81 offen lds
  s_add_u32 m0, s95, 75648
  s_add_u32 s81, s95, 74400
  buffer_load_dwordx4 v48, s[36:39], s81 offen lds
  s_add_u32 m0, s95, 79744
  s_add_u32 s81, s95, 78496
  buffer_load_dwordx4 v48, s[36:39], s81 offen lds
  s_add_u32 m0, s95, 83840
  s_add_u32 s81, s95, 82592
  buffer_load_dwordx4 v48, s[36:39], s81 offen lds
  s_add_u32 m0, s95, 87936
  s_add_u32 s81, s95, 86688
  buffer_load_dwordx4 v48, s[36:39], s81 offen lds
  s_add_u32 m0, s95, 92032
  s_add_u32 s81, s95, 90784
  buffer_load_dwordx4 v48, s[36:39], s81 offen lds
  s_add_u32 m0, s95, 96128
  s_add_u32 s81, s95, 94880
  buffer_load_dwordx4 v48, s[36:39], s81 offen lds
  s_add_u32 m0, s95, 100224
  s_add_u32 s81, s95, 98976
  buffer_load_dwordx4 v48, s[36:39], s81 offen lds
  s_add_u32 m0, s96, 71552
  s_add_u32 s81, s96, 70304
  s_mov_b64 exec, s[82:83]
  buffer_load_dwordx4 v48, s[36:39], s81 offen lds
  s_mov_b64 exec, -1
  s_add_u32 m0, s95, 36288
  s_add_u32 s81, s95, 35152
  buffer_load_dwordx4 v48, s[36:39], s81 offen lds
  s_add_u32 m0, s95, 40384
  s_add_u32 s81, s95, 39248
  buffer_load_dwordx4 v48, s[36:39], s81 offen lds
  s_add_u32 m0, s95, 44480
  s_add_u32 s81, s95, 43344
  buffer_load_dwordx4 v48, s[36:39], s81 offen lds
  s_add_u32 m0, s95, 48576
  s_add_u32 s81, s95, 47440
  buffer_load_dwordx4 v48, s[36:39], s81 offen lds
  s_add_u32 m0, s95, 52672
  s_add_u32 s81, s95, 51536
  buffer_load_dwordx4 v48, s[36:39], s81 offen lds
  s_add_u32 m0, s95, 56768
  s_add_u32 s81, s95, 55632
  buffer_load_dwordx4 v48, s[36:39], s81 offen lds
  s_waitcnt vmcnt(6) lgkmcnt(0)
  ds_add_u32 v1, v3 offset:0
  s_add_u32 m0, s95, 60864
  s_add_u32 s81, s95, 59728
  buffer_load_dwordx4 v48, s[36:39], s81 offen lds
  s_add_u32 m0, s95, 64960
  s_add_u32 s81, s95, 63824
  buffer_load_dwordx4 v48, s[36:39], s81 offen lds
  s_add_u32 m0, s96, 36288
  s_add_u32 s81, s96, 35152
  s_mov_b64 exec, s[82:83]
  buffer_load_dwordx4 v48, s[36:39], s81 offen lds
  s_mov_b64 exec, -1
  s_add_u32 m0, s95, 1024
  s_add_u32 s81, s95, 0
  buffer_load_dwordx4 v48, s[36:39], s81 offen lds
  s_add_u32 m0, s95, 5120
  s_add_u32 s81, s95, 4096
  buffer_load_dwordx4 v48, s[36:39], s81 offen lds
  s_add_u32 m0, s95, 9216
  s_add_u32 s81, s95, 8192
  buffer_load_dwordx4 v48, s[36:39], s81 offen lds
  s_add_u32 m0, s95, 13312
  s_add_u32 s81, s95, 12288
  buffer_load_dwordx4 v48, s[36:39], s81 offen lds
  s_add_u32 m0, s95, 17408
  s_add_u32 s81, s95, 16384
  buffer_load_dwordx4 v48, s[36:39], s81 offen lds
  s_add_u32 m0, s95, 21504
  s_add_u32 s81, s95, 20476
  buffer_load_dwordx4 v248, s[36:39], s81 offen lds
  s_waitcnt vmcnt(6) lgkmcnt(0)
  ds_add_u32 v1, v3 offset:4
  s_add_u32 m0, s95, 25600
  s_add_u32 s81, s95, 24572
  buffer_load_dwordx4 v48, s[36:39], s81 offen lds
  s_add_u32 m0, s95, 29696
  s_add_u32 s81, s95, 28668
  buffer_load_dwordx4 v48, s[36:39], s81 offen lds
  s_add_u32 m0, s96, 1024
  s_lshr_b32 s81, s96, 13
  s_sub_u32 s81, s96, s81
  s_mov_b64 exec, s[82:83]
  buffer_load_dwordx4 v48, s[36:39], s81 offen lds
  s_mov_b64 exec, -1
  s_branch L_addrc
L_g1a:
  s_setprio 1
  v_bfe_u32 v43, v0, 2, 2
  v_lshl_add_u32 v43, v41, 3, v43
  v_bfe_u32 v44, v0, 4, 1
  v_lshlrev_b32 v44, 5, v44
  v_and_b32 v45, 3, v0
  v_lshl_add_u32 v44, v45, 3, v44
  v_lshl_add_u32 v240, v43, 6, v44
  v_add_u32 v240, 106816, v240
  s_lshl_b32 s68, s79, 6
  s_add_u32 s68, s68, 36288
  v_add_u32 v44, s68, v44
  v_mul_u32_u24 v45, 1352, v43
  v_add_u32 v241, v44, v45
  v_add_u32 v45, 16, v43
  v_min_u32 v45, 25, v45
  v_mul_u32_u24 v45, 1352, v45
  v_add_u32 v242, v44, v45
  v_add_u32 v45, 20, v43
  v_min_u32 v45, 25, v45
  v_mul_u32_u24 v45, 1352, v45
  v_add_u32 v243, v44, v45
  s_lshl_b32 s68, s79, 5
  v_add_u32 v246, s68, v42
  v_mul_u32_u24 v43, 52, v246
  v_lshl_add_u32 v43, v41, 3, v43
  v_add_u32 v244, 71552, v43
  v_lshlrev_b32 v43, 1, v246
  v_add_u32 v245, 108864, v43
  v_mov_b32 v216, 0
  v_mov_b32 v217, 0
  v_lshlrev_b32 v43, 3, v0
  v_add_u32 v44, 106816, v43
  s_lshl_b32 s68, s79, 9
  v_add_u32 v44, s68, v44
  ds_write_b64 v44, v[216:217]
  v_lshl_add_u32 v43, v41, 7, v246
  s_mov_b32 s69, 2521
  s_mov_b32 s70, 106816
  v_mul_u32_u24 v44, s69, v43
  v_lshrrev_b32 v44, 16, v44
  v_mad_u32_u24 v44, v44, 12, s70
  v_lshl_add_u32 v68, v43, 1, v44
  v_add_u32 v43, 256, v43
  v_mul_u32_u24 v44, s69, v43
  v_lshrrev_b32 v44, 16, v44
  v_mad_u32_u24 v44, v44, 12, s70
  v_lshl_add_u32 v69, v43, 1, v44
  v_add_u32 v43, 256, v43
  v_mul_u32_u24 v44, s69, v43
  v_lshrrev_b32 v44, 16, v44
  v_mad_u32_u24 v44, v44, 12, s70
  v_lshl_add_u32 v70, v43, 1, v44
  v_mov_b32 v44, 676
  v_cmp_gt_u32 s[92:93], v44, v43
  v_add_u32 v43, 0, v246
  v_mul_u32_u24 v44, s69, v43
  v_lshrrev_b32 v44, 16, v44
  v_lshl_add_u32 v44, v44, 2, v244
  v_add_u32 v72, 0, v44
  v_add_u32 v43, 128, v246
  v_mul_u32_u24 v44, s69, v43
  v_lshrrev_b32 v44, 16, v44
  v_lshl_add_u32 v44, v44, 2, v244
  v_add_u32 v73, 6656, v44
  v_add_u32 v43, 256, v246
  v_mul_u32_u24 v44, s69, v43
  v_lshrrev_b32 v44, 16, v44
  v_lshl_add_u32 v44, v44, 2, v244
  v_add_u32 v74, 13312, v44
  v_add_u32 v43, 384, v246
  v_mul_u32_u24 v44, s69, v43
  v_lshrrev_b32 v44, 16, v44
  v_lshl_add_u32 v44, v44, 2, v244
  v_add_u32 v75, 19968, v44
  v_add_u32 v43, 512, v246
  v_mul_u32_u24 v44, s69, v43
  v_lshrrev_b32 v44, 16, v44
  v_lshl_add_u32 v44, v44, 2, v244
  v_add_u32 v76, 26624, v44
  v_add_u32 v43, 640, v246
  v_mul_u32_u24 v44, s69, v43
  v_lshrrev_b32 v44, 16, v44
  v_lshl_add_u32 v44, v44, 2, v244
  v_add_u32 v77, 33280, v44
  v_lshlrev_b32 v78, 4, v41
  v_add_u32 v78, 110376, v78
  v_lshlrev_b32 v79, 1, v0
  v_add_u32 v79, 110272, v79
  v_lshlrev_b32 v80, 6, v0
  v_add_u32 v80, 106868, v80
L_addrc:
  s_mul_i32 s69, s27, 2979
  s_lshr_b32 s69, s69, 6
  s_mul_i32 s98, s27, 44
  s_and_b32 s70, s2, 7
  s_add_u32 s85, s98, s3
  s_lshl_b32 s85, s85, 2
  s_lshl_b32 s98, s70, 14
  s_add_u32 s85, s85, s98
  s_add_u32 s85, s85, 10240
  s_mul_i32 s98, s27, 44
  s_lshl_b32 s77, s70, 9
  s_add_u32 s94, s77, s98
  s_add_u32 s77, s77, s69
  s_add_u32 s94, s94, s3
  s_mul_i32 s94, s94, 104
  s_lshl_b32 s98, s27, 2
  s_add_u32 s98, s98, s3
  s_add_u32 s98, s98, s70
  s_and_b32 s98, s98, 7
  s_mul_i32 s98, s98, 16640
  s_add_u32 s98, s98, 12288
  s_sub_u32 s72, 6, s84
  s_lshl_b32 s99, s84, 1
  s_mov_b32 s26, -1
  v_lshrrev_b32 v43, 3, v0
  v_min_u32 v43, 6, v43
  v_lshlrev_b32 v17, 4, v43
  s_mul_i32 s70, s70, 88
  s_add_u32 s70, s100, s70
  s_mov_b32 s71, 704
  v_mov_b32 v44, s70
  v_mad_u32_u24 v19, v0, s71, v44
  s_mul_i32 s70, s100, 104
  s_sub_u32 s70, s70, 313
  v_min_u32 v44, 16, v0
  v_mul_u32_u24 v45, 26, v44
  v_add_u32 v45, s70, v45
  v_cmp_lt_u32 vcc, 12, v44
  s_nop 1
  v_cndmask_b32 v19, v19, v45, vcc
  v_lshlrev_b32 v19, 7, v19
  s_mov_b32 s101, 638976
  s_mov_b32 s32, s6
  s_and_b32 s33, s7, 0xffff
  s_mov_b32 s34, 12800000
  s_mov_b32 s35, 0x20000
  s_mov_b32 s44, s12
  s_and_b32 s45, s13, 0xffff
  s_mov_b32 s46, 5537792
  s_mov_b32 s47, 0x20000
  s_mov_b32 s28, s4
  s_and_b32 s29, s5, 0xffff
  s_mov_b32 s30, 425984
  s_mov_b32 s31, 0x20000
  s_and_b32 s70, s3, 1
  s_lshl_b32 s70, s70, 1
  v_add_u32 v46, s70, v41
  v_min_u32 v43, 25, v42
  s_mul_i32 s68, s84, 4
  s_add_u32 s68, s68, 1352
  s_mul_i32 s69, s84, 70528
  s_add_u32 s69, s69, 1024
  v_mul_u32_u24 v44, s68, v43
  v_add_u32 v44, s69, v44
  v_lshlrev_b32 v247, 2, v43
  v_add_u32 v247, 70528, v247
  s_lshl_b32 s68, s84, 2
  s_xor_b32 s68, s68, 4
  v_lshrrev_b32 v45, 2, v43
  v_and_b32 v45, s68, v45
  v_add_u32 v44, v44, v45
  v_sub_u32 v247, v247, v45
  v_mul_u32_u24 v65, 52, v43
  v_lshl_add_u32 v65, v46, 1, v65
  v_add_u32 v65, 108864, v65
  v_lshlrev_b32 v67, 1, v43
  v_add_u32 v67, 110272, v67
  v_mad_u32_u24 v60, v46, 52, v44
  v_lshl_add_u32 v61, v46, 1, v44
  v_lshl_add_u32 v49, v46, 1, v60
  v_lshlrev_b32 v43, 3, v46
  s_mov_b32 s68, 0x01000100
  v_bfe_i32 v45, s68, v43, 8
  v_lshl_add_u32 v50, v45, 1, v60
  v_mad_i32_i24 v51, v45, 52, v61
  s_mov_b32 s68, 0xff00ff00
  v_bfe_i32 v45, s68, v43, 8
  v_lshl_add_u32 v52, v45, 1, v60
  v_mad_i32_i24 v53, v45, 52, v61
  s_mov_b32 s68, 0xff020100
  v_bfe_i32 v45, s68, v43, 8
  v_lshl_add_u32 v54, v45, 1, v60
  v_mad_i32_i24 v55, v45, 52, v61
  s_mov_b32 s68, 0x0b0a0100
  v_bfe_i32 v45, s68, v43, 8
  v_lshl_add_u32 v56, v45, 1, v60
  v_mad_i32_i24 v57, v45, 52, v61
  s_mov_b32 s68, 0xf3f20100
  v_bfe_i32 v45, s68, v43, 8
  v_lshl_add_u32 v58, v45, 1, v60
  v_mad_i32_i24 v59, v45, 52, v61
  s_mov_b32 s68, 0x00023600
  v_bfe_u32 v45, s68, v43, 8
  v_add_u32 v60, v45, v44
  v_add_u32 v61, 52, v44
  v_mov_b32 v47, 1048576
  v_cmp_eq_u32 vcc, 3, v46
  s_nop 1
  v_cndmask_b32 v60, v60, v47, vcc
  v_cndmask_b32 v67, v47, v67, vcc
  v_cmp_eq_u32 vcc, 2, v46
  s_nop 1
  v_cndmask_b32 v61, v47, v61, vcc
  v_cmp_gt_u32 vcc, 2, v46
  s_nop 1
  v_cndmask_b32 v64, v47, v65, vcc
  s_lshr_b32 s69, s79, 1
  s_mul_i32 s69, s69, 6144
  s_mul_i32 s68, s84, 6144
  v_lshlrev_b32 v45, 8, v46
  v_lshl_add_u32 v43, v42, 4, v45
  v_add_u32 v63, 1024, v43
  v_add_u32 v66, 36288, v43
  v_bfe_u32 v43, v0, 2, 2
  v_lshl_add_u32 v45, v43, 4, v45
  v_and_b32 v43, 3, v0
  v_lshl_add_u32 v44, v43, 6, v45
  v_add_u32 v44, 12288, v44
  v_cmp_lt_u32 vcc, 15, v42
  s_nop 1
  v_cndmask_b32 v63, v63, v44, vcc
  v_add_u32 v44, 16, v44
  v_cndmask_b32 v66, v66, v44, vcc
  v_lshl_add_u32 v44, v43, 5, v45
  v_add_u32 v44, 24560, v44
  v_cmp_lt_u32 vcc, 19, v42
  s_nop 1
  v_cndmask_b32 v63, v63, v44, vcc
  v_add_u32 v63, s69, v63
  v_add_u32 v66, s68, v66
  v_cmp_lt_u32 vcc, 25, v42
  s_nop 1
  v_cndmask_b32 v63, v63, v47, vcc
  v_cndmask_b32 v66, v66, v47, vcc
  v_mov_b32 v62, 0
  s_mul_i32 s74, s3, 4224
  s_add_u32 s74, s74, 111040
  s_mov_b32 s75, -39488
  v_add_u32 v28, 1024, v48
  v_and_b32 v43, 11, v0
  v_cmp_eq_u32 vcc, 11, v43
  s_nop 1
  v_cndmask_b32 v31, v28, v47, vcc
  v_and_b32 v43, 3, v0
  v_cmp_eq_u32 vcc, 0, v43
  s_nop 1
  v_cndmask_b32 v30, v31, v47, vcc
  v_lshrrev_b32 v46, 4, v0
  v_bfe_u32 v43, v0, 1, 3
  v_lshlrev_b32 v45, 4, v43
  v_add_u32 v45, 24576, v45
  v_and_b32 v43, 10, v0
  v_cmp_eq_u32 vcc, 10, v43
  s_nop 1
  v_cndmask_b32 v45, v45, v47, vcc
  v_and_b32 v44, 1, v0
  v_lshl_add_u32 v29, v46, 9, v45
  v_lshl_add_u32 v29, v44, 2, v29
  v_add_u32 v29, 1024, v29
  v_lshl_add_u32 v22, v46, 8, v45
  v_lshl_add_u32 v22, v44, 20, v22
  v_and_b32 v47, 15, v0
  s_mov_b32 s68, 1056
  v_lshlrev_b32 v43, 1, v47
  v_add_u32 v43, s74, v43
  v_mad_u32_u24 v7, v46, s68, v43
  s_lshl_b32 s68, s3, 10
  s_add_u32 s68, s68, 144832
  v_add_u32 v10, s68, v48
  v_add_u32 v43, 256, v48
  v_and_b32 v43, 1023, v43
  v_add_u32 v11, s68, v43
  v_xor_b32 v43, 512, v48
  v_add_u32 v12, s68, v43
  v_lshlrev_b32 v13, 4, v41
  v_mov_b32 v32, 0
  v_mov_b32 v33, 0
  v_mov_b32 v34, 0
  v_mov_b32 v35, 0
  v_mov_b32 v36, 0
  v_mov_b32 v37, 0
  v_mov_b32 v38, 0
  v_mov_b32 v39, 0
  v_mov_b32 v216, 0
  v_mov_b32 v217, 0
  v_mov_b32 v218, 0
  v_mov_b32 v219, 0
  v_mov_b32 v220, 0
  v_mov_b32 v221, 0
  v_mov_b32 v222, 0
  v_mov_b32 v223, 0
  v_mov_b32 v224, 0
  v_mov_b32 v225, 0
  v_mov_b32 v226, 0
  v_mov_b32 v227, 0
  v_mov_b32 v228, 0
  v_mov_b32 v229, 0
  v_mov_b32 v230, 0
  v_mov_b32 v231, 0
  v_mov_b32 v232, 0
  v_mov_b32 v233, 0
  v_mov_b32 v234, 0
  v_mov_b32 v235, 0
  v_mov_b32 v236, 0
  v_mov_b32 v237, 0
  v_mov_b32 v238, 0
  v_mov_b32 v239, 0
  v_mul_u32_u24 v44, 1056, v46
  v_bfe_u32 v45, v0, 2, 2
  v_lshl_add_u32 v44, v45, 7, v44
  v_and_b32 v45, 3, v0
  v_lshl_add_u32 v9, v45, 3, v44
  v_add_u32 v8, s74, v9
  v_and_b32 v45, 1, v0
  s_mov_b32 s68, 0xaaaaaaaa
  v_mul_lo_u32 v16, s68, v45
  v_or_b32 v16, 0x44444444, v16
  v_lshlrev_b32 v15, 1, v0
  v_add_u32 v15, s74, v15
  v_mov_b32 v14, 0x3f80
  ds_write_b16 v15, v14 offset:4064
  v_add_u32 v15, s75, v15
  s_mul_i32 s71, s3, 6
  s_add_u32 s77, s77, s71
  s_mul_i32 s77, s77, 104
  s_add_u32 s73, s77, 80
  s_add_u32 s77, s77, 16
  s_mov_b32 s71, 10923
  v_min_u32 v43, 35, v0
  v_mul_u32_u24 v44, s71, v43
  v_lshrrev_b32 v44, 16, v44
  v_mul_u32_u24 v44, 80, v44
  v_lshl_add_u32 v20, v43, 2, v44
  s_cmp_eq_u32 s84, 0
  s_cbranch_scc1 L_g0pf
  s_waitcnt lgkmcnt(0)
  ds_add_u32 v1, v3 offset:0
  s_sub_u32 s94, s94, 416
  buffer_load_dwordx4 v[204:207], v17, s[28:31], s94 offen offset:0
  s_add_u32 s94, s94, 416
  buffer_load_dwordx4 v[24:27], v17, s[28:31], s94 offen offset:0
  s_add_u32 s94, s94, 832
  s_sub_u32 s68, s77, 2496
  buffer_load_dword v208, v20, s[28:31], s68 offen
  buffer_load_dword v209, v20, s[28:31], s77 offen
  s_add_u32 s77, s77, 24
  buffer_load_dword v21, v20, s[28:31], s77 offen
  s_cmp_eq_u32 s77, s73
  s_cselect_b32 s73, 0x7000000, s73
  s_cselect_b32 s77, 0x7000000, s77
  s_add_u32 s77, s77, 24
  s_min_u32 s77, s77, s73
L_csync1:
  ds_read_b32 v4, v2 offset:0
  s_waitcnt lgkmcnt(0)
  v_cmp_gt_u32 vcc, 8, v4
  s_cbranch_vccnz L_csync1
  ds_read_b64 v[132:133], v78 offset:0
  ds_read_b64 v[134:135], v78 offset:8
  ds_read_b64 v[136:137], v78 offset:32
  ds_read_b64 v[138:139], v78 offset:40
  ds_read_u16 v45, v79 offset:52
  ds_read_b64_tr_b16 v[84:85], v241 offset:35264
  ds_read_b64_tr_b16 v[86:87], v241 offset:40672
  ds_read_b64_tr_b16 v[88:89], v242 offset:35264
  ds_read_b64_tr_b16 v[90:91], v243 offset:35264
  ds_read_b64_tr_b16 v[92:93], v241 offset:35520
  ds_read_b64_tr_b16 v[94:95], v241 offset:40928
  ds_read_b64_tr_b16 v[96:97], v242 offset:35520
  ds_read_b64_tr_b16 v[98:99], v243 offset:35520
  ds_read_b64_tr_b16 v[100:101], v241 offset:35776
  ds_read_b64_tr_b16 v[102:103], v241 offset:41184
  ds_read_b64_tr_b16 v[104:105], v242 offset:35776
  ds_read_b64_tr_b16 v[106:107], v243 offset:35776
  ds_read_b64_tr_b16 v[108:109], v241 offset:36032
  ds_read_b64_tr_b16 v[110:111], v241 offset:41440
  ds_read_b64_tr_b16 v[112:113], v242 offset:36032
  ds_read_b64_tr_b16 v[114:115], v243 offset:36032
  s_waitcnt lgkmcnt(14)
  v_mfma_f32_32x32x16_bf16 v[140:155], v[132:135], v[84:87], 0
  s_waitcnt lgkmcnt(12)
  v_mfma_f32_32x32x16_bf16 v[140:155], v[136:139], v[88:91], v[140:155]
  ds_read_b64_tr_b16 v[116:117], v241 offset:36288
  ds_read_b64_tr_b16 v[118:119], v241 offset:41696
  ds_read_b64_tr_b16 v[120:121], v242 offset:36288
  ds_read_b64_tr_b16 v[122:123], v243 offset:36288
  s_waitcnt lgkmcnt(14)
  v_mfma_f32_32x32x16_bf16 v[156:171], v[132:135], v[92:95], 0
  s_waitcnt lgkmcnt(12)
  v_mfma_f32_32x32x16_bf16 v[156:171], v[136:139], v[96:99], v[156:171]
  ds_read_b64_tr_b16 v[124:125], v241 offset:36544
  ds_read_b64_tr_b16 v[126:127], v241 offset:41952
  ds_read_b64_tr_b16 v[128:129], v242 offset:36544
  ds_read_b64_tr_b16 v[130:131], v243 offset:36544
  s_waitcnt lgkmcnt(14)
  v_mfma_f32_32x32x16_bf16 v[172:187], v[132:135], v[100:103], 0
  s_waitcnt lgkmcnt(12)
  v_mfma_f32_32x32x16_bf16 v[172:187], v[136:139], v[104:107], v[172:187]
  v_cvt_pk_bf16_f32 v81, v140, 0
  s_waitcnt lgkmcnt(10)
  v_mfma_f32_32x32x16_bf16 v[188:203], v[132:135], v[108:111], 0
  s_waitcnt lgkmcnt(8)
  v_mfma_f32_32x32x16_bf16 v[188:203], v[136:139], v[112:115], v[188:203]
  s_mov_b32 exec_lo, 0
  v_cvt_pk_bf16_f32 v81, v156, 0
  s_mov_b32 exec_lo, -1
  ds_write_b16 v68, v81
  s_waitcnt lgkmcnt(7)
  v_mfma_f32_32x32x16_bf16 v[140:155], v[132:135], v[116:119], 0
  s_waitcnt lgkmcnt(5)
  v_mfma_f32_32x32x16_bf16 v[140:155], v[136:139], v[120:123], v[140:155]
  v_cvt_pk_bf16_f32 v82, v172, 0
  s_waitcnt lgkmcnt(3)
  v_mfma_f32_32x32x16_bf16 v[156:171], v[132:135], v[124:127], 0
  s_waitcnt lgkmcnt(1)
  v_mfma_f32_32x32x16_bf16 v[156:171], v[136:139], v[128:131], v[156:171]
  s_mov_b32 exec_lo, 0
  v_cvt_pk_bf16_f32 v82, v188, 0
  s_mov_b32 exec_lo, -1
  ds_write_b16 v69, v82
  s_nop 2
  v_cvt_pk_bf16_f32 v83, v140, 0
  s_mov_b32 exec_lo, 0
  s_nop 2
  v_cvt_pk_bf16_f32 v83, v156, 0
  s_mov_b64 exec, s[92:93]
  ds_write_b16 v70, v83
  s_mov_b64 exec, 0x3ffffff
  ds_write_b16 v80, v45
  s_mov_b64 exec, -1
  s_waitcnt lgkmcnt(0)
  ds_add_u32 v1, v3 offset:32
  v_cmp_gt_u32 s[92:93], 36, v246
L_csync2:
  ds_read_b32 v4, v2 offset:4
  s_waitcnt lgkmcnt(0)
  v_cmp_gt_u32 vcc, 4, v4
  s_cbranch_vccnz L_csync2
  ds_read_b64_tr_b16 v[84:85], v241 offset:0
  ds_read_b64_tr_b16 v[86:87], v241 offset:5408
  ds_read_b64_tr_b16 v[88:89], v242 offset:0
  ds_read_b64_tr_b16 v[90:91], v243 offset:0
  ds_read_b64_tr_b16 v[92:93], v241 offset:256
  ds_read_b64_tr_b16 v[94:95], v241 offset:5664
  ds_read_b64_tr_b16 v[96:97], v242 offset:256
  ds_read_b64_tr_b16 v[98:99], v243 offset:256
  ds_read_b64_tr_b16 v[100:101], v241 offset:512
  ds_read_b64_tr_b16 v[102:103], v241 offset:5920
  ds_read_b64_tr_b16 v[104:105], v242 offset:512
  ds_read_b64_tr_b16 v[106:107], v243 offset:512
  ds_read_b64_tr_b16 v[108:109], v241 offset:768
  ds_read_b64_tr_b16 v[110:111], v241 offset:6176
  ds_read_b64_tr_b16 v[112:113], v242 offset:768
  ds_read_b64_tr_b16 v[114:115], v243 offset:768
  ds_read_b64_tr_b16 v[116:117], v241 offset:1024
  ds_read_b64_tr_b16 v[118:119], v241 offset:6432
  ds_read_b64_tr_b16 v[120:121], v242 offset:1024
  ds_read_b64_tr_b16 v[122:123], v243 offset:1024
  ds_read_b64_tr_b16 v[124:125], v241 offset:1280
  ds_read_b64_tr_b16 v[126:127], v241 offset:6688
  ds_read_b64_tr_b16 v[128:129], v242 offset:1280
  ds_read_b64_tr_b16 v[130:131], v243 offset:1280
L_csync3:
  ds_read_b32 v4, v2 offset:32
  s_waitcnt lgkmcnt(0)
  v_cmp_gt_u32 vcc, 4, v4
  s_cbranch_vccnz L_csync3
  s_setprio 0
  s_waitcnt vmcnt(2)
  v_lshlrev_b32 v208, 7, v208
  buffer_load_dword v255, v208, s[32:35], 0 offen
  s_waitcnt vmcnt(2)
  v_lshlrev_b32 v209, 7, v209
  buffer_load_dword v255, v209, s[32:35], 0 offen
  s_mov_b64 exec, 131071
  buffer_load_dword v255, v19, s[44:47], s101 offen
  s_mov_b64 exec, -1
  s_add_u32 s101, s101, 1171456
  ds_read_b64_tr_b16 v[132:133], v240 offset:0
  ds_read_b64_tr_b16 v[134:135], v240 offset:256
  ds_read_b64_tr_b16 v[136:137], v240 offset:1024
  ds_read_b64_tr_b16 v[138:139], v240 offset:1280
  s_waitcnt lgkmcnt(2)
  v_mfma_f32_32x32x16_bf16 v[140:155], v[132:135], v[84:87], 0
  s_waitcnt lgkmcnt(0)
  v_mfma_f32_32x32x16_bf16 v[140:155], v[136:139], v[88:91], v[140:155]
  v_mfma_f32_32x32x16_bf16 v[156:171], v[132:135], v[92:95], 0
  v_mfma_f32_32x32x16_bf16 v[156:171], v[136:139], v[96:99], v[156:171]
  v_mfma_f32_32x32x16_bf16 v[172:187], v[132:135], v[100:103], 0
  v_mfma_f32_32x32x16_bf16 v[172:187], v[136:139], v[104:107], v[172:187]
  s_nop 7
  v_cvt_pk_bf16_f32 v84, v140, v141
  v_cvt_pk_bf16_f32 v85, v142, v143
  v_cvt_pk_bf16_f32 v86, v144, v145
  v_cvt_pk_bf16_f32 v87, v146, v147
  v_cvt_pk_bf16_f32 v88, v148, v149
  v_cvt_pk_bf16_f32 v89, v150, v151
  v_cvt_pk_bf16_f32 v90, v152, v153
  v_cvt_pk_bf16_f32 v91, v154, v155
  ds_write2_b32 v72, v84, v85 offset0:0 offset1:1
  v_max3_f32 v62, v62, abs(v140), abs(v141)
  v_max3_f32 v62, v62, abs(v142), abs(v143)
  v_max3_f32 v62, v62, abs(v144), abs(v145)
  ds_write2_b32 v72, v86, v87 offset0:4 offset1:5
  v_max3_f32 v62, v62, abs(v146), abs(v147)
  v_max3_f32 v62, v62, abs(v148), abs(v149)
  ds_write2_b32 v72, v88, v89 offset0:8 offset1:9
  v_max3_f32 v62, v62, abs(v150), abs(v151)
  v_max3_f32 v62, v62, abs(v152), abs(v153)
  v_mfma_f32_32x32x16_bf16 v[188:203], v[132:135], v[108:111], 0
  v_mfma_f32_32x32x16_bf16 v[188:203], v[136:139], v[112:115], v[188:203]
  v_cvt_pk_bf16_f32 v92, v156, v157
  v_cvt_pk_bf16_f32 v93, v158, v159
  v_cvt_pk_bf16_f32 v94, v160, v161
  v_cvt_pk_bf16_f32 v95, v162, v163
  v_cvt_pk_bf16_f32 v96, v164, v165
  v_cvt_pk_bf16_f32 v97, v166, v167
  v_cvt_pk_bf16_f32 v98, v168, v169
  v_cvt_pk_bf16_f32 v99, v170, v171
  ds_write2_b32 v73, v92, v93 offset0:0 offset1:1
  v_max3_f32 v62, v62, abs(v156), abs(v157)
  v_max3_f32 v62, v62, abs(v158), abs(v159)
  v_max3_f32 v62, v62, abs(v160), abs(v161)
  ds_write2_b32 v73, v94, v95 offset0:4 offset1:5
  v_max3_f32 v62, v62, abs(v162), abs(v163)
  v_max3_f32 v62, v62, abs(v164), abs(v165)
  ds_write2_b32 v73, v96, v97 offset0:8 offset1:9
  v_max3_f32 v62, v62, abs(v166), abs(v167)
  v_max3_f32 v62, v62, abs(v168), abs(v169)
  v_mfma_f32_32x32x16_bf16 v[140:155], v[132:135], v[116:119], 0
  v_mfma_f32_32x32x16_bf16 v[140:155], v[136:139], v[120:123], v[140:155]
  v_cvt_pk_bf16_f32 v100, v172, v173
  v_cvt_pk_bf16_f32 v101, v174, v175
  v_cvt_pk_bf16_f32 v102, v176, v177
  v_cvt_pk_bf16_f32 v103, v178, v179
  v_cvt_pk_bf16_f32 v104, v180, v181
  v_cvt_pk_bf16_f32 v105, v182, v183
  v_cvt_pk_bf16_f32 v106, v184, v185
  v_cvt_pk_bf16_f32 v107, v186, v187
  ds_write2_b32 v74, v100, v101 offset0:0 offset1:1
  v_max3_f32 v62, v62, abs(v172), abs(v173)
  v_max3_f32 v62, v62, abs(v174), abs(v175)
  v_max3_f32 v62, v62, abs(v176), abs(v177)
  ds_write2_b32 v74, v102, v103 offset0:4 offset1:5
  v_max3_f32 v62, v62, abs(v178), abs(v179)
  v_max3_f32 v62, v62, abs(v180), abs(v181)
  ds_write2_b32 v74, v104, v105 offset0:8 offset1:9
  v_max3_f32 v62, v62, abs(v182), abs(v183)
  v_max3_f32 v62, v62, abs(v184), abs(v185)
  v_mfma_f32_32x32x16_bf16 v[156:171], v[132:135], v[124:127], 0
  v_mfma_f32_32x32x16_bf16 v[156:171], v[136:139], v[128:131], v[156:171]
  v_cvt_pk_bf16_f32 v108, v188, v189
  v_cvt_pk_bf16_f32 v109, v190, v191
  v_cvt_pk_bf16_f32 v110, v192, v193
  v_cvt_pk_bf16_f32 v111, v194, v195
  v_cvt_pk_bf16_f32 v112, v196, v197
  v_cvt_pk_bf16_f32 v113, v198, v199
  v_cvt_pk_bf16_f32 v114, v200, v201
  v_cvt_pk_bf16_f32 v115, v202, v203
  ds_write2_b32 v75, v108, v109 offset0:0 offset1:1
  v_max3_f32 v62, v62, abs(v188), abs(v189)
  v_max3_f32 v62, v62, abs(v190), abs(v191)
  v_max3_f32 v62, v62, abs(v192), abs(v193)
  ds_write2_b32 v75, v110, v111 offset0:4 offset1:5
  v_max3_f32 v62, v62, abs(v194), abs(v195)
  v_max3_f32 v62, v62, abs(v196), abs(v197)
  ds_write2_b32 v75, v112, v113 offset0:8 offset1:9
  v_max3_f32 v62, v62, abs(v198), abs(v199)
  v_max3_f32 v62, v62, abs(v200), abs(v201)
  v_cvt_pk_bf16_f32 v116, v140, v141
  v_cvt_pk_bf16_f32 v117, v142, v143
  v_cvt_pk_bf16_f32 v118, v144, v145
  v_cvt_pk_bf16_f32 v119, v146, v147
  v_cvt_pk_bf16_f32 v120, v148, v149
  v_cvt_pk_bf16_f32 v121, v150, v151
  v_cvt_pk_bf16_f32 v122, v152, v153
  v_cvt_pk_bf16_f32 v123, v154, v155
  ds_write2_b32 v76, v116, v117 offset0:0 offset1:1
  v_max3_f32 v62, v62, abs(v140), abs(v141)
  v_max3_f32 v62, v62, abs(v142), abs(v143)
  v_max3_f32 v62, v62, abs(v144), abs(v145)
  ds_write2_b32 v76, v118, v119 offset0:4 offset1:5
  v_max3_f32 v62, v62, abs(v146), abs(v147)
  v_max3_f32 v62, v62, abs(v148), abs(v149)
  ds_write2_b32 v76, v120, v121 offset0:8 offset1:9
  v_max3_f32 v62, v62, abs(v150), abs(v151)
  v_max3_f32 v62, v62, abs(v152), abs(v153)
  v_cvt_pk_bf16_f32 v124, v156, v157
  v_cvt_pk_bf16_f32 v125, v158, v159
  v_cvt_pk_bf16_f32 v126, v160, v161
  v_cvt_pk_bf16_f32 v127, v162, v163
  v_cvt_pk_bf16_f32 v128, v164, v165
  v_cvt_pk_bf16_f32 v129, v166, v167
  v_cvt_pk_bf16_f32 v130, v168, v169
  v_cvt_pk_bf16_f32 v131, v170, v171
  s_mov_b64 exec, s[92:93]
  ds_write2_b32 v77, v124, v125 offset0:0 offset1:1
  v_max3_f32 v62, v62, abs(v156), abs(v157)
  v_max3_f32 v62, v62, abs(v158), abs(v159)
  v_max3_f32 v62, v62, abs(v160), abs(v161)
  ds_write2_b32 v77, v126, v127 offset0:4 offset1:5
  v_max3_f32 v62, v62, abs(v162), abs(v163)
  v_max3_f32 v62, v62, abs(v164), abs(v165)
  ds_write2_b32 v77, v128, v129 offset0:8 offset1:9
  v_max3_f32 v62, v62, abs(v166), abs(v167)
  v_max3_f32 v62, v62, abs(v168), abs(v169)
  s_mov_b32 exec_hi, 0
  ds_write_b32 v77, v130 offset:48
  ds_write_b16 v245, v131 offset:1280
  s_mov_b32 exec_lo, -1
  ds_write_b32 v76, v122 offset:48
  ds_write_b16 v245, v123 offset:1024
  ds_write_b32 v75, v114 offset:48
  ds_write_b16 v245, v115 offset:768
  ds_write_b32 v74, v106 offset:48
  ds_write_b16 v245, v107 offset:512
  ds_write_b32 v73, v98 offset:48
  ds_write_b16 v245, v99 offset:256
  ds_write_b32 v72, v90 offset:48
  ds_write_b16 v245, v91 offset:0
  s_mov_b64 exec, -1
  v_max_u32_dpp v62, v62, v62 row_shr:1 row_mask:0xf bank_mask:0xf
  s_nop 1
  v_max_u32_dpp v62, v62, v62 row_shr:2 row_mask:0xf bank_mask:0xf
  s_nop 1
  v_max_u32_dpp v62, v62, v62 row_shr:4 row_mask:0xf bank_mask:0xf
  s_nop 1
  v_max_u32_dpp v62, v62, v62 row_shr:8 row_mask:0xf bank_mask:0xf
  s_nop 1
  v_max_u32_dpp v62, v62, v62 row_bcast:15 row_mask:0xa bank_mask:0xf
  s_nop 1
  v_max_u32_dpp v62, v62, v62 row_bcast:31 row_mask:0xc bank_mask:0xf
  s_nop 0
  v_readlane_b32 s68, v62, 63
  s_nop 1
  v_mov_b32 v62, s68
  ds_max_u32 v1, v62 offset:28
  ds_add_u32 v1, v3 offset:24
  s_setprio 0
  v_lshl_add_u32 v24, v24, 7, v18
  v_lshl_add_u32 v25, v25, 7, v18
  s_mov_b32 exec_hi, 0x0000ffff
  v_lshl_add_u32 v26, v26, 7, v18
  v_lshl_add_u32 v27, v27, 7, v18
  s_mov_b32 exec_lo, 0
  s_mov_b32 exec_hi, 0xffff0000
  v_mov_b32 v27, v25
  v_mov_b32 v26, v25
  s_mov_b32 exec_hi, 0x00ff0000
  v_mov_b32 v26, v24
  s_mov_b64 exec, -1
  s_add_u32 m0, s74, 0
  s_nop 0
  buffer_load_dwordx4 v24, s[32:35], 0 offen lds
  s_add_u32 m0, s74, 1056
  s_nop 0
  buffer_load_dwordx4 v25, s[32:35], 0 offen lds
  s_add_u32 m0, s74, 2112
  s_nop 0
  buffer_load_dwordx4 v26, s[32:35], 0 offen lds
  s_add_u32 m0, s74, 3168
  s_mov_b32 exec_hi, 0x00ffffff
  buffer_load_dwordx4 v27, s[32:35], 0 offen lds
  s_mov_b32 exec_hi, -1
  v_lshl_add_u32 v204, v204, 7, v18
  v_lshl_add_u32 v205, v205, 7, v18
  s_mov_b32 exec_hi, 0x0000ffff
  v_lshl_add_u32 v206, v206, 7, v18
  v_lshl_add_u32 v207, v207, 7, v18
  s_mov_b32 exec_lo, 0
  s_mov_b32 exec_hi, 0xffff0000
  v_mov_b32 v207, v205
  v_mov_b32 v206, v205
  s_mov_b32 exec_hi, 0x00ff0000
  v_mov_b32 v206, v204
  s_mov_b64 exec, -1
  s_add_u32 m0, s74, -16896
  s_nop 0
  buffer_load_dwordx4 v204, s[32:35], 0 offen lds
  s_add_u32 m0, s74, -15840
  s_nop 0
  buffer_load_dwordx4 v205, s[32:35], 0 offen lds
  s_add_u32 m0, s74, -14784
  s_nop 0
  buffer_load_dwordx4 v206, s[32:35], 0 offen lds
  s_add_u32 m0, s74, -13728
  s_mov_b32 exec_hi, 0x00ffffff
  buffer_load_dwordx4 v207, s[32:35], 0 offen lds
  s_mov_b32 exec_hi, -1
  buffer_load_dwordx4 v[24:27], v17, s[28:31], s94 offen offset:0
  s_add_u32 s94, s94, 832
  s_branch L_uph
L_g0pf:
  s_add_u32 s94, s94, 832
  s_add_u32 s77, s77, 24
  buffer_load_dwordx4 v[24:27], v17, s[28:31], s94 offen offset:0
  s_add_u32 s94, s94, 832
  buffer_load_dword v21, v20, s[28:31], s77 offen
  s_cmp_eq_u32 s77, s73
  s_cselect_b32 s73, 0x7000000, s73
  s_cselect_b32 s77, 0x7000000, s77
  s_add_u32 s77, s77, 24
  s_min_u32 s77, s77, s73
  s_mov_b64 exec, 131071
  buffer_load_dword v255, v19, s[44:47], s101 offen
  s_mov_b64 exec, -1
  s_add_u32 s101, s101, 1171456
  s_waitcnt vmcnt(3) lgkmcnt(0)
  ds_add_u32 v1, v3 offset:8
  s_mov_b32 s97, 0
L_csync4:
  ds_read_b32 v4, v2 offset:8
  s_waitcnt lgkmcnt(0)
  v_cmp_gt_u32 vcc, 4, v4
  s_cbranch_vccnz L_csync4
  s_cmp_ge_u32 s79, 2
  s_cbranch_scc1 L_chunk2
L_chunk0:
  ds_read_u16_d16_hi v216, v49 offset:0
  ds_read_u16_d16_hi v218, v49 offset:648
  ds_read_u16_d16_hi v220, v49 offset:216
  ds_read_u16_d16_hi v222, v49 offset:864
  ds_read_u16_d16_hi v224, v49 offset:432
  ds_read_u16_d16_hi v226, v49 offset:1080
  ds_read_u16_d16_hi v228, v49 offset:8
  ds_read_u16_d16_hi v229, v49 offset:208
  ds_read_u16_d16_hi v230, v49 offset:656
  ds_read_u16_d16_hi v231, v49 offset:856
  ds_read_u16_d16_hi v232, v49 offset:32
  ds_read_u16_d16_hi v233, v49 offset:832
  ds_read_u16_d16_hi v234, v49 offset:632
  ds_read_u16_d16_hi v235, v49 offset:232
  s_waitcnt lgkmcnt(12)
  v_mov_b32 v85, v218
  v_mov_b32 v84, v216
  v_max3_f32 v62, v62, abs(v84), abs(v85)
  ds_read_u16_d16_hi v236, v49 offset:16
  ds_read_u16_d16_hi v237, v49 offset:416
  ds_read_u16_d16_hi v238, v49 offset:664
  ds_read_u16_d16_hi v239, v49 offset:1064
  s_waitcnt lgkmcnt(14)
  v_mov_b32 v87, v222
  v_mov_b32 v86, v220
  v_max3_f32 v62, v62, abs(v86), abs(v87)
  ds_read_u16_d16_hi v216, v49 offset:40
  ds_read_u16_d16_hi v217, v49 offset:1040
  ds_read_u16_d16_hi v218, v49 offset:640
  ds_read_u16_d16_hi v219, v49 offset:440
  s_waitcnt lgkmcnt(14)
  v_mov_b32 v89, v226
  v_mov_b32 v88, v224
  v_max3_f32 v62, v62, abs(v88), abs(v89)
  ds_read_u16_d16_hi v220, v49 offset:224
  ds_read_u16_d16_hi v221, v49 offset:424
  ds_read_u16_d16_hi v222, v49 offset:872
  ds_read_u16_d16_hi v223, v49 offset:1072
  s_waitcnt lgkmcnt(14)
  v_add_f32 v91, v230, v231
  v_add_f32 v90, v228, v229
  v_max3_f32 v62, v62, abs(v90), abs(v91)
  ds_read_u16_d16_hi v224, v49 offset:248
  ds_read_u16_d16_hi v225, v49 offset:1048
  ds_read_u16_d16_hi v226, v49 offset:848
  ds_read_u16_d16_hi v227, v49 offset:448
  s_waitcnt lgkmcnt(14)
  v_add_f32 v93, v234, v235
  v_add_f32 v92, v232, v233
  v_max3_f32 v62, v62, abs(v92), abs(v93)
  ds_read_u16_d16_hi v228, v50 offset:48
  ds_read_u16_d16_hi v229, v51 offset:1248
  ds_read_u16_d16_hi v230, v50 offset:672
  ds_read_u16_d16_hi v231, v51 offset:1272
  s_waitcnt lgkmcnt(14)
  v_add_f32 v95, v238, v239
  v_add_f32 v94, v236, v237
  v_max3_f32 v62, v62, abs(v94), abs(v95)
  ds_read_u16_d16_hi v232, v50 offset:256
  ds_read_u16_d16_hi v233, v51 offset:1256
  ds_read_u16_d16_hi v234, v50 offset:880
  ds_read_u16_d16_hi v235, v51 offset:1280
  s_waitcnt lgkmcnt(14)
  v_add_f32 v97, v218, v219
  v_add_f32 v96, v216, v217
  v_max3_f32 v62, v62, abs(v96), abs(v97)
  ds_read_u16_d16_hi v236, v50 offset:464
  ds_read_u16_d16_hi v237, v51 offset:1264
  ds_read_u16_d16_hi v238, v50 offset:1088
  ds_read_u16_d16_hi v239, v51 offset:1288
  s_waitcnt lgkmcnt(14)
  v_add_f32 v99, v222, v223
  v_add_f32 v98, v220, v221
  v_max3_f32 v62, v62, abs(v98), abs(v99)
  s_waitcnt lgkmcnt(12)
  v_add_f32 v101, v226, v227
  v_add_f32 v100, v224, v225
  v_max3_f32 v62, v62, abs(v100), abs(v101)
  s_waitcnt lgkmcnt(8)
  v_add_f32 v103, v230, v231
  v_add_f32 v102, v228, v229
  v_max3_f32 v62, v62, abs(v102), abs(v103)
  s_waitcnt lgkmcnt(4)
  v_add_f32 v105, v234, v235
  v_add_f32 v104, v232, v233
  v_max3_f32 v62, v62, abs(v104), abs(v105)
  s_waitcnt lgkmcnt(0)
  v_add_f32 v107, v238, v239
  v_add_f32 v106, v236, v237
  v_max3_f32 v62, v62, abs(v106), abs(v107)
  s_cmp_lg_u32 s97, 0
  s_cbranch_scc1 L_uconv0
L_chunk1:
  ds_read_u16_d16_hi v216, v49 offset:24
  ds_read_u16_d16_hi v217, v49 offset:624
  ds_read_u16_d16_hi v218, v49 offset:240
  ds_read_u16_d16_hi v219, v49 offset:840
  ds_read_u16_d16_hi v220, v49 offset:456
  ds_read_u16_d16_hi v221, v49 offset:1056
  ds_read_u16_d16_hi v222, v60 offset:1296
  ds_read_u16_d16_hi v223, v61 offset:1296
  ds_read_u16_d16_hi v224, v52 offset:50
  ds_read_u16_d16_hi v225, v53 offset:1300
  ds_read_u16_d16_hi v226, v52 offset:674
  ds_read_u16_d16_hi v227, v53 offset:1324
  ds_read_u16_d16_hi v228, v52 offset:258
  ds_read_u16_d16_hi v229, v53 offset:1308
  ds_read_u16_d16_hi v230, v52 offset:882
  ds_read_u16_d16_hi v231, v53 offset:1332
  ds_read_u16_d16_hi v232, v52 offset:466
  ds_read_u16_d16_hi v233, v53 offset:1316
  ds_read_u16_d16_hi v234, v52 offset:1090
  ds_read_u16_d16_hi v235, v53 offset:1340
  s_waitcnt lgkmcnt(14)
  v_add_f32 v109, v218, v219
  v_add_f32 v108, v216, v217
  v_max3_f32 v62, v62, abs(v108), abs(v109)
  ds_read_u16_d16_hi v236, v54 offset:2
  ds_read_u16_d16_hi v237, v55 offset:52
  ds_read_u16_d16_hi v238, v54 offset:650
  ds_read_u16_d16_hi v239, v55 offset:700
  s_waitcnt lgkmcnt(14)
  v_add_f32 v111, v222, v223
  v_add_f32 v110, v220, v221
  v_max3_f32 v62, v62, abs(v110), abs(v111)
  ds_read_u16_d16_hi v216, v54 offset:26
  ds_read_u16_d16_hi v217, v55 offset:676
  ds_read_u16_d16_hi v218, v54 offset:626
  ds_read_u16_d16_hi v219, v55 offset:76
  s_waitcnt lgkmcnt(14)
  v_add_f32 v113, v226, v227
  v_add_f32 v112, v224, v225
  v_max3_f32 v62, v62, abs(v112), abs(v113)
  ds_read_u16_d16_hi v220, v54 offset:10
  ds_read_u16_d16_hi v221, v55 offset:260
  ds_read_u16_d16_hi v222, v54 offset:658
  ds_read_u16_d16_hi v223, v55 offset:908
  s_waitcnt lgkmcnt(14)
  v_add_f32 v115, v230, v231
  v_add_f32 v114, v228, v229
  v_max3_f32 v62, v62, abs(v114), abs(v115)
  ds_read_u16_d16_hi v224, v54 offset:34
  ds_read_u16_d16_hi v225, v55 offset:884
  ds_read_u16_d16_hi v226, v54 offset:634
  ds_read_u16_d16_hi v227, v55 offset:284
  s_waitcnt lgkmcnt(14)
  v_add_f32 v117, v234, v235
  v_add_f32 v116, v232, v233
  v_max3_f32 v62, v62, abs(v116), abs(v117)
  ds_read_u16_d16_hi v228, v54 offset:18
  ds_read_u16_d16_hi v229, v55 offset:468
  ds_read_u16_d16_hi v230, v54 offset:666
  ds_read_u16_d16_hi v231, v55 offset:1116
  s_waitcnt lgkmcnt(14)
  v_add_f32 v119, v238, v239
  v_add_f32 v118, v236, v237
  v_max3_f32 v62, v62, abs(v118), abs(v119)
  ds_read_u16_d16_hi v232, v54 offset:42
  ds_read_u16_d16_hi v233, v55 offset:1092
  ds_read_u16_d16_hi v234, v54 offset:642
  ds_read_u16_d16_hi v235, v55 offset:492
  s_waitcnt lgkmcnt(14)
  v_add_f32 v121, v218, v219
  v_add_f32 v120, v216, v217
  v_max3_f32 v62, v62, abs(v120), abs(v121)
  ds_read_u16_d16_hi v236, v54 offset:210
  ds_read_u16_d16_hi v237, v55 offset:60
  ds_read_u16_d16_hi v238, v54 offset:858
  ds_read_u16_d16_hi v239, v55 offset:708
  s_waitcnt lgkmcnt(14)
  v_add_f32 v123, v222, v223
  v_add_f32 v122, v220, v221
  v_max3_f32 v62, v62, abs(v122), abs(v123)
  s_waitcnt lgkmcnt(12)
  v_add_f32 v125, v226, v227
  v_add_f32 v124, v224, v225
  v_max3_f32 v62, v62, abs(v124), abs(v125)
  s_waitcnt lgkmcnt(8)
  v_add_f32 v127, v230, v231
  v_add_f32 v126, v228, v229
  v_max3_f32 v62, v62, abs(v126), abs(v127)
  s_waitcnt lgkmcnt(4)
  v_add_f32 v129, v234, v235
  v_add_f32 v128, v232, v233
  v_max3_f32 v62, v62, abs(v128), abs(v129)
  s_waitcnt lgkmcnt(0)
  v_add_f32 v131, v238, v239
  v_add_f32 v130, v236, v237
  v_max3_f32 v62, v62, abs(v130), abs(v131)
  s_cmp_lg_u32 s97, 0
  s_cbranch_scc1 L_uconv1
  s_branch L_w1conv
L_chunk2:
  ds_read_u16_d16_hi v216, v54 offset:234
  ds_read_u16_d16_hi v217, v55 offset:684
  ds_read_u16_d16_hi v218, v54 offset:834
  ds_read_u16_d16_hi v219, v55 offset:84
  ds_read_u16_d16_hi v220, v54 offset:218
  ds_read_u16_d16_hi v221, v55 offset:268
  ds_read_u16_d16_hi v222, v54 offset:866
  ds_read_u16_d16_hi v223, v55 offset:916
  ds_read_u16_d16_hi v224, v54 offset:242
  ds_read_u16_d16_hi v225, v55 offset:892
  ds_read_u16_d16_hi v226, v54 offset:842
  ds_read_u16_d16_hi v227, v55 offset:292
  ds_read_u16_d16_hi v228, v54 offset:226
  ds_read_u16_d16_hi v229, v55 offset:476
  ds_read_u16_d16_hi v230, v54 offset:874
  ds_read_u16_d16_hi v231, v55 offset:1124
  ds_read_u16_d16_hi v232, v54 offset:250
  ds_read_u16_d16_hi v233, v55 offset:1100
  ds_read_u16_d16_hi v234, v54 offset:850
  ds_read_u16_d16_hi v235, v55 offset:500
  s_waitcnt lgkmcnt(14)
  v_add_f32 v85, v218, v219
  v_add_f32 v84, v216, v217
  v_max3_f32 v62, v62, abs(v84), abs(v85)
  ds_read_u16_d16_hi v236, v54 offset:418
  ds_read_u16_d16_hi v237, v55 offset:68
  ds_read_u16_d16_hi v238, v54 offset:1066
  ds_read_u16_d16_hi v239, v55 offset:716
  s_waitcnt lgkmcnt(14)
  v_add_f32 v87, v222, v223
  v_add_f32 v86, v220, v221
  v_max3_f32 v62, v62, abs(v86), abs(v87)
  ds_read_u16_d16_hi v216, v54 offset:442
  ds_read_u16_d16_hi v217, v55 offset:692
  ds_read_u16_d16_hi v218, v54 offset:1042
  ds_read_u16_d16_hi v219, v55 offset:92
  s_waitcnt lgkmcnt(14)
  v_add_f32 v89, v226, v227
  v_add_f32 v88, v224, v225
  v_max3_f32 v62, v62, abs(v88), abs(v89)
  ds_read_u16_d16_hi v220, v54 offset:426
  ds_read_u16_d16_hi v221, v55 offset:276
  ds_read_u16_d16_hi v222, v54 offset:1074
  ds_read_u16_d16_hi v223, v55 offset:924
  s_waitcnt lgkmcnt(14)
  v_add_f32 v91, v230, v231
  v_add_f32 v90, v228, v229
  v_max3_f32 v62, v62, abs(v90), abs(v91)
  ds_read_u16_d16_hi v224, v54 offset:450
  ds_read_u16_d16_hi v225, v55 offset:900
  ds_read_u16_d16_hi v226, v54 offset:1050
  ds_read_u16_d16_hi v227, v55 offset:300
  s_waitcnt lgkmcnt(14)
  v_add_f32 v93, v234, v235
  v_add_f32 v92, v232, v233
  v_max3_f32 v62, v62, abs(v92), abs(v93)
  ds_read_u16_d16_hi v228, v54 offset:434
  ds_read_u16_d16_hi v229, v55 offset:484
  ds_read_u16_d16_hi v230, v54 offset:1082
  ds_read_u16_d16_hi v231, v55 offset:1132
  s_waitcnt lgkmcnt(14)
  v_add_f32 v95, v238, v239
  v_add_f32 v94, v236, v237
  v_max3_f32 v62, v62, abs(v94), abs(v95)
  ds_read_u16_d16_hi v232, v54 offset:458
  ds_read_u16_d16_hi v233, v55 offset:1108
  ds_read_u16_d16_hi v234, v54 offset:1058
  ds_read_u16_d16_hi v235, v55 offset:508
  s_waitcnt lgkmcnt(14)
  v_add_f32 v97, v218, v219
  v_add_f32 v96, v216, v217
  v_max3_f32 v62, v62, abs(v96), abs(v97)
  ds_read_u16_d16_hi v236, v56 offset:4
  ds_read_u16_d16_hi v237, v57 offset:104
  ds_read_u16_d16_hi v238, v58 offset:652
  ds_read_u16_d16_hi v239, v59 offset:752
  s_waitcnt lgkmcnt(14)
  v_add_f32 v99, v222, v223
  v_add_f32 v98, v220, v221
  v_max3_f32 v62, v62, abs(v98), abs(v99)
  s_waitcnt lgkmcnt(12)
  v_add_f32 v101, v226, v227
  v_add_f32 v100, v224, v225
  v_max3_f32 v62, v62, abs(v100), abs(v101)
  s_waitcnt lgkmcnt(8)
  v_add_f32 v103, v230, v231
  v_add_f32 v102, v228, v229
  v_max3_f32 v62, v62, abs(v102), abs(v103)
  s_waitcnt lgkmcnt(4)
  v_add_f32 v105, v234, v235
  v_add_f32 v104, v232, v233
  v_max3_f32 v62, v62, abs(v104), abs(v105)
  s_waitcnt lgkmcnt(0)
  v_add_f32 v107, v238, v239
  v_add_f32 v106, v236, v237
  v_max3_f32 v62, v62, abs(v106), abs(v107)
  s_cmp_lg_u32 s97, 0
  s_cbranch_scc1 L_uconv0
L_chunk3:
  ds_read_u16_d16_hi v216, v56 offset:220
  ds_read_u16_d16_hi v217, v57 offset:320
  ds_read_u16_d16_hi v218, v58 offset:868
  ds_read_u16_d16_hi v219, v59 offset:968
  ds_read_u16_d16_hi v220, v56 offset:436
  ds_read_u16_d16_hi v221, v57 offset:536
  ds_read_u16_d16_hi v222, v58 offset:1084
  ds_read_u16_d16_hi v223, v59 offset:1184
  ds_read_u16_d16_hi v224, v56 offset:12
  ds_read_u16_d16_hi v225, v57 offset:312
  ds_read_u16_d16_hi v226, v58 offset:660
  ds_read_u16_d16_hi v227, v59 offset:960
  ds_read_u16_d16_hi v228, v58 offset:36
  ds_read_u16_d16_hi v229, v59 offset:936
  ds_read_u16_d16_hi v230, v56 offset:636
  ds_read_u16_d16_hi v231, v57 offset:336
  ds_read_u16_d16_hi v232, v56 offset:20
  ds_read_u16_d16_hi v233, v57 offset:520
  ds_read_u16_d16_hi v234, v58 offset:668
  ds_read_u16_d16_hi v235, v59 offset:1168
  s_waitcnt lgkmcnt(14)
  v_add_f32 v109, v218, v219
  v_add_f32 v108, v216, v217
  v_max3_f32 v62, v62, abs(v108), abs(v109)
  ds_read_u16_d16_hi v236, v58 offset:44
  ds_read_u16_d16_hi v237, v59 offset:1144
  ds_read_u16_d16_hi v238, v56 offset:644
  ds_read_u16_d16_hi v239, v57 offset:544
  s_waitcnt lgkmcnt(14)
  v_add_f32 v111, v222, v223
  v_add_f32 v110, v220, v221
  v_max3_f32 v62, v62, abs(v110), abs(v111)
  ds_read_u16_d16_hi v216, v56 offset:228
  ds_read_u16_d16_hi v217, v57 offset:528
  ds_read_u16_d16_hi v218, v58 offset:876
  ds_read_u16_d16_hi v219, v59 offset:1176
  s_waitcnt lgkmcnt(14)
  v_add_f32 v113, v226, v227
  v_add_f32 v112, v224, v225
  v_max3_f32 v62, v62, abs(v112), abs(v113)
  ds_read_u16_d16_hi v220, v58 offset:252
  ds_read_u16_d16_hi v221, v59 offset:1152
  ds_read_u16_d16_hi v222, v56 offset:852
  ds_read_u16_d16_hi v223, v57 offset:552
  s_waitcnt lgkmcnt(14)
  v_add_f32 v115, v230, v231
  v_add_f32 v114, v228, v229
  v_max3_f32 v62, v62, abs(v114), abs(v115)
  ds_read_u16_d16_hi v224, v65 offset:0
  ds_read_u16_d16_hi v225, v65 offset:8
  ds_read_u16_d16_hi v226, v65 offset:16
  ds_read_u16_d16_hi v227, v65 offset:24
  ds_read_u16_d16_hi v228, v65 offset:32
  ds_read_u16_d16_hi v229, v65 offset:40
  ds_read_u16_d16_hi v230, v64 offset:48
  ds_read_u16_d16_hi v231, v67
  s_waitcnt lgkmcnt(14)
  v_add_f32 v117, v234, v235
  v_add_f32 v116, v232, v233
  v_max3_f32 v62, v62, abs(v116), abs(v117)
  v_add_f32 v119, v238, v239
  v_add_f32 v118, v236, v237
  v_max3_f32 v62, v62, abs(v118), abs(v119)
  s_waitcnt lgkmcnt(12)
  v_add_f32 v121, v218, v219
  v_add_f32 v120, v216, v217
  v_max3_f32 v62, v62, abs(v120), abs(v121)
  s_waitcnt lgkmcnt(8)
  v_add_f32 v123, v222, v223
  v_add_f32 v122, v220, v221
  v_max3_f32 v62, v62, abs(v122), abs(v123)
  s_cmp_lg_u32 s97, 0
  s_cbranch_scc1 L_uconv1
L_w1conv:
  v_max_u32_dpp v62, v62, v62 row_shr:1 row_mask:0xf bank_mask:0xf
  s_nop 1
  v_max_u32_dpp v62, v62, v62 row_shr:2 row_mask:0xf bank_mask:0xf
  s_nop 1
  v_max_u32_dpp v62, v62, v62 row_shr:4 row_mask:0xf bank_mask:0xf
  s_nop 1
  v_max_u32_dpp v62, v62, v62 row_shr:8 row_mask:0xf bank_mask:0xf
  s_nop 1
  v_max_u32_dpp v62, v62, v62 row_bcast:15 row_mask:0xa bank_mask:0xf
  s_nop 1
  v_max_u32_dpp v62, v62, v62 row_bcast:31 row_mask:0xc bank_mask:0xf
  s_nop 0
  v_readlane_b32 s68, v62, 63
  s_nop 1
  v_mov_b32 v62, s68
  ds_max_u32 v1, v62 offset:20
  ds_add_u32 v1, v3 offset:16
  v_add_u32 v49, v49, v247
  v_add_u32 v50, v50, v247
  v_add_u32 v51, v51, v247
  v_add_u32 v52, v52, v247
  v_add_u32 v53, v53, v247
  v_add_u32 v54, v54, v247
  v_add_u32 v55, v55, v247
  v_add_u32 v56, v56, v247
  v_add_u32 v57, v57, v247
  v_add_u32 v58, v58, v247
  v_add_u32 v59, v59, v247
  v_add_u32 v60, v60, v247
  v_add_u32 v61, v61, v247
L_csync5:
  ds_read_b64 v[40:41], v2 offset:16
  s_waitcnt lgkmcnt(0)
  v_cmp_gt_u32 vcc, 4, v40
  s_cbranch_vccnz L_csync5
  v_readfirstlane_b32 s70, v41
  s_nop 0
  s_lshr_b32 s70, s70, 23
  s_sub_i32 s70, 141, s70
  s_min_i32 s70, s70, 40
  s_add_i32 s51, s70, 127
  s_lshl_b32 s51, s51, 23
  v_fma_mixlo_f16 v132, v84, s51, 0
  v_fma_mixlo_f16 v133, v86, s51, 0
  v_fma_mixlo_f16 v134, v88, s51, 0
  v_fma_mixlo_f16 v135, v90, s51, 0
  v_fma_mixhi_f16 v132, v85, s51, 0
  v_fma_mixhi_f16 v133, v87, s51, 0
  v_fma_mixhi_f16 v134, v89, s51, 0
  v_fma_mixhi_f16 v135, v91, s51, 0
  v_fma_mixlo_f16 v136, v92, s51, 0
  v_fma_mixlo_f16 v137, v94, s51, 0
  v_fma_mixlo_f16 v138, v96, s51, 0
  v_fma_mixlo_f16 v139, v98, s51, 0
  v_fma_mixhi_f16 v136, v93, s51, 0
  v_fma_mixhi_f16 v137, v95, s51, 0
  v_fma_mixhi_f16 v138, v97, s51, 0
  v_fma_mixhi_f16 v139, v99, s51, 0
  ds_write_b128 v63, v[132:135] offset:0
  v_fma_mixlo_f16 v140, v100, s51, 0
  v_fma_mixlo_f16 v141, v102, s51, 0
  v_fma_mixlo_f16 v142, v104, s51, 0
  v_fma_mixlo_f16 v143, v106, s51, 0
  v_fma_mixhi_f16 v140, v101, s51, 0
  v_fma_mixhi_f16 v141, v103, s51, 0
  v_fma_mixhi_f16 v142, v105, s51, 0
  v_fma_mixhi_f16 v143, v107, s51, 0
  ds_write_b128 v63, v[136:139] offset:1024
  v_fma_mixlo_f16 v144, v108, s51, 0
  v_fma_mixlo_f16 v145, v110, s51, 0
  v_fma_mixlo_f16 v146, v112, s51, 0
  v_fma_mixlo_f16 v147, v114, s51, 0
  v_fma_mixhi_f16 v144, v109, s51, 0
  v_fma_mixhi_f16 v145, v111, s51, 0
  v_fma_mixhi_f16 v146, v113, s51, 0
  v_fma_mixhi_f16 v147, v115, s51, 0
  ds_write_b128 v63, v[140:143] offset:2048
  v_fma_mixlo_f16 v148, v116, s51, 0
  v_fma_mixlo_f16 v149, v118, s51, 0
  v_fma_mixlo_f16 v150, v120, s51, 0
  v_fma_mixlo_f16 v151, v122, s51, 0
  v_fma_mixhi_f16 v148, v117, s51, 0
  v_fma_mixhi_f16 v149, v119, s51, 0
  v_fma_mixhi_f16 v150, v121, s51, 0
  v_fma_mixhi_f16 v151, v123, s51, 0
  ds_write_b128 v63, v[144:147] offset:3072
  ds_write_b128 v63, v[148:151] offset:4096
  s_cmp_ge_u32 s79, 2
  s_cbranch_scc1 L_w1x
  v_fma_mixlo_f16 v152, v124, s51, 0
  v_fma_mixlo_f16 v153, v126, s51, 0
  v_fma_mixlo_f16 v154, v128, s51, 0
  v_fma_mixlo_f16 v155, v130, s51, 0
  v_fma_mixhi_f16 v152, v125, s51, 0
  v_fma_mixhi_f16 v153, v127, s51, 0
  v_fma_mixhi_f16 v154, v129, s51, 0
  v_fma_mixhi_f16 v155, v131, s51, 0
  ds_write_b128 v63, v[152:155] offset:5120
L_w1x:
L_uph:
L_csync6:
  ds_read_b64 v[40:41], v2 offset:24
  s_waitcnt lgkmcnt(0)
  v_cmp_gt_u32 vcc, 4, v40
  s_cbranch_vccnz L_csync6
  v_readfirstlane_b32 s71, v41
  s_nop 0
  s_lshr_b32 s71, s71, 23
  s_sub_i32 s71, 140, s71
  s_min_i32 s71, s71, 40
  s_add_i32 s51, s71, 127
  s_lshl_b32 s51, s51, 23
  s_mov_b32 s97, 1
  s_lshr_b32 s69, s3, 1
  s_cmp_eq_u32 s69, 0
  s_cbranch_scc1 L_chunk0
  s_cmp_eq_u32 s69, 1
  s_cbranch_scc1 L_chunk1
  s_cmp_eq_u32 s69, 2
  s_cbranch_scc1 L_chunk2
  s_branch L_chunk3
L_uconv0:
  v_fma_mixlo_f16 v132, v84, s51, 0
  v_fma_mixlo_f16 v133, v86, s51, 0
  v_fma_mixlo_f16 v134, v88, s51, 0
  v_fma_mixlo_f16 v135, v90, s51, 0
  v_fma_mixhi_f16 v132, v85, s51, 0
  v_fma_mixhi_f16 v133, v87, s51, 0
  v_fma_mixhi_f16 v134, v89, s51, 0
  v_fma_mixhi_f16 v135, v91, s51, 0
L_csync7:
  ds_read_b64 v[40:41], v2 offset:16
  s_waitcnt lgkmcnt(0)
  v_cmp_gt_u32 vcc, 4, v40
  s_cbranch_vccnz L_csync7
  v_readfirstlane_b32 s70, v41
  s_nop 0
  s_lshr_b32 s70, s70, 23
  s_sub_i32 s70, 141, s70
  s_min_i32 s70, s70, 40
  ds_write_b128 v66, v[132:135] offset:0
  v_fma_mixlo_f16 v136, v92, s51, 0
  v_fma_mixlo_f16 v137, v94, s51, 0
  v_fma_mixlo_f16 v138, v96, s51, 0
  v_fma_mixlo_f16 v139, v98, s51, 0
  v_fma_mixhi_f16 v136, v93, s51, 0
  v_fma_mixhi_f16 v137, v95, s51, 0
  v_fma_mixhi_f16 v138, v97, s51, 0
  v_fma_mixhi_f16 v139, v99, s51, 0
  ds_write_b128 v66, v[136:139] offset:1024
  v_fma_mixlo_f16 v140, v100, s51, 0
  v_fma_mixlo_f16 v141, v102, s51, 0
  v_fma_mixlo_f16 v142, v104, s51, 0
  v_fma_mixlo_f16 v143, v106, s51, 0
  v_fma_mixhi_f16 v140, v101, s51, 0
  v_fma_mixhi_f16 v141, v103, s51, 0
  v_fma_mixhi_f16 v142, v105, s51, 0
  v_fma_mixhi_f16 v143, v107, s51, 0
  ds_write_b128 v66, v[140:143] offset:2048
  s_branch L_built
L_uconv1:
  v_fma_mixlo_f16 v144, v108, s51, 0
  v_fma_mixlo_f16 v145, v110, s51, 0
  v_fma_mixlo_f16 v146, v112, s51, 0
  v_fma_mixlo_f16 v147, v114, s51, 0
  v_fma_mixhi_f16 v144, v109, s51, 0
  v_fma_mixhi_f16 v145, v111, s51, 0
  v_fma_mixhi_f16 v146, v113, s51, 0
  v_fma_mixhi_f16 v147, v115, s51, 0
L_csync8:
  ds_read_b64 v[40:41], v2 offset:16
  s_waitcnt lgkmcnt(0)
  v_cmp_gt_u32 vcc, 4, v40
  s_cbranch_vccnz L_csync8
  v_readfirstlane_b32 s70, v41
  s_nop 0
  s_lshr_b32 s70, s70, 23
  s_sub_i32 s70, 141, s70
  s_min_i32 s70, s70, 40
  ds_write_b128 v66, v[144:147] offset:3072
  v_fma_mixlo_f16 v148, v116, s51, 0
  v_fma_mixlo_f16 v149, v118, s51, 0
  v_fma_mixlo_f16 v150, v120, s51, 0
  v_fma_mixlo_f16 v151, v122, s51, 0
  v_fma_mixhi_f16 v148, v117, s51, 0
  v_fma_mixhi_f16 v149, v119, s51, 0
  v_fma_mixhi_f16 v150, v121, s51, 0
  v_fma_mixhi_f16 v151, v123, s51, 0
  ds_write_b128 v66, v[148:151] offset:4096
  s_cmp_lg_u32 s84, 0
  s_cbranch_scc1 L_ulin
  v_fma_mixlo_f16 v152, v124, s51, 0
  v_fma_mixlo_f16 v153, v126, s51, 0
  v_fma_mixlo_f16 v154, v128, s51, 0
  v_fma_mixlo_f16 v155, v130, s51, 0
  v_fma_mixhi_f16 v152, v125, s51, 0
  v_fma_mixhi_f16 v153, v127, s51, 0
  v_fma_mixhi_f16 v154, v129, s51, 0
  v_fma_mixhi_f16 v155, v131, s51, 0
  ds_write_b128 v66, v[152:155] offset:5120
  s_branch L_built
L_ulin:
  v_mul_f32 v224, s51, v224
  v_mul_f32 v225, s51, v225
  v_mul_f32 v226, s51, v226
  v_mul_f32 v227, s51, v227
  v_mul_f32 v228, s51, v228
  v_mul_f32 v229, s51, v229
  v_mul_f32 v230, s51, v230
  v_mul_f32 v231, s51, v231
  v_cvt_pk_bf16_f32 v152, v224, v225
  v_cvt_pk_bf16_f32 v153, v226, v227
  v_cvt_pk_bf16_f32 v154, v228, v229
  v_cvt_pk_bf16_f32 v155, v230, v231
  ds_write_b128 v66, v[152:155] offset:5120
L_built:
  s_waitcnt vmcnt(1)
  v_mov_b32 v4, s84
  ds_add_u32 v1, v4 offset:36
  s_mov_b32 s60, s24
  s_and_b32 s61, s25, 0xffff
  s_mov_b32 s62, 268435456
  s_mov_b32 s63, 0x20000
  s_mov_b32 s64, s22
  s_and_b32 s65, s23, 0xffff
  s_mov_b32 s66, 256
  s_mov_b32 s67, 0x20000
  v_lshlrev_b32 v251, 2, v0
  s_mov_b64 exec, 0xff
  s_mov_b32 s81, 0x80000
  buffer_load_dword v255, v251, s[60:63], s81 offen
  buffer_load_dword v249, v251, s[64:67], 0 offen offset:128 sc1
  s_mov_b64 exec, -1
  v_mov_b32 v251, 0
  s_add_i32 s48, s70, s71
L_csync9:
  ds_read_b32 v4, v2 offset:36
  s_waitcnt lgkmcnt(0)
  v_cmp_gt_u32 vcc, 4, v4
  s_cbranch_vccnz L_csync9
  ds_read_u16_d16_hi v32, v7 offset:0
  ds_read_u16_d16_hi v33, v7 offset:128
  ds_read_u16_d16_hi v34, v7 offset:256
  ds_read_u16_d16_hi v35, v7 offset:384
  ds_read_u16_d16_hi v36, v7 offset:512
  ds_read_u16_d16_hi v37, v7 offset:640
  ds_read_u16_d16_hi v38, v7 offset:768
  ds_read_u16_d16_hi v39, v7 offset:896
  s_waitcnt lgkmcnt(0)
  v_cvt_pk_f16_f32 v43, v38, v39
  v_cvt_pk_f16_f32 v40, v32, v35
  v_cvt_pk_f16_f32 v41, v33, v36
  v_cvt_pk_f16_f32 v42, v34, v37
  ds_write_b128 v10, v[40:43]
  ds_read_b128 v[44:47], v11
  ds_read_b128 v[48:51], v12
  ds_read_b64_tr_b16 v[52:53], v8 offset:0
  ds_read_b64_tr_b16 v[54:55], v8 offset:512
  v_pk_mul_f16 v56, v40, v40 op_sel:[0,0] op_sel_hi:[1,1]
  v_pk_mul_f16 v57, v41, v41 op_sel:[0,0] op_sel_hi:[1,1]
  v_pk_mul_f16 v58, v42, v42 op_sel:[0,0] op_sel_hi:[1,1]
  v_pk_mul_f16 v59, v40, v41 op_sel:[0,0] op_sel_hi:[1,1]
  ds_read_u16_d16_hi v32, v7 offset:32
  ds_read_u16_d16_hi v33, v7 offset:160
  s_waitcnt vmcnt(3)
  v_lshlrev_b32 v21, 7, v21
  buffer_load_dword v255, v21, s[32:35], 0 offen
  s_mov_b64 exec, 131071
  buffer_load_dword v255, v19, s[44:47], s101 offen
  s_mov_b64 exec, -1
  s_add_u32 s101, s101, 1171456
  s_waitcnt lgkmcnt(0)
  s_barrier
  s_setprio 1
  ds_read_b128 v[240:243], v28 offset:46528
  ds_read_b128 v[128:131], v28 offset:35264
  ds_read_b128 v[84:87], v28 offset:0
  ds_read_b128 v[216:219], v22
  ds_read_b128 v[244:247], v30 offset:22528
  ds_read_b128 v[172:175], v31 offset:11264
  ds_read_b128 v[176:179], v31 offset:12288
  ds_read_b128 v[180:183], v31 offset:13312
  ds_read2_b32 v[220:221], v29 offset0:0 offset1:2
  ds_read2_b32 v[222:223], v29 offset0:64 offset1:66
  v_add_u32 v29, 2048, v29
  ds_read_b128 v[88:91], v28 offset:1024
  ds_read_b128 v[92:95], v28 offset:2048
  ds_read_b128 v[132:135], v28 offset:36288
  ds_read_b128 v[136:139], v28 offset:37312
  ds_read_b128 v[140:143], v28 offset:38336
  ds_read_b128 v[144:147], v28 offset:39360
  ds_read2_b32 v[224:225], v29 offset0:0 offset1:2
  ds_read2_b32 v[226:227], v29 offset0:64 offset1:66
  v_add_u32 v29, 2048, v29
  s_cmp_lg_u32 s84, 0
  s_cbranch_scc1 L_prf
  s_setprio 2
L_prf:
  s_waitcnt lgkmcnt(14)
  v_mfma_f32_16x16x32_bf16 v[72:75], v[240:243], v[52:55], 0
  ds_read_b128 v[184:187], v31 offset:14336
  v_mfma_f32_16x16x32_f16 v[72:75], v[128:131], v[56:59], v[72:75]
  ds_read_b128 v[188:191], v31 offset:15360
  v_mfma_f32_16x16x32_f16 v[68:71], v[84:87], v[56:59], 0
  ds_read_b128 v[96:99], v28 offset:3072
  v_pk_mul_f16 v60, v40, v41 op_sel:[0,1] op_sel_hi:[1,0]
  v_mfma_f32_16x16x32_f16 v[80:83], v[216:219], v[56:59], 0
  ds_read_b128 v[100:103], v28 offset:4096
  v_pk_mul_f16 v61, v40, v42 op_sel:[0,0] op_sel_hi:[1,1]
  v_pk_mul_f16 v62, v40, v42 op_sel:[0,1] op_sel_hi:[1,0]
  s_waitcnt lgkmcnt(14)
  v_mfma_f32_16x16x32_bf16 v[76:79], v[244:247], v[52:55], 0
  ds_read_b128 v[104:107], v28 offset:5120
  v_pk_mul_f16 v63, v41, v42 op_sel:[0,0] op_sel_hi:[1,1]
  v_pk_mul_f16 v64, v41, v42 op_sel:[0,1] op_sel_hi:[1,0]
  v_mfma_f32_16x16x32_f16 v[76:79], v[172:175], v[56:59], v[76:79]
  ds_read_b128 v[108:111], v28 offset:6144
  v_pk_mul_f16 v65, v40, v43 op_sel:[0,0] op_sel_hi:[1,0]
  v_pk_mul_f16 v66, v41, v43 op_sel:[0,0] op_sel_hi:[1,0]
  v_pk_mul_f16 v67, v42, v43 op_sel:[0,0] op_sel_hi:[1,0]
  v_mfma_f32_16x16x32_f16 v[76:79], v[176:179], v[60:63], v[76:79]
  ds_read2_b32 v[228:229], v29 offset0:0 offset1:2
  ds_read2_b32 v[230:231], v29 offset0:64 offset1:66
  v_add_u32 v29, 2048, v29
  v_alignbit_b32 v48, v48, v48, v13
  v_mfma_f32_16x16x32_f16 v[76:79], v[180:183], v[64:67], v[76:79]
  ds_read_b128 v[148:151], v28 offset:40384
  v_mul_f16_sdwa v52, v40, v40 dst_sel:WORD_0 dst_unused:UNUSED_PAD src0_sel:WORD_0 src1_sel:WORD_1
  v_mul_f16_sdwa v53, v42, v42 dst_sel:WORD_0 dst_unused:UNUSED_PAD src0_sel:WORD_0 src1_sel:WORD_1
  s_waitcnt lgkmcnt(14)
  v_smfmac_f32_16x16x64_f16 v[80:83], v[220:223], v[60:67], v16
  ds_read_b128 v[152:155], v28 offset:41408
  v_alignbit_b32 v49, v49, v49, v13
  v_mfma_f32_16x16x32_f16 v[68:71], v[88:91], v[60:63], v[68:71]
  ds_read_b128 v[192:195], v31 offset:16384
  v_mul_f16_sdwa v52, v41, v41 dst_sel:WORD_1 dst_unused:UNUSED_PRESERVE src0_sel:WORD_0 src1_sel:WORD_1
  v_mul_f16_sdwa v53, v43, v43 dst_sel:WORD_1 dst_unused:UNUSED_PRESERVE src0_sel:WORD_0 src1_sel:WORD_1
  v_mfma_f32_16x16x32_f16 v[68:71], v[92:95], v[64:67], v[68:71]
  ds_read_b128 v[196:199], v31 offset:17408
  v_pk_mul_f16 v54, v40, v47 op_sel:[0,0] op_sel_hi:[1,0]
  v_mfma_f32_16x16x32_f16 v[72:75], v[132:135], v[60:63], v[72:75]
  ds_read_b128 v[200:203], v31 offset:18432
  v_pk_mul_f16 v55, v41, v47 op_sel:[0,0] op_sel_hi:[1,0]
  v_pk_mul_f16 v56, v42, v47 op_sel:[0,0] op_sel_hi:[1,0]
  s_waitcnt lgkmcnt(14)
  v_mfma_f32_16x16x32_f16 v[72:75], v[136:139], v[64:67], v[72:75]
  ds_read_b128 v[204:207], v31 offset:19456
  v_pk_mul_f16 v57, v40, v44 op_sel:[0,0] op_sel_hi:[1,1]
  v_pk_mul_f16 v58, v40, v44 op_sel:[0,1] op_sel_hi:[1,0]
  v_pk_mul_f16 v59, v40, v45 op_sel:[0,0] op_sel_hi:[1,1]
  v_mfma_f32_16x16x32_f16 v[72:75], v[140:143], v[52:55], v[72:75]
  ds_read2_b32 v[232:233], v29 offset0:0 offset1:2
  ds_read2_b32 v[234:235], v29 offset0:64 offset1:66
  v_add_u32 v29, 2048, v29
  v_pk_mul_f16 v60, v40, v45 op_sel:[0,1] op_sel_hi:[1,0]
  v_mfma_f32_16x16x32_f16 v[72:75], v[144:147], v[56:59], v[72:75]
  ds_read_b128 v[156:159], v28 offset:42432
  v_pk_mul_f16 v61, v40, v46 op_sel:[0,0] op_sel_hi:[1,1]
  v_pk_mul_f16 v62, v40, v46 op_sel:[0,1] op_sel_hi:[1,0]
  s_waitcnt lgkmcnt(14)
  v_smfmac_f32_16x16x64_f16 v[80:83], v[224:227], v[52:59], v16
  ds_read_b128 v[160:163], v28 offset:43456
  v_pk_mul_f16 v63, v41, v44 op_sel:[0,0] op_sel_hi:[1,1]
  v_mfma_f32_16x16x32_f16 v[76:79], v[184:187], v[52:55], v[76:79]
  ds_read_b128 v[112:115], v28 offset:7168
  v_pk_mul_f16 v64, v41, v44 op_sel:[0,1] op_sel_hi:[1,0]
  v_pk_mul_f16 v65, v41, v45 op_sel:[0,0] op_sel_hi:[1,1]
  v_mfma_f32_16x16x32_f16 v[76:79], v[188:191], v[56:59], v[76:79]
  ds_read_b128 v[116:119], v28 offset:8192
  v_pk_mul_f16 v66, v41, v45 op_sel:[0,1] op_sel_hi:[1,0]
  v_mfma_f32_16x16x32_f16 v[68:71], v[96:99], v[52:55], v[68:71]
  ds_read_b128 v[120:123], v28 offset:9216
  v_pk_mul_f16 v67, v41, v46 op_sel:[0,0] op_sel_hi:[1,1]
  ds_write_b16 v15, v14 offset:4064
  s_and_b32 s81, s2, 7
  s_waitcnt vmcnt(2)
  v_cmp_eq_u32 vcc, 0, v249
  s_nop 0
  s_bitcmp1_b32 vcc_lo, s81
  s_cbranch_scc0 L_cclr_ok
  s_mov_b32 s78, 0x40000
L_cclr:
  s_sub_u32 s78, s78, 1
  s_cbranch_scc1 L_cclr_ok
  v_lshlrev_b32 v249, 2, v0
  v_and_b32 v249, 31, v249
  buffer_load_dword v249, v249, s[64:67], 0 offen offset:128 sc1
  s_waitcnt vmcnt(0)
  v_cmp_eq_u32 vcc, 0, v249
  s_nop 0
  s_bitcmp1_b32 vcc_lo, s81
  s_cbranch_scc1 L_cclr
L_cclr_ok:
  v_lshl_add_u32 v24, v24, 7, v18
  v_lshl_add_u32 v25, v25, 7, v18
  s_mov_b32 exec_hi, 0x0000ffff
  v_lshl_add_u32 v26, v26, 7, v18
  v_lshl_add_u32 v27, v27, 7, v18
  s_mov_b32 exec_lo, 0
  s_mov_b32 exec_hi, 0xffff0000
  v_mov_b32 v27, v25
  v_mov_b32 v26, v25
  s_mov_b32 exec_hi, 0x00ff0000
  v_mov_b32 v26, v24
  s_mov_b64 exec, -1
  s_add_u32 m0, s74, -39488
  s_nop 0
  buffer_load_dwordx4 v24, s[32:35], 0 offen lds
  s_add_u32 m0, s74, -38432
  s_nop 0
  buffer_load_dwordx4 v25, s[32:35], 0 offen lds
  s_add_u32 m0, s74, -37376
  s_nop 0
  buffer_load_dwordx4 v26, s[32:35], 0 offen lds
  s_add_u32 m0, s74, -36320
  s_mov_b32 exec_hi, 0x00ffffff
  buffer_load_dwordx4 v27, s[32:35], 0 offen lds
  s_mov_b32 exec_hi, -1
  s_mov_b64 exec, 131071
  buffer_load_dword v255, v19, s[44:47], s101 offen
  s_mov_b64 exec, -1
  s_add_u32 s101, s101, 1171456
  s_sub_i32 s48, 0, s48
  s_mov_b32 s49, s48
  s_mov_b32 s97, 1
  s_mov_b32 s50, 1
  s_mov_b32 s96, 0
  s_cmp_lg_u32 s3, 7
  s_cbranch_scc1 L_nw0
  s_mov_b32 s52, s16
  s_and_b32 s53, s17, 0xffff
  s_mov_b32 s54, 3328
  s_mov_b32 s55, 0x20000
  v_lshlrev_b32 v22, 7, v0
  buffer_load_dword v255, v22, s[52:55], 0 offen
L_nw0:
  v_alignbit_b32 v50, v50, v50, v13
  s_waitcnt lgkmcnt(14)
  v_mfma_f32_16x16x32_f16 v[68:71], v[100:103], v[56:59], v[68:71]
  ds_read_b128 v[124:127], v28 offset:10240
  v_pk_mul_f16 v52, v41, v46 op_sel:[0,1] op_sel_hi:[1,0]
  v_pk_mul_f16 v53, v42, v44 op_sel:[0,0] op_sel_hi:[1,1]
  v_mfma_f32_16x16x32_f16 v[68:71], v[104:107], v[60:63], v[68:71]
  ds_read_b128 v[164:167], v28 offset:44480
  v_pk_mul_f16 v54, v42, v44 op_sel:[0,1] op_sel_hi:[1,0]
  v_pk_mul_f16 v55, v42, v45 op_sel:[0,0] op_sel_hi:[1,1]
  v_mfma_f32_16x16x32_f16 v[68:71], v[108:111], v[64:67], v[68:71]
  ds_read_b128 v[168:171], v28 offset:45504
  v_pk_mul_f16 v56, v42, v45 op_sel:[0,1] op_sel_hi:[1,0]
  v_pk_mul_f16 v57, v42, v46 op_sel:[0,0] op_sel_hi:[1,1]
  v_smfmac_f32_16x16x64_f16 v[80:83], v[228:231], v[60:67], v16
  ds_read2_b32 v[236:237], v29 offset0:0 offset1:2
  ds_read2_b32 v[238:239], v29 offset0:64 offset1:66
  v_add_u32 v29, 2048, v29
  v_pk_mul_f16 v58, v42, v46 op_sel:[0,1] op_sel_hi:[1,0]
  v_pk_mul_f16 v59, v40, v48 op_sel:[0,0] op_sel_hi:[1,1]
  s_waitcnt lgkmcnt(14)
  v_mfma_f32_16x16x32_f16 v[72:75], v[148:151], v[60:63], v[72:75]
  ds_read_b128 v[208:211], v31 offset:20480
  ds_read_u16_d16_hi v34, v7 offset:288
  ds_read_u16_d16_hi v35, v7 offset:416
  v_mfma_f32_16x16x32_f16 v[72:75], v[152:155], v[64:67], v[72:75]
  ds_read_b128 v[212:215], v31 offset:21504
  ds_read_u16_d16_hi v36, v7 offset:544
  ds_read_u16_d16_hi v37, v7 offset:672
  v_mfma_f32_16x16x32_f16 v[76:79], v[192:195], v[60:63], v[76:79]
  ds_read_u16_d16_hi v38, v7 offset:800
  ds_read_u16_d16_hi v39, v7 offset:928
  v_mfma_f32_16x16x32_f16 v[76:79], v[196:199], v[64:67], v[76:79]
  v_pk_mul_f16 v60, v41, v49 op_sel:[0,0] op_sel_hi:[1,1]
  v_pk_mul_f16 v61, v42, v50 op_sel:[0,0] op_sel_hi:[1,1]
  v_mfma_f32_16x16x32_f16 v[76:79], v[200:203], v[52:55], v[76:79]
  v_pk_mul_f16 v62, v40, v49 op_sel:[0,0] op_sel_hi:[1,1]
  v_pk_mul_f16 v63, v40, v49 op_sel:[0,1] op_sel_hi:[1,0]
  s_waitcnt lgkmcnt(14)
  v_mfma_f32_16x16x32_f16 v[76:79], v[204:207], v[56:59], v[76:79]
  v_pk_mul_f16 v64, v40, v50 op_sel:[0,0] op_sel_hi:[1,1]
  v_pk_mul_f16 v65, v40, v50 op_sel:[0,1] op_sel_hi:[1,0]
  v_smfmac_f32_16x16x64_f16 v[80:83], v[232:235], v[52:59], v16
  v_pk_mul_f16 v66, v41, v50 op_sel:[0,0] op_sel_hi:[1,1]
  v_pk_mul_f16 v67, v41, v50 op_sel:[0,1] op_sel_hi:[1,0]
  v_mfma_f32_16x16x32_f16 v[72:75], v[156:159], v[52:55], v[72:75]
  s_waitcnt lgkmcnt(0)
  v_cvt_pk_f16_f32 v43, v38, v39
  v_mfma_f32_16x16x32_f16 v[72:75], v[160:163], v[56:59], v[72:75]
  v_cvt_pk_f16_f32 v40, v32, v35
  v_cvt_pk_f16_f32 v41, v33, v36
  v_mfma_f32_16x16x32_f16 v[68:71], v[112:115], v[52:55], v[68:71]
  v_cvt_pk_f16_f32 v42, v34, v37
  v_mfma_f32_16x16x32_f16 v[68:71], v[116:119], v[56:59], v[68:71]
  ds_write_b128 v10, v[40:43]
  v_mfma_f32_16x16x32_f16 v[68:71], v[120:123], v[60:63], v[68:71]
  v_mfma_f32_16x16x32_f16 v[68:71], v[124:127], v[64:67], v[68:71]
  ds_read_b128 v[44:47], v11
  ds_read_b128 v[48:51], v12
  v_mfma_f32_16x16x32_f16 v[72:75], v[164:167], v[60:63], v[72:75]
  ds_read_b64_tr_b16 v[52:53], v8 offset:32
  ds_read_b64_tr_b16 v[54:55], v8 offset:544
  v_mfma_f32_16x16x32_f16 v[72:75], v[168:171], v[64:67], v[72:75]
  v_pk_mul_f16 v56, v40, v40 op_sel:[0,0] op_sel_hi:[1,1]
  v_pk_mul_f16 v57, v41, v41 op_sel:[0,0] op_sel_hi:[1,1]
  v_smfmac_f32_16x16x64_f16 v[80:83], v[236:239], v[60:67], v16
  v_pk_mul_f16 v58, v42, v42 op_sel:[0,0] op_sel_hi:[1,1]
  v_pk_mul_f16 v59, v40, v41 op_sel:[0,0] op_sel_hi:[1,1]
  v_mfma_f32_16x16x32_f16 v[76:79], v[208:211], v[60:63], v[76:79]
  s_nop 1
  v_mul_f32 v14, v68, v72
  v_fmac_f32 v14, v69, v73
  v_mfma_f32_16x16x32_f16 v[76:79], v[212:215], v[64:67], v[76:79]
  v_fmac_f32 v14, v70, v74
  v_fmac_f32 v14, v71, v75
  ds_add_u32 v1, v3 offset:12
  s_branch L_grp1
L_prime:
  v_mov_b32 v68, 0
  v_mov_b32 v69, 0
  v_mov_b32 v70, 0
  v_mov_b32 v71, 0
  v_mov_b32 v72, 0
  v_mov_b32 v73, 0
  v_mov_b32 v74, 0
  v_mov_b32 v75, 0
  v_mov_b32 v76, 0
  v_mov_b32 v77, 0
  v_mov_b32 v78, 0
  v_mov_b32 v79, 0
  v_mov_b32 v80, 0
  v_mov_b32 v81, 0
  v_mov_b32 v82, 0
  v_mov_b32 v83, 0
  v_mov_b32 v22, 0
  v_mov_b32 v23, 0
  ds_read_u16_d16_hi v32, v7 offset:0
  ds_read_u16_d16_hi v33, v7 offset:128
  ds_read_u16_d16_hi v34, v7 offset:256
  ds_read_u16_d16_hi v35, v7 offset:384
  ds_read_u16_d16_hi v36, v7 offset:512
  ds_read_u16_d16_hi v37, v7 offset:640
  ds_read_u16_d16_hi v38, v7 offset:768
  ds_read_u16_d16_hi v39, v7 offset:896
  s_waitcnt lgkmcnt(0)
  v_cvt_pk_f16_f32 v43, v38, v39
  v_cvt_pk_f16_f32 v40, v32, v35
  v_cvt_pk_f16_f32 v41, v33, v36
  v_cvt_pk_f16_f32 v42, v34, v37
  ds_write_b128 v10, v[40:43]
  ds_read_b128 v[44:47], v11
  ds_read_b128 v[48:51], v12
  ds_read_b64_tr_b16 v[52:53], v8 offset:0
  ds_read_b64_tr_b16 v[54:55], v8 offset:512
  v_pk_mul_f16 v56, v40, v40 op_sel:[0,0] op_sel_hi:[1,1]
  v_pk_mul_f16 v57, v41, v41 op_sel:[0,0] op_sel_hi:[1,1]
  v_pk_mul_f16 v58, v42, v42 op_sel:[0,0] op_sel_hi:[1,1]
  v_pk_mul_f16 v59, v40, v41 op_sel:[0,0] op_sel_hi:[1,1]
  ds_read_u16_d16_hi v32, v7 offset:32
  ds_read_u16_d16_hi v33, v7 offset:160
L_cin_loop:
  s_cmp_lg_u32 s84, 0
  s_cbranch_scc1 L_pr0
  s_setprio 2
L_pr0:
  s_waitcnt lgkmcnt(2)
  v_mfma_f32_16x16x32_bf16 v[72:75], v[240:243], v[52:55], 0
  v_add_f32 v22, v80, v81
  v_add_f32 v23, v82, v83
  v_mfma_f32_16x16x32_f16 v[72:75], v[128:131], v[56:59], v[72:75]
  v_fmac_f32 v14, v76, v77
  v_fmac_f32 v14, v22, v78
  v_mfma_f32_16x16x32_f16 v[68:71], v[84:87], v[56:59], 0
  v_fmac_f32 v14, v23, v79
  v_pk_mul_f16 v60, v40, v41 op_sel:[0,1] op_sel_hi:[1,0]
  v_mfma_f32_16x16x32_f16 v[80:83], v[216:219], v[56:59], 0
  v_pk_mul_f16 v61, v40, v42 op_sel:[0,0] op_sel_hi:[1,1]
  v_pk_mul_f16 v62, v40, v42 op_sel:[0,1] op_sel_hi:[1,0]
  v_mfma_f32_16x16x32_bf16 v[76:79], v[244:247], v[52:55], 0
  v_pk_mul_f16 v63, v41, v42 op_sel:[0,0] op_sel_hi:[1,1]
  v_pk_mul_f16 v64, v41, v42 op_sel:[0,1] op_sel_hi:[1,0]
  v_mfma_f32_16x16x32_f16 v[76:79], v[172:175], v[56:59], v[76:79]
  v_pk_mul_f16 v65, v40, v43 op_sel:[0,0] op_sel_hi:[1,0]
  v_pk_mul_f16 v66, v41, v43 op_sel:[0,0] op_sel_hi:[1,0]
  v_pk_mul_f16 v67, v42, v43 op_sel:[0,0] op_sel_hi:[1,0]
  v_mfma_f32_16x16x32_f16 v[76:79], v[176:179], v[60:63], v[76:79]
  v_add_f32_dpp v14, v14, v14 row_shr:1 row_mask:0xf bank_mask:0xf
  v_alignbit_b32 v48, v48, v48, v13
  v_mfma_f32_16x16x32_f16 v[76:79], v[180:183], v[64:67], v[76:79]
  v_mul_f16_sdwa v52, v40, v40 dst_sel:WORD_0 dst_unused:UNUSED_PAD src0_sel:WORD_0 src1_sel:WORD_1
  v_mul_f16_sdwa v53, v42, v42 dst_sel:WORD_0 dst_unused:UNUSED_PAD src0_sel:WORD_0 src1_sel:WORD_1
  v_smfmac_f32_16x16x64_f16 v[80:83], v[220:223], v[60:67], v16
  v_add_f32_dpp v14, v14, v14 row_shr:2 row_mask:0xf bank_mask:0xf
  v_alignbit_b32 v49, v49, v49, v13
  v_mfma_f32_16x16x32_f16 v[68:71], v[88:91], v[60:63], v[68:71]
  v_mul_f16_sdwa v52, v41, v41 dst_sel:WORD_1 dst_unused:UNUSED_PRESERVE src0_sel:WORD_0 src1_sel:WORD_1
  v_mul_f16_sdwa v53, v43, v43 dst_sel:WORD_1 dst_unused:UNUSED_PRESERVE src0_sel:WORD_0 src1_sel:WORD_1
  v_mfma_f32_16x16x32_f16 v[68:71], v[92:95], v[64:67], v[68:71]
  v_add_f32_dpp v14, v14, v14 row_shr:4 row_mask:0xf bank_mask:0xf
  v_pk_mul_f16 v54, v40, v47 op_sel:[0,0] op_sel_hi:[1,0]
  v_mfma_f32_16x16x32_f16 v[72:75], v[132:135], v[60:63], v[72:75]
  v_pk_mul_f16 v55, v41, v47 op_sel:[0,0] op_sel_hi:[1,0]
  v_pk_mul_f16 v56, v42, v47 op_sel:[0,0] op_sel_hi:[1,0]
  v_mfma_f32_16x16x32_f16 v[72:75], v[136:139], v[64:67], v[72:75]
  v_pk_mul_f16 v57, v40, v44 op_sel:[0,0] op_sel_hi:[1,1]
  v_pk_mul_f16 v58, v40, v44 op_sel:[0,1] op_sel_hi:[1,0]
  v_pk_mul_f16 v59, v40, v45 op_sel:[0,0] op_sel_hi:[1,1]
  v_mfma_f32_16x16x32_f16 v[72:75], v[140:143], v[52:55], v[72:75]
  v_add_f32_dpp v14, v14, v14 row_shr:8 row_mask:0xf bank_mask:0xf
  v_pk_mul_f16 v60, v40, v45 op_sel:[0,1] op_sel_hi:[1,0]
  v_mfma_f32_16x16x32_f16 v[72:75], v[144:147], v[56:59], v[72:75]
  v_pk_mul_f16 v61, v40, v46 op_sel:[0,0] op_sel_hi:[1,1]
  v_pk_mul_f16 v62, v40, v46 op_sel:[0,1] op_sel_hi:[1,0]
  v_smfmac_f32_16x16x64_f16 v[80:83], v[224:227], v[52:59], v16
  v_add_f32_dpp v14, v14, v14 row_bcast:15 row_mask:0xa bank_mask:0xf
  v_pk_mul_f16 v63, v41, v44 op_sel:[0,0] op_sel_hi:[1,1]
  v_mfma_f32_16x16x32_f16 v[76:79], v[184:187], v[52:55], v[76:79]
  v_pk_mul_f16 v64, v41, v44 op_sel:[0,1] op_sel_hi:[1,0]
  v_pk_mul_f16 v65, v41, v45 op_sel:[0,0] op_sel_hi:[1,1]
  v_mfma_f32_16x16x32_f16 v[76:79], v[188:191], v[56:59], v[76:79]
  v_add_f32_dpp v14, v14, v14 row_bcast:31 row_mask:0xc bank_mask:0xf
  v_pk_mul_f16 v66, v41, v45 op_sel:[0,1] op_sel_hi:[1,0]
  v_mfma_f32_16x16x32_f16 v[68:71], v[96:99], v[52:55], v[68:71]
  v_pk_mul_f16 v67, v41, v46 op_sel:[0,0] op_sel_hi:[1,1]
  s_waitcnt vmcnt(0)
L_blk:
  s_cmp_eq_u32 s50, 0
  s_cbranch_scc1 L_blkend
  v_readlane_b32 s81, v14, 63
  v_ldexp_f32 v14, v14, s49
  v_and_b32 v14, -2, v14
  s_cmp_ge_u32 s50, 2
  s_cbranch_scc1 L_good
  s_cmp_eq_u64 s[90:91], 0
  s_cbranch_scc1 L_slow
  s_bfe_u32 s81, s81, 0x80017
  s_cmp_eq_u32 s81, 255
  s_cbranch_scc1 L_slow
L_good:
  s_mov_b32 exec_lo, 0
  s_mov_b32 exec_hi, 0x80000000
  buffer_store_dword v14, v251, s[60:63], s85 offen sc1
  s_mov_b64 exec, -1
  s_add_u32 s85, s85, 32
  s_sub_u32 s72, s72, 1
  s_cmp_eq_u32 s72, 0
  s_cbranch_scc1 L_cin_done
  s_cmp_eq_u32 s72, 1
  s_cbranch_scc1 L_lastnext
  v_lshl_add_u32 v24, v24, 7, v18
  v_lshl_add_u32 v25, v25, 7, v18
  s_mov_b32 exec_hi, 0x0000ffff
  v_lshl_add_u32 v26, v26, 7, v18
  v_lshl_add_u32 v27, v27, 7, v18
  s_mov_b32 exec_lo, 0
  s_mov_b32 exec_hi, 0xffff0000
  v_mov_b32 v27, v25
  v_mov_b32 v26, v25
  s_mov_b32 exec_hi, 0x00ff0000
  v_mov_b32 v26, v24
  s_mov_b64 exec, -1
  s_add_u32 m0, s74, 0
  s_nop 0
  buffer_load_dwordx4 v24, s[32:35], 0 offen lds
  s_add_u32 m0, s74, 1056
  s_nop 0
  buffer_load_dwordx4 v25, s[32:35], 0 offen lds
  s_add_u32 m0, s74, 2112
  s_nop 0
  buffer_load_dwordx4 v26, s[32:35], 0 offen lds
  s_add_u32 m0, s74, 3168
  s_mov_b32 exec_hi, 0x00ffffff
  buffer_load_dwordx4 v27, s[32:35], 0 offen lds
  s_mov_b32 exec_hi, -1
  s_add_u32 s94, s94, 832
  s_cmp_lg_u32 s72, s99
  s_cbranch_scc1 L_nodma
  s_lshr_b32 s81, s98, 14
  v_cmp_eq_u32 vcc, 0, v249
  s_nop 0
  s_bitcmp1_b32 vcc_lo, s81
  s_cbranch_scc0 L_tclr_ok
  s_mov_b32 s78, 0x40000
L_tclr:
  s_sub_u32 s78, s78, 1
  s_cbranch_scc1 L_tclr_ok
  v_lshlrev_b32 v249, 2, v0
  v_and_b32 v249, 31, v249
  buffer_load_dword v249, v249, s[64:67], 0 offen offset:128 sc1
  s_waitcnt vmcnt(0)
  v_cmp_eq_u32 vcc, 0, v249
  s_nop 0
  s_bitcmp1_b32 vcc_lo, s81
  s_cbranch_scc1 L_tclr
L_tclr_ok:
  v_mov_b32 v250, 1
  s_mov_b64 exec, 1
  buffer_atomic_add v250, v251, s[60:63], s98 offen sc0
  s_mov_b64 exec, -1
  s_mov_b32 s99, 8
  s_branch L_nodma
L_lastnext:
  s_cmp_lt_i32 s26, 0
  s_cselect_b32 s85, s85, s26
L_nodma:
  s_add_u32 s74, s74, s75
  s_sub_u32 s75, 0, s75
  s_mov_b32 s49, s48
  s_mov_b32 s97, 1
  s_cmp_eq_u32 s50, 3
  s_cbranch_scc1 L_slow2
L_blkend:
  s_mov_b32 s50, s97
  s_cmp_ge_u32 s101, 5537792
  s_cbranch_scc1 L_npf
  s_mov_b64 exec, 131071
  buffer_load_dword v255, v19, s[44:47], s101 offen
  s_mov_b64 exec, -1
  s_add_u32 s101, s101, 1171456
L_npf:
  v_alignbit_b32 v50, v50, v50, v13
  v_mfma_f32_16x16x32_f16 v[68:71], v[100:103], v[56:59], v[68:71]
  v_pk_mul_f16 v52, v41, v46 op_sel:[0,1] op_sel_hi:[1,0]
  v_pk_mul_f16 v53, v42, v44 op_sel:[0,0] op_sel_hi:[1,1]
  v_mfma_f32_16x16x32_f16 v[68:71], v[104:107], v[60:63], v[68:71]
  v_pk_mul_f16 v54, v42, v44 op_sel:[0,1] op_sel_hi:[1,0]
  v_pk_mul_f16 v55, v42, v45 op_sel:[0,0] op_sel_hi:[1,1]
  v_mfma_f32_16x16x32_f16 v[68:71], v[108:111], v[64:67], v[68:71]
  v_pk_mul_f16 v56, v42, v45 op_sel:[0,1] op_sel_hi:[1,0]
  v_pk_mul_f16 v57, v42, v46 op_sel:[0,0] op_sel_hi:[1,1]
  v_smfmac_f32_16x16x64_f16 v[80:83], v[228:231], v[60:67], v16
  v_pk_mul_f16 v58, v42, v46 op_sel:[0,1] op_sel_hi:[1,0]
  v_pk_mul_f16 v59, v40, v48 op_sel:[0,0] op_sel_hi:[1,1]
  v_mfma_f32_16x16x32_f16 v[72:75], v[148:151], v[60:63], v[72:75]
  ds_read_u16_d16_hi v34, v7 offset:288
  ds_read_u16_d16_hi v35, v7 offset:416
  v_mfma_f32_16x16x32_f16 v[72:75], v[152:155], v[64:67], v[72:75]
  ds_read_u16_d16_hi v36, v7 offset:544
  ds_read_u16_d16_hi v37, v7 offset:672
  v_mfma_f32_16x16x32_f16 v[76:79], v[192:195], v[60:63], v[76:79]
  ds_read_u16_d16_hi v38, v7 offset:800
  ds_read_u16_d16_hi v39, v7 offset:928
  v_mfma_f32_16x16x32_f16 v[76:79], v[196:199], v[64:67], v[76:79]
  v_pk_mul_f16 v60, v41, v49 op_sel:[0,0] op_sel_hi:[1,1]
  v_pk_mul_f16 v61, v42, v50 op_sel:[0,0] op_sel_hi:[1,1]
  v_mfma_f32_16x16x32_f16 v[76:79], v[200:203], v[52:55], v[76:79]
  v_pk_mul_f16 v62, v40, v49 op_sel:[0,0] op_sel_hi:[1,1]
  v_pk_mul_f16 v63, v40, v49 op_sel:[0,1] op_sel_hi:[1,0]
  v_mfma_f32_16x16x32_f16 v[76:79], v[204:207], v[56:59], v[76:79]
  v_pk_mul_f16 v64, v40, v50 op_sel:[0,0] op_sel_hi:[1,1]
  v_pk_mul_f16 v65, v40, v50 op_sel:[0,1] op_sel_hi:[1,0]
  v_smfmac_f32_16x16x64_f16 v[80:83], v[232:235], v[52:59], v16
  v_pk_mul_f16 v66, v41, v50 op_sel:[0,0] op_sel_hi:[1,1]
  v_pk_mul_f16 v67, v41, v50 op_sel:[0,1] op_sel_hi:[1,0]
  v_mfma_f32_16x16x32_f16 v[72:75], v[156:159], v[52:55], v[72:75]
  s_waitcnt lgkmcnt(0)
  v_cvt_pk_f16_f32 v43, v38, v39
  v_mfma_f32_16x16x32_f16 v[72:75], v[160:163], v[56:59], v[72:75]
  v_cvt_pk_f16_f32 v40, v32, v35
  v_cvt_pk_f16_f32 v41, v33, v36
  v_mfma_f32_16x16x32_f16 v[68:71], v[112:115], v[52:55], v[68:71]
  v_cvt_pk_f16_f32 v42, v34, v37
  v_mfma_f32_16x16x32_f16 v[68:71], v[116:119], v[56:59], v[68:71]
  ds_write_b128 v10, v[40:43]
  v_mfma_f32_16x16x32_f16 v[68:71], v[120:123], v[60:63], v[68:71]
  v_mfma_f32_16x16x32_f16 v[68:71], v[124:127], v[64:67], v[68:71]
  ds_read_b128 v[44:47], v11
  ds_read_b128 v[48:51], v12
  v_mfma_f32_16x16x32_f16 v[72:75], v[164:167], v[60:63], v[72:75]
  ds_read_b64_tr_b16 v[52:53], v8 offset:32
  ds_read_b64_tr_b16 v[54:55], v8 offset:544
  v_mfma_f32_16x16x32_f16 v[72:75], v[168:171], v[64:67], v[72:75]
  v_pk_mul_f16 v56, v40, v40 op_sel:[0,0] op_sel_hi:[1,1]
  v_pk_mul_f16 v57, v41, v41 op_sel:[0,0] op_sel_hi:[1,1]
  v_smfmac_f32_16x16x64_f16 v[80:83], v[236:239], v[60:67], v16
  v_pk_mul_f16 v58, v42, v42 op_sel:[0,0] op_sel_hi:[1,1]
  v_pk_mul_f16 v59, v40, v41 op_sel:[0,0] op_sel_hi:[1,1]
  v_mfma_f32_16x16x32_f16 v[76:79], v[208:211], v[60:63], v[76:79]
  s_nop 1
  v_mul_f32 v14, v68, v72
  v_fmac_f32 v14, v69, v73
  v_mfma_f32_16x16x32_f16 v[76:79], v[212:215], v[64:67], v[76:79]
  v_fmac_f32 v14, v70, v74
  v_fmac_f32 v14, v71, v75
L_grp1:
  s_waitcnt lgkmcnt(0)
  v_mfma_f32_16x16x32_bf16 v[72:75], v[240:243], v[52:55], 0
  v_add_f32 v22, v80, v81
  v_add_f32 v23, v82, v83
  v_mfma_f32_16x16x32_f16 v[72:75], v[128:131], v[56:59], v[72:75]
  s_nop 0
  v_fmac_f32 v14, v76, v77
  v_fmac_f32 v14, v22, v78
  v_mfma_f32_16x16x32_f16 v[68:71], v[84:87], v[56:59], 0
  v_fmac_f32 v14, v23, v79
  v_pk_mul_f16 v60, v40, v41 op_sel:[0,1] op_sel_hi:[1,0]
  v_mfma_f32_16x16x32_f16 v[80:83], v[216:219], v[56:59], 0
  v_pk_mul_f16 v61, v40, v42 op_sel:[0,0] op_sel_hi:[1,1]
  v_pk_mul_f16 v62, v40, v42 op_sel:[0,1] op_sel_hi:[1,0]
  v_mfma_f32_16x16x32_bf16 v[76:79], v[244:247], v[52:55], 0
  v_pk_mul_f16 v63, v41, v42 op_sel:[0,0] op_sel_hi:[1,1]
  v_pk_mul_f16 v64, v41, v42 op_sel:[0,1] op_sel_hi:[1,0]
  v_mfma_f32_16x16x32_f16 v[76:79], v[172:175], v[56:59], v[76:79]
  v_pk_mul_f16 v65, v40, v43 op_sel:[0,0] op_sel_hi:[1,0]
  v_pk_mul_f16 v66, v41, v43 op_sel:[0,0] op_sel_hi:[1,0]
  v_pk_mul_f16 v67, v42, v43 op_sel:[0,0] op_sel_hi:[1,0]
  v_mfma_f32_16x16x32_f16 v[76:79], v[176:179], v[60:63], v[76:79]
  v_or3_b32 v15, v56, v57, v58
  v_alignbit_b32 v48, v48, v48, v13
  v_mfma_f32_16x16x32_f16 v[76:79], v[180:183], v[64:67], v[76:79]
  v_mul_f16_sdwa v52, v40, v40 dst_sel:WORD_0 dst_unused:UNUSED_PAD src0_sel:WORD_0 src1_sel:WORD_1
  v_mul_f16_sdwa v53, v42, v42 dst_sel:WORD_0 dst_unused:UNUSED_PAD src0_sel:WORD_0 src1_sel:WORD_1
  v_smfmac_f32_16x16x64_f16 v[80:83], v[220:223], v[60:67], v16
  v_mul_f16_sdwa v52, v41, v41 dst_sel:WORD_1 dst_unused:UNUSED_PRESERVE src0_sel:WORD_0 src1_sel:WORD_1
  v_mul_f16_sdwa v53, v43, v43 dst_sel:WORD_1 dst_unused:UNUSED_PRESERVE src0_sel:WORD_0 src1_sel:WORD_1
  v_mfma_f32_16x16x32_f16 v[68:71], v[88:91], v[60:63], v[68:71]
  v_pk_mul_f16 v54, v40, v47 op_sel:[0,0] op_sel_hi:[1,0]
  v_pk_mul_f16 v55, v41, v47 op_sel:[0,0] op_sel_hi:[1,0]
  v_mfma_f32_16x16x32_f16 v[68:71], v[92:95], v[64:67], v[68:71]
  v_pk_mul_f16 v56, v42, v47 op_sel:[0,0] op_sel_hi:[1,0]
  v_pk_mul_f16 v57, v40, v44 op_sel:[0,0] op_sel_hi:[1,1]
  v_mfma_f32_16x16x32_f16 v[72:75], v[132:135], v[60:63], v[72:75]
  v_pk_mul_f16 v58, v40, v44 op_sel:[0,1] op_sel_hi:[1,0]
  v_pk_mul_f16 v59, v40, v45 op_sel:[0,0] op_sel_hi:[1,1]
  v_mfma_f32_16x16x32_f16 v[72:75], v[136:139], v[64:67], v[72:75]
  v_pk_mul_f16 v60, v40, v45 op_sel:[0,1] op_sel_hi:[1,0]
  v_pk_mul_f16 v61, v40, v46 op_sel:[0,0] op_sel_hi:[1,1]
  v_mfma_f32_16x16x32_f16 v[72:75], v[140:143], v[52:55], v[72:75]
  v_pk_mul_f16 v62, v40, v46 op_sel:[0,1] op_sel_hi:[1,0]
  v_pk_mul_f16 v63, v41, v44 op_sel:[0,0] op_sel_hi:[1,1]
  v_mfma_f32_16x16x32_f16 v[72:75], v[144:147], v[56:59], v[72:75]
  v_pk_mul_f16 v64, v41, v44 op_sel:[0,1] op_sel_hi:[1,0]
  v_pk_mul_f16 v65, v41, v45 op_sel:[0,0] op_sel_hi:[1,1]
  v_smfmac_f32_16x16x64_f16 v[80:83], v[224:227], v[52:59], v16
  v_pk_mul_f16 v66, v41, v45 op_sel:[0,1] op_sel_hi:[1,0]
  v_pk_mul_f16 v67, v41, v46 op_sel:[0,0] op_sel_hi:[1,1]
  v_mfma_f32_16x16x32_f16 v[76:79], v[184:187], v[52:55], v[76:79]
  v_alignbit_b32 v49, v49, v49, v13
  v_alignbit_b32 v50, v50, v50, v13
  v_mfma_f32_16x16x32_f16 v[76:79], v[188:191], v[56:59], v[76:79]
  ds_read_u16_d16_hi v32, v7 offset:64
  ds_read_u16_d16_hi v33, v7 offset:192
  v_mfma_f32_16x16x32_f16 v[68:71], v[96:99], v[52:55], v[68:71]
  v_pk_mul_f16 v52, v41, v46 op_sel:[0,1] op_sel_hi:[1,0]
  v_pk_mul_f16 v53, v42, v44 op_sel:[0,0] op_sel_hi:[1,1]
  v_mfma_f32_16x16x32_f16 v[68:71], v[100:103], v[56:59], v[68:71]
  v_pk_mul_f16 v54, v42, v44 op_sel:[0,1] op_sel_hi:[1,0]
  v_pk_mul_f16 v55, v42, v45 op_sel:[0,0] op_sel_hi:[1,1]
  v_mfma_f32_16x16x32_f16 v[68:71], v[104:107], v[60:63], v[68:71]
  v_pk_mul_f16 v56, v42, v45 op_sel:[0,1] op_sel_hi:[1,0]
  v_pk_mul_f16 v57, v42, v46 op_sel:[0,0] op_sel_hi:[1,1]
  v_mfma_f32_16x16x32_f16 v[68:71], v[108:111], v[64:67], v[68:71]
  v_pk_mul_f16 v58, v42, v46 op_sel:[0,1] op_sel_hi:[1,0]
  v_pk_mul_f16 v59, v40, v48 op_sel:[0,0] op_sel_hi:[1,1]
  v_smfmac_f32_16x16x64_f16 v[80:83], v[228:231], v[60:67], v16
  ds_read_u16_d16_hi v34, v7 offset:320
  ds_read_u16_d16_hi v35, v7 offset:448
  v_mfma_f32_16x16x32_f16 v[72:75], v[148:151], v[60:63], v[72:75]
  ds_read_u16_d16_hi v36, v7 offset:576
  ds_read_u16_d16_hi v37, v7 offset:704
  v_mfma_f32_16x16x32_f16 v[72:75], v[152:155], v[64:67], v[72:75]
  ds_read_u16_d16_hi v38, v7 offset:832
  ds_read_u16_d16_hi v39, v7 offset:960
  v_mfma_f32_16x16x32_f16 v[76:79], v[192:195], v[60:63], v[76:79]
  v_and_b32 v15, 0x60006000, v15
  v_cmp_ne_u32 s[90:91], 0, v15
  v_mfma_f32_16x16x32_f16 v[76:79], v[196:199], v[64:67], v[76:79]
  v_pk_mul_f16 v60, v41, v49 op_sel:[0,0] op_sel_hi:[1,1]
  v_pk_mul_f16 v61, v42, v50 op_sel:[0,0] op_sel_hi:[1,1]
  v_mfma_f32_16x16x32_f16 v[76:79], v[200:203], v[52:55], v[76:79]
  v_pk_mul_f16 v62, v40, v49 op_sel:[0,0] op_sel_hi:[1,1]
  v_pk_mul_f16 v63, v40, v49 op_sel:[0,1] op_sel_hi:[1,0]
  v_mfma_f32_16x16x32_f16 v[76:79], v[204:207], v[56:59], v[76:79]
  v_pk_mul_f16 v64, v40, v50 op_sel:[0,0] op_sel_hi:[1,1]
  v_pk_mul_f16 v65, v40, v50 op_sel:[0,1] op_sel_hi:[1,0]
  v_smfmac_f32_16x16x64_f16 v[80:83], v[232:235], v[52:59], v16
  v_pk_mul_f16 v66, v41, v50 op_sel:[0,0] op_sel_hi:[1,1]
  v_pk_mul_f16 v67, v41, v50 op_sel:[0,1] op_sel_hi:[1,0]
  v_mfma_f32_16x16x32_f16 v[72:75], v[156:159], v[52:55], v[72:75]
  s_waitcnt lgkmcnt(0)
  v_cvt_pk_f16_f32 v43, v38, v39
  v_mfma_f32_16x16x32_f16 v[72:75], v[160:163], v[56:59], v[72:75]
  v_cvt_pk_f16_f32 v40, v32, v35
  v_cvt_pk_f16_f32 v41, v33, v36
  v_mfma_f32_16x16x32_f16 v[68:71], v[112:115], v[52:55], v[68:71]
  v_cvt_pk_f16_f32 v42, v34, v37
  v_mfma_f32_16x16x32_f16 v[68:71], v[116:119], v[56:59], v[68:71]
  ds_write_b128 v10, v[40:43]
  v_mfma_f32_16x16x32_f16 v[68:71], v[120:123], v[60:63], v[68:71]
  v_mfma_f32_16x16x32_f16 v[68:71], v[124:127], v[64:67], v[68:71]
  ds_read_b128 v[44:47], v11
  ds_read_b128 v[48:51], v12
  v_mfma_f32_16x16x32_f16 v[72:75], v[164:167], v[60:63], v[72:75]
  ds_read_b64_tr_b16 v[52:53], v8 offset:64
  ds_read_b64_tr_b16 v[54:55], v8 offset:576
  v_mfma_f32_16x16x32_f16 v[72:75], v[168:171], v[64:67], v[72:75]
  v_pk_mul_f16 v56, v40, v40 op_sel:[0,0] op_sel_hi:[1,1]
  v_pk_mul_f16 v57, v41, v41 op_sel:[0,0] op_sel_hi:[1,1]
  v_smfmac_f32_16x16x64_f16 v[80:83], v[236:239], v[60:67], v16
  v_pk_mul_f16 v58, v42, v42 op_sel:[0,0] op_sel_hi:[1,1]
  v_pk_mul_f16 v59, v40, v41 op_sel:[0,0] op_sel_hi:[1,1]
  v_mfma_f32_16x16x32_f16 v[76:79], v[208:211], v[60:63], v[76:79]
  s_nop 1
  v_fmac_f32 v14, v68, v72
  v_fmac_f32 v14, v69, v73
  v_mfma_f32_16x16x32_f16 v[76:79], v[212:215], v[64:67], v[76:79]
  v_fmac_f32 v14, v70, v74
  v_fmac_f32 v14, v71, v75
  s_cmp_eq_u32 s72, s96
  s_cbranch_scc1 L_htail
  s_waitcnt lgkmcnt(0)
  v_mfma_f32_16x16x32_bf16 v[72:75], v[240:243], v[52:55], 0
  v_add_f32 v22, v80, v81
  v_add_f32 v23, v82, v83
  v_mfma_f32_16x16x32_f16 v[72:75], v[128:131], v[56:59], v[72:75]
  v_fmac_f32 v14, v76, v77
  v_fmac_f32 v14, v22, v78
  v_mfma_f32_16x16x32_f16 v[68:71], v[84:87], v[56:59], 0
  v_fmac_f32 v14, v23, v79
  v_pk_mul_f16 v60, v40, v41 op_sel:[0,1] op_sel_hi:[1,0]
  v_mfma_f32_16x16x32_f16 v[80:83], v[216:219], v[56:59], 0
  v_pk_mul_f16 v61, v40, v42 op_sel:[0,0] op_sel_hi:[1,1]
  v_pk_mul_f16 v62, v40, v42 op_sel:[0,1] op_sel_hi:[1,0]
  v_mfma_f32_16x16x32_bf16 v[76:79], v[244:247], v[52:55], 0
  v_pk_mul_f16 v63, v41, v42 op_sel:[0,0] op_sel_hi:[1,1]
  v_pk_mul_f16 v64, v41, v42 op_sel:[0,1] op_sel_hi:[1,0]
  v_mfma_f32_16x16x32_f16 v[76:79], v[172:175], v[56:59], v[76:79]
  v_pk_mul_f16 v65, v40, v43 op_sel:[0,0] op_sel_hi:[1,0]
  v_pk_mul_f16 v66, v41, v43 op_sel:[0,0] op_sel_hi:[1,0]
  v_pk_mul_f16 v67, v42, v43 op_sel:[0,0] op_sel_hi:[1,0]
  v_mfma_f32_16x16x32_f16 v[76:79], v[176:179], v[60:63], v[76:79]
  v_mul_f16_sdwa v52, v40, v40 dst_sel:WORD_0 dst_unused:UNUSED_PAD src0_sel:WORD_0 src1_sel:WORD_1
  v_mul_f16_sdwa v53, v42, v42 dst_sel:WORD_0 dst_unused:UNUSED_PAD src0_sel:WORD_0 src1_sel:WORD_1
  v_mfma_f32_16x16x32_f16 v[76:79], v[180:183], v[64:67], v[76:79]
  v_mul_f16_sdwa v52, v41, v41 dst_sel:WORD_1 dst_unused:UNUSED_PRESERVE src0_sel:WORD_0 src1_sel:WORD_1
  v_mul_f16_sdwa v53, v43, v43 dst_sel:WORD_1 dst_unused:UNUSED_PRESERVE src0_sel:WORD_0 src1_sel:WORD_1
  v_smfmac_f32_16x16x64_f16 v[80:83], v[220:223], v[60:67], v16
  v_pk_mul_f16 v54, v40, v47 op_sel:[0,0] op_sel_hi:[1,0]
  v_pk_mul_f16 v55, v41, v47 op_sel:[0,0] op_sel_hi:[1,0]
  v_mfma_f32_16x16x32_f16 v[68:71], v[88:91], v[60:63], v[68:71]
  v_pk_mul_f16 v56, v42, v47 op_sel:[0,0] op_sel_hi:[1,0]
  v_pk_mul_f16 v57, v40, v44 op_sel:[0,0] op_sel_hi:[1,1]
  v_mfma_f32_16x16x32_f16 v[68:71], v[92:95], v[64:67], v[68:71]
  v_pk_mul_f16 v58, v40, v44 op_sel:[0,1] op_sel_hi:[1,0]
  v_pk_mul_f16 v59, v40, v45 op_sel:[0,0] op_sel_hi:[1,1]
  v_mfma_f32_16x16x32_f16 v[72:75], v[132:135], v[60:63], v[72:75]
  v_pk_mul_f16 v60, v40, v45 op_sel:[0,1] op_sel_hi:[1,0]
  v_pk_mul_f16 v61, v40, v46 op_sel:[0,0] op_sel_hi:[1,1]
  v_mfma_f32_16x16x32_f16 v[72:75], v[136:139], v[64:67], v[72:75]
  v_pk_mul_f16 v62, v40, v46 op_sel:[0,1] op_sel_hi:[1,0]
  v_pk_mul_f16 v63, v41, v44 op_sel:[0,0] op_sel_hi:[1,1]
  v_mfma_f32_16x16x32_f16 v[72:75], v[140:143], v[52:55], v[72:75]
  v_pk_mul_f16 v64, v41, v44 op_sel:[0,1] op_sel_hi:[1,0]
  v_pk_mul_f16 v65, v41, v45 op_sel:[0,0] op_sel_hi:[1,1]
  v_mfma_f32_16x16x32_f16 v[72:75], v[144:147], v[56:59], v[72:75]
  v_pk_mul_f16 v66, v41, v45 op_sel:[0,1] op_sel_hi:[1,0]
  v_pk_mul_f16 v67, v41, v46 op_sel:[0,0] op_sel_hi:[1,1]
  v_smfmac_f32_16x16x64_f16 v[80:83], v[224:227], v[52:59], v16
  v_alignbit_b32 v48, v48, v48, v13
  v_alignbit_b32 v49, v49, v49, v13
  v_mfma_f32_16x16x32_f16 v[76:79], v[184:187], v[52:55], v[76:79]
  v_alignbit_b32 v50, v50, v50, v13
  ds_read_u16_d16_hi v32, v7 offset:96
  v_mfma_f32_16x16x32_f16 v[76:79], v[188:191], v[56:59], v[76:79]
  ds_read_u16_d16_hi v33, v7 offset:224
  ds_read_u16_d16_hi v34, v7 offset:352
  s_cmp_lg_u32 s99, 8
  s_cbranch_scc1 L_hk
  s_waitcnt vmcnt(0)
  v_readfirstlane_b32 s81, v250
  s_mov_b32 s99, 0
  s_add_u32 s81, s81, 1
  s_cmp_ge_u32 s81, 36
  s_cbranch_scc1 L_hk
  s_add_u32 s72, s72, 1
  s_mov_b32 s26, 10240
  s_cmp_lt_u32 s81, 20
  s_cbranch_scc1 L_hkf
  s_add_u32 s81, s81, 20
  s_and_b32 s94, s81, 1
  s_lshr_b32 s81, s81, 1
  s_mov_b32 s96, 1
  s_lshl_b32 s94, s94, 6
  v_xor_b32 v18, s94, v18
  s_lshl_b32 s94, s94, 5
  s_add_u32 s26, s26, s94
L_hkf:
  s_add_u32 s81, s81, 484
  s_lshl_b32 s94, s81, 2
  s_add_u32 s26, s26, s94
  s_andn2_b32 s94, s98, 0x3fff
  s_add_u32 s26, s26, s94
  s_lshr_b32 s94, s94, 5
  s_add_u32 s94, s94, s81
  s_mul_i32 s94, s94, 104
L_hk:
  buffer_load_dwordx4 v[24:27], v17, s[28:31], s94 offen offset:0
  v_mfma_f32_16x16x32_f16 v[68:71], v[96:99], v[52:55], v[68:71]
  v_pk_mul_f16 v52, v41, v46 op_sel:[0,1] op_sel_hi:[1,0]
  v_pk_mul_f16 v53, v42, v44 op_sel:[0,0] op_sel_hi:[1,1]
  v_mfma_f32_16x16x32_f16 v[68:71], v[100:103], v[56:59], v[68:71]
  v_pk_mul_f16 v54, v42, v44 op_sel:[0,1] op_sel_hi:[1,0]
  v_pk_mul_f16 v55, v42, v45 op_sel:[0,0] op_sel_hi:[1,1]
  v_mfma_f32_16x16x32_f16 v[68:71], v[104:107], v[60:63], v[68:71]
  v_pk_mul_f16 v56, v42, v45 op_sel:[0,1] op_sel_hi:[1,0]
  v_pk_mul_f16 v57, v42, v46 op_sel:[0,0] op_sel_hi:[1,1]
  v_mfma_f32_16x16x32_f16 v[68:71], v[108:111], v[64:67], v[68:71]
  v_pk_mul_f16 v58, v42, v46 op_sel:[0,1] op_sel_hi:[1,0]
  v_pk_mul_f16 v59, v40, v48 op_sel:[0,0] op_sel_hi:[1,1]
  v_smfmac_f32_16x16x64_f16 v[80:83], v[228:231], v[60:67], v16
  ds_read_u16_d16_hi v35, v7 offset:480
  ds_read_u16_d16_hi v36, v7 offset:608
  v_mfma_f32_16x16x32_f16 v[72:75], v[148:151], v[60:63], v[72:75]
  ds_read_u16_d16_hi v37, v7 offset:736
  ds_read_u16_d16_hi v38, v7 offset:864
  v_mfma_f32_16x16x32_f16 v[72:75], v[152:155], v[64:67], v[72:75]
  ds_read_u16_d16_hi v39, v7 offset:992
  v_mfma_f32_16x16x32_f16 v[76:79], v[192:195], v[60:63], v[76:79]
  v_pk_mul_f16 v60, v41, v49 op_sel:[0,0] op_sel_hi:[1,1]
  v_pk_mul_f16 v61, v42, v50 op_sel:[0,0] op_sel_hi:[1,1]
  v_mfma_f32_16x16x32_f16 v[76:79], v[196:199], v[64:67], v[76:79]
  v_pk_mul_f16 v62, v40, v49 op_sel:[0,0] op_sel_hi:[1,1]
  v_pk_mul_f16 v63, v40, v49 op_sel:[0,1] op_sel_hi:[1,0]
  v_mfma_f32_16x16x32_f16 v[76:79], v[200:203], v[52:55], v[76:79]
  v_pk_mul_f16 v64, v40, v50 op_sel:[0,0] op_sel_hi:[1,1]
  v_pk_mul_f16 v65, v40, v50 op_sel:[0,1] op_sel_hi:[1,0]
  s_cmp_lg_u32 s84, 0
  s_cbranch_scc1 L_pr110
  s_setprio 0
L_pr110:
  v_mfma_f32_16x16x32_f16 v[76:79], v[204:207], v[56:59], v[76:79]
  v_pk_mul_f16 v66, v41, v50 op_sel:[0,0] op_sel_hi:[1,1]
  v_pk_mul_f16 v67, v41, v50 op_sel:[0,1] op_sel_hi:[1,0]
  v_smfmac_f32_16x16x64_f16 v[80:83], v[232:235], v[52:59], v16
  s_waitcnt lgkmcnt(0)
  v_cvt_pk_f16_f32 v43, v38, v39
  v_mfma_f32_16x16x32_f16 v[72:75], v[156:159], v[52:55], v[72:75]
  v_cvt_pk_f16_f32 v40, v32, v35
  v_cvt_pk_f16_f32 v41, v33, v36
  v_mfma_f32_16x16x32_f16 v[72:75], v[160:163], v[56:59], v[72:75]
  v_cvt_pk_f16_f32 v42, v34, v37
  v_mfma_f32_16x16x32_f16 v[68:71], v[112:115], v[52:55], v[68:71]
  ds_write_b128 v10, v[40:43]
  v_mfma_f32_16x16x32_f16 v[68:71], v[116:119], v[56:59], v[68:71]
  v_add_u32 v7, s75, v7
  s_waitcnt vmcnt(1)
  v_mfma_f32_16x16x32_f16 v[68:71], v[120:123], v[60:63], v[68:71]
  ds_read_b128 v[44:47], v11
  ds_read_b128 v[48:51], v12
  v_mfma_f32_16x16x32_f16 v[68:71], v[124:127], v[64:67], v[68:71]
  ds_read_b64_tr_b16 v[52:53], v8 offset:96
  ds_read_b64_tr_b16 v[54:55], v8 offset:608
  v_mfma_f32_16x16x32_f16 v[72:75], v[164:167], v[60:63], v[72:75]
  v_pk_mul_f16 v56, v40, v40 op_sel:[0,0] op_sel_hi:[1,1]
  v_pk_mul_f16 v57, v41, v41 op_sel:[0,0] op_sel_hi:[1,1]
  v_mfma_f32_16x16x32_f16 v[72:75], v[168:171], v[64:67], v[72:75]
  v_pk_mul_f16 v58, v42, v42 op_sel:[0,0] op_sel_hi:[1,1]
  v_pk_mul_f16 v59, v40, v41 op_sel:[0,0] op_sel_hi:[1,1]
  v_smfmac_f32_16x16x64_f16 v[80:83], v[236:239], v[60:67], v16
  ds_read_u16_d16_hi v32, v7 offset:0
  ds_read_u16_d16_hi v33, v7 offset:128
  v_mfma_f32_16x16x32_f16 v[76:79], v[208:211], v[60:63], v[76:79]
  s_nop 1
  v_fmac_f32 v14, v68, v72
  v_fmac_f32 v14, v69, v73
  v_mfma_f32_16x16x32_f16 v[76:79], v[212:215], v[64:67], v[76:79]
  v_fmac_f32 v14, v70, v74
  v_fmac_f32 v14, v71, v75
  s_waitcnt lgkmcnt(2)
  v_mfma_f32_16x16x32_bf16 v[72:75], v[240:243], v[52:55], 0
  v_add_f32 v22, v80, v81
  v_add_f32 v23, v82, v83
  v_mfma_f32_16x16x32_f16 v[72:75], v[128:131], v[56:59], v[72:75]
  s_nop 0
  v_fmac_f32 v14, v76, v77
  v_fmac_f32 v14, v22, v78
  v_mfma_f32_16x16x32_f16 v[68:71], v[84:87], v[56:59], 0
  v_fmac_f32 v14, v23, v79
  v_pk_mul_f16 v60, v40, v41 op_sel:[0,1] op_sel_hi:[1,0]
  v_mfma_f32_16x16x32_f16 v[80:83], v[216:219], v[56:59], 0
  v_pk_mul_f16 v61, v40, v42 op_sel:[0,0] op_sel_hi:[1,1]
  v_pk_mul_f16 v62, v40, v42 op_sel:[0,1] op_sel_hi:[1,0]
  v_mfma_f32_16x16x32_bf16 v[76:79], v[244:247], v[52:55], 0
  v_pk_mul_f16 v63, v41, v42 op_sel:[0,0] op_sel_hi:[1,1]
  v_pk_mul_f16 v64, v41, v42 op_sel:[0,1] op_sel_hi:[1,0]
  v_mfma_f32_16x16x32_f16 v[76:79], v[172:175], v[56:59], v[76:79]
  v_pk_mul_f16 v65, v40, v43 op_sel:[0,0] op_sel_hi:[1,0]
  v_pk_mul_f16 v66, v41, v43 op_sel:[0,0] op_sel_hi:[1,0]
  v_pk_mul_f16 v67, v42, v43 op_sel:[0,0] op_sel_hi:[1,0]
  v_mfma_f32_16x16x32_f16 v[76:79], v[176:179], v[60:63], v[76:79]
  v_mul_f16_sdwa v52, v40, v40 dst_sel:WORD_0 dst_unused:UNUSED_PAD src0_sel:WORD_0 src1_sel:WORD_1
  v_mul_f16_sdwa v53, v42, v42 dst_sel:WORD_0 dst_unused:UNUSED_PAD src0_sel:WORD_0 src1_sel:WORD_1
  v_mfma_f32_16x16x32_f16 v[76:79], v[180:183], v[64:67], v[76:79]
  v_mul_f16_sdwa v52, v41, v41 dst_sel:WORD_1 dst_unused:UNUSED_PRESERVE src0_sel:WORD_0 src1_sel:WORD_1
  v_mul_f16_sdwa v53, v43, v43 dst_sel:WORD_1 dst_unused:UNUSED_PRESERVE src0_sel:WORD_0 src1_sel:WORD_1
  v_smfmac_f32_16x16x64_f16 v[80:83], v[220:223], v[60:67], v16
  v_pk_mul_f16 v54, v40, v47 op_sel:[0,0] op_sel_hi:[1,0]
  v_pk_mul_f16 v55, v41, v47 op_sel:[0,0] op_sel_hi:[1,0]
  v_mfma_f32_16x16x32_f16 v[68:71], v[88:91], v[60:63], v[68:71]
  v_pk_mul_f16 v56, v42, v47 op_sel:[0,0] op_sel_hi:[1,0]
  v_pk_mul_f16 v57, v40, v44 op_sel:[0,0] op_sel_hi:[1,1]
  v_mfma_f32_16x16x32_f16 v[68:71], v[92:95], v[64:67], v[68:71]
  v_pk_mul_f16 v58, v40, v44 op_sel:[0,1] op_sel_hi:[1,0]
  v_pk_mul_f16 v59, v40, v45 op_sel:[0,0] op_sel_hi:[1,1]
  v_mfma_f32_16x16x32_f16 v[72:75], v[132:135], v[60:63], v[72:75]
  v_pk_mul_f16 v60, v40, v45 op_sel:[0,1] op_sel_hi:[1,0]
  v_pk_mul_f16 v61, v40, v46 op_sel:[0,0] op_sel_hi:[1,1]
  v_mfma_f32_16x16x32_f16 v[72:75], v[136:139], v[64:67], v[72:75]
  v_pk_mul_f16 v62, v40, v46 op_sel:[0,1] op_sel_hi:[1,0]
  v_pk_mul_f16 v63, v41, v44 op_sel:[0,0] op_sel_hi:[1,1]
  v_mfma_f32_16x16x32_f16 v[72:75], v[140:143], v[52:55], v[72:75]
  v_pk_mul_f16 v64, v41, v44 op_sel:[0,1] op_sel_hi:[1,0]
  v_pk_mul_f16 v65, v41, v45 op_sel:[0,0] op_sel_hi:[1,1]
  v_mfma_f32_16x16x32_f16 v[72:75], v[144:147], v[56:59], v[72:75]
  v_pk_mul_f16 v66, v41, v45 op_sel:[0,1] op_sel_hi:[1,0]
  v_pk_mul_f16 v67, v41, v46 op_sel:[0,0] op_sel_hi:[1,1]
  v_smfmac_f32_16x16x64_f16 v[80:83], v[224:227], v[52:59], v16
  v_alignbit_b32 v48, v48, v48, v13
  v_alignbit_b32 v49, v49, v49, v13
  v_mfma_f32_16x16x32_f16 v[76:79], v[184:187], v[52:55], v[76:79]
  v_alignbit_b32 v50, v50, v50, v13
  ds_read_u16_d16_hi v34, v7 offset:256
  v_mfma_f32_16x16x32_f16 v[76:79], v[188:191], v[56:59], v[76:79]
  ds_read_u16_d16_hi v35, v7 offset:384
  ds_read_u16_d16_hi v36, v7 offset:512
  v_mfma_f32_16x16x32_f16 v[68:71], v[96:99], v[52:55], v[68:71]
  v_pk_mul_f16 v52, v41, v46 op_sel:[0,1] op_sel_hi:[1,0]
  v_pk_mul_f16 v53, v42, v44 op_sel:[0,0] op_sel_hi:[1,1]
  v_mfma_f32_16x16x32_f16 v[68:71], v[100:103], v[56:59], v[68:71]
  v_pk_mul_f16 v54, v42, v44 op_sel:[0,1] op_sel_hi:[1,0]
  v_pk_mul_f16 v55, v42, v45 op_sel:[0,0] op_sel_hi:[1,1]
  v_mfma_f32_16x16x32_f16 v[68:71], v[104:107], v[60:63], v[68:71]
  v_pk_mul_f16 v56, v42, v45 op_sel:[0,1] op_sel_hi:[1,0]
  v_pk_mul_f16 v57, v42, v46 op_sel:[0,0] op_sel_hi:[1,1]
  v_mfma_f32_16x16x32_f16 v[68:71], v[108:111], v[64:67], v[68:71]
  v_pk_mul_f16 v58, v42, v46 op_sel:[0,1] op_sel_hi:[1,0]
  v_pk_mul_f16 v59, v40, v48 op_sel:[0,0] op_sel_hi:[1,1]
  v_smfmac_f32_16x16x64_f16 v[80:83], v[228:231], v[60:67], v16
  ds_read_u16_d16_hi v37, v7 offset:640
  ds_read_u16_d16_hi v38, v7 offset:768
  v_mfma_f32_16x16x32_f16 v[72:75], v[148:151], v[60:63], v[72:75]
  ds_read_u16_d16_hi v39, v7 offset:896
  s_add_u32 s81, s74, s75
  v_add_u32 v8, s81, v9
  v_mfma_f32_16x16x32_f16 v[72:75], v[152:155], v[64:67], v[72:75]
  v_mfma_f32_16x16x32_f16 v[76:79], v[192:195], v[60:63], v[76:79]
  v_pk_mul_f16 v60, v41, v49 op_sel:[0,0] op_sel_hi:[1,1]
  v_pk_mul_f16 v61, v42, v50 op_sel:[0,0] op_sel_hi:[1,1]
  v_mfma_f32_16x16x32_f16 v[76:79], v[196:199], v[64:67], v[76:79]
  v_pk_mul_f16 v62, v40, v49 op_sel:[0,0] op_sel_hi:[1,1]
  v_pk_mul_f16 v63, v40, v49 op_sel:[0,1] op_sel_hi:[1,0]
  v_mfma_f32_16x16x32_f16 v[76:79], v[200:203], v[52:55], v[76:79]
  v_pk_mul_f16 v64, v40, v50 op_sel:[0,0] op_sel_hi:[1,1]
  v_pk_mul_f16 v65, v40, v50 op_sel:[0,1] op_sel_hi:[1,0]
  v_mfma_f32_16x16x32_f16 v[76:79], v[204:207], v[56:59], v[76:79]
  v_pk_mul_f16 v66, v41, v50 op_sel:[0,0] op_sel_hi:[1,1]
  v_pk_mul_f16 v67, v41, v50 op_sel:[0,1] op_sel_hi:[1,0]
  v_smfmac_f32_16x16x64_f16 v[80:83], v[232:235], v[52:59], v16
  s_waitcnt lgkmcnt(0)
  v_cvt_pk_f16_f32 v43, v38, v39
  v_mfma_f32_16x16x32_f16 v[72:75], v[156:159], v[52:55], v[72:75]
  v_cvt_pk_f16_f32 v40, v32, v35
  v_cvt_pk_f16_f32 v41, v33, v36
  v_mfma_f32_16x16x32_f16 v[72:75], v[160:163], v[56:59], v[72:75]
  v_cvt_pk_f16_f32 v42, v34, v37
  v_mfma_f32_16x16x32_f16 v[68:71], v[112:115], v[52:55], v[68:71]
  ds_write_b128 v10, v[40:43]
  v_mfma_f32_16x16x32_f16 v[68:71], v[116:119], v[56:59], v[68:71]
  v_mfma_f32_16x16x32_f16 v[68:71], v[120:123], v[60:63], v[68:71]
  ds_read_b128 v[44:47], v11
  ds_read_b128 v[48:51], v12
  v_mfma_f32_16x16x32_f16 v[68:71], v[124:127], v[64:67], v[68:71]
  ds_read_b64_tr_b16 v[52:53], v8 offset:0
  ds_read_b64_tr_b16 v[54:55], v8 offset:512
  v_mfma_f32_16x16x32_f16 v[72:75], v[164:167], v[60:63], v[72:75]
  v_pk_mul_f16 v56, v40, v40 op_sel:[0,0] op_sel_hi:[1,1]
  v_pk_mul_f16 v57, v41, v41 op_sel:[0,0] op_sel_hi:[1,1]
  v_mfma_f32_16x16x32_f16 v[72:75], v[168:171], v[64:67], v[72:75]
  v_pk_mul_f16 v58, v42, v42 op_sel:[0,0] op_sel_hi:[1,1]
  v_pk_mul_f16 v59, v40, v41 op_sel:[0,0] op_sel_hi:[1,1]
  v_smfmac_f32_16x16x64_f16 v[80:83], v[236:239], v[60:67], v16
  ds_read_u16_d16_hi v32, v7 offset:32
  ds_read_u16_d16_hi v33, v7 offset:160
  v_mfma_f32_16x16x32_f16 v[76:79], v[208:211], v[60:63], v[76:79]
  s_nop 1
  v_fmac_f32 v14, v68, v72
  v_fmac_f32 v14, v69, v73
  v_mfma_f32_16x16x32_f16 v[76:79], v[212:215], v[64:67], v[76:79]
  v_fmac_f32 v14, v70, v74
  v_fmac_f32 v14, v71, v75
  s_cmp_lg_u32 s72, 1
  s_cbranch_scc1 L_cin_loop
  v_add_f32 v22, v80, v81
  v_add_f32 v23, v82, v83
  s_nop 1
  v_fmac_f32 v14, v76, v77
  v_fmac_f32 v14, v22, v78
  v_fmac_f32 v14, v23, v79
  s_nop 1
  v_add_f32_dpp v14, v14, v14 row_shr:1 row_mask:0xf bank_mask:0xf
  s_nop 1
  v_add_f32_dpp v14, v14, v14 row_shr:2 row_mask:0xf bank_mask:0xf
  s_nop 1
  v_add_f32_dpp v14, v14, v14 row_shr:4 row_mask:0xf bank_mask:0xf
  s_nop 1
  v_add_f32_dpp v14, v14, v14 row_shr:8 row_mask:0xf bank_mask:0xf
  s_nop 1
  v_add_f32_dpp v14, v14, v14 row_bcast:15 row_mask:0xa bank_mask:0xf
  s_nop 1
  v_add_f32_dpp v14, v14, v14 row_bcast:31 row_mask:0xc bank_mask:0xf
  s_branch L_blk
L_htail:
  v_add_f32 v22, v80, v81
  v_add_f32 v23, v82, v83
  s_nop 1
  v_fmac_f32 v14, v76, v77
  v_fmac_f32 v14, v22, v78
  v_fmac_f32 v14, v23, v79
  s_nop 1
  v_add_f32_dpp v14, v14, v14 row_shr:1 row_mask:0xf bank_mask:0xf
  s_nop 1
  v_add_f32_dpp v14, v14, v14 row_shr:2 row_mask:0xf bank_mask:0xf
  s_nop 1
  v_add_f32_dpp v14, v14, v14 row_shr:4 row_mask:0xf bank_mask:0xf
  s_nop 1
  v_add_f32_dpp v14, v14, v14 row_shr:8 row_mask:0xf bank_mask:0xf
  s_nop 1
  v_add_f32_dpp v14, v14, v14 row_bcast:15 row_mask:0xa bank_mask:0xf
  s_nop 1
  v_add_f32_dpp v14, v14, v14 row_bcast:31 row_mask:0xc bank_mask:0xf
  v_add_u32 v7, s75, v7
  s_branch L_blk
L_slow:
  v_subrev_u32 v7, s75, v7
L_slow2:
  v_lshlrev_b32 v22, 1, v0
  v_add_u32 v23, s74, v22
  s_mul_i32 s81, s3, 4224
  s_add_u32 s81, s81, 1024
  v_add_u32 v22, s81, v22
  v_add_u32 v8, s81, v9
L_csync10:
  ds_read_b32 v4, v2 offset:12
  s_waitcnt lgkmcnt(0)
  v_cmp_gt_u32 vcc, 8, v4
  s_cbranch_vccnz L_csync10
  ds_read_u16 v52, v23 offset:0
  ds_read_u16 v53, v23 offset:128
  ds_read_u16 v54, v23 offset:256
  ds_read_u16 v55, v23 offset:384
  ds_read_u16 v56, v23 offset:512
  ds_read_u16 v57, v23 offset:640
  ds_read_u16 v58, v23 offset:768
  ds_read_u16 v59, v23 offset:896
  ds_read_u16 v60, v23 offset:1056
  ds_read_u16 v61, v23 offset:1184
  ds_read_u16 v62, v23 offset:1312
  ds_read_u16 v63, v23 offset:1440
  ds_read_u16 v64, v23 offset:1568
  ds_read_u16 v65, v23 offset:1696
  ds_read_u16 v66, v23 offset:1824
  ds_read_u16 v67, v23 offset:1952
  ds_read_u16 v68, v23 offset:2112
  ds_read_u16 v69, v23 offset:2240
  ds_read_u16 v70, v23 offset:2368
  ds_read_u16 v71, v23 offset:2496
  ds_read_u16 v72, v23 offset:2624
  ds_read_u16 v73, v23 offset:2752
  ds_read_u16 v74, v23 offset:2880
  ds_read_u16 v75, v23 offset:3008
  ds_read_u16 v76, v23 offset:3168
  ds_read_u16 v77, v23 offset:3296
  ds_read_u16 v78, v23 offset:3424
  ds_read_u16 v79, v23 offset:3552
  ds_read_u16 v80, v23 offset:3680
  ds_read_u16 v81, v23 offset:3808
  ds_read_u16 v82, v23 offset:3936
  s_waitcnt lgkmcnt(14)
  v_lshlrev_b32 v52, 16, v52
  v_lshlrev_b32 v53, 16, v53
  v_lshlrev_b32 v54, 16, v54
  v_lshlrev_b32 v55, 16, v55
  v_lshlrev_b32 v56, 16, v56
  v_lshlrev_b32 v57, 16, v57
  v_lshlrev_b32 v58, 16, v58
  v_lshlrev_b32 v59, 16, v59
  v_lshlrev_b32 v60, 16, v60
  v_lshlrev_b32 v61, 16, v61
  v_lshlrev_b32 v62, 16, v62
  v_lshlrev_b32 v63, 16, v63
  v_lshlrev_b32 v64, 16, v64
  v_lshlrev_b32 v65, 16, v65
  v_lshlrev_b32 v66, 16, v66
  v_lshlrev_b32 v67, 16, v67
  v_lshlrev_b32 v68, 16, v68
  s_waitcnt lgkmcnt(13)
  v_lshlrev_b32 v69, 16, v69
  s_waitcnt lgkmcnt(12)
  v_lshlrev_b32 v70, 16, v70
  s_waitcnt lgkmcnt(11)
  v_lshlrev_b32 v71, 16, v71
  s_waitcnt lgkmcnt(10)
  v_lshlrev_b32 v72, 16, v72
  s_waitcnt lgkmcnt(9)
  v_lshlrev_b32 v73, 16, v73
  s_waitcnt lgkmcnt(8)
  v_lshlrev_b32 v74, 16, v74
  s_waitcnt lgkmcnt(7)
  v_lshlrev_b32 v75, 16, v75
  s_waitcnt lgkmcnt(6)
  v_lshlrev_b32 v76, 16, v76
  s_waitcnt lgkmcnt(5)
  v_lshlrev_b32 v77, 16, v77
  s_waitcnt lgkmcnt(4)
  v_lshlrev_b32 v78, 16, v78
  s_waitcnt lgkmcnt(3)
  v_lshlrev_b32 v79, 16, v79
  s_waitcnt lgkmcnt(2)
  v_lshlrev_b32 v80, 16, v80
  s_waitcnt lgkmcnt(1)
  v_lshlrev_b32 v81, 16, v81
  s_waitcnt lgkmcnt(0)
  v_lshlrev_b32 v82, 16, v82
  v_max3_f32 v14, abs(v52), abs(v53), abs(v54)
  v_max3_f32 v14, v14, abs(v55), abs(v56)
  v_max3_f32 v14, v14, abs(v57), abs(v58)
  v_max3_f32 v14, v14, abs(v59), abs(v60)
  v_max3_f32 v14, v14, abs(v61), abs(v62)
  v_max3_f32 v14, v14, abs(v63), abs(v64)
  v_max3_f32 v14, v14, abs(v65), abs(v66)
  v_max3_f32 v14, v14, abs(v67), abs(v68)
  v_max3_f32 v14, v14, abs(v69), abs(v70)
  v_max3_f32 v14, v14, abs(v71), abs(v72)
  v_max3_f32 v14, v14, abs(v73), abs(v74)
  v_max3_f32 v14, v14, abs(v75), abs(v76)
  v_max3_f32 v14, v14, abs(v77), abs(v78)
  v_max3_f32 v14, v14, abs(v79), abs(v80)
  v_max3_f32 v14, v14, abs(v81), abs(v82)
  s_nop 1
  v_max_u32_dpp v14, v14, v14 row_shr:1 row_mask:0xf bank_mask:0xf
  s_nop 1
  v_max_u32_dpp v14, v14, v14 row_shr:2 row_mask:0xf bank_mask:0xf
  s_nop 1
  v_max_u32_dpp v14, v14, v14 row_shr:4 row_mask:0xf bank_mask:0xf
  s_nop 1
  v_max_u32_dpp v14, v14, v14 row_shr:8 row_mask:0xf bank_mask:0xf
  s_nop 1
  v_max_u32_dpp v14, v14, v14 row_bcast:15 row_mask:0xa bank_mask:0xf
  s_nop 1
  v_max_u32_dpp v14, v14, v14 row_bcast:31 row_mask:0xc bank_mask:0xf
  s_nop 0
  v_readlane_b32 s81, v14, 63
  s_nop 0
  s_lshr_b32 s81, s81, 23
  s_sub_i32 s81, 134, s81
  s_cmp_le_u32 s81, 9
  s_cselect_b32 s97, 2, 3
  s_min_i32 s81, s81, 16
  s_lshl_b32 s49, s81, 2
  s_sub_i32 s49, s48, s49
  s_add_i32 s81, s81, 127
  s_lshl_b32 s81, s81, 23
  v_mov_b32 v83, s81
  v_mul_f32 v52, s81, v52
  v_mul_f32 v53, s81, v53
  v_mul_f32 v54, s81, v54
  v_mul_f32 v55, s81, v55
  v_mul_f32 v56, s81, v56
  v_mul_f32 v57, s81, v57
  v_mul_f32 v58, s81, v58
  v_mul_f32 v59, s81, v59
  v_mul_f32 v60, s81, v60
  v_mul_f32 v61, s81, v61
  v_mul_f32 v62, s81, v62
  v_mul_f32 v63, s81, v63
  v_mul_f32 v64, s81, v64
  v_mul_f32 v65, s81, v65
  v_mul_f32 v66, s81, v66
  v_mul_f32 v67, s81, v67
  v_mul_f32 v68, s81, v68
  v_mul_f32 v69, s81, v69
  v_mul_f32 v70, s81, v70
  v_mul_f32 v71, s81, v71
  v_mul_f32 v72, s81, v72
  v_mul_f32 v73, s81, v73
  v_mul_f32 v74, s81, v74
  v_mul_f32 v75, s81, v75
  v_mul_f32 v76, s81, v76
  v_mul_f32 v77, s81, v77
  v_mul_f32 v78, s81, v78
  v_mul_f32 v79, s81, v79
  v_mul_f32 v80, s81, v80
  v_mul_f32 v81, s81, v81
  v_mul_f32 v82, s81, v82
  ds_write_b16_d16_hi v23, v52 offset:0
  ds_write_b16_d16_hi v23, v53 offset:128
  ds_write_b16_d16_hi v23, v54 offset:256
  ds_write_b16_d16_hi v23, v55 offset:384
  ds_write_b16_d16_hi v23, v56 offset:512
  ds_write_b16_d16_hi v23, v57 offset:640
  ds_write_b16_d16_hi v23, v58 offset:768
  ds_write_b16_d16_hi v23, v59 offset:896
  ds_write_b16_d16_hi v23, v60 offset:1056
  ds_write_b16_d16_hi v23, v61 offset:1184
  ds_write_b16_d16_hi v23, v62 offset:1312
  ds_write_b16_d16_hi v23, v63 offset:1440
  ds_write_b16_d16_hi v23, v64 offset:1568
  ds_write_b16_d16_hi v23, v65 offset:1696
  ds_write_b16_d16_hi v23, v66 offset:1824
  ds_write_b16_d16_hi v23, v67 offset:1952
  ds_write_b16_d16_hi v23, v68 offset:2112
  ds_write_b16_d16_hi v23, v69 offset:2240
  ds_write_b16_d16_hi v23, v70 offset:2368
  ds_write_b16_d16_hi v23, v71 offset:2496
  ds_write_b16_d16_hi v23, v72 offset:2624
  ds_write_b16_d16_hi v23, v73 offset:2752
  ds_write_b16_d16_hi v23, v74 offset:2880
  ds_write_b16_d16_hi v23, v75 offset:3008
  ds_write_b16_d16_hi v23, v76 offset:3168
  ds_write_b16_d16_hi v23, v77 offset:3296
  ds_write_b16_d16_hi v23, v78 offset:3424
  ds_write_b16_d16_hi v23, v79 offset:3552
  ds_write_b16_d16_hi v23, v80 offset:3680
  ds_write_b16_d16_hi v23, v81 offset:3808
  ds_write_b16_d16_hi v23, v82 offset:3936
  v_mul_f32 v52, s81, v52
  v_mul_f32 v53, s81, v53
  v_mul_f32 v54, s81, v54
  v_mul_f32 v55, s81, v55
  v_mul_f32 v56, s81, v56
  v_mul_f32 v57, s81, v57
  v_mul_f32 v58, s81, v58
  v_mul_f32 v59, s81, v59
  v_mul_f32 v60, s81, v60
  v_mul_f32 v61, s81, v61
  v_mul_f32 v62, s81, v62
  v_mul_f32 v63, s81, v63
  v_mul_f32 v64, s81, v64
  v_mul_f32 v65, s81, v65
  v_mul_f32 v66, s81, v66
  v_mul_f32 v67, s81, v67
  v_mul_f32 v68, s81, v68
  v_mul_f32 v69, s81, v69
  v_mul_f32 v70, s81, v70
  v_mul_f32 v71, s81, v71
  v_mul_f32 v72, s81, v72
  v_mul_f32 v73, s81, v73
  v_mul_f32 v74, s81, v74
  v_mul_f32 v75, s81, v75
  v_mul_f32 v76, s81, v76
  v_mul_f32 v77, s81, v77
  v_mul_f32 v78, s81, v78
  v_mul_f32 v79, s81, v79
  v_mul_f32 v80, s81, v80
  v_mul_f32 v81, s81, v81
  v_mul_f32 v82, s81, v82
  v_mul_f32 v83, s81, v83
  ds_write_b16_d16_hi v22, v52 offset:0
  ds_write_b16_d16_hi v22, v53 offset:128
  ds_write_b16_d16_hi v22, v54 offset:256
  ds_write_b16_d16_hi v22, v55 offset:384
  ds_write_b16_d16_hi v22, v56 offset:512
  ds_write_b16_d16_hi v22, v57 offset:640
  ds_write_b16_d16_hi v22, v58 offset:768
  ds_write_b16_d16_hi v22, v59 offset:896
  ds_write_b16_d16_hi v22, v60 offset:1056
  ds_write_b16_d16_hi v22, v61 offset:1184
  ds_write_b16_d16_hi v22, v62 offset:1312
  ds_write_b16_d16_hi v22, v63 offset:1440
  ds_write_b16_d16_hi v22, v64 offset:1568
  ds_write_b16_d16_hi v22, v65 offset:1696
  ds_write_b16_d16_hi v22, v66 offset:1824
  ds_write_b16_d16_hi v22, v67 offset:1952
  ds_write_b16_d16_hi v22, v68 offset:2112
  ds_write_b16_d16_hi v22, v69 offset:2240
  ds_write_b16_d16_hi v22, v70 offset:2368
  ds_write_b16_d16_hi v22, v71 offset:2496
  ds_write_b16_d16_hi v22, v72 offset:2624
  ds_write_b16_d16_hi v22, v73 offset:2752
  ds_write_b16_d16_hi v22, v74 offset:2880
  ds_write_b16_d16_hi v22, v75 offset:3008
  ds_write_b16_d16_hi v22, v76 offset:3168
  ds_write_b16_d16_hi v22, v77 offset:3296
  ds_write_b16_d16_hi v22, v78 offset:3424
  ds_write_b16_d16_hi v22, v79 offset:3552
  ds_write_b16_d16_hi v22, v80 offset:3680
  ds_write_b16_d16_hi v22, v81 offset:3808
  ds_write_b16_d16_hi v22, v82 offset:3936
  ds_write_b16_d16_hi v22, v83 offset:4064
  s_mov_b32 s50, 0
  s_waitcnt lgkmcnt(0)
  s_branch L_prime
L_cin_done:
  s_endpgm
L_rem:
  s_lshr_b32 s84, s3, 2
  s_and_b32 s68, s2, 7
  s_lshl_b32 s68, s68, 3
  s_add_u32 s68, s68, s3
  s_mul_i32 s68, s68, 6656
  s_lshl_b32 s76, s3, 14
  v_lshlrev_b32 v248, 4, v0
  v_lshrrev_b32 v246, 4, v0
  v_lshrrev_b32 v247, 3, v0
  v_mul_u32_u24 v13, 3328, v247
  v_and_b32 v247, 2, v247
  s_and_b32 s69, s3, 1
  s_lshl_b32 s69, s69, 2
  v_or_b32 v247, s69, v247
  v_and_b32 v9, 7, v0
  v_xor_b32 v247, v247, v9
  v_lshl_add_u32 v13, v247, 4, v13
  s_mul_i32 s74, s3, 26624
  s_add_u32 s74, s74, 3200
  s_lshl_b32 s75, s3, 10
  s_add_u32 s75, s75, 131072
  s_waitcnt lgkmcnt(0)
  s_load_dword s80, s[18:19], 0
  s_mov_b32 s28, s4
  s_and_b32 s29, s5, 0xffff
  s_mov_b32 s30, 425984
  s_mov_b32 s31, 0x20000
  s_add_u32 m0, s76, 8192
  s_nop 0
  buffer_load_dwordx4 v248, s[28:31], s68 offen lds
  s_add_u32 s68, s68, 1024
  s_add_u32 m0, s76, 9216
  s_nop 0
  buffer_load_dwordx4 v248, s[28:31], s68 offen lds
  s_add_u32 s68, s68, 1024
  s_add_u32 m0, s76, 10240
  s_nop 0
  buffer_load_dwordx4 v248, s[28:31], s68 offen lds
  s_add_u32 s68, s68, 1024
  s_add_u32 m0, s76, 11264
  s_nop 0
  buffer_load_dwordx4 v248, s[28:31], s68 offen lds
  s_add_u32 s68, s68, 1024
  s_add_u32 m0, s76, 12288
  s_nop 0
  buffer_load_dwordx4 v248, s[28:31], s68 offen lds
  s_add_u32 s68, s68, 1024
  s_add_u32 m0, s76, 13312
  s_nop 0
  buffer_load_dwordx4 v248, s[28:31], s68 offen lds
  s_add_u32 s68, s68, 1024
  s_add_u32 m0, s76, 14336
  s_nop 0
  buffer_load_dwordx4 v248, s[28:31], s68 offen lds
  s_add_u32 s68, s68, 1024
  s_mov_b32 s44, s12
  s_and_b32 s45, s13, 0xffff
  s_mov_b32 s46, 5537792
  s_mov_b32 s47, 0x20000
  s_add_u32 m0, s75, 0
  s_nop 0
  buffer_load_dwordx4 v13, s[44:47], s74 offen lds
  s_add_u32 s74, s74, 212992
  s_mov_b32 s60, s24
  s_and_b32 s61, s25, 0xffff
  s_mov_b32 s62, 268435456
  s_mov_b32 s63, 0x20000
  s_mov_b32 s64, s22
  s_and_b32 s65, s23, 0xffff
  s_mov_b32 s66, 256
  s_mov_b32 s67, 0x20000
  v_mov_b32 v64, -1
  v_mov_b32 v65, -1
  v_mov_b32 v66, -1
  v_mov_b32 v67, -1
  s_and_b32 s70, s2, 7
  s_lshl_b32 s68, s70, 3
  s_add_u32 s68, s68, s3
  s_lshl_b32 s68, s68, 11
  s_lshl_b32 s70, s70, 2
  buffer_store_dwordx4 v[64:67], v248, s[60:63], s68 offen sc1
  buffer_store_dwordx4 v[64:67], v248, s[60:63], s68 offen offset:1024 sc1
  s_mov_b32 s48, s14
  s_and_b32 s49, s15, 0xffff
  s_mov_b32 s50, 3328
  s_mov_b32 s51, 0x20000
  s_mov_b32 s52, s16
  s_and_b32 s53, s17, 0xffff
  s_mov_b32 s54, 3328
  s_mov_b32 s55, 0x20000
  s_mov_b32 s32, s6
  s_and_b32 s33, s7, 0xffff
  s_mov_b32 s34, 12800000
  s_mov_b32 s35, 0x20000
  v_xor_b32 v248, v9, v246
  v_lshlrev_b32 v14, 4, v248
  v_xor_b32 v15, 64, v14
  v_bfe_u32 v247, v0, 2, 2
  v_lshl_add_u32 v248, v246, 3, v247
  v_lshlrev_b32 v248, 7, v248
  v_and_b32 v247, 3, v0
  v_lshl_add_u32 v248, v247, 3, v248
  v_add_u32 v248, 131072, v248
  v_bfe_u32 v247, v0, 3, 2
  v_lshl_add_u32 v1, v247, 5, v248
  v_xor_b32 v2, 32, v1
  v_xor_b32 v7, 64, v1
  v_xor_b32 v8, 96, v1
  v_and_b32 v248, 15, v0
  v_lshlrev_b32 v248, 7, v248
  v_bfe_u32 v247, v0, 1, 3
  v_xor_b32 v247, v247, v246
  v_lshl_add_u32 v248, v247, 4, v248
  v_add_u32 v11, s76, v248
  v_xor_b32 v12, 64, v11
  v_lshrrev_b32 v247, 3, v0
  v_lshl_add_u32 v248, v9, 3, v247
  v_mul_u32_u24 v248, 104, v248
  v_add_u32 v248, s76, v248
  s_mov_b32 s56, s20
  s_and_b32 s57, s21, 0xffff
  s_mov_b32 s58, 8192
  s_mov_b32 s59, 0x20000
  s_and_b32 s77, s2, 7
  s_lshl_b32 s68, s77, 14
  s_lshl_b32 s69, s3, 8
  s_add_u32 s68, s68, s69
  s_add_u32 s69, s68, 4096
  s_add_u32 s71, s68, 8192
  s_lshl_b32 s77, s77, 3
  s_add_u32 s77, s77, s3
  s_lshl_b32 s77, s77, 7
  v_lshlrev_b32 v3, 2, v0
  v_lshlrev_b32 v4, 1, v0
  s_lshl_b32 s81, s3, 6
  v_add_u32 v5, s81, v0
  v_cmp_lt_u32 vcc, 503, v5
  v_add_u32 v5, 4096, v3
  v_mov_b32 v6, 0x7f000000
  v_cndmask_b32 v5, v6, v5, vcc
  v_mov_b32 v240, 0xc0135761
  v_mov_b32 v241, 0xc0135761
  v_mov_b32 v242, 0xbdd2d3e8
  v_mov_b32 v243, 0xbdd2d3e8
  v_mov_b32 v244, 0x71800000
  v_mov_b32 v160, 0
  v_mov_b32 v161, 0
  v_mov_b32 v162, 0
  v_mov_b32 v163, 0
  v_mov_b32 v164, 0
  v_mov_b32 v165, 0
  v_mov_b32 v166, 0
  v_mov_b32 v167, 0
  v_mov_b32 v168, 0
  v_mov_b32 v169, 0
  v_mov_b32 v170, 0
  v_mov_b32 v171, 0
  v_mov_b32 v172, 0
  v_mov_b32 v173, 0
  v_mov_b32 v174, 0
  v_mov_b32 v175, 0
  v_mov_b32 v176, 0
  v_mov_b32 v177, 0
  v_mov_b32 v178, 0
  v_mov_b32 v179, 0
  v_mov_b32 v180, 0
  v_mov_b32 v181, 0
  v_mov_b32 v182, 0
  v_mov_b32 v183, 0
  v_mov_b32 v184, 0
  v_mov_b32 v185, 0
  v_mov_b32 v186, 0
  v_mov_b32 v187, 0
  v_mov_b32 v188, 0
  v_mov_b32 v189, 0
  v_mov_b32 v190, 0
  v_mov_b32 v191, 0
  v_mov_b32 v192, 0
  v_mov_b32 v193, 0
  v_mov_b32 v194, 0
  v_mov_b32 v195, 0
  v_mov_b32 v196, 0
  v_mov_b32 v197, 0
  v_mov_b32 v198, 0
  v_mov_b32 v199, 0
  v_mov_b32 v200, 0
  v_mov_b32 v201, 0
  v_mov_b32 v202, 0
  v_mov_b32 v203, 0
  v_mov_b32 v204, 0
  v_mov_b32 v205, 0
  v_mov_b32 v206, 0
  v_mov_b32 v207, 0
  v_mov_b32 v208, 0
  v_mov_b32 v209, 0
  v_mov_b32 v210, 0
  v_mov_b32 v211, 0
  v_mov_b32 v212, 0
  v_mov_b32 v213, 0
  v_mov_b32 v214, 0
  v_mov_b32 v215, 0
  v_mov_b32 v216, 0
  v_mov_b32 v217, 0
  v_mov_b32 v218, 0
  v_mov_b32 v219, 0
  v_mov_b32 v220, 0
  v_mov_b32 v221, 0
  v_mov_b32 v222, 0
  v_mov_b32 v223, 0
  s_waitcnt vmcnt(0) lgkmcnt(0)
  s_lshl_b32 s80, s80, 16
  ds_read_b64 v[32:33], v248 offset:8192
  ds_read_b64 v[34:35], v248 offset:8200
  ds_read_b64 v[36:37], v248 offset:8208
  ds_read_b64 v[38:39], v248 offset:8216
  ds_read_b64 v[40:41], v248 offset:8224
  ds_read_b64 v[42:43], v248 offset:8232
  ds_read_b64 v[44:45], v248 offset:8240
  ds_read_b64 v[46:47], v248 offset:8248
  ds_read_b64 v[48:49], v248 offset:8256
  ds_read_b64 v[50:51], v248 offset:8264
  ds_read_b64 v[52:53], v248 offset:8272
  ds_read_b64 v[54:55], v248 offset:8280
  ds_read_b64 v[56:57], v248 offset:8288
  v_mov_b32 v24, 0
  v_mov_b32 v25, 0
  v_mov_b32 v26, 0
  v_mov_b32 v27, 0
  v_mov_b32 v28, 0
  v_mov_b32 v29, 0
  v_mov_b32 v30, 0
  v_mov_b32 v31, 0
  v_mov_b32 v58, 0x7f000000
  v_mov_b32 v59, 0x7f000000
  s_waitcnt lgkmcnt(12)
  v_lshlrev_b32 v32, 7, v32
  s_nop 1
  v_add_u32_dpp v24, v32, v14 row_newbcast:0 row_mask:0xf bank_mask:0x3
  v_add_u32_dpp v25, v32, v15 row_newbcast:1 row_mask:0xf bank_mask:0x3
  v_add_u32_dpp v26, v32, v14 row_newbcast:2 row_mask:0xf bank_mask:0x3
  v_add_u32_dpp v27, v32, v15 row_newbcast:3 row_mask:0xf bank_mask:0x3
  v_add_u32_dpp v24, v32, v14 row_newbcast:8 row_mask:0xf bank_mask:0xc
  v_add_u32_dpp v25, v32, v15 row_newbcast:9 row_mask:0xf bank_mask:0xc
  v_add_u32_dpp v26, v32, v14 row_newbcast:10 row_mask:0xf bank_mask:0xc
  v_add_u32_dpp v27, v32, v15 row_newbcast:11 row_mask:0xf bank_mask:0xc
  s_add_u32 m0, s76, 0
  s_nop 0
  buffer_load_dwordx4 v24, s[32:35], 0 offen lds
  s_add_u32 m0, s76, 1024
  s_nop 0
  buffer_load_dwordx4 v25, s[32:35], 0 offen lds
  s_add_u32 m0, s76, 2048
  s_nop 0
  buffer_load_dwordx4 v26, s[32:35], 0 offen lds
  s_add_u32 m0, s76, 3072
  s_nop 0
  buffer_load_dwordx4 v27, s[32:35], 0 offen lds
  v_add_u32_dpp v28, v32, v14 row_newbcast:4 row_mask:0xf bank_mask:0x3
  v_add_u32_dpp v29, v32, v15 row_newbcast:5 row_mask:0xf bank_mask:0x3
  v_add_u32_dpp v30, v32, v14 row_newbcast:6 row_mask:0xf bank_mask:0x3
  v_add_u32_dpp v31, v32, v15 row_newbcast:7 row_mask:0xf bank_mask:0x3
  v_add_u32_dpp v28, v32, v14 row_newbcast:12 row_mask:0xf bank_mask:0xc
  v_add_u32_dpp v29, v32, v15 row_newbcast:13 row_mask:0xf bank_mask:0xc
  v_add_u32_dpp v30, v32, v14 row_newbcast:14 row_mask:0xf bank_mask:0xc
  v_add_u32_dpp v31, v32, v15 row_newbcast:15 row_mask:0xf bank_mask:0xc
  s_add_u32 m0, s76, 4096
  s_nop 0
  buffer_load_dwordx4 v28, s[32:35], 0 offen lds
  s_add_u32 m0, s76, 5120
  s_nop 0
  buffer_load_dwordx4 v29, s[32:35], 0 offen lds
  s_add_u32 m0, s76, 6144
  s_nop 0
  buffer_load_dwordx4 v30, s[32:35], 0 offen lds
  s_add_u32 m0, s76, 7168
  s_nop 0
  buffer_load_dwordx4 v31, s[32:35], 0 offen lds
  s_add_u32 m0, s75, 8192
  s_nop 0
  buffer_load_dwordx4 v13, s[44:47], s74 offen lds
  s_add_u32 s74, s74, 212992
  s_waitcnt lgkmcnt(0)
  v_lshlrev_b32 v57, 7, v57
  v_lshlrev_b32 v56, 7, v56
  v_lshlrev_b32 v55, 7, v55
  v_lshlrev_b32 v54, 7, v54
  v_lshlrev_b32 v53, 7, v53
  v_lshlrev_b32 v52, 7, v52
  v_lshlrev_b32 v51, 7, v51
  v_lshlrev_b32 v50, 7, v50
  v_lshlrev_b32 v49, 7, v49
  v_lshlrev_b32 v48, 7, v48
  v_lshlrev_b32 v47, 7, v47
  v_lshlrev_b32 v46, 7, v46
  v_lshlrev_b32 v45, 7, v45
  v_lshlrev_b32 v44, 7, v44
  v_lshlrev_b32 v43, 7, v43
  v_lshlrev_b32 v42, 7, v42
  v_lshlrev_b32 v41, 7, v41
  v_lshlrev_b32 v40, 7, v40
  v_lshlrev_b32 v39, 7, v39
  v_lshlrev_b32 v38, 7, v38
  v_lshlrev_b32 v37, 7, v37
  v_lshlrev_b32 v36, 7, v36
  v_lshlrev_b32 v35, 7, v35
  v_lshlrev_b32 v34, 7, v34
  v_lshlrev_b32 v33, 7, v33
  s_nop 1
  v_add_u32_dpp v24, v33, v14 row_newbcast:0 row_mask:0xf bank_mask:0x3
  v_add_u32_dpp v25, v33, v15 row_newbcast:1 row_mask:0xf bank_mask:0x3
  v_add_u32_dpp v26, v33, v14 row_newbcast:2 row_mask:0xf bank_mask:0x3
  v_add_u32_dpp v27, v33, v15 row_newbcast:3 row_mask:0xf bank_mask:0x3
  v_add_u32_dpp v24, v33, v14 row_newbcast:8 row_mask:0xf bank_mask:0xc
  v_add_u32_dpp v25, v33, v15 row_newbcast:9 row_mask:0xf bank_mask:0xc
  v_add_u32_dpp v26, v33, v14 row_newbcast:10 row_mask:0xf bank_mask:0xc
  v_add_u32_dpp v27, v33, v15 row_newbcast:11 row_mask:0xf bank_mask:0xc
  s_add_u32 m0, s76, 8192
  s_nop 0
  buffer_load_dwordx4 v24, s[32:35], 0 offen lds
  s_add_u32 m0, s76, 9216
  s_nop 0
  buffer_load_dwordx4 v25, s[32:35], 0 offen lds
  s_add_u32 m0, s76, 10240
  s_nop 0
  buffer_load_dwordx4 v26, s[32:35], 0 offen lds
  s_add_u32 m0, s76, 11264
  s_nop 0
  buffer_load_dwordx4 v27, s[32:35], 0 offen lds
  v_add_u32_dpp v28, v33, v14 row_newbcast:4 row_mask:0xf bank_mask:0x3
  v_add_u32_dpp v29, v33, v15 row_newbcast:5 row_mask:0xf bank_mask:0x3
  v_add_u32_dpp v30, v33, v14 row_newbcast:6 row_mask:0xf bank_mask:0x3
  v_add_u32_dpp v31, v33, v15 row_newbcast:7 row_mask:0xf bank_mask:0x3
  v_add_u32_dpp v28, v33, v14 row_newbcast:12 row_mask:0xf bank_mask:0xc
  v_add_u32_dpp v29, v33, v15 row_newbcast:13 row_mask:0xf bank_mask:0xc
  v_add_u32_dpp v30, v33, v14 row_newbcast:14 row_mask:0xf bank_mask:0xc
  v_add_u32_dpp v31, v33, v15 row_newbcast:15 row_mask:0xf bank_mask:0xc
  s_add_u32 m0, s76, 12288
  s_nop 0
  buffer_load_dwordx4 v28, s[32:35], 0 offen lds
  s_add_u32 m0, s76, 13312
  s_nop 0
  buffer_load_dwordx4 v29, s[32:35], 0 offen lds
  s_add_u32 m0, s76, 14336
  s_nop 0
  buffer_load_dwordx4 v30, s[32:35], 0 offen lds
  s_add_u32 m0, s76, 15360
  s_nop 0
  buffer_load_dwordx4 v31, s[32:35], 0 offen lds
  s_add_u32 m0, s75, 16384
  s_nop 0
  buffer_load_dwordx4 v13, s[44:47], s74 offen lds
  s_add_u32 s74, s74, 212992
  v_lshlrev_b32 v248, 3, v246
  s_mov_b32 s73, 3
  v_mov_b32 v9, v34
  s_nop 1
  v_add_u32_dpp v24, v9, v14 row_newbcast:0 row_mask:0xf bank_mask:0x3
  v_add_u32_dpp v25, v9, v15 row_newbcast:1 row_mask:0xf bank_mask:0x3
  v_add_u32_dpp v26, v9, v14 row_newbcast:2 row_mask:0xf bank_mask:0x3
  v_add_u32_dpp v27, v9, v15 row_newbcast:3 row_mask:0xf bank_mask:0x3
  v_add_u32_dpp v24, v9, v14 row_newbcast:8 row_mask:0xf bank_mask:0xc
  v_add_u32_dpp v25, v9, v15 row_newbcast:9 row_mask:0xf bank_mask:0xc
  v_add_u32_dpp v26, v9, v14 row_newbcast:10 row_mask:0xf bank_mask:0xc
  v_add_u32_dpp v27, v9, v15 row_newbcast:11 row_mask:0xf bank_mask:0xc
  s_waitcnt vmcnt(14)
  s_barrier
  ds_read_b128 v[76:79], v12 offset:2048
  ds_read_b128 v[72:75], v11 offset:2048
  ds_read_b128 v[68:71], v12 offset:0
  ds_read_b128 v[64:67], v11 offset:0
  ds_read_b64_tr_b16 v[96:97], v1 offset:0
  ds_read_b64_tr_b16 v[98:99], v1 offset:512
  ds_read_b64_tr_b16 v[100:101], v1 offset:4096
  ds_read_b64_tr_b16 v[102:103], v1 offset:4608
  ds_read_b64_tr_b16 v[104:105], v2 offset:0
  ds_read_b64_tr_b16 v[106:107], v2 offset:512
  ds_read_b64_tr_b16 v[108:109], v2 offset:4096
  ds_read_b64_tr_b16 v[110:111], v2 offset:4608
  ds_read_b64_tr_b16 v[112:113], v7 offset:0
  ds_read_b64_tr_b16 v[114:115], v7 offset:512
  ds_read_b64_tr_b16 v[116:117], v7 offset:4096
  ds_read_b64_tr_b16 v[118:119], v7 offset:4608
  ds_read_b64_tr_b16 v[120:121], v8 offset:0
  ds_read_b64_tr_b16 v[122:123], v8 offset:512
  ds_read_b64_tr_b16 v[124:125], v8 offset:4096
  ds_read_b64_tr_b16 v[126:127], v8 offset:4608
  s_cmp_lg_u32 s3, 7
  s_cbranch_scc1 L_rem_loop
  s_mov_b64 exec, 1
  buffer_store_dword v240, v14, s[64:67], s70 offen offset:128 sc1
  s_mov_b64 exec, -1
L_rem_loop:
  s_waitcnt vmcnt(9)
  s_barrier
  s_waitcnt lgkmcnt(8)
  v_mfma_f32_16x16x32_bf16 v[160:163], v[96:99], v[64:67], v[160:163]
  ds_read_b128 v[92:95], v12 offset:6144
  ds_read_b128 v[88:91], v11 offset:6144
  s_waitcnt lgkmcnt(14)
  v_mfma_f32_16x16x32_bf16 v[160:163], v[100:103], v[68:71], v[160:163]
  ds_read_b128 v[84:87], v12 offset:4096
  s_add_u32 m0, s76, 0
  s_nop 0
  buffer_load_dwordx4 v24, s[32:35], 0 offen lds
  v_mfma_f32_16x16x32_bf16 v[164:167], v[96:99], v[72:75], v[164:167]
  ds_read_b128 v[80:83], v11 offset:4096
  v_mfma_f32_16x16x32_bf16 v[164:167], v[100:103], v[76:79], v[164:167]
  ds_read_b64_tr_b16 v[128:129], v1 offset:8192
  s_waitcnt lgkmcnt(14)
  v_mfma_f32_16x16x32_bf16 v[176:179], v[104:107], v[64:67], v[176:179]
  ds_read_b64_tr_b16 v[130:131], v1 offset:8704
  s_add_u32 m0, s76, 1024
  s_nop 0
  buffer_load_dwordx4 v25, s[32:35], 0 offen lds
  s_waitcnt lgkmcnt(14)
  v_mfma_f32_16x16x32_bf16 v[176:179], v[108:111], v[68:71], v[176:179]
  ds_read_b64_tr_b16 v[132:133], v1 offset:12288
  v_mfma_f32_16x16x32_bf16 v[180:183], v[104:107], v[72:75], v[180:183]
  ds_read_b64_tr_b16 v[134:135], v1 offset:12800
  v_mfma_f32_16x16x32_bf16 v[180:183], v[108:111], v[76:79], v[180:183]
  ds_read_b64_tr_b16 v[136:137], v2 offset:8192
  s_waitcnt lgkmcnt(14)
  v_mfma_f32_16x16x32_bf16 v[192:195], v[112:115], v[64:67], v[192:195]
  ds_read_b64_tr_b16 v[138:139], v2 offset:8704
  s_add_u32 m0, s76, 2048
  s_nop 0
  buffer_load_dwordx4 v26, s[32:35], 0 offen lds
  s_waitcnt lgkmcnt(14)
  v_mfma_f32_16x16x32_bf16 v[192:195], v[116:119], v[68:71], v[192:195]
  ds_read_b64_tr_b16 v[140:141], v2 offset:12288
  v_mfma_f32_16x16x32_bf16 v[196:199], v[112:115], v[72:75], v[196:199]
  ds_read_b64_tr_b16 v[142:143], v2 offset:12800
  v_mfma_f32_16x16x32_bf16 v[196:199], v[116:119], v[76:79], v[196:199]
  v_add_u32_dpp v28, v9, v14 row_newbcast:4 row_mask:0xf bank_mask:0x3
  v_add_u32_dpp v29, v9, v15 row_newbcast:5 row_mask:0xf bank_mask:0x3
  s_waitcnt lgkmcnt(14)
  v_mfma_f32_16x16x32_bf16 v[208:211], v[120:123], v[64:67], v[208:211]
  s_add_u32 m0, s76, 3072
  s_nop 0
  buffer_load_dwordx4 v27, s[32:35], 0 offen lds
  v_add_u32_dpp v30, v9, v14 row_newbcast:6 row_mask:0xf bank_mask:0x3
  v_add_u32_dpp v31, v9, v15 row_newbcast:7 row_mask:0xf bank_mask:0x3
  s_waitcnt lgkmcnt(12)
  v_mfma_f32_16x16x32_bf16 v[208:211], v[124:127], v[68:71], v[208:211]
  v_add_u32_dpp v28, v9, v14 row_newbcast:12 row_mask:0xf bank_mask:0xc
  v_mfma_f32_16x16x32_bf16 v[212:215], v[120:123], v[72:75], v[212:215]
  v_add_u32_dpp v29, v9, v15 row_newbcast:13 row_mask:0xf bank_mask:0xc
  v_add_u32_dpp v30, v9, v14 row_newbcast:14 row_mask:0xf bank_mask:0xc
  v_mfma_f32_16x16x32_bf16 v[212:215], v[124:127], v[76:79], v[212:215]
  v_add_u32_dpp v31, v9, v15 row_newbcast:15 row_mask:0xf bank_mask:0xc
  s_waitcnt vmcnt(9)
  s_waitcnt lgkmcnt(8)
  v_mfma_f32_16x16x32_bf16 v[168:171], v[96:99], v[80:83], v[168:171]
  ds_read_b128 v[76:79], v12 offset:10240
  ds_read_b128 v[72:75], v11 offset:10240
  v_mfma_f32_16x16x32_bf16 v[168:171], v[100:103], v[84:87], v[168:171]
  ds_read_b128 v[68:71], v12 offset:8192
  s_add_u32 m0, s76, 4096
  s_nop 0
  buffer_load_dwordx4 v28, s[32:35], 0 offen lds
  v_mfma_f32_16x16x32_bf16 v[172:175], v[96:99], v[88:91], v[172:175]
  ds_read_b128 v[64:67], v11 offset:8192
  v_mfma_f32_16x16x32_bf16 v[172:175], v[100:103], v[92:95], v[172:175]
  ds_read_b64_tr_b16 v[144:145], v7 offset:8192
  v_mfma_f32_16x16x32_bf16 v[184:187], v[104:107], v[80:83], v[184:187]
  ds_read_b64_tr_b16 v[146:147], v7 offset:8704
  s_add_u32 m0, s76, 5120
  s_nop 0
  buffer_load_dwordx4 v29, s[32:35], 0 offen lds
  v_mfma_f32_16x16x32_bf16 v[184:187], v[108:111], v[84:87], v[184:187]
  ds_read_b64_tr_b16 v[148:149], v7 offset:12288
  v_mfma_f32_16x16x32_bf16 v[188:191], v[104:107], v[88:91], v[188:191]
  ds_read_b64_tr_b16 v[150:151], v7 offset:12800
  v_mfma_f32_16x16x32_bf16 v[188:191], v[108:111], v[92:95], v[188:191]
  ds_read_b64_tr_b16 v[152:153], v8 offset:8192
  s_add_u32 m0, s76, 6144
  s_nop 0
  buffer_load_dwordx4 v30, s[32:35], 0 offen lds
  v_mfma_f32_16x16x32_bf16 v[200:203], v[112:115], v[80:83], v[200:203]
  ds_read_b64_tr_b16 v[154:155], v8 offset:8704
  v_mfma_f32_16x16x32_bf16 v[200:203], v[116:119], v[84:87], v[200:203]
  ds_read_b64_tr_b16 v[156:157], v8 offset:12288
  v_mfma_f32_16x16x32_bf16 v[204:207], v[112:115], v[88:91], v[204:207]
  ds_read_b64_tr_b16 v[158:159], v8 offset:12800
  s_add_u32 m0, s76, 7168
  s_nop 0
  buffer_load_dwordx4 v31, s[32:35], 0 offen lds
  v_mfma_f32_16x16x32_bf16 v[204:207], v[116:119], v[92:95], v[204:207]
  s_set_gpr_idx_on s73, gpr_idx(SRC0)
  s_nop 0
  v_mov_b32 v9, v32
  s_set_gpr_idx_off
  s_add_u32 s73, s73, 1
  v_add_u32_dpp v24, v9, v14 row_newbcast:0 row_mask:0xf bank_mask:0x3
  v_mfma_f32_16x16x32_bf16 v[216:219], v[120:123], v[80:83], v[216:219]
  v_add_u32_dpp v25, v9, v15 row_newbcast:1 row_mask:0xf bank_mask:0x3
  v_add_u32_dpp v26, v9, v14 row_newbcast:2 row_mask:0xf bank_mask:0x3
  v_mfma_f32_16x16x32_bf16 v[216:219], v[124:127], v[84:87], v[216:219]
  s_xor_b32 s75, s75, 16384
  s_add_u32 m0, s75, 8192
  s_nop 0
  buffer_load_dwordx4 v13, s[44:47], s74 offen lds
  s_add_u32 s74, s74, 212992
  s_xor_b32 s75, s75, 16384
  v_add_u32_dpp v27, v9, v15 row_newbcast:3 row_mask:0xf bank_mask:0x3
  v_add_u32_dpp v24, v9, v14 row_newbcast:8 row_mask:0xf bank_mask:0xc
  v_mfma_f32_16x16x32_bf16 v[220:223], v[120:123], v[88:91], v[220:223]
  v_add_u32_dpp v25, v9, v15 row_newbcast:9 row_mask:0xf bank_mask:0xc
  v_add_u32_dpp v26, v9, v14 row_newbcast:10 row_mask:0xf bank_mask:0xc
  v_mfma_f32_16x16x32_bf16 v[220:223], v[124:127], v[92:95], v[220:223]
  v_add_u32_dpp v27, v9, v15 row_newbcast:11 row_mask:0xf bank_mask:0xc
L_rnv:
  s_waitcnt vmcnt(9)
  s_barrier
  v_xor_b32 v1, 16384, v1
  v_xor_b32 v2, 16384, v2
  v_xor_b32 v7, 16384, v7
  v_xor_b32 v8, 16384, v8
  s_waitcnt lgkmcnt(8)
  v_mfma_f32_16x16x32_bf16 v[160:163], v[128:131], v[64:67], v[160:163]
  ds_read_b128 v[92:95], v12 offset:14336
  ds_read_b128 v[88:91], v11 offset:14336
  v_mfma_f32_16x16x32_bf16 v[160:163], v[132:135], v[68:71], v[160:163]
  ds_read_b128 v[84:87], v12 offset:12288
  s_add_u32 m0, s76, 8192
  s_nop 0
  buffer_load_dwordx4 v24, s[32:35], 0 offen lds
  v_mfma_f32_16x16x32_bf16 v[164:167], v[128:131], v[72:75], v[164:167]
  ds_read_b128 v[80:83], v11 offset:12288
  v_mfma_f32_16x16x32_bf16 v[164:167], v[132:135], v[76:79], v[164:167]
  ds_read_b64_tr_b16 v[96:97], v1 offset:0
  v_mfma_f32_16x16x32_bf16 v[176:179], v[136:139], v[64:67], v[176:179]
  ds_read_b64_tr_b16 v[98:99], v1 offset:512
  s_add_u32 m0, s76, 9216
  s_nop 0
  buffer_load_dwordx4 v25, s[32:35], 0 offen lds
  v_mfma_f32_16x16x32_bf16 v[176:179], v[140:143], v[68:71], v[176:179]
  ds_read_b64_tr_b16 v[100:101], v1 offset:4096
  v_mfma_f32_16x16x32_bf16 v[180:183], v[136:139], v[72:75], v[180:183]
  ds_read_b64_tr_b16 v[102:103], v1 offset:4608
  v_mfma_f32_16x16x32_bf16 v[180:183], v[140:143], v[76:79], v[180:183]
  ds_read_b64_tr_b16 v[104:105], v2 offset:0
  s_waitcnt lgkmcnt(14)
  v_mfma_f32_16x16x32_bf16 v[192:195], v[144:147], v[64:67], v[192:195]
  ds_read_b64_tr_b16 v[106:107], v2 offset:512
  s_add_u32 m0, s76, 10240
  s_nop 0
  buffer_load_dwordx4 v26, s[32:35], 0 offen lds
  s_waitcnt lgkmcnt(14)
  v_mfma_f32_16x16x32_bf16 v[192:195], v[148:151], v[68:71], v[192:195]
  ds_read_b64_tr_b16 v[108:109], v2 offset:4096
  v_mfma_f32_16x16x32_bf16 v[196:199], v[144:147], v[72:75], v[196:199]
  ds_read_b64_tr_b16 v[110:111], v2 offset:4608
  v_mfma_f32_16x16x32_bf16 v[196:199], v[148:151], v[76:79], v[196:199]
  v_add_u32_dpp v28, v9, v14 row_newbcast:4 row_mask:0xf bank_mask:0x3
  v_add_u32_dpp v29, v9, v15 row_newbcast:5 row_mask:0xf bank_mask:0x3
  s_waitcnt lgkmcnt(14)
  v_mfma_f32_16x16x32_bf16 v[208:211], v[152:155], v[64:67], v[208:211]
  s_add_u32 m0, s76, 11264
  s_nop 0
  buffer_load_dwordx4 v27, s[32:35], 0 offen lds
  v_add_u32_dpp v30, v9, v14 row_newbcast:6 row_mask:0xf bank_mask:0x3
  v_add_u32_dpp v31, v9, v15 row_newbcast:7 row_mask:0xf bank_mask:0x3
  s_waitcnt lgkmcnt(12)
  v_mfma_f32_16x16x32_bf16 v[208:211], v[156:159], v[68:71], v[208:211]
  v_add_u32_dpp v28, v9, v14 row_newbcast:12 row_mask:0xf bank_mask:0xc
  v_mfma_f32_16x16x32_bf16 v[212:215], v[152:155], v[72:75], v[212:215]
  v_add_u32_dpp v29, v9, v15 row_newbcast:13 row_mask:0xf bank_mask:0xc
  v_add_u32_dpp v30, v9, v14 row_newbcast:14 row_mask:0xf bank_mask:0xc
  v_mfma_f32_16x16x32_bf16 v[212:215], v[156:159], v[76:79], v[212:215]
  v_add_u32_dpp v31, v9, v15 row_newbcast:15 row_mask:0xf bank_mask:0xc
  s_waitcnt vmcnt(9)
  s_waitcnt lgkmcnt(8)
  v_mfma_f32_16x16x32_bf16 v[168:171], v[128:131], v[80:83], v[168:171]
  ds_read_b128 v[76:79], v12 offset:2048
  ds_read_b128 v[72:75], v11 offset:2048
  v_mfma_f32_16x16x32_bf16 v[168:171], v[132:135], v[84:87], v[168:171]
  ds_read_b128 v[68:71], v12 offset:0
  s_add_u32 m0, s76, 12288
  s_nop 0
  buffer_load_dwordx4 v28, s[32:35], 0 offen lds
  v_mfma_f32_16x16x32_bf16 v[172:175], v[128:131], v[88:91], v[172:175]
  ds_read_b128 v[64:67], v11 offset:0
  v_mfma_f32_16x16x32_bf16 v[172:175], v[132:135], v[92:95], v[172:175]
  ds_read_b64_tr_b16 v[112:113], v7 offset:0
  v_mfma_f32_16x16x32_bf16 v[184:187], v[136:139], v[80:83], v[184:187]
  ds_read_b64_tr_b16 v[114:115], v7 offset:512
  s_add_u32 m0, s76, 13312
  s_nop 0
  buffer_load_dwordx4 v29, s[32:35], 0 offen lds
  v_mfma_f32_16x16x32_bf16 v[184:187], v[140:143], v[84:87], v[184:187]
  ds_read_b64_tr_b16 v[116:117], v7 offset:4096
  v_mfma_f32_16x16x32_bf16 v[188:191], v[136:139], v[88:91], v[188:191]
  ds_read_b64_tr_b16 v[118:119], v7 offset:4608
  v_mfma_f32_16x16x32_bf16 v[188:191], v[140:143], v[92:95], v[188:191]
  ds_read_b64_tr_b16 v[120:121], v8 offset:0
  s_add_u32 m0, s76, 14336
  s_nop 0
  buffer_load_dwordx4 v30, s[32:35], 0 offen lds
  v_mfma_f32_16x16x32_bf16 v[200:203], v[144:147], v[80:83], v[200:203]
  ds_read_b64_tr_b16 v[122:123], v8 offset:512
  v_mfma_f32_16x16x32_bf16 v[200:203], v[148:151], v[84:87], v[200:203]
  ds_read_b64_tr_b16 v[124:125], v8 offset:4096
  v_mfma_f32_16x16x32_bf16 v[204:207], v[144:147], v[88:91], v[204:207]
  ds_read_b64_tr_b16 v[126:127], v8 offset:4608
  s_add_u32 m0, s76, 15360
  s_nop 0
  buffer_load_dwordx4 v31, s[32:35], 0 offen lds
  v_mfma_f32_16x16x32_bf16 v[204:207], v[148:151], v[92:95], v[204:207]
  s_set_gpr_idx_on s73, gpr_idx(SRC0)
  s_nop 0
  v_mov_b32 v9, v32
  s_set_gpr_idx_off
  s_add_u32 s73, s73, 1
  v_add_u32_dpp v24, v9, v14 row_newbcast:0 row_mask:0xf bank_mask:0x3
  v_mfma_f32_16x16x32_bf16 v[216:219], v[152:155], v[80:83], v[216:219]
  v_add_u32_dpp v25, v9, v15 row_newbcast:1 row_mask:0xf bank_mask:0x3
  v_add_u32_dpp v26, v9, v14 row_newbcast:2 row_mask:0xf bank_mask:0x3
  v_mfma_f32_16x16x32_bf16 v[216:219], v[156:159], v[84:87], v[216:219]
  s_add_u32 m0, s75, 0
  s_nop 0
  buffer_load_dwordx4 v13, s[44:47], s74 offen lds
  s_add_u32 s74, s74, 212992
  s_xor_b32 s75, s75, 16384
  v_add_u32_dpp v27, v9, v15 row_newbcast:3 row_mask:0xf bank_mask:0x3
  v_add_u32_dpp v24, v9, v14 row_newbcast:8 row_mask:0xf bank_mask:0xc
  v_mfma_f32_16x16x32_bf16 v[220:223], v[152:155], v[88:91], v[220:223]
  v_add_u32_dpp v25, v9, v15 row_newbcast:9 row_mask:0xf bank_mask:0xc
  v_add_u32_dpp v26, v9, v14 row_newbcast:10 row_mask:0xf bank_mask:0xc
  v_mfma_f32_16x16x32_bf16 v[220:223], v[156:159], v[92:95], v[220:223]
  v_add_u32_dpp v27, v9, v15 row_newbcast:11 row_mask:0xf bank_mask:0xc
  s_cmp_lt_u32 s73, 27
  s_cbranch_scc1 L_rem_loop
  s_waitcnt vmcnt(9)
  s_barrier
  s_waitcnt lgkmcnt(8)
  v_mfma_f32_16x16x32_bf16 v[160:163], v[96:99], v[64:67], v[160:163]
  ds_read_b128 v[92:95], v12 offset:6144
  ds_read_b128 v[88:91], v11 offset:6144
  v_mfma_f32_16x16x32_bf16 v[160:163], v[100:103], v[68:71], v[160:163]
  ds_read_b128 v[84:87], v12 offset:4096
  buffer_load_dwordx2 v[224:225], v248, s[48:51], 0 offen offset:3200
  v_mfma_f32_16x16x32_bf16 v[164:167], v[96:99], v[72:75], v[164:167]
  ds_read_b128 v[80:83], v11 offset:4096
  buffer_load_dwordx2 v[226:227], v248, s[48:51], 0 offen offset:3232
  v_mfma_f32_16x16x32_bf16 v[164:167], v[100:103], v[76:79], v[164:167]
  ds_read_b64_tr_b16 v[128:129], v1 offset:8192
  v_mfma_f32_16x16x32_bf16 v[176:179], v[104:107], v[64:67], v[176:179]
  ds_read_b64_tr_b16 v[130:131], v1 offset:8704
  buffer_load_dwordx2 v[228:229], v248, s[48:51], 0 offen offset:3264
  v_mfma_f32_16x16x32_bf16 v[176:179], v[108:111], v[68:71], v[176:179]
  ds_read_b64_tr_b16 v[132:133], v1 offset:12288
  v_mfma_f32_16x16x32_bf16 v[180:183], v[104:107], v[72:75], v[180:183]
  ds_read_b64_tr_b16 v[134:135], v1 offset:12800
  buffer_load_dwordx2 v[230:231], v248, s[48:51], 0 offen offset:3296
  v_mfma_f32_16x16x32_bf16 v[180:183], v[108:111], v[76:79], v[180:183]
  ds_read_b64_tr_b16 v[136:137], v2 offset:8192
  buffer_load_dwordx2 v[232:233], v248, s[52:55], 0 offen offset:3200
  s_waitcnt lgkmcnt(14)
  v_mfma_f32_16x16x32_bf16 v[192:195], v[112:115], v[64:67], v[192:195]
  ds_read_b64_tr_b16 v[138:139], v2 offset:8704
  s_waitcnt lgkmcnt(14)
  v_mfma_f32_16x16x32_bf16 v[192:195], v[116:119], v[68:71], v[192:195]
  ds_read_b64_tr_b16 v[140:141], v2 offset:12288
  buffer_load_dwordx2 v[234:235], v248, s[52:55], 0 offen offset:3232
  v_mfma_f32_16x16x32_bf16 v[196:199], v[112:115], v[72:75], v[196:199]
  ds_read_b64_tr_b16 v[142:143], v2 offset:12800
  v_mfma_f32_16x16x32_bf16 v[196:199], v[116:119], v[76:79], v[196:199]
  buffer_load_dwordx2 v[236:237], v248, s[52:55], 0 offen offset:3264
  s_waitcnt lgkmcnt(14)
  v_mfma_f32_16x16x32_bf16 v[208:211], v[120:123], v[64:67], v[208:211]
  buffer_load_dwordx2 v[238:239], v248, s[52:55], 0 offen offset:3296
  s_waitcnt lgkmcnt(12)
  v_mfma_f32_16x16x32_bf16 v[208:211], v[124:127], v[68:71], v[208:211]
  v_mfma_f32_16x16x32_bf16 v[212:215], v[120:123], v[72:75], v[212:215]
  buffer_load_dword v255, v3, s[56:59], s77 offen
  v_mfma_f32_16x16x32_bf16 v[212:215], v[124:127], v[76:79], v[212:215]
  s_waitcnt vmcnt(14)
  s_waitcnt lgkmcnt(8)
  v_mfma_f32_16x16x32_bf16 v[168:171], v[96:99], v[80:83], v[168:171]
  ds_read_b128 v[76:79], v12 offset:10240
  ds_read_b128 v[72:75], v11 offset:10240
  v_mfma_f32_16x16x32_bf16 v[168:171], v[100:103], v[84:87], v[168:171]
  ds_read_b128 v[68:71], v12 offset:8192
  v_mfma_f32_16x16x32_bf16 v[172:175], v[96:99], v[88:91], v[172:175]
  ds_read_b128 v[64:67], v11 offset:8192
  v_mfma_f32_16x16x32_bf16 v[172:175], v[100:103], v[92:95], v[172:175]
  ds_read_b64_tr_b16 v[144:145], v7 offset:8192
  v_mfma_f32_16x16x32_bf16 v[184:187], v[104:107], v[80:83], v[184:187]
  ds_read_b64_tr_b16 v[146:147], v7 offset:8704
  v_mfma_f32_16x16x32_bf16 v[184:187], v[108:111], v[84:87], v[184:187]
  ds_read_b64_tr_b16 v[148:149], v7 offset:12288
  v_mfma_f32_16x16x32_bf16 v[188:191], v[104:107], v[88:91], v[188:191]
  ds_read_b64_tr_b16 v[150:151], v7 offset:12800
  v_mfma_f32_16x16x32_bf16 v[188:191], v[108:111], v[92:95], v[188:191]
  ds_read_b64_tr_b16 v[152:153], v8 offset:8192
  v_mfma_f32_16x16x32_bf16 v[200:203], v[112:115], v[80:83], v[200:203]
  ds_read_b64_tr_b16 v[154:155], v8 offset:8704
  v_mfma_f32_16x16x32_bf16 v[200:203], v[116:119], v[84:87], v[200:203]
  ds_read_b64_tr_b16 v[156:157], v8 offset:12288
  v_mfma_f32_16x16x32_bf16 v[204:207], v[112:115], v[88:91], v[204:207]
  ds_read_b64_tr_b16 v[158:159], v8 offset:12800
  v_mfma_f32_16x16x32_bf16 v[204:207], v[116:119], v[92:95], v[204:207]
  v_mfma_f32_16x16x32_bf16 v[216:219], v[120:123], v[80:83], v[216:219]
  v_mfma_f32_16x16x32_bf16 v[216:219], v[124:127], v[84:87], v[216:219]
  v_mfma_f32_16x16x32_bf16 v[220:223], v[120:123], v[88:91], v[220:223]
  v_mfma_f32_16x16x32_bf16 v[220:223], v[124:127], v[92:95], v[220:223]
  s_waitcnt vmcnt(10)
  s_waitcnt lgkmcnt(8)
  v_mfma_f32_16x16x32_bf16 v[160:163], v[128:131], v[64:67], v[160:163]
  ds_read_b128 v[92:95], v12 offset:14336
  v_mfma_f32_16x16x32_bf16 v[160:163], v[132:135], v[68:71], v[160:163]
  v_mfma_f32_16x16x32_bf16 v[164:167], v[128:131], v[72:75], v[164:167]
  ds_read_b128 v[88:91], v11 offset:14336
  v_mfma_f32_16x16x32_bf16 v[164:167], v[132:135], v[76:79], v[164:167]
  s_waitcnt vmcnt(4)
  v_lshlrev_b32 v48, 16, v232
  v_and_b32 v49, 0xffff0000, v232
  v_mfma_f32_16x16x32_bf16 v[176:179], v[136:139], v[64:67], v[176:179]
  v_lshlrev_b32 v50, 16, v233
  v_and_b32 v51, 0xffff0000, v233
  v_mfma_f32_16x16x32_bf16 v[176:179], v[140:143], v[68:71], v[176:179]
  ds_read_b128 v[84:87], v12 offset:12288
  s_waitcnt vmcnt(3)
  v_lshlrev_b32 v52, 16, v234
  v_and_b32 v53, 0xffff0000, v234
  v_mfma_f32_16x16x32_bf16 v[180:183], v[136:139], v[72:75], v[180:183]
  v_lshlrev_b32 v54, 16, v235
  v_and_b32 v55, 0xffff0000, v235
  v_mfma_f32_16x16x32_bf16 v[180:183], v[140:143], v[76:79], v[180:183]
  s_waitcnt vmcnt(2)
  v_lshlrev_b32 v56, 16, v236
  v_and_b32 v57, 0xffff0000, v236
  s_waitcnt lgkmcnt(9)
  v_mfma_f32_16x16x32_bf16 v[192:195], v[144:147], v[64:67], v[192:195]
  ds_read_b128 v[80:83], v11 offset:12288
  v_lshlrev_b32 v58, 16, v237
  s_waitcnt lgkmcnt(8)
  v_mfma_f32_16x16x32_bf16 v[192:195], v[148:151], v[68:71], v[192:195]
  v_and_b32 v59, 0xffff0000, v237
  s_waitcnt vmcnt(1)
  v_lshlrev_b32 v60, 16, v238
  v_mfma_f32_16x16x32_bf16 v[196:199], v[144:147], v[72:75], v[196:199]
  v_and_b32 v61, 0xffff0000, v238
  v_lshlrev_b32 v62, 16, v239
  v_mfma_f32_16x16x32_bf16 v[196:199], v[148:151], v[76:79], v[196:199]
  v_and_b32 v63, 0xffff0000, v239
  v_lshlrev_b32 v32, 16, v224
  s_waitcnt lgkmcnt(6)
  v_mfma_f32_16x16x32_bf16 v[208:211], v[152:155], v[64:67], v[208:211]
  v_and_b32 v33, 0xffff0000, v224
  v_lshlrev_b32 v34, 16, v225
  s_waitcnt lgkmcnt(4)
  v_mfma_f32_16x16x32_bf16 v[208:211], v[156:159], v[68:71], v[208:211]
  v_and_b32 v35, 0xffff0000, v225
  v_lshlrev_b32 v36, 16, v226
  v_mfma_f32_16x16x32_bf16 v[212:215], v[152:155], v[72:75], v[212:215]
  v_and_b32 v37, 0xffff0000, v226
  v_mfma_f32_16x16x32_bf16 v[212:215], v[156:159], v[76:79], v[212:215]
  s_waitcnt lgkmcnt(0)
  v_mfma_f32_16x16x32_bf16 v[168:171], v[128:131], v[80:83], v[168:171]
  v_lshlrev_b32 v38, 16, v227
  v_and_b32 v39, 0xffff0000, v227
  v_mfma_f32_16x16x32_bf16 v[168:171], v[132:135], v[84:87], v[168:171]
  v_lshlrev_b32 v40, 16, v228
  v_mfma_f32_16x16x32_bf16 v[172:175], v[128:131], v[88:91], v[172:175]
  v_and_b32 v41, 0xffff0000, v228
  v_mfma_f32_16x16x32_bf16 v[172:175], v[132:135], v[92:95], v[172:175]
  v_lshlrev_b32 v42, 16, v229
  v_mfma_f32_16x16x32_bf16 v[184:187], v[136:139], v[80:83], v[184:187]
  v_and_b32 v43, 0xffff0000, v229
  v_lshlrev_b32 v44, 16, v230
  v_mfma_f32_16x16x32_bf16 v[184:187], v[140:143], v[84:87], v[184:187]
  v_and_b32 v45, 0xffff0000, v230
  v_mfma_f32_16x16x32_bf16 v[188:191], v[136:139], v[88:91], v[188:191]
  v_lshlrev_b32 v46, 16, v231
  v_mfma_f32_16x16x32_bf16 v[188:191], v[140:143], v[92:95], v[188:191]
  v_and_b32 v47, 0xffff0000, v231
  v_mfma_f32_16x16x32_bf16 v[200:203], v[144:147], v[80:83], v[200:203]
  v_rcp_f32 v48, v48
  v_rcp_f32 v49, v49
  v_mfma_f32_16x16x32_bf16 v[200:203], v[148:151], v[84:87], v[200:203]
  v_rcp_f32 v50, v50
  v_mfma_f32_16x16x32_bf16 v[204:207], v[144:147], v[88:91], v[204:207]
  v_rcp_f32 v51, v51
  v_mfma_f32_16x16x32_bf16 v[204:207], v[148:151], v[92:95], v[204:207]
  v_rcp_f32 v52, v52
  v_mfma_f32_16x16x32_bf16 v[216:219], v[152:155], v[80:83], v[216:219]
  v_rcp_f32 v53, v53
  v_rcp_f32 v54, v54
  v_mfma_f32_16x16x32_bf16 v[216:219], v[156:159], v[84:87], v[216:219]
  v_rcp_f32 v55, v55
  v_mfma_f32_16x16x32_bf16 v[220:223], v[152:155], v[88:91], v[220:223]
  v_rcp_f32 v56, v56
  v_mfma_f32_16x16x32_bf16 v[220:223], v[156:159], v[92:95], v[220:223]
  v_rcp_f32 v57, v57
  s_nop 0
L_repi:
  v_rcp_f32 v58, v58
  v_rcp_f32 v59, v59
  v_rcp_f32 v60, v60
  v_rcp_f32 v61, v61
  v_rcp_f32 v62, v62
  v_rcp_f32 v63, v63
  v_med3_f32 v48, v48, -v244, v244
  v_med3_f32 v49, v49, -v244, v244
  v_med3_f32 v50, v50, -v244, v244
  v_med3_f32 v51, v51, -v244, v244
  v_med3_f32 v52, v52, -v244, v244
  v_med3_f32 v53, v53, -v244, v244
  v_med3_f32 v54, v54, -v244, v244
  v_med3_f32 v55, v55, -v244, v244
  v_med3_f32 v56, v56, -v244, v244
  v_med3_f32 v57, v57, -v244, v244
  v_med3_f32 v58, v58, -v244, v244
  v_med3_f32 v59, v59, -v244, v244
  v_med3_f32 v60, v60, -v244, v244
  v_med3_f32 v61, v61, -v244, v244
  v_med3_f32 v62, v62, -v244, v244
  v_med3_f32 v63, v63, -v244, v244
  v_pk_add_f32 v[160:161], v[160:161], v[32:33]
  v_pk_add_f32 v[162:163], v[162:163], v[34:35]
  v_pk_add_f32 v[164:165], v[164:165], v[32:33]
  v_pk_add_f32 v[166:167], v[166:167], v[34:35]
  v_pk_add_f32 v[168:169], v[168:169], v[32:33]
  v_pk_add_f32 v[170:171], v[170:171], v[34:35]
  v_pk_add_f32 v[172:173], v[172:173], v[32:33]
  v_pk_add_f32 v[174:175], v[174:175], v[34:35]
  v_pk_add_f32 v[176:177], v[176:177], v[36:37]
  v_pk_add_f32 v[178:179], v[178:179], v[38:39]
  v_pk_add_f32 v[180:181], v[180:181], v[36:37]
  v_pk_add_f32 v[182:183], v[182:183], v[38:39]
  v_pk_add_f32 v[184:185], v[184:185], v[36:37]
  v_pk_add_f32 v[186:187], v[186:187], v[38:39]
  v_pk_add_f32 v[188:189], v[188:189], v[36:37]
  v_pk_add_f32 v[190:191], v[190:191], v[38:39]
  v_pk_add_f32 v[192:193], v[192:193], v[40:41]
  v_pk_add_f32 v[194:195], v[194:195], v[42:43]
  v_pk_add_f32 v[196:197], v[196:197], v[40:41]
  v_pk_add_f32 v[198:199], v[198:199], v[42:43]
  v_pk_add_f32 v[200:201], v[200:201], v[40:41]
  v_pk_add_f32 v[202:203], v[202:203], v[42:43]
  v_pk_add_f32 v[204:205], v[204:205], v[40:41]
  v_pk_add_f32 v[206:207], v[206:207], v[42:43]
  v_pk_add_f32 v[208:209], v[208:209], v[44:45]
  v_pk_add_f32 v[210:211], v[210:211], v[46:47]
  v_pk_add_f32 v[212:213], v[212:213], v[44:45]
  v_pk_add_f32 v[214:215], v[214:215], v[46:47]
  v_pk_add_f32 v[216:217], v[216:217], v[44:45]
  v_pk_add_f32 v[218:219], v[218:219], v[46:47]
  v_pk_add_f32 v[220:221], v[220:221], v[44:45]
  v_pk_add_f32 v[222:223], v[222:223], v[46:47]
  v_pk_mul_f32 v[64:65], v[160:161], v[160:161]
  v_pk_mul_f32 v[68:69], v[164:165], v[164:165]
  v_pk_mul_f32 v[72:73], v[168:169], v[168:169]
  v_pk_mul_f32 v[76:77], v[172:173], v[172:173]
  v_pk_fma_f32 v[64:65], v[64:65], v[242:243], v[240:241]
  v_pk_fma_f32 v[68:69], v[68:69], v[242:243], v[240:241]
  v_pk_fma_f32 v[72:73], v[72:73], v[242:243], v[240:241]
  v_pk_fma_f32 v[76:77], v[76:77], v[242:243], v[240:241]
  v_pk_mul_f32 v[64:65], v[64:65], v[160:161]
  v_pk_mul_f32 v[68:69], v[68:69], v[164:165]
  v_pk_mul_f32 v[72:73], v[72:73], v[168:169]
  v_pk_mul_f32 v[76:77], v[76:77], v[172:173]
  v_exp_f32 v64, v64
  v_exp_f32 v65, v65
  v_exp_f32 v68, v68
  v_exp_f32 v69, v69
  v_exp_f32 v72, v72
  v_exp_f32 v73, v73
  v_exp_f32 v76, v76
  v_exp_f32 v77, v77
  v_pk_fma_f32 v[64:65], v[64:65], v[48:49], v[48:49]
  v_pk_fma_f32 v[68:69], v[68:69], v[48:49], v[48:49]
  v_pk_fma_f32 v[72:73], v[72:73], v[48:49], v[48:49]
  v_pk_fma_f32 v[76:77], v[76:77], v[48:49], v[48:49]
  v_rcp_f32 v64, v64
  v_rcp_f32 v65, v65
  v_rcp_f32 v68, v68
  v_rcp_f32 v69, v69
  v_rcp_f32 v72, v72
  v_rcp_f32 v73, v73
  v_rcp_f32 v76, v76
  v_rcp_f32 v77, v77
  v_pk_mul_f32 v[16:17], v[64:65], v[160:161]
  v_pk_mul_f32 v[18:19], v[68:69], v[164:165]
  v_pk_mul_f32 v[20:21], v[72:73], v[168:169]
  v_pk_mul_f32 v[22:23], v[76:77], v[172:173]
  v_pk_mul_f32 v[80:81], v[162:163], v[162:163]
  v_pk_mul_f32 v[84:85], v[166:167], v[166:167]
  v_pk_mul_f32 v[88:89], v[170:171], v[170:171]
  v_pk_mul_f32 v[92:93], v[174:175], v[174:175]
  v_pk_fma_f32 v[80:81], v[80:81], v[242:243], v[240:241]
  v_pk_fma_f32 v[84:85], v[84:85], v[242:243], v[240:241]
  v_pk_fma_f32 v[88:89], v[88:89], v[242:243], v[240:241]
  v_pk_fma_f32 v[92:93], v[92:93], v[242:243], v[240:241]
  v_pk_mul_f32 v[80:81], v[80:81], v[162:163]
  v_pk_mul_f32 v[84:85], v[84:85], v[166:167]
  v_pk_mul_f32 v[88:89], v[88:89], v[170:171]
  v_pk_mul_f32 v[92:93], v[92:93], v[174:175]
  v_exp_f32 v80, v80
  v_exp_f32 v81, v81
  v_exp_f32 v84, v84
  v_exp_f32 v85, v85
  v_exp_f32 v88, v88
  v_exp_f32 v89, v89
  v_exp_f32 v92, v92
  v_exp_f32 v93, v93
  v_pk_fma_f32 v[80:81], v[80:81], v[50:51], v[50:51]
  v_pk_fma_f32 v[84:85], v[84:85], v[50:51], v[50:51]
  v_pk_fma_f32 v[88:89], v[88:89], v[50:51], v[50:51]
  v_pk_fma_f32 v[92:93], v[92:93], v[50:51], v[50:51]
  v_rcp_f32 v80, v80
  v_rcp_f32 v81, v81
  v_rcp_f32 v84, v84
  v_rcp_f32 v85, v85
  v_rcp_f32 v88, v88
  v_rcp_f32 v89, v89
  v_rcp_f32 v92, v92
  v_rcp_f32 v93, v93
  v_pk_fma_f32 v[16:17], v[80:81], v[162:163], v[16:17]
  v_pk_fma_f32 v[18:19], v[84:85], v[166:167], v[18:19]
  v_pk_fma_f32 v[20:21], v[88:89], v[170:171], v[20:21]
  v_pk_fma_f32 v[22:23], v[92:93], v[174:175], v[22:23]
  v_pk_mul_f32 v[64:65], v[176:177], v[176:177]
  v_pk_mul_f32 v[68:69], v[180:181], v[180:181]
  v_pk_mul_f32 v[72:73], v[184:185], v[184:185]
  v_pk_mul_f32 v[76:77], v[188:189], v[188:189]
  v_pk_fma_f32 v[64:65], v[64:65], v[242:243], v[240:241]
  v_pk_fma_f32 v[68:69], v[68:69], v[242:243], v[240:241]
  v_pk_fma_f32 v[72:73], v[72:73], v[242:243], v[240:241]
  v_pk_fma_f32 v[76:77], v[76:77], v[242:243], v[240:241]
  v_pk_mul_f32 v[64:65], v[64:65], v[176:177]
  v_pk_mul_f32 v[68:69], v[68:69], v[180:181]
  v_pk_mul_f32 v[72:73], v[72:73], v[184:185]
  v_pk_mul_f32 v[76:77], v[76:77], v[188:189]
  v_exp_f32 v64, v64
  v_exp_f32 v65, v65
  v_exp_f32 v68, v68
  v_exp_f32 v69, v69
  v_exp_f32 v72, v72
  v_exp_f32 v73, v73
  v_exp_f32 v76, v76
  v_exp_f32 v77, v77
  v_pk_fma_f32 v[64:65], v[64:65], v[52:53], v[52:53]
  v_pk_fma_f32 v[68:69], v[68:69], v[52:53], v[52:53]
  v_pk_fma_f32 v[72:73], v[72:73], v[52:53], v[52:53]
  v_pk_fma_f32 v[76:77], v[76:77], v[52:53], v[52:53]
  v_rcp_f32 v64, v64
  v_rcp_f32 v65, v65
  v_rcp_f32 v68, v68
  v_rcp_f32 v69, v69
  v_rcp_f32 v72, v72
  v_rcp_f32 v73, v73
  v_rcp_f32 v76, v76
  v_rcp_f32 v77, v77
  v_pk_fma_f32 v[16:17], v[64:65], v[176:177], v[16:17]
  v_pk_fma_f32 v[18:19], v[68:69], v[180:181], v[18:19]
  v_pk_fma_f32 v[20:21], v[72:73], v[184:185], v[20:21]
  v_pk_fma_f32 v[22:23], v[76:77], v[188:189], v[22:23]
  v_pk_mul_f32 v[80:81], v[178:179], v[178:179]
  v_pk_mul_f32 v[84:85], v[182:183], v[182:183]
  v_pk_mul_f32 v[88:89], v[186:187], v[186:187]
  v_pk_mul_f32 v[92:93], v[190:191], v[190:191]
  v_pk_fma_f32 v[80:81], v[80:81], v[242:243], v[240:241]
  v_pk_fma_f32 v[84:85], v[84:85], v[242:243], v[240:241]
  v_pk_fma_f32 v[88:89], v[88:89], v[242:243], v[240:241]
  v_pk_fma_f32 v[92:93], v[92:93], v[242:243], v[240:241]
  v_pk_mul_f32 v[80:81], v[80:81], v[178:179]
  v_pk_mul_f32 v[84:85], v[84:85], v[182:183]
  v_pk_mul_f32 v[88:89], v[88:89], v[186:187]
  v_pk_mul_f32 v[92:93], v[92:93], v[190:191]
  v_exp_f32 v80, v80
  v_exp_f32 v81, v81
  v_exp_f32 v84, v84
  v_exp_f32 v85, v85
  v_exp_f32 v88, v88
  v_exp_f32 v89, v89
  v_exp_f32 v92, v92
  v_exp_f32 v93, v93
  v_pk_fma_f32 v[80:81], v[80:81], v[54:55], v[54:55]
  v_pk_fma_f32 v[84:85], v[84:85], v[54:55], v[54:55]
  v_pk_fma_f32 v[88:89], v[88:89], v[54:55], v[54:55]
  v_pk_fma_f32 v[92:93], v[92:93], v[54:55], v[54:55]
  v_rcp_f32 v80, v80
  v_rcp_f32 v81, v81
  v_rcp_f32 v84, v84
  v_rcp_f32 v85, v85
  v_rcp_f32 v88, v88
  v_rcp_f32 v89, v89
  v_rcp_f32 v92, v92
  v_rcp_f32 v93, v93
  v_pk_fma_f32 v[16:17], v[80:81], v[178:179], v[16:17]
  v_pk_fma_f32 v[18:19], v[84:85], v[182:183], v[18:19]
  v_pk_fma_f32 v[20:21], v[88:89], v[186:187], v[20:21]
  v_pk_fma_f32 v[22:23], v[92:93], v[190:191], v[22:23]
  v_pk_mul_f32 v[64:65], v[192:193], v[192:193]
  v_pk_mul_f32 v[68:69], v[196:197], v[196:197]
  v_pk_mul_f32 v[72:73], v[200:201], v[200:201]
  v_pk_mul_f32 v[76:77], v[204:205], v[204:205]
  v_pk_fma_f32 v[64:65], v[64:65], v[242:243], v[240:241]
  v_pk_fma_f32 v[68:69], v[68:69], v[242:243], v[240:241]
  v_pk_fma_f32 v[72:73], v[72:73], v[242:243], v[240:241]
  v_pk_fma_f32 v[76:77], v[76:77], v[242:243], v[240:241]
  v_pk_mul_f32 v[64:65], v[64:65], v[192:193]
  v_pk_mul_f32 v[68:69], v[68:69], v[196:197]
  v_pk_mul_f32 v[72:73], v[72:73], v[200:201]
  v_pk_mul_f32 v[76:77], v[76:77], v[204:205]
  v_exp_f32 v64, v64
  v_exp_f32 v65, v65
  v_exp_f32 v68, v68
  v_exp_f32 v69, v69
  v_exp_f32 v72, v72
  v_exp_f32 v73, v73
  v_exp_f32 v76, v76
  v_exp_f32 v77, v77
  v_pk_fma_f32 v[64:65], v[64:65], v[56:57], v[56:57]
  v_pk_fma_f32 v[68:69], v[68:69], v[56:57], v[56:57]
  v_pk_fma_f32 v[72:73], v[72:73], v[56:57], v[56:57]
  v_pk_fma_f32 v[76:77], v[76:77], v[56:57], v[56:57]
  v_rcp_f32 v64, v64
  v_rcp_f32 v65, v65
  v_rcp_f32 v68, v68
  v_rcp_f32 v69, v69
  v_rcp_f32 v72, v72
  v_rcp_f32 v73, v73
  v_rcp_f32 v76, v76
  v_rcp_f32 v77, v77
  v_pk_fma_f32 v[16:17], v[64:65], v[192:193], v[16:17]
  v_pk_fma_f32 v[18:19], v[68:69], v[196:197], v[18:19]
  v_pk_fma_f32 v[20:21], v[72:73], v[200:201], v[20:21]
  v_pk_fma_f32 v[22:23], v[76:77], v[204:205], v[22:23]
  v_pk_mul_f32 v[80:81], v[194:195], v[194:195]
  v_pk_mul_f32 v[84:85], v[198:199], v[198:199]
  v_pk_mul_f32 v[88:89], v[202:203], v[202:203]
  v_pk_mul_f32 v[92:93], v[206:207], v[206:207]
  v_pk_fma_f32 v[80:81], v[80:81], v[242:243], v[240:241]
  v_pk_fma_f32 v[84:85], v[84:85], v[242:243], v[240:241]
  v_pk_fma_f32 v[88:89], v[88:89], v[242:243], v[240:241]
  v_pk_fma_f32 v[92:93], v[92:93], v[242:243], v[240:241]
  v_pk_mul_f32 v[80:81], v[80:81], v[194:195]
  v_pk_mul_f32 v[84:85], v[84:85], v[198:199]
  v_pk_mul_f32 v[88:89], v[88:89], v[202:203]
  v_pk_mul_f32 v[92:93], v[92:93], v[206:207]
  v_exp_f32 v80, v80
  v_exp_f32 v81, v81
  v_exp_f32 v84, v84
  v_exp_f32 v85, v85
  v_exp_f32 v88, v88
  v_exp_f32 v89, v89
  v_exp_f32 v92, v92
  v_exp_f32 v93, v93
  v_pk_fma_f32 v[80:81], v[80:81], v[58:59], v[58:59]
  v_pk_fma_f32 v[84:85], v[84:85], v[58:59], v[58:59]
  v_pk_fma_f32 v[88:89], v[88:89], v[58:59], v[58:59]
  v_pk_fma_f32 v[92:93], v[92:93], v[58:59], v[58:59]
  v_rcp_f32 v80, v80
  v_rcp_f32 v81, v81
  v_rcp_f32 v84, v84
  v_rcp_f32 v85, v85
  v_rcp_f32 v88, v88
  v_rcp_f32 v89, v89
  v_rcp_f32 v92, v92
  v_rcp_f32 v93, v93
  v_pk_fma_f32 v[16:17], v[80:81], v[194:195], v[16:17]
  v_pk_fma_f32 v[18:19], v[84:85], v[198:199], v[18:19]
  v_pk_fma_f32 v[20:21], v[88:89], v[202:203], v[20:21]
  v_pk_fma_f32 v[22:23], v[92:93], v[206:207], v[22:23]
  buffer_load_dword v128, v3, s[60:63], s68 offen offset:0 sc1
  buffer_load_dword v129, v3, s[60:63], s68 offen offset:2048 sc1
  buffer_load_dword v130, v3, s[60:63], s69 offen offset:0 sc1
  buffer_load_dword v131, v3, s[60:63], s69 offen offset:2048 sc1
  buffer_load_dword v132, v3, s[60:63], s71 offen offset:0 sc1
  buffer_load_dword v133, v3, s[60:63], s71 offen offset:2048 sc1
  buffer_load_dword v134, v5, s[60:63], s71 offen sc1
  v_pk_mul_f32 v[64:65], v[208:209], v[208:209]
  v_pk_mul_f32 v[68:69], v[212:213], v[212:213]
  v_pk_mul_f32 v[72:73], v[216:217], v[216:217]
  v_pk_mul_f32 v[76:77], v[220:221], v[220:221]
  v_pk_fma_f32 v[64:65], v[64:65], v[242:243], v[240:241]
  v_pk_fma_f32 v[68:69], v[68:69], v[242:243], v[240:241]
  v_pk_fma_f32 v[72:73], v[72:73], v[242:243], v[240:241]
  v_pk_fma_f32 v[76:77], v[76:77], v[242:243], v[240:241]
  v_pk_mul_f32 v[64:65], v[64:65], v[208:209]
  v_pk_mul_f32 v[68:69], v[68:69], v[212:213]
  v_pk_mul_f32 v[72:73], v[72:73], v[216:217]
  v_pk_mul_f32 v[76:77], v[76:77], v[220:221]
  v_exp_f32 v64, v64
  v_exp_f32 v65, v65
  v_exp_f32 v68, v68
  v_exp_f32 v69, v69
  v_exp_f32 v72, v72
  v_exp_f32 v73, v73
  v_exp_f32 v76, v76
  v_exp_f32 v77, v77
  v_pk_fma_f32 v[64:65], v[64:65], v[60:61], v[60:61]
  v_pk_fma_f32 v[68:69], v[68:69], v[60:61], v[60:61]
  v_pk_fma_f32 v[72:73], v[72:73], v[60:61], v[60:61]
  v_pk_fma_f32 v[76:77], v[76:77], v[60:61], v[60:61]
  v_rcp_f32 v64, v64
  v_rcp_f32 v65, v65
  v_rcp_f32 v68, v68
  v_rcp_f32 v69, v69
  v_rcp_f32 v72, v72
  v_rcp_f32 v73, v73
  v_rcp_f32 v76, v76
  v_rcp_f32 v77, v77
  v_pk_fma_f32 v[16:17], v[64:65], v[208:209], v[16:17]
  v_pk_fma_f32 v[18:19], v[68:69], v[212:213], v[18:19]
  v_pk_fma_f32 v[20:21], v[72:73], v[216:217], v[20:21]
  v_pk_fma_f32 v[22:23], v[76:77], v[220:221], v[22:23]
  v_pk_mul_f32 v[80:81], v[210:211], v[210:211]
  v_pk_mul_f32 v[84:85], v[214:215], v[214:215]
  v_pk_mul_f32 v[88:89], v[218:219], v[218:219]
  v_pk_mul_f32 v[92:93], v[222:223], v[222:223]
  v_pk_fma_f32 v[80:81], v[80:81], v[242:243], v[240:241]
  v_pk_fma_f32 v[84:85], v[84:85], v[242:243], v[240:241]
  v_pk_fma_f32 v[88:89], v[88:89], v[242:243], v[240:241]
  v_pk_fma_f32 v[92:93], v[92:93], v[242:243], v[240:241]
  v_pk_mul_f32 v[80:81], v[80:81], v[210:211]
  v_pk_mul_f32 v[84:85], v[84:85], v[214:215]
  v_pk_mul_f32 v[88:89], v[88:89], v[218:219]
  v_pk_mul_f32 v[92:93], v[92:93], v[222:223]
  v_exp_f32 v80, v80
  v_exp_f32 v81, v81
  v_exp_f32 v84, v84
  v_exp_f32 v85, v85
  v_exp_f32 v88, v88
  v_exp_f32 v89, v89
  v_exp_f32 v92, v92
  v_exp_f32 v93, v93
  v_pk_fma_f32 v[80:81], v[80:81], v[62:63], v[62:63]
  v_pk_fma_f32 v[84:85], v[84:85], v[62:63], v[62:63]
  v_pk_fma_f32 v[88:89], v[88:89], v[62:63], v[62:63]
  v_pk_fma_f32 v[92:93], v[92:93], v[62:63], v[62:63]
  v_rcp_f32 v80, v80
  v_rcp_f32 v81, v81
  v_rcp_f32 v84, v84
  v_rcp_f32 v85, v85
  v_rcp_f32 v88, v88
  v_rcp_f32 v89, v89
  v_rcp_f32 v92, v92
  v_rcp_f32 v93, v93
  v_pk_fma_f32 v[16:17], v[80:81], v[210:211], v[16:17]
  v_pk_fma_f32 v[18:19], v[84:85], v[214:215], v[18:19]
  v_pk_fma_f32 v[20:21], v[88:89], v[218:219], v[20:21]
  v_pk_fma_f32 v[22:23], v[92:93], v[222:223], v[22:23]
  v_add_f32 v16, v16, v17
  v_add_f32 v18, v18, v19
  v_add_f32 v20, v20, v21
  v_add_f32 v22, v22, v23
  s_nop 0
  v_permlane32_swap_b32 v16, v20
  v_permlane32_swap_b32 v18, v22
  v_add_f32 v16, v16, v20
  v_add_f32 v18, v18, v22
  s_nop 1
  v_permlane16_swap_b32 v16, v18
  v_add_f32 v16, v16, v18
  v_add_f32 v16, s80, v16
L_rclr:
  s_mov_b32 s72, 0x40000
  s_branch L_pchk
L_poll:
  s_sub_u32 s72, s72, 1
  s_cbranch_scc1 L_pollx
  buffer_load_dword v128, v3, s[60:63], s68 offen offset:0 sc1
  buffer_load_dword v129, v3, s[60:63], s68 offen offset:2048 sc1
  buffer_load_dword v130, v3, s[60:63], s69 offen offset:0 sc1
  buffer_load_dword v131, v3, s[60:63], s69 offen offset:2048 sc1
  buffer_load_dword v132, v3, s[60:63], s71 offen offset:0 sc1
  buffer_load_dword v133, v3, s[60:63], s71 offen offset:2048 sc1
  buffer_load_dword v134, v5, s[60:63], s71 offen sc1
L_pchk:
  s_waitcnt vmcnt(0)
  v_max3_u32 v136, v128, v129, v130
  v_max3_u32 v137, v131, v132, v133
  v_max3_u32 v136, v136, v137, v134
  v_cmp_eq_u32 vcc, -1, v136
  s_cbranch_vccnz L_poll
L_pollx:
  v_add_f32 v128, v128, v129
  v_add_f32 v130, v130, v131
  v_add_f32 v132, v132, v133
  v_add_f32 v16, v16, v134
  v_add_f32 v128, v128, v130
  v_add_f32 v132, v132, v16
  v_add_f32 v128, v128, v132
  v_cvt_pk_bf16_f32 v128, v128, v128
  buffer_store_short v128, v4, s[56:59], s77 offen
  s_endpgm
L_end:
  s_endpgm
.section .rodata,"a"
.p2align 6
.amdhsa_kernel standalone__deep_cross_xdeepfm__recsys_kernel
  .amdhsa_next_free_vgpr 256
  .amdhsa_next_free_sgpr 102
  .amdhsa_accum_offset 256
  .amdhsa_group_segment_fixed_size 0
  .amdhsa_kernarg_size 88
  .amdhsa_user_sgpr_count 2
  .amdhsa_user_sgpr_kernarg_segment_ptr 1
  .amdhsa_system_sgpr_workgroup_id_x 1
  .amdhsa_float_denorm_mode_32 3
.end_amdhsa_kernel
```

```asm
; @launch grid=(256,1,1) block=(512,1,1) lds=163840
.amdgcn_target "amdgcn-amd-amdhsa--gfx950"
.text
.globl standalone__deep_cross_xdeepfm__recsys_kernel
.p2align 8
.type standalone__deep_cross_xdeepfm__recsys_kernel,@function
standalone__deep_cross_xdeepfm__recsys_kernel:
  s_cmp_ge_u32 s2, 256
  s_cbranch_scc1 L_end
  s_load_dwordx16 s[4:19], s[0:1], 0
  s_load_dwordx4 s[20:23], s[0:1], 64
  s_load_dwordx2 s[24:25], s[0:1], 80
  v_lshrrev_b32 v1, 6, v0
  s_getpc_b64 s[92:93]
L_pc:
  s_and_b32 s68, s2, 0xf8
  v_add_u32 v2, s68, v1
  v_lshlrev_b32 v2, 7, v2
  v_and_b32 v3, 1, v0
  v_lshl_add_u32 v2, v3, 15, v2
  v_min_u32 v2, L_end-L_pc, v2
  v_mov_b32 v3, s93
  v_add_co_u32 v2, vcc, s92, v2
  s_nop 1
  v_addc_co_u32 v3, vcc, 0, v3, vcc
  global_load_dword v255, v[2:3], off
  v_and_b32 v0, 63, v0
  v_readfirstlane_b32 s3, v1
  s_and_b32 s68, s2, 7
  s_lshl_b32 s68, s68, 2
  s_lshr_b32 s26, s2, 6
  s_add_u32 s26, s26, s68
  s_bfe_u32 s27, s2, 0x30003
  s_and_b32 s80, s2, 0xf8
  s_add_u32 s80, s80, s3
  s_lshl_b32 s80, s80, 21
  s_lshr_b32 s68, s2, 3
  s_cmp_eq_u32 s68, 5
  s_cbranch_scc1 L_rem
  s_cmp_ge_u32 s27, 5
  s_cbranch_scc1 L_cin
  s_mul_i32 s77, s27, 640
  s_mul_i32 s70, s3, 7
  v_min_u32 v64, 6, v0
  v_add_u32 v64, s70, v64
  v_min_u32 v64, 51, v64
  v_lshrrev_b32 v62, 1, v64
  v_mul_u32_u24 v62, 96, v62
  v_lshl_add_u32 v64, v64, 2, v62
  s_mul_i32 s78, s27, 26
  s_min_u32 s78, s78, 102
  s_lshl_b32 s71, s26, 7
  s_add_u32 s78, s78, s71
  s_mul_i32 s78, s78, 104
  s_and_b32 s70, s26, 3
  s_lshl_b32 s70, s70, 3
  s_add_u32 s70, s70, s3
  s_mul_i32 s70, s70, 3328
  s_add_u32 s81, s70, s77
  v_min_u32 v56, 15, v0
  v_lshrrev_b32 v62, 3, v56
  s_mov_b32 s70, 106496
  v_mul_u32_u24 v62, s70, v62
  v_and_b32 v56, 7, v56
  v_min_u32 v56, 4, v56
  v_lshl_add_u32 v56, v56, 7, v62
  s_xor_b32 s70, s3, 4
  s_lshl_b32 s70, s70, 4
  s_add_u32 s70, s70, s71
  v_lshrrev_b32 v60, 3, v0
  v_add_u32 v60, s70, v60
  v_mul_u32_u24 v13, 104, v60
  s_waitcnt lgkmcnt(0)
  s_mov_b32 s28, s4
  s_and_b32 s29, s5, 0xffff
  s_mov_b32 s30, 425984
  s_mov_b32 s31, 0x20000
  buffer_load_dwordx3 v[52:54], v64, s[28:31], s78 offen
  buffer_load_dwordx2 v[44:45], v13, s[28:31], 0 offen offset:0
  buffer_load_dwordx2 v[48:49], v13, s[28:31], 0 offen offset:832
  s_mov_b32 s32, s6
  s_and_b32 s33, s7, 0xffff
  s_mov_b32 s34, 12800000
  s_mov_b32 s35, 0x20000
  v_mov_b32 v68, s80
  buffer_load_dword v255, v68, s[32:35], 0 offen
  v_lshlrev_b32 v37, 4, v0
  s_mov_b32 s48, s14
  s_and_b32 s49, s15, 0xffff
  s_mov_b32 s50, 3328
  s_mov_b32 s51, 0x20000
  s_mov_b32 s44, s12
  s_and_b32 s45, s13, 0xffff
  s_mov_b32 s46, 5537792
  s_mov_b32 s47, 0x20000
  buffer_load_dword v255, v56, s[44:47], s81 offen
  v_mov_b32 v57, v56
  s_add_u32 s85, s81, 212992
  s_mov_b32 m0, 155648
  s_mov_b32 exec_hi, 0xff
  buffer_load_dwordx4 v37, s[48:51], s77 offen lds
  s_mov_b64 exec, -1
  s_mul_i32 s81, s26, 5
  s_add_u32 s81, s81, s27
  s_lshl_b32 s81, s81, 3
  s_add_u32 s81, s81, s3
  s_add_u32 s81, s81, 1664
  s_lshl_b32 s81, s81, 7
  v_min_u32 v56, 2, v0
  v_mul_u32_u24 v56, 163840, v56
  buffer_load_dword v255, v56, s[44:47], s81 offen
  s_lshr_b32 s68, s3, 2
  s_and_b32 s69, s3, 3
  s_mov_b32 s70, 1639
  s_and_b32 s78, s69, 1
  s_lshl_b32 s78, s78, 2
  s_mov_b32 s81, 3328
  v_mov_b32 v60, v0
  v_mul_u32_u24 v61, s70, v60
  v_lshrrev_b32 v61, 16, v61
  v_mul_u32_u24 v64, 40, v61
  v_sub_u32 v64, v60, v64
  v_and_b32 v63, 2, v61
  v_or_b32 v63, s78, v63
  v_xor_b32 v64, v64, v63
  v_mul_u32_u24 v61, s81, v61
  v_lshl_add_u32 v29, v64, 4, v61
  v_add_u32 v60, 64, v60
  v_mul_u32_u24 v61, s70, v60
  v_lshrrev_b32 v61, 16, v61
  v_mul_u32_u24 v64, 40, v61
  v_sub_u32 v64, v60, v64
  v_and_b32 v63, 2, v61
  v_or_b32 v63, s78, v63
  v_xor_b32 v64, v64, v63
  v_mul_u32_u24 v61, s81, v61
  v_lshl_add_u32 v30, v64, 4, v61
  v_subrev_u32 v30, 1024, v30
  v_add_u32 v60, 64, v60
  v_mul_u32_u24 v61, s70, v60
  v_lshrrev_b32 v61, 16, v61
  v_mul_u32_u24 v64, 40, v61
  v_sub_u32 v64, v60, v64
  v_and_b32 v63, 2, v61
  v_or_b32 v63, s78, v63
  v_xor_b32 v64, v64, v63
  v_mul_u32_u24 v61, s81, v61
  v_lshl_add_u32 v31, v64, 4, v61
  v_subrev_u32 v31, 2048, v31
  v_add_u32 v60, 64, v60
  v_mul_u32_u24 v61, s70, v60
  v_lshrrev_b32 v61, 16, v61
  v_mul_u32_u24 v64, 40, v61
  v_sub_u32 v64, v60, v64
  v_and_b32 v63, 2, v61
  v_or_b32 v63, s78, v63
  v_xor_b32 v64, v64, v63
  v_mul_u32_u24 v61, s81, v61
  v_lshl_add_u32 v32, v64, 4, v61
  v_subrev_u32 v32, 3072, v32
  v_add_u32 v60, 64, v60
  v_mul_u32_u24 v61, s70, v60
  v_lshrrev_b32 v61, 16, v61
  v_mul_u32_u24 v64, 40, v61
  v_sub_u32 v64, v60, v64
  v_and_b32 v63, 2, v61
  v_or_b32 v63, s78, v63
  v_xor_b32 v64, v64, v63
  v_mul_u32_u24 v61, s81, v61
  v_lshl_add_u32 v33, v64, 4, v61
  s_mul_i32 s70, s3, 26624
  s_add_u32 s74, s70, s77
  s_mul_i32 s75, s3, 5120
  s_add_u32 s75, s75, 32768
  s_lshl_b32 s71, s68, 14
  s_lshl_b32 s76, s69, 11
  s_add_u32 s76, s76, s71
  s_xor_b32 s76, s76, 16384
  v_and_b32 v64, 7, v0
  v_lshrrev_b32 v62, 4, v0
  v_xor_b32 v64, v64, v62
  v_lshlrev_b32 v14, 4, v64
  v_xor_b32 v15, 64, v14
  v_and_b32 v64, 15, v0
  v_lshlrev_b32 v64, 7, v64
  s_lshl_b32 s71, s68, 14
  v_bfe_u32 v63, v0, 1, 3
  v_xor_b32 v63, v63, v62
  v_lshl_add_u32 v64, v63, 4, v64
  v_add_u32 v11, s71, v64
  v_xor_b32 v12, 64, v11
  s_mov_b32 s52, s16
  s_and_b32 s53, s17, 0xffff
  s_mov_b32 s54, 3328
  s_mov_b32 s55, 0x20000
  s_mul_i32 s71, s69, 5
  v_bfe_u32 v63, v0, 2, 2
  v_lshl_add_u32 v64, v62, 3, v63
  v_mul_u32_u24 v64, 640, v64
  v_and_b32 v63, 3, v0
  v_lshl_add_u32 v64, v63, 3, v64
  v_add_u32 v64, 32768, v64
  v_bfe_u32 v63, v0, 3, 2
  v_xor_b32 v60, s71, v63
  v_lshl_add_u32 v1, v60, 5, v64
  v_add_u32 v6, 61440, v1
  s_add_u32 s71, s71, 1
  v_xor_b32 v60, s71, v63
  v_lshl_add_u32 v2, v60, 5, v64
  v_add_u32 v7, 61440, v2
  s_add_u32 s71, s71, 1
  v_xor_b32 v60, s71, v63
  v_lshl_add_u32 v3, v60, 5, v64
  v_add_u32 v8, 61440, v3
  s_add_u32 s71, s71, 1
  v_xor_b32 v60, s71, v63
  v_lshl_add_u32 v4, v60, 5, v64
  v_add_u32 v9, 61440, v4
  s_add_u32 s71, s71, 1
  v_xor_b32 v60, s71, v63
  v_lshl_add_u32 v5, v60, 5, v64
  v_add_u32 v10, 61440, v5
  s_add_u32 s71, s71, 1
  s_mul_i32 s71, s69, 160
  s_add_u32 s71, s71, 155648
  v_lshlrev_b32 v64, 3, v62
  v_add_u32 v35, s71, v64
  s_lshl_b32 s70, s69, 1
  s_add_u32 s70, s70, s68
  s_lshl_b32 s70, s70, 8
  s_add_u32 s70, s70, 156928
  v_lshlrev_b32 v36, 2, v0
  v_add_u32 v36, s70, v36
  s_add_u32 m0, s75, 0
  s_nop 0
  buffer_load_dwordx4 v29, s[44:47], s74 offen offset:0 lds
  buffer_load_dwordx4 v30, s[44:47], s74 offen offset:1024 lds
  buffer_load_dwordx4 v31, s[44:47], s74 offen offset:2048 lds
  buffer_load_dwordx4 v32, s[44:47], s74 offen offset:3072 lds
  s_add_u32 m0, m0, 4096
  s_nop 0
  buffer_load_dwordx4 v33, s[44:47], s74 offen offset:0 lds
  s_add_u32 s74, s74, 212992
  buffer_load_dword v255, v57, s[44:47], s85 offen
  s_add_u32 s85, s85, 212992
  s_waitcnt vmcnt(12)
  v_lshlrev_b32 v52, 7, v52
  s_barrier
  buffer_load_dword v255, v52, s[32:35], 0 offen
  s_waitcnt vmcnt(11)
  v_lshl_add_u32 v34, v48, 7, v15
  v_lshl_add_u32 v28, v44, 7, v14
  s_add_u32 m0, s76, 0
  s_nop 0
  buffer_load_dwordx4 v28, s[32:35], 0 offen lds
  s_add_u32 m0, m0, 1024
  s_nop 0
  buffer_load_dwordx4 v34, s[32:35], 0 offen lds
  v_lshlrev_b32 v54, 7, v54
  buffer_load_dword v255, v54, s[32:35], 0 offen
  s_barrier
  s_waitcnt vmcnt(11)
  ds_read_b64 v[220:221], v35 offset:0
  ds_read_b64 v[222:223], v35 offset:32
  ds_read_b64 v[224:225], v35 offset:64
  ds_read_b64 v[226:227], v35 offset:96
  ds_read_b64 v[228:229], v35 offset:128
  s_waitcnt lgkmcnt(4)
  v_lshlrev_b32 v140, 16, v220
  v_and_b32 v141, 0xffff0000, v220
  v_lshlrev_b32 v142, 16, v221
  v_and_b32 v143, 0xffff0000, v221
  s_waitcnt lgkmcnt(3)
  v_lshlrev_b32 v156, 16, v222
  v_and_b32 v157, 0xffff0000, v222
  v_lshlrev_b32 v158, 16, v223
  v_and_b32 v159, 0xffff0000, v223
  s_waitcnt lgkmcnt(2)
  v_lshlrev_b32 v172, 16, v224
  v_and_b32 v173, 0xffff0000, v224
  v_lshlrev_b32 v174, 16, v225
  v_and_b32 v175, 0xffff0000, v225
  s_waitcnt lgkmcnt(1)
  v_lshlrev_b32 v188, 16, v226
  v_and_b32 v189, 0xffff0000, v226
  v_lshlrev_b32 v190, 16, v227
  v_and_b32 v191, 0xffff0000, v227
  s_waitcnt lgkmcnt(0)
  v_lshlrev_b32 v204, 16, v228
  v_and_b32 v205, 0xffff0000, v228
  v_lshlrev_b32 v206, 16, v229
  v_and_b32 v207, 0xffff0000, v229
  v_mov_b64 v[144:145], v[140:141]
  v_mov_b64 v[146:147], v[142:143]
  v_mov_b64 v[148:149], v[140:141]
  v_mov_b64 v[150:151], v[142:143]
  v_mov_b64 v[152:153], v[140:141]
  v_mov_b64 v[154:155], v[142:143]
  v_mov_b64 v[160:161], v[156:157]
  v_mov_b64 v[162:163], v[158:159]
  v_mov_b64 v[164:165], v[156:157]
  v_mov_b64 v[166:167], v[158:159]
  v_mov_b64 v[168:169], v[156:157]
  v_mov_b64 v[170:171], v[158:159]
  v_mov_b64 v[176:177], v[172:173]
  v_mov_b64 v[178:179], v[174:175]
  v_mov_b64 v[180:181], v[172:173]
  v_mov_b64 v[182:183], v[174:175]
  v_mov_b64 v[184:185], v[172:173]
  v_mov_b64 v[186:187], v[174:175]
  v_mov_b64 v[192:193], v[188:189]
  v_mov_b64 v[194:195], v[190:191]
  v_mov_b64 v[196:197], v[188:189]
  v_mov_b64 v[198:199], v[190:191]
  v_mov_b64 v[200:201], v[188:189]
  v_mov_b64 v[202:203], v[190:191]
  v_mov_b64 v[208:209], v[204:205]
  v_mov_b64 v[210:211], v[206:207]
  v_mov_b64 v[212:213], v[204:205]
  v_mov_b64 v[214:215], v[206:207]
  v_mov_b64 v[216:217], v[204:205]
  v_mov_b64 v[218:219], v[206:207]
  s_lshl_b32 s73, s68, 2
  s_add_u32 s73, s73, 4
  buffer_load_dwordx3 v[16:18], v13, s[28:31], s73 offen offset:0
  buffer_load_dwordx3 v[20:22], v13, s[28:31], s73 offen offset:832
  s_add_u32 s73, s73, 12
  s_mov_b32 s72, 0
  s_cmp_lg_u32 s68, 0
  s_cbranch_scc1 L_dnn_h1
L_dnn_h0:
  s_add_u32 m0, s75, 40960
  s_nop 0
  buffer_load_dwordx4 v29, s[44:47], s74 offen offset:0 lds
  buffer_load_dwordx4 v30, s[44:47], s74 offen offset:1024 lds
  buffer_load_dwordx4 v31, s[44:47], s74 offen offset:2048 lds
  buffer_load_dwordx4 v32, s[44:47], s74 offen offset:3072 lds
  s_add_u32 m0, m0, 4096
  s_nop 0
  buffer_load_dwordx4 v33, s[44:47], s74 offen offset:0 lds
  s_add_u32 s74, s74, 212992
  s_waitcnt vmcnt(12) lgkmcnt(0)
  s_barrier
  buffer_load_dwordx3 v[24:26], v13, s[28:31], s73 offen offset:0
  buffer_load_dwordx3 v[240:242], v13, s[28:31], s73 offen offset:832
  s_add_u32 s73, s73, 12
L_dnn_loop0:
  ds_read_b64_tr_b16 v[40:41], v1 offset:0
  s_add_u32 m0, s75, 81920
  s_nop 0
  buffer_load_dwordx4 v29, s[44:47], s74 offen offset:0 lds
  ds_read_b64_tr_b16 v[42:43], v1 offset:2560
  ds_read_b64_tr_b16 v[44:45], v1 offset:20480
  ds_read_b64_tr_b16 v[46:47], v1 offset:23040
  ds_read_b64_tr_b16 v[48:49], v2 offset:0
  buffer_load_dwordx4 v30, s[44:47], s74 offen offset:1024 lds
  ds_read_b64_tr_b16 v[50:51], v2 offset:2560
  ds_read_b64_tr_b16 v[52:53], v2 offset:20480
  ds_read_b64_tr_b16 v[54:55], v2 offset:23040
  ds_read_b64_tr_b16 v[56:57], v3 offset:0
  buffer_load_dwordx4 v31, s[44:47], s74 offen offset:2048 lds
  ds_read_b64_tr_b16 v[58:59], v3 offset:2560
  ds_read_b64_tr_b16 v[60:61], v3 offset:20480
  ds_read_b64_tr_b16 v[62:63], v3 offset:23040
  ds_read_b64_tr_b16 v[64:65], v4 offset:0
  buffer_load_dwordx4 v32, s[44:47], s74 offen offset:3072 lds
  ds_read_b64_tr_b16 v[66:67], v4 offset:2560
  ds_read_b64_tr_b16 v[68:69], v4 offset:20480
  ds_read_b64_tr_b16 v[70:71], v4 offset:23040
  ds_read_b128 v[80:83], v11 offset:0
  s_add_u32 m0, m0, 4096
  s_nop 0
  buffer_load_dwordx4 v33, s[44:47], s74 offen offset:0 lds
  s_add_u32 s74, s74, 212992
  ds_read_b128 v[84:87], v12 offset:0
  ds_read_b128 v[88:91], v11 offset:2048
  ds_read_b128 v[92:95], v12 offset:2048
  ds_read_b128 v[96:99], v11 offset:4096
  s_waitcnt vmcnt(12)
  v_lshl_add_u32 v34, v20, 7, v15
  v_lshl_add_u32 v28, v16, 7, v14
  s_add_u32 m0, s76, 8192
  s_nop 0
  buffer_load_dwordx4 v28, s[32:35], 0 offen lds
  ds_read_b128 v[100:103], v12 offset:4096
  ds_read_b128 v[104:107], v11 offset:6144
  ds_read_b128 v[108:111], v12 offset:6144
  ds_read_b64_tr_b16 v[72:73], v5 offset:0
  s_add_u32 m0, m0, 1024
  s_nop 0
  buffer_load_dwordx4 v34, s[32:35], 0 offen lds
  ds_read_b64_tr_b16 v[74:75], v5 offset:2560
  ds_read_b64_tr_b16 v[76:77], v5 offset:20480
  ds_read_b64_tr_b16 v[78:79], v5 offset:23040
L_dnn_in0:
  s_waitcnt vmcnt(9) lgkmcnt(0)
  s_barrier
  s_setprio 0
  v_mfma_f32_16x16x32_bf16 v[140:143], v[40:43], v[80:83], v[140:143]
  v_mfma_f32_16x16x32_bf16 v[140:143], v[44:47], v[84:87], v[140:143]
  v_mfma_f32_16x16x32_bf16 v[144:147], v[40:43], v[88:91], v[144:147]
  v_mfma_f32_16x16x32_bf16 v[144:147], v[44:47], v[92:95], v[144:147]
  v_mfma_f32_16x16x32_bf16 v[148:151], v[40:43], v[96:99], v[148:151]
  v_mfma_f32_16x16x32_bf16 v[148:151], v[44:47], v[100:103], v[148:151]
  v_mfma_f32_16x16x32_bf16 v[152:155], v[40:43], v[104:107], v[152:155]
  v_mfma_f32_16x16x32_bf16 v[152:155], v[44:47], v[108:111], v[152:155]
  v_mfma_f32_16x16x32_bf16 v[168:171], v[48:51], v[104:107], v[168:171]
  v_mfma_f32_16x16x32_bf16 v[168:171], v[52:55], v[108:111], v[168:171]
  v_mfma_f32_16x16x32_bf16 v[164:167], v[48:51], v[96:99], v[164:167]
  v_mfma_f32_16x16x32_bf16 v[164:167], v[52:55], v[100:103], v[164:167]
  v_mfma_f32_16x16x32_bf16 v[160:163], v[48:51], v[88:91], v[160:163]
  v_mfma_f32_16x16x32_bf16 v[160:163], v[52:55], v[92:95], v[160:163]
  v_mfma_f32_16x16x32_bf16 v[156:159], v[48:51], v[80:83], v[156:159]
  v_mfma_f32_16x16x32_bf16 v[156:159], v[52:55], v[84:87], v[156:159]
  v_mfma_f32_16x16x32_bf16 v[172:175], v[56:59], v[80:83], v[172:175]
  v_mfma_f32_16x16x32_bf16 v[172:175], v[60:63], v[84:87], v[172:175]
  v_mfma_f32_16x16x32_bf16 v[176:179], v[56:59], v[88:91], v[176:179]
  v_mfma_f32_16x16x32_bf16 v[176:179], v[60:63], v[92:95], v[176:179]
  v_mfma_f32_16x16x32_bf16 v[180:183], v[56:59], v[96:99], v[180:183]
  v_mfma_f32_16x16x32_bf16 v[180:183], v[60:63], v[100:103], v[180:183]
  v_mfma_f32_16x16x32_bf16 v[184:187], v[56:59], v[104:107], v[184:187]
  v_mfma_f32_16x16x32_bf16 v[184:187], v[60:63], v[108:111], v[184:187]
  v_mfma_f32_16x16x32_bf16 v[200:203], v[64:67], v[104:107], v[200:203]
  v_mfma_f32_16x16x32_bf16 v[200:203], v[68:71], v[108:111], v[200:203]
  v_mfma_f32_16x16x32_bf16 v[196:199], v[64:67], v[96:99], v[196:199]
  v_mfma_f32_16x16x32_bf16 v[196:199], v[68:71], v[100:103], v[196:199]
  v_mfma_f32_16x16x32_bf16 v[192:195], v[64:67], v[88:91], v[192:195]
  v_mfma_f32_16x16x32_bf16 v[192:195], v[68:71], v[92:95], v[192:195]
  v_mfma_f32_16x16x32_bf16 v[188:191], v[64:67], v[80:83], v[188:191]
  v_mfma_f32_16x16x32_bf16 v[188:191], v[68:71], v[84:87], v[188:191]
  v_mfma_f32_16x16x32_bf16 v[204:207], v[72:75], v[80:83], v[204:207]
  v_mfma_f32_16x16x32_bf16 v[204:207], v[76:79], v[84:87], v[204:207]
  v_mfma_f32_16x16x32_bf16 v[208:211], v[72:75], v[88:91], v[208:211]
  v_mfma_f32_16x16x32_bf16 v[208:211], v[76:79], v[92:95], v[208:211]
  v_mfma_f32_16x16x32_bf16 v[212:215], v[72:75], v[96:99], v[212:215]
  v_mfma_f32_16x16x32_bf16 v[212:215], v[76:79], v[100:103], v[212:215]
  v_mfma_f32_16x16x32_bf16 v[216:219], v[72:75], v[104:107], v[216:219]
  s_setprio 2
  s_waitcnt vmcnt(9)
  s_barrier
  v_mfma_f32_16x16x32_bf16 v[216:219], v[76:79], v[108:111], v[216:219]
  ds_read_b64_tr_b16 v[40:41], v1 offset:40960
  s_add_u32 m0, s75, 0
  s_nop 0
  buffer_load_dwordx4 v29, s[44:47], s74 offen offset:0 lds
  ds_read_b64_tr_b16 v[42:43], v1 offset:43520
  ds_read_b64_tr_b16 v[44:45], v6 offset:0
  ds_read_b64_tr_b16 v[46:47], v6 offset:2560
  ds_read_b64_tr_b16 v[48:49], v2 offset:40960
  buffer_load_dwordx4 v30, s[44:47], s74 offen offset:1024 lds
  ds_read_b64_tr_b16 v[50:51], v2 offset:43520
  ds_read_b64_tr_b16 v[52:53], v7 offset:0
  ds_read_b64_tr_b16 v[54:55], v7 offset:2560
  ds_read_b64_tr_b16 v[56:57], v3 offset:40960
  buffer_load_dwordx4 v31, s[44:47], s74 offen offset:2048 lds
  ds_read_b64_tr_b16 v[58:59], v3 offset:43520
  ds_read_b64_tr_b16 v[60:61], v8 offset:0
  ds_read_b64_tr_b16 v[62:63], v8 offset:2560
  ds_read_b64_tr_b16 v[64:65], v4 offset:40960
  buffer_load_dwordx4 v32, s[44:47], s74 offen offset:3072 lds
  ds_read_b64_tr_b16 v[66:67], v4 offset:43520
  ds_read_b64_tr_b16 v[68:69], v9 offset:0
  ds_read_b64_tr_b16 v[70:71], v9 offset:2560
  ds_read_b128 v[80:83], v11 offset:8192
  s_add_u32 m0, m0, 4096
  s_nop 0
  buffer_load_dwordx4 v33, s[44:47], s74 offen offset:0 lds
  s_add_u32 s74, s74, 212992
  ds_read_b128 v[84:87], v12 offset:8192
  ds_read_b128 v[88:91], v11 offset:10240
  ds_read_b128 v[92:95], v12 offset:10240
  ds_read_b128 v[96:99], v11 offset:12288
  v_lshl_add_u32 v34, v21, 7, v15
  v_lshl_add_u32 v28, v17, 7, v14
  s_add_u32 m0, s76, 0
  s_nop 0
  buffer_load_dwordx4 v28, s[32:35], 0 offen lds
  ds_read_b128 v[100:103], v12 offset:12288
  ds_read_b128 v[104:107], v11 offset:14336
  ds_read_b128 v[108:111], v12 offset:14336
  ds_read_b64_tr_b16 v[72:73], v5 offset:40960
  s_add_u32 m0, m0, 1024
  s_nop 0
  buffer_load_dwordx4 v34, s[32:35], 0 offen lds
  ds_read_b64_tr_b16 v[74:75], v5 offset:43520
  ds_read_b64_tr_b16 v[76:77], v10 offset:0
  ds_read_b64_tr_b16 v[78:79], v10 offset:2560
  s_waitcnt vmcnt(7) lgkmcnt(0)
  s_barrier
  s_setprio 0
  v_mfma_f32_16x16x32_bf16 v[140:143], v[40:43], v[80:83], v[140:143]
  v_mfma_f32_16x16x32_bf16 v[140:143], v[44:47], v[84:87], v[140:143]
  v_mfma_f32_16x16x32_bf16 v[144:147], v[40:43], v[88:91], v[144:147]
  v_mfma_f32_16x16x32_bf16 v[144:147], v[44:47], v[92:95], v[144:147]
  v_mfma_f32_16x16x32_bf16 v[148:151], v[40:43], v[96:99], v[148:151]
  v_mfma_f32_16x16x32_bf16 v[148:151], v[44:47], v[100:103], v[148:151]
  v_mfma_f32_16x16x32_bf16 v[152:155], v[40:43], v[104:107], v[152:155]
  v_mfma_f32_16x16x32_bf16 v[152:155], v[44:47], v[108:111], v[152:155]
  v_mfma_f32_16x16x32_bf16 v[168:171], v[48:51], v[104:107], v[168:171]
  v_mfma_f32_16x16x32_bf16 v[168:171], v[52:55], v[108:111], v[168:171]
  v_mfma_f32_16x16x32_bf16 v[164:167], v[48:51], v[96:99], v[164:167]
  v_mfma_f32_16x16x32_bf16 v[164:167], v[52:55], v[100:103], v[164:167]
  v_mfma_f32_16x16x32_bf16 v[160:163], v[48:51], v[88:91], v[160:163]
  v_mfma_f32_16x16x32_bf16 v[160:163], v[52:55], v[92:95], v[160:163]
  v_mfma_f32_16x16x32_bf16 v[156:159], v[48:51], v[80:83], v[156:159]
  v_mfma_f32_16x16x32_bf16 v[156:159], v[52:55], v[84:87], v[156:159]
  v_mfma_f32_16x16x32_bf16 v[172:175], v[56:59], v[80:83], v[172:175]
  v_mfma_f32_16x16x32_bf16 v[172:175], v[60:63], v[84:87], v[172:175]
  v_mfma_f32_16x16x32_bf16 v[176:179], v[56:59], v[88:91], v[176:179]
  v_mfma_f32_16x16x32_bf16 v[176:179], v[60:63], v[92:95], v[176:179]
  v_mfma_f32_16x16x32_bf16 v[180:183], v[56:59], v[96:99], v[180:183]
  v_mfma_f32_16x16x32_bf16 v[180:183], v[60:63], v[100:103], v[180:183]
  v_mfma_f32_16x16x32_bf16 v[184:187], v[56:59], v[104:107], v[184:187]
  v_mfma_f32_16x16x32_bf16 v[184:187], v[60:63], v[108:111], v[184:187]
  v_mfma_f32_16x16x32_bf16 v[200:203], v[64:67], v[104:107], v[200:203]
  v_mfma_f32_16x16x32_bf16 v[200:203], v[68:71], v[108:111], v[200:203]
  v_mfma_f32_16x16x32_bf16 v[196:199], v[64:67], v[96:99], v[196:199]
  v_mfma_f32_16x16x32_bf16 v[196:199], v[68:71], v[100:103], v[196:199]
  v_mfma_f32_16x16x32_bf16 v[192:195], v[64:67], v[88:91], v[192:195]
  v_mfma_f32_16x16x32_bf16 v[192:195], v[68:71], v[92:95], v[192:195]
  v_mfma_f32_16x16x32_bf16 v[188:191], v[64:67], v[80:83], v[188:191]
  v_mfma_f32_16x16x32_bf16 v[188:191], v[68:71], v[84:87], v[188:191]
  v_mfma_f32_16x16x32_bf16 v[204:207], v[72:75], v[80:83], v[204:207]
  v_mfma_f32_16x16x32_bf16 v[204:207], v[76:79], v[84:87], v[204:207]
  v_mfma_f32_16x16x32_bf16 v[208:211], v[72:75], v[88:91], v[208:211]
  v_mfma_f32_16x16x32_bf16 v[208:211], v[76:79], v[92:95], v[208:211]
  v_mfma_f32_16x16x32_bf16 v[212:215], v[72:75], v[96:99], v[212:215]
  v_mfma_f32_16x16x32_bf16 v[212:215], v[76:79], v[100:103], v[212:215]
  v_mfma_f32_16x16x32_bf16 v[216:219], v[72:75], v[104:107], v[216:219]
  s_setprio 2
  s_barrier
  v_mfma_f32_16x16x32_bf16 v[216:219], v[76:79], v[108:111], v[216:219]
  ds_read_b64_tr_b16 v[40:41], v6 offset:20480
  s_add_u32 m0, s75, 40960
  s_nop 0
  buffer_load_dwordx4 v29, s[44:47], s74 offen offset:0 lds
  ds_read_b64_tr_b16 v[42:43], v6 offset:23040
  ds_read_b64_tr_b16 v[44:45], v6 offset:40960
  ds_read_b64_tr_b16 v[46:47], v6 offset:43520
  ds_read_b64_tr_b16 v[48:49], v7 offset:20480
  buffer_load_dwordx4 v30, s[44:47], s74 offen offset:1024 lds
  ds_read_b64_tr_b16 v[50:51], v7 offset:23040
  ds_read_b64_tr_b16 v[52:53], v7 offset:40960
  ds_read_b64_tr_b16 v[54:55], v7 offset:43520
  ds_read_b64_tr_b16 v[56:57], v8 offset:20480
  buffer_load_dwordx4 v31, s[44:47], s74 offen offset:2048 lds
  ds_read_b64_tr_b16 v[58:59], v8 offset:23040
  ds_read_b64_tr_b16 v[60:61], v8 offset:40960
  ds_read_b64_tr_b16 v[62:63], v8 offset:43520
  ds_read_b64_tr_b16 v[64:65], v9 offset:20480
  buffer_load_dwordx4 v32, s[44:47], s74 offen offset:3072 lds
  ds_read_b64_tr_b16 v[66:67], v9 offset:23040
  ds_read_b64_tr_b16 v[68:69], v9 offset:40960
  ds_read_b64_tr_b16 v[70:71], v9 offset:43520
  ds_read_b128 v[80:83], v11 offset:0
  s_add_u32 m0, m0, 4096
  s_nop 0
  buffer_load_dwordx4 v33, s[44:47], s74 offen offset:0 lds
  s_add_u32 s74, s74, 212992
  ds_read_b128 v[84:87], v12 offset:0
  ds_read_b128 v[88:91], v11 offset:2048
  ds_read_b128 v[92:95], v12 offset:2048
  ds_read_b128 v[96:99], v11 offset:4096
  v_lshl_add_u32 v34, v22, 7, v15
  v_lshl_add_u32 v28, v18, 7, v14
  s_add_u32 m0, s76, 8192
  s_nop 0
  buffer_load_dwordx4 v28, s[32:35], 0 offen lds
  ds_read_b128 v[100:103], v12 offset:4096
  ds_read_b128 v[104:107], v11 offset:6144
  ds_read_b128 v[108:111], v12 offset:6144
  ds_read_b64_tr_b16 v[72:73], v10 offset:20480
  s_add_u32 m0, m0, 1024
  s_nop 0
  buffer_load_dwordx4 v34, s[32:35], 0 offen lds
  ds_read_b64_tr_b16 v[74:75], v10 offset:23040
  ds_read_b64_tr_b16 v[76:77], v10 offset:40960
  ds_read_b64_tr_b16 v[78:79], v10 offset:43520
  buffer_load_dwordx3 v[16:18], v13, s[28:31], s73 offen offset:0
  buffer_load_dwordx3 v[20:22], v13, s[28:31], s73 offen offset:832
  s_add_u32 s73, s73, 12
  s_waitcnt vmcnt(9) lgkmcnt(0)
  s_barrier
  s_setprio 0
  v_mfma_f32_16x16x32_bf16 v[140:143], v[40:43], v[80:83], v[140:143]
  v_mfma_f32_16x16x32_bf16 v[140:143], v[44:47], v[84:87], v[140:143]
  v_mfma_f32_16x16x32_bf16 v[144:147], v[40:43], v[88:91], v[144:147]
  v_mfma_f32_16x16x32_bf16 v[144:147], v[44:47], v[92:95], v[144:147]
  v_mfma_f32_16x16x32_bf16 v[148:151], v[40:43], v[96:99], v[148:151]
  v_mfma_f32_16x16x32_bf16 v[148:151], v[44:47], v[100:103], v[148:151]
  v_mfma_f32_16x16x32_bf16 v[152:155], v[40:43], v[104:107], v[152:155]
  v_mfma_f32_16x16x32_bf16 v[152:155], v[44:47], v[108:111], v[152:155]
  v_mfma_f32_16x16x32_bf16 v[168:171], v[48:51], v[104:107], v[168:171]
  v_mfma_f32_16x16x32_bf16 v[168:171], v[52:55], v[108:111], v[168:171]
  v_mfma_f32_16x16x32_bf16 v[164:167], v[48:51], v[96:99], v[164:167]
  v_mfma_f32_16x16x32_bf16 v[164:167], v[52:55], v[100:103], v[164:167]
  v_mfma_f32_16x16x32_bf16 v[160:163], v[48:51], v[88:91], v[160:163]
  v_mfma_f32_16x16x32_bf16 v[160:163], v[52:55], v[92:95], v[160:163]
  v_mfma_f32_16x16x32_bf16 v[156:159], v[48:51], v[80:83], v[156:159]
  v_mfma_f32_16x16x32_bf16 v[156:159], v[52:55], v[84:87], v[156:159]
  v_mfma_f32_16x16x32_bf16 v[172:175], v[56:59], v[80:83], v[172:175]
  v_mfma_f32_16x16x32_bf16 v[172:175], v[60:63], v[84:87], v[172:175]
  v_mfma_f32_16x16x32_bf16 v[176:179], v[56:59], v[88:91], v[176:179]
  v_mfma_f32_16x16x32_bf16 v[176:179], v[60:63], v[92:95], v[176:179]
  v_mfma_f32_16x16x32_bf16 v[180:183], v[56:59], v[96:99], v[180:183]
  v_mfma_f32_16x16x32_bf16 v[180:183], v[60:63], v[100:103], v[180:183]
  v_mfma_f32_16x16x32_bf16 v[184:187], v[56:59], v[104:107], v[184:187]
  v_mfma_f32_16x16x32_bf16 v[184:187], v[60:63], v[108:111], v[184:187]
  v_mfma_f32_16x16x32_bf16 v[200:203], v[64:67], v[104:107], v[200:203]
  v_mfma_f32_16x16x32_bf16 v[200:203], v[68:71], v[108:111], v[200:203]
  v_mfma_f32_16x16x32_bf16 v[196:199], v[64:67], v[96:99], v[196:199]
  v_mfma_f32_16x16x32_bf16 v[196:199], v[68:71], v[100:103], v[196:199]
  v_mfma_f32_16x16x32_bf16 v[192:195], v[64:67], v[88:91], v[192:195]
  v_mfma_f32_16x16x32_bf16 v[192:195], v[68:71], v[92:95], v[192:195]
  v_mfma_f32_16x16x32_bf16 v[188:191], v[64:67], v[80:83], v[188:191]
  v_mfma_f32_16x16x32_bf16 v[188:191], v[68:71], v[84:87], v[188:191]
  v_mfma_f32_16x16x32_bf16 v[204:207], v[72:75], v[80:83], v[204:207]
  v_mfma_f32_16x16x32_bf16 v[204:207], v[76:79], v[84:87], v[204:207]
  v_mfma_f32_16x16x32_bf16 v[208:211], v[72:75], v[88:91], v[208:211]
  v_mfma_f32_16x16x32_bf16 v[208:211], v[76:79], v[92:95], v[208:211]
  v_mfma_f32_16x16x32_bf16 v[212:215], v[72:75], v[96:99], v[212:215]
  v_mfma_f32_16x16x32_bf16 v[212:215], v[76:79], v[100:103], v[212:215]
  v_mfma_f32_16x16x32_bf16 v[216:219], v[72:75], v[104:107], v[216:219]
  s_setprio 2
  s_barrier
  v_mfma_f32_16x16x32_bf16 v[216:219], v[76:79], v[108:111], v[216:219]
  ds_read_b64_tr_b16 v[40:41], v1 offset:0
  s_add_u32 m0, s75, 81920
  s_nop 0
  buffer_load_dwordx4 v29, s[44:47], s74 offen offset:0 lds
  ds_read_b64_tr_b16 v[42:43], v1 offset:2560
  ds_read_b64_tr_b16 v[44:45], v1 offset:20480
  ds_read_b64_tr_b16 v[46:47], v1 offset:23040
  ds_read_b64_tr_b16 v[48:49], v2 offset:0
  buffer_load_dwordx4 v30, s[44:47], s74 offen offset:1024 lds
  ds_read_b64_tr_b16 v[50:51], v2 offset:2560
  ds_read_b64_tr_b16 v[52:53], v2 offset:20480
  ds_read_b64_tr_b16 v[54:55], v2 offset:23040
  ds_read_b64_tr_b16 v[56:57], v3 offset:0
  buffer_load_dwordx4 v31, s[44:47], s74 offen offset:2048 lds
  ds_read_b64_tr_b16 v[58:59], v3 offset:2560
  ds_read_b64_tr_b16 v[60:61], v3 offset:20480
  ds_read_b64_tr_b16 v[62:63], v3 offset:23040
  ds_read_b64_tr_b16 v[64:65], v4 offset:0
  buffer_load_dwordx4 v32, s[44:47], s74 offen offset:3072 lds
  ds_read_b64_tr_b16 v[66:67], v4 offset:2560
  ds_read_b64_tr_b16 v[68:69], v4 offset:20480
  ds_read_b64_tr_b16 v[70:71], v4 offset:23040
  ds_read_b128 v[80:83], v11 offset:8192
  s_add_u32 m0, m0, 4096
  s_nop 0
  buffer_load_dwordx4 v33, s[44:47], s74 offen offset:0 lds
  s_add_u32 s74, s74, 212992
  ds_read_b128 v[84:87], v12 offset:8192
  ds_read_b128 v[88:91], v11 offset:10240
  ds_read_b128 v[92:95], v12 offset:10240
  ds_read_b128 v[96:99], v11 offset:12288
  v_lshl_add_u32 v34, v240, 7, v15
  v_lshl_add_u32 v28, v24, 7, v14
  s_add_u32 m0, s76, 0
  s_nop 0
  buffer_load_dwordx4 v28, s[32:35], 0 offen lds
  ds_read_b128 v[100:103], v12 offset:12288
  ds_read_b128 v[104:107], v11 offset:14336
  ds_read_b128 v[108:111], v12 offset:14336
  ds_read_b64_tr_b16 v[72:73], v5 offset:0
  s_add_u32 m0, m0, 1024
  s_nop 0
  buffer_load_dwordx4 v34, s[32:35], 0 offen lds
  ds_read_b64_tr_b16 v[74:75], v5 offset:2560
  ds_read_b64_tr_b16 v[76:77], v5 offset:20480
  ds_read_b64_tr_b16 v[78:79], v5 offset:23040
  s_waitcnt vmcnt(9) lgkmcnt(0)
  s_barrier
  s_setprio 0
  v_mfma_f32_16x16x32_bf16 v[140:143], v[40:43], v[80:83], v[140:143]
  v_mfma_f32_16x16x32_bf16 v[140:143], v[44:47], v[84:87], v[140:143]
  v_mfma_f32_16x16x32_bf16 v[144:147], v[40:43], v[88:91], v[144:147]
  v_mfma_f32_16x16x32_bf16 v[144:147], v[44:47], v[92:95], v[144:147]
  v_mfma_f32_16x16x32_bf16 v[148:151], v[40:43], v[96:99], v[148:151]
  v_mfma_f32_16x16x32_bf16 v[148:151], v[44:47], v[100:103], v[148:151]
  v_mfma_f32_16x16x32_bf16 v[152:155], v[40:43], v[104:107], v[152:155]
  v_mfma_f32_16x16x32_bf16 v[152:155], v[44:47], v[108:111], v[152:155]
  v_mfma_f32_16x16x32_bf16 v[168:171], v[48:51], v[104:107], v[168:171]
  v_mfma_f32_16x16x32_bf16 v[168:171], v[52:55], v[108:111], v[168:171]
  v_mfma_f32_16x16x32_bf16 v[164:167], v[48:51], v[96:99], v[164:167]
  v_mfma_f32_16x16x32_bf16 v[164:167], v[52:55], v[100:103], v[164:167]
  v_mfma_f32_16x16x32_bf16 v[160:163], v[48:51], v[88:91], v[160:163]
  v_mfma_f32_16x16x32_bf16 v[160:163], v[52:55], v[92:95], v[160:163]
  v_mfma_f32_16x16x32_bf16 v[156:159], v[48:51], v[80:83], v[156:159]
  v_mfma_f32_16x16x32_bf16 v[156:159], v[52:55], v[84:87], v[156:159]
  v_mfma_f32_16x16x32_bf16 v[172:175], v[56:59], v[80:83], v[172:175]
  v_mfma_f32_16x16x32_bf16 v[172:175], v[60:63], v[84:87], v[172:175]
  v_mfma_f32_16x16x32_bf16 v[176:179], v[56:59], v[88:91], v[176:179]
  v_mfma_f32_16x16x32_bf16 v[176:179], v[60:63], v[92:95], v[176:179]
  v_mfma_f32_16x16x32_bf16 v[180:183], v[56:59], v[96:99], v[180:183]
  v_mfma_f32_16x16x32_bf16 v[180:183], v[60:63], v[100:103], v[180:183]
  v_mfma_f32_16x16x32_bf16 v[184:187], v[56:59], v[104:107], v[184:187]
  v_mfma_f32_16x16x32_bf16 v[184:187], v[60:63], v[108:111], v[184:187]
  v_mfma_f32_16x16x32_bf16 v[200:203], v[64:67], v[104:107], v[200:203]
  v_mfma_f32_16x16x32_bf16 v[200:203], v[68:71], v[108:111], v[200:203]
  v_mfma_f32_16x16x32_bf16 v[196:199], v[64:67], v[96:99], v[196:199]
  v_mfma_f32_16x16x32_bf16 v[196:199], v[68:71], v[100:103], v[196:199]
  v_mfma_f32_16x16x32_bf16 v[192:195], v[64:67], v[88:91], v[192:195]
  v_mfma_f32_16x16x32_bf16 v[192:195], v[68:71], v[92:95], v[192:195]
  v_mfma_f32_16x16x32_bf16 v[188:191], v[64:67], v[80:83], v[188:191]
  v_mfma_f32_16x16x32_bf16 v[188:191], v[68:71], v[84:87], v[188:191]
  v_mfma_f32_16x16x32_bf16 v[204:207], v[72:75], v[80:83], v[204:207]
  v_mfma_f32_16x16x32_bf16 v[204:207], v[76:79], v[84:87], v[204:207]
  v_mfma_f32_16x16x32_bf16 v[208:211], v[72:75], v[88:91], v[208:211]
  v_mfma_f32_16x16x32_bf16 v[208:211], v[76:79], v[92:95], v[208:211]
  v_mfma_f32_16x16x32_bf16 v[212:215], v[72:75], v[96:99], v[212:215]
  v_mfma_f32_16x16x32_bf16 v[212:215], v[76:79], v[100:103], v[212:215]
  v_mfma_f32_16x16x32_bf16 v[216:219], v[72:75], v[104:107], v[216:219]
  s_setprio 2
  s_barrier
  v_mfma_f32_16x16x32_bf16 v[216:219], v[76:79], v[108:111], v[216:219]
  ds_read_b64_tr_b16 v[40:41], v1 offset:40960
  s_add_u32 m0, s75, 0
  s_nop 0
  buffer_load_dwordx4 v29, s[44:47], s74 offen offset:0 lds
  ds_read_b64_tr_b16 v[42:43], v1 offset:43520
  ds_read_b64_tr_b16 v[44:45], v6 offset:0
  ds_read_b64_tr_b16 v[46:47], v6 offset:2560
  ds_read_b64_tr_b16 v[48:49], v2 offset:40960
  buffer_load_dwordx4 v30, s[44:47], s74 offen offset:1024 lds
  ds_read_b64_tr_b16 v[50:51], v2 offset:43520
  ds_read_b64_tr_b16 v[52:53], v7 offset:0
  ds_read_b64_tr_b16 v[54:55], v7 offset:2560
  ds_read_b64_tr_b16 v[56:57], v3 offset:40960
  buffer_load_dwordx4 v31, s[44:47], s74 offen offset:2048 lds
  ds_read_b64_tr_b16 v[58:59], v3 offset:43520
  ds_read_b64_tr_b16 v[60:61], v8 offset:0
  ds_read_b64_tr_b16 v[62:63], v8 offset:2560
  ds_read_b64_tr_b16 v[64:65], v4 offset:40960
  buffer_load_dwordx4 v32, s[44:47], s74 offen offset:3072 lds
  ds_read_b64_tr_b16 v[66:67], v4 offset:43520
  ds_read_b64_tr_b16 v[68:69], v9 offset:0
  ds_read_b64_tr_b16 v[70:71], v9 offset:2560
  ds_read_b128 v[80:83], v11 offset:0
  s_add_u32 m0, m0, 4096
  s_nop 0
  buffer_load_dwordx4 v33, s[44:47], s74 offen offset:0 lds
  s_add_u32 s74, s74, 212992
  ds_read_b128 v[84:87], v12 offset:0
  ds_read_b128 v[88:91], v11 offset:2048
  ds_read_b128 v[92:95], v12 offset:2048
  ds_read_b128 v[96:99], v11 offset:4096
  v_lshl_add_u32 v34, v241, 7, v15
  v_lshl_add_u32 v28, v25, 7, v14
  s_add_u32 m0, s76, 8192
  s_nop 0
  buffer_load_dwordx4 v28, s[32:35], 0 offen lds
  ds_read_b128 v[100:103], v12 offset:4096
  ds_read_b128 v[104:107], v11 offset:6144
  ds_read_b128 v[108:111], v12 offset:6144
  ds_read_b64_tr_b16 v[72:73], v5 offset:40960
  s_add_u32 m0, m0, 1024
  s_nop 0
  buffer_load_dwordx4 v34, s[32:35], 0 offen lds
  ds_read_b64_tr_b16 v[74:75], v5 offset:43520
  ds_read_b64_tr_b16 v[76:77], v10 offset:0
  ds_read_b64_tr_b16 v[78:79], v10 offset:2560
  s_waitcnt vmcnt(7) lgkmcnt(0)
  s_barrier
  s_setprio 0
  v_mfma_f32_16x16x32_bf16 v[140:143], v[40:43], v[80:83], v[140:143]
  v_mfma_f32_16x16x32_bf16 v[140:143], v[44:47], v[84:87], v[140:143]
  v_mfma_f32_16x16x32_bf16 v[144:147], v[40:43], v[88:91], v[144:147]
  v_mfma_f32_16x16x32_bf16 v[144:147], v[44:47], v[92:95], v[144:147]
  v_mfma_f32_16x16x32_bf16 v[148:151], v[40:43], v[96:99], v[148:151]
  v_mfma_f32_16x16x32_bf16 v[148:151], v[44:47], v[100:103], v[148:151]
  v_mfma_f32_16x16x32_bf16 v[152:155], v[40:43], v[104:107], v[152:155]
  v_mfma_f32_16x16x32_bf16 v[152:155], v[44:47], v[108:111], v[152:155]
  v_mfma_f32_16x16x32_bf16 v[168:171], v[48:51], v[104:107], v[168:171]
  v_mfma_f32_16x16x32_bf16 v[168:171], v[52:55], v[108:111], v[168:171]
  v_mfma_f32_16x16x32_bf16 v[164:167], v[48:51], v[96:99], v[164:167]
  v_mfma_f32_16x16x32_bf16 v[164:167], v[52:55], v[100:103], v[164:167]
  v_mfma_f32_16x16x32_bf16 v[160:163], v[48:51], v[88:91], v[160:163]
  v_mfma_f32_16x16x32_bf16 v[160:163], v[52:55], v[92:95], v[160:163]
  v_mfma_f32_16x16x32_bf16 v[156:159], v[48:51], v[80:83], v[156:159]
  v_mfma_f32_16x16x32_bf16 v[156:159], v[52:55], v[84:87], v[156:159]
  v_mfma_f32_16x16x32_bf16 v[172:175], v[56:59], v[80:83], v[172:175]
  v_mfma_f32_16x16x32_bf16 v[172:175], v[60:63], v[84:87], v[172:175]
  v_mfma_f32_16x16x32_bf16 v[176:179], v[56:59], v[88:91], v[176:179]
  v_mfma_f32_16x16x32_bf16 v[176:179], v[60:63], v[92:95], v[176:179]
  v_mfma_f32_16x16x32_bf16 v[180:183], v[56:59], v[96:99], v[180:183]
  v_mfma_f32_16x16x32_bf16 v[180:183], v[60:63], v[100:103], v[180:183]
  v_mfma_f32_16x16x32_bf16 v[184:187], v[56:59], v[104:107], v[184:187]
  v_mfma_f32_16x16x32_bf16 v[184:187], v[60:63], v[108:111], v[184:187]
  v_mfma_f32_16x16x32_bf16 v[200:203], v[64:67], v[104:107], v[200:203]
  v_mfma_f32_16x16x32_bf16 v[200:203], v[68:71], v[108:111], v[200:203]
  v_mfma_f32_16x16x32_bf16 v[196:199], v[64:67], v[96:99], v[196:199]
  v_mfma_f32_16x16x32_bf16 v[196:199], v[68:71], v[100:103], v[196:199]
  v_mfma_f32_16x16x32_bf16 v[192:195], v[64:67], v[88:91], v[192:195]
  v_mfma_f32_16x16x32_bf16 v[192:195], v[68:71], v[92:95], v[192:195]
  v_mfma_f32_16x16x32_bf16 v[188:191], v[64:67], v[80:83], v[188:191]
  v_mfma_f32_16x16x32_bf16 v[188:191], v[68:71], v[84:87], v[188:191]
  v_mfma_f32_16x16x32_bf16 v[204:207], v[72:75], v[80:83], v[204:207]
  v_mfma_f32_16x16x32_bf16 v[204:207], v[76:79], v[84:87], v[204:207]
  v_mfma_f32_16x16x32_bf16 v[208:211], v[72:75], v[88:91], v[208:211]
  v_mfma_f32_16x16x32_bf16 v[208:211], v[76:79], v[92:95], v[208:211]
  v_mfma_f32_16x16x32_bf16 v[212:215], v[72:75], v[96:99], v[212:215]
  v_mfma_f32_16x16x32_bf16 v[212:215], v[76:79], v[100:103], v[212:215]
  v_mfma_f32_16x16x32_bf16 v[216:219], v[72:75], v[104:107], v[216:219]
  s_setprio 2
  s_barrier
  v_mfma_f32_16x16x32_bf16 v[216:219], v[76:79], v[108:111], v[216:219]
  ds_read_b64_tr_b16 v[40:41], v6 offset:20480
  s_add_u32 m0, s75, 40960
  s_nop 0
  buffer_load_dwordx4 v29, s[44:47], s74 offen offset:0 lds
  ds_read_b64_tr_b16 v[42:43], v6 offset:23040
  ds_read_b64_tr_b16 v[44:45], v6 offset:40960
  ds_read_b64_tr_b16 v[46:47], v6 offset:43520
  ds_read_b64_tr_b16 v[48:49], v7 offset:20480
  buffer_load_dwordx4 v30, s[44:47], s74 offen offset:1024 lds
  ds_read_b64_tr_b16 v[50:51], v7 offset:23040
  ds_read_b64_tr_b16 v[52:53], v7 offset:40960
  ds_read_b64_tr_b16 v[54:55], v7 offset:43520
  ds_read_b64_tr_b16 v[56:57], v8 offset:20480
  buffer_load_dwordx4 v31, s[44:47], s74 offen offset:2048 lds
  ds_read_b64_tr_b16 v[58:59], v8 offset:23040
  ds_read_b64_tr_b16 v[60:61], v8 offset:40960
  ds_read_b64_tr_b16 v[62:63], v8 offset:43520
  ds_read_b64_tr_b16 v[64:65], v9 offset:20480
  buffer_load_dwordx4 v32, s[44:47], s74 offen offset:3072 lds
  ds_read_b64_tr_b16 v[66:67], v9 offset:23040
  ds_read_b64_tr_b16 v[68:69], v9 offset:40960
  ds_read_b64_tr_b16 v[70:71], v9 offset:43520
  ds_read_b128 v[80:83], v11 offset:8192
  s_add_u32 m0, m0, 4096
  s_nop 0
  buffer_load_dwordx4 v33, s[44:47], s74 offen offset:0 lds
  s_add_u32 s74, s74, 212992
  ds_read_b128 v[84:87], v12 offset:8192
  ds_read_b128 v[88:91], v11 offset:10240
  ds_read_b128 v[92:95], v12 offset:10240
  ds_read_b128 v[96:99], v11 offset:12288
  v_lshl_add_u32 v34, v242, 7, v15
  v_lshl_add_u32 v28, v26, 7, v14
  s_add_u32 m0, s76, 0
  s_nop 0
  buffer_load_dwordx4 v28, s[32:35], 0 offen lds
  ds_read_b128 v[100:103], v12 offset:12288
  ds_read_b128 v[104:107], v11 offset:14336
  ds_read_b128 v[108:111], v12 offset:14336
  ds_read_b64_tr_b16 v[72:73], v10 offset:20480
  s_add_u32 m0, m0, 1024
  s_nop 0
  buffer_load_dwordx4 v34, s[32:35], 0 offen lds
  ds_read_b64_tr_b16 v[74:75], v10 offset:23040
  ds_read_b64_tr_b16 v[76:77], v10 offset:40960
  ds_read_b64_tr_b16 v[78:79], v10 offset:43520
  buffer_load_dwordx3 v[24:26], v13, s[28:31], s73 offen offset:0
  buffer_load_dwordx3 v[240:242], v13, s[28:31], s73 offen offset:832
  s_add_u32 s73, s73, 12
  s_waitcnt vmcnt(9) lgkmcnt(0)
  s_barrier
  s_setprio 0
  v_mfma_f32_16x16x32_bf16 v[140:143], v[40:43], v[80:83], v[140:143]
  s_add_u32 s72, s72, 1
  v_mfma_f32_16x16x32_bf16 v[140:143], v[44:47], v[84:87], v[140:143]
  v_mfma_f32_16x16x32_bf16 v[144:147], v[40:43], v[88:91], v[144:147]
  v_mfma_f32_16x16x32_bf16 v[144:147], v[44:47], v[92:95], v[144:147]
  v_mfma_f32_16x16x32_bf16 v[148:151], v[40:43], v[96:99], v[148:151]
  v_mfma_f32_16x16x32_bf16 v[148:151], v[44:47], v[100:103], v[148:151]
  v_mfma_f32_16x16x32_bf16 v[152:155], v[40:43], v[104:107], v[152:155]
  v_mfma_f32_16x16x32_bf16 v[152:155], v[44:47], v[108:111], v[152:155]
  v_mfma_f32_16x16x32_bf16 v[168:171], v[48:51], v[104:107], v[168:171]
  v_mfma_f32_16x16x32_bf16 v[168:171], v[52:55], v[108:111], v[168:171]
  v_mfma_f32_16x16x32_bf16 v[164:167], v[48:51], v[96:99], v[164:167]
  v_mfma_f32_16x16x32_bf16 v[164:167], v[52:55], v[100:103], v[164:167]
  v_mfma_f32_16x16x32_bf16 v[160:163], v[48:51], v[88:91], v[160:163]
  v_mfma_f32_16x16x32_bf16 v[160:163], v[52:55], v[92:95], v[160:163]
  v_mfma_f32_16x16x32_bf16 v[156:159], v[48:51], v[80:83], v[156:159]
  v_mfma_f32_16x16x32_bf16 v[156:159], v[52:55], v[84:87], v[156:159]
  v_mfma_f32_16x16x32_bf16 v[172:175], v[56:59], v[80:83], v[172:175]
  v_mfma_f32_16x16x32_bf16 v[172:175], v[60:63], v[84:87], v[172:175]
  v_mfma_f32_16x16x32_bf16 v[176:179], v[56:59], v[88:91], v[176:179]
  v_mfma_f32_16x16x32_bf16 v[176:179], v[60:63], v[92:95], v[176:179]
  s_cmp_lt_u32 s72, 4
  v_mfma_f32_16x16x32_bf16 v[180:183], v[56:59], v[96:99], v[180:183]
  v_mfma_f32_16x16x32_bf16 v[180:183], v[60:63], v[100:103], v[180:183]
  v_mfma_f32_16x16x32_bf16 v[184:187], v[56:59], v[104:107], v[184:187]
  v_mfma_f32_16x16x32_bf16 v[184:187], v[60:63], v[108:111], v[184:187]
  v_mfma_f32_16x16x32_bf16 v[200:203], v[64:67], v[104:107], v[200:203]
  v_mfma_f32_16x16x32_bf16 v[200:203], v[68:71], v[108:111], v[200:203]
  v_mfma_f32_16x16x32_bf16 v[196:199], v[64:67], v[96:99], v[196:199]
  v_mfma_f32_16x16x32_bf16 v[196:199], v[68:71], v[100:103], v[196:199]
  v_mfma_f32_16x16x32_bf16 v[192:195], v[64:67], v[88:91], v[192:195]
  v_mfma_f32_16x16x32_bf16 v[192:195], v[68:71], v[92:95], v[192:195]
  v_mfma_f32_16x16x32_bf16 v[188:191], v[64:67], v[80:83], v[188:191]
  v_mfma_f32_16x16x32_bf16 v[188:191], v[68:71], v[84:87], v[188:191]
  v_mfma_f32_16x16x32_bf16 v[204:207], v[72:75], v[80:83], v[204:207]
  v_mfma_f32_16x16x32_bf16 v[204:207], v[76:79], v[84:87], v[204:207]
  v_mfma_f32_16x16x32_bf16 v[208:211], v[72:75], v[88:91], v[208:211]
  v_mfma_f32_16x16x32_bf16 v[208:211], v[76:79], v[92:95], v[208:211]
  v_mfma_f32_16x16x32_bf16 v[212:215], v[72:75], v[96:99], v[212:215]
  v_mfma_f32_16x16x32_bf16 v[212:215], v[76:79], v[100:103], v[212:215]
  v_mfma_f32_16x16x32_bf16 v[216:219], v[72:75], v[104:107], v[216:219]
  s_setprio 2
  s_barrier
  v_mfma_f32_16x16x32_bf16 v[216:219], v[76:79], v[108:111], v[216:219]
  s_cbranch_scc1 L_dnn_loop0
  ds_read_b64_tr_b16 v[40:41], v1 offset:0
  v_lshl_add_u32 v34, v20, 7, v15
  v_lshl_add_u32 v28, v16, 7, v14
  s_add_u32 m0, s76, 8192
  s_nop 0
  buffer_load_dwordx4 v28, s[32:35], 0 offen lds
  ds_read_b64_tr_b16 v[42:43], v1 offset:2560
  ds_read_b64_tr_b16 v[44:45], v1 offset:20480
  ds_read_b64_tr_b16 v[46:47], v1 offset:23040
  ds_read_b64_tr_b16 v[48:49], v2 offset:0
  ds_read_b64_tr_b16 v[50:51], v2 offset:2560
  ds_read_b64_tr_b16 v[52:53], v2 offset:20480
  ds_read_b64_tr_b16 v[54:55], v2 offset:23040
  ds_read_b64_tr_b16 v[56:57], v3 offset:0
  ds_read_b64_tr_b16 v[58:59], v3 offset:2560
  ds_read_b64_tr_b16 v[60:61], v3 offset:20480
  ds_read_b64_tr_b16 v[62:63], v3 offset:23040
  ds_read_b64_tr_b16 v[64:65], v4 offset:0
  ds_read_b64_tr_b16 v[66:67], v4 offset:2560
  ds_read_b64_tr_b16 v[68:69], v4 offset:20480
  ds_read_b64_tr_b16 v[70:71], v4 offset:23040
  ds_read_b128 v[80:83], v11 offset:0
  s_add_u32 m0, m0, 1024
  s_nop 0
  buffer_load_dwordx4 v34, s[32:35], 0 offen lds
  ds_read_b128 v[84:87], v12 offset:0
  ds_read_b128 v[88:91], v11 offset:2048
  ds_read_b128 v[92:95], v12 offset:2048
  ds_read_b128 v[96:99], v11 offset:4096
  ds_read_b128 v[100:103], v12 offset:4096
  ds_read_b128 v[104:107], v11 offset:6144
  ds_read_b128 v[108:111], v12 offset:6144
  ds_read_b64_tr_b16 v[72:73], v5 offset:0
  ds_read_b64_tr_b16 v[74:75], v5 offset:2560
  ds_read_b64_tr_b16 v[76:77], v5 offset:20480
  ds_read_b64_tr_b16 v[78:79], v5 offset:23040
  ds_read_b64 v[220:221], v35 offset:640
  ds_read_b64 v[222:223], v35 offset:672
  ds_read_b64 v[224:225], v35 offset:704
  ds_read_b64 v[226:227], v35 offset:736
  ds_read_b64 v[228:229], v35 offset:768
  s_mov_b32 s60, s24
  s_and_b32 s61, s25, 0xffff
  s_mov_b32 s62, 268435456
  s_mov_b32 s63, 0x20000
  s_mov_b32 s64, s22
  s_and_b32 s65, s23, 0xffff
  s_mov_b32 s66, 256
  s_mov_b32 s67, 0x20000
  v_lshlrev_b32 v28, 2, v0
  s_mov_b64 exec, 0xff
  s_mov_b32 s81, 0x80000
  buffer_load_dword v255, v28, s[60:63], s81 offen
  buffer_load_dword v37, v28, s[64:67], 0 offen offset:128 sc1
  s_mov_b64 exec, -1
  v_mov_b32 v28, 0
  s_waitcnt vmcnt(6) lgkmcnt(0)
  s_barrier
  s_setprio 0
  v_mfma_f32_16x16x32_bf16 v[140:143], v[40:43], v[80:83], v[140:143]
  v_mov_b32 v232, 0xc0135761
  v_mov_b32 v233, 0xc0135761
  v_mfma_f32_16x16x32_bf16 v[140:143], v[44:47], v[84:87], v[140:143]
  v_mov_b32 v234, 0xbdd2d3e8
  v_mov_b32 v235, 0xbdd2d3e8
  v_mfma_f32_16x16x32_bf16 v[144:147], v[40:43], v[88:91], v[144:147]
  v_mov_b32 v236, 0xc2b40000
  v_mov_b32 v237, 0xc2b40000
  v_mfma_f32_16x16x32_bf16 v[144:147], v[44:47], v[92:95], v[144:147]
  v_lshlrev_b32 v112, 16, v220
  v_and_b32 v113, 0xffff0000, v220
  v_mfma_f32_16x16x32_bf16 v[148:151], v[40:43], v[96:99], v[148:151]
  v_lshlrev_b32 v114, 16, v221
  v_and_b32 v115, 0xffff0000, v221
  v_mfma_f32_16x16x32_bf16 v[148:151], v[44:47], v[100:103], v[148:151]
  v_lshlrev_b32 v116, 16, v222
  v_and_b32 v117, 0xffff0000, v222
  v_mfma_f32_16x16x32_bf16 v[152:155], v[40:43], v[104:107], v[152:155]
  v_lshlrev_b32 v118, 16, v223
  v_and_b32 v119, 0xffff0000, v223
  v_mfma_f32_16x16x32_bf16 v[152:155], v[44:47], v[108:111], v[152:155]
  v_lshlrev_b32 v120, 16, v224
  v_and_b32 v121, 0xffff0000, v224
  v_mfma_f32_16x16x32_bf16 v[168:171], v[48:51], v[104:107], v[168:171]
  v_lshlrev_b32 v122, 16, v225
  v_and_b32 v123, 0xffff0000, v225
  v_mfma_f32_16x16x32_bf16 v[168:171], v[52:55], v[108:111], v[168:171]
  v_lshlrev_b32 v124, 16, v226
  v_mfma_f32_16x16x32_bf16 v[164:167], v[48:51], v[96:99], v[164:167]
  v_and_b32 v125, 0xffff0000, v226
  v_lshlrev_b32 v126, 16, v227
  v_mfma_f32_16x16x32_bf16 v[164:167], v[52:55], v[100:103], v[164:167]
  v_and_b32 v127, 0xffff0000, v227
  v_lshlrev_b32 v128, 16, v228
  v_mfma_f32_16x16x32_bf16 v[160:163], v[48:51], v[88:91], v[160:163]
  v_and_b32 v129, 0xffff0000, v228
  v_lshlrev_b32 v130, 16, v229
  v_mfma_f32_16x16x32_bf16 v[160:163], v[52:55], v[92:95], v[160:163]
  v_and_b32 v131, 0xffff0000, v229
  v_mov_b32 v239, 0x21800000
  v_mfma_f32_16x16x32_bf16 v[156:159], v[48:51], v[80:83], v[156:159]
  v_mov_b32 v238, 0x30800000
  v_max3_f32 v239, v239, abs(v112), abs(v113)
  v_mfma_f32_16x16x32_bf16 v[156:159], v[52:55], v[84:87], v[156:159]
  v_max3_f32 v239, v239, abs(v114), abs(v115)
  v_max3_f32 v239, v239, abs(v116), abs(v117)
  v_mfma_f32_16x16x32_bf16 v[172:175], v[56:59], v[80:83], v[172:175]
  v_max3_f32 v239, v239, abs(v118), abs(v119)
  v_max3_f32 v239, v239, abs(v120), abs(v121)
  v_mfma_f32_16x16x32_bf16 v[172:175], v[60:63], v[84:87], v[172:175]
  v_max3_f32 v239, v239, abs(v122), abs(v123)
  v_max3_f32 v239, v239, abs(v124), abs(v125)
  v_mfma_f32_16x16x32_bf16 v[176:179], v[56:59], v[88:91], v[176:179]
  v_max3_f32 v239, v239, abs(v126), abs(v127)
  v_mfma_f32_16x16x32_bf16 v[176:179], v[60:63], v[92:95], v[176:179]
  v_max3_f32 v239, v239, abs(v128), abs(v129)
  v_max3_f32 v239, v239, abs(v130), abs(v131)
  v_mfma_f32_16x16x32_bf16 v[180:183], v[56:59], v[96:99], v[180:183]
  v_and_b32 v239, 0x7f800000, v239
  v_mul_f32 v239, 0x22000000, v239
  v_mfma_f32_16x16x32_bf16 v[180:183], v[60:63], v[100:103], v[180:183]
  v_rcp_f32 v112, v112
  v_mfma_f32_16x16x32_bf16 v[184:187], v[56:59], v[104:107], v[184:187]
  v_rcp_f32 v113, v113
  v_mfma_f32_16x16x32_bf16 v[184:187], v[60:63], v[108:111], v[184:187]
  v_rcp_f32 v114, v114
  v_mfma_f32_16x16x32_bf16 v[200:203], v[64:67], v[104:107], v[200:203]
  v_rcp_f32 v115, v115
  v_mfma_f32_16x16x32_bf16 v[200:203], v[68:71], v[108:111], v[200:203]
  v_rcp_f32 v116, v116
  v_mfma_f32_16x16x32_bf16 v[196:199], v[64:67], v[96:99], v[196:199]
  v_rcp_f32 v117, v117
  v_mfma_f32_16x16x32_bf16 v[196:199], v[68:71], v[100:103], v[196:199]
  v_rcp_f32 v118, v118
  v_mfma_f32_16x16x32_bf16 v[192:195], v[64:67], v[88:91], v[192:195]
  v_rcp_f32 v119, v119
  v_mfma_f32_16x16x32_bf16 v[192:195], v[68:71], v[92:95], v[192:195]
  v_rcp_f32 v120, v120
  v_mfma_f32_16x16x32_bf16 v[188:191], v[64:67], v[80:83], v[188:191]
  v_rcp_f32 v121, v121
  v_mfma_f32_16x16x32_bf16 v[188:191], v[68:71], v[84:87], v[188:191]
  v_rcp_f32 v122, v122
  v_mfma_f32_16x16x32_bf16 v[204:207], v[72:75], v[80:83], v[204:207]
  v_rcp_f32 v123, v123
  v_mfma_f32_16x16x32_bf16 v[204:207], v[76:79], v[84:87], v[204:207]
  v_rcp_f32 v124, v124
  v_mfma_f32_16x16x32_bf16 v[208:211], v[72:75], v[88:91], v[208:211]
  v_rcp_f32 v125, v125
  v_mfma_f32_16x16x32_bf16 v[208:211], v[76:79], v[92:95], v[208:211]
  v_rcp_f32 v126, v126
  v_mfma_f32_16x16x32_bf16 v[212:215], v[72:75], v[96:99], v[212:215]
  v_rcp_f32 v127, v127
  v_mfma_f32_16x16x32_bf16 v[212:215], v[76:79], v[100:103], v[212:215]
  v_mfma_f32_16x16x32_bf16 v[216:219], v[72:75], v[104:107], v[216:219]
  s_setprio 2
  s_barrier
  v_mfma_f32_16x16x32_bf16 v[216:219], v[76:79], v[108:111], v[216:219]
  ds_read_b64_tr_b16 v[40:41], v1 offset:40960
  ds_read_b64_tr_b16 v[42:43], v1 offset:43520
  ds_read_b64_tr_b16 v[44:45], v6 offset:0
  ds_read_b64_tr_b16 v[46:47], v6 offset:2560
  ds_read_b64_tr_b16 v[48:49], v2 offset:40960
  ds_read_b64_tr_b16 v[50:51], v2 offset:43520
  ds_read_b64_tr_b16 v[52:53], v7 offset:0
  ds_read_b64_tr_b16 v[54:55], v7 offset:2560
  ds_read_b64_tr_b16 v[56:57], v3 offset:40960
  ds_read_b64_tr_b16 v[58:59], v3 offset:43520
  ds_read_b64_tr_b16 v[60:61], v8 offset:0
  ds_read_b64_tr_b16 v[62:63], v8 offset:2560
  ds_read_b64_tr_b16 v[64:65], v4 offset:40960
  ds_read_b64_tr_b16 v[66:67], v4 offset:43520
  ds_read_b64_tr_b16 v[68:69], v9 offset:0
  ds_read_b64_tr_b16 v[70:71], v9 offset:2560
  ds_read_b128 v[80:83], v11 offset:8192
  ds_read_b128 v[84:87], v12 offset:8192
  ds_read_b128 v[88:91], v11 offset:10240
  ds_read_b128 v[92:95], v12 offset:10240
  ds_read_b128 v[96:99], v11 offset:12288
  ds_read_b128 v[100:103], v12 offset:12288
  ds_read_b128 v[104:107], v11 offset:14336
  ds_read_b128 v[108:111], v12 offset:14336
  ds_read_b64_tr_b16 v[72:73], v5 offset:40960
  ds_read_b64_tr_b16 v[74:75], v5 offset:43520
  ds_read_b64_tr_b16 v[76:77], v10 offset:0
  ds_read_b64_tr_b16 v[78:79], v10 offset:2560
  s_waitcnt vmcnt(2) lgkmcnt(0)
  s_barrier
  s_setprio 0
  v_mfma_f32_16x16x32_bf16 v[140:143], v[40:43], v[80:83], v[140:143]
  v_rcp_f32 v128, v128
  v_mfma_f32_16x16x32_bf16 v[140:143], v[44:47], v[84:87], v[140:143]
  v_rcp_f32 v129, v129
  v_mfma_f32_16x16x32_bf16 v[144:147], v[40:43], v[88:91], v[144:147]
  v_rcp_f32 v130, v130
  v_mfma_f32_16x16x32_bf16 v[144:147], v[44:47], v[92:95], v[144:147]
  v_rcp_f32 v131, v131
  v_mfma_f32_16x16x32_bf16 v[148:151], v[40:43], v[96:99], v[148:151]
  v_mul_f32 v112, v239, v112
  v_mfma_f32_16x16x32_bf16 v[148:151], v[44:47], v[100:103], v[148:151]
  v_mul_f32 v113, v239, v113
  v_mul_f32 v114, v239, v114
  v_mfma_f32_16x16x32_bf16 v[152:155], v[40:43], v[104:107], v[152:155]
  v_mul_f32 v115, v239, v115
  v_mul_f32 v116, v239, v116
  v_mfma_f32_16x16x32_bf16 v[152:155], v[44:47], v[108:111], v[152:155]
  v_mul_f32 v117, v239, v117
  v_mul_f32 v118, v239, v118
  v_mfma_f32_16x16x32_bf16 v[168:171], v[48:51], v[104:107], v[168:171]
  v_mul_f32 v119, v239, v119
  v_mul_f32 v120, v239, v120
  v_mfma_f32_16x16x32_bf16 v[168:171], v[52:55], v[108:111], v[168:171]
  v_mul_f32 v121, v239, v121
  v_mfma_f32_16x16x32_bf16 v[164:167], v[48:51], v[96:99], v[164:167]
  v_mul_f32 v122, v239, v122
  v_mul_f32 v123, v239, v123
  v_mfma_f32_16x16x32_bf16 v[164:167], v[52:55], v[100:103], v[164:167]
  v_mul_f32 v124, v239, v124
  v_mul_f32 v125, v239, v125
  v_mfma_f32_16x16x32_bf16 v[160:163], v[48:51], v[88:91], v[160:163]
  v_mul_f32 v126, v239, v126
  v_mul_f32 v127, v239, v127
  v_mfma_f32_16x16x32_bf16 v[160:163], v[52:55], v[92:95], v[160:163]
  v_mul_f32 v128, v239, v128
  v_mul_f32 v129, v239, v129
  v_mfma_f32_16x16x32_bf16 v[156:159], v[48:51], v[80:83], v[156:159]
  v_mul_f32 v130, v239, v130
  v_mfma_f32_16x16x32_bf16 v[156:159], v[52:55], v[84:87], v[156:159]
  v_mul_f32 v131, v239, v131
  v_med3_f32 v112, v112, -v238, v238
  v_mfma_f32_16x16x32_bf16 v[172:175], v[56:59], v[80:83], v[172:175]
  v_med3_f32 v113, v113, -v238, v238
  v_med3_f32 v114, v114, -v238, v238
  v_mfma_f32_16x16x32_bf16 v[172:175], v[60:63], v[84:87], v[172:175]
  v_med3_f32 v115, v115, -v238, v238
  v_med3_f32 v116, v116, -v238, v238
  v_mfma_f32_16x16x32_bf16 v[176:179], v[56:59], v[88:91], v[176:179]
  v_med3_f32 v117, v117, -v238, v238
  v_mfma_f32_16x16x32_bf16 v[176:179], v[60:63], v[92:95], v[176:179]
  v_med3_f32 v118, v118, -v238, v238
  v_med3_f32 v119, v119, -v238, v238
  v_mfma_f32_16x16x32_bf16 v[180:183], v[56:59], v[96:99], v[180:183]
  v_med3_f32 v120, v120, -v238, v238
  v_med3_f32 v121, v121, -v238, v238
  v_mfma_f32_16x16x32_bf16 v[180:183], v[60:63], v[100:103], v[180:183]
  v_med3_f32 v122, v122, -v238, v238
  v_med3_f32 v123, v123, -v238, v238
  v_mfma_f32_16x16x32_bf16 v[184:187], v[56:59], v[104:107], v[184:187]
  v_med3_f32 v124, v124, -v238, v238
  v_med3_f32 v125, v125, -v238, v238
  v_mfma_f32_16x16x32_bf16 v[184:187], v[60:63], v[108:111], v[184:187]
  v_med3_f32 v126, v126, -v238, v238
  v_mfma_f32_16x16x32_bf16 v[200:203], v[64:67], v[104:107], v[200:203]
  v_med3_f32 v127, v127, -v238, v238
  v_med3_f32 v128, v128, -v238, v238
  v_mfma_f32_16x16x32_bf16 v[200:203], v[68:71], v[108:111], v[200:203]
  v_med3_f32 v129, v129, -v238, v238
  v_med3_f32 v130, v130, -v238, v238
  v_mfma_f32_16x16x32_bf16 v[196:199], v[64:67], v[96:99], v[196:199]
  v_med3_f32 v131, v131, -v238, v238
  v_mul_f32 v132, 0x6c800000, v112
  v_mfma_f32_16x16x32_bf16 v[196:199], v[68:71], v[100:103], v[196:199]
  v_mul_f32 v133, 0x6c800000, v113
  v_mul_f32 v134, 0x6c800000, v114
  v_mfma_f32_16x16x32_bf16 v[192:195], v[64:67], v[88:91], v[192:195]
  v_mul_f32 v135, 0x6c800000, v115
  v_mfma_f32_16x16x32_bf16 v[192:195], v[68:71], v[92:95], v[192:195]
  v_mul_f32 v136, 0x6c800000, v116
  v_mul_f32 v137, 0x6c800000, v117
  v_mfma_f32_16x16x32_bf16 v[188:191], v[64:67], v[80:83], v[188:191]
  v_mul_f32 v138, 0x6c800000, v118
  v_mul_f32 v139, 0x6c800000, v119
  v_mfma_f32_16x16x32_bf16 v[188:191], v[68:71], v[84:87], v[188:191]
  v_mul_f32 v220, 0x6c800000, v120
  v_mul_f32 v221, 0x6c800000, v121
  v_mfma_f32_16x16x32_bf16 v[204:207], v[72:75], v[80:83], v[204:207]
  v_mul_f32 v222, 0x6c800000, v122
  v_mul_f32 v223, 0x6c800000, v123
  v_mfma_f32_16x16x32_bf16 v[204:207], v[76:79], v[84:87], v[204:207]
  v_mul_f32 v224, 0x6c800000, v124
  v_mfma_f32_16x16x32_bf16 v[208:211], v[72:75], v[88:91], v[208:211]
  v_mul_f32 v225, 0x6c800000, v125
  v_mul_f32 v226, 0x6c800000, v126
  v_mfma_f32_16x16x32_bf16 v[208:211], v[76:79], v[92:95], v[208:211]
  v_mul_f32 v227, 0x6c800000, v127
  v_mul_f32 v228, 0x6c800000, v128
  v_mfma_f32_16x16x32_bf16 v[212:215], v[72:75], v[96:99], v[212:215]
  v_mul_f32 v229, 0x6c800000, v129
  v_mul_f32 v230, 0x6c800000, v130
  v_mfma_f32_16x16x32_bf16 v[212:215], v[76:79], v[100:103], v[212:215]
  v_mul_f32 v231, 0x6c800000, v131
  v_mfma_f32_16x16x32_bf16 v[216:219], v[72:75], v[104:107], v[216:219]
  s_setprio 2
  s_barrier
  v_mfma_f32_16x16x32_bf16 v[216:219], v[76:79], v[108:111], v[216:219]
  s_setprio 0
  s_branch L_epi
L_dnn_h1:
  v_lshl_add_u32 v34, v49, 7, v15
  v_lshl_add_u32 v28, v45, 7, v14
  s_add_u32 m0, s76, 8192
  s_nop 0
  buffer_load_dwordx4 v28, s[32:35], 0 offen lds
  s_add_u32 m0, m0, 1024
  s_nop 0
  buffer_load_dwordx4 v34, s[32:35], 0 offen lds
  s_add_u32 m0, s75, 40960
  s_nop 0
  buffer_load_dwordx4 v29, s[44:47], s74 offen offset:0 lds
  buffer_load_dwordx4 v30, s[44:47], s74 offen offset:1024 lds
  buffer_load_dwordx4 v31, s[44:47], s74 offen offset:2048 lds
  buffer_load_dwordx4 v32, s[44:47], s74 offen offset:3072 lds
  s_add_u32 m0, m0, 4096
  s_nop 0
  buffer_load_dwordx4 v33, s[44:47], s74 offen offset:0 lds
  s_add_u32 s74, s74, 212992
  s_waitcnt vmcnt(14)
  s_waitcnt vmcnt(10) lgkmcnt(0)
  s_barrier
  buffer_load_dwordx3 v[24:26], v13, s[28:31], s73 offen offset:0
  buffer_load_dwordx3 v[240:242], v13, s[28:31], s73 offen offset:832
  s_add_u32 s73, s73, 12
  s_barrier
L_dnn_loop1:
  ds_read_b64_tr_b16 v[40:41], v1 offset:0
  s_add_u32 m0, s75, 81920
  s_nop 0
  buffer_load_dwordx4 v29, s[44:47], s74 offen offset:0 lds
  ds_read_b64_tr_b16 v[42:43], v1 offset:2560
  ds_read_b64_tr_b16 v[44:45], v1 offset:20480
  ds_read_b64_tr_b16 v[46:47], v1 offset:23040
  ds_read_b64_tr_b16 v[48:49], v2 offset:0
  buffer_load_dwordx4 v30, s[44:47], s74 offen offset:1024 lds
  ds_read_b64_tr_b16 v[50:51], v2 offset:2560
  ds_read_b64_tr_b16 v[52:53], v2 offset:20480
  ds_read_b64_tr_b16 v[54:55], v2 offset:23040
  ds_read_b64_tr_b16 v[56:57], v3 offset:0
  buffer_load_dwordx4 v31, s[44:47], s74 offen offset:2048 lds
  ds_read_b64_tr_b16 v[58:59], v3 offset:2560
  ds_read_b64_tr_b16 v[60:61], v3 offset:20480
  ds_read_b64_tr_b16 v[62:63], v3 offset:23040
  ds_read_b64_tr_b16 v[64:65], v4 offset:0
  buffer_load_dwordx4 v32, s[44:47], s74 offen offset:3072 lds
  ds_read_b64_tr_b16 v[66:67], v4 offset:2560
  ds_read_b64_tr_b16 v[68:69], v4 offset:20480
  ds_read_b64_tr_b16 v[70:71], v4 offset:23040
  ds_read_b128 v[80:83], v11 offset:0
  s_add_u32 m0, m0, 4096
  s_nop 0
  buffer_load_dwordx4 v33, s[44:47], s74 offen offset:0 lds
  s_add_u32 s74, s74, 212992
  ds_read_b128 v[84:87], v12 offset:0
  ds_read_b128 v[88:91], v11 offset:2048
  ds_read_b128 v[92:95], v12 offset:2048
  ds_read_b128 v[96:99], v11 offset:4096
  s_waitcnt vmcnt(14)
  v_lshl_add_u32 v34, v20, 7, v15
  v_lshl_add_u32 v28, v16, 7, v14
  s_add_u32 m0, s76, 0
  s_nop 0
  buffer_load_dwordx4 v28, s[32:35], 0 offen lds
  ds_read_b128 v[100:103], v12 offset:4096
  ds_read_b128 v[104:107], v11 offset:6144
  ds_read_b128 v[108:111], v12 offset:6144
  ds_read_b64_tr_b16 v[72:73], v5 offset:0
  s_add_u32 m0, m0, 1024
  s_nop 0
  buffer_load_dwordx4 v34, s[32:35], 0 offen lds
  ds_read_b64_tr_b16 v[74:75], v5 offset:2560
  ds_read_b64_tr_b16 v[76:77], v5 offset:20480
  ds_read_b64_tr_b16 v[78:79], v5 offset:23040
L_dnn_in1:
  s_waitcnt vmcnt(9) lgkmcnt(0)
  s_waitcnt vmcnt(9)
  s_barrier
  s_setprio 0
  v_mfma_f32_16x16x32_bf16 v[140:143], v[40:43], v[80:83], v[140:143]
  v_mfma_f32_16x16x32_bf16 v[140:143], v[44:47], v[84:87], v[140:143]
  v_mfma_f32_16x16x32_bf16 v[144:147], v[40:43], v[88:91], v[144:147]
  v_mfma_f32_16x16x32_bf16 v[144:147], v[44:47], v[92:95], v[144:147]
  v_mfma_f32_16x16x32_bf16 v[148:151], v[40:43], v[96:99], v[148:151]
  v_mfma_f32_16x16x32_bf16 v[148:151], v[44:47], v[100:103], v[148:151]
  v_mfma_f32_16x16x32_bf16 v[152:155], v[40:43], v[104:107], v[152:155]
  v_mfma_f32_16x16x32_bf16 v[152:155], v[44:47], v[108:111], v[152:155]
  v_mfma_f32_16x16x32_bf16 v[168:171], v[48:51], v[104:107], v[168:171]
  v_mfma_f32_16x16x32_bf16 v[168:171], v[52:55], v[108:111], v[168:171]
  v_mfma_f32_16x16x32_bf16 v[164:167], v[48:51], v[96:99], v[164:167]
  v_mfma_f32_16x16x32_bf16 v[164:167], v[52:55], v[100:103], v[164:167]
  v_mfma_f32_16x16x32_bf16 v[160:163], v[48:51], v[88:91], v[160:163]
  v_mfma_f32_16x16x32_bf16 v[160:163], v[52:55], v[92:95], v[160:163]
  v_mfma_f32_16x16x32_bf16 v[156:159], v[48:51], v[80:83], v[156:159]
  v_mfma_f32_16x16x32_bf16 v[156:159], v[52:55], v[84:87], v[156:159]
  v_mfma_f32_16x16x32_bf16 v[172:175], v[56:59], v[80:83], v[172:175]
  v_mfma_f32_16x16x32_bf16 v[172:175], v[60:63], v[84:87], v[172:175]
  v_mfma_f32_16x16x32_bf16 v[176:179], v[56:59], v[88:91], v[176:179]
  v_mfma_f32_16x16x32_bf16 v[176:179], v[60:63], v[92:95], v[176:179]
  v_mfma_f32_16x16x32_bf16 v[180:183], v[56:59], v[96:99], v[180:183]
  v_mfma_f32_16x16x32_bf16 v[180:183], v[60:63], v[100:103], v[180:183]
  v_mfma_f32_16x16x32_bf16 v[184:187], v[56:59], v[104:107], v[184:187]
  v_mfma_f32_16x16x32_bf16 v[184:187], v[60:63], v[108:111], v[184:187]
  v_mfma_f32_16x16x32_bf16 v[200:203], v[64:67], v[104:107], v[200:203]
  v_mfma_f32_16x16x32_bf16 v[200:203], v[68:71], v[108:111], v[200:203]
  v_mfma_f32_16x16x32_bf16 v[196:199], v[64:67], v[96:99], v[196:199]
  v_mfma_f32_16x16x32_bf16 v[196:199], v[68:71], v[100:103], v[196:199]
  v_mfma_f32_16x16x32_bf16 v[192:195], v[64:67], v[88:91], v[192:195]
  v_mfma_f32_16x16x32_bf16 v[192:195], v[68:71], v[92:95], v[192:195]
  v_mfma_f32_16x16x32_bf16 v[188:191], v[64:67], v[80:83], v[188:191]
  v_mfma_f32_16x16x32_bf16 v[188:191], v[68:71], v[84:87], v[188:191]
  v_mfma_f32_16x16x32_bf16 v[204:207], v[72:75], v[80:83], v[204:207]
  v_mfma_f32_16x16x32_bf16 v[204:207], v[76:79], v[84:87], v[204:207]
  v_mfma_f32_16x16x32_bf16 v[208:211], v[72:75], v[88:91], v[208:211]
  v_mfma_f32_16x16x32_bf16 v[208:211], v[76:79], v[92:95], v[208:211]
  v_mfma_f32_16x16x32_bf16 v[212:215], v[72:75], v[96:99], v[212:215]
  v_mfma_f32_16x16x32_bf16 v[212:215], v[76:79], v[100:103], v[212:215]
  v_mfma_f32_16x16x32_bf16 v[216:219], v[72:75], v[104:107], v[216:219]
  s_setprio 2
  s_barrier
  v_mfma_f32_16x16x32_bf16 v[216:219], v[76:79], v[108:111], v[216:219]
  ds_read_b64_tr_b16 v[40:41], v1 offset:40960
  s_add_u32 m0, s75, 0
  s_nop 0
  buffer_load_dwordx4 v29, s[44:47], s74 offen offset:0 lds
  ds_read_b64_tr_b16 v[42:43], v1 offset:43520
  ds_read_b64_tr_b16 v[44:45], v6 offset:0
  ds_read_b64_tr_b16 v[46:47], v6 offset:2560
  ds_read_b64_tr_b16 v[48:49], v2 offset:40960
  buffer_load_dwordx4 v30, s[44:47], s74 offen offset:1024 lds
  ds_read_b64_tr_b16 v[50:51], v2 offset:43520
  ds_read_b64_tr_b16 v[52:53], v7 offset:0
  ds_read_b64_tr_b16 v[54:55], v7 offset:2560
  ds_read_b64_tr_b16 v[56:57], v3 offset:40960
  buffer_load_dwordx4 v31, s[44:47], s74 offen offset:2048 lds
  ds_read_b64_tr_b16 v[58:59], v3 offset:43520
  ds_read_b64_tr_b16 v[60:61], v8 offset:0
  ds_read_b64_tr_b16 v[62:63], v8 offset:2560
  ds_read_b64_tr_b16 v[64:65], v4 offset:40960
  buffer_load_dwordx4 v32, s[44:47], s74 offen offset:3072 lds
  ds_read_b64_tr_b16 v[66:67], v4 offset:43520
  ds_read_b64_tr_b16 v[68:69], v9 offset:0
  ds_read_b64_tr_b16 v[70:71], v9 offset:2560
  ds_read_b128 v[80:83], v11 offset:8192
  s_add_u32 m0, m0, 4096
  s_nop 0
  buffer_load_dwordx4 v33, s[44:47], s74 offen offset:0 lds
  s_add_u32 s74, s74, 212992
  ds_read_b128 v[84:87], v12 offset:8192
  ds_read_b128 v[88:91], v11 offset:10240
  ds_read_b128 v[92:95], v12 offset:10240
  ds_read_b128 v[96:99], v11 offset:12288
  v_lshl_add_u32 v34, v21, 7, v15
  v_lshl_add_u32 v28, v17, 7, v14
  s_add_u32 m0, s76, 8192
  s_nop 0
  buffer_load_dwordx4 v28, s[32:35], 0 offen lds
  ds_read_b128 v[100:103], v12 offset:12288
  ds_read_b128 v[104:107], v11 offset:14336
  ds_read_b128 v[108:111], v12 offset:14336
  ds_read_b64_tr_b16 v[72:73], v5 offset:40960
  s_add_u32 m0, m0, 1024
  s_nop 0
  buffer_load_dwordx4 v34, s[32:35], 0 offen lds
  ds_read_b64_tr_b16 v[74:75], v5 offset:43520
  ds_read_b64_tr_b16 v[76:77], v10 offset:0
  ds_read_b64_tr_b16 v[78:79], v10 offset:2560
  s_waitcnt vmcnt(7) lgkmcnt(0)
  s_barrier
  s_setprio 0
  v_mfma_f32_16x16x32_bf16 v[140:143], v[40:43], v[80:83], v[140:143]
  v_mfma_f32_16x16x32_bf16 v[140:143], v[44:47], v[84:87], v[140:143]
  v_mfma_f32_16x16x32_bf16 v[144:147], v[40:43], v[88:91], v[144:147]
  v_mfma_f32_16x16x32_bf16 v[144:147], v[44:47], v[92:95], v[144:147]
  v_mfma_f32_16x16x32_bf16 v[148:151], v[40:43], v[96:99], v[148:151]
  v_mfma_f32_16x16x32_bf16 v[148:151], v[44:47], v[100:103], v[148:151]
  v_mfma_f32_16x16x32_bf16 v[152:155], v[40:43], v[104:107], v[152:155]
  v_mfma_f32_16x16x32_bf16 v[152:155], v[44:47], v[108:111], v[152:155]
  v_mfma_f32_16x16x32_bf16 v[168:171], v[48:51], v[104:107], v[168:171]
  v_mfma_f32_16x16x32_bf16 v[168:171], v[52:55], v[108:111], v[168:171]
  v_mfma_f32_16x16x32_bf16 v[164:167], v[48:51], v[96:99], v[164:167]
  v_mfma_f32_16x16x32_bf16 v[164:167], v[52:55], v[100:103], v[164:167]
  v_mfma_f32_16x16x32_bf16 v[160:163], v[48:51], v[88:91], v[160:163]
  v_mfma_f32_16x16x32_bf16 v[160:163], v[52:55], v[92:95], v[160:163]
  v_mfma_f32_16x16x32_bf16 v[156:159], v[48:51], v[80:83], v[156:159]
  v_mfma_f32_16x16x32_bf16 v[156:159], v[52:55], v[84:87], v[156:159]
  v_mfma_f32_16x16x32_bf16 v[172:175], v[56:59], v[80:83], v[172:175]
  v_mfma_f32_16x16x32_bf16 v[172:175], v[60:63], v[84:87], v[172:175]
  v_mfma_f32_16x16x32_bf16 v[176:179], v[56:59], v[88:91], v[176:179]
  v_mfma_f32_16x16x32_bf16 v[176:179], v[60:63], v[92:95], v[176:179]
  v_mfma_f32_16x16x32_bf16 v[180:183], v[56:59], v[96:99], v[180:183]
  v_mfma_f32_16x16x32_bf16 v[180:183], v[60:63], v[100:103], v[180:183]
  v_mfma_f32_16x16x32_bf16 v[184:187], v[56:59], v[104:107], v[184:187]
  v_mfma_f32_16x16x32_bf16 v[184:187], v[60:63], v[108:111], v[184:187]
  v_mfma_f32_16x16x32_bf16 v[200:203], v[64:67], v[104:107], v[200:203]
  v_mfma_f32_16x16x32_bf16 v[200:203], v[68:71], v[108:111], v[200:203]
  v_mfma_f32_16x16x32_bf16 v[196:199], v[64:67], v[96:99], v[196:199]
  v_mfma_f32_16x16x32_bf16 v[196:199], v[68:71], v[100:103], v[196:199]
  v_mfma_f32_16x16x32_bf16 v[192:195], v[64:67], v[88:91], v[192:195]
  v_mfma_f32_16x16x32_bf16 v[192:195], v[68:71], v[92:95], v[192:195]
  v_mfma_f32_16x16x32_bf16 v[188:191], v[64:67], v[80:83], v[188:191]
  v_mfma_f32_16x16x32_bf16 v[188:191], v[68:71], v[84:87], v[188:191]
  v_mfma_f32_16x16x32_bf16 v[204:207], v[72:75], v[80:83], v[204:207]
  v_mfma_f32_16x16x32_bf16 v[204:207], v[76:79], v[84:87], v[204:207]
  v_mfma_f32_16x16x32_bf16 v[208:211], v[72:75], v[88:91], v[208:211]
  v_mfma_f32_16x16x32_bf16 v[208:211], v[76:79], v[92:95], v[208:211]
  v_mfma_f32_16x16x32_bf16 v[212:215], v[72:75], v[96:99], v[212:215]
  v_mfma_f32_16x16x32_bf16 v[212:215], v[76:79], v[100:103], v[212:215]
  v_mfma_f32_16x16x32_bf16 v[216:219], v[72:75], v[104:107], v[216:219]
  s_setprio 2
  s_barrier
  v_mfma_f32_16x16x32_bf16 v[216:219], v[76:79], v[108:111], v[216:219]
  ds_read_b64_tr_b16 v[40:41], v6 offset:20480
  s_add_u32 m0, s75, 40960
  s_nop 0
  buffer_load_dwordx4 v29, s[44:47], s74 offen offset:0 lds
  ds_read_b64_tr_b16 v[42:43], v6 offset:23040
  ds_read_b64_tr_b16 v[44:45], v6 offset:40960
  ds_read_b64_tr_b16 v[46:47], v6 offset:43520
  ds_read_b64_tr_b16 v[48:49], v7 offset:20480
  buffer_load_dwordx4 v30, s[44:47], s74 offen offset:1024 lds
  ds_read_b64_tr_b16 v[50:51], v7 offset:23040
  ds_read_b64_tr_b16 v[52:53], v7 offset:40960
  ds_read_b64_tr_b16 v[54:55], v7 offset:43520
  ds_read_b64_tr_b16 v[56:57], v8 offset:20480
  buffer_load_dwordx4 v31, s[44:47], s74 offen offset:2048 lds
  ds_read_b64_tr_b16 v[58:59], v8 offset:23040
  ds_read_b64_tr_b16 v[60:61], v8 offset:40960
  ds_read_b64_tr_b16 v[62:63], v8 offset:43520
  ds_read_b64_tr_b16 v[64:65], v9 offset:20480
  buffer_load_dwordx4 v32, s[44:47], s74 offen offset:3072 lds
  ds_read_b64_tr_b16 v[66:67], v9 offset:23040
  ds_read_b64_tr_b16 v[68:69], v9 offset:40960
  ds_read_b64_tr_b16 v[70:71], v9 offset:43520
  ds_read_b128 v[80:83], v11 offset:0
  s_add_u32 m0, m0, 4096
  s_nop 0
  buffer_load_dwordx4 v33, s[44:47], s74 offen offset:0 lds
  s_add_u32 s74, s74, 212992
  ds_read_b128 v[84:87], v12 offset:0
  ds_read_b128 v[88:91], v11 offset:2048
  ds_read_b128 v[92:95], v12 offset:2048
  ds_read_b128 v[96:99], v11 offset:4096
  v_lshl_add_u32 v34, v22, 7, v15
  v_lshl_add_u32 v28, v18, 7, v14
  s_add_u32 m0, s76, 0
  s_nop 0
  buffer_load_dwordx4 v28, s[32:35], 0 offen lds
  ds_read_b128 v[100:103], v12 offset:4096
  ds_read_b128 v[104:107], v11 offset:6144
  ds_read_b128 v[108:111], v12 offset:6144
  ds_read_b64_tr_b16 v[72:73], v10 offset:20480
  s_add_u32 m0, m0, 1024
  s_nop 0
  buffer_load_dwordx4 v34, s[32:35], 0 offen lds
  ds_read_b64_tr_b16 v[74:75], v10 offset:23040
  ds_read_b64_tr_b16 v[76:77], v10 offset:40960
  ds_read_b64_tr_b16 v[78:79], v10 offset:43520
  buffer_load_dwordx3 v[16:18], v13, s[28:31], s73 offen offset:0
  buffer_load_dwordx3 v[20:22], v13, s[28:31], s73 offen offset:832
  s_add_u32 s73, s73, 12
  s_waitcnt vmcnt(9) lgkmcnt(0)
  s_barrier
  s_setprio 0
  v_mfma_f32_16x16x32_bf16 v[140:143], v[40:43], v[80:83], v[140:143]
  v_mfma_f32_16x16x32_bf16 v[140:143], v[44:47], v[84:87], v[140:143]
  v_mfma_f32_16x16x32_bf16 v[144:147], v[40:43], v[88:91], v[144:147]
  v_mfma_f32_16x16x32_bf16 v[144:147], v[44:47], v[92:95], v[144:147]
  v_mfma_f32_16x16x32_bf16 v[148:151], v[40:43], v[96:99], v[148:151]
  v_mfma_f32_16x16x32_bf16 v[148:151], v[44:47], v[100:103], v[148:151]
  v_mfma_f32_16x16x32_bf16 v[152:155], v[40:43], v[104:107], v[152:155]
  v_mfma_f32_16x16x32_bf16 v[152:155], v[44:47], v[108:111], v[152:155]
  v_mfma_f32_16x16x32_bf16 v[168:171], v[48:51], v[104:107], v[168:171]
  v_mfma_f32_16x16x32_bf16 v[168:171], v[52:55], v[108:111], v[168:171]
  v_mfma_f32_16x16x32_bf16 v[164:167], v[48:51], v[96:99], v[164:167]
  v_mfma_f32_16x16x32_bf16 v[164:167], v[52:55], v[100:103], v[164:167]
  v_mfma_f32_16x16x32_bf16 v[160:163], v[48:51], v[88:91], v[160:163]
  v_mfma_f32_16x16x32_bf16 v[160:163], v[52:55], v[92:95], v[160:163]
  v_mfma_f32_16x16x32_bf16 v[156:159], v[48:51], v[80:83], v[156:159]
  v_mfma_f32_16x16x32_bf16 v[156:159], v[52:55], v[84:87], v[156:159]
  v_mfma_f32_16x16x32_bf16 v[172:175], v[56:59], v[80:83], v[172:175]
  v_mfma_f32_16x16x32_bf16 v[172:175], v[60:63], v[84:87], v[172:175]
  v_mfma_f32_16x16x32_bf16 v[176:179], v[56:59], v[88:91], v[176:179]
  v_mfma_f32_16x16x32_bf16 v[176:179], v[60:63], v[92:95], v[176:179]
  v_mfma_f32_16x16x32_bf16 v[180:183], v[56:59], v[96:99], v[180:183]
  v_mfma_f32_16x16x32_bf16 v[180:183], v[60:63], v[100:103], v[180:183]
  v_mfma_f32_16x16x32_bf16 v[184:187], v[56:59], v[104:107], v[184:187]
  v_mfma_f32_16x16x32_bf16 v[184:187], v[60:63], v[108:111], v[184:187]
  v_mfma_f32_16x16x32_bf16 v[200:203], v[64:67], v[104:107], v[200:203]
  v_mfma_f32_16x16x32_bf16 v[200:203], v[68:71], v[108:111], v[200:203]
  v_mfma_f32_16x16x32_bf16 v[196:199], v[64:67], v[96:99], v[196:199]
  v_mfma_f32_16x16x32_bf16 v[196:199], v[68:71], v[100:103], v[196:199]
  v_mfma_f32_16x16x32_bf16 v[192:195], v[64:67], v[88:91], v[192:195]
  v_mfma_f32_16x16x32_bf16 v[192:195], v[68:71], v[92:95], v[192:195]
  v_mfma_f32_16x16x32_bf16 v[188:191], v[64:67], v[80:83], v[188:191]
  v_mfma_f32_16x16x32_bf16 v[188:191], v[68:71], v[84:87], v[188:191]
  v_mfma_f32_16x16x32_bf16 v[204:207], v[72:75], v[80:83], v[204:207]
  v_mfma_f32_16x16x32_bf16 v[204:207], v[76:79], v[84:87], v[204:207]
  v_mfma_f32_16x16x32_bf16 v[208:211], v[72:75], v[88:91], v[208:211]
  v_mfma_f32_16x16x32_bf16 v[208:211], v[76:79], v[92:95], v[208:211]
  v_mfma_f32_16x16x32_bf16 v[212:215], v[72:75], v[96:99], v[212:215]
  v_mfma_f32_16x16x32_bf16 v[212:215], v[76:79], v[100:103], v[212:215]
  v_mfma_f32_16x16x32_bf16 v[216:219], v[72:75], v[104:107], v[216:219]
  s_setprio 2
  s_barrier
  v_mfma_f32_16x16x32_bf16 v[216:219], v[76:79], v[108:111], v[216:219]
  ds_read_b64_tr_b16 v[40:41], v1 offset:0
  s_add_u32 m0, s75, 81920
  s_nop 0
  buffer_load_dwordx4 v29, s[44:47], s74 offen offset:0 lds
  ds_read_b64_tr_b16 v[42:43], v1 offset:2560
  ds_read_b64_tr_b16 v[44:45], v1 offset:20480
  ds_read_b64_tr_b16 v[46:47], v1 offset:23040
  ds_read_b64_tr_b16 v[48:49], v2 offset:0
  buffer_load_dwordx4 v30, s[44:47], s74 offen offset:1024 lds
  ds_read_b64_tr_b16 v[50:51], v2 offset:2560
  ds_read_b64_tr_b16 v[52:53], v2 offset:20480
  ds_read_b64_tr_b16 v[54:55], v2 offset:23040
  ds_read_b64_tr_b16 v[56:57], v3 offset:0
  buffer_load_dwordx4 v31, s[44:47], s74 offen offset:2048 lds
  ds_read_b64_tr_b16 v[58:59], v3 offset:2560
  ds_read_b64_tr_b16 v[60:61], v3 offset:20480
  ds_read_b64_tr_b16 v[62:63], v3 offset:23040
  ds_read_b64_tr_b16 v[64:65], v4 offset:0
  buffer_load_dwordx4 v32, s[44:47], s74 offen offset:3072 lds
  ds_read_b64_tr_b16 v[66:67], v4 offset:2560
  ds_read_b64_tr_b16 v[68:69], v4 offset:20480
  ds_read_b64_tr_b16 v[70:71], v4 offset:23040
  ds_read_b128 v[80:83], v11 offset:8192
  s_add_u32 m0, m0, 4096
  s_nop 0
  buffer_load_dwordx4 v33, s[44:47], s74 offen offset:0 lds
  s_add_u32 s74, s74, 212992
  ds_read_b128 v[84:87], v12 offset:8192
  ds_read_b128 v[88:91], v11 offset:10240
  ds_read_b128 v[92:95], v12 offset:10240
  ds_read_b128 v[96:99], v11 offset:12288
  v_lshl_add_u32 v34, v240, 7, v15
  v_lshl_add_u32 v28, v24, 7, v14
  s_add_u32 m0, s76, 8192
  s_nop 0
  buffer_load_dwordx4 v28, s[32:35], 0 offen lds
  ds_read_b128 v[100:103], v12 offset:12288
  ds_read_b128 v[104:107], v11 offset:14336
  ds_read_b128 v[108:111], v12 offset:14336
  ds_read_b64_tr_b16 v[72:73], v5 offset:0
  s_add_u32 m0, m0, 1024
  s_nop 0
  buffer_load_dwordx4 v34, s[32:35], 0 offen lds
  ds_read_b64_tr_b16 v[74:75], v5 offset:2560
  ds_read_b64_tr_b16 v[76:77], v5 offset:20480
  ds_read_b64_tr_b16 v[78:79], v5 offset:23040
  s_waitcnt vmcnt(9) lgkmcnt(0)
  s_barrier
  s_setprio 0
  v_mfma_f32_16x16x32_bf16 v[140:143], v[40:43], v[80:83], v[140:143]
  v_mfma_f32_16x16x32_bf16 v[140:143], v[44:47], v[84:87], v[140:143]
  v_mfma_f32_16x16x32_bf16 v[144:147], v[40:43], v[88:91], v[144:147]
  v_mfma_f32_16x16x32_bf16 v[144:147], v[44:47], v[92:95], v[144:147]
  v_mfma_f32_16x16x32_bf16 v[148:151], v[40:43], v[96:99], v[148:151]
  v_mfma_f32_16x16x32_bf16 v[148:151], v[44:47], v[100:103], v[148:151]
  v_mfma_f32_16x16x32_bf16 v[152:155], v[40:43], v[104:107], v[152:155]
  v_mfma_f32_16x16x32_bf16 v[152:155], v[44:47], v[108:111], v[152:155]
  v_mfma_f32_16x16x32_bf16 v[168:171], v[48:51], v[104:107], v[168:171]
  v_mfma_f32_16x16x32_bf16 v[168:171], v[52:55], v[108:111], v[168:171]
  v_mfma_f32_16x16x32_bf16 v[164:167], v[48:51], v[96:99], v[164:167]
  v_mfma_f32_16x16x32_bf16 v[164:167], v[52:55], v[100:103], v[164:167]
  v_mfma_f32_16x16x32_bf16 v[160:163], v[48:51], v[88:91], v[160:163]
  v_mfma_f32_16x16x32_bf16 v[160:163], v[52:55], v[92:95], v[160:163]
  v_mfma_f32_16x16x32_bf16 v[156:159], v[48:51], v[80:83], v[156:159]
  v_mfma_f32_16x16x32_bf16 v[156:159], v[52:55], v[84:87], v[156:159]
  v_mfma_f32_16x16x32_bf16 v[172:175], v[56:59], v[80:83], v[172:175]
  v_mfma_f32_16x16x32_bf16 v[172:175], v[60:63], v[84:87], v[172:175]
  v_mfma_f32_16x16x32_bf16 v[176:179], v[56:59], v[88:91], v[176:179]
  v_mfma_f32_16x16x32_bf16 v[176:179], v[60:63], v[92:95], v[176:179]
  v_mfma_f32_16x16x32_bf16 v[180:183], v[56:59], v[96:99], v[180:183]
  v_mfma_f32_16x16x32_bf16 v[180:183], v[60:63], v[100:103], v[180:183]
  v_mfma_f32_16x16x32_bf16 v[184:187], v[56:59], v[104:107], v[184:187]
  v_mfma_f32_16x16x32_bf16 v[184:187], v[60:63], v[108:111], v[184:187]
  v_mfma_f32_16x16x32_bf16 v[200:203], v[64:67], v[104:107], v[200:203]
  v_mfma_f32_16x16x32_bf16 v[200:203], v[68:71], v[108:111], v[200:203]
  v_mfma_f32_16x16x32_bf16 v[196:199], v[64:67], v[96:99], v[196:199]
  v_mfma_f32_16x16x32_bf16 v[196:199], v[68:71], v[100:103], v[196:199]
  v_mfma_f32_16x16x32_bf16 v[192:195], v[64:67], v[88:91], v[192:195]
  v_mfma_f32_16x16x32_bf16 v[192:195], v[68:71], v[92:95], v[192:195]
  v_mfma_f32_16x16x32_bf16 v[188:191], v[64:67], v[80:83], v[188:191]
  v_mfma_f32_16x16x32_bf16 v[188:191], v[68:71], v[84:87], v[188:191]
  v_mfma_f32_16x16x32_bf16 v[204:207], v[72:75], v[80:83], v[204:207]
  v_mfma_f32_16x16x32_bf16 v[204:207], v[76:79], v[84:87], v[204:207]
  v_mfma_f32_16x16x32_bf16 v[208:211], v[72:75], v[88:91], v[208:211]
  v_mfma_f32_16x16x32_bf16 v[208:211], v[76:79], v[92:95], v[208:211]
  v_mfma_f32_16x16x32_bf16 v[212:215], v[72:75], v[96:99], v[212:215]
  v_mfma_f32_16x16x32_bf16 v[212:215], v[76:79], v[100:103], v[212:215]
  v_mfma_f32_16x16x32_bf16 v[216:219], v[72:75], v[104:107], v[216:219]
  s_setprio 2
  s_barrier
  v_mfma_f32_16x16x32_bf16 v[216:219], v[76:79], v[108:111], v[216:219]
  ds_read_b64_tr_b16 v[40:41], v1 offset:40960
  s_add_u32 m0, s75, 0
  s_nop 0
  buffer_load_dwordx4 v29, s[44:47], s74 offen offset:0 lds
  ds_read_b64_tr_b16 v[42:43], v1 offset:43520
  ds_read_b64_tr_b16 v[44:45], v6 offset:0
  ds_read_b64_tr_b16 v[46:47], v6 offset:2560
  ds_read_b64_tr_b16 v[48:49], v2 offset:40960
  buffer_load_dwordx4 v30, s[44:47], s74 offen offset:1024 lds
  ds_read_b64_tr_b16 v[50:51], v2 offset:43520
  ds_read_b64_tr_b16 v[52:53], v7 offset:0
  ds_read_b64_tr_b16 v[54:55], v7 offset:2560
  ds_read_b64_tr_b16 v[56:57], v3 offset:40960
  buffer_load_dwordx4 v31, s[44:47], s74 offen offset:2048 lds
  ds_read_b64_tr_b16 v[58:59], v3 offset:43520
  ds_read_b64_tr_b16 v[60:61], v8 offset:0
  ds_read_b64_tr_b16 v[62:63], v8 offset:2560
  ds_read_b64_tr_b16 v[64:65], v4 offset:40960
  buffer_load_dwordx4 v32, s[44:47], s74 offen offset:3072 lds
  ds_read_b64_tr_b16 v[66:67], v4 offset:43520
  ds_read_b64_tr_b16 v[68:69], v9 offset:0
  ds_read_b64_tr_b16 v[70:71], v9 offset:2560
  ds_read_b128 v[80:83], v11 offset:0
  s_add_u32 m0, m0, 4096
  s_nop 0
  buffer_load_dwordx4 v33, s[44:47], s74 offen offset:0 lds
  s_add_u32 s74, s74, 212992
  ds_read_b128 v[84:87], v12 offset:0
  ds_read_b128 v[88:91], v11 offset:2048
  ds_read_b128 v[92:95], v12 offset:2048
  ds_read_b128 v[96:99], v11 offset:4096
  v_lshl_add_u32 v34, v241, 7, v15
  v_lshl_add_u32 v28, v25, 7, v14
  s_add_u32 m0, s76, 0
  s_nop 0
  buffer_load_dwordx4 v28, s[32:35], 0 offen lds
  ds_read_b128 v[100:103], v12 offset:4096
  ds_read_b128 v[104:107], v11 offset:6144
  ds_read_b128 v[108:111], v12 offset:6144
  ds_read_b64_tr_b16 v[72:73], v5 offset:40960
  s_add_u32 m0, m0, 1024
  s_nop 0
  buffer_load_dwordx4 v34, s[32:35], 0 offen lds
  ds_read_b64_tr_b16 v[74:75], v5 offset:43520
  ds_read_b64_tr_b16 v[76:77], v10 offset:0
  ds_read_b64_tr_b16 v[78:79], v10 offset:2560
  s_mov_b32 m0, 156288
  s_mov_b32 exec_hi, 0xff
  buffer_load_dwordx4 v37, s[52:55], s77 offen lds
  s_mov_b64 exec, -1
  s_waitcnt vmcnt(8) lgkmcnt(0)
  s_barrier
  s_setprio 0
  v_mfma_f32_16x16x32_bf16 v[140:143], v[40:43], v[80:83], v[140:143]
  v_mfma_f32_16x16x32_bf16 v[140:143], v[44:47], v[84:87], v[140:143]
  v_mfma_f32_16x16x32_bf16 v[144:147], v[40:43], v[88:91], v[144:147]
  v_mfma_f32_16x16x32_bf16 v[144:147], v[44:47], v[92:95], v[144:147]
  v_mfma_f32_16x16x32_bf16 v[148:151], v[40:43], v[96:99], v[148:151]
  v_mfma_f32_16x16x32_bf16 v[148:151], v[44:47], v[100:103], v[148:151]
  v_mfma_f32_16x16x32_bf16 v[152:155], v[40:43], v[104:107], v[152:155]
  v_mfma_f32_16x16x32_bf16 v[152:155], v[44:47], v[108:111], v[152:155]
  v_mfma_f32_16x16x32_bf16 v[168:171], v[48:51], v[104:107], v[168:171]
  v_mfma_f32_16x16x32_bf16 v[168:171], v[52:55], v[108:111], v[168:171]
  v_mfma_f32_16x16x32_bf16 v[164:167], v[48:51], v[96:99], v[164:167]
  v_mfma_f32_16x16x32_bf16 v[164:167], v[52:55], v[100:103], v[164:167]
  v_mfma_f32_16x16x32_bf16 v[160:163], v[48:51], v[88:91], v[160:163]
  v_mfma_f32_16x16x32_bf16 v[160:163], v[52:55], v[92:95], v[160:163]
  v_mfma_f32_16x16x32_bf16 v[156:159], v[48:51], v[80:83], v[156:159]
  v_mfma_f32_16x16x32_bf16 v[156:159], v[52:55], v[84:87], v[156:159]
  v_mfma_f32_16x16x32_bf16 v[172:175], v[56:59], v[80:83], v[172:175]
  v_mfma_f32_16x16x32_bf16 v[172:175], v[60:63], v[84:87], v[172:175]
  v_mfma_f32_16x16x32_bf16 v[176:179], v[56:59], v[88:91], v[176:179]
  v_mfma_f32_16x16x32_bf16 v[176:179], v[60:63], v[92:95], v[176:179]
  v_mfma_f32_16x16x32_bf16 v[180:183], v[56:59], v[96:99], v[180:183]
  v_mfma_f32_16x16x32_bf16 v[180:183], v[60:63], v[100:103], v[180:183]
  v_mfma_f32_16x16x32_bf16 v[184:187], v[56:59], v[104:107], v[184:187]
  v_mfma_f32_16x16x32_bf16 v[184:187], v[60:63], v[108:111], v[184:187]
  v_mfma_f32_16x16x32_bf16 v[200:203], v[64:67], v[104:107], v[200:203]
  v_mfma_f32_16x16x32_bf16 v[200:203], v[68:71], v[108:111], v[200:203]
  v_mfma_f32_16x16x32_bf16 v[196:199], v[64:67], v[96:99], v[196:199]
  v_mfma_f32_16x16x32_bf16 v[196:199], v[68:71], v[100:103], v[196:199]
  v_mfma_f32_16x16x32_bf16 v[192:195], v[64:67], v[88:91], v[192:195]
  v_mfma_f32_16x16x32_bf16 v[192:195], v[68:71], v[92:95], v[192:195]
  v_mfma_f32_16x16x32_bf16 v[188:191], v[64:67], v[80:83], v[188:191]
  v_mfma_f32_16x16x32_bf16 v[188:191], v[68:71], v[84:87], v[188:191]
  v_mfma_f32_16x16x32_bf16 v[204:207], v[72:75], v[80:83], v[204:207]
  v_mfma_f32_16x16x32_bf16 v[204:207], v[76:79], v[84:87], v[204:207]
  v_mfma_f32_16x16x32_bf16 v[208:211], v[72:75], v[88:91], v[208:211]
  v_mfma_f32_16x16x32_bf16 v[208:211], v[76:79], v[92:95], v[208:211]
  v_mfma_f32_16x16x32_bf16 v[212:215], v[72:75], v[96:99], v[212:215]
  v_mfma_f32_16x16x32_bf16 v[212:215], v[76:79], v[100:103], v[212:215]
  v_mfma_f32_16x16x32_bf16 v[216:219], v[72:75], v[104:107], v[216:219]
  s_setprio 2
  s_barrier
  v_mfma_f32_16x16x32_bf16 v[216:219], v[76:79], v[108:111], v[216:219]
  ds_read_b64_tr_b16 v[40:41], v6 offset:20480
  s_add_u32 m0, s75, 40960
  s_nop 0
  buffer_load_dwordx4 v29, s[44:47], s74 offen offset:0 lds
  ds_read_b64_tr_b16 v[42:43], v6 offset:23040
  ds_read_b64_tr_b16 v[44:45], v6 offset:40960
  ds_read_b64_tr_b16 v[46:47], v6 offset:43520
  ds_read_b64_tr_b16 v[48:49], v7 offset:20480
  buffer_load_dwordx4 v30, s[44:47], s74 offen offset:1024 lds
  ds_read_b64_tr_b16 v[50:51], v7 offset:23040
  ds_read_b64_tr_b16 v[52:53], v7 offset:40960
  ds_read_b64_tr_b16 v[54:55], v7 offset:43520
  ds_read_b64_tr_b16 v[56:57], v8 offset:20480
  buffer_load_dwordx4 v31, s[44:47], s74 offen offset:2048 lds
  ds_read_b64_tr_b16 v[58:59], v8 offset:23040
  ds_read_b64_tr_b16 v[60:61], v8 offset:40960
  ds_read_b64_tr_b16 v[62:63], v8 offset:43520
  ds_read_b64_tr_b16 v[64:65], v9 offset:20480
  buffer_load_dwordx4 v32, s[44:47], s74 offen offset:3072 lds
  ds_read_b64_tr_b16 v[66:67], v9 offset:23040
  ds_read_b64_tr_b16 v[68:69], v9 offset:40960
  ds_read_b64_tr_b16 v[70:71], v9 offset:43520
  ds_read_b128 v[80:83], v11 offset:8192
  s_add_u32 m0, m0, 4096
  s_nop 0
  buffer_load_dwordx4 v33, s[44:47], s74 offen offset:0 lds
  s_add_u32 s74, s74, 212992
  ds_read_b128 v[84:87], v12 offset:8192
  ds_read_b128 v[88:91], v11 offset:10240
  ds_read_b128 v[92:95], v12 offset:10240
  ds_read_b128 v[96:99], v11 offset:12288
  v_lshl_add_u32 v34, v242, 7, v15
  v_lshl_add_u32 v28, v26, 7, v14
  s_add_u32 m0, s76, 8192
  s_nop 0
  buffer_load_dwordx4 v28, s[32:35], 0 offen lds
  ds_read_b128 v[100:103], v12 offset:12288
  ds_read_b128 v[104:107], v11 offset:14336
  ds_read_b128 v[108:111], v12 offset:14336
  ds_read_b64_tr_b16 v[72:73], v10 offset:20480
  s_add_u32 m0, m0, 1024
  s_nop 0
  buffer_load_dwordx4 v34, s[32:35], 0 offen lds
  ds_read_b64_tr_b16 v[74:75], v10 offset:23040
  ds_read_b64_tr_b16 v[76:77], v10 offset:40960
  ds_read_b64_tr_b16 v[78:79], v10 offset:43520
  buffer_load_dwordx3 v[24:26], v13, s[28:31], s73 offen offset:0
  buffer_load_dwordx3 v[240:242], v13, s[28:31], s73 offen offset:832
  s_add_u32 s73, s73, 12
  s_waitcnt vmcnt(10) lgkmcnt(0)
  s_barrier
  s_setprio 0
  v_mfma_f32_16x16x32_bf16 v[140:143], v[40:43], v[80:83], v[140:143]
  s_add_u32 s72, s72, 1
  v_mfma_f32_16x16x32_bf16 v[140:143], v[44:47], v[84:87], v[140:143]
  v_mfma_f32_16x16x32_bf16 v[144:147], v[40:43], v[88:91], v[144:147]
  v_mfma_f32_16x16x32_bf16 v[144:147], v[44:47], v[92:95], v[144:147]
  v_mfma_f32_16x16x32_bf16 v[148:151], v[40:43], v[96:99], v[148:151]
  v_mfma_f32_16x16x32_bf16 v[148:151], v[44:47], v[100:103], v[148:151]
  v_mfma_f32_16x16x32_bf16 v[152:155], v[40:43], v[104:107], v[152:155]
  v_mfma_f32_16x16x32_bf16 v[152:155], v[44:47], v[108:111], v[152:155]
  v_mfma_f32_16x16x32_bf16 v[168:171], v[48:51], v[104:107], v[168:171]
  v_mfma_f32_16x16x32_bf16 v[168:171], v[52:55], v[108:111], v[168:171]
  v_mfma_f32_16x16x32_bf16 v[164:167], v[48:51], v[96:99], v[164:167]
  v_mfma_f32_16x16x32_bf16 v[164:167], v[52:55], v[100:103], v[164:167]
  v_mfma_f32_16x16x32_bf16 v[160:163], v[48:51], v[88:91], v[160:163]
  v_mfma_f32_16x16x32_bf16 v[160:163], v[52:55], v[92:95], v[160:163]
  v_mfma_f32_16x16x32_bf16 v[156:159], v[48:51], v[80:83], v[156:159]
  v_mfma_f32_16x16x32_bf16 v[156:159], v[52:55], v[84:87], v[156:159]
  v_mfma_f32_16x16x32_bf16 v[172:175], v[56:59], v[80:83], v[172:175]
  v_mfma_f32_16x16x32_bf16 v[172:175], v[60:63], v[84:87], v[172:175]
  v_mfma_f32_16x16x32_bf16 v[176:179], v[56:59], v[88:91], v[176:179]
  v_mfma_f32_16x16x32_bf16 v[176:179], v[60:63], v[92:95], v[176:179]
  s_cmp_lt_u32 s72, 4
  v_mfma_f32_16x16x32_bf16 v[180:183], v[56:59], v[96:99], v[180:183]
  v_mfma_f32_16x16x32_bf16 v[180:183], v[60:63], v[100:103], v[180:183]
  v_mfma_f32_16x16x32_bf16 v[184:187], v[56:59], v[104:107], v[184:187]
  v_mfma_f32_16x16x32_bf16 v[184:187], v[60:63], v[108:111], v[184:187]
  v_mfma_f32_16x16x32_bf16 v[200:203], v[64:67], v[104:107], v[200:203]
  v_mfma_f32_16x16x32_bf16 v[200:203], v[68:71], v[108:111], v[200:203]
  v_mfma_f32_16x16x32_bf16 v[196:199], v[64:67], v[96:99], v[196:199]
  v_mfma_f32_16x16x32_bf16 v[196:199], v[68:71], v[100:103], v[196:199]
  v_mfma_f32_16x16x32_bf16 v[192:195], v[64:67], v[88:91], v[192:195]
  v_mfma_f32_16x16x32_bf16 v[192:195], v[68:71], v[92:95], v[192:195]
  v_mfma_f32_16x16x32_bf16 v[188:191], v[64:67], v[80:83], v[188:191]
  v_mfma_f32_16x16x32_bf16 v[188:191], v[68:71], v[84:87], v[188:191]
  v_mfma_f32_16x16x32_bf16 v[204:207], v[72:75], v[80:83], v[204:207]
  v_mfma_f32_16x16x32_bf16 v[204:207], v[76:79], v[84:87], v[204:207]
  v_mfma_f32_16x16x32_bf16 v[208:211], v[72:75], v[88:91], v[208:211]
  v_mfma_f32_16x16x32_bf16 v[208:211], v[76:79], v[92:95], v[208:211]
  v_mfma_f32_16x16x32_bf16 v[212:215], v[72:75], v[96:99], v[212:215]
  v_mfma_f32_16x16x32_bf16 v[212:215], v[76:79], v[100:103], v[212:215]
  v_mfma_f32_16x16x32_bf16 v[216:219], v[72:75], v[104:107], v[216:219]
  s_setprio 2
  s_barrier
  v_mfma_f32_16x16x32_bf16 v[216:219], v[76:79], v[108:111], v[216:219]
  s_cbranch_scc1 L_dnn_loop1
  ds_read_b64_tr_b16 v[40:41], v1 offset:0
  ds_read_b64_tr_b16 v[42:43], v1 offset:2560
  ds_read_b64_tr_b16 v[44:45], v1 offset:20480
  ds_read_b64_tr_b16 v[46:47], v1 offset:23040
  ds_read_b64_tr_b16 v[48:49], v2 offset:0
  ds_read_b64_tr_b16 v[50:51], v2 offset:2560
  ds_read_b64_tr_b16 v[52:53], v2 offset:20480
  ds_read_b64_tr_b16 v[54:55], v2 offset:23040
  ds_read_b64_tr_b16 v[56:57], v3 offset:0
  ds_read_b64_tr_b16 v[58:59], v3 offset:2560
  ds_read_b64_tr_b16 v[60:61], v3 offset:20480
  ds_read_b64_tr_b16 v[62:63], v3 offset:23040
  ds_read_b64_tr_b16 v[64:65], v4 offset:0
  ds_read_b64_tr_b16 v[66:67], v4 offset:2560
  ds_read_b64_tr_b16 v[68:69], v4 offset:20480
  ds_read_b64_tr_b16 v[70:71], v4 offset:23040
  ds_read_b128 v[80:83], v11 offset:0
  ds_read_b128 v[84:87], v12 offset:0
  ds_read_b128 v[88:91], v11 offset:2048
  ds_read_b128 v[92:95], v12 offset:2048
  ds_read_b128 v[96:99], v11 offset:4096
  ds_read_b128 v[100:103], v12 offset:4096
  ds_read_b128 v[104:107], v11 offset:6144
  ds_read_b128 v[108:111], v12 offset:6144
  ds_read_b64_tr_b16 v[72:73], v5 offset:0
  ds_read_b64_tr_b16 v[74:75], v5 offset:2560
  ds_read_b64_tr_b16 v[76:77], v5 offset:20480
  ds_read_b64_tr_b16 v[78:79], v5 offset:23040
  ds_read_b64 v[220:221], v35 offset:640
  ds_read_b64 v[222:223], v35 offset:672
  ds_read_b64 v[224:225], v35 offset:704
  ds_read_b64 v[226:227], v35 offset:736
  ds_read_b64 v[228:229], v35 offset:768
  s_waitcnt vmcnt(2) lgkmcnt(0)
  s_barrier
  s_setprio 0
  v_mfma_f32_16x16x32_bf16 v[140:143], v[40:43], v[80:83], v[140:143]
  v_mov_b32 v232, 0xc0135761
  v_mov_b32 v233, 0xc0135761
  v_mfma_f32_16x16x32_bf16 v[140:143], v[44:47], v[84:87], v[140:143]
  v_mov_b32 v234, 0xbdd2d3e8
  v_mov_b32 v235, 0xbdd2d3e8
  v_mfma_f32_16x16x32_bf16 v[144:147], v[40:43], v[88:91], v[144:147]
  v_mov_b32 v236, 0xc2b40000
  v_mov_b32 v237, 0xc2b40000
  v_mfma_f32_16x16x32_bf16 v[144:147], v[44:47], v[92:95], v[144:147]
  v_lshlrev_b32 v112, 16, v220
  v_and_b32 v113, 0xffff0000, v220
  v_mfma_f32_16x16x32_bf16 v[148:151], v[40:43], v[96:99], v[148:151]
  v_lshlrev_b32 v114, 16, v221
  v_and_b32 v115, 0xffff0000, v221
  v_mfma_f32_16x16x32_bf16 v[148:151], v[44:47], v[100:103], v[148:151]
  v_lshlrev_b32 v116, 16, v222
  v_and_b32 v117, 0xffff0000, v222
  v_mfma_f32_16x16x32_bf16 v[152:155], v[40:43], v[104:107], v[152:155]
  v_lshlrev_b32 v118, 16, v223
  v_and_b32 v119, 0xffff0000, v223
  v_mfma_f32_16x16x32_bf16 v[152:155], v[44:47], v[108:111], v[152:155]
  v_lshlrev_b32 v120, 16, v224
  v_and_b32 v121, 0xffff0000, v224
  v_mfma_f32_16x16x32_bf16 v[168:171], v[48:51], v[104:107], v[168:171]
  v_lshlrev_b32 v122, 16, v225
  v_and_b32 v123, 0xffff0000, v225
  v_mfma_f32_16x16x32_bf16 v[168:171], v[52:55], v[108:111], v[168:171]
  v_lshlrev_b32 v124, 16, v226
  v_mfma_f32_16x16x32_bf16 v[164:167], v[48:51], v[96:99], v[164:167]
  v_and_b32 v125, 0xffff0000, v226
  v_lshlrev_b32 v126, 16, v227
  v_mfma_f32_16x16x32_bf16 v[164:167], v[52:55], v[100:103], v[164:167]
  v_and_b32 v127, 0xffff0000, v227
  v_lshlrev_b32 v128, 16, v228
  v_mfma_f32_16x16x32_bf16 v[160:163], v[48:51], v[88:91], v[160:163]
  v_and_b32 v129, 0xffff0000, v228
  v_lshlrev_b32 v130, 16, v229
  v_mfma_f32_16x16x32_bf16 v[160:163], v[52:55], v[92:95], v[160:163]
  v_and_b32 v131, 0xffff0000, v229
  v_mov_b32 v239, 0x21800000
  v_mfma_f32_16x16x32_bf16 v[156:159], v[48:51], v[80:83], v[156:159]
  v_mov_b32 v238, 0x30800000
  v_max3_f32 v239, v239, abs(v112), abs(v113)
  v_mfma_f32_16x16x32_bf16 v[156:159], v[52:55], v[84:87], v[156:159]
  v_max3_f32 v239, v239, abs(v114), abs(v115)
  v_max3_f32 v239, v239, abs(v116), abs(v117)
  v_mfma_f32_16x16x32_bf16 v[172:175], v[56:59], v[80:83], v[172:175]
  v_max3_f32 v239, v239, abs(v118), abs(v119)
  v_max3_f32 v239, v239, abs(v120), abs(v121)
  v_mfma_f32_16x16x32_bf16 v[172:175], v[60:63], v[84:87], v[172:175]
  v_max3_f32 v239, v239, abs(v122), abs(v123)
  v_max3_f32 v239, v239, abs(v124), abs(v125)
  v_mfma_f32_16x16x32_bf16 v[176:179], v[56:59], v[88:91], v[176:179]
  v_max3_f32 v239, v239, abs(v126), abs(v127)
  v_mfma_f32_16x16x32_bf16 v[176:179], v[60:63], v[92:95], v[176:179]
  v_max3_f32 v239, v239, abs(v128), abs(v129)
  v_max3_f32 v239, v239, abs(v130), abs(v131)
  v_mfma_f32_16x16x32_bf16 v[180:183], v[56:59], v[96:99], v[180:183]
  v_and_b32 v239, 0x7f800000, v239
  v_mul_f32 v239, 0x22000000, v239
  v_mfma_f32_16x16x32_bf16 v[180:183], v[60:63], v[100:103], v[180:183]
  v_rcp_f32 v112, v112
  v_mfma_f32_16x16x32_bf16 v[184:187], v[56:59], v[104:107], v[184:187]
  v_rcp_f32 v113, v113
  v_mfma_f32_16x16x32_bf16 v[184:187], v[60:63], v[108:111], v[184:187]
  v_rcp_f32 v114, v114
  v_mfma_f32_16x16x32_bf16 v[200:203], v[64:67], v[104:107], v[200:203]
  v_rcp_f32 v115, v115
  v_mfma_f32_16x16x32_bf16 v[200:203], v[68:71], v[108:111], v[200:203]
  v_rcp_f32 v116, v116
  v_mfma_f32_16x16x32_bf16 v[196:199], v[64:67], v[96:99], v[196:199]
  v_rcp_f32 v117, v117
  v_mfma_f32_16x16x32_bf16 v[196:199], v[68:71], v[100:103], v[196:199]
  v_rcp_f32 v118, v118
  v_mfma_f32_16x16x32_bf16 v[192:195], v[64:67], v[88:91], v[192:195]
  v_rcp_f32 v119, v119
  v_mfma_f32_16x16x32_bf16 v[192:195], v[68:71], v[92:95], v[192:195]
  v_rcp_f32 v120, v120
  v_mfma_f32_16x16x32_bf16 v[188:191], v[64:67], v[80:83], v[188:191]
  v_rcp_f32 v121, v121
  v_mfma_f32_16x16x32_bf16 v[188:191], v[68:71], v[84:87], v[188:191]
  v_rcp_f32 v122, v122
  v_mfma_f32_16x16x32_bf16 v[204:207], v[72:75], v[80:83], v[204:207]
  v_rcp_f32 v123, v123
  v_mfma_f32_16x16x32_bf16 v[204:207], v[76:79], v[84:87], v[204:207]
  v_rcp_f32 v124, v124
  v_mfma_f32_16x16x32_bf16 v[208:211], v[72:75], v[88:91], v[208:211]
  v_rcp_f32 v125, v125
  v_mfma_f32_16x16x32_bf16 v[208:211], v[76:79], v[92:95], v[208:211]
  v_rcp_f32 v126, v126
  v_mfma_f32_16x16x32_bf16 v[212:215], v[72:75], v[96:99], v[212:215]
  v_rcp_f32 v127, v127
  v_mfma_f32_16x16x32_bf16 v[212:215], v[76:79], v[100:103], v[212:215]
  v_mfma_f32_16x16x32_bf16 v[216:219], v[72:75], v[104:107], v[216:219]
  s_setprio 2
  s_barrier
  v_mfma_f32_16x16x32_bf16 v[216:219], v[76:79], v[108:111], v[216:219]
  ds_read_b64_tr_b16 v[40:41], v1 offset:40960
  ds_read_b64_tr_b16 v[42:43], v1 offset:43520
  ds_read_b64_tr_b16 v[44:45], v6 offset:0
  ds_read_b64_tr_b16 v[46:47], v6 offset:2560
  ds_read_b64_tr_b16 v[48:49], v2 offset:40960
  ds_read_b64_tr_b16 v[50:51], v2 offset:43520
  ds_read_b64_tr_b16 v[52:53], v7 offset:0
  ds_read_b64_tr_b16 v[54:55], v7 offset:2560
  ds_read_b64_tr_b16 v[56:57], v3 offset:40960
  ds_read_b64_tr_b16 v[58:59], v3 offset:43520
  ds_read_b64_tr_b16 v[60:61], v8 offset:0
  ds_read_b64_tr_b16 v[62:63], v8 offset:2560
  ds_read_b64_tr_b16 v[64:65], v4 offset:40960
  ds_read_b64_tr_b16 v[66:67], v4 offset:43520
  ds_read_b64_tr_b16 v[68:69], v9 offset:0
  ds_read_b64_tr_b16 v[70:71], v9 offset:2560
  ds_read_b128 v[80:83], v11 offset:8192
  ds_read_b128 v[84:87], v12 offset:8192
  ds_read_b128 v[88:91], v11 offset:10240
  ds_read_b128 v[92:95], v12 offset:10240
  ds_read_b128 v[96:99], v11 offset:12288
  ds_read_b128 v[100:103], v12 offset:12288
  ds_read_b128 v[104:107], v11 offset:14336
  ds_read_b128 v[108:111], v12 offset:14336
  ds_read_b64_tr_b16 v[72:73], v5 offset:40960
  ds_read_b64_tr_b16 v[74:75], v5 offset:43520
  ds_read_b64_tr_b16 v[76:77], v10 offset:0
  ds_read_b64_tr_b16 v[78:79], v10 offset:2560
  s_waitcnt lgkmcnt(0)
  s_barrier
  v_mfma_f32_16x16x32_bf16 v[140:143], v[40:43], v[80:83], v[140:143]
  v_rcp_f32 v128, v128
  v_mfma_f32_16x16x32_bf16 v[140:143], v[44:47], v[84:87], v[140:143]
  v_rcp_f32 v129, v129
  v_mfma_f32_16x16x32_bf16 v[144:147], v[40:43], v[88:91], v[144:147]
  v_rcp_f32 v130, v130
  v_mfma_f32_16x16x32_bf16 v[144:147], v[44:47], v[92:95], v[144:147]
  v_rcp_f32 v131, v131
  v_mfma_f32_16x16x32_bf16 v[148:151], v[40:43], v[96:99], v[148:151]
  v_mul_f32 v112, v239, v112
  v_mfma_f32_16x16x32_bf16 v[148:151], v[44:47], v[100:103], v[148:151]
  v_mul_f32 v113, v239, v113
  v_mul_f32 v114, v239, v114
  v_mfma_f32_16x16x32_bf16 v[152:155], v[40:43], v[104:107], v[152:155]
  v_mul_f32 v115, v239, v115
  v_mul_f32 v116, v239, v116
  v_mfma_f32_16x16x32_bf16 v[152:155], v[44:47], v[108:111], v[152:155]
  v_mul_f32 v117, v239, v117
  v_mul_f32 v118, v239, v118
  v_mfma_f32_16x16x32_bf16 v[168:171], v[48:51], v[104:107], v[168:171]
  v_mul_f32 v119, v239, v119
  v_mul_f32 v120, v239, v120
  v_mfma_f32_16x16x32_bf16 v[168:171], v[52:55], v[108:111], v[168:171]
  v_mul_f32 v121, v239, v121
  v_mfma_f32_16x16x32_bf16 v[164:167], v[48:51], v[96:99], v[164:167]
  v_mul_f32 v122, v239, v122
  v_mul_f32 v123, v239, v123
  v_mfma_f32_16x16x32_bf16 v[164:167], v[52:55], v[100:103], v[164:167]
  v_mul_f32 v124, v239, v124
  v_mul_f32 v125, v239, v125
  v_mfma_f32_16x16x32_bf16 v[160:163], v[48:51], v[88:91], v[160:163]
  v_mul_f32 v126, v239, v126
  v_mul_f32 v127, v239, v127
  v_mfma_f32_16x16x32_bf16 v[160:163], v[52:55], v[92:95], v[160:163]
  v_mul_f32 v128, v239, v128
  v_mul_f32 v129, v239, v129
  v_mfma_f32_16x16x32_bf16 v[156:159], v[48:51], v[80:83], v[156:159]
  v_mul_f32 v130, v239, v130
  v_mfma_f32_16x16x32_bf16 v[156:159], v[52:55], v[84:87], v[156:159]
  v_mul_f32 v131, v239, v131
  v_med3_f32 v112, v112, -v238, v238
  v_mfma_f32_16x16x32_bf16 v[172:175], v[56:59], v[80:83], v[172:175]
  v_med3_f32 v113, v113, -v238, v238
  v_med3_f32 v114, v114, -v238, v238
  v_mfma_f32_16x16x32_bf16 v[172:175], v[60:63], v[84:87], v[172:175]
  v_med3_f32 v115, v115, -v238, v238
  v_med3_f32 v116, v116, -v238, v238
  v_mfma_f32_16x16x32_bf16 v[176:179], v[56:59], v[88:91], v[176:179]
  v_med3_f32 v117, v117, -v238, v238
  v_mfma_f32_16x16x32_bf16 v[176:179], v[60:63], v[92:95], v[176:179]
  v_med3_f32 v118, v118, -v238, v238
  v_med3_f32 v119, v119, -v238, v238
  v_mfma_f32_16x16x32_bf16 v[180:183], v[56:59], v[96:99], v[180:183]
  v_med3_f32 v120, v120, -v238, v238
  v_med3_f32 v121, v121, -v238, v238
  v_mfma_f32_16x16x32_bf16 v[180:183], v[60:63], v[100:103], v[180:183]
  v_med3_f32 v122, v122, -v238, v238
  v_med3_f32 v123, v123, -v238, v238
  v_mfma_f32_16x16x32_bf16 v[184:187], v[56:59], v[104:107], v[184:187]
  v_med3_f32 v124, v124, -v238, v238
  v_med3_f32 v125, v125, -v238, v238
  v_mfma_f32_16x16x32_bf16 v[184:187], v[60:63], v[108:111], v[184:187]
  v_med3_f32 v126, v126, -v238, v238
  v_mfma_f32_16x16x32_bf16 v[200:203], v[64:67], v[104:107], v[200:203]
  v_med3_f32 v127, v127, -v238, v238
  v_med3_f32 v128, v128, -v238, v238
  v_mfma_f32_16x16x32_bf16 v[200:203], v[68:71], v[108:111], v[200:203]
  v_med3_f32 v129, v129, -v238, v238
  v_med3_f32 v130, v130, -v238, v238
  v_mfma_f32_16x16x32_bf16 v[196:199], v[64:67], v[96:99], v[196:199]
  v_med3_f32 v131, v131, -v238, v238
  v_mul_f32 v132, 0x6c800000, v112
  v_mfma_f32_16x16x32_bf16 v[196:199], v[68:71], v[100:103], v[196:199]
  v_mul_f32 v133, 0x6c800000, v113
  v_mul_f32 v134, 0x6c800000, v114
  v_mfma_f32_16x16x32_bf16 v[192:195], v[64:67], v[88:91], v[192:195]
  v_mul_f32 v135, 0x6c800000, v115
  v_mfma_f32_16x16x32_bf16 v[192:195], v[68:71], v[92:95], v[192:195]
  v_mul_f32 v136, 0x6c800000, v116
  v_mul_f32 v137, 0x6c800000, v117
  v_mfma_f32_16x16x32_bf16 v[188:191], v[64:67], v[80:83], v[188:191]
  v_mul_f32 v138, 0x6c800000, v118
  v_mul_f32 v139, 0x6c800000, v119
  v_mfma_f32_16x16x32_bf16 v[188:191], v[68:71], v[84:87], v[188:191]
  v_mul_f32 v220, 0x6c800000, v120
  v_mul_f32 v221, 0x6c800000, v121
  v_mfma_f32_16x16x32_bf16 v[204:207], v[72:75], v[80:83], v[204:207]
  v_mul_f32 v222, 0x6c800000, v122
  v_mul_f32 v223, 0x6c800000, v123
  v_mfma_f32_16x16x32_bf16 v[204:207], v[76:79], v[84:87], v[204:207]
  v_mul_f32 v224, 0x6c800000, v124
  v_mfma_f32_16x16x32_bf16 v[208:211], v[72:75], v[88:91], v[208:211]
  v_mul_f32 v225, 0x6c800000, v125
  v_mul_f32 v226, 0x6c800000, v126
  v_mfma_f32_16x16x32_bf16 v[208:211], v[76:79], v[92:95], v[208:211]
  v_mul_f32 v227, 0x6c800000, v127
  v_mul_f32 v228, 0x6c800000, v128
  v_mfma_f32_16x16x32_bf16 v[212:215], v[72:75], v[96:99], v[212:215]
  v_mul_f32 v229, 0x6c800000, v129
  v_mul_f32 v230, 0x6c800000, v130
  v_mfma_f32_16x16x32_bf16 v[212:215], v[76:79], v[100:103], v[212:215]
  v_mul_f32 v231, 0x6c800000, v131
  v_mfma_f32_16x16x32_bf16 v[216:219], v[72:75], v[104:107], v[216:219]
  v_mfma_f32_16x16x32_bf16 v[216:219], v[76:79], v[108:111], v[216:219]
  s_setprio 0
L_epi:
  s_lshl_b32 s69, s27, 11
  s_and_b32 s71, s26, 3
  s_lshl_b32 s71, s71, 9
  s_add_u32 s69, s69, s71
  s_lshr_b32 s68, s26, 2
  s_lshl_b32 s68, s68, 14
  s_add_u32 s69, s69, s68
  v_lshlrev_b32 v3, 3, v0
  v_add_u32 v2, 156928, v3
  v_pk_mul_f32 v[40:41], v[140:141], v[140:141]
  v_pk_mul_f32 v[42:43], v[142:143], v[142:143]
  v_pk_mul_f32 v[46:47], v[144:145], v[144:145]
  v_pk_mul_f32 v[48:49], v[146:147], v[146:147]
  v_pk_mul_f32 v[52:53], v[148:149], v[148:149]
  v_pk_mul_f32 v[54:55], v[150:151], v[150:151]
  v_pk_mul_f32 v[58:59], v[152:153], v[152:153]
  v_pk_mul_f32 v[60:61], v[154:155], v[154:155]
  v_pk_fma_f32 v[40:41], v[40:41], v[234:235], v[232:233]
  v_pk_fma_f32 v[42:43], v[42:43], v[234:235], v[232:233]
  v_pk_fma_f32 v[46:47], v[46:47], v[234:235], v[232:233]
  v_pk_fma_f32 v[48:49], v[48:49], v[234:235], v[232:233]
  v_pk_fma_f32 v[52:53], v[52:53], v[234:235], v[232:233]
  v_pk_fma_f32 v[54:55], v[54:55], v[234:235], v[232:233]
  v_pk_fma_f32 v[58:59], v[58:59], v[234:235], v[232:233]
  v_pk_fma_f32 v[60:61], v[60:61], v[234:235], v[232:233]
  v_pk_fma_f32 v[40:41], v[40:41], v[140:141], v[236:237]
  v_pk_fma_f32 v[42:43], v[42:43], v[142:143], v[236:237]
  v_pk_fma_f32 v[46:47], v[46:47], v[144:145], v[236:237]
  v_pk_fma_f32 v[48:49], v[48:49], v[146:147], v[236:237]
  v_pk_fma_f32 v[52:53], v[52:53], v[148:149], v[236:237]
  v_pk_fma_f32 v[54:55], v[54:55], v[150:151], v[236:237]
  v_pk_fma_f32 v[58:59], v[58:59], v[152:153], v[236:237]
  v_pk_fma_f32 v[60:61], v[60:61], v[154:155], v[236:237]
  v_exp_f32 v40, v40 clamp
  v_exp_f32 v41, v41 clamp
  v_exp_f32 v42, v42 clamp
  v_exp_f32 v43, v43 clamp
  v_exp_f32 v46, v46 clamp
  v_exp_f32 v47, v47 clamp
  v_exp_f32 v48, v48 clamp
  v_exp_f32 v49, v49 clamp
  v_exp_f32 v52, v52 clamp
  v_exp_f32 v53, v53 clamp
  v_exp_f32 v54, v54 clamp
  v_exp_f32 v55, v55 clamp
  v_exp_f32 v58, v58 clamp
  v_exp_f32 v59, v59 clamp
  v_exp_f32 v60, v60 clamp
  v_exp_f32 v61, v61 clamp
  v_pk_fma_f32 v[40:41], v[40:41], v[132:133], v[112:113]
  v_pk_fma_f32 v[42:43], v[42:43], v[134:135], v[114:115]
  v_pk_fma_f32 v[46:47], v[46:47], v[132:133], v[112:113]
  v_pk_fma_f32 v[48:49], v[48:49], v[134:135], v[114:115]
  v_pk_fma_f32 v[52:53], v[52:53], v[132:133], v[112:113]
  v_pk_fma_f32 v[54:55], v[54:55], v[134:135], v[114:115]
  v_pk_fma_f32 v[58:59], v[58:59], v[132:133], v[112:113]
  v_pk_fma_f32 v[60:61], v[60:61], v[134:135], v[114:115]
  v_pk_mul_f32 v[44:45], v[140:141], v[42:43]
  v_pk_mul_f32 v[50:51], v[144:145], v[48:49]
  v_pk_mul_f32 v[56:57], v[148:149], v[54:55]
  v_pk_mul_f32 v[62:63], v[152:153], v[60:61]
  v_pk_fma_f32 v[44:45], v[142:143], v[40:41], v[44:45]
  v_pk_fma_f32 v[50:51], v[146:147], v[46:47], v[50:51]
  v_pk_fma_f32 v[56:57], v[150:151], v[52:53], v[56:57]
  v_pk_fma_f32 v[62:63], v[154:155], v[58:59], v[62:63]
  v_pk_mul_f32 v[40:41], v[40:41], v[42:43]
  v_pk_mul_f32 v[46:47], v[46:47], v[48:49]
  v_pk_mul_f32 v[52:53], v[52:53], v[54:55]
  v_pk_mul_f32 v[58:59], v[58:59], v[60:61]
  v_rcp_f32 v40, v40
  v_rcp_f32 v41, v41
  v_rcp_f32 v46, v46
  v_rcp_f32 v47, v47
  v_rcp_f32 v52, v52
  v_rcp_f32 v53, v53
  v_rcp_f32 v58, v58
  v_rcp_f32 v59, v59
  v_pk_mul_f32 v[16:17], v[40:41], v[44:45]
  v_pk_mul_f32 v[18:19], v[46:47], v[50:51]
  v_pk_mul_f32 v[20:21], v[52:53], v[56:57]
  v_pk_mul_f32 v[22:23], v[58:59], v[62:63]
  v_pk_mul_f32 v[64:65], v[156:157], v[156:157]
  v_pk_mul_f32 v[66:67], v[158:159], v[158:159]
  v_pk_mul_f32 v[70:71], v[160:161], v[160:161]
  v_pk_mul_f32 v[72:73], v[162:163], v[162:163]
  v_pk_mul_f32 v[76:77], v[164:165], v[164:165]
  v_pk_mul_f32 v[78:79], v[166:167], v[166:167]
  v_pk_mul_f32 v[82:83], v[168:169], v[168:169]
  v_pk_mul_f32 v[84:85], v[170:171], v[170:171]
  v_pk_fma_f32 v[64:65], v[64:65], v[234:235], v[232:233]
  v_pk_fma_f32 v[66:67], v[66:67], v[234:235], v[232:233]
  v_pk_fma_f32 v[70:71], v[70:71], v[234:235], v[232:233]
  v_pk_fma_f32 v[72:73], v[72:73], v[234:235], v[232:233]
  v_pk_fma_f32 v[76:77], v[76:77], v[234:235], v[232:233]
  v_pk_fma_f32 v[78:79], v[78:79], v[234:235], v[232:233]
  v_pk_fma_f32 v[82:83], v[82:83], v[234:235], v[232:233]
  v_pk_fma_f32 v[84:85], v[84:85], v[234:235], v[232:233]
  v_pk_fma_f32 v[64:65], v[64:65], v[156:157], v[236:237]
  v_pk_fma_f32 v[66:67], v[66:67], v[158:159], v[236:237]
  v_pk_fma_f32 v[70:71], v[70:71], v[160:161], v[236:237]
  v_pk_fma_f32 v[72:73], v[72:73], v[162:163], v[236:237]
  v_pk_fma_f32 v[76:77], v[76:77], v[164:165], v[236:237]
  v_pk_fma_f32 v[78:79], v[78:79], v[166:167], v[236:237]
  v_pk_fma_f32 v[82:83], v[82:83], v[168:169], v[236:237]
  v_pk_fma_f32 v[84:85], v[84:85], v[170:171], v[236:237]
  v_exp_f32 v64, v64 clamp
  v_exp_f32 v65, v65 clamp
  v_exp_f32 v66, v66 clamp
  v_exp_f32 v67, v67 clamp
  v_exp_f32 v70, v70 clamp
  v_exp_f32 v71, v71 clamp
  v_exp_f32 v72, v72 clamp
  v_exp_f32 v73, v73 clamp
  v_exp_f32 v76, v76 clamp
  v_exp_f32 v77, v77 clamp
  v_exp_f32 v78, v78 clamp
  v_exp_f32 v79, v79 clamp
  v_exp_f32 v82, v82 clamp
  v_exp_f32 v83, v83 clamp
  v_exp_f32 v84, v84 clamp
  v_exp_f32 v85, v85 clamp
  v_pk_fma_f32 v[64:65], v[64:65], v[136:137], v[116:117]
  v_pk_fma_f32 v[66:67], v[66:67], v[138:139], v[118:119]
  v_pk_fma_f32 v[70:71], v[70:71], v[136:137], v[116:117]
  v_pk_fma_f32 v[72:73], v[72:73], v[138:139], v[118:119]
  v_pk_fma_f32 v[76:77], v[76:77], v[136:137], v[116:117]
  v_pk_fma_f32 v[78:79], v[78:79], v[138:139], v[118:119]
  v_pk_fma_f32 v[82:83], v[82:83], v[136:137], v[116:117]
  v_pk_fma_f32 v[84:85], v[84:85], v[138:139], v[118:119]
  v_pk_mul_f32 v[68:69], v[156:157], v[66:67]
  v_pk_mul_f32 v[74:75], v[160:161], v[72:73]
  v_pk_mul_f32 v[80:81], v[164:165], v[78:79]
  v_pk_mul_f32 v[86:87], v[168:169], v[84:85]
  v_pk_fma_f32 v[68:69], v[158:159], v[64:65], v[68:69]
  v_pk_fma_f32 v[74:75], v[162:163], v[70:71], v[74:75]
  v_pk_fma_f32 v[80:81], v[166:167], v[76:77], v[80:81]
  v_pk_fma_f32 v[86:87], v[170:171], v[82:83], v[86:87]
  v_pk_mul_f32 v[64:65], v[64:65], v[66:67]
  v_pk_mul_f32 v[70:71], v[70:71], v[72:73]
  v_pk_mul_f32 v[76:77], v[76:77], v[78:79]
  v_pk_mul_f32 v[82:83], v[82:83], v[84:85]
  v_rcp_f32 v64, v64
  v_rcp_f32 v65, v65
  v_rcp_f32 v70, v70
  v_rcp_f32 v71, v71
  v_rcp_f32 v76, v76
  v_rcp_f32 v77, v77
  v_rcp_f32 v82, v82
  v_rcp_f32 v83, v83
  v_pk_fma_f32 v[16:17], v[64:65], v[68:69], v[16:17]
  v_pk_fma_f32 v[18:19], v[70:71], v[74:75], v[18:19]
  v_pk_fma_f32 v[20:21], v[76:77], v[80:81], v[20:21]
  v_pk_fma_f32 v[22:23], v[82:83], v[86:87], v[22:23]
  v_pk_mul_f32 v[40:41], v[172:173], v[172:173]
  v_pk_mul_f32 v[42:43], v[174:175], v[174:175]
  v_pk_mul_f32 v[46:47], v[176:177], v[176:177]
  v_pk_mul_f32 v[48:49], v[178:179], v[178:179]
  v_pk_mul_f32 v[52:53], v[180:181], v[180:181]
  v_pk_mul_f32 v[54:55], v[182:183], v[182:183]
  v_pk_mul_f32 v[58:59], v[184:185], v[184:185]
  v_pk_mul_f32 v[60:61], v[186:187], v[186:187]
  v_pk_fma_f32 v[40:41], v[40:41], v[234:235], v[232:233]
  v_pk_fma_f32 v[42:43], v[42:43], v[234:235], v[232:233]
  v_pk_fma_f32 v[46:47], v[46:47], v[234:235], v[232:233]
  v_pk_fma_f32 v[48:49], v[48:49], v[234:235], v[232:233]
  v_pk_fma_f32 v[52:53], v[52:53], v[234:235], v[232:233]
  v_pk_fma_f32 v[54:55], v[54:55], v[234:235], v[232:233]
  v_pk_fma_f32 v[58:59], v[58:59], v[234:235], v[232:233]
  v_pk_fma_f32 v[60:61], v[60:61], v[234:235], v[232:233]
  v_pk_fma_f32 v[40:41], v[40:41], v[172:173], v[236:237]
  v_pk_fma_f32 v[42:43], v[42:43], v[174:175], v[236:237]
  v_pk_fma_f32 v[46:47], v[46:47], v[176:177], v[236:237]
  v_pk_fma_f32 v[48:49], v[48:49], v[178:179], v[236:237]
  v_pk_fma_f32 v[52:53], v[52:53], v[180:181], v[236:237]
  v_pk_fma_f32 v[54:55], v[54:55], v[182:183], v[236:237]
  v_pk_fma_f32 v[58:59], v[58:59], v[184:185], v[236:237]
  v_pk_fma_f32 v[60:61], v[60:61], v[186:187], v[236:237]
  v_exp_f32 v40, v40 clamp
  v_exp_f32 v41, v41 clamp
  v_exp_f32 v42, v42 clamp
  v_exp_f32 v43, v43 clamp
  v_exp_f32 v46, v46 clamp
  v_exp_f32 v47, v47 clamp
  v_exp_f32 v48, v48 clamp
  v_exp_f32 v49, v49 clamp
  v_exp_f32 v52, v52 clamp
  v_exp_f32 v53, v53 clamp
  v_exp_f32 v54, v54 clamp
  v_exp_f32 v55, v55 clamp
  v_exp_f32 v58, v58 clamp
  v_exp_f32 v59, v59 clamp
  v_exp_f32 v60, v60 clamp
  v_exp_f32 v61, v61 clamp
  v_pk_fma_f32 v[40:41], v[40:41], v[220:221], v[120:121]
  v_pk_fma_f32 v[42:43], v[42:43], v[222:223], v[122:123]
  v_pk_fma_f32 v[46:47], v[46:47], v[220:221], v[120:121]
  v_pk_fma_f32 v[48:49], v[48:49], v[222:223], v[122:123]
  v_pk_fma_f32 v[52:53], v[52:53], v[220:221], v[120:121]
  v_pk_fma_f32 v[54:55], v[54:55], v[222:223], v[122:123]
  v_pk_fma_f32 v[58:59], v[58:59], v[220:221], v[120:121]
  v_pk_fma_f32 v[60:61], v[60:61], v[222:223], v[122:123]
  v_pk_mul_f32 v[44:45], v[172:173], v[42:43]
  v_pk_mul_f32 v[50:51], v[176:177], v[48:49]
  v_pk_mul_f32 v[56:57], v[180:181], v[54:55]
  v_pk_mul_f32 v[62:63], v[184:185], v[60:61]
  v_pk_fma_f32 v[44:45], v[174:175], v[40:41], v[44:45]
  v_pk_fma_f32 v[50:51], v[178:179], v[46:47], v[50:51]
  v_pk_fma_f32 v[56:57], v[182:183], v[52:53], v[56:57]
  v_pk_fma_f32 v[62:63], v[186:187], v[58:59], v[62:63]
  v_pk_mul_f32 v[40:41], v[40:41], v[42:43]
  v_pk_mul_f32 v[46:47], v[46:47], v[48:49]
  v_pk_mul_f32 v[52:53], v[52:53], v[54:55]
  v_pk_mul_f32 v[58:59], v[58:59], v[60:61]
  v_rcp_f32 v40, v40
  v_rcp_f32 v41, v41
  v_rcp_f32 v46, v46
  v_rcp_f32 v47, v47
  v_rcp_f32 v52, v52
  v_rcp_f32 v53, v53
  v_rcp_f32 v58, v58
  v_rcp_f32 v59, v59
  v_pk_fma_f32 v[16:17], v[40:41], v[44:45], v[16:17]
  v_pk_fma_f32 v[18:19], v[46:47], v[50:51], v[18:19]
  v_pk_fma_f32 v[20:21], v[52:53], v[56:57], v[20:21]
  v_pk_fma_f32 v[22:23], v[58:59], v[62:63], v[22:23]
  v_pk_mul_f32 v[64:65], v[188:189], v[188:189]
  v_pk_mul_f32 v[66:67], v[190:191], v[190:191]
  v_pk_mul_f32 v[70:71], v[192:193], v[192:193]
  v_pk_mul_f32 v[72:73], v[194:195], v[194:195]
  v_pk_mul_f32 v[76:77], v[196:197], v[196:197]
  v_pk_mul_f32 v[78:79], v[198:199], v[198:199]
  v_pk_mul_f32 v[82:83], v[200:201], v[200:201]
  v_pk_mul_f32 v[84:85], v[202:203], v[202:203]
  v_pk_fma_f32 v[64:65], v[64:65], v[234:235], v[232:233]
  v_pk_fma_f32 v[66:67], v[66:67], v[234:235], v[232:233]
  v_pk_fma_f32 v[70:71], v[70:71], v[234:235], v[232:233]
  v_pk_fma_f32 v[72:73], v[72:73], v[234:235], v[232:233]
  v_pk_fma_f32 v[76:77], v[76:77], v[234:235], v[232:233]
  v_pk_fma_f32 v[78:79], v[78:79], v[234:235], v[232:233]
  v_pk_fma_f32 v[82:83], v[82:83], v[234:235], v[232:233]
  v_pk_fma_f32 v[84:85], v[84:85], v[234:235], v[232:233]
  v_pk_fma_f32 v[64:65], v[64:65], v[188:189], v[236:237]
  v_pk_fma_f32 v[66:67], v[66:67], v[190:191], v[236:237]
  v_pk_fma_f32 v[70:71], v[70:71], v[192:193], v[236:237]
  v_pk_fma_f32 v[72:73], v[72:73], v[194:195], v[236:237]
  v_pk_fma_f32 v[76:77], v[76:77], v[196:197], v[236:237]
  v_pk_fma_f32 v[78:79], v[78:79], v[198:199], v[236:237]
  v_pk_fma_f32 v[82:83], v[82:83], v[200:201], v[236:237]
  v_pk_fma_f32 v[84:85], v[84:85], v[202:203], v[236:237]
  v_exp_f32 v64, v64 clamp
  v_exp_f32 v65, v65 clamp
  v_exp_f32 v66, v66 clamp
  v_exp_f32 v67, v67 clamp
  v_exp_f32 v70, v70 clamp
  v_exp_f32 v71, v71 clamp
  v_exp_f32 v72, v72 clamp
  v_exp_f32 v73, v73 clamp
  v_exp_f32 v76, v76 clamp
  v_exp_f32 v77, v77 clamp
  v_exp_f32 v78, v78 clamp
  v_exp_f32 v79, v79 clamp
  v_exp_f32 v82, v82 clamp
  v_exp_f32 v83, v83 clamp
  v_exp_f32 v84, v84 clamp
  v_exp_f32 v85, v85 clamp
  v_pk_fma_f32 v[64:65], v[64:65], v[224:225], v[124:125]
  v_pk_fma_f32 v[66:67], v[66:67], v[226:227], v[126:127]
  v_pk_fma_f32 v[70:71], v[70:71], v[224:225], v[124:125]
  v_pk_fma_f32 v[72:73], v[72:73], v[226:227], v[126:127]
  v_pk_fma_f32 v[76:77], v[76:77], v[224:225], v[124:125]
  v_pk_fma_f32 v[78:79], v[78:79], v[226:227], v[126:127]
  v_pk_fma_f32 v[82:83], v[82:83], v[224:225], v[124:125]
  v_pk_fma_f32 v[84:85], v[84:85], v[226:227], v[126:127]
  v_pk_mul_f32 v[68:69], v[188:189], v[66:67]
  v_pk_mul_f32 v[74:75], v[192:193], v[72:73]
  v_pk_mul_f32 v[80:81], v[196:197], v[78:79]
  v_pk_mul_f32 v[86:87], v[200:201], v[84:85]
  v_pk_fma_f32 v[68:69], v[190:191], v[64:65], v[68:69]
  v_pk_fma_f32 v[74:75], v[194:195], v[70:71], v[74:75]
  v_pk_fma_f32 v[80:81], v[198:199], v[76:77], v[80:81]
  v_pk_fma_f32 v[86:87], v[202:203], v[82:83], v[86:87]
  v_pk_mul_f32 v[64:65], v[64:65], v[66:67]
  v_pk_mul_f32 v[70:71], v[70:71], v[72:73]
  v_pk_mul_f32 v[76:77], v[76:77], v[78:79]
  v_pk_mul_f32 v[82:83], v[82:83], v[84:85]
  v_rcp_f32 v64, v64
  v_rcp_f32 v65, v65
  v_rcp_f32 v70, v70
  v_rcp_f32 v71, v71
  v_rcp_f32 v76, v76
  v_rcp_f32 v77, v77
  v_rcp_f32 v82, v82
  v_rcp_f32 v83, v83
  v_pk_fma_f32 v[16:17], v[64:65], v[68:69], v[16:17]
  v_pk_fma_f32 v[18:19], v[70:71], v[74:75], v[18:19]
  v_pk_fma_f32 v[20:21], v[76:77], v[80:81], v[20:21]
  v_pk_fma_f32 v[22:23], v[82:83], v[86:87], v[22:23]
  v_pk_mul_f32 v[40:41], v[204:205], v[204:205]
  v_pk_mul_f32 v[42:43], v[206:207], v[206:207]
  v_pk_mul_f32 v[46:47], v[208:209], v[208:209]
  v_pk_mul_f32 v[48:49], v[210:211], v[210:211]
  v_pk_mul_f32 v[52:53], v[212:213], v[212:213]
  v_pk_mul_f32 v[54:55], v[214:215], v[214:215]
  v_pk_mul_f32 v[58:59], v[216:217], v[216:217]
  v_pk_mul_f32 v[60:61], v[218:219], v[218:219]
  v_pk_fma_f32 v[40:41], v[40:41], v[234:235], v[232:233]
  v_pk_fma_f32 v[42:43], v[42:43], v[234:235], v[232:233]
  v_pk_fma_f32 v[46:47], v[46:47], v[234:235], v[232:233]
  v_pk_fma_f32 v[48:49], v[48:49], v[234:235], v[232:233]
  v_pk_fma_f32 v[52:53], v[52:53], v[234:235], v[232:233]
  v_pk_fma_f32 v[54:55], v[54:55], v[234:235], v[232:233]
  v_pk_fma_f32 v[58:59], v[58:59], v[234:235], v[232:233]
  v_pk_fma_f32 v[60:61], v[60:61], v[234:235], v[232:233]
  v_pk_fma_f32 v[40:41], v[40:41], v[204:205], v[236:237]
  v_pk_fma_f32 v[42:43], v[42:43], v[206:207], v[236:237]
  v_pk_fma_f32 v[46:47], v[46:47], v[208:209], v[236:237]
  v_pk_fma_f32 v[48:49], v[48:49], v[210:211], v[236:237]
  v_pk_fma_f32 v[52:53], v[52:53], v[212:213], v[236:237]
  v_pk_fma_f32 v[54:55], v[54:55], v[214:215], v[236:237]
  v_pk_fma_f32 v[58:59], v[58:59], v[216:217], v[236:237]
  v_pk_fma_f32 v[60:61], v[60:61], v[218:219], v[236:237]
  v_exp_f32 v40, v40 clamp
  v_exp_f32 v41, v41 clamp
  v_exp_f32 v42, v42 clamp
  v_exp_f32 v43, v43 clamp
  v_exp_f32 v46, v46 clamp
  v_exp_f32 v47, v47 clamp
  v_exp_f32 v48, v48 clamp
  v_exp_f32 v49, v49 clamp
  v_exp_f32 v52, v52 clamp
  v_exp_f32 v53, v53 clamp
  v_exp_f32 v54, v54 clamp
  v_exp_f32 v55, v55 clamp
  v_exp_f32 v58, v58 clamp
  v_exp_f32 v59, v59 clamp
  v_exp_f32 v60, v60 clamp
  v_exp_f32 v61, v61 clamp
  v_pk_fma_f32 v[40:41], v[40:41], v[228:229], v[128:129]
  v_pk_fma_f32 v[42:43], v[42:43], v[230:231], v[130:131]
  v_pk_fma_f32 v[46:47], v[46:47], v[228:229], v[128:129]
  v_pk_fma_f32 v[48:49], v[48:49], v[230:231], v[130:131]
  v_pk_fma_f32 v[52:53], v[52:53], v[228:229], v[128:129]
  v_pk_fma_f32 v[54:55], v[54:55], v[230:231], v[130:131]
  v_pk_fma_f32 v[58:59], v[58:59], v[228:229], v[128:129]
  v_pk_fma_f32 v[60:61], v[60:61], v[230:231], v[130:131]
  v_pk_mul_f32 v[44:45], v[204:205], v[42:43]
  v_pk_mul_f32 v[50:51], v[208:209], v[48:49]
  v_pk_mul_f32 v[56:57], v[212:213], v[54:55]
  v_pk_mul_f32 v[62:63], v[216:217], v[60:61]
  v_pk_fma_f32 v[44:45], v[206:207], v[40:41], v[44:45]
  v_pk_fma_f32 v[50:51], v[210:211], v[46:47], v[50:51]
  v_pk_fma_f32 v[56:57], v[214:215], v[52:53], v[56:57]
  v_pk_fma_f32 v[62:63], v[218:219], v[58:59], v[62:63]
  v_pk_mul_f32 v[40:41], v[40:41], v[42:43]
  v_pk_mul_f32 v[46:47], v[46:47], v[48:49]
  v_pk_mul_f32 v[52:53], v[52:53], v[54:55]
  v_pk_mul_f32 v[58:59], v[58:59], v[60:61]
  v_rcp_f32 v40, v40
  v_rcp_f32 v41, v41
  v_rcp_f32 v46, v46
  v_rcp_f32 v47, v47
  v_rcp_f32 v52, v52
  v_rcp_f32 v53, v53
  v_rcp_f32 v58, v58
  v_rcp_f32 v59, v59
  v_pk_fma_f32 v[16:17], v[40:41], v[44:45], v[16:17]
  v_pk_fma_f32 v[18:19], v[46:47], v[50:51], v[18:19]
  v_pk_fma_f32 v[20:21], v[52:53], v[56:57], v[20:21]
  v_pk_fma_f32 v[22:23], v[58:59], v[62:63], v[22:23]
  v_add_f32 v16, v16, v17
  v_add_f32 v18, v18, v19
  v_add_f32 v20, v20, v21
  v_add_f32 v22, v22, v23
  v_mul_f32 v16, v239, v16
  v_mul_f32 v18, v239, v18
  v_mul_f32 v20, v239, v20
  v_mul_f32 v22, v239, v22
  s_nop 0
  v_permlane32_swap_b32 v16, v20
  v_permlane32_swap_b32 v18, v22
  v_add_f32 v16, v16, v20
  v_add_f32 v18, v18, v22
  s_nop 1
  v_permlane16_swap_b32 v16, v18
  v_add_f32 v16, v16, v18
  ds_write_b32 v36, v16
  s_waitcnt lgkmcnt(0)
  s_cmp_eq_u32 s3, 0
  s_cbranch_scc1 L_dpub
  s_barrier
  s_endpgm
L_dpub:
  s_mov_b32 s60, s24
  s_and_b32 s61, s25, 0xffff
  s_mov_b32 s62, 268435456
  s_mov_b32 s63, 0x20000
  s_mov_b32 s64, s22
  s_and_b32 s65, s23, 0xffff
  s_mov_b32 s66, 256
  s_mov_b32 s67, 0x20000
  s_and_b32 s81, s2, 7
  s_waitcnt vmcnt(0)
  v_cmp_eq_u32 vcc, 0, v37
  s_nop 0
  s_bitcmp1_b32 vcc_lo, s81
  s_cbranch_scc0 L_dclr_ok
  s_mov_b32 s78, 0x40000
L_dclr:
  s_sub_u32 s78, s78, 1
  s_cbranch_scc1 L_dclr_ok
  v_lshlrev_b32 v37, 2, v0
  v_and_b32 v37, 31, v37
  buffer_load_dword v37, v37, s[64:67], 0 offen offset:128 sc1
  s_waitcnt vmcnt(0)
  v_cmp_eq_u32 vcc, 0, v37
  s_nop 0
  s_bitcmp1_b32 vcc_lo, s81
  s_cbranch_scc1 L_dclr
L_dclr_ok:
  s_barrier
  ds_read_b64 v[64:65], v2 offset:0
  ds_read_b64 v[66:67], v2 offset:512
  ds_read_b64 v[68:69], v2 offset:1024
  ds_read_b64 v[70:71], v2 offset:1536
  s_waitcnt lgkmcnt(2)
  v_pk_add_f32 v[64:65], v[64:65], v[66:67]
  s_waitcnt lgkmcnt(0)
  v_pk_add_f32 v[68:69], v[68:69], v[70:71]
  v_pk_add_f32 v[64:65], v[64:65], v[68:69]
  v_and_b32 v64, -2, v64
  v_and_b32 v65, -2, v65
  buffer_store_dwordx2 v[64:65], v3, s[60:63], s69 offen sc1
  s_endpgm
L_cin:
  s_and_b32 s68, s26, 3
  s_mul_i32 s68, s68, 3
  s_add_u32 s27, s68, s27
  s_sub_u32 s27, s27, 6
  s_and_b32 s79, s3, 3
  s_lshr_b32 s84, s3, 2
  s_lshl_b32 s100, s27, 3
  s_add_u32 s100, s100, s3
  s_mul_i32 s68, s100, 1280
  v_min_u32 v40, 9, v0
  v_lshlrev_b32 v40, 7, v40
  v_lshlrev_b32 v48, 4, v0
  s_lshl_b32 s95, s79, 10
  s_cmp_eq_u32 s79, 2
  s_cselect_b64 s[82:83], 0x3fffff, -1
  s_cmp_eq_u32 s79, 3
  s_cselect_b32 s96, 0, 32768
  s_add_u32 s96, s96, s95
  v_mov_b32 v2, 110464
  v_lshlrev_b32 v1, 20, v0
  v_add_u32 v1, 110464, v1
  v_and_b32 v44, 7, v0
  v_lshlrev_b32 v18, 4, v44
  v_and_b32 v44, 15, v0
  v_lshl_add_u32 v44, v44, 2, v2
  v_mov_b32 v3, 0
  ds_write_b32 v44, v3
  v_lshrrev_b32 v41, 5, v0
  v_and_b32 v42, 31, v0
  s_waitcnt lgkmcnt(0)
  v_mov_b32 v3, 1
  s_mov_b32 s36, s8
  s_and_b32 s37, s9, 0xffff
  s_mov_b32 s38, 105456
  s_mov_b32 s39, 0x20000
  buffer_load_dword v255, v40, s[36:39], s68 offen
  s_barrier
  v_add_u32 v248, s95, v48
  v_cmp_gt_u32 vcc, 1152, v248
  s_nop 1
  v_cndmask_b32 v248, 0, 4, vcc
  v_add_u32 v248, v248, v48
  s_cmp_lg_u32 s84, 0
  s_cbranch_scc1 L_g1a
  s_branch L_g0pf
L_g1a:
  s_setprio 1
  v_bfe_u32 v43, v0, 2, 2
  v_lshl_add_u32 v43, v41, 3, v43
  v_bfe_u32 v44, v0, 4, 1
  v_lshlrev_b32 v44, 5, v44
  v_and_b32 v45, 3, v0
  v_lshl_add_u32 v44, v45, 3, v44
  v_lshl_add_u32 v240, v43, 6, v44
  v_add_u32 v240, 106816, v240
  s_lshl_b32 s68, s79, 6
  s_add_u32 s68, s68, 36288
  v_add_u32 v44, s68, v44
  v_mul_u32_u24 v45, 1352, v43
  v_add_u32 v241, v44, v45
  v_add_u32 v45, 16, v43
  v_min_u32 v45, 25, v45
  v_mul_u32_u24 v45, 1352, v45
  v_add_u32 v242, v44, v45
  v_add_u32 v45, 20, v43
  v_min_u32 v45, 25, v45
  v_mul_u32_u24 v45, 1352, v45
  v_add_u32 v243, v44, v45
  s_lshl_b32 s68, s79, 5
  v_add_u32 v246, s68, v42
  v_mul_u32_u24 v43, 52, v246
  v_lshl_add_u32 v43, v41, 3, v43
  v_add_u32 v244, 71552, v43
  v_lshlrev_b32 v43, 1, v246
  v_add_u32 v245, 108864, v43
  v_mov_b32 v216, 0
  v_mov_b32 v217, 0
  v_lshlrev_b32 v43, 3, v0
  v_add_u32 v44, 106816, v43
  s_lshl_b32 s68, s79, 9
  v_add_u32 v44, s68, v44
  ds_write_b64 v44, v[216:217]
  v_lshl_add_u32 v43, v41, 7, v246
  s_mov_b32 s69, 2521
  s_mov_b32 s70, 106816
  v_mul_u32_u24 v44, s69, v43
  v_lshrrev_b32 v44, 16, v44
  v_mad_u32_u24 v44, v44, 12, s70
  v_lshl_add_u32 v68, v43, 1, v44
  v_add_u32 v43, 256, v43
  v_mul_u32_u24 v44, s69, v43
  v_lshrrev_b32 v44, 16, v44
  v_mad_u32_u24 v44, v44, 12, s70
  v_lshl_add_u32 v69, v43, 1, v44
  v_add_u32 v43, 256, v43
  v_mul_u32_u24 v44, s69, v43
  v_lshrrev_b32 v44, 16, v44
  v_mad_u32_u24 v44, v44, 12, s70
  v_lshl_add_u32 v70, v43, 1, v44
  v_mov_b32 v44, 676
  v_cmp_gt_u32 s[92:93], v44, v43
  v_add_u32 v43, 0, v246
  v_mul_u32_u24 v44, s69, v43
  v_lshrrev_b32 v44, 16, v44
  v_lshl_add_u32 v44, v44, 2, v244
  v_add_u32 v72, 0, v44
  v_add_u32 v43, 128, v246
  v_mul_u32_u24 v44, s69, v43
  v_lshrrev_b32 v44, 16, v44
  v_lshl_add_u32 v44, v44, 2, v244
  v_add_u32 v73, 6656, v44
  v_add_u32 v43, 256, v246
  v_mul_u32_u24 v44, s69, v43
  v_lshrrev_b32 v44, 16, v44
  v_lshl_add_u32 v44, v44, 2, v244
  v_add_u32 v74, 13312, v44
  v_add_u32 v43, 384, v246
  v_mul_u32_u24 v44, s69, v43
  v_lshrrev_b32 v44, 16, v44
  v_lshl_add_u32 v44, v44, 2, v244
  v_add_u32 v75, 19968, v44
  v_add_u32 v43, 512, v246
  v_mul_u32_u24 v44, s69, v43
  v_lshrrev_b32 v44, 16, v44
  v_lshl_add_u32 v44, v44, 2, v244
  v_add_u32 v76, 26624, v44
  v_add_u32 v43, 640, v246
  v_mul_u32_u24 v44, s69, v43
  v_lshrrev_b32 v44, 16, v44
  v_lshl_add_u32 v44, v44, 2, v244
  v_add_u32 v77, 33280, v44
  v_lshlrev_b32 v78, 4, v41
  v_add_u32 v78, 110376, v78
  v_lshlrev_b32 v79, 1, v0
  v_add_u32 v79, 110272, v79
  v_lshlrev_b32 v80, 6, v0
  v_add_u32 v80, 106868, v80
L_addrc:
  s_mul_i32 s69, s27, 2979
  s_lshr_b32 s69, s69, 6
  s_mul_i32 s98, s27, 44
  s_and_b32 s70, s2, 7
  s_add_u32 s85, s98, s3
  s_lshl_b32 s85, s85, 2
  s_lshl_b32 s98, s70, 14
  s_add_u32 s85, s85, s98
  s_add_u32 s85, s85, 10240
  s_mul_i32 s98, s27, 44
  s_lshl_b32 s77, s70, 9
  s_add_u32 s94, s77, s98
  s_add_u32 s77, s77, s69
  s_add_u32 s94, s94, s3
  s_mul_i32 s94, s94, 104
  s_lshl_b32 s98, s27, 2
  s_add_u32 s98, s98, s3
  s_add_u32 s98, s98, s70
  s_and_b32 s98, s98, 7
  s_mul_i32 s98, s98, 16640
  s_add_u32 s98, s98, 12288
  s_sub_u32 s72, 6, s84
  s_lshl_b32 s99, s84, 1
  s_mov_b32 s26, -1
  v_lshrrev_b32 v43, 3, v0
  v_min_u32 v43, 6, v43
  v_lshlrev_b32 v17, 4, v43
  s_mul_i32 s70, s70, 88
  s_add_u32 s70, s100, s70
  s_mov_b32 s71, 704
  v_mov_b32 v44, s70
  v_mad_u32_u24 v19, v0, s71, v44
  s_mul_i32 s70, s100, 104
  s_sub_u32 s70, s70, 313
  v_min_u32 v44, 16, v0
  v_mul_u32_u24 v45, 26, v44
  v_add_u32 v45, s70, v45
  v_cmp_lt_u32 vcc, 12, v44
  s_nop 1
  v_cndmask_b32 v19, v19, v45, vcc
  v_lshlrev_b32 v19, 7, v19
  s_mov_b32 s101, 638976
  s_mov_b32 s32, s6
  s_and_b32 s33, s7, 0xffff
  s_mov_b32 s34, 12800000
  s_mov_b32 s35, 0x20000
  s_mov_b32 s44, s12
  s_and_b32 s45, s13, 0xffff
  s_mov_b32 s46, 5537792
  s_mov_b32 s47, 0x20000
  s_mov_b32 s28, s4
  s_and_b32 s29, s5, 0xffff
  s_mov_b32 s30, 425984
  s_mov_b32 s31, 0x20000
  s_and_b32 s70, s3, 1
  s_lshl_b32 s70, s70, 1
  v_add_u32 v46, s70, v41
  v_min_u32 v43, 25, v42
  s_mul_i32 s68, s84, 4
  s_add_u32 s68, s68, 1352
  s_mul_i32 s69, s84, 70528
  s_add_u32 s69, s69, 1024
  v_mul_u32_u24 v44, s68, v43
  v_add_u32 v44, s69, v44
  v_lshlrev_b32 v247, 2, v43
  v_add_u32 v247, 70528, v247
  s_lshl_b32 s68, s84, 2
  s_xor_b32 s68, s68, 4
  v_lshrrev_b32 v45, 2, v43
  v_and_b32 v45, s68, v45
  v_add_u32 v44, v44, v45
  v_sub_u32 v247, v247, v45
  v_mul_u32_u24 v65, 52, v43
  v_lshl_add_u32 v65, v46, 1, v65
  v_add_u32 v65, 108864, v65
  v_lshlrev_b32 v67, 1, v43
  v_add_u32 v67, 110272, v67
  v_mad_u32_u24 v60, v46, 52, v44
  v_lshl_add_u32 v61, v46, 1, v44
  v_lshl_add_u32 v49, v46, 1, v60
  v_lshlrev_b32 v43, 3, v46
  s_mov_b32 s68, 0x01000100
  v_bfe_i32 v45, s68, v43, 8
  v_lshl_add_u32 v50, v45, 1, v60
  v_mad_i32_i24 v51, v45, 52, v61
  s_mov_b32 s68, 0xff00ff00
  v_bfe_i32 v45, s68, v43, 8
  v_lshl_add_u32 v52, v45, 1, v60
  v_mad_i32_i24 v53, v45, 52, v61
  s_mov_b32 s68, 0xff020100
  v_bfe_i32 v45, s68, v43, 8
  v_lshl_add_u32 v54, v45, 1, v60
  v_mad_i32_i24 v55, v45, 52, v61
  s_mov_b32 s68, 0x0b0a0100
  v_bfe_i32 v45, s68, v43, 8
  v_lshl_add_u32 v56, v45, 1, v60
  v_mad_i32_i24 v57, v45, 52, v61
  s_mov_b32 s68, 0xf3f20100
  v_bfe_i32 v45, s68, v43, 8
  v_lshl_add_u32 v58, v45, 1, v60
  v_mad_i32_i24 v59, v45, 52, v61
  s_mov_b32 s68, 0x00023600
  v_bfe_u32 v45, s68, v43, 8
  v_add_u32 v60, v45, v44
  v_add_u32 v61, 52, v44
  v_mov_b32 v47, 1048576
  v_cmp_eq_u32 vcc, 3, v46
  s_nop 1
  v_cndmask_b32 v60, v60, v47, vcc
  v_cndmask_b32 v67, v47, v67, vcc
  v_cmp_eq_u32 vcc, 2, v46
  s_nop 1
  v_cndmask_b32 v61, v47, v61, vcc
  v_cmp_gt_u32 vcc, 2, v46
  s_nop 1
  v_cndmask_b32 v64, v47, v65, vcc
  s_lshr_b32 s69, s79, 1
  s_mul_i32 s69, s69, 6144
  s_mul_i32 s68, s84, 6144
  v_lshlrev_b32 v45, 8, v46
  v_lshl_add_u32 v43, v42, 4, v45
  v_add_u32 v63, 1024, v43
  v_add_u32 v66, 36288, v43
  v_bfe_u32 v43, v0, 2, 2
  v_lshl_add_u32 v45, v43, 4, v45
  v_and_b32 v43, 3, v0
  v_lshl_add_u32 v44, v43, 6, v45
  v_add_u32 v44, 12288, v44
  v_cmp_lt_u32 vcc, 15, v42
  s_nop 1
  v_cndmask_b32 v63, v63, v44, vcc
  v_add_u32 v44, 16, v44
  v_cndmask_b32 v66, v66, v44, vcc
  v_lshl_add_u32 v44, v43, 5, v45
  v_add_u32 v44, 24560, v44
  v_cmp_lt_u32 vcc, 19, v42
  s_nop 1
  v_cndmask_b32 v63, v63, v44, vcc
  v_add_u32 v63, s69, v63
  v_add_u32 v66, s68, v66
  v_cmp_lt_u32 vcc, 25, v42
  s_nop 1
  v_cndmask_b32 v63, v63, v47, vcc
  v_cndmask_b32 v66, v66, v47, vcc
  v_mov_b32 v62, 0
  s_mul_i32 s74, s3, 4224
  s_add_u32 s74, s74, 111040
  s_mov_b32 s75, -39488
  v_add_u32 v28, 1024, v48
  v_and_b32 v43, 11, v0
  v_cmp_eq_u32 vcc, 11, v43
  s_nop 1
  v_cndmask_b32 v31, v28, v47, vcc
  v_and_b32 v43, 3, v0
  v_cmp_eq_u32 vcc, 0, v43
  s_nop 1
  v_cndmask_b32 v30, v31, v47, vcc
  v_lshrrev_b32 v46, 4, v0
  v_bfe_u32 v43, v0, 1, 3
  v_lshlrev_b32 v45, 4, v43
  v_add_u32 v45, 24576, v45
  v_and_b32 v43, 10, v0
  v_cmp_eq_u32 vcc, 10, v43
  s_nop 1
  v_cndmask_b32 v45, v45, v47, vcc
  v_and_b32 v44, 1, v0
  v_lshl_add_u32 v29, v46, 9, v45
  v_lshl_add_u32 v29, v44, 2, v29
  v_add_u32 v29, 1024, v29
  v_lshl_add_u32 v22, v46, 8, v45
  v_lshl_add_u32 v22, v44, 20, v22
  v_and_b32 v47, 15, v0
  s_mov_b32 s68, 1056
  v_lshlrev_b32 v43, 1, v47
  v_add_u32 v43, s74, v43
  v_mad_u32_u24 v7, v46, s68, v43
  s_lshl_b32 s68, s3, 10
  s_add_u32 s68, s68, 144832
  v_add_u32 v10, s68, v48
  v_add_u32 v43, 256, v48
  v_and_b32 v43, 1023, v43
  v_add_u32 v11, s68, v43
  v_xor_b32 v43, 512, v48
  v_add_u32 v12, s68, v43
  v_lshlrev_b32 v13, 4, v41
  v_mov_b32 v32, 0
  v_mov_b32 v33, 0
  v_mov_b32 v34, 0
  v_mov_b32 v35, 0
  v_mov_b32 v36, 0
  v_mov_b32 v37, 0
  v_mov_b32 v38, 0
  v_mov_b32 v39, 0
  v_mov_b32 v216, 0
  v_mov_b32 v217, 0
  v_mov_b32 v218, 0
  v_mov_b32 v219, 0
  v_mov_b32 v220, 0
  v_mov_b32 v221, 0
  v_mov_b32 v222, 0
  v_mov_b32 v223, 0
  v_mov_b32 v224, 0
  v_mov_b32 v225, 0
  v_mov_b32 v226, 0
  v_mov_b32 v227, 0
  v_mov_b32 v228, 0
  v_mov_b32 v229, 0
  v_mov_b32 v230, 0
  v_mov_b32 v231, 0
  v_mov_b32 v232, 0
  v_mov_b32 v233, 0
  v_mov_b32 v234, 0
  v_mov_b32 v235, 0
  v_mov_b32 v236, 0
  v_mov_b32 v237, 0
  v_mov_b32 v238, 0
  v_mov_b32 v239, 0
  v_mul_u32_u24 v44, 1056, v46
  v_bfe_u32 v45, v0, 2, 2
  v_lshl_add_u32 v44, v45, 7, v44
  v_and_b32 v45, 3, v0
  v_lshl_add_u32 v9, v45, 3, v44
  v_add_u32 v8, s74, v9
  v_and_b32 v45, 1, v0
  s_mov_b32 s68, 0xaaaaaaaa
  v_mul_lo_u32 v16, s68, v45
  v_or_b32 v16, 0x44444444, v16
  v_lshlrev_b32 v15, 1, v0
  v_add_u32 v15, s74, v15
  v_mov_b32 v14, 0x3f80
  ds_write_b16 v15, v14 offset:4064
  v_add_u32 v15, s75, v15
  s_mul_i32 s71, s3, 6
  s_add_u32 s77, s77, s71
  s_mul_i32 s77, s77, 104
  s_add_u32 s73, s77, 80
  s_add_u32 s77, s77, 16
  s_mov_b32 s71, 10923
  v_min_u32 v43, 35, v0
  v_mul_u32_u24 v44, s71, v43
  v_lshrrev_b32 v44, 16, v44
  v_mul_u32_u24 v44, 80, v44
  v_lshl_add_u32 v20, v43, 2, v44
  s_waitcnt lgkmcnt(0)
  ds_add_u32 v1, v3 offset:0
  s_sub_u32 s94, s94, 416
  buffer_load_dwordx4 v[204:207], v17, s[28:31], s94 offen offset:0
  s_add_u32 s94, s94, 416
  buffer_load_dwordx4 v[24:27], v17, s[28:31], s94 offen offset:0
  s_add_u32 s94, s94, 832
  s_sub_u32 s68, s77, 2496
  buffer_load_dword v208, v20, s[28:31], s68 offen
  buffer_load_dword v209, v20, s[28:31], s77 offen
  s_add_u32 s77, s77, 24
  buffer_load_dword v21, v20, s[28:31], s77 offen
  s_cmp_eq_u32 s77, s73
  s_cselect_b32 s73, 0x7000000, s73
  s_cselect_b32 s77, 0x7000000, s77
  s_add_u32 s77, s77, 24
  s_min_u32 s77, s77, s73
L_csync1:
  ds_read_b32 v4, v2 offset:0
  s_waitcnt lgkmcnt(0)
  v_cmp_gt_u32 vcc, 8, v4
  s_cbranch_vccnz L_csync1
  ds_read_b64 v[132:133], v78 offset:0
  ds_read_b64 v[134:135], v78 offset:8
  ds_read_b64 v[136:137], v78 offset:32
  ds_read_b64 v[138:139], v78 offset:40
  ds_read_u16 v45, v79 offset:52
  ds_read_b64_tr_b16 v[84:85], v241 offset:35264
  ds_read_b64_tr_b16 v[86:87], v241 offset:40672
  ds_read_b64_tr_b16 v[88:89], v242 offset:35264
  ds_read_b64_tr_b16 v[90:91], v243 offset:35264
  ds_read_b64_tr_b16 v[92:93], v241 offset:35520
  ds_read_b64_tr_b16 v[94:95], v241 offset:40928
  ds_read_b64_tr_b16 v[96:97], v242 offset:35520
  ds_read_b64_tr_b16 v[98:99], v243 offset:35520
  ds_read_b64_tr_b16 v[100:101], v241 offset:35776
  ds_read_b64_tr_b16 v[102:103], v241 offset:41184
  ds_read_b64_tr_b16 v[104:105], v242 offset:35776
  ds_read_b64_tr_b16 v[106:107], v243 offset:35776
  ds_read_b64_tr_b16 v[108:109], v241 offset:36032
  ds_read_b64_tr_b16 v[110:111], v241 offset:41440
  ds_read_b64_tr_b16 v[112:113], v242 offset:36032
  ds_read_b64_tr_b16 v[114:115], v243 offset:36032
  s_waitcnt lgkmcnt(14)
  v_mfma_f32_32x32x16_bf16 v[140:155], v[132:135], v[84:87], 0
  s_waitcnt lgkmcnt(12)
  v_mfma_f32_32x32x16_bf16 v[140:155], v[136:139], v[88:91], v[140:155]
  ds_read_b64_tr_b16 v[116:117], v241 offset:36288
  ds_read_b64_tr_b16 v[118:119], v241 offset:41696
  ds_read_b64_tr_b16 v[120:121], v242 offset:36288
  ds_read_b64_tr_b16 v[122:123], v243 offset:36288
  s_waitcnt lgkmcnt(14)
  v_mfma_f32_32x32x16_bf16 v[156:171], v[132:135], v[92:95], 0
  s_waitcnt lgkmcnt(12)
  v_mfma_f32_32x32x16_bf16 v[156:171], v[136:139], v[96:99], v[156:171]
  ds_read_b64_tr_b16 v[124:125], v241 offset:36544
  ds_read_b64_tr_b16 v[126:127], v241 offset:41952
  ds_read_b64_tr_b16 v[128:129], v242 offset:36544
  ds_read_b64_tr_b16 v[130:131], v243 offset:36544
  s_waitcnt lgkmcnt(14)
  v_mfma_f32_32x32x16_bf16 v[172:187], v[132:135], v[100:103], 0
  s_waitcnt lgkmcnt(12)
  v_mfma_f32_32x32x16_bf16 v[172:187], v[136:139], v[104:107], v[172:187]
  v_cvt_pk_bf16_f32 v81, v140, 0
  s_waitcnt lgkmcnt(10)
  v_mfma_f32_32x32x16_bf16 v[188:203], v[132:135], v[108:111], 0
  s_waitcnt lgkmcnt(8)
  v_mfma_f32_32x32x16_bf16 v[188:203], v[136:139], v[112:115], v[188:203]
  s_mov_b32 exec_lo, 0
  v_cvt_pk_bf16_f32 v81, v156, 0
  s_mov_b32 exec_lo, -1
  ds_write_b16 v68, v81
  s_waitcnt lgkmcnt(7)
  v_mfma_f32_32x32x16_bf16 v[140:155], v[132:135], v[116:119], 0
  s_waitcnt lgkmcnt(5)
  v_mfma_f32_32x32x16_bf16 v[140:155], v[136:139], v[120:123], v[140:155]
  v_cvt_pk_bf16_f32 v82, v172, 0
  s_waitcnt lgkmcnt(3)
  v_mfma_f32_32x32x16_bf16 v[156:171], v[132:135], v[124:127], 0
  s_waitcnt lgkmcnt(1)
  v_mfma_f32_32x32x16_bf16 v[156:171], v[136:139], v[128:131], v[156:171]
  s_mov_b32 exec_lo, 0
  v_cvt_pk_bf16_f32 v82, v188, 0
  s_mov_b32 exec_lo, -1
  ds_write_b16 v69, v82
  s_nop 2
  v_cvt_pk_bf16_f32 v83, v140, 0
  s_mov_b32 exec_lo, 0
  s_nop 2
  v_cvt_pk_bf16_f32 v83, v156, 0
  s_mov_b64 exec, s[92:93]
  ds_write_b16 v70, v83
  s_mov_b64 exec, 0x3ffffff
  ds_write_b16 v80, v45
  s_mov_b64 exec, -1
  s_waitcnt lgkmcnt(0)
  ds_add_u32 v1, v3 offset:32
  v_cmp_gt_u32 s[92:93], 36, v246
L_csync2:
  ds_read_b32 v4, v2 offset:4
  s_waitcnt lgkmcnt(0)
  v_cmp_gt_u32 vcc, 4, v4
  s_cbranch_vccnz L_csync2
  ds_read_b64_tr_b16 v[84:85], v241 offset:0
  ds_read_b64_tr_b16 v[86:87], v241 offset:5408
  ds_read_b64_tr_b16 v[88:89], v242 offset:0
  ds_read_b64_tr_b16 v[90:91], v243 offset:0
  ds_read_b64_tr_b16 v[92:93], v241 offset:256
  ds_read_b64_tr_b16 v[94:95], v241 offset:5664
  ds_read_b64_tr_b16 v[96:97], v242 offset:256
  ds_read_b64_tr_b16 v[98:99], v243 offset:256
  ds_read_b64_tr_b16 v[100:101], v241 offset:512
  ds_read_b64_tr_b16 v[102:103], v241 offset:5920
  ds_read_b64_tr_b16 v[104:105], v242 offset:512
  ds_read_b64_tr_b16 v[106:107], v243 offset:512
  ds_read_b64_tr_b16 v[108:109], v241 offset:768
  ds_read_b64_tr_b16 v[110:111], v241 offset:6176
  ds_read_b64_tr_b16 v[112:113], v242 offset:768
  ds_read_b64_tr_b16 v[114:115], v243 offset:768
  ds_read_b64_tr_b16 v[116:117], v241 offset:1024
  ds_read_b64_tr_b16 v[118:119], v241 offset:6432
  ds_read_b64_tr_b16 v[120:121], v242 offset:1024
  ds_read_b64_tr_b16 v[122:123], v243 offset:1024
  ds_read_b64_tr_b16 v[124:125], v241 offset:1280
  ds_read_b64_tr_b16 v[126:127], v241 offset:6688
  ds_read_b64_tr_b16 v[128:129], v242 offset:1280
  ds_read_b64_tr_b16 v[130:131], v243 offset:1280
L_csync3:
  ds_read_b32 v4, v2 offset:32
  s_waitcnt lgkmcnt(0)
  v_cmp_gt_u32 vcc, 4, v4
  s_cbranch_vccnz L_csync3
  s_setprio 0
  s_waitcnt vmcnt(2)
  v_lshlrev_b32 v208, 7, v208
  buffer_load_dword v255, v208, s[32:35], 0 offen
  s_waitcnt vmcnt(2)
  v_lshlrev_b32 v209, 7, v209
  buffer_load_dword v255, v209, s[32:35], 0 offen
  s_mov_b64 exec, 131071
  buffer_load_dword v255, v19, s[44:47], s101 offen
  s_mov_b64 exec, -1
  s_add_u32 s101, s101, 1171456
  ds_read_b64_tr_b16 v[132:133], v240 offset:0
  ds_read_b64_tr_b16 v[134:135], v240 offset:256
  ds_read_b64_tr_b16 v[136:137], v240 offset:1024
  ds_read_b64_tr_b16 v[138:139], v240 offset:1280
  s_waitcnt lgkmcnt(2)
  v_mfma_f32_32x32x16_bf16 v[140:155], v[132:135], v[84:87], 0
  s_waitcnt lgkmcnt(0)
  v_mfma_f32_32x32x16_bf16 v[140:155], v[136:139], v[88:91], v[140:155]
  v_mfma_f32_32x32x16_bf16 v[156:171], v[132:135], v[92:95], 0
  v_mfma_f32_32x32x16_bf16 v[156:171], v[136:139], v[96:99], v[156:171]
  v_mfma_f32_32x32x16_bf16 v[172:187], v[132:135], v[100:103], 0
  v_mfma_f32_32x32x16_bf16 v[172:187], v[136:139], v[104:107], v[172:187]
  s_nop 7
  v_cvt_pk_bf16_f32 v84, v140, v141
  v_cvt_pk_bf16_f32 v85, v142, v143
  v_cvt_pk_bf16_f32 v86, v144, v145
  v_cvt_pk_bf16_f32 v87, v146, v147
  v_cvt_pk_bf16_f32 v88, v148, v149
  v_cvt_pk_bf16_f32 v89, v150, v151
  v_cvt_pk_bf16_f32 v90, v152, v153
  v_cvt_pk_bf16_f32 v91, v154, v155
  ds_write2_b32 v72, v84, v85 offset0:0 offset1:1
  v_max3_f32 v62, v62, abs(v140), abs(v141)
  v_max3_f32 v62, v62, abs(v142), abs(v143)
  v_max3_f32 v62, v62, abs(v144), abs(v145)
  ds_write2_b32 v72, v86, v87 offset0:4 offset1:5
  v_max3_f32 v62, v62, abs(v146), abs(v147)
  v_max3_f32 v62, v62, abs(v148), abs(v149)
  ds_write2_b32 v72, v88, v89 offset0:8 offset1:9
  v_max3_f32 v62, v62, abs(v150), abs(v151)
  v_max3_f32 v62, v62, abs(v152), abs(v153)
  v_mfma_f32_32x32x16_bf16 v[188:203], v[132:135], v[108:111], 0
  v_mfma_f32_32x32x16_bf16 v[188:203], v[136:139], v[112:115], v[188:203]
  v_cvt_pk_bf16_f32 v92, v156, v157
  v_cvt_pk_bf16_f32 v93, v158, v159
  v_cvt_pk_bf16_f32 v94, v160, v161
  v_cvt_pk_bf16_f32 v95, v162, v163
  v_cvt_pk_bf16_f32 v96, v164, v165
  v_cvt_pk_bf16_f32 v97, v166, v167
  v_cvt_pk_bf16_f32 v98, v168, v169
  v_cvt_pk_bf16_f32 v99, v170, v171
  ds_write2_b32 v73, v92, v93 offset0:0 offset1:1
  v_max3_f32 v62, v62, abs(v156), abs(v157)
  v_max3_f32 v62, v62, abs(v158), abs(v159)
  v_max3_f32 v62, v62, abs(v160), abs(v161)
  ds_write2_b32 v73, v94, v95 offset0:4 offset1:5
  v_max3_f32 v62, v62, abs(v162), abs(v163)
  v_max3_f32 v62, v62, abs(v164), abs(v165)
  ds_write2_b32 v73, v96, v97 offset0:8 offset1:9
  v_max3_f32 v62, v62, abs(v166), abs(v167)
  v_max3_f32 v62, v62, abs(v168), abs(v169)
  v_mfma_f32_32x32x16_bf16 v[140:155], v[132:135], v[116:119], 0
  v_mfma_f32_32x32x16_bf16 v[140:155], v[136:139], v[120:123], v[140:155]
  v_cvt_pk_bf16_f32 v100, v172, v173
  v_cvt_pk_bf16_f32 v101, v174, v175
  v_cvt_pk_bf16_f32 v102, v176, v177
  v_cvt_pk_bf16_f32 v103, v178, v179
  v_cvt_pk_bf16_f32 v104, v180, v181
  v_cvt_pk_bf16_f32 v105, v182, v183
  v_cvt_pk_bf16_f32 v106, v184, v185
  v_cvt_pk_bf16_f32 v107, v186, v187
  ds_write2_b32 v74, v100, v101 offset0:0 offset1:1
  v_max3_f32 v62, v62, abs(v172), abs(v173)
  v_max3_f32 v62, v62, abs(v174), abs(v175)
  v_max3_f32 v62, v62, abs(v176), abs(v177)
  ds_write2_b32 v74, v102, v103 offset0:4 offset1:5
  v_max3_f32 v62, v62, abs(v178), abs(v179)
  v_max3_f32 v62, v62, abs(v180), abs(v181)
  ds_write2_b32 v74, v104, v105 offset0:8 offset1:9
  v_max3_f32 v62, v62, abs(v182), abs(v183)
  v_max3_f32 v62, v62, abs(v184), abs(v185)
  v_mfma_f32_32x32x16_bf16 v[156:171], v[132:135], v[124:127], 0
  v_mfma_f32_32x32x16_bf16 v[156:171], v[136:139], v[128:131], v[156:171]
  v_cvt_pk_bf16_f32 v108, v188, v189
  v_cvt_pk_bf16_f32 v109, v190, v191
  v_cvt_pk_bf16_f32 v110, v192, v193
  v_cvt_pk_bf16_f32 v111, v194, v195
  v_cvt_pk_bf16_f32 v112, v196, v197
  v_cvt_pk_bf16_f32 v113, v198, v199
  v_cvt_pk_bf16_f32 v114, v200, v201
  v_cvt_pk_bf16_f32 v115, v202, v203
  ds_write2_b32 v75, v108, v109 offset0:0 offset1:1
  v_max3_f32 v62, v62, abs(v188), abs(v189)
  v_max3_f32 v62, v62, abs(v190), abs(v191)
  v_max3_f32 v62, v62, abs(v192), abs(v193)
  ds_write2_b32 v75, v110, v111 offset0:4 offset1:5
  v_max3_f32 v62, v62, abs(v194), abs(v195)
  v_max3_f32 v62, v62, abs(v196), abs(v197)
  ds_write2_b32 v75, v112, v113 offset0:8 offset1:9
  v_max3_f32 v62, v62, abs(v198), abs(v199)
  v_max3_f32 v62, v62, abs(v200), abs(v201)
  v_cvt_pk_bf16_f32 v116, v140, v141
  v_cvt_pk_bf16_f32 v117, v142, v143
  v_cvt_pk_bf16_f32 v118, v144, v145
  v_cvt_pk_bf16_f32 v119, v146, v147
  v_cvt_pk_bf16_f32 v120, v148, v149
  v_cvt_pk_bf16_f32 v121, v150, v151
  v_cvt_pk_bf16_f32 v122, v152, v153
  v_cvt_pk_bf16_f32 v123, v154, v155
  ds_write2_b32 v76, v116, v117 offset0:0 offset1:1
  v_max3_f32 v62, v62, abs(v140), abs(v141)
  v_max3_f32 v62, v62, abs(v142), abs(v143)
  v_max3_f32 v62, v62, abs(v144), abs(v145)
  ds_write2_b32 v76, v118, v119 offset0:4 offset1:5
  v_max3_f32 v62, v62, abs(v146), abs(v147)
  v_max3_f32 v62, v62, abs(v148), abs(v149)
  ds_write2_b32 v76, v120, v121 offset0:8 offset1:9
  v_max3_f32 v62, v62, abs(v150), abs(v151)
  v_max3_f32 v62, v62, abs(v152), abs(v153)
  v_cvt_pk_bf16_f32 v124, v156, v157
  v_cvt_pk_bf16_f32 v125, v158, v159
  v_cvt_pk_bf16_f32 v126, v160, v161
  v_cvt_pk_bf16_f32 v127, v162, v163
  v_cvt_pk_bf16_f32 v128, v164, v165
  v_cvt_pk_bf16_f32 v129, v166, v167
  v_cvt_pk_bf16_f32 v130, v168, v169
  v_cvt_pk_bf16_f32 v131, v170, v171
  s_mov_b64 exec, s[92:93]
  ds_write2_b32 v77, v124, v125 offset0:0 offset1:1
  v_max3_f32 v62, v62, abs(v156), abs(v157)
  v_max3_f32 v62, v62, abs(v158), abs(v159)
  v_max3_f32 v62, v62, abs(v160), abs(v161)
  ds_write2_b32 v77, v126, v127 offset0:4 offset1:5
  v_max3_f32 v62, v62, abs(v162), abs(v163)
  v_max3_f32 v62, v62, abs(v164), abs(v165)
  ds_write2_b32 v77, v128, v129 offset0:8 offset1:9
  v_max3_f32 v62, v62, abs(v166), abs(v167)
  v_max3_f32 v62, v62, abs(v168), abs(v169)
  s_mov_b32 exec_hi, 0
  ds_write_b32 v77, v130 offset:48
  ds_write_b16 v245, v131 offset:1280
  s_mov_b32 exec_lo, -1
  ds_write_b32 v76, v122 offset:48
  ds_write_b16 v245, v123 offset:1024
  ds_write_b32 v75, v114 offset:48
  ds_write_b16 v245, v115 offset:768
  ds_write_b32 v74, v106 offset:48
  ds_write_b16 v245, v107 offset:512
  ds_write_b32 v73, v98 offset:48
  ds_write_b16 v245, v99 offset:256
  ds_write_b32 v72, v90 offset:48
  ds_write_b16 v245, v91 offset:0
  s_mov_b64 exec, -1
  v_max_u32_dpp v62, v62, v62 row_shr:1 row_mask:0xf bank_mask:0xf
  s_nop 1
  v_max_u32_dpp v62, v62, v62 row_shr:2 row_mask:0xf bank_mask:0xf
  s_nop 1
  v_max_u32_dpp v62, v62, v62 row_shr:4 row_mask:0xf bank_mask:0xf
  s_nop 1
  v_max_u32_dpp v62, v62, v62 row_shr:8 row_mask:0xf bank_mask:0xf
  s_nop 1
  v_max_u32_dpp v62, v62, v62 row_bcast:15 row_mask:0xa bank_mask:0xf
  s_nop 1
  v_max_u32_dpp v62, v62, v62 row_bcast:31 row_mask:0xc bank_mask:0xf
  s_nop 0
  v_readlane_b32 s68, v62, 63
  s_nop 1
  v_mov_b32 v62, s68
  ds_max_u32 v1, v62 offset:28
  ds_add_u32 v1, v3 offset:24
  s_setprio 0
  v_lshl_add_u32 v24, v24, 7, v18
  v_lshl_add_u32 v25, v25, 7, v18
  s_mov_b32 exec_hi, 0x0000ffff
  v_lshl_add_u32 v26, v26, 7, v18
  v_lshl_add_u32 v27, v27, 7, v18
  s_mov_b32 exec_lo, 0
  s_mov_b32 exec_hi, 0xffff0000
  v_mov_b32 v27, v25
  v_mov_b32 v26, v25
  s_mov_b32 exec_hi, 0x00ff0000
  v_mov_b32 v26, v24
  s_mov_b64 exec, -1
  s_add_u32 m0, s74, 0
  s_nop 0
  buffer_load_dwordx4 v24, s[32:35], 0 offen lds
  s_add_u32 m0, s74, 1056
  s_nop 0
  buffer_load_dwordx4 v25, s[32:35], 0 offen lds
  s_add_u32 m0, s74, 2112
  s_nop 0
  buffer_load_dwordx4 v26, s[32:35], 0 offen lds
  s_add_u32 m0, s74, 3168
  s_mov_b32 exec_hi, 0x00ffffff
  buffer_load_dwordx4 v27, s[32:35], 0 offen lds
  s_mov_b32 exec_hi, -1
  v_lshl_add_u32 v204, v204, 7, v18
  v_lshl_add_u32 v205, v205, 7, v18
  s_mov_b32 exec_hi, 0x0000ffff
  v_lshl_add_u32 v206, v206, 7, v18
  v_lshl_add_u32 v207, v207, 7, v18
  s_mov_b32 exec_lo, 0
  s_mov_b32 exec_hi, 0xffff0000
  v_mov_b32 v207, v205
  v_mov_b32 v206, v205
  s_mov_b32 exec_hi, 0x00ff0000
  v_mov_b32 v206, v204
  s_mov_b64 exec, -1
  s_add_u32 m0, s74, -16896
  s_nop 0
  buffer_load_dwordx4 v204, s[32:35], 0 offen lds
  s_add_u32 m0, s74, -15840
  s_nop 0
  buffer_load_dwordx4 v205, s[32:35], 0 offen lds
  s_add_u32 m0, s74, -14784
  s_nop 0
  buffer_load_dwordx4 v206, s[32:35], 0 offen lds
  s_add_u32 m0, s74, -13728
  s_mov_b32 exec_hi, 0x00ffffff
  buffer_load_dwordx4 v207, s[32:35], 0 offen lds
  s_mov_b32 exec_hi, -1
  buffer_load_dwordx4 v[24:27], v17, s[28:31], s94 offen offset:0
  s_add_u32 s94, s94, 832
  s_branch L_uph
L_g0pf:
  s_mov_b32 s40, s10
  s_and_b32 s41, s11, 0xffff
  s_mov_b32 s42, 156
  s_mov_b32 s43, 0x20000
  s_mov_b32 m0, 110272
  s_mov_b64 exec, 0x7ff
  buffer_load_dwordx4 v48, s[40:43], 0 offen lds
  s_mov_b64 exec, -1
  s_add_u32 m0, s95, 71552
  s_add_u32 s81, s95, 70304
  buffer_load_dwordx4 v48, s[36:39], s81 offen lds
  s_add_u32 m0, s95, 75648
  s_add_u32 s81, s95, 74400
  buffer_load_dwordx4 v48, s[36:39], s81 offen lds
  s_add_u32 m0, s95, 79744
  s_add_u32 s81, s95, 78496
  buffer_load_dwordx4 v48, s[36:39], s81 offen lds
  s_add_u32 m0, s95, 83840
  s_add_u32 s81, s95, 82592
  buffer_load_dwordx4 v48, s[36:39], s81 offen lds
  s_add_u32 m0, s95, 87936
  s_add_u32 s81, s95, 86688
  buffer_load_dwordx4 v48, s[36:39], s81 offen lds
  s_add_u32 m0, s95, 92032
  s_add_u32 s81, s95, 90784
  buffer_load_dwordx4 v48, s[36:39], s81 offen lds
  s_add_u32 m0, s95, 96128
  s_add_u32 s81, s95, 94880
  buffer_load_dwordx4 v48, s[36:39], s81 offen lds
  s_add_u32 m0, s95, 100224
  s_add_u32 s81, s95, 98976
  buffer_load_dwordx4 v48, s[36:39], s81 offen lds
  s_add_u32 m0, s96, 71552
  s_add_u32 s81, s96, 70304
  s_mov_b64 exec, s[82:83]
  buffer_load_dwordx4 v48, s[36:39], s81 offen lds
  s_mov_b64 exec, -1
  s_mul_i32 s69, s27, 2979
  s_add_u32 m0, s95, 36288
  s_add_u32 s81, s95, 35152
  buffer_load_dwordx4 v48, s[36:39], s81 offen lds
  s_lshr_b32 s69, s69, 6
  s_mul_i32 s98, s27, 44
  s_and_b32 s70, s2, 7
  s_add_u32 s85, s98, s3
  s_lshl_b32 s85, s85, 2
  s_lshl_b32 s98, s70, 14
  s_add_u32 s85, s85, s98
  s_add_u32 m0, s95, 40384
  s_add_u32 s81, s95, 39248
  buffer_load_dwordx4 v48, s[36:39], s81 offen lds
  s_add_u32 s85, s85, 10240
  s_mul_i32 s98, s27, 44
  s_lshl_b32 s77, s70, 9
  s_add_u32 s94, s77, s98
  s_add_u32 s77, s77, s69
  s_add_u32 s94, s94, s3
  s_mul_i32 s94, s94, 104
  s_lshl_b32 s98, s27, 2
  s_add_u32 m0, s95, 44480
  s_add_u32 s81, s95, 43344
  buffer_load_dwordx4 v48, s[36:39], s81 offen lds
  s_add_u32 s98, s98, s3
  s_add_u32 s98, s98, s70
  s_and_b32 s98, s98, 7
  s_mul_i32 s98, s98, 16640
  s_add_u32 s98, s98, 12288
  s_sub_u32 s72, 6, s84
  s_lshl_b32 s99, s84, 1
  s_add_u32 m0, s95, 48576
  s_add_u32 s81, s95, 47440
  buffer_load_dwordx4 v48, s[36:39], s81 offen lds
  s_mov_b32 s26, -1
  v_lshrrev_b32 v43, 3, v0
  v_min_u32 v43, 6, v43
  v_lshlrev_b32 v17, 4, v43
  s_mul_i32 s70, s70, 88
  s_add_u32 s70, s100, s70
  s_mov_b32 s71, 704
  v_mov_b32 v44, s70
  s_add_u32 m0, s95, 52672
  s_add_u32 s81, s95, 51536
  buffer_load_dwordx4 v48, s[36:39], s81 offen lds
  v_mad_u32_u24 v19, v0, s71, v44
  s_mul_i32 s70, s100, 104
  s_sub_u32 s70, s70, 313
  v_min_u32 v44, 16, v0
  v_mul_u32_u24 v45, 26, v44
  v_add_u32 v45, s70, v45
  v_cmp_lt_u32 vcc, 12, v44
  s_nop 1
  v_cndmask_b32 v19, v19, v45, vcc
  s_add_u32 m0, s95, 56768
  s_add_u32 s81, s95, 55632
  buffer_load_dwordx4 v48, s[36:39], s81 offen lds
  v_lshlrev_b32 v19, 7, v19
  s_mov_b32 s101, 638976
  s_mov_b32 s32, s6
  s_and_b32 s33, s7, 0xffff
  s_mov_b32 s34, 12800000
  s_mov_b32 s35, 0x20000
  s_mov_b32 s44, s12
  s_waitcnt vmcnt(6) lgkmcnt(0)
  ds_add_u32 v1, v3 offset:0
  s_and_b32 s45, s13, 0xffff
  s_mov_b32 s46, 5537792
  s_mov_b32 s47, 0x20000
  s_mov_b32 s28, s4
  s_and_b32 s29, s5, 0xffff
  s_mov_b32 s30, 425984
  s_mov_b32 s31, 0x20000
  s_and_b32 s70, s3, 1
  s_add_u32 m0, s95, 60864
  s_add_u32 s81, s95, 59728
  buffer_load_dwordx4 v48, s[36:39], s81 offen lds
  s_lshl_b32 s70, s70, 1
  v_add_u32 v46, s70, v41
  v_min_u32 v43, 25, v42
  s_mul_i32 s68, s84, 4
  s_add_u32 s68, s68, 1352
  s_mul_i32 s69, s84, 70528
  s_add_u32 s69, s69, 1024
  v_mul_u32_u24 v44, s68, v43
  s_add_u32 m0, s95, 64960
  s_add_u32 s81, s95, 63824
  buffer_load_dwordx4 v48, s[36:39], s81 offen lds
  v_add_u32 v44, s69, v44
  v_lshlrev_b32 v247, 2, v43
  v_add_u32 v247, 70528, v247
  s_lshl_b32 s68, s84, 2
  s_xor_b32 s68, s68, 4
  v_lshrrev_b32 v45, 2, v43
  v_and_b32 v45, s68, v45
  s_add_u32 m0, s96, 36288
  s_add_u32 s81, s96, 35152
  s_mov_b64 exec, s[82:83]
  buffer_load_dwordx4 v48, s[36:39], s81 offen lds
  s_mov_b64 exec, -1
  v_add_u32 v44, v44, v45
  v_sub_u32 v247, v247, v45
  v_mul_u32_u24 v65, 52, v43
  v_lshl_add_u32 v65, v46, 1, v65
  v_add_u32 v65, 108864, v65
  v_lshlrev_b32 v67, 1, v43
  v_add_u32 v67, 110272, v67
  v_mad_u32_u24 v60, v46, 52, v44
  s_add_u32 m0, s95, 1024
  s_add_u32 s81, s95, 0
  buffer_load_dwordx4 v48, s[36:39], s81 offen lds
  v_lshl_add_u32 v61, v46, 1, v44
  v_lshl_add_u32 v49, v46, 1, v60
  v_lshlrev_b32 v43, 3, v46
  s_mov_b32 s68, 0x01000100
  v_bfe_i32 v45, s68, v43, 8
  v_lshl_add_u32 v50, v45, 1, v60
  v_mad_i32_i24 v51, v45, 52, v61
  s_mov_b32 s68, 0xff00ff00
  s_add_u32 m0, s95, 5120
  s_add_u32 s81, s95, 4096
  buffer_load_dwordx4 v48, s[36:39], s81 offen lds
  v_bfe_i32 v45, s68, v43, 8
  v_lshl_add_u32 v52, v45, 1, v60
  v_mad_i32_i24 v53, v45, 52, v61
  s_mov_b32 s68, 0xff020100
  v_bfe_i32 v45, s68, v43, 8
  v_lshl_add_u32 v54, v45, 1, v60
  v_mad_i32_i24 v55, v45, 52, v61
  s_add_u32 m0, s95, 9216
  s_add_u32 s81, s95, 8192
  buffer_load_dwordx4 v48, s[36:39], s81 offen lds
  s_mov_b32 s68, 0x0b0a0100
  v_bfe_i32 v45, s68, v43, 8
  v_lshl_add_u32 v56, v45, 1, v60
  v_mad_i32_i24 v57, v45, 52, v61
  s_mov_b32 s68, 0xf3f20100
  v_bfe_i32 v45, s68, v43, 8
  v_lshl_add_u32 v58, v45, 1, v60
  v_mad_i32_i24 v59, v45, 52, v61
  s_waitcnt vmcnt(3) lgkmcnt(0)
  ds_add_u32 v1, v3 offset:4
  s_mov_b32 s68, 0x00023600
  v_bfe_u32 v45, s68, v43, 8
  v_add_u32 v60, v45, v44
  v_add_u32 v61, 52, v44
  v_mov_b32 v47, 1048576
  v_cmp_eq_u32 vcc, 3, v46
  s_nop 1
  v_cndmask_b32 v60, v60, v47, vcc
  v_cndmask_b32 v67, v47, v67, vcc
  s_add_u32 m0, s95, 13312
  s_add_u32 s81, s95, 12288
  buffer_load_dwordx4 v48, s[36:39], s81 offen lds
  v_cmp_eq_u32 vcc, 2, v46
  s_nop 1
  v_cndmask_b32 v61, v47, v61, vcc
  v_cmp_gt_u32 vcc, 2, v46
  s_nop 1
  v_cndmask_b32 v64, v47, v65, vcc
  s_lshr_b32 s69, s79, 1
  s_mul_i32 s69, s69, 6144
  s_mul_i32 s68, s84, 6144
  s_add_u32 m0, s95, 17408
  s_add_u32 s81, s95, 16384
  buffer_load_dwordx4 v48, s[36:39], s81 offen lds
  v_lshlrev_b32 v45, 8, v46
  v_lshl_add_u32 v43, v42, 4, v45
  v_add_u32 v63, 1024, v43
  v_add_u32 v66, 36288, v43
  v_bfe_u32 v43, v0, 2, 2
  v_lshl_add_u32 v45, v43, 4, v45
  v_and_b32 v43, 3, v0
  v_lshl_add_u32 v44, v43, 6, v45
  s_add_u32 m0, s95, 21504
  s_add_u32 s81, s95, 20476
  buffer_load_dwordx4 v248, s[36:39], s81 offen lds
  v_add_u32 v44, 12288, v44
  v_cmp_lt_u32 vcc, 15, v42
  s_nop 1
  v_cndmask_b32 v63, v63, v44, vcc
  v_add_u32 v44, 16, v44
  v_cndmask_b32 v66, v66, v44, vcc
  v_lshl_add_u32 v44, v43, 5, v45
  v_add_u32 v44, 24560, v44
  v_cmp_lt_u32 vcc, 19, v42
  s_add_u32 m0, s95, 25600
  s_add_u32 s81, s95, 24572
  buffer_load_dwordx4 v48, s[36:39], s81 offen lds
  v_cndmask_b32 v63, v63, v44, vcc
  v_add_u32 v63, s69, v63
  v_add_u32 v66, s68, v66
  v_cmp_lt_u32 vcc, 25, v42
  s_nop 1
  v_cndmask_b32 v63, v63, v47, vcc
  v_cndmask_b32 v66, v66, v47, vcc
  v_mov_b32 v62, 0
  s_add_u32 m0, s95, 29696
  s_add_u32 s81, s95, 28668
  buffer_load_dwordx4 v48, s[36:39], s81 offen lds
  s_mul_i32 s74, s3, 4224
  s_add_u32 s74, s74, 111040
  s_mov_b32 s75, -39488
  v_add_u32 v28, 1024, v48
  v_and_b32 v43, 11, v0
  v_cmp_eq_u32 vcc, 11, v43
  s_nop 1
  v_cndmask_b32 v31, v28, v47, vcc
  v_and_b32 v43, 3, v0
  s_add_u32 m0, s96, 1024
  s_lshr_b32 s81, s96, 13
  s_sub_u32 s81, s96, s81
  s_mov_b64 exec, s[82:83]
  buffer_load_dwordx4 v48, s[36:39], s81 offen lds
  s_mov_b64 exec, -1
  v_cmp_eq_u32 vcc, 0, v43
  s_nop 1
  v_cndmask_b32 v30, v31, v47, vcc
  v_lshrrev_b32 v46, 4, v0
  v_bfe_u32 v43, v0, 1, 3
  v_lshlrev_b32 v45, 4, v43
  v_add_u32 v45, 24576, v45
  v_and_b32 v43, 10, v0
  v_cmp_eq_u32 vcc, 10, v43
  s_nop 1
  v_cndmask_b32 v45, v45, v47, vcc
  v_and_b32 v44, 1, v0
  v_lshl_add_u32 v29, v46, 9, v45
  v_lshl_add_u32 v29, v44, 2, v29
  v_add_u32 v29, 1024, v29
  v_lshl_add_u32 v22, v46, 8, v45
  v_lshl_add_u32 v22, v44, 20, v22
  v_and_b32 v47, 15, v0
  s_mov_b32 s68, 1056
  v_lshlrev_b32 v43, 1, v47
  v_add_u32 v43, s74, v43
  v_mad_u32_u24 v7, v46, s68, v43
  s_lshl_b32 s68, s3, 10
  s_add_u32 s68, s68, 144832
  v_add_u32 v10, s68, v48
  v_add_u32 v43, 256, v48
  v_and_b32 v43, 1023, v43
  v_add_u32 v11, s68, v43
  v_xor_b32 v43, 512, v48
  v_add_u32 v12, s68, v43
  v_lshlrev_b32 v13, 4, v41
  v_mov_b32 v32, 0
  v_mov_b32 v33, 0
  v_mov_b32 v34, 0
  v_mov_b32 v35, 0
  v_mov_b32 v36, 0
  v_mov_b32 v37, 0
  v_mov_b32 v38, 0
  v_mov_b32 v39, 0
  v_mov_b32 v216, 0
  v_mov_b32 v217, 0
  v_mov_b32 v218, 0
  v_mov_b32 v219, 0
  v_mov_b32 v220, 0
  v_mov_b32 v221, 0
  v_mov_b32 v222, 0
  v_mov_b32 v223, 0
  v_mov_b32 v224, 0
  v_mov_b32 v225, 0
  v_mov_b32 v226, 0
  v_mov_b32 v227, 0
  v_mov_b32 v228, 0
  v_mov_b32 v229, 0
  v_mov_b32 v230, 0
  v_mov_b32 v231, 0
  v_mov_b32 v232, 0
  v_mov_b32 v233, 0
  v_mov_b32 v234, 0
  v_mov_b32 v235, 0
  v_mov_b32 v236, 0
  v_mov_b32 v237, 0
  v_mov_b32 v238, 0
  v_mov_b32 v239, 0
  v_mul_u32_u24 v44, 1056, v46
  v_bfe_u32 v45, v0, 2, 2
  v_lshl_add_u32 v44, v45, 7, v44
  v_and_b32 v45, 3, v0
  v_lshl_add_u32 v9, v45, 3, v44
  v_add_u32 v8, s74, v9
  v_and_b32 v45, 1, v0
  s_mov_b32 s68, 0xaaaaaaaa
  v_mul_lo_u32 v16, s68, v45
  v_or_b32 v16, 0x44444444, v16
  v_lshlrev_b32 v15, 1, v0
  v_add_u32 v15, s74, v15
  v_mov_b32 v14, 0x3f80
  ds_write_b16 v15, v14 offset:4064
  v_add_u32 v15, s75, v15
  s_mul_i32 s71, s3, 6
  s_add_u32 s77, s77, s71
  s_mul_i32 s77, s77, 104
  s_add_u32 s73, s77, 80
  s_add_u32 s77, s77, 16
  s_mov_b32 s71, 10923
  v_min_u32 v43, 35, v0
  v_mul_u32_u24 v44, s71, v43
  v_lshrrev_b32 v44, 16, v44
  v_mul_u32_u24 v44, 80, v44
  v_lshl_add_u32 v20, v43, 2, v44
  s_add_u32 s94, s94, 832
  s_add_u32 s77, s77, 24
  buffer_load_dwordx4 v[24:27], v17, s[28:31], s94 offen offset:0
  s_add_u32 s94, s94, 832
  buffer_load_dword v21, v20, s[28:31], s77 offen
  s_cmp_eq_u32 s77, s73
  s_cselect_b32 s73, 0x7000000, s73
  s_cselect_b32 s77, 0x7000000, s77
  s_add_u32 s77, s77, 24
  s_min_u32 s77, s77, s73
  s_mov_b64 exec, 131071
  buffer_load_dword v255, v19, s[44:47], s101 offen
  s_mov_b64 exec, -1
  s_add_u32 s101, s101, 1171456
  s_waitcnt vmcnt(3) lgkmcnt(0)
  ds_add_u32 v1, v3 offset:8
  s_mov_b32 s97, 0
L_csync4:
  ds_read_b32 v4, v2 offset:8
  s_waitcnt lgkmcnt(0)
  v_cmp_gt_u32 vcc, 4, v4
  s_cbranch_vccnz L_csync4
  s_cmp_ge_u32 s79, 2
  s_cbranch_scc1 L_chunk2
L_chunk0:
  ds_read_u16_d16_hi v216, v49 offset:0
  ds_read_u16_d16_hi v218, v49 offset:648
  ds_read_u16_d16_hi v220, v49 offset:216
  ds_read_u16_d16_hi v222, v49 offset:864
  ds_read_u16_d16_hi v224, v49 offset:432
  ds_read_u16_d16_hi v226, v49 offset:1080
  ds_read_u16_d16_hi v228, v49 offset:8
  ds_read_u16_d16_hi v229, v49 offset:208
  ds_read_u16_d16_hi v230, v49 offset:656
  ds_read_u16_d16_hi v231, v49 offset:856
  ds_read_u16_d16_hi v232, v49 offset:32
  ds_read_u16_d16_hi v233, v49 offset:832
  ds_read_u16_d16_hi v234, v49 offset:632
  ds_read_u16_d16_hi v235, v49 offset:232
  s_waitcnt lgkmcnt(12)
  v_mov_b32 v85, v218
  v_mov_b32 v84, v216
  v_max3_f32 v62, v62, abs(v84), abs(v85)
  ds_read_u16_d16_hi v236, v49 offset:16
  ds_read_u16_d16_hi v237, v49 offset:416
  ds_read_u16_d16_hi v238, v49 offset:664
  ds_read_u16_d16_hi v239, v49 offset:1064
  s_waitcnt lgkmcnt(14)
  v_mov_b32 v87, v222
  v_mov_b32 v86, v220
  v_max3_f32 v62, v62, abs(v86), abs(v87)
  ds_read_u16_d16_hi v216, v49 offset:40
  ds_read_u16_d16_hi v217, v49 offset:1040
  ds_read_u16_d16_hi v218, v49 offset:640
  ds_read_u16_d16_hi v219, v49 offset:440
  s_waitcnt lgkmcnt(14)
  v_mov_b32 v89, v226
  v_mov_b32 v88, v224
  v_max3_f32 v62, v62, abs(v88), abs(v89)
  ds_read_u16_d16_hi v220, v49 offset:224
  ds_read_u16_d16_hi v221, v49 offset:424
  ds_read_u16_d16_hi v222, v49 offset:872
  ds_read_u16_d16_hi v223, v49 offset:1072
  s_waitcnt lgkmcnt(14)
  v_add_f32 v91, v230, v231
  v_add_f32 v90, v228, v229
  v_max3_f32 v62, v62, abs(v90), abs(v91)
  ds_read_u16_d16_hi v224, v49 offset:248
  ds_read_u16_d16_hi v225, v49 offset:1048
  ds_read_u16_d16_hi v226, v49 offset:848
  ds_read_u16_d16_hi v227, v49 offset:448
  s_waitcnt lgkmcnt(14)
  v_add_f32 v93, v234, v235
  v_add_f32 v92, v232, v233
  v_max3_f32 v62, v62, abs(v92), abs(v93)
  ds_read_u16_d16_hi v228, v50 offset:48
  ds_read_u16_d16_hi v229, v51 offset:1248
  ds_read_u16_d16_hi v230, v50 offset:672
  ds_read_u16_d16_hi v231, v51 offset:1272
  s_waitcnt lgkmcnt(14)
  v_add_f32 v95, v238, v239
  v_add_f32 v94, v236, v237
  v_max3_f32 v62, v62, abs(v94), abs(v95)
  ds_read_u16_d16_hi v232, v50 offset:256
  ds_read_u16_d16_hi v233, v51 offset:1256
  ds_read_u16_d16_hi v234, v50 offset:880
  ds_read_u16_d16_hi v235, v51 offset:1280
  s_waitcnt lgkmcnt(14)
  v_add_f32 v97, v218, v219
  v_add_f32 v96, v216, v217
  v_max3_f32 v62, v62, abs(v96), abs(v97)
  ds_read_u16_d16_hi v236, v50 offset:464
  ds_read_u16_d16_hi v237, v51 offset:1264
  ds_read_u16_d16_hi v238, v50 offset:1088
  ds_read_u16_d16_hi v239, v51 offset:1288
  s_waitcnt lgkmcnt(14)
  v_add_f32 v99, v222, v223
  v_add_f32 v98, v220, v221
  v_max3_f32 v62, v62, abs(v98), abs(v99)
  s_waitcnt lgkmcnt(12)
  v_add_f32 v101, v226, v227
  v_add_f32 v100, v224, v225
  v_max3_f32 v62, v62, abs(v100), abs(v101)
  s_waitcnt lgkmcnt(8)
  v_add_f32 v103, v230, v231
  v_add_f32 v102, v228, v229
  v_max3_f32 v62, v62, abs(v102), abs(v103)
  s_waitcnt lgkmcnt(4)
  v_add_f32 v105, v234, v235
  v_add_f32 v104, v232, v233
  v_max3_f32 v62, v62, abs(v104), abs(v105)
  s_waitcnt lgkmcnt(0)
  v_add_f32 v107, v238, v239
  v_add_f32 v106, v236, v237
  v_max3_f32 v62, v62, abs(v106), abs(v107)
  s_cmp_lg_u32 s97, 0
  s_cbranch_scc1 L_uconv0
L_chunk1:
  ds_read_u16_d16_hi v216, v49 offset:24
  ds_read_u16_d16_hi v217, v49 offset:624
  ds_read_u16_d16_hi v218, v49 offset:240
  ds_read_u16_d16_hi v219, v49 offset:840
  ds_read_u16_d16_hi v220, v49 offset:456
  ds_read_u16_d16_hi v221, v49 offset:1056
  ds_read_u16_d16_hi v222, v60 offset:1296
  ds_read_u16_d16_hi v223, v61 offset:1296
  ds_read_u16_d16_hi v224, v52 offset:50
  ds_read_u16_d16_hi v225, v53 offset:1300
  ds_read_u16_d16_hi v226, v52 offset:674
  ds_read_u16_d16_hi v227, v53 offset:1324
  ds_read_u16_d16_hi v228, v52 offset:258
  ds_read_u16_d16_hi v229, v53 offset:1308
  ds_read_u16_d16_hi v230, v52 offset:882
  ds_read_u16_d16_hi v231, v53 offset:1332
  ds_read_u16_d16_hi v232, v52 offset:466
  ds_read_u16_d16_hi v233, v53 offset:1316
  ds_read_u16_d16_hi v234, v52 offset:1090
  ds_read_u16_d16_hi v235, v53 offset:1340
  s_waitcnt lgkmcnt(14)
  v_add_f32 v109, v218, v219
  v_add_f32 v108, v216, v217
  v_max3_f32 v62, v62, abs(v108), abs(v109)
  ds_read_u16_d16_hi v236, v54 offset:2
  ds_read_u16_d16_hi v237, v55 offset:52
  ds_read_u16_d16_hi v238, v54 offset:650
  ds_read_u16_d16_hi v239, v55 offset:700
  s_waitcnt lgkmcnt(14)
  v_add_f32 v111, v222, v223
  v_add_f32 v110, v220, v221
  v_max3_f32 v62, v62, abs(v110), abs(v111)
  ds_read_u16_d16_hi v216, v54 offset:26
  ds_read_u16_d16_hi v217, v55 offset:676
  ds_read_u16_d16_hi v218, v54 offset:626
  ds_read_u16_d16_hi v219, v55 offset:76
  s_waitcnt lgkmcnt(14)
  v_add_f32 v113, v226, v227
  v_add_f32 v112, v224, v225
  v_max3_f32 v62, v62, abs(v112), abs(v113)
  ds_read_u16_d16_hi v220, v54 offset:10
  ds_read_u16_d16_hi v221, v55 offset:260
  ds_read_u16_d16_hi v222, v54 offset:658
  ds_read_u16_d16_hi v223, v55 offset:908
  s_waitcnt lgkmcnt(14)
  v_add_f32 v115, v230, v231
  v_add_f32 v114, v228, v229
  v_max3_f32 v62, v62, abs(v114), abs(v115)
  ds_read_u16_d16_hi v224, v54 offset:34
  ds_read_u16_d16_hi v225, v55 offset:884
  ds_read_u16_d16_hi v226, v54 offset:634
  ds_read_u16_d16_hi v227, v55 offset:284
  s_waitcnt lgkmcnt(14)
  v_add_f32 v117, v234, v235
  v_add_f32 v116, v232, v233
  v_max3_f32 v62, v62, abs(v116), abs(v117)
  ds_read_u16_d16_hi v228, v54 offset:18
  ds_read_u16_d16_hi v229, v55 offset:468
  ds_read_u16_d16_hi v230, v54 offset:666
  ds_read_u16_d16_hi v231, v55 offset:1116
  s_waitcnt lgkmcnt(14)
  v_add_f32 v119, v238, v239
  v_add_f32 v118, v236, v237
  v_max3_f32 v62, v62, abs(v118), abs(v119)
  ds_read_u16_d16_hi v232, v54 offset:42
  ds_read_u16_d16_hi v233, v55 offset:1092
  ds_read_u16_d16_hi v234, v54 offset:642
  ds_read_u16_d16_hi v235, v55 offset:492
  s_waitcnt lgkmcnt(14)
  v_add_f32 v121, v218, v219
  v_add_f32 v120, v216, v217
  v_max3_f32 v62, v62, abs(v120), abs(v121)
  ds_read_u16_d16_hi v236, v54 offset:210
  ds_read_u16_d16_hi v237, v55 offset:60
  ds_read_u16_d16_hi v238, v54 offset:858
  ds_read_u16_d16_hi v239, v55 offset:708
  s_waitcnt lgkmcnt(14)
  v_add_f32 v123, v222, v223
  v_add_f32 v122, v220, v221
  v_max3_f32 v62, v62, abs(v122), abs(v123)
  s_waitcnt lgkmcnt(12)
  v_add_f32 v125, v226, v227
  v_add_f32 v124, v224, v225
  v_max3_f32 v62, v62, abs(v124), abs(v125)
  s_waitcnt lgkmcnt(8)
  v_add_f32 v127, v230, v231
  v_add_f32 v126, v228, v229
  v_max3_f32 v62, v62, abs(v126), abs(v127)
  s_waitcnt lgkmcnt(4)
  v_add_f32 v129, v234, v235
  v_add_f32 v128, v232, v233
  v_max3_f32 v62, v62, abs(v128), abs(v129)
  s_waitcnt lgkmcnt(0)
  v_add_f32 v131, v238, v239
  v_add_f32 v130, v236, v237
  v_max3_f32 v62, v62, abs(v130), abs(v131)
  s_cmp_lg_u32 s97, 0
  s_cbranch_scc1 L_uconv1
  s_branch L_w1conv
L_chunk2:
  ds_read_u16_d16_hi v216, v54 offset:234
  ds_read_u16_d16_hi v217, v55 offset:684
  ds_read_u16_d16_hi v218, v54 offset:834
  ds_read_u16_d16_hi v219, v55 offset:84
  ds_read_u16_d16_hi v220, v54 offset:218
  ds_read_u16_d16_hi v221, v55 offset:268
  ds_read_u16_d16_hi v222, v54 offset:866
  ds_read_u16_d16_hi v223, v55 offset:916
  ds_read_u16_d16_hi v224, v54 offset:242
  ds_read_u16_d16_hi v225, v55 offset:892
  ds_read_u16_d16_hi v226, v54 offset:842
  ds_read_u16_d16_hi v227, v55 offset:292
  ds_read_u16_d16_hi v228, v54 offset:226
  ds_read_u16_d16_hi v229, v55 offset:476
  ds_read_u16_d16_hi v230, v54 offset:874
  ds_read_u16_d16_hi v231, v55 offset:1124
  ds_read_u16_d16_hi v232, v54 offset:250
  ds_read_u16_d16_hi v233, v55 offset:1100
  ds_read_u16_d16_hi v234, v54 offset:850
  ds_read_u16_d16_hi v235, v55 offset:500
  s_waitcnt lgkmcnt(14)
  v_add_f32 v85, v218, v219
  v_add_f32 v84, v216, v217
  v_max3_f32 v62, v62, abs(v84), abs(v85)
  ds_read_u16_d16_hi v236, v54 offset:418
  ds_read_u16_d16_hi v237, v55 offset:68
  ds_read_u16_d16_hi v238, v54 offset:1066
  ds_read_u16_d16_hi v239, v55 offset:716
  s_waitcnt lgkmcnt(14)
  v_add_f32 v87, v222, v223
  v_add_f32 v86, v220, v221
  v_max3_f32 v62, v62, abs(v86), abs(v87)
  ds_read_u16_d16_hi v216, v54 offset:442
  ds_read_u16_d16_hi v217, v55 offset:692
  ds_read_u16_d16_hi v218, v54 offset:1042
  ds_read_u16_d16_hi v219, v55 offset:92
  s_waitcnt lgkmcnt(14)
  v_add_f32 v89, v226, v227
  v_add_f32 v88, v224, v225
  v_max3_f32 v62, v62, abs(v88), abs(v89)
  ds_read_u16_d16_hi v220, v54 offset:426
  ds_read_u16_d16_hi v221, v55 offset:276
  ds_read_u16_d16_hi v222, v54 offset:1074
  ds_read_u16_d16_hi v223, v55 offset:924
  s_waitcnt lgkmcnt(14)
  v_add_f32 v91, v230, v231
  v_add_f32 v90, v228, v229
  v_max3_f32 v62, v62, abs(v90), abs(v91)
  ds_read_u16_d16_hi v224, v54 offset:450
  ds_read_u16_d16_hi v225, v55 offset:900
  ds_read_u16_d16_hi v226, v54 offset:1050
  ds_read_u16_d16_hi v227, v55 offset:300
  s_waitcnt lgkmcnt(14)
  v_add_f32 v93, v234, v235
  v_add_f32 v92, v232, v233
  v_max3_f32 v62, v62, abs(v92), abs(v93)
  ds_read_u16_d16_hi v228, v54 offset:434
  ds_read_u16_d16_hi v229, v55 offset:484
  ds_read_u16_d16_hi v230, v54 offset:1082
  ds_read_u16_d16_hi v231, v55 offset:1132
  s_waitcnt lgkmcnt(14)
  v_add_f32 v95, v238, v239
  v_add_f32 v94, v236, v237
  v_max3_f32 v62, v62, abs(v94), abs(v95)
  ds_read_u16_d16_hi v232, v54 offset:458
  ds_read_u16_d16_hi v233, v55 offset:1108
  ds_read_u16_d16_hi v234, v54 offset:1058
  ds_read_u16_d16_hi v235, v55 offset:508
  s_waitcnt lgkmcnt(14)
  v_add_f32 v97, v218, v219
  v_add_f32 v96, v216, v217
  v_max3_f32 v62, v62, abs(v96), abs(v97)
  ds_read_u16_d16_hi v236, v56 offset:4
  ds_read_u16_d16_hi v237, v57 offset:104
  ds_read_u16_d16_hi v238, v58 offset:652
  ds_read_u16_d16_hi v239, v59 offset:752
  s_waitcnt lgkmcnt(14)
  v_add_f32 v99, v222, v223
  v_add_f32 v98, v220, v221
  v_max3_f32 v62, v62, abs(v98), abs(v99)
  s_waitcnt lgkmcnt(12)
  v_add_f32 v101, v226, v227
  v_add_f32 v100, v224, v225
  v_max3_f32 v62, v62, abs(v100), abs(v101)
  s_waitcnt lgkmcnt(8)
  v_add_f32 v103, v230, v231
  v_add_f32 v102, v228, v229
  v_max3_f32 v62, v62, abs(v102), abs(v103)
  s_waitcnt lgkmcnt(4)
  v_add_f32 v105, v234, v235
  v_add_f32 v104, v232, v233
  v_max3_f32 v62, v62, abs(v104), abs(v105)
  s_waitcnt lgkmcnt(0)
  v_add_f32 v107, v238, v239
  v_add_f32 v106, v236, v237
  v_max3_f32 v62, v62, abs(v106), abs(v107)
  s_cmp_lg_u32 s97, 0
  s_cbranch_scc1 L_uconv0
L_chunk3:
  ds_read_u16_d16_hi v216, v56 offset:220
  ds_read_u16_d16_hi v217, v57 offset:320
  ds_read_u16_d16_hi v218, v58 offset:868
  ds_read_u16_d16_hi v219, v59 offset:968
  ds_read_u16_d16_hi v220, v56 offset:436
  ds_read_u16_d16_hi v221, v57 offset:536
  ds_read_u16_d16_hi v222, v58 offset:1084
  ds_read_u16_d16_hi v223, v59 offset:1184
  ds_read_u16_d16_hi v224, v56 offset:12
  ds_read_u16_d16_hi v225, v57 offset:312
  ds_read_u16_d16_hi v226, v58 offset:660
  ds_read_u16_d16_hi v227, v59 offset:960
  ds_read_u16_d16_hi v228, v58 offset:36
  ds_read_u16_d16_hi v229, v59 offset:936
  ds_read_u16_d16_hi v230, v56 offset:636
  ds_read_u16_d16_hi v231, v57 offset:336
  ds_read_u16_d16_hi v232, v56 offset:20
  ds_read_u16_d16_hi v233, v57 offset:520
  ds_read_u16_d16_hi v234, v58 offset:668
  ds_read_u16_d16_hi v235, v59 offset:1168
  s_waitcnt lgkmcnt(14)
  v_add_f32 v109, v218, v219
  v_add_f32 v108, v216, v217
  v_max3_f32 v62, v62, abs(v108), abs(v109)
  ds_read_u16_d16_hi v236, v58 offset:44
  ds_read_u16_d16_hi v237, v59 offset:1144
  ds_read_u16_d16_hi v238, v56 offset:644
  ds_read_u16_d16_hi v239, v57 offset:544
  s_waitcnt lgkmcnt(14)
  v_add_f32 v111, v222, v223
  v_add_f32 v110, v220, v221
  v_max3_f32 v62, v62, abs(v110), abs(v111)
  ds_read_u16_d16_hi v216, v56 offset:228
  ds_read_u16_d16_hi v217, v57 offset:528
  ds_read_u16_d16_hi v218, v58 offset:876
  ds_read_u16_d16_hi v219, v59 offset:1176
  s_waitcnt lgkmcnt(14)
  v_add_f32 v113, v226, v227
  v_add_f32 v112, v224, v225
  v_max3_f32 v62, v62, abs(v112), abs(v113)
  ds_read_u16_d16_hi v220, v58 offset:252
  ds_read_u16_d16_hi v221, v59 offset:1152
  ds_read_u16_d16_hi v222, v56 offset:852
  ds_read_u16_d16_hi v223, v57 offset:552
  s_waitcnt lgkmcnt(14)
  v_add_f32 v115, v230, v231
  v_add_f32 v114, v228, v229
  v_max3_f32 v62, v62, abs(v114), abs(v115)
  ds_read_u16_d16_hi v224, v65 offset:0
  ds_read_u16_d16_hi v225, v65 offset:8
  ds_read_u16_d16_hi v226, v65 offset:16
  ds_read_u16_d16_hi v227, v65 offset:24
  ds_read_u16_d16_hi v228, v65 offset:32
  ds_read_u16_d16_hi v229, v65 offset:40
  ds_read_u16_d16_hi v230, v64 offset:48
  ds_read_u16_d16_hi v231, v67
  s_waitcnt lgkmcnt(14)
  v_add_f32 v117, v234, v235
  v_add_f32 v116, v232, v233
  v_max3_f32 v62, v62, abs(v116), abs(v117)
  v_add_f32 v119, v238, v239
  v_add_f32 v118, v236, v237
  v_max3_f32 v62, v62, abs(v118), abs(v119)
  s_waitcnt lgkmcnt(12)
  v_add_f32 v121, v218, v219
  v_add_f32 v120, v216, v217
  v_max3_f32 v62, v62, abs(v120), abs(v121)
  s_waitcnt lgkmcnt(8)
  v_add_f32 v123, v222, v223
  v_add_f32 v122, v220, v221
  v_max3_f32 v62, v62, abs(v122), abs(v123)
  s_cmp_lg_u32 s97, 0
  s_cbranch_scc1 L_uconv1
L_w1conv:
  v_max_u32_dpp v62, v62, v62 row_shr:1 row_mask:0xf bank_mask:0xf
  s_nop 1
  v_max_u32_dpp v62, v62, v62 row_shr:2 row_mask:0xf bank_mask:0xf
  s_nop 1
  v_max_u32_dpp v62, v62, v62 row_shr:4 row_mask:0xf bank_mask:0xf
  s_nop 1
  v_max_u32_dpp v62, v62, v62 row_shr:8 row_mask:0xf bank_mask:0xf
  s_nop 1
  v_max_u32_dpp v62, v62, v62 row_bcast:15 row_mask:0xa bank_mask:0xf
  s_nop 1
  v_max_u32_dpp v62, v62, v62 row_bcast:31 row_mask:0xc bank_mask:0xf
  s_nop 0
  v_readlane_b32 s68, v62, 63
  s_nop 1
  v_mov_b32 v62, s68
  ds_max_u32 v1, v62 offset:20
  ds_add_u32 v1, v3 offset:16
  v_add_u32 v49, v49, v247
  v_add_u32 v50, v50, v247
  v_add_u32 v51, v51, v247
  v_add_u32 v52, v52, v247
  v_add_u32 v53, v53, v247
  v_add_u32 v54, v54, v247
  v_add_u32 v55, v55, v247
  v_add_u32 v56, v56, v247
  v_add_u32 v57, v57, v247
  v_add_u32 v58, v58, v247
  v_add_u32 v59, v59, v247
  v_add_u32 v60, v60, v247
  v_add_u32 v61, v61, v247
L_csync5:
  ds_read_b64 v[40:41], v2 offset:16
  s_waitcnt lgkmcnt(0)
  v_cmp_gt_u32 vcc, 4, v40
  s_cbranch_vccnz L_csync5
  v_readfirstlane_b32 s70, v41
  s_nop 0
  s_lshr_b32 s70, s70, 23
  s_sub_i32 s70, 141, s70
  s_min_i32 s70, s70, 40
  s_add_i32 s51, s70, 127
  s_lshl_b32 s51, s51, 23
  v_fma_mixlo_f16 v132, v84, s51, 0
  v_fma_mixlo_f16 v133, v86, s51, 0
  v_fma_mixlo_f16 v134, v88, s51, 0
  v_fma_mixlo_f16 v135, v90, s51, 0
  v_fma_mixhi_f16 v132, v85, s51, 0
  v_fma_mixhi_f16 v133, v87, s51, 0
  v_fma_mixhi_f16 v134, v89, s51, 0
  v_fma_mixhi_f16 v135, v91, s51, 0
  v_fma_mixlo_f16 v136, v92, s51, 0
  v_fma_mixlo_f16 v137, v94, s51, 0
  v_fma_mixlo_f16 v138, v96, s51, 0
  v_fma_mixlo_f16 v139, v98, s51, 0
  v_fma_mixhi_f16 v136, v93, s51, 0
  v_fma_mixhi_f16 v137, v95, s51, 0
  v_fma_mixhi_f16 v138, v97, s51, 0
  v_fma_mixhi_f16 v139, v99, s51, 0
  ds_write_b128 v63, v[132:135] offset:0
  v_fma_mixlo_f16 v140, v100, s51, 0
  v_fma_mixlo_f16 v141, v102, s51, 0
  v_fma_mixlo_f16 v142, v104, s51, 0
  v_fma_mixlo_f16 v143, v106, s51, 0
  v_fma_mixhi_f16 v140, v101, s51, 0
  v_fma_mixhi_f16 v141, v103, s51, 0
  v_fma_mixhi_f16 v142, v105, s51, 0
  v_fma_mixhi_f16 v143, v107, s51, 0
  ds_write_b128 v63, v[136:139] offset:1024
  v_fma_mixlo_f16 v144, v108, s51, 0
  v_fma_mixlo_f16 v145, v110, s51, 0
  v_fma_mixlo_f16 v146, v112, s51, 0
  v_fma_mixlo_f16 v147, v114, s51, 0
  v_fma_mixhi_f16 v144, v109, s51, 0
  v_fma_mixhi_f16 v145, v111, s51, 0
  v_fma_mixhi_f16 v146, v113, s51, 0
  v_fma_mixhi_f16 v147, v115, s51, 0
  ds_write_b128 v63, v[140:143] offset:2048
  v_fma_mixlo_f16 v148, v116, s51, 0
  v_fma_mixlo_f16 v149, v118, s51, 0
  v_fma_mixlo_f16 v150, v120, s51, 0
  v_fma_mixlo_f16 v151, v122, s51, 0
  v_fma_mixhi_f16 v148, v117, s51, 0
  v_fma_mixhi_f16 v149, v119, s51, 0
  v_fma_mixhi_f16 v150, v121, s51, 0
  v_fma_mixhi_f16 v151, v123, s51, 0
  ds_write_b128 v63, v[144:147] offset:3072
  ds_write_b128 v63, v[148:151] offset:4096
  s_cmp_ge_u32 s79, 2
  s_cbranch_scc1 L_w1x
  v_fma_mixlo_f16 v152, v124, s51, 0
  v_fma_mixlo_f16 v153, v126, s51, 0
  v_fma_mixlo_f16 v154, v128, s51, 0
  v_fma_mixlo_f16 v155, v130, s51, 0
  v_fma_mixhi_f16 v152, v125, s51, 0
  v_fma_mixhi_f16 v153, v127, s51, 0
  v_fma_mixhi_f16 v154, v129, s51, 0
  v_fma_mixhi_f16 v155, v131, s51, 0
  ds_write_b128 v63, v[152:155] offset:5120
L_w1x:
L_uph:
L_csync6:
  ds_read_b64 v[40:41], v2 offset:24
  s_waitcnt lgkmcnt(0)
  v_cmp_gt_u32 vcc, 4, v40
  s_cbranch_vccnz L_csync6
  v_readfirstlane_b32 s71, v41
  s_nop 0
  s_lshr_b32 s71, s71, 23
  s_sub_i32 s71, 140, s71
  s_min_i32 s71, s71, 40
  s_add_i32 s51, s71, 127
  s_lshl_b32 s51, s51, 23
  s_mov_b32 s97, 1
  s_lshr_b32 s69, s3, 1
  s_cmp_eq_u32 s69, 0
  s_cbranch_scc1 L_chunk0
  s_cmp_eq_u32 s69, 1
  s_cbranch_scc1 L_chunk1
  s_cmp_eq_u32 s69, 2
  s_cbranch_scc1 L_chunk2
  s_branch L_chunk3
L_uconv0:
  v_fma_mixlo_f16 v132, v84, s51, 0
  v_fma_mixlo_f16 v133, v86, s51, 0
  v_fma_mixlo_f16 v134, v88, s51, 0
  v_fma_mixlo_f16 v135, v90, s51, 0
  v_fma_mixhi_f16 v132, v85, s51, 0
  v_fma_mixhi_f16 v133, v87, s51, 0
  v_fma_mixhi_f16 v134, v89, s51, 0
  v_fma_mixhi_f16 v135, v91, s51, 0
L_csync7:
  ds_read_b64 v[40:41], v2 offset:16
  s_waitcnt lgkmcnt(0)
  v_cmp_gt_u32 vcc, 4, v40
  s_cbranch_vccnz L_csync7
  v_readfirstlane_b32 s70, v41
  s_nop 0
  s_lshr_b32 s70, s70, 23
  s_sub_i32 s70, 141, s70
  s_min_i32 s70, s70, 40
  ds_write_b128 v66, v[132:135] offset:0
  v_fma_mixlo_f16 v136, v92, s51, 0
  v_fma_mixlo_f16 v137, v94, s51, 0
  v_fma_mixlo_f16 v138, v96, s51, 0
  v_fma_mixlo_f16 v139, v98, s51, 0
  v_fma_mixhi_f16 v136, v93, s51, 0
  v_fma_mixhi_f16 v137, v95, s51, 0
  v_fma_mixhi_f16 v138, v97, s51, 0
  v_fma_mixhi_f16 v139, v99, s51, 0
  ds_write_b128 v66, v[136:139] offset:1024
  v_fma_mixlo_f16 v140, v100, s51, 0
  v_fma_mixlo_f16 v141, v102, s51, 0
  v_fma_mixlo_f16 v142, v104, s51, 0
  v_fma_mixlo_f16 v143, v106, s51, 0
  v_fma_mixhi_f16 v140, v101, s51, 0
  v_fma_mixhi_f16 v141, v103, s51, 0
  v_fma_mixhi_f16 v142, v105, s51, 0
  v_fma_mixhi_f16 v143, v107, s51, 0
  ds_write_b128 v66, v[140:143] offset:2048
  s_branch L_built
L_uconv1:
  v_fma_mixlo_f16 v144, v108, s51, 0
  v_fma_mixlo_f16 v145, v110, s51, 0
  v_fma_mixlo_f16 v146, v112, s51, 0
  v_fma_mixlo_f16 v147, v114, s51, 0
  v_fma_mixhi_f16 v144, v109, s51, 0
  v_fma_mixhi_f16 v145, v111, s51, 0
  v_fma_mixhi_f16 v146, v113, s51, 0
  v_fma_mixhi_f16 v147, v115, s51, 0
L_csync8:
  ds_read_b64 v[40:41], v2 offset:16
  s_waitcnt lgkmcnt(0)
  v_cmp_gt_u32 vcc, 4, v40
  s_cbranch_vccnz L_csync8
  v_readfirstlane_b32 s70, v41
  s_nop 0
  s_lshr_b32 s70, s70, 23
  s_sub_i32 s70, 141, s70
  s_min_i32 s70, s70, 40
  ds_write_b128 v66, v[144:147] offset:3072
  v_fma_mixlo_f16 v148, v116, s51, 0
  v_fma_mixlo_f16 v149, v118, s51, 0
  v_fma_mixlo_f16 v150, v120, s51, 0
  v_fma_mixlo_f16 v151, v122, s51, 0
  v_fma_mixhi_f16 v148, v117, s51, 0
  v_fma_mixhi_f16 v149, v119, s51, 0
  v_fma_mixhi_f16 v150, v121, s51, 0
  v_fma_mixhi_f16 v151, v123, s51, 0
  ds_write_b128 v66, v[148:151] offset:4096
  s_cmp_lg_u32 s84, 0
  s_cbranch_scc1 L_ulin
  v_fma_mixlo_f16 v152, v124, s51, 0
  v_fma_mixlo_f16 v153, v126, s51, 0
  v_fma_mixlo_f16 v154, v128, s51, 0
  v_fma_mixlo_f16 v155, v130, s51, 0
  v_fma_mixhi_f16 v152, v125, s51, 0
  v_fma_mixhi_f16 v153, v127, s51, 0
  v_fma_mixhi_f16 v154, v129, s51, 0
  v_fma_mixhi_f16 v155, v131, s51, 0
  ds_write_b128 v66, v[152:155] offset:5120
  s_branch L_built
L_ulin:
  v_mul_f32 v224, s51, v224
  v_mul_f32 v225, s51, v225
  v_mul_f32 v226, s51, v226
  v_mul_f32 v227, s51, v227
  v_mul_f32 v228, s51, v228
  v_mul_f32 v229, s51, v229
  v_mul_f32 v230, s51, v230
  v_mul_f32 v231, s51, v231
  v_cvt_pk_bf16_f32 v152, v224, v225
  v_cvt_pk_bf16_f32 v153, v226, v227
  v_cvt_pk_bf16_f32 v154, v228, v229
  v_cvt_pk_bf16_f32 v155, v230, v231
  ds_write_b128 v66, v[152:155] offset:5120
L_built:
  s_waitcnt vmcnt(1)
  v_mov_b32 v4, s84
  ds_add_u32 v1, v4 offset:36
  s_mov_b32 s60, s24
  s_and_b32 s61, s25, 0xffff
  s_mov_b32 s62, 268435456
  s_mov_b32 s63, 0x20000
  s_mov_b32 s64, s22
  s_and_b32 s65, s23, 0xffff
  s_mov_b32 s66, 256
  s_mov_b32 s67, 0x20000
  v_lshlrev_b32 v251, 2, v0
  s_mov_b64 exec, 0xff
  s_mov_b32 s81, 0x80000
  buffer_load_dword v255, v251, s[60:63], s81 offen
  buffer_load_dword v249, v251, s[64:67], 0 offen offset:128 sc1
  s_mov_b64 exec, -1
  v_mov_b32 v251, 0
  s_add_i32 s48, s70, s71
L_csync9:
  ds_read_b32 v4, v2 offset:36
  s_waitcnt lgkmcnt(0)
  v_cmp_gt_u32 vcc, 4, v4
  s_cbranch_vccnz L_csync9
  ds_read_u16_d16_hi v32, v7 offset:0
  ds_read_u16_d16_hi v33, v7 offset:128
  ds_read_u16_d16_hi v34, v7 offset:256
  ds_read_u16_d16_hi v35, v7 offset:384
  ds_read_u16_d16_hi v36, v7 offset:512
  ds_read_u16_d16_hi v37, v7 offset:640
  ds_read_u16_d16_hi v38, v7 offset:768
  ds_read_u16_d16_hi v39, v7 offset:896
  s_waitcnt lgkmcnt(0)
  v_cvt_pk_f16_f32 v43, v38, v39
  v_cvt_pk_f16_f32 v40, v32, v35
  v_cvt_pk_f16_f32 v41, v33, v36
  v_cvt_pk_f16_f32 v42, v34, v37
  ds_write_b128 v10, v[40:43]
  ds_read_b128 v[44:47], v11
  ds_read_b128 v[48:51], v12
  ds_read_b64_tr_b16 v[52:53], v8 offset:0
  ds_read_b64_tr_b16 v[54:55], v8 offset:512
  v_pk_mul_f16 v56, v40, v40 op_sel:[0,0] op_sel_hi:[1,1]
  v_pk_mul_f16 v57, v41, v41 op_sel:[0,0] op_sel_hi:[1,1]
  v_pk_mul_f16 v58, v42, v42 op_sel:[0,0] op_sel_hi:[1,1]
  v_pk_mul_f16 v59, v40, v41 op_sel:[0,0] op_sel_hi:[1,1]
  ds_read_u16_d16_hi v32, v7 offset:32
  ds_read_u16_d16_hi v33, v7 offset:160
  s_waitcnt vmcnt(3)
  v_lshlrev_b32 v21, 7, v21
  buffer_load_dword v255, v21, s[32:35], 0 offen
  s_mov_b64 exec, 131071
  buffer_load_dword v255, v19, s[44:47], s101 offen
  s_mov_b64 exec, -1
  s_add_u32 s101, s101, 1171456
  s_waitcnt lgkmcnt(0)
  s_barrier
  s_setprio 1
  ds_read_b128 v[240:243], v28 offset:46528
  ds_read_b128 v[128:131], v28 offset:35264
  ds_read_b128 v[84:87], v28 offset:0
  ds_read_b128 v[216:219], v22
  ds_read_b128 v[244:247], v30 offset:22528
  ds_read_b128 v[172:175], v31 offset:11264
  ds_read_b128 v[176:179], v31 offset:12288
  ds_read_b128 v[180:183], v31 offset:13312
  ds_read2_b32 v[220:221], v29 offset0:0 offset1:2
  ds_read2_b32 v[222:223], v29 offset0:64 offset1:66
  v_add_u32 v29, 2048, v29
  ds_read_b128 v[88:91], v28 offset:1024
  ds_read_b128 v[92:95], v28 offset:2048
  ds_read_b128 v[132:135], v28 offset:36288
  ds_read_b128 v[136:139], v28 offset:37312
  ds_read_b128 v[140:143], v28 offset:38336
  ds_read_b128 v[144:147], v28 offset:39360
  ds_read2_b32 v[224:225], v29 offset0:0 offset1:2
  ds_read2_b32 v[226:227], v29 offset0:64 offset1:66
  v_add_u32 v29, 2048, v29
  s_cmp_lg_u32 s84, 0
  s_cbranch_scc1 L_prf
  s_setprio 2
L_prf:
  s_waitcnt lgkmcnt(14)
  v_mfma_f32_16x16x32_bf16 v[72:75], v[240:243], v[52:55], 0
  ds_read_b128 v[184:187], v31 offset:14336
  v_mfma_f32_16x16x32_f16 v[72:75], v[128:131], v[56:59], v[72:75]
  ds_read_b128 v[188:191], v31 offset:15360
  v_mfma_f32_16x16x32_f16 v[68:71], v[84:87], v[56:59], 0
  ds_read_b128 v[96:99], v28 offset:3072
  v_pk_mul_f16 v60, v40, v41 op_sel:[0,1] op_sel_hi:[1,0]
  v_mfma_f32_16x16x32_f16 v[80:83], v[216:219], v[56:59], 0
  ds_read_b128 v[100:103], v28 offset:4096
  v_pk_mul_f16 v61, v40, v42 op_sel:[0,0] op_sel_hi:[1,1]
  v_pk_mul_f16 v62, v40, v42 op_sel:[0,1] op_sel_hi:[1,0]
  s_waitcnt lgkmcnt(14)
  v_mfma_f32_16x16x32_bf16 v[76:79], v[244:247], v[52:55], 0
  ds_read_b128 v[104:107], v28 offset:5120
  v_pk_mul_f16 v63, v41, v42 op_sel:[0,0] op_sel_hi:[1,1]
  v_pk_mul_f16 v64, v41, v42 op_sel:[0,1] op_sel_hi:[1,0]
  v_mfma_f32_16x16x32_f16 v[76:79], v[172:175], v[56:59], v[76:79]
  ds_read_b128 v[108:111], v28 offset:6144
  v_pk_mul_f16 v65, v40, v43 op_sel:[0,0] op_sel_hi:[1,0]
  v_pk_mul_f16 v66, v41, v43 op_sel:[0,0] op_sel_hi:[1,0]
  v_pk_mul_f16 v67, v42, v43 op_sel:[0,0] op_sel_hi:[1,0]
  v_mfma_f32_16x16x32_f16 v[76:79], v[176:179], v[60:63], v[76:79]
  ds_read2_b32 v[228:229], v29 offset0:0 offset1:2
  ds_read2_b32 v[230:231], v29 offset0:64 offset1:66
  v_add_u32 v29, 2048, v29
  v_alignbit_b32 v48, v48, v48, v13
  v_mfma_f32_16x16x32_f16 v[76:79], v[180:183], v[64:67], v[76:79]
  ds_read_b128 v[148:151], v28 offset:40384
  v_mul_f16_sdwa v52, v40, v40 dst_sel:WORD_0 dst_unused:UNUSED_PAD src0_sel:WORD_0 src1_sel:WORD_1
  v_mul_f16_sdwa v53, v42, v42 dst_sel:WORD_0 dst_unused:UNUSED_PAD src0_sel:WORD_0 src1_sel:WORD_1
  s_waitcnt lgkmcnt(14)
  v_smfmac_f32_16x16x64_f16 v[80:83], v[220:223], v[60:67], v16
  ds_read_b128 v[152:155], v28 offset:41408
  v_alignbit_b32 v49, v49, v49, v13
  v_mfma_f32_16x16x32_f16 v[68:71], v[88:91], v[60:63], v[68:71]
  ds_read_b128 v[192:195], v31 offset:16384
  v_mul_f16_sdwa v52, v41, v41 dst_sel:WORD_1 dst_unused:UNUSED_PRESERVE src0_sel:WORD_0 src1_sel:WORD_1
  v_mul_f16_sdwa v53, v43, v43 dst_sel:WORD_1 dst_unused:UNUSED_PRESERVE src0_sel:WORD_0 src1_sel:WORD_1
  v_mfma_f32_16x16x32_f16 v[68:71], v[92:95], v[64:67], v[68:71]
  ds_read_b128 v[196:199], v31 offset:17408
  v_pk_mul_f16 v54, v40, v47 op_sel:[0,0] op_sel_hi:[1,0]
  v_mfma_f32_16x16x32_f16 v[72:75], v[132:135], v[60:63], v[72:75]
  ds_read_b128 v[200:203], v31 offset:18432
  v_pk_mul_f16 v55, v41, v47 op_sel:[0,0] op_sel_hi:[1,0]
  v_pk_mul_f16 v56, v42, v47 op_sel:[0,0] op_sel_hi:[1,0]
  s_waitcnt lgkmcnt(14)
  v_mfma_f32_16x16x32_f16 v[72:75], v[136:139], v[64:67], v[72:75]
  ds_read_b128 v[204:207], v31 offset:19456
  v_pk_mul_f16 v57, v40, v44 op_sel:[0,0] op_sel_hi:[1,1]
  v_pk_mul_f16 v58, v40, v44 op_sel:[0,1] op_sel_hi:[1,0]
  v_pk_mul_f16 v59, v40, v45 op_sel:[0,0] op_sel_hi:[1,1]
  v_mfma_f32_16x16x32_f16 v[72:75], v[140:143], v[52:55], v[72:75]
  ds_read2_b32 v[232:233], v29 offset0:0 offset1:2
  ds_read2_b32 v[234:235], v29 offset0:64 offset1:66
  v_add_u32 v29, 2048, v29
  v_pk_mul_f16 v60, v40, v45 op_sel:[0,1] op_sel_hi:[1,0]
  v_mfma_f32_16x16x32_f16 v[72:75], v[144:147], v[56:59], v[72:75]
  ds_read_b128 v[156:159], v28 offset:42432
  v_pk_mul_f16 v61, v40, v46 op_sel:[0,0] op_sel_hi:[1,1]
  v_pk_mul_f16 v62, v40, v46 op_sel:[0,1] op_sel_hi:[1,0]
  s_waitcnt lgkmcnt(14)
  v_smfmac_f32_16x16x64_f16 v[80:83], v[224:227], v[52:59], v16
  ds_read_b128 v[160:163], v28 offset:43456
  v_pk_mul_f16 v63, v41, v44 op_sel:[0,0] op_sel_hi:[1,1]
  v_mfma_f32_16x16x32_f16 v[76:79], v[184:187], v[52:55], v[76:79]
  ds_read_b128 v[112:115], v28 offset:7168
  v_pk_mul_f16 v64, v41, v44 op_sel:[0,1] op_sel_hi:[1,0]
  v_pk_mul_f16 v65, v41, v45 op_sel:[0,0] op_sel_hi:[1,1]
  v_mfma_f32_16x16x32_f16 v[76:79], v[188:191], v[56:59], v[76:79]
  ds_read_b128 v[116:119], v28 offset:8192
  v_pk_mul_f16 v66, v41, v45 op_sel:[0,1] op_sel_hi:[1,0]
  v_mfma_f32_16x16x32_f16 v[68:71], v[96:99], v[52:55], v[68:71]
  ds_read_b128 v[120:123], v28 offset:9216
  v_pk_mul_f16 v67, v41, v46 op_sel:[0,0] op_sel_hi:[1,1]
  ds_write_b16 v15, v14 offset:4064
  s_and_b32 s81, s2, 7
  s_waitcnt vmcnt(2)
  v_cmp_eq_u32 vcc, 0, v249
  s_nop 0
  s_bitcmp1_b32 vcc_lo, s81
  s_cbranch_scc0 L_cclr_ok
  s_mov_b32 s78, 0x40000
L_cclr:
  s_sub_u32 s78, s78, 1
  s_cbranch_scc1 L_cclr_ok
  v_lshlrev_b32 v249, 2, v0
  v_and_b32 v249, 31, v249
  buffer_load_dword v249, v249, s[64:67], 0 offen offset:128 sc1
  s_waitcnt vmcnt(0)
  v_cmp_eq_u32 vcc, 0, v249
  s_nop 0
  s_bitcmp1_b32 vcc_lo, s81
  s_cbranch_scc1 L_cclr
L_cclr_ok:
  v_lshl_add_u32 v24, v24, 7, v18
  v_lshl_add_u32 v25, v25, 7, v18
  s_mov_b32 exec_hi, 0x0000ffff
  v_lshl_add_u32 v26, v26, 7, v18
  v_lshl_add_u32 v27, v27, 7, v18
  s_mov_b32 exec_lo, 0
  s_mov_b32 exec_hi, 0xffff0000
  v_mov_b32 v27, v25
  v_mov_b32 v26, v25
  s_mov_b32 exec_hi, 0x00ff0000
  v_mov_b32 v26, v24
  s_mov_b64 exec, -1
  s_add_u32 m0, s74, -39488
  s_nop 0
  buffer_load_dwordx4 v24, s[32:35], 0 offen lds
  s_add_u32 m0, s74, -38432
  s_nop 0
  buffer_load_dwordx4 v25, s[32:35], 0 offen lds
  s_add_u32 m0, s74, -37376
  s_nop 0
  buffer_load_dwordx4 v26, s[32:35], 0 offen lds
  s_add_u32 m0, s74, -36320
  s_mov_b32 exec_hi, 0x00ffffff
  buffer_load_dwordx4 v27, s[32:35], 0 offen lds
  s_mov_b32 exec_hi, -1
  s_mov_b64 exec, 131071
  buffer_load_dword v255, v19, s[44:47], s101 offen
  s_mov_b64 exec, -1
  s_add_u32 s101, s101, 1171456
  s_sub_i32 s48, 0, s48
  s_mov_b32 s49, s48
  s_mov_b32 s97, 1
  s_mov_b32 s50, 1
  s_mov_b32 s96, 0
  s_cmp_lg_u32 s3, 7
  s_cbranch_scc1 L_nw0
  s_mov_b32 s52, s16
  s_and_b32 s53, s17, 0xffff
  s_mov_b32 s54, 3328
  s_mov_b32 s55, 0x20000
  v_lshlrev_b32 v22, 7, v0
  buffer_load_dword v255, v22, s[52:55], 0 offen
L_nw0:
  v_alignbit_b32 v50, v50, v50, v13
  s_waitcnt lgkmcnt(14)
  v_mfma_f32_16x16x32_f16 v[68:71], v[100:103], v[56:59], v[68:71]
  ds_read_b128 v[124:127], v28 offset:10240
  v_pk_mul_f16 v52, v41, v46 op_sel:[0,1] op_sel_hi:[1,0]
  v_pk_mul_f16 v53, v42, v44 op_sel:[0,0] op_sel_hi:[1,1]
  v_mfma_f32_16x16x32_f16 v[68:71], v[104:107], v[60:63], v[68:71]
  ds_read_b128 v[164:167], v28 offset:44480
  v_pk_mul_f16 v54, v42, v44 op_sel:[0,1] op_sel_hi:[1,0]
  v_pk_mul_f16 v55, v42, v45 op_sel:[0,0] op_sel_hi:[1,1]
  v_mfma_f32_16x16x32_f16 v[68:71], v[108:111], v[64:67], v[68:71]
  ds_read_b128 v[168:171], v28 offset:45504
  v_pk_mul_f16 v56, v42, v45 op_sel:[0,1] op_sel_hi:[1,0]
  v_pk_mul_f16 v57, v42, v46 op_sel:[0,0] op_sel_hi:[1,1]
  v_smfmac_f32_16x16x64_f16 v[80:83], v[228:231], v[60:67], v16
  ds_read2_b32 v[236:237], v29 offset0:0 offset1:2
  ds_read2_b32 v[238:239], v29 offset0:64 offset1:66
  v_add_u32 v29, 2048, v29
  v_pk_mul_f16 v58, v42, v46 op_sel:[0,1] op_sel_hi:[1,0]
  v_pk_mul_f16 v59, v40, v48 op_sel:[0,0] op_sel_hi:[1,1]
  s_waitcnt lgkmcnt(14)
  v_mfma_f32_16x16x32_f16 v[72:75], v[148:151], v[60:63], v[72:75]
  ds_read_b128 v[208:211], v31 offset:20480
  ds_read_u16_d16_hi v34, v7 offset:288
  ds_read_u16_d16_hi v35, v7 offset:416
  v_mfma_f32_16x16x32_f16 v[72:75], v[152:155], v[64:67], v[72:75]
  ds_read_b128 v[212:215], v31 offset:21504
  ds_read_u16_d16_hi v36, v7 offset:544
  ds_read_u16_d16_hi v37, v7 offset:672
  v_mfma_f32_16x16x32_f16 v[76:79], v[192:195], v[60:63], v[76:79]
  ds_read_u16_d16_hi v38, v7 offset:800
  ds_read_u16_d16_hi v39, v7 offset:928
  v_mfma_f32_16x16x32_f16 v[76:79], v[196:199], v[64:67], v[76:79]
  v_pk_mul_f16 v60, v41, v49 op_sel:[0,0] op_sel_hi:[1,1]
  v_pk_mul_f16 v61, v42, v50 op_sel:[0,0] op_sel_hi:[1,1]
  v_mfma_f32_16x16x32_f16 v[76:79], v[200:203], v[52:55], v[76:79]
  v_pk_mul_f16 v62, v40, v49 op_sel:[0,0] op_sel_hi:[1,1]
  v_pk_mul_f16 v63, v40, v49 op_sel:[0,1] op_sel_hi:[1,0]
  s_waitcnt lgkmcnt(14)
  v_mfma_f32_16x16x32_f16 v[76:79], v[204:207], v[56:59], v[76:79]
  v_pk_mul_f16 v64, v40, v50 op_sel:[0,0] op_sel_hi:[1,1]
  v_pk_mul_f16 v65, v40, v50 op_sel:[0,1] op_sel_hi:[1,0]
  v_smfmac_f32_16x16x64_f16 v[80:83], v[232:235], v[52:59], v16
  v_pk_mul_f16 v66, v41, v50 op_sel:[0,0] op_sel_hi:[1,1]
  v_pk_mul_f16 v67, v41, v50 op_sel:[0,1] op_sel_hi:[1,0]
  v_mfma_f32_16x16x32_f16 v[72:75], v[156:159], v[52:55], v[72:75]
  s_waitcnt lgkmcnt(0)
  v_cvt_pk_f16_f32 v43, v38, v39
  v_mfma_f32_16x16x32_f16 v[72:75], v[160:163], v[56:59], v[72:75]
  v_cvt_pk_f16_f32 v40, v32, v35
  v_cvt_pk_f16_f32 v41, v33, v36
  v_mfma_f32_16x16x32_f16 v[68:71], v[112:115], v[52:55], v[68:71]
  v_cvt_pk_f16_f32 v42, v34, v37
  v_mfma_f32_16x16x32_f16 v[68:71], v[116:119], v[56:59], v[68:71]
  ds_write_b128 v10, v[40:43]
  v_mfma_f32_16x16x32_f16 v[68:71], v[120:123], v[60:63], v[68:71]
  v_mfma_f32_16x16x32_f16 v[68:71], v[124:127], v[64:67], v[68:71]
  ds_read_b128 v[44:47], v11
  ds_read_b128 v[48:51], v12
  v_mfma_f32_16x16x32_f16 v[72:75], v[164:167], v[60:63], v[72:75]
  ds_read_b64_tr_b16 v[52:53], v8 offset:32
  ds_read_b64_tr_b16 v[54:55], v8 offset:544
  v_mfma_f32_16x16x32_f16 v[72:75], v[168:171], v[64:67], v[72:75]
  v_pk_mul_f16 v56, v40, v40 op_sel:[0,0] op_sel_hi:[1,1]
  v_pk_mul_f16 v57, v41, v41 op_sel:[0,0] op_sel_hi:[1,1]
  v_smfmac_f32_16x16x64_f16 v[80:83], v[236:239], v[60:67], v16
  v_pk_mul_f16 v58, v42, v42 op_sel:[0,0] op_sel_hi:[1,1]
  v_pk_mul_f16 v59, v40, v41 op_sel:[0,0] op_sel_hi:[1,1]
  v_mfma_f32_16x16x32_f16 v[76:79], v[208:211], v[60:63], v[76:79]
  s_nop 1
  v_mul_f32 v14, v68, v72
  v_fmac_f32 v14, v69, v73
  v_mfma_f32_16x16x32_f16 v[76:79], v[212:215], v[64:67], v[76:79]
  v_fmac_f32 v14, v70, v74
  v_fmac_f32 v14, v71, v75
  ds_add_u32 v1, v3 offset:12
  s_branch L_grp1
L_prime:
  v_mov_b32 v68, 0
  v_mov_b32 v69, 0
  v_mov_b32 v70, 0
  v_mov_b32 v71, 0
  v_mov_b32 v72, 0
  v_mov_b32 v73, 0
  v_mov_b32 v74, 0
  v_mov_b32 v75, 0
  v_mov_b32 v76, 0
  v_mov_b32 v77, 0
  v_mov_b32 v78, 0
  v_mov_b32 v79, 0
  v_mov_b32 v80, 0
  v_mov_b32 v81, 0
  v_mov_b32 v82, 0
  v_mov_b32 v83, 0
  v_mov_b32 v22, 0
  v_mov_b32 v23, 0
  ds_read_u16_d16_hi v32, v7 offset:0
  ds_read_u16_d16_hi v33, v7 offset:128
  ds_read_u16_d16_hi v34, v7 offset:256
  ds_read_u16_d16_hi v35, v7 offset:384
  ds_read_u16_d16_hi v36, v7 offset:512
  ds_read_u16_d16_hi v37, v7 offset:640
  ds_read_u16_d16_hi v38, v7 offset:768
  ds_read_u16_d16_hi v39, v7 offset:896
  s_waitcnt lgkmcnt(0)
  v_cvt_pk_f16_f32 v43, v38, v39
  v_cvt_pk_f16_f32 v40, v32, v35
  v_cvt_pk_f16_f32 v41, v33, v36
  v_cvt_pk_f16_f32 v42, v34, v37
  ds_write_b128 v10, v[40:43]
  ds_read_b128 v[44:47], v11
  ds_read_b128 v[48:51], v12
  ds_read_b64_tr_b16 v[52:53], v8 offset:0
  ds_read_b64_tr_b16 v[54:55], v8 offset:512
  v_pk_mul_f16 v56, v40, v40 op_sel:[0,0] op_sel_hi:[1,1]
  v_pk_mul_f16 v57, v41, v41 op_sel:[0,0] op_sel_hi:[1,1]
  v_pk_mul_f16 v58, v42, v42 op_sel:[0,0] op_sel_hi:[1,1]
  v_pk_mul_f16 v59, v40, v41 op_sel:[0,0] op_sel_hi:[1,1]
  ds_read_u16_d16_hi v32, v7 offset:32
  ds_read_u16_d16_hi v33, v7 offset:160
L_cin_loop:
  s_cmp_lg_u32 s84, 0
  s_cbranch_scc1 L_pr0
  s_setprio 2
L_pr0:
  s_waitcnt lgkmcnt(2)
  v_mfma_f32_16x16x32_bf16 v[72:75], v[240:243], v[52:55], 0
  v_add_f32 v22, v80, v81
  v_add_f32 v23, v82, v83
  v_mfma_f32_16x16x32_f16 v[72:75], v[128:131], v[56:59], v[72:75]
  v_fmac_f32 v14, v76, v77
  v_fmac_f32 v14, v22, v78
  v_mfma_f32_16x16x32_f16 v[68:71], v[84:87], v[56:59], 0
  v_fmac_f32 v14, v23, v79
  v_pk_mul_f16 v60, v40, v41 op_sel:[0,1] op_sel_hi:[1,0]
  v_mfma_f32_16x16x32_f16 v[80:83], v[216:219], v[56:59], 0
  v_pk_mul_f16 v61, v40, v42 op_sel:[0,0] op_sel_hi:[1,1]
  v_pk_mul_f16 v62, v40, v42 op_sel:[0,1] op_sel_hi:[1,0]
  v_mfma_f32_16x16x32_bf16 v[76:79], v[244:247], v[52:55], 0
  v_pk_mul_f16 v63, v41, v42 op_sel:[0,0] op_sel_hi:[1,1]
  v_pk_mul_f16 v64, v41, v42 op_sel:[0,1] op_sel_hi:[1,0]
  v_mfma_f32_16x16x32_f16 v[76:79], v[172:175], v[56:59], v[76:79]
  v_pk_mul_f16 v65, v40, v43 op_sel:[0,0] op_sel_hi:[1,0]
  v_pk_mul_f16 v66, v41, v43 op_sel:[0,0] op_sel_hi:[1,0]
  v_pk_mul_f16 v67, v42, v43 op_sel:[0,0] op_sel_hi:[1,0]
  v_mfma_f32_16x16x32_f16 v[76:79], v[176:179], v[60:63], v[76:79]
  v_add_f32_dpp v14, v14, v14 row_shr:1 row_mask:0xf bank_mask:0xf
  v_alignbit_b32 v48, v48, v48, v13
  v_mfma_f32_16x16x32_f16 v[76:79], v[180:183], v[64:67], v[76:79]
  v_mul_f16_sdwa v52, v40, v40 dst_sel:WORD_0 dst_unused:UNUSED_PAD src0_sel:WORD_0 src1_sel:WORD_1
  v_mul_f16_sdwa v53, v42, v42 dst_sel:WORD_0 dst_unused:UNUSED_PAD src0_sel:WORD_0 src1_sel:WORD_1
  v_smfmac_f32_16x16x64_f16 v[80:83], v[220:223], v[60:67], v16
  v_add_f32_dpp v14, v14, v14 row_shr:2 row_mask:0xf bank_mask:0xf
  v_alignbit_b32 v49, v49, v49, v13
  v_mfma_f32_16x16x32_f16 v[68:71], v[88:91], v[60:63], v[68:71]
  v_mul_f16_sdwa v52, v41, v41 dst_sel:WORD_1 dst_unused:UNUSED_PRESERVE src0_sel:WORD_0 src1_sel:WORD_1
  v_mul_f16_sdwa v53, v43, v43 dst_sel:WORD_1 dst_unused:UNUSED_PRESERVE src0_sel:WORD_0 src1_sel:WORD_1
  v_mfma_f32_16x16x32_f16 v[68:71], v[92:95], v[64:67], v[68:71]
  v_add_f32_dpp v14, v14, v14 row_shr:4 row_mask:0xf bank_mask:0xf
  v_pk_mul_f16 v54, v40, v47 op_sel:[0,0] op_sel_hi:[1,0]
  v_mfma_f32_16x16x32_f16 v[72:75], v[132:135], v[60:63], v[72:75]
  v_pk_mul_f16 v55, v41, v47 op_sel:[0,0] op_sel_hi:[1,0]
  v_pk_mul_f16 v56, v42, v47 op_sel:[0,0] op_sel_hi:[1,0]
  v_mfma_f32_16x16x32_f16 v[72:75], v[136:139], v[64:67], v[72:75]
  v_pk_mul_f16 v57, v40, v44 op_sel:[0,0] op_sel_hi:[1,1]
  v_pk_mul_f16 v58, v40, v44 op_sel:[0,1] op_sel_hi:[1,0]
  v_pk_mul_f16 v59, v40, v45 op_sel:[0,0] op_sel_hi:[1,1]
  v_mfma_f32_16x16x32_f16 v[72:75], v[140:143], v[52:55], v[72:75]
  v_add_f32_dpp v14, v14, v14 row_shr:8 row_mask:0xf bank_mask:0xf
  v_pk_mul_f16 v60, v40, v45 op_sel:[0,1] op_sel_hi:[1,0]
  v_mfma_f32_16x16x32_f16 v[72:75], v[144:147], v[56:59], v[72:75]
  v_pk_mul_f16 v61, v40, v46 op_sel:[0,0] op_sel_hi:[1,1]
  v_pk_mul_f16 v62, v40, v46 op_sel:[0,1] op_sel_hi:[1,0]
  v_smfmac_f32_16x16x64_f16 v[80:83], v[224:227], v[52:59], v16
  v_add_f32_dpp v14, v14, v14 row_bcast:15 row_mask:0xa bank_mask:0xf
  v_pk_mul_f16 v63, v41, v44 op_sel:[0,0] op_sel_hi:[1,1]
  v_mfma_f32_16x16x32_f16 v[76:79], v[184:187], v[52:55], v[76:79]
  v_pk_mul_f16 v64, v41, v44 op_sel:[0,1] op_sel_hi:[1,0]
  v_pk_mul_f16 v65, v41, v45 op_sel:[0,0] op_sel_hi:[1,1]
  v_mfma_f32_16x16x32_f16 v[76:79], v[188:191], v[56:59], v[76:79]
  v_add_f32_dpp v14, v14, v14 row_bcast:31 row_mask:0xc bank_mask:0xf
  v_pk_mul_f16 v66, v41, v45 op_sel:[0,1] op_sel_hi:[1,0]
  v_mfma_f32_16x16x32_f16 v[68:71], v[96:99], v[52:55], v[68:71]
  v_pk_mul_f16 v67, v41, v46 op_sel:[0,0] op_sel_hi:[1,1]
  s_waitcnt vmcnt(0)
L_blk:
  s_cmp_eq_u32 s50, 0
  s_cbranch_scc1 L_blkend
  v_readlane_b32 s81, v14, 63
  v_ldexp_f32 v14, v14, s49
  v_and_b32 v14, -2, v14
  s_cmp_ge_u32 s50, 2
  s_cbranch_scc1 L_good
  s_cmp_eq_u64 s[90:91], 0
  s_cbranch_scc1 L_slow
  s_bfe_u32 s81, s81, 0x80017
  s_cmp_eq_u32 s81, 255
  s_cbranch_scc1 L_slow
L_good:
  s_mov_b32 exec_lo, 0
  s_mov_b32 exec_hi, 0x80000000
  buffer_store_dword v14, v251, s[60:63], s85 offen sc1
  s_mov_b64 exec, -1
  s_add_u32 s85, s85, 32
  s_sub_u32 s72, s72, 1
  s_cmp_eq_u32 s72, 0
  s_cbranch_scc1 L_cin_done
  s_cmp_eq_u32 s72, 1
  s_cbranch_scc1 L_lastnext
  v_lshl_add_u32 v24, v24, 7, v18
  v_lshl_add_u32 v25, v25, 7, v18
  s_mov_b32 exec_hi, 0x0000ffff
  v_lshl_add_u32 v26, v26, 7, v18
  v_lshl_add_u32 v27, v27, 7, v18
  s_mov_b32 exec_lo, 0
  s_mov_b32 exec_hi, 0xffff0000
  v_mov_b32 v27, v25
  v_mov_b32 v26, v25
  s_mov_b32 exec_hi, 0x00ff0000
  v_mov_b32 v26, v24
  s_mov_b64 exec, -1
  s_add_u32 m0, s74, 0
  s_nop 0
  buffer_load_dwordx4 v24, s[32:35], 0 offen lds
  s_add_u32 m0, s74, 1056
  s_nop 0
  buffer_load_dwordx4 v25, s[32:35], 0 offen lds
  s_add_u32 m0, s74, 2112
  s_nop 0
  buffer_load_dwordx4 v26, s[32:35], 0 offen lds
  s_add_u32 m0, s74, 3168
  s_mov_b32 exec_hi, 0x00ffffff
  buffer_load_dwordx4 v27, s[32:35], 0 offen lds
  s_mov_b32 exec_hi, -1
  s_add_u32 s94, s94, 832
  s_cmp_lg_u32 s72, s99
  s_cbranch_scc1 L_nodma
  s_lshr_b32 s81, s98, 14
  v_cmp_eq_u32 vcc, 0, v249
  s_nop 0
  s_bitcmp1_b32 vcc_lo, s81
  s_cbranch_scc0 L_tclr_ok
  s_mov_b32 s78, 0x40000
L_tclr:
  s_sub_u32 s78, s78, 1
  s_cbranch_scc1 L_tclr_ok
  v_lshlrev_b32 v249, 2, v0
  v_and_b32 v249, 31, v249
  buffer_load_dword v249, v249, s[64:67], 0 offen offset:128 sc1
  s_waitcnt vmcnt(0)
  v_cmp_eq_u32 vcc, 0, v249
  s_nop 0
  s_bitcmp1_b32 vcc_lo, s81
  s_cbranch_scc1 L_tclr
L_tclr_ok:
  v_mov_b32 v250, 1
  s_mov_b64 exec, 1
  buffer_atomic_add v250, v251, s[60:63], s98 offen sc0
  s_mov_b64 exec, -1
  s_mov_b32 s99, 8
  s_branch L_nodma
L_lastnext:
  s_cmp_lt_i32 s26, 0
  s_cselect_b32 s85, s85, s26
L_nodma:
  s_add_u32 s74, s74, s75
  s_sub_u32 s75, 0, s75
  s_mov_b32 s49, s48
  s_mov_b32 s97, 1
  s_cmp_eq_u32 s50, 3
  s_cbranch_scc1 L_slow2
L_blkend:
  s_mov_b32 s50, s97
  s_cmp_ge_u32 s101, 5537792
  s_cbranch_scc1 L_npf
  s_mov_b64 exec, 131071
  buffer_load_dword v255, v19, s[44:47], s101 offen
  s_mov_b64 exec, -1
  s_add_u32 s101, s101, 1171456
L_npf:
  v_alignbit_b32 v50, v50, v50, v13
  v_mfma_f32_16x16x32_f16 v[68:71], v[100:103], v[56:59], v[68:71]
  v_pk_mul_f16 v52, v41, v46 op_sel:[0,1] op_sel_hi:[1,0]
  v_pk_mul_f16 v53, v42, v44 op_sel:[0,0] op_sel_hi:[1,1]
  v_mfma_f32_16x16x32_f16 v[68:71], v[104:107], v[60:63], v[68:71]
  v_pk_mul_f16 v54, v42, v44 op_sel:[0,1] op_sel_hi:[1,0]
  v_pk_mul_f16 v55, v42, v45 op_sel:[0,0] op_sel_hi:[1,1]
  v_mfma_f32_16x16x32_f16 v[68:71], v[108:111], v[64:67], v[68:71]
  v_pk_mul_f16 v56, v42, v45 op_sel:[0,1] op_sel_hi:[1,0]
  v_pk_mul_f16 v57, v42, v46 op_sel:[0,0] op_sel_hi:[1,1]
  v_smfmac_f32_16x16x64_f16 v[80:83], v[228:231], v[60:67], v16
  v_pk_mul_f16 v58, v42, v46 op_sel:[0,1] op_sel_hi:[1,0]
  v_pk_mul_f16 v59, v40, v48 op_sel:[0,0] op_sel_hi:[1,1]
  v_mfma_f32_16x16x32_f16 v[72:75], v[148:151], v[60:63], v[72:75]
  ds_read_u16_d16_hi v34, v7 offset:288
  ds_read_u16_d16_hi v35, v7 offset:416
  v_mfma_f32_16x16x32_f16 v[72:75], v[152:155], v[64:67], v[72:75]
  ds_read_u16_d16_hi v36, v7 offset:544
  ds_read_u16_d16_hi v37, v7 offset:672
  v_mfma_f32_16x16x32_f16 v[76:79], v[192:195], v[60:63], v[76:79]
  ds_read_u16_d16_hi v38, v7 offset:800
  ds_read_u16_d16_hi v39, v7 offset:928
  v_mfma_f32_16x16x32_f16 v[76:79], v[196:199], v[64:67], v[76:79]
  v_pk_mul_f16 v60, v41, v49 op_sel:[0,0] op_sel_hi:[1,1]
  v_pk_mul_f16 v61, v42, v50 op_sel:[0,0] op_sel_hi:[1,1]
  v_mfma_f32_16x16x32_f16 v[76:79], v[200:203], v[52:55], v[76:79]
  v_pk_mul_f16 v62, v40, v49 op_sel:[0,0] op_sel_hi:[1,1]
  v_pk_mul_f16 v63, v40, v49 op_sel:[0,1] op_sel_hi:[1,0]
  v_mfma_f32_16x16x32_f16 v[76:79], v[204:207], v[56:59], v[76:79]
  v_pk_mul_f16 v64, v40, v50 op_sel:[0,0] op_sel_hi:[1,1]
  v_pk_mul_f16 v65, v40, v50 op_sel:[0,1] op_sel_hi:[1,0]
  v_smfmac_f32_16x16x64_f16 v[80:83], v[232:235], v[52:59], v16
  v_pk_mul_f16 v66, v41, v50 op_sel:[0,0] op_sel_hi:[1,1]
  v_pk_mul_f16 v67, v41, v50 op_sel:[0,1] op_sel_hi:[1,0]
  v_mfma_f32_16x16x32_f16 v[72:75], v[156:159], v[52:55], v[72:75]
  s_waitcnt lgkmcnt(0)
  v_cvt_pk_f16_f32 v43, v38, v39
  v_mfma_f32_16x16x32_f16 v[72:75], v[160:163], v[56:59], v[72:75]
  v_cvt_pk_f16_f32 v40, v32, v35
  v_cvt_pk_f16_f32 v41, v33, v36
  v_mfma_f32_16x16x32_f16 v[68:71], v[112:115], v[52:55], v[68:71]
  v_cvt_pk_f16_f32 v42, v34, v37
  v_mfma_f32_16x16x32_f16 v[68:71], v[116:119], v[56:59], v[68:71]
  ds_write_b128 v10, v[40:43]
  v_mfma_f32_16x16x32_f16 v[68:71], v[120:123], v[60:63], v[68:71]
  v_mfma_f32_16x16x32_f16 v[68:71], v[124:127], v[64:67], v[68:71]
  ds_read_b128 v[44:47], v11
  ds_read_b128 v[48:51], v12
  v_mfma_f32_16x16x32_f16 v[72:75], v[164:167], v[60:63], v[72:75]
  ds_read_b64_tr_b16 v[52:53], v8 offset:32
  ds_read_b64_tr_b16 v[54:55], v8 offset:544
  v_mfma_f32_16x16x32_f16 v[72:75], v[168:171], v[64:67], v[72:75]
  v_pk_mul_f16 v56, v40, v40 op_sel:[0,0] op_sel_hi:[1,1]
  v_pk_mul_f16 v57, v41, v41 op_sel:[0,0] op_sel_hi:[1,1]
  v_smfmac_f32_16x16x64_f16 v[80:83], v[236:239], v[60:67], v16
  v_pk_mul_f16 v58, v42, v42 op_sel:[0,0] op_sel_hi:[1,1]
  v_pk_mul_f16 v59, v40, v41 op_sel:[0,0] op_sel_hi:[1,1]
  v_mfma_f32_16x16x32_f16 v[76:79], v[208:211], v[60:63], v[76:79]
  s_nop 1
  v_mul_f32 v14, v68, v72
  v_fmac_f32 v14, v69, v73
  v_mfma_f32_16x16x32_f16 v[76:79], v[212:215], v[64:67], v[76:79]
  v_fmac_f32 v14, v70, v74
  v_fmac_f32 v14, v71, v75
L_grp1:
  s_waitcnt lgkmcnt(0)
  v_mfma_f32_16x16x32_bf16 v[72:75], v[240:243], v[52:55], 0
  v_add_f32 v22, v80, v81
  v_add_f32 v23, v82, v83
  v_mfma_f32_16x16x32_f16 v[72:75], v[128:131], v[56:59], v[72:75]
  s_nop 0
  v_fmac_f32 v14, v76, v77
  v_fmac_f32 v14, v22, v78
  v_mfma_f32_16x16x32_f16 v[68:71], v[84:87], v[56:59], 0
  v_fmac_f32 v14, v23, v79
  v_pk_mul_f16 v60, v40, v41 op_sel:[0,1] op_sel_hi:[1,0]
  v_mfma_f32_16x16x32_f16 v[80:83], v[216:219], v[56:59], 0
  v_pk_mul_f16 v61, v40, v42 op_sel:[0,0] op_sel_hi:[1,1]
  v_pk_mul_f16 v62, v40, v42 op_sel:[0,1] op_sel_hi:[1,0]
  v_mfma_f32_16x16x32_bf16 v[76:79], v[244:247], v[52:55], 0
  v_pk_mul_f16 v63, v41, v42 op_sel:[0,0] op_sel_hi:[1,1]
  v_pk_mul_f16 v64, v41, v42 op_sel:[0,1] op_sel_hi:[1,0]
  v_mfma_f32_16x16x32_f16 v[76:79], v[172:175], v[56:59], v[76:79]
  v_pk_mul_f16 v65, v40, v43 op_sel:[0,0] op_sel_hi:[1,0]
  v_pk_mul_f16 v66, v41, v43 op_sel:[0,0] op_sel_hi:[1,0]
  v_pk_mul_f16 v67, v42, v43 op_sel:[0,0] op_sel_hi:[1,0]
  v_mfma_f32_16x16x32_f16 v[76:79], v[176:179], v[60:63], v[76:79]
  v_or3_b32 v15, v56, v57, v58
  v_alignbit_b32 v48, v48, v48, v13
  v_mfma_f32_16x16x32_f16 v[76:79], v[180:183], v[64:67], v[76:79]
  v_mul_f16_sdwa v52, v40, v40 dst_sel:WORD_0 dst_unused:UNUSED_PAD src0_sel:WORD_0 src1_sel:WORD_1
  v_mul_f16_sdwa v53, v42, v42 dst_sel:WORD_0 dst_unused:UNUSED_PAD src0_sel:WORD_0 src1_sel:WORD_1
  v_smfmac_f32_16x16x64_f16 v[80:83], v[220:223], v[60:67], v16
  v_mul_f16_sdwa v52, v41, v41 dst_sel:WORD_1 dst_unused:UNUSED_PRESERVE src0_sel:WORD_0 src1_sel:WORD_1
  v_mul_f16_sdwa v53, v43, v43 dst_sel:WORD_1 dst_unused:UNUSED_PRESERVE src0_sel:WORD_0 src1_sel:WORD_1
  v_mfma_f32_16x16x32_f16 v[68:71], v[88:91], v[60:63], v[68:71]
  v_pk_mul_f16 v54, v40, v47 op_sel:[0,0] op_sel_hi:[1,0]
  v_pk_mul_f16 v55, v41, v47 op_sel:[0,0] op_sel_hi:[1,0]
  v_mfma_f32_16x16x32_f16 v[68:71], v[92:95], v[64:67], v[68:71]
  v_pk_mul_f16 v56, v42, v47 op_sel:[0,0] op_sel_hi:[1,0]
  v_pk_mul_f16 v57, v40, v44 op_sel:[0,0] op_sel_hi:[1,1]
  v_mfma_f32_16x16x32_f16 v[72:75], v[132:135], v[60:63], v[72:75]
  v_pk_mul_f16 v58, v40, v44 op_sel:[0,1] op_sel_hi:[1,0]
  v_pk_mul_f16 v59, v40, v45 op_sel:[0,0] op_sel_hi:[1,1]
  v_mfma_f32_16x16x32_f16 v[72:75], v[136:139], v[64:67], v[72:75]
  v_pk_mul_f16 v60, v40, v45 op_sel:[0,1] op_sel_hi:[1,0]
  v_pk_mul_f16 v61, v40, v46 op_sel:[0,0] op_sel_hi:[1,1]
  v_mfma_f32_16x16x32_f16 v[72:75], v[140:143], v[52:55], v[72:75]
  v_pk_mul_f16 v62, v40, v46 op_sel:[0,1] op_sel_hi:[1,0]
  v_pk_mul_f16 v63, v41, v44 op_sel:[0,0] op_sel_hi:[1,1]
  v_mfma_f32_16x16x32_f16 v[72:75], v[144:147], v[56:59], v[72:75]
  v_pk_mul_f16 v64, v41, v44 op_sel:[0,1] op_sel_hi:[1,0]
  v_pk_mul_f16 v65, v41, v45 op_sel:[0,0] op_sel_hi:[1,1]
  v_smfmac_f32_16x16x64_f16 v[80:83], v[224:227], v[52:59], v16
  v_pk_mul_f16 v66, v41, v45 op_sel:[0,1] op_sel_hi:[1,0]
  v_pk_mul_f16 v67, v41, v46 op_sel:[0,0] op_sel_hi:[1,1]
  v_mfma_f32_16x16x32_f16 v[76:79], v[184:187], v[52:55], v[76:79]
  v_alignbit_b32 v49, v49, v49, v13
  v_alignbit_b32 v50, v50, v50, v13
  v_mfma_f32_16x16x32_f16 v[76:79], v[188:191], v[56:59], v[76:79]
  ds_read_u16_d16_hi v32, v7 offset:64
  ds_read_u16_d16_hi v33, v7 offset:192
  v_mfma_f32_16x16x32_f16 v[68:71], v[96:99], v[52:55], v[68:71]
  v_pk_mul_f16 v52, v41, v46 op_sel:[0,1] op_sel_hi:[1,0]
  v_pk_mul_f16 v53, v42, v44 op_sel:[0,0] op_sel_hi:[1,1]
  v_mfma_f32_16x16x32_f16 v[68:71], v[100:103], v[56:59], v[68:71]
  v_pk_mul_f16 v54, v42, v44 op_sel:[0,1] op_sel_hi:[1,0]
  v_pk_mul_f16 v55, v42, v45 op_sel:[0,0] op_sel_hi:[1,1]
  v_mfma_f32_16x16x32_f16 v[68:71], v[104:107], v[60:63], v[68:71]
  v_pk_mul_f16 v56, v42, v45 op_sel:[0,1] op_sel_hi:[1,0]
  v_pk_mul_f16 v57, v42, v46 op_sel:[0,0] op_sel_hi:[1,1]
  v_mfma_f32_16x16x32_f16 v[68:71], v[108:111], v[64:67], v[68:71]
  v_pk_mul_f16 v58, v42, v46 op_sel:[0,1] op_sel_hi:[1,0]
  v_pk_mul_f16 v59, v40, v48 op_sel:[0,0] op_sel_hi:[1,1]
  v_smfmac_f32_16x16x64_f16 v[80:83], v[228:231], v[60:67], v16
  ds_read_u16_d16_hi v34, v7 offset:320
  ds_read_u16_d16_hi v35, v7 offset:448
  v_mfma_f32_16x16x32_f16 v[72:75], v[148:151], v[60:63], v[72:75]
  ds_read_u16_d16_hi v36, v7 offset:576
  ds_read_u16_d16_hi v37, v7 offset:704
  v_mfma_f32_16x16x32_f16 v[72:75], v[152:155], v[64:67], v[72:75]
  ds_read_u16_d16_hi v38, v7 offset:832
  ds_read_u16_d16_hi v39, v7 offset:960
  v_mfma_f32_16x16x32_f16 v[76:79], v[192:195], v[60:63], v[76:79]
  v_and_b32 v15, 0x60006000, v15
  v_cmp_ne_u32 s[90:91], 0, v15
  v_mfma_f32_16x16x32_f16 v[76:79], v[196:199], v[64:67], v[76:79]
  v_pk_mul_f16 v60, v41, v49 op_sel:[0,0] op_sel_hi:[1,1]
  v_pk_mul_f16 v61, v42, v50 op_sel:[0,0] op_sel_hi:[1,1]
  v_mfma_f32_16x16x32_f16 v[76:79], v[200:203], v[52:55], v[76:79]
  v_pk_mul_f16 v62, v40, v49 op_sel:[0,0] op_sel_hi:[1,1]
  v_pk_mul_f16 v63, v40, v49 op_sel:[0,1] op_sel_hi:[1,0]
  v_mfma_f32_16x16x32_f16 v[76:79], v[204:207], v[56:59], v[76:79]
  v_pk_mul_f16 v64, v40, v50 op_sel:[0,0] op_sel_hi:[1,1]
  v_pk_mul_f16 v65, v40, v50 op_sel:[0,1] op_sel_hi:[1,0]
  v_smfmac_f32_16x16x64_f16 v[80:83], v[232:235], v[52:59], v16
  v_pk_mul_f16 v66, v41, v50 op_sel:[0,0] op_sel_hi:[1,1]
  v_pk_mul_f16 v67, v41, v50 op_sel:[0,1] op_sel_hi:[1,0]
  v_mfma_f32_16x16x32_f16 v[72:75], v[156:159], v[52:55], v[72:75]
  s_waitcnt lgkmcnt(0)
  v_cvt_pk_f16_f32 v43, v38, v39
  v_mfma_f32_16x16x32_f16 v[72:75], v[160:163], v[56:59], v[72:75]
  v_cvt_pk_f16_f32 v40, v32, v35
  v_cvt_pk_f16_f32 v41, v33, v36
  v_mfma_f32_16x16x32_f16 v[68:71], v[112:115], v[52:55], v[68:71]
  v_cvt_pk_f16_f32 v42, v34, v37
  v_mfma_f32_16x16x32_f16 v[68:71], v[116:119], v[56:59], v[68:71]
  ds_write_b128 v10, v[40:43]
  v_mfma_f32_16x16x32_f16 v[68:71], v[120:123], v[60:63], v[68:71]
  v_mfma_f32_16x16x32_f16 v[68:71], v[124:127], v[64:67], v[68:71]
  ds_read_b128 v[44:47], v11
  ds_read_b128 v[48:51], v12
  v_mfma_f32_16x16x32_f16 v[72:75], v[164:167], v[60:63], v[72:75]
  ds_read_b64_tr_b16 v[52:53], v8 offset:64
  ds_read_b64_tr_b16 v[54:55], v8 offset:576
  v_mfma_f32_16x16x32_f16 v[72:75], v[168:171], v[64:67], v[72:75]
  v_pk_mul_f16 v56, v40, v40 op_sel:[0,0] op_sel_hi:[1,1]
  v_pk_mul_f16 v57, v41, v41 op_sel:[0,0] op_sel_hi:[1,1]
  v_smfmac_f32_16x16x64_f16 v[80:83], v[236:239], v[60:67], v16
  v_pk_mul_f16 v58, v42, v42 op_sel:[0,0] op_sel_hi:[1,1]
  v_pk_mul_f16 v59, v40, v41 op_sel:[0,0] op_sel_hi:[1,1]
  v_mfma_f32_16x16x32_f16 v[76:79], v[208:211], v[60:63], v[76:79]
  s_nop 1
  v_fmac_f32 v14, v68, v72
  v_fmac_f32 v14, v69, v73
  v_mfma_f32_16x16x32_f16 v[76:79], v[212:215], v[64:67], v[76:79]
  v_fmac_f32 v14, v70, v74
  v_fmac_f32 v14, v71, v75
  s_cmp_eq_u32 s72, s96
  s_cbranch_scc1 L_htail
  s_waitcnt lgkmcnt(0)
  v_mfma_f32_16x16x32_bf16 v[72:75], v[240:243], v[52:55], 0
  v_add_f32 v22, v80, v81
  v_add_f32 v23, v82, v83
  v_mfma_f32_16x16x32_f16 v[72:75], v[128:131], v[56:59], v[72:75]
  v_fmac_f32 v14, v76, v77
  v_fmac_f32 v14, v22, v78
  v_mfma_f32_16x16x32_f16 v[68:71], v[84:87], v[56:59], 0
  v_fmac_f32 v14, v23, v79
  v_pk_mul_f16 v60, v40, v41 op_sel:[0,1] op_sel_hi:[1,0]
  v_mfma_f32_16x16x32_f16 v[80:83], v[216:219], v[56:59], 0
  v_pk_mul_f16 v61, v40, v42 op_sel:[0,0] op_sel_hi:[1,1]
  v_pk_mul_f16 v62, v40, v42 op_sel:[0,1] op_sel_hi:[1,0]
  v_mfma_f32_16x16x32_bf16 v[76:79], v[244:247], v[52:55], 0
  v_pk_mul_f16 v63, v41, v42 op_sel:[0,0] op_sel_hi:[1,1]
  v_pk_mul_f16 v64, v41, v42 op_sel:[0,1] op_sel_hi:[1,0]
  v_mfma_f32_16x16x32_f16 v[76:79], v[172:175], v[56:59], v[76:79]
  v_pk_mul_f16 v65, v40, v43 op_sel:[0,0] op_sel_hi:[1,0]
  v_pk_mul_f16 v66, v41, v43 op_sel:[0,0] op_sel_hi:[1,0]
  v_pk_mul_f16 v67, v42, v43 op_sel:[0,0] op_sel_hi:[1,0]
  v_mfma_f32_16x16x32_f16 v[76:79], v[176:179], v[60:63], v[76:79]
  v_mul_f16_sdwa v52, v40, v40 dst_sel:WORD_0 dst_unused:UNUSED_PAD src0_sel:WORD_0 src1_sel:WORD_1
  v_mul_f16_sdwa v53, v42, v42 dst_sel:WORD_0 dst_unused:UNUSED_PAD src0_sel:WORD_0 src1_sel:WORD_1
  v_mfma_f32_16x16x32_f16 v[76:79], v[180:183], v[64:67], v[76:79]
  v_mul_f16_sdwa v52, v41, v41 dst_sel:WORD_1 dst_unused:UNUSED_PRESERVE src0_sel:WORD_0 src1_sel:WORD_1
  v_mul_f16_sdwa v53, v43, v43 dst_sel:WORD_1 dst_unused:UNUSED_PRESERVE src0_sel:WORD_0 src1_sel:WORD_1
  v_smfmac_f32_16x16x64_f16 v[80:83], v[220:223], v[60:67], v16
  v_pk_mul_f16 v54, v40, v47 op_sel:[0,0] op_sel_hi:[1,0]
  v_pk_mul_f16 v55, v41, v47 op_sel:[0,0] op_sel_hi:[1,0]
  v_mfma_f32_16x16x32_f16 v[68:71], v[88:91], v[60:63], v[68:71]
  v_pk_mul_f16 v56, v42, v47 op_sel:[0,0] op_sel_hi:[1,0]
  v_pk_mul_f16 v57, v40, v44 op_sel:[0,0] op_sel_hi:[1,1]
  v_mfma_f32_16x16x32_f16 v[68:71], v[92:95], v[64:67], v[68:71]
  v_pk_mul_f16 v58, v40, v44 op_sel:[0,1] op_sel_hi:[1,0]
  v_pk_mul_f16 v59, v40, v45 op_sel:[0,0] op_sel_hi:[1,1]
  v_mfma_f32_16x16x32_f16 v[72:75], v[132:135], v[60:63], v[72:75]
  v_pk_mul_f16 v60, v40, v45 op_sel:[0,1] op_sel_hi:[1,0]
  v_pk_mul_f16 v61, v40, v46 op_sel:[0,0] op_sel_hi:[1,1]
  v_mfma_f32_16x16x32_f16 v[72:75], v[136:139], v[64:67], v[72:75]
  v_pk_mul_f16 v62, v40, v46 op_sel:[0,1] op_sel_hi:[1,0]
  v_pk_mul_f16 v63, v41, v44 op_sel:[0,0] op_sel_hi:[1,1]
  v_mfma_f32_16x16x32_f16 v[72:75], v[140:143], v[52:55], v[72:75]
  v_pk_mul_f16 v64, v41, v44 op_sel:[0,1] op_sel_hi:[1,0]
  v_pk_mul_f16 v65, v41, v45 op_sel:[0,0] op_sel_hi:[1,1]
  v_mfma_f32_16x16x32_f16 v[72:75], v[144:147], v[56:59], v[72:75]
  v_pk_mul_f16 v66, v41, v45 op_sel:[0,1] op_sel_hi:[1,0]
  v_pk_mul_f16 v67, v41, v46 op_sel:[0,0] op_sel_hi:[1,1]
  v_smfmac_f32_16x16x64_f16 v[80:83], v[224:227], v[52:59], v16
  v_alignbit_b32 v48, v48, v48, v13
  v_alignbit_b32 v49, v49, v49, v13
  v_mfma_f32_16x16x32_f16 v[76:79], v[184:187], v[52:55], v[76:79]
  v_alignbit_b32 v50, v50, v50, v13
  ds_read_u16_d16_hi v32, v7 offset:96
  v_mfma_f32_16x16x32_f16 v[76:79], v[188:191], v[56:59], v[76:79]
  ds_read_u16_d16_hi v33, v7 offset:224
  ds_read_u16_d16_hi v34, v7 offset:352
  s_cmp_lg_u32 s99, 8
  s_cbranch_scc1 L_hk
  s_waitcnt vmcnt(0)
  v_readfirstlane_b32 s81, v250
  s_mov_b32 s99, 0
  s_add_u32 s81, s81, 1
  s_cmp_ge_u32 s81, 32
  s_cbranch_scc1 L_hk
  s_add_u32 s72, s72, 1
  s_mov_b32 s26, 10240
  s_cmp_lt_u32 s81, 24
  s_cbranch_scc1 L_hkf
  s_add_u32 s81, s81, 24
  s_and_b32 s94, s81, 1
  s_lshr_b32 s81, s81, 1
  s_mov_b32 s96, 1
  s_lshl_b32 s94, s94, 6
  v_xor_b32 v18, s94, v18
  s_lshl_b32 s94, s94, 5
  s_add_u32 s26, s26, s94
L_hkf:
  s_add_u32 s81, s81, 484
  s_lshl_b32 s94, s81, 2
  s_add_u32 s26, s26, s94
  s_andn2_b32 s94, s98, 0x3fff
  s_add_u32 s26, s26, s94
  s_lshr_b32 s94, s94, 5
  s_add_u32 s94, s94, s81
  s_mul_i32 s94, s94, 104
L_hk:
  buffer_load_dwordx4 v[24:27], v17, s[28:31], s94 offen offset:0
  v_mfma_f32_16x16x32_f16 v[68:71], v[96:99], v[52:55], v[68:71]
  v_pk_mul_f16 v52, v41, v46 op_sel:[0,1] op_sel_hi:[1,0]
  v_pk_mul_f16 v53, v42, v44 op_sel:[0,0] op_sel_hi:[1,1]
  v_mfma_f32_16x16x32_f16 v[68:71], v[100:103], v[56:59], v[68:71]
  v_pk_mul_f16 v54, v42, v44 op_sel:[0,1] op_sel_hi:[1,0]
  v_pk_mul_f16 v55, v42, v45 op_sel:[0,0] op_sel_hi:[1,1]
  v_mfma_f32_16x16x32_f16 v[68:71], v[104:107], v[60:63], v[68:71]
  v_pk_mul_f16 v56, v42, v45 op_sel:[0,1] op_sel_hi:[1,0]
  v_pk_mul_f16 v57, v42, v46 op_sel:[0,0] op_sel_hi:[1,1]
  v_mfma_f32_16x16x32_f16 v[68:71], v[108:111], v[64:67], v[68:71]
  v_pk_mul_f16 v58, v42, v46 op_sel:[0,1] op_sel_hi:[1,0]
  v_pk_mul_f16 v59, v40, v48 op_sel:[0,0] op_sel_hi:[1,1]
  v_smfmac_f32_16x16x64_f16 v[80:83], v[228:231], v[60:67], v16
  ds_read_u16_d16_hi v35, v7 offset:480
  ds_read_u16_d16_hi v36, v7 offset:608
  v_mfma_f32_16x16x32_f16 v[72:75], v[148:151], v[60:63], v[72:75]
  ds_read_u16_d16_hi v37, v7 offset:736
  ds_read_u16_d16_hi v38, v7 offset:864
  v_mfma_f32_16x16x32_f16 v[72:75], v[152:155], v[64:67], v[72:75]
  ds_read_u16_d16_hi v39, v7 offset:992
  v_mfma_f32_16x16x32_f16 v[76:79], v[192:195], v[60:63], v[76:79]
  v_pk_mul_f16 v60, v41, v49 op_sel:[0,0] op_sel_hi:[1,1]
  v_pk_mul_f16 v61, v42, v50 op_sel:[0,0] op_sel_hi:[1,1]
  v_mfma_f32_16x16x32_f16 v[76:79], v[196:199], v[64:67], v[76:79]
  v_pk_mul_f16 v62, v40, v49 op_sel:[0,0] op_sel_hi:[1,1]
  v_pk_mul_f16 v63, v40, v49 op_sel:[0,1] op_sel_hi:[1,0]
  v_mfma_f32_16x16x32_f16 v[76:79], v[200:203], v[52:55], v[76:79]
  v_pk_mul_f16 v64, v40, v50 op_sel:[0,0] op_sel_hi:[1,1]
  v_pk_mul_f16 v65, v40, v50 op_sel:[0,1] op_sel_hi:[1,0]
  s_cmp_lg_u32 s84, 0
  s_cbranch_scc1 L_pr110
  s_setprio 0
L_pr110:
  v_mfma_f32_16x16x32_f16 v[76:79], v[204:207], v[56:59], v[76:79]
  v_pk_mul_f16 v66, v41, v50 op_sel:[0,0] op_sel_hi:[1,1]
  v_pk_mul_f16 v67, v41, v50 op_sel:[0,1] op_sel_hi:[1,0]
  v_smfmac_f32_16x16x64_f16 v[80:83], v[232:235], v[52:59], v16
  s_waitcnt lgkmcnt(0)
  v_cvt_pk_f16_f32 v43, v38, v39
  v_mfma_f32_16x16x32_f16 v[72:75], v[156:159], v[52:55], v[72:75]
  v_cvt_pk_f16_f32 v40, v32, v35
  v_cvt_pk_f16_f32 v41, v33, v36
  v_mfma_f32_16x16x32_f16 v[72:75], v[160:163], v[56:59], v[72:75]
  v_cvt_pk_f16_f32 v42, v34, v37
  v_mfma_f32_16x16x32_f16 v[68:71], v[112:115], v[52:55], v[68:71]
  ds_write_b128 v10, v[40:43]
  v_mfma_f32_16x16x32_f16 v[68:71], v[116:119], v[56:59], v[68:71]
  v_add_u32 v7, s75, v7
  s_waitcnt vmcnt(1)
  v_mfma_f32_16x16x32_f16 v[68:71], v[120:123], v[60:63], v[68:71]
  ds_read_b128 v[44:47], v11
  ds_read_b128 v[48:51], v12
  v_mfma_f32_16x16x32_f16 v[68:71], v[124:127], v[64:67], v[68:71]
  ds_read_b64_tr_b16 v[52:53], v8 offset:96
  ds_read_b64_tr_b16 v[54:55], v8 offset:608
  v_mfma_f32_16x16x32_f16 v[72:75], v[164:167], v[60:63], v[72:75]
  v_pk_mul_f16 v56, v40, v40 op_sel:[0,0] op_sel_hi:[1,1]
  v_pk_mul_f16 v57, v41, v41 op_sel:[0,0] op_sel_hi:[1,1]
  v_mfma_f32_16x16x32_f16 v[72:75], v[168:171], v[64:67], v[72:75]
  v_pk_mul_f16 v58, v42, v42 op_sel:[0,0] op_sel_hi:[1,1]
  v_pk_mul_f16 v59, v40, v41 op_sel:[0,0] op_sel_hi:[1,1]
  v_smfmac_f32_16x16x64_f16 v[80:83], v[236:239], v[60:67], v16
  ds_read_u16_d16_hi v32, v7 offset:0
  ds_read_u16_d16_hi v33, v7 offset:128
  v_mfma_f32_16x16x32_f16 v[76:79], v[208:211], v[60:63], v[76:79]
  s_nop 1
  v_fmac_f32 v14, v68, v72
  v_fmac_f32 v14, v69, v73
  v_mfma_f32_16x16x32_f16 v[76:79], v[212:215], v[64:67], v[76:79]
  v_fmac_f32 v14, v70, v74
  v_fmac_f32 v14, v71, v75
  s_waitcnt lgkmcnt(2)
  v_mfma_f32_16x16x32_bf16 v[72:75], v[240:243], v[52:55], 0
  v_add_f32 v22, v80, v81
  v_add_f32 v23, v82, v83
  v_mfma_f32_16x16x32_f16 v[72:75], v[128:131], v[56:59], v[72:75]
  s_nop 0
  v_fmac_f32 v14, v76, v77
  v_fmac_f32 v14, v22, v78
  v_mfma_f32_16x16x32_f16 v[68:71], v[84:87], v[56:59], 0
  v_fmac_f32 v14, v23, v79
  v_pk_mul_f16 v60, v40, v41 op_sel:[0,1] op_sel_hi:[1,0]
  v_mfma_f32_16x16x32_f16 v[80:83], v[216:219], v[56:59], 0
  v_pk_mul_f16 v61, v40, v42 op_sel:[0,0] op_sel_hi:[1,1]
  v_pk_mul_f16 v62, v40, v42 op_sel:[0,1] op_sel_hi:[1,0]
  v_mfma_f32_16x16x32_bf16 v[76:79], v[244:247], v[52:55], 0
  v_pk_mul_f16 v63, v41, v42 op_sel:[0,0] op_sel_hi:[1,1]
  v_pk_mul_f16 v64, v41, v42 op_sel:[0,1] op_sel_hi:[1,0]
  v_mfma_f32_16x16x32_f16 v[76:79], v[172:175], v[56:59], v[76:79]
  v_pk_mul_f16 v65, v40, v43 op_sel:[0,0] op_sel_hi:[1,0]
  v_pk_mul_f16 v66, v41, v43 op_sel:[0,0] op_sel_hi:[1,0]
  v_pk_mul_f16 v67, v42, v43 op_sel:[0,0] op_sel_hi:[1,0]
  v_mfma_f32_16x16x32_f16 v[76:79], v[176:179], v[60:63], v[76:79]
  v_mul_f16_sdwa v52, v40, v40 dst_sel:WORD_0 dst_unused:UNUSED_PAD src0_sel:WORD_0 src1_sel:WORD_1
  v_mul_f16_sdwa v53, v42, v42 dst_sel:WORD_0 dst_unused:UNUSED_PAD src0_sel:WORD_0 src1_sel:WORD_1
  v_mfma_f32_16x16x32_f16 v[76:79], v[180:183], v[64:67], v[76:79]
  v_mul_f16_sdwa v52, v41, v41 dst_sel:WORD_1 dst_unused:UNUSED_PRESERVE src0_sel:WORD_0 src1_sel:WORD_1
  v_mul_f16_sdwa v53, v43, v43 dst_sel:WORD_1 dst_unused:UNUSED_PRESERVE src0_sel:WORD_0 src1_sel:WORD_1
  v_smfmac_f32_16x16x64_f16 v[80:83], v[220:223], v[60:67], v16
  v_pk_mul_f16 v54, v40, v47 op_sel:[0,0] op_sel_hi:[1,0]
  v_pk_mul_f16 v55, v41, v47 op_sel:[0,0] op_sel_hi:[1,0]
  v_mfma_f32_16x16x32_f16 v[68:71], v[88:91], v[60:63], v[68:71]
  v_pk_mul_f16 v56, v42, v47 op_sel:[0,0] op_sel_hi:[1,0]
  v_pk_mul_f16 v57, v40, v44 op_sel:[0,0] op_sel_hi:[1,1]
  v_mfma_f32_16x16x32_f16 v[68:71], v[92:95], v[64:67], v[68:71]
  v_pk_mul_f16 v58, v40, v44 op_sel:[0,1] op_sel_hi:[1,0]
  v_pk_mul_f16 v59, v40, v45 op_sel:[0,0] op_sel_hi:[1,1]
  v_mfma_f32_16x16x32_f16 v[72:75], v[132:135], v[60:63], v[72:75]
  v_pk_mul_f16 v60, v40, v45 op_sel:[0,1] op_sel_hi:[1,0]
  v_pk_mul_f16 v61, v40, v46 op_sel:[0,0] op_sel_hi:[1,1]
  v_mfma_f32_16x16x32_f16 v[72:75], v[136:139], v[64:67], v[72:75]
  v_pk_mul_f16 v62, v40, v46 op_sel:[0,1] op_sel_hi:[1,0]
  v_pk_mul_f16 v63, v41, v44 op_sel:[0,0] op_sel_hi:[1,1]
  v_mfma_f32_16x16x32_f16 v[72:75], v[140:143], v[52:55], v[72:75]
  v_pk_mul_f16 v64, v41, v44 op_sel:[0,1] op_sel_hi:[1,0]
  v_pk_mul_f16 v65, v41, v45 op_sel:[0,0] op_sel_hi:[1,1]
  v_mfma_f32_16x16x32_f16 v[72:75], v[144:147], v[56:59], v[72:75]
  v_pk_mul_f16 v66, v41, v45 op_sel:[0,1] op_sel_hi:[1,0]
  v_pk_mul_f16 v67, v41, v46 op_sel:[0,0] op_sel_hi:[1,1]
  v_smfmac_f32_16x16x64_f16 v[80:83], v[224:227], v[52:59], v16
  v_alignbit_b32 v48, v48, v48, v13
  v_alignbit_b32 v49, v49, v49, v13
  v_mfma_f32_16x16x32_f16 v[76:79], v[184:187], v[52:55], v[76:79]
  v_alignbit_b32 v50, v50, v50, v13
  ds_read_u16_d16_hi v34, v7 offset:256
  v_mfma_f32_16x16x32_f16 v[76:79], v[188:191], v[56:59], v[76:79]
  ds_read_u16_d16_hi v35, v7 offset:384
  ds_read_u16_d16_hi v36, v7 offset:512
  v_mfma_f32_16x16x32_f16 v[68:71], v[96:99], v[52:55], v[68:71]
  v_pk_mul_f16 v52, v41, v46 op_sel:[0,1] op_sel_hi:[1,0]
  v_pk_mul_f16 v53, v42, v44 op_sel:[0,0] op_sel_hi:[1,1]
  v_mfma_f32_16x16x32_f16 v[68:71], v[100:103], v[56:59], v[68:71]
  v_pk_mul_f16 v54, v42, v44 op_sel:[0,1] op_sel_hi:[1,0]
  v_pk_mul_f16 v55, v42, v45 op_sel:[0,0] op_sel_hi:[1,1]
  v_mfma_f32_16x16x32_f16 v[68:71], v[104:107], v[60:63], v[68:71]
  v_pk_mul_f16 v56, v42, v45 op_sel:[0,1] op_sel_hi:[1,0]
  v_pk_mul_f16 v57, v42, v46 op_sel:[0,0] op_sel_hi:[1,1]
  v_mfma_f32_16x16x32_f16 v[68:71], v[108:111], v[64:67], v[68:71]
  v_pk_mul_f16 v58, v42, v46 op_sel:[0,1] op_sel_hi:[1,0]
  v_pk_mul_f16 v59, v40, v48 op_sel:[0,0] op_sel_hi:[1,1]
  v_smfmac_f32_16x16x64_f16 v[80:83], v[228:231], v[60:67], v16
  ds_read_u16_d16_hi v37, v7 offset:640
  ds_read_u16_d16_hi v38, v7 offset:768
  v_mfma_f32_16x16x32_f16 v[72:75], v[148:151], v[60:63], v[72:75]
  ds_read_u16_d16_hi v39, v7 offset:896
  s_add_u32 s81, s74, s75
  v_add_u32 v8, s81, v9
  v_mfma_f32_16x16x32_f16 v[72:75], v[152:155], v[64:67], v[72:75]
  v_mfma_f32_16x16x32_f16 v[76:79], v[192:195], v[60:63], v[76:79]
  v_pk_mul_f16 v60, v41, v49 op_sel:[0,0] op_sel_hi:[1,1]
  v_pk_mul_f16 v61, v42, v50 op_sel:[0,0] op_sel_hi:[1,1]
  v_mfma_f32_16x16x32_f16 v[76:79], v[196:199], v[64:67], v[76:79]
  v_pk_mul_f16 v62, v40, v49 op_sel:[0,0] op_sel_hi:[1,1]
  v_pk_mul_f16 v63, v40, v49 op_sel:[0,1] op_sel_hi:[1,0]
  v_mfma_f32_16x16x32_f16 v[76:79], v[200:203], v[52:55], v[76:79]
  v_pk_mul_f16 v64, v40, v50 op_sel:[0,0] op_sel_hi:[1,1]
  v_pk_mul_f16 v65, v40, v50 op_sel:[0,1] op_sel_hi:[1,0]
  v_mfma_f32_16x16x32_f16 v[76:79], v[204:207], v[56:59], v[76:79]
  v_pk_mul_f16 v66, v41, v50 op_sel:[0,0] op_sel_hi:[1,1]
  v_pk_mul_f16 v67, v41, v50 op_sel:[0,1] op_sel_hi:[1,0]
  v_smfmac_f32_16x16x64_f16 v[80:83], v[232:235], v[52:59], v16
  s_waitcnt lgkmcnt(0)
  v_cvt_pk_f16_f32 v43, v38, v39
  v_mfma_f32_16x16x32_f16 v[72:75], v[156:159], v[52:55], v[72:75]
  v_cvt_pk_f16_f32 v40, v32, v35
  v_cvt_pk_f16_f32 v41, v33, v36
  v_mfma_f32_16x16x32_f16 v[72:75], v[160:163], v[56:59], v[72:75]
  v_cvt_pk_f16_f32 v42, v34, v37
  v_mfma_f32_16x16x32_f16 v[68:71], v[112:115], v[52:55], v[68:71]
  ds_write_b128 v10, v[40:43]
  v_mfma_f32_16x16x32_f16 v[68:71], v[116:119], v[56:59], v[68:71]
  v_mfma_f32_16x16x32_f16 v[68:71], v[120:123], v[60:63], v[68:71]
  ds_read_b128 v[44:47], v11
  ds_read_b128 v[48:51], v12
  v_mfma_f32_16x16x32_f16 v[68:71], v[124:127], v[64:67], v[68:71]
  ds_read_b64_tr_b16 v[52:53], v8 offset:0
  ds_read_b64_tr_b16 v[54:55], v8 offset:512
  v_mfma_f32_16x16x32_f16 v[72:75], v[164:167], v[60:63], v[72:75]
  v_pk_mul_f16 v56, v40, v40 op_sel:[0,0] op_sel_hi:[1,1]
  v_pk_mul_f16 v57, v41, v41 op_sel:[0,0] op_sel_hi:[1,1]
  v_mfma_f32_16x16x32_f16 v[72:75], v[168:171], v[64:67], v[72:75]
  v_pk_mul_f16 v58, v42, v42 op_sel:[0,0] op_sel_hi:[1,1]
  v_pk_mul_f16 v59, v40, v41 op_sel:[0,0] op_sel_hi:[1,1]
  v_smfmac_f32_16x16x64_f16 v[80:83], v[236:239], v[60:67], v16
  ds_read_u16_d16_hi v32, v7 offset:32
  ds_read_u16_d16_hi v33, v7 offset:160
  v_mfma_f32_16x16x32_f16 v[76:79], v[208:211], v[60:63], v[76:79]
  s_nop 1
  v_fmac_f32 v14, v68, v72
  v_fmac_f32 v14, v69, v73
  v_mfma_f32_16x16x32_f16 v[76:79], v[212:215], v[64:67], v[76:79]
  v_fmac_f32 v14, v70, v74
  v_fmac_f32 v14, v71, v75
  s_cmp_lg_u32 s72, 1
  s_cbranch_scc1 L_cin_loop
  v_add_f32 v22, v80, v81
  v_add_f32 v23, v82, v83
  s_nop 1
  v_fmac_f32 v14, v76, v77
  v_fmac_f32 v14, v22, v78
  v_fmac_f32 v14, v23, v79
  s_nop 1
  v_add_f32_dpp v14, v14, v14 row_shr:1 row_mask:0xf bank_mask:0xf
  s_nop 1
  v_add_f32_dpp v14, v14, v14 row_shr:2 row_mask:0xf bank_mask:0xf
  s_nop 1
  v_add_f32_dpp v14, v14, v14 row_shr:4 row_mask:0xf bank_mask:0xf
  s_nop 1
  v_add_f32_dpp v14, v14, v14 row_shr:8 row_mask:0xf bank_mask:0xf
  s_nop 1
  v_add_f32_dpp v14, v14, v14 row_bcast:15 row_mask:0xa bank_mask:0xf
  s_nop 1
  v_add_f32_dpp v14, v14, v14 row_bcast:31 row_mask:0xc bank_mask:0xf
  s_branch L_blk
L_htail:
  v_add_f32 v22, v80, v81
  v_add_f32 v23, v82, v83
  s_nop 1
  v_fmac_f32 v14, v76, v77
  v_fmac_f32 v14, v22, v78
  v_fmac_f32 v14, v23, v79
  s_nop 1
  v_add_f32_dpp v14, v14, v14 row_shr:1 row_mask:0xf bank_mask:0xf
  s_nop 1
  v_add_f32_dpp v14, v14, v14 row_shr:2 row_mask:0xf bank_mask:0xf
  s_nop 1
  v_add_f32_dpp v14, v14, v14 row_shr:4 row_mask:0xf bank_mask:0xf
  s_nop 1
  v_add_f32_dpp v14, v14, v14 row_shr:8 row_mask:0xf bank_mask:0xf
  s_nop 1
  v_add_f32_dpp v14, v14, v14 row_bcast:15 row_mask:0xa bank_mask:0xf
  s_nop 1
  v_add_f32_dpp v14, v14, v14 row_bcast:31 row_mask:0xc bank_mask:0xf
  v_add_u32 v7, s75, v7
  s_branch L_blk
L_slow:
  v_subrev_u32 v7, s75, v7
L_slow2:
  v_lshlrev_b32 v22, 1, v0
  v_add_u32 v23, s74, v22
  s_mul_i32 s81, s3, 4224
  s_add_u32 s81, s81, 1024
  v_add_u32 v22, s81, v22
  v_add_u32 v8, s81, v9
L_csync10:
  ds_read_b32 v4, v2 offset:12
  s_waitcnt lgkmcnt(0)
  v_cmp_gt_u32 vcc, 8, v4
  s_cbranch_vccnz L_csync10
  ds_read_u16 v52, v23 offset:0
  ds_read_u16 v53, v23 offset:128
  ds_read_u16 v54, v23 offset:256
  ds_read_u16 v55, v23 offset:384
  ds_read_u16 v56, v23 offset:512
  ds_read_u16 v57, v23 offset:640
  ds_read_u16 v58, v23 offset:768
  ds_read_u16 v59, v23 offset:896
  ds_read_u16 v60, v23 offset:1056
  ds_read_u16 v61, v23 offset:1184
  ds_read_u16 v62, v23 offset:1312
  ds_read_u16 v63, v23 offset:1440
  ds_read_u16 v64, v23 offset:1568
  ds_read_u16 v65, v23 offset:1696
  ds_read_u16 v66, v23 offset:1824
  ds_read_u16 v67, v23 offset:1952
  ds_read_u16 v68, v23 offset:2112
  ds_read_u16 v69, v23 offset:2240
  ds_read_u16 v70, v23 offset:2368
  ds_read_u16 v71, v23 offset:2496
  ds_read_u16 v72, v23 offset:2624
  ds_read_u16 v73, v23 offset:2752
  ds_read_u16 v74, v23 offset:2880
  ds_read_u16 v75, v23 offset:3008
  ds_read_u16 v76, v23 offset:3168
  ds_read_u16 v77, v23 offset:3296
  ds_read_u16 v78, v23 offset:3424
  ds_read_u16 v79, v23 offset:3552
  ds_read_u16 v80, v23 offset:3680
  ds_read_u16 v81, v23 offset:3808
  ds_read_u16 v82, v23 offset:3936
  s_waitcnt lgkmcnt(14)
  v_lshlrev_b32 v52, 16, v52
  v_lshlrev_b32 v53, 16, v53
  v_lshlrev_b32 v54, 16, v54
  v_lshlrev_b32 v55, 16, v55
  v_lshlrev_b32 v56, 16, v56
  v_lshlrev_b32 v57, 16, v57
  v_lshlrev_b32 v58, 16, v58
  v_lshlrev_b32 v59, 16, v59
  v_lshlrev_b32 v60, 16, v60
  v_lshlrev_b32 v61, 16, v61
  v_lshlrev_b32 v62, 16, v62
  v_lshlrev_b32 v63, 16, v63
  v_lshlrev_b32 v64, 16, v64
  v_lshlrev_b32 v65, 16, v65
  v_lshlrev_b32 v66, 16, v66
  v_lshlrev_b32 v67, 16, v67
  v_lshlrev_b32 v68, 16, v68
  s_waitcnt lgkmcnt(13)
  v_lshlrev_b32 v69, 16, v69
  s_waitcnt lgkmcnt(12)
  v_lshlrev_b32 v70, 16, v70
  s_waitcnt lgkmcnt(11)
  v_lshlrev_b32 v71, 16, v71
  s_waitcnt lgkmcnt(10)
  v_lshlrev_b32 v72, 16, v72
  s_waitcnt lgkmcnt(9)
  v_lshlrev_b32 v73, 16, v73
  s_waitcnt lgkmcnt(8)
  v_lshlrev_b32 v74, 16, v74
  s_waitcnt lgkmcnt(7)
  v_lshlrev_b32 v75, 16, v75
  s_waitcnt lgkmcnt(6)
  v_lshlrev_b32 v76, 16, v76
  s_waitcnt lgkmcnt(5)
  v_lshlrev_b32 v77, 16, v77
  s_waitcnt lgkmcnt(4)
  v_lshlrev_b32 v78, 16, v78
  s_waitcnt lgkmcnt(3)
  v_lshlrev_b32 v79, 16, v79
  s_waitcnt lgkmcnt(2)
  v_lshlrev_b32 v80, 16, v80
  s_waitcnt lgkmcnt(1)
  v_lshlrev_b32 v81, 16, v81
  s_waitcnt lgkmcnt(0)
  v_lshlrev_b32 v82, 16, v82
  v_max3_f32 v14, abs(v52), abs(v53), abs(v54)
  v_max3_f32 v14, v14, abs(v55), abs(v56)
  v_max3_f32 v14, v14, abs(v57), abs(v58)
  v_max3_f32 v14, v14, abs(v59), abs(v60)
  v_max3_f32 v14, v14, abs(v61), abs(v62)
  v_max3_f32 v14, v14, abs(v63), abs(v64)
  v_max3_f32 v14, v14, abs(v65), abs(v66)
  v_max3_f32 v14, v14, abs(v67), abs(v68)
  v_max3_f32 v14, v14, abs(v69), abs(v70)
  v_max3_f32 v14, v14, abs(v71), abs(v72)
  v_max3_f32 v14, v14, abs(v73), abs(v74)
  v_max3_f32 v14, v14, abs(v75), abs(v76)
  v_max3_f32 v14, v14, abs(v77), abs(v78)
  v_max3_f32 v14, v14, abs(v79), abs(v80)
  v_max3_f32 v14, v14, abs(v81), abs(v82)
  s_nop 1
  v_max_u32_dpp v14, v14, v14 row_shr:1 row_mask:0xf bank_mask:0xf
  s_nop 1
  v_max_u32_dpp v14, v14, v14 row_shr:2 row_mask:0xf bank_mask:0xf
  s_nop 1
  v_max_u32_dpp v14, v14, v14 row_shr:4 row_mask:0xf bank_mask:0xf
  s_nop 1
  v_max_u32_dpp v14, v14, v14 row_shr:8 row_mask:0xf bank_mask:0xf
  s_nop 1
  v_max_u32_dpp v14, v14, v14 row_bcast:15 row_mask:0xa bank_mask:0xf
  s_nop 1
  v_max_u32_dpp v14, v14, v14 row_bcast:31 row_mask:0xc bank_mask:0xf
  s_nop 0
  v_readlane_b32 s81, v14, 63
  s_nop 0
  s_lshr_b32 s81, s81, 23
  s_sub_i32 s81, 134, s81
  s_cmp_le_u32 s81, 9
  s_cselect_b32 s97, 2, 3
  s_min_i32 s81, s81, 16
  s_lshl_b32 s49, s81, 2
  s_sub_i32 s49, s48, s49
  s_add_i32 s81, s81, 127
  s_lshl_b32 s81, s81, 23
  v_mov_b32 v83, s81
  v_mul_f32 v52, s81, v52
  v_mul_f32 v53, s81, v53
  v_mul_f32 v54, s81, v54
  v_mul_f32 v55, s81, v55
  v_mul_f32 v56, s81, v56
  v_mul_f32 v57, s81, v57
  v_mul_f32 v58, s81, v58
  v_mul_f32 v59, s81, v59
  v_mul_f32 v60, s81, v60
  v_mul_f32 v61, s81, v61
  v_mul_f32 v62, s81, v62
  v_mul_f32 v63, s81, v63
  v_mul_f32 v64, s81, v64
  v_mul_f32 v65, s81, v65
  v_mul_f32 v66, s81, v66
  v_mul_f32 v67, s81, v67
  v_mul_f32 v68, s81, v68
  v_mul_f32 v69, s81, v69
  v_mul_f32 v70, s81, v70
  v_mul_f32 v71, s81, v71
  v_mul_f32 v72, s81, v72
  v_mul_f32 v73, s81, v73
  v_mul_f32 v74, s81, v74
  v_mul_f32 v75, s81, v75
  v_mul_f32 v76, s81, v76
  v_mul_f32 v77, s81, v77
  v_mul_f32 v78, s81, v78
  v_mul_f32 v79, s81, v79
  v_mul_f32 v80, s81, v80
  v_mul_f32 v81, s81, v81
  v_mul_f32 v82, s81, v82
  ds_write_b16_d16_hi v23, v52 offset:0
  ds_write_b16_d16_hi v23, v53 offset:128
  ds_write_b16_d16_hi v23, v54 offset:256
  ds_write_b16_d16_hi v23, v55 offset:384
  ds_write_b16_d16_hi v23, v56 offset:512
  ds_write_b16_d16_hi v23, v57 offset:640
  ds_write_b16_d16_hi v23, v58 offset:768
  ds_write_b16_d16_hi v23, v59 offset:896
  ds_write_b16_d16_hi v23, v60 offset:1056
  ds_write_b16_d16_hi v23, v61 offset:1184
  ds_write_b16_d16_hi v23, v62 offset:1312
  ds_write_b16_d16_hi v23, v63 offset:1440
  ds_write_b16_d16_hi v23, v64 offset:1568
  ds_write_b16_d16_hi v23, v65 offset:1696
  ds_write_b16_d16_hi v23, v66 offset:1824
  ds_write_b16_d16_hi v23, v67 offset:1952
  ds_write_b16_d16_hi v23, v68 offset:2112
  ds_write_b16_d16_hi v23, v69 offset:2240
  ds_write_b16_d16_hi v23, v70 offset:2368
  ds_write_b16_d16_hi v23, v71 offset:2496
  ds_write_b16_d16_hi v23, v72 offset:2624
  ds_write_b16_d16_hi v23, v73 offset:2752
  ds_write_b16_d16_hi v23, v74 offset:2880
  ds_write_b16_d16_hi v23, v75 offset:3008
  ds_write_b16_d16_hi v23, v76 offset:3168
  ds_write_b16_d16_hi v23, v77 offset:3296
  ds_write_b16_d16_hi v23, v78 offset:3424
  ds_write_b16_d16_hi v23, v79 offset:3552
  ds_write_b16_d16_hi v23, v80 offset:3680
  ds_write_b16_d16_hi v23, v81 offset:3808
  ds_write_b16_d16_hi v23, v82 offset:3936
  v_mul_f32 v52, s81, v52
  v_mul_f32 v53, s81, v53
  v_mul_f32 v54, s81, v54
  v_mul_f32 v55, s81, v55
  v_mul_f32 v56, s81, v56
  v_mul_f32 v57, s81, v57
  v_mul_f32 v58, s81, v58
  v_mul_f32 v59, s81, v59
  v_mul_f32 v60, s81, v60
  v_mul_f32 v61, s81, v61
  v_mul_f32 v62, s81, v62
  v_mul_f32 v63, s81, v63
  v_mul_f32 v64, s81, v64
  v_mul_f32 v65, s81, v65
  v_mul_f32 v66, s81, v66
  v_mul_f32 v67, s81, v67
  v_mul_f32 v68, s81, v68
  v_mul_f32 v69, s81, v69
  v_mul_f32 v70, s81, v70
  v_mul_f32 v71, s81, v71
  v_mul_f32 v72, s81, v72
  v_mul_f32 v73, s81, v73
  v_mul_f32 v74, s81, v74
  v_mul_f32 v75, s81, v75
  v_mul_f32 v76, s81, v76
  v_mul_f32 v77, s81, v77
  v_mul_f32 v78, s81, v78
  v_mul_f32 v79, s81, v79
  v_mul_f32 v80, s81, v80
  v_mul_f32 v81, s81, v81
  v_mul_f32 v82, s81, v82
  v_mul_f32 v83, s81, v83
  ds_write_b16_d16_hi v22, v52 offset:0
  ds_write_b16_d16_hi v22, v53 offset:128
  ds_write_b16_d16_hi v22, v54 offset:256
  ds_write_b16_d16_hi v22, v55 offset:384
  ds_write_b16_d16_hi v22, v56 offset:512
  ds_write_b16_d16_hi v22, v57 offset:640
  ds_write_b16_d16_hi v22, v58 offset:768
  ds_write_b16_d16_hi v22, v59 offset:896
  ds_write_b16_d16_hi v22, v60 offset:1056
  ds_write_b16_d16_hi v22, v61 offset:1184
  ds_write_b16_d16_hi v22, v62 offset:1312
  ds_write_b16_d16_hi v22, v63 offset:1440
  ds_write_b16_d16_hi v22, v64 offset:1568
  ds_write_b16_d16_hi v22, v65 offset:1696
  ds_write_b16_d16_hi v22, v66 offset:1824
  ds_write_b16_d16_hi v22, v67 offset:1952
  ds_write_b16_d16_hi v22, v68 offset:2112
  ds_write_b16_d16_hi v22, v69 offset:2240
  ds_write_b16_d16_hi v22, v70 offset:2368
  ds_write_b16_d16_hi v22, v71 offset:2496
  ds_write_b16_d16_hi v22, v72 offset:2624
  ds_write_b16_d16_hi v22, v73 offset:2752
  ds_write_b16_d16_hi v22, v74 offset:2880
  ds_write_b16_d16_hi v22, v75 offset:3008
  ds_write_b16_d16_hi v22, v76 offset:3168
  ds_write_b16_d16_hi v22, v77 offset:3296
  ds_write_b16_d16_hi v22, v78 offset:3424
  ds_write_b16_d16_hi v22, v79 offset:3552
  ds_write_b16_d16_hi v22, v80 offset:3680
  ds_write_b16_d16_hi v22, v81 offset:3808
  ds_write_b16_d16_hi v22, v82 offset:3936
  ds_write_b16_d16_hi v22, v83 offset:4064
  s_mov_b32 s50, 0
  s_waitcnt lgkmcnt(0)
  s_branch L_prime
L_cin_done:
  s_endpgm
L_rem:
  s_lshr_b32 s84, s3, 2
  s_and_b32 s68, s2, 7
  s_lshl_b32 s68, s68, 3
  s_add_u32 s68, s68, s3
  s_mul_i32 s68, s68, 6656
  s_lshl_b32 s76, s3, 14
  v_lshlrev_b32 v248, 4, v0
  v_lshrrev_b32 v246, 4, v0
  v_lshrrev_b32 v247, 3, v0
  v_mul_u32_u24 v13, 3328, v247
  v_and_b32 v247, 2, v247
  s_and_b32 s69, s3, 1
  s_lshl_b32 s69, s69, 2
  v_or_b32 v247, s69, v247
  v_and_b32 v9, 7, v0
  v_xor_b32 v247, v247, v9
  v_lshl_add_u32 v13, v247, 4, v13
  s_mul_i32 s74, s3, 26624
  s_add_u32 s74, s74, 3200
  s_lshl_b32 s75, s3, 10
  s_add_u32 s75, s75, 131072
  s_waitcnt lgkmcnt(0)
  s_load_dword s80, s[18:19], 0
  s_mov_b32 s28, s4
  s_and_b32 s29, s5, 0xffff
  s_mov_b32 s30, 425984
  s_mov_b32 s31, 0x20000
  s_add_u32 m0, s76, 8192
  s_nop 0
  buffer_load_dwordx4 v248, s[28:31], s68 offen lds
  s_add_u32 s68, s68, 1024
  s_add_u32 m0, s76, 9216
  s_nop 0
  buffer_load_dwordx4 v248, s[28:31], s68 offen lds
  s_add_u32 s68, s68, 1024
  s_add_u32 m0, s76, 10240
  s_nop 0
  buffer_load_dwordx4 v248, s[28:31], s68 offen lds
  s_add_u32 s68, s68, 1024
  s_add_u32 m0, s76, 11264
  s_nop 0
  buffer_load_dwordx4 v248, s[28:31], s68 offen lds
  s_add_u32 s68, s68, 1024
  s_add_u32 m0, s76, 12288
  s_nop 0
  buffer_load_dwordx4 v248, s[28:31], s68 offen lds
  s_add_u32 s68, s68, 1024
  s_add_u32 m0, s76, 13312
  s_nop 0
  buffer_load_dwordx4 v248, s[28:31], s68 offen lds
  s_add_u32 s68, s68, 1024
  s_add_u32 m0, s76, 14336
  s_nop 0
  buffer_load_dwordx4 v248, s[28:31], s68 offen lds
  s_add_u32 s68, s68, 1024
  s_mov_b32 s44, s12
  s_and_b32 s45, s13, 0xffff
  s_mov_b32 s46, 5537792
  s_mov_b32 s47, 0x20000
  s_add_u32 m0, s75, 0
  s_nop 0
  buffer_load_dwordx4 v13, s[44:47], s74 offen lds
  s_add_u32 s74, s74, 212992
  s_mov_b32 s60, s24
  s_and_b32 s61, s25, 0xffff
  s_mov_b32 s62, 268435456
  s_mov_b32 s63, 0x20000
  s_mov_b32 s64, s22
  s_and_b32 s65, s23, 0xffff
  s_mov_b32 s66, 256
  s_mov_b32 s67, 0x20000
  v_mov_b32 v64, -1
  v_mov_b32 v65, -1
  v_mov_b32 v66, -1
  v_mov_b32 v67, -1
  s_and_b32 s70, s2, 7
  s_lshl_b32 s68, s70, 3
  s_add_u32 s68, s68, s3
  s_lshl_b32 s68, s68, 11
  s_lshl_b32 s70, s70, 2
  buffer_store_dwordx4 v[64:67], v248, s[60:63], s68 offen sc1
  buffer_store_dwordx4 v[64:67], v248, s[60:63], s68 offen offset:1024 sc1
  s_mov_b32 s48, s14
  s_and_b32 s49, s15, 0xffff
  s_mov_b32 s50, 3328
  s_mov_b32 s51, 0x20000
  s_mov_b32 s52, s16
  s_and_b32 s53, s17, 0xffff
  s_mov_b32 s54, 3328
  s_mov_b32 s55, 0x20000
  s_mov_b32 s32, s6
  s_and_b32 s33, s7, 0xffff
  s_mov_b32 s34, 12800000
  s_mov_b32 s35, 0x20000
  v_xor_b32 v248, v9, v246
  v_lshlrev_b32 v14, 4, v248
  v_xor_b32 v15, 64, v14
  v_bfe_u32 v247, v0, 2, 2
  v_lshl_add_u32 v248, v246, 3, v247
  v_lshlrev_b32 v248, 7, v248
  v_and_b32 v247, 3, v0
  v_lshl_add_u32 v248, v247, 3, v248
  v_add_u32 v248, 131072, v248
  v_bfe_u32 v247, v0, 3, 2
  v_lshl_add_u32 v1, v247, 5, v248
  v_xor_b32 v2, 32, v1
  v_xor_b32 v7, 64, v1
  v_xor_b32 v8, 96, v1
  v_and_b32 v248, 15, v0
  v_lshlrev_b32 v248, 7, v248
  v_bfe_u32 v247, v0, 1, 3
  v_xor_b32 v247, v247, v246
  v_lshl_add_u32 v248, v247, 4, v248
  v_add_u32 v11, s76, v248
  v_xor_b32 v12, 64, v11
  v_lshrrev_b32 v247, 3, v0
  v_lshl_add_u32 v248, v9, 3, v247
  v_mul_u32_u24 v248, 104, v248
  v_add_u32 v248, s76, v248
  s_mov_b32 s56, s20
  s_and_b32 s57, s21, 0xffff
  s_mov_b32 s58, 8192
  s_mov_b32 s59, 0x20000
  s_and_b32 s77, s2, 7
  s_lshl_b32 s68, s77, 14
  s_lshl_b32 s69, s3, 8
  s_add_u32 s68, s68, s69
  s_add_u32 s69, s68, 4096
  s_add_u32 s71, s68, 8192
  s_lshl_b32 s77, s77, 3
  s_add_u32 s77, s77, s3
  s_lshl_b32 s77, s77, 7
  v_lshlrev_b32 v3, 2, v0
  v_lshlrev_b32 v4, 1, v0
  s_lshl_b32 s81, s3, 6
  v_add_u32 v5, s81, v0
  v_cmp_lt_u32 vcc, 507, v5
  v_add_u32 v5, 4096, v3
  v_mov_b32 v6, 0x7f000000
  v_cndmask_b32 v5, v6, v5, vcc
  v_mov_b32 v240, 0xc0135761
  v_mov_b32 v241, 0xc0135761
  v_mov_b32 v242, 0xbdd2d3e8
  v_mov_b32 v243, 0xbdd2d3e8
  v_mov_b32 v244, 0x71800000
  v_mov_b32 v160, 0
  v_mov_b32 v161, 0
  v_mov_b32 v162, 0
  v_mov_b32 v163, 0
  v_mov_b32 v164, 0
  v_mov_b32 v165, 0
  v_mov_b32 v166, 0
  v_mov_b32 v167, 0
  v_mov_b32 v168, 0
  v_mov_b32 v169, 0
  v_mov_b32 v170, 0
  v_mov_b32 v171, 0
  v_mov_b32 v172, 0
  v_mov_b32 v173, 0
  v_mov_b32 v174, 0
  v_mov_b32 v175, 0
  v_mov_b32 v176, 0
  v_mov_b32 v177, 0
  v_mov_b32 v178, 0
  v_mov_b32 v179, 0
  v_mov_b32 v180, 0
  v_mov_b32 v181, 0
  v_mov_b32 v182, 0
  v_mov_b32 v183, 0
  v_mov_b32 v184, 0
  v_mov_b32 v185, 0
  v_mov_b32 v186, 0
  v_mov_b32 v187, 0
  v_mov_b32 v188, 0
  v_mov_b32 v189, 0
  v_mov_b32 v190, 0
  v_mov_b32 v191, 0
  v_mov_b32 v192, 0
  v_mov_b32 v193, 0
  v_mov_b32 v194, 0
  v_mov_b32 v195, 0
  v_mov_b32 v196, 0
  v_mov_b32 v197, 0
  v_mov_b32 v198, 0
  v_mov_b32 v199, 0
  v_mov_b32 v200, 0
  v_mov_b32 v201, 0
  v_mov_b32 v202, 0
  v_mov_b32 v203, 0
  v_mov_b32 v204, 0
  v_mov_b32 v205, 0
  v_mov_b32 v206, 0
  v_mov_b32 v207, 0
  v_mov_b32 v208, 0
  v_mov_b32 v209, 0
  v_mov_b32 v210, 0
  v_mov_b32 v211, 0
  v_mov_b32 v212, 0
  v_mov_b32 v213, 0
  v_mov_b32 v214, 0
  v_mov_b32 v215, 0
  v_mov_b32 v216, 0
  v_mov_b32 v217, 0
  v_mov_b32 v218, 0
  v_mov_b32 v219, 0
  v_mov_b32 v220, 0
  v_mov_b32 v221, 0
  v_mov_b32 v222, 0
  v_mov_b32 v223, 0
  s_waitcnt vmcnt(0) lgkmcnt(0)
  s_lshl_b32 s80, s80, 16
  ds_read_b64 v[32:33], v248 offset:8192
  ds_read_b64 v[34:35], v248 offset:8200
  ds_read_b64 v[36:37], v248 offset:8208
  ds_read_b64 v[38:39], v248 offset:8216
  ds_read_b64 v[40:41], v248 offset:8224
  ds_read_b64 v[42:43], v248 offset:8232
  ds_read_b64 v[44:45], v248 offset:8240
  ds_read_b64 v[46:47], v248 offset:8248
  ds_read_b64 v[48:49], v248 offset:8256
  ds_read_b64 v[50:51], v248 offset:8264
  ds_read_b64 v[52:53], v248 offset:8272
  ds_read_b64 v[54:55], v248 offset:8280
  ds_read_b64 v[56:57], v248 offset:8288
  v_mov_b32 v24, 0
  v_mov_b32 v25, 0
  v_mov_b32 v26, 0
  v_mov_b32 v27, 0
  v_mov_b32 v28, 0
  v_mov_b32 v29, 0
  v_mov_b32 v30, 0
  v_mov_b32 v31, 0
  v_mov_b32 v58, 0x7f000000
  v_mov_b32 v59, 0x7f000000
  s_waitcnt lgkmcnt(12)
  v_lshlrev_b32 v32, 7, v32
  s_nop 1
  v_add_u32_dpp v24, v32, v14 row_newbcast:0 row_mask:0xf bank_mask:0x3
  v_add_u32_dpp v25, v32, v15 row_newbcast:1 row_mask:0xf bank_mask:0x3
  v_add_u32_dpp v26, v32, v14 row_newbcast:2 row_mask:0xf bank_mask:0x3
  v_add_u32_dpp v27, v32, v15 row_newbcast:3 row_mask:0xf bank_mask:0x3
  v_add_u32_dpp v24, v32, v14 row_newbcast:8 row_mask:0xf bank_mask:0xc
  v_add_u32_dpp v25, v32, v15 row_newbcast:9 row_mask:0xf bank_mask:0xc
  v_add_u32_dpp v26, v32, v14 row_newbcast:10 row_mask:0xf bank_mask:0xc
  v_add_u32_dpp v27, v32, v15 row_newbcast:11 row_mask:0xf bank_mask:0xc
  s_add_u32 m0, s76, 0
  s_nop 0
  buffer_load_dwordx4 v24, s[32:35], 0 offen lds
  s_add_u32 m0, s76, 1024
  s_nop 0
  buffer_load_dwordx4 v25, s[32:35], 0 offen lds
  s_add_u32 m0, s76, 2048
  s_nop 0
  buffer_load_dwordx4 v26, s[32:35], 0 offen lds
  s_add_u32 m0, s76, 3072
  s_nop 0
  buffer_load_dwordx4 v27, s[32:35], 0 offen lds
  v_add_u32_dpp v28, v32, v14 row_newbcast:4 row_mask:0xf bank_mask:0x3
  v_add_u32_dpp v29, v32, v15 row_newbcast:5 row_mask:0xf bank_mask:0x3
  v_add_u32_dpp v30, v32, v14 row_newbcast:6 row_mask:0xf bank_mask:0x3
  v_add_u32_dpp v31, v32, v15 row_newbcast:7 row_mask:0xf bank_mask:0x3
  v_add_u32_dpp v28, v32, v14 row_newbcast:12 row_mask:0xf bank_mask:0xc
  v_add_u32_dpp v29, v32, v15 row_newbcast:13 row_mask:0xf bank_mask:0xc
  v_add_u32_dpp v30, v32, v14 row_newbcast:14 row_mask:0xf bank_mask:0xc
  v_add_u32_dpp v31, v32, v15 row_newbcast:15 row_mask:0xf bank_mask:0xc
  s_add_u32 m0, s76, 4096
  s_nop 0
  buffer_load_dwordx4 v28, s[32:35], 0 offen lds
  s_add_u32 m0, s76, 5120
  s_nop 0
  buffer_load_dwordx4 v29, s[32:35], 0 offen lds
  s_add_u32 m0, s76, 6144
  s_nop 0
  buffer_load_dwordx4 v30, s[32:35], 0 offen lds
  s_add_u32 m0, s76, 7168
  s_nop 0
  buffer_load_dwordx4 v31, s[32:35], 0 offen lds
  s_add_u32 m0, s75, 8192
  s_nop 0
  buffer_load_dwordx4 v13, s[44:47], s74 offen lds
  s_add_u32 s74, s74, 212992
  s_waitcnt lgkmcnt(0)
  v_lshlrev_b32 v57, 7, v57
  v_lshlrev_b32 v56, 7, v56
  v_lshlrev_b32 v55, 7, v55
  v_lshlrev_b32 v54, 7, v54
  v_lshlrev_b32 v53, 7, v53
  v_lshlrev_b32 v52, 7, v52
  v_lshlrev_b32 v51, 7, v51
  v_lshlrev_b32 v50, 7, v50
  v_lshlrev_b32 v49, 7, v49
  v_lshlrev_b32 v48, 7, v48
  v_lshlrev_b32 v47, 7, v47
  v_lshlrev_b32 v46, 7, v46
  v_lshlrev_b32 v45, 7, v45
  v_lshlrev_b32 v44, 7, v44
  v_lshlrev_b32 v43, 7, v43
  v_lshlrev_b32 v42, 7, v42
  v_lshlrev_b32 v41, 7, v41
  v_lshlrev_b32 v40, 7, v40
  v_lshlrev_b32 v39, 7, v39
  v_lshlrev_b32 v38, 7, v38
  v_lshlrev_b32 v37, 7, v37
  v_lshlrev_b32 v36, 7, v36
  v_lshlrev_b32 v35, 7, v35
  v_lshlrev_b32 v34, 7, v34
  v_lshlrev_b32 v33, 7, v33
  s_nop 1
  v_add_u32_dpp v24, v33, v14 row_newbcast:0 row_mask:0xf bank_mask:0x3
  v_add_u32_dpp v25, v33, v15 row_newbcast:1 row_mask:0xf bank_mask:0x3
  v_add_u32_dpp v26, v33, v14 row_newbcast:2 row_mask:0xf bank_mask:0x3
  v_add_u32_dpp v27, v33, v15 row_newbcast:3 row_mask:0xf bank_mask:0x3
  v_add_u32_dpp v24, v33, v14 row_newbcast:8 row_mask:0xf bank_mask:0xc
  v_add_u32_dpp v25, v33, v15 row_newbcast:9 row_mask:0xf bank_mask:0xc
  v_add_u32_dpp v26, v33, v14 row_newbcast:10 row_mask:0xf bank_mask:0xc
  v_add_u32_dpp v27, v33, v15 row_newbcast:11 row_mask:0xf bank_mask:0xc
  s_add_u32 m0, s76, 8192
  s_nop 0
  buffer_load_dwordx4 v24, s[32:35], 0 offen lds
  s_add_u32 m0, s76, 9216
  s_nop 0
  buffer_load_dwordx4 v25, s[32:35], 0 offen lds
  s_add_u32 m0, s76, 10240
  s_nop 0
  buffer_load_dwordx4 v26, s[32:35], 0 offen lds
  s_add_u32 m0, s76, 11264
  s_nop 0
  buffer_load_dwordx4 v27, s[32:35], 0 offen lds
  v_add_u32_dpp v28, v33, v14 row_newbcast:4 row_mask:0xf bank_mask:0x3
  v_add_u32_dpp v29, v33, v15 row_newbcast:5 row_mask:0xf bank_mask:0x3
  v_add_u32_dpp v30, v33, v14 row_newbcast:6 row_mask:0xf bank_mask:0x3
  v_add_u32_dpp v31, v33, v15 row_newbcast:7 row_mask:0xf bank_mask:0x3
  v_add_u32_dpp v28, v33, v14 row_newbcast:12 row_mask:0xf bank_mask:0xc
  v_add_u32_dpp v29, v33, v15 row_newbcast:13 row_mask:0xf bank_mask:0xc
  v_add_u32_dpp v30, v33, v14 row_newbcast:14 row_mask:0xf bank_mask:0xc
  v_add_u32_dpp v31, v33, v15 row_newbcast:15 row_mask:0xf bank_mask:0xc
  s_add_u32 m0, s76, 12288
  s_nop 0
  buffer_load_dwordx4 v28, s[32:35], 0 offen lds
  s_add_u32 m0, s76, 13312
  s_nop 0
  buffer_load_dwordx4 v29, s[32:35], 0 offen lds
  s_add_u32 m0, s76, 14336
  s_nop 0
  buffer_load_dwordx4 v30, s[32:35], 0 offen lds
  s_add_u32 m0, s76, 15360
  s_nop 0
  buffer_load_dwordx4 v31, s[32:35], 0 offen lds
  s_add_u32 m0, s75, 16384
  s_nop 0
  buffer_load_dwordx4 v13, s[44:47], s74 offen lds
  s_add_u32 s74, s74, 212992
  v_lshlrev_b32 v248, 3, v246
  s_mov_b32 s73, 3
  v_mov_b32 v9, v34
  s_nop 1
  v_add_u32_dpp v24, v9, v14 row_newbcast:0 row_mask:0xf bank_mask:0x3
  v_add_u32_dpp v25, v9, v15 row_newbcast:1 row_mask:0xf bank_mask:0x3
  v_add_u32_dpp v26, v9, v14 row_newbcast:2 row_mask:0xf bank_mask:0x3
  v_add_u32_dpp v27, v9, v15 row_newbcast:3 row_mask:0xf bank_mask:0x3
  v_add_u32_dpp v24, v9, v14 row_newbcast:8 row_mask:0xf bank_mask:0xc
  v_add_u32_dpp v25, v9, v15 row_newbcast:9 row_mask:0xf bank_mask:0xc
  v_add_u32_dpp v26, v9, v14 row_newbcast:10 row_mask:0xf bank_mask:0xc
  v_add_u32_dpp v27, v9, v15 row_newbcast:11 row_mask:0xf bank_mask:0xc
  s_waitcnt vmcnt(14)
  s_barrier
  ds_read_b128 v[76:79], v12 offset:2048
  ds_read_b128 v[72:75], v11 offset:2048
  ds_read_b128 v[68:71], v12 offset:0
  ds_read_b128 v[64:67], v11 offset:0
  ds_read_b64_tr_b16 v[96:97], v1 offset:0
  ds_read_b64_tr_b16 v[98:99], v1 offset:512
  ds_read_b64_tr_b16 v[100:101], v1 offset:4096
  ds_read_b64_tr_b16 v[102:103], v1 offset:4608
  ds_read_b64_tr_b16 v[104:105], v2 offset:0
  ds_read_b64_tr_b16 v[106:107], v2 offset:512
  ds_read_b64_tr_b16 v[108:109], v2 offset:4096
  ds_read_b64_tr_b16 v[110:111], v2 offset:4608
  ds_read_b64_tr_b16 v[112:113], v7 offset:0
  ds_read_b64_tr_b16 v[114:115], v7 offset:512
  ds_read_b64_tr_b16 v[116:117], v7 offset:4096
  ds_read_b64_tr_b16 v[118:119], v7 offset:4608
  ds_read_b64_tr_b16 v[120:121], v8 offset:0
  ds_read_b64_tr_b16 v[122:123], v8 offset:512
  ds_read_b64_tr_b16 v[124:125], v8 offset:4096
  ds_read_b64_tr_b16 v[126:127], v8 offset:4608
  s_cmp_lg_u32 s3, 7
  s_cbranch_scc1 L_rem_loop
  s_mov_b64 exec, 1
  buffer_store_dword v240, v14, s[64:67], s70 offen offset:128 sc1
  s_mov_b64 exec, -1
L_rem_loop:
  s_waitcnt vmcnt(9)
  s_barrier
  s_waitcnt lgkmcnt(8)
  v_mfma_f32_16x16x32_bf16 v[160:163], v[96:99], v[64:67], v[160:163]
  ds_read_b128 v[92:95], v12 offset:6144
  ds_read_b128 v[88:91], v11 offset:6144
  s_waitcnt lgkmcnt(14)
  v_mfma_f32_16x16x32_bf16 v[160:163], v[100:103], v[68:71], v[160:163]
  ds_read_b128 v[84:87], v12 offset:4096
  s_add_u32 m0, s76, 0
  s_nop 0
  buffer_load_dwordx4 v24, s[32:35], 0 offen lds
  v_mfma_f32_16x16x32_bf16 v[164:167], v[96:99], v[72:75], v[164:167]
  ds_read_b128 v[80:83], v11 offset:4096
  v_mfma_f32_16x16x32_bf16 v[164:167], v[100:103], v[76:79], v[164:167]
  ds_read_b64_tr_b16 v[128:129], v1 offset:8192
  s_waitcnt lgkmcnt(14)
  v_mfma_f32_16x16x32_bf16 v[176:179], v[104:107], v[64:67], v[176:179]
  ds_read_b64_tr_b16 v[130:131], v1 offset:8704
  s_add_u32 m0, s76, 1024
  s_nop 0
  buffer_load_dwordx4 v25, s[32:35], 0 offen lds
  s_waitcnt lgkmcnt(14)
  v_mfma_f32_16x16x32_bf16 v[176:179], v[108:111], v[68:71], v[176:179]
  ds_read_b64_tr_b16 v[132:133], v1 offset:12288
  v_mfma_f32_16x16x32_bf16 v[180:183], v[104:107], v[72:75], v[180:183]
  ds_read_b64_tr_b16 v[134:135], v1 offset:12800
  v_mfma_f32_16x16x32_bf16 v[180:183], v[108:111], v[76:79], v[180:183]
  ds_read_b64_tr_b16 v[136:137], v2 offset:8192
  s_waitcnt lgkmcnt(14)
  v_mfma_f32_16x16x32_bf16 v[192:195], v[112:115], v[64:67], v[192:195]
  ds_read_b64_tr_b16 v[138:139], v2 offset:8704
  s_add_u32 m0, s76, 2048
  s_nop 0
  buffer_load_dwordx4 v26, s[32:35], 0 offen lds
  s_waitcnt lgkmcnt(14)
  v_mfma_f32_16x16x32_bf16 v[192:195], v[116:119], v[68:71], v[192:195]
  ds_read_b64_tr_b16 v[140:141], v2 offset:12288
  v_mfma_f32_16x16x32_bf16 v[196:199], v[112:115], v[72:75], v[196:199]
  ds_read_b64_tr_b16 v[142:143], v2 offset:12800
  v_mfma_f32_16x16x32_bf16 v[196:199], v[116:119], v[76:79], v[196:199]
  v_add_u32_dpp v28, v9, v14 row_newbcast:4 row_mask:0xf bank_mask:0x3
  v_add_u32_dpp v29, v9, v15 row_newbcast:5 row_mask:0xf bank_mask:0x3
  s_waitcnt lgkmcnt(14)
  v_mfma_f32_16x16x32_bf16 v[208:211], v[120:123], v[64:67], v[208:211]
  s_add_u32 m0, s76, 3072
  s_nop 0
  buffer_load_dwordx4 v27, s[32:35], 0 offen lds
  v_add_u32_dpp v30, v9, v14 row_newbcast:6 row_mask:0xf bank_mask:0x3
  v_add_u32_dpp v31, v9, v15 row_newbcast:7 row_mask:0xf bank_mask:0x3
  s_waitcnt lgkmcnt(12)
  v_mfma_f32_16x16x32_bf16 v[208:211], v[124:127], v[68:71], v[208:211]
  v_add_u32_dpp v28, v9, v14 row_newbcast:12 row_mask:0xf bank_mask:0xc
  v_mfma_f32_16x16x32_bf16 v[212:215], v[120:123], v[72:75], v[212:215]
  v_add_u32_dpp v29, v9, v15 row_newbcast:13 row_mask:0xf bank_mask:0xc
  v_add_u32_dpp v30, v9, v14 row_newbcast:14 row_mask:0xf bank_mask:0xc
  v_mfma_f32_16x16x32_bf16 v[212:215], v[124:127], v[76:79], v[212:215]
  v_add_u32_dpp v31, v9, v15 row_newbcast:15 row_mask:0xf bank_mask:0xc
  s_waitcnt vmcnt(9)
  s_waitcnt lgkmcnt(8)
  v_mfma_f32_16x16x32_bf16 v[168:171], v[96:99], v[80:83], v[168:171]
  ds_read_b128 v[76:79], v12 offset:10240
  ds_read_b128 v[72:75], v11 offset:10240
  v_mfma_f32_16x16x32_bf16 v[168:171], v[100:103], v[84:87], v[168:171]
  ds_read_b128 v[68:71], v12 offset:8192
  s_add_u32 m0, s76, 4096
  s_nop 0
  buffer_load_dwordx4 v28, s[32:35], 0 offen lds
  v_mfma_f32_16x16x32_bf16 v[172:175], v[96:99], v[88:91], v[172:175]
  ds_read_b128 v[64:67], v11 offset:8192
  v_mfma_f32_16x16x32_bf16 v[172:175], v[100:103], v[92:95], v[172:175]
  ds_read_b64_tr_b16 v[144:145], v7 offset:8192
  v_mfma_f32_16x16x32_bf16 v[184:187], v[104:107], v[80:83], v[184:187]
  ds_read_b64_tr_b16 v[146:147], v7 offset:8704
  s_add_u32 m0, s76, 5120
  s_nop 0
  buffer_load_dwordx4 v29, s[32:35], 0 offen lds
  v_mfma_f32_16x16x32_bf16 v[184:187], v[108:111], v[84:87], v[184:187]
  ds_read_b64_tr_b16 v[148:149], v7 offset:12288
  v_mfma_f32_16x16x32_bf16 v[188:191], v[104:107], v[88:91], v[188:191]
  ds_read_b64_tr_b16 v[150:151], v7 offset:12800
  v_mfma_f32_16x16x32_bf16 v[188:191], v[108:111], v[92:95], v[188:191]
  ds_read_b64_tr_b16 v[152:153], v8 offset:8192
  s_add_u32 m0, s76, 6144
  s_nop 0
  buffer_load_dwordx4 v30, s[32:35], 0 offen lds
  v_mfma_f32_16x16x32_bf16 v[200:203], v[112:115], v[80:83], v[200:203]
  ds_read_b64_tr_b16 v[154:155], v8 offset:8704
  v_mfma_f32_16x16x32_bf16 v[200:203], v[116:119], v[84:87], v[200:203]
  ds_read_b64_tr_b16 v[156:157], v8 offset:12288
  v_mfma_f32_16x16x32_bf16 v[204:207], v[112:115], v[88:91], v[204:207]
  ds_read_b64_tr_b16 v[158:159], v8 offset:12800
  s_add_u32 m0, s76, 7168
  s_nop 0
  buffer_load_dwordx4 v31, s[32:35], 0 offen lds
  v_mfma_f32_16x16x32_bf16 v[204:207], v[116:119], v[92:95], v[204:207]
  s_set_gpr_idx_on s73, gpr_idx(SRC0)
  s_nop 0
  v_mov_b32 v9, v32
  s_set_gpr_idx_off
  s_add_u32 s73, s73, 1
  v_add_u32_dpp v24, v9, v14 row_newbcast:0 row_mask:0xf bank_mask:0x3
  v_mfma_f32_16x16x32_bf16 v[216:219], v[120:123], v[80:83], v[216:219]
  v_add_u32_dpp v25, v9, v15 row_newbcast:1 row_mask:0xf bank_mask:0x3
  v_add_u32_dpp v26, v9, v14 row_newbcast:2 row_mask:0xf bank_mask:0x3
  v_mfma_f32_16x16x32_bf16 v[216:219], v[124:127], v[84:87], v[216:219]
  s_xor_b32 s75, s75, 16384
  s_add_u32 m0, s75, 8192
  s_nop 0
  buffer_load_dwordx4 v13, s[44:47], s74 offen lds
  s_add_u32 s74, s74, 212992
  s_xor_b32 s75, s75, 16384
  v_add_u32_dpp v27, v9, v15 row_newbcast:3 row_mask:0xf bank_mask:0x3
  v_add_u32_dpp v24, v9, v14 row_newbcast:8 row_mask:0xf bank_mask:0xc
  v_mfma_f32_16x16x32_bf16 v[220:223], v[120:123], v[88:91], v[220:223]
  v_add_u32_dpp v25, v9, v15 row_newbcast:9 row_mask:0xf bank_mask:0xc
  v_add_u32_dpp v26, v9, v14 row_newbcast:10 row_mask:0xf bank_mask:0xc
  v_mfma_f32_16x16x32_bf16 v[220:223], v[124:127], v[92:95], v[220:223]
  v_add_u32_dpp v27, v9, v15 row_newbcast:11 row_mask:0xf bank_mask:0xc
L_rnv:
  s_waitcnt vmcnt(9)
  s_barrier
  v_xor_b32 v1, 16384, v1
  v_xor_b32 v2, 16384, v2
  v_xor_b32 v7, 16384, v7
  v_xor_b32 v8, 16384, v8
  s_waitcnt lgkmcnt(8)
  v_mfma_f32_16x16x32_bf16 v[160:163], v[128:131], v[64:67], v[160:163]
  ds_read_b128 v[92:95], v12 offset:14336
  ds_read_b128 v[88:91], v11 offset:14336
  v_mfma_f32_16x16x32_bf16 v[160:163], v[132:135], v[68:71], v[160:163]
  ds_read_b128 v[84:87], v12 offset:12288
  s_add_u32 m0, s76, 8192
  s_nop 0
  buffer_load_dwordx4 v24, s[32:35], 0 offen lds
  v_mfma_f32_16x16x32_bf16 v[164:167], v[128:131], v[72:75], v[164:167]
  ds_read_b128 v[80:83], v11 offset:12288
  v_mfma_f32_16x16x32_bf16 v[164:167], v[132:135], v[76:79], v[164:167]
  ds_read_b64_tr_b16 v[96:97], v1 offset:0
  v_mfma_f32_16x16x32_bf16 v[176:179], v[136:139], v[64:67], v[176:179]
  ds_read_b64_tr_b16 v[98:99], v1 offset:512
  s_add_u32 m0, s76, 9216
  s_nop 0
  buffer_load_dwordx4 v25, s[32:35], 0 offen lds
  v_mfma_f32_16x16x32_bf16 v[176:179], v[140:143], v[68:71], v[176:179]
  ds_read_b64_tr_b16 v[100:101], v1 offset:4096
  v_mfma_f32_16x16x32_bf16 v[180:183], v[136:139], v[72:75], v[180:183]
  ds_read_b64_tr_b16 v[102:103], v1 offset:4608
  v_mfma_f32_16x16x32_bf16 v[180:183], v[140:143], v[76:79], v[180:183]
  ds_read_b64_tr_b16 v[104:105], v2 offset:0
  s_waitcnt lgkmcnt(14)
  v_mfma_f32_16x16x32_bf16 v[192:195], v[144:147], v[64:67], v[192:195]
  ds_read_b64_tr_b16 v[106:107], v2 offset:512
  s_add_u32 m0, s76, 10240
  s_nop 0
  buffer_load_dwordx4 v26, s[32:35], 0 offen lds
  s_waitcnt lgkmcnt(14)
  v_mfma_f32_16x16x32_bf16 v[192:195], v[148:151], v[68:71], v[192:195]
  ds_read_b64_tr_b16 v[108:109], v2 offset:4096
  v_mfma_f32_16x16x32_bf16 v[196:199], v[144:147], v[72:75], v[196:199]
  ds_read_b64_tr_b16 v[110:111], v2 offset:4608
  v_mfma_f32_16x16x32_bf16 v[196:199], v[148:151], v[76:79], v[196:199]
  v_add_u32_dpp v28, v9, v14 row_newbcast:4 row_mask:0xf bank_mask:0x3
  v_add_u32_dpp v29, v9, v15 row_newbcast:5 row_mask:0xf bank_mask:0x3
  s_waitcnt lgkmcnt(14)
  v_mfma_f32_16x16x32_bf16 v[208:211], v[152:155], v[64:67], v[208:211]
  s_add_u32 m0, s76, 11264
  s_nop 0
  buffer_load_dwordx4 v27, s[32:35], 0 offen lds
  v_add_u32_dpp v30, v9, v14 row_newbcast:6 row_mask:0xf bank_mask:0x3
  v_add_u32_dpp v31, v9, v15 row_newbcast:7 row_mask:0xf bank_mask:0x3
  s_waitcnt lgkmcnt(12)
  v_mfma_f32_16x16x32_bf16 v[208:211], v[156:159], v[68:71], v[208:211]
  v_add_u32_dpp v28, v9, v14 row_newbcast:12 row_mask:0xf bank_mask:0xc
  v_mfma_f32_16x16x32_bf16 v[212:215], v[152:155], v[72:75], v[212:215]
  v_add_u32_dpp v29, v9, v15 row_newbcast:13 row_mask:0xf bank_mask:0xc
  v_add_u32_dpp v30, v9, v14 row_newbcast:14 row_mask:0xf bank_mask:0xc
  v_mfma_f32_16x16x32_bf16 v[212:215], v[156:159], v[76:79], v[212:215]
  v_add_u32_dpp v31, v9, v15 row_newbcast:15 row_mask:0xf bank_mask:0xc
  s_waitcnt vmcnt(9)
  s_waitcnt lgkmcnt(8)
  v_mfma_f32_16x16x32_bf16 v[168:171], v[128:131], v[80:83], v[168:171]
  ds_read_b128 v[76:79], v12 offset:2048
  ds_read_b128 v[72:75], v11 offset:2048
  v_mfma_f32_16x16x32_bf16 v[168:171], v[132:135], v[84:87], v[168:171]
  ds_read_b128 v[68:71], v12 offset:0
  s_add_u32 m0, s76, 12288
  s_nop 0
  buffer_load_dwordx4 v28, s[32:35], 0 offen lds
  v_mfma_f32_16x16x32_bf16 v[172:175], v[128:131], v[88:91], v[172:175]
  ds_read_b128 v[64:67], v11 offset:0
  v_mfma_f32_16x16x32_bf16 v[172:175], v[132:135], v[92:95], v[172:175]
  ds_read_b64_tr_b16 v[112:113], v7 offset:0
  v_mfma_f32_16x16x32_bf16 v[184:187], v[136:139], v[80:83], v[184:187]
  ds_read_b64_tr_b16 v[114:115], v7 offset:512
  s_add_u32 m0, s76, 13312
  s_nop 0
  buffer_load_dwordx4 v29, s[32:35], 0 offen lds
  v_mfma_f32_16x16x32_bf16 v[184:187], v[140:143], v[84:87], v[184:187]
  ds_read_b64_tr_b16 v[116:117], v7 offset:4096
  v_mfma_f32_16x16x32_bf16 v[188:191], v[136:139], v[88:91], v[188:191]
  ds_read_b64_tr_b16 v[118:119], v7 offset:4608
  v_mfma_f32_16x16x32_bf16 v[188:191], v[140:143], v[92:95], v[188:191]
  ds_read_b64_tr_b16 v[120:121], v8 offset:0
  s_add_u32 m0, s76, 14336
  s_nop 0
  buffer_load_dwordx4 v30, s[32:35], 0 offen lds
  v_mfma_f32_16x16x32_bf16 v[200:203], v[144:147], v[80:83], v[200:203]
  ds_read_b64_tr_b16 v[122:123], v8 offset:512
  v_mfma_f32_16x16x32_bf16 v[200:203], v[148:151], v[84:87], v[200:203]
  ds_read_b64_tr_b16 v[124:125], v8 offset:4096
  v_mfma_f32_16x16x32_bf16 v[204:207], v[144:147], v[88:91], v[204:207]
  ds_read_b64_tr_b16 v[126:127], v8 offset:4608
  s_add_u32 m0, s76, 15360
  s_nop 0
  buffer_load_dwordx4 v31, s[32:35], 0 offen lds
  v_mfma_f32_16x16x32_bf16 v[204:207], v[148:151], v[92:95], v[204:207]
  s_set_gpr_idx_on s73, gpr_idx(SRC0)
  s_nop 0
  v_mov_b32 v9, v32
  s_set_gpr_idx_off
  s_add_u32 s73, s73, 1
  v_add_u32_dpp v24, v9, v14 row_newbcast:0 row_mask:0xf bank_mask:0x3
  v_mfma_f32_16x16x32_bf16 v[216:219], v[152:155], v[80:83], v[216:219]
  v_add_u32_dpp v25, v9, v15 row_newbcast:1 row_mask:0xf bank_mask:0x3
  v_add_u32_dpp v26, v9, v14 row_newbcast:2 row_mask:0xf bank_mask:0x3
  v_mfma_f32_16x16x32_bf16 v[216:219], v[156:159], v[84:87], v[216:219]
  s_add_u32 m0, s75, 0
  s_nop 0
  buffer_load_dwordx4 v13, s[44:47], s74 offen lds
  s_add_u32 s74, s74, 212992
  s_xor_b32 s75, s75, 16384
  v_add_u32_dpp v27, v9, v15 row_newbcast:3 row_mask:0xf bank_mask:0x3
  v_add_u32_dpp v24, v9, v14 row_newbcast:8 row_mask:0xf bank_mask:0xc
  v_mfma_f32_16x16x32_bf16 v[220:223], v[152:155], v[88:91], v[220:223]
  v_add_u32_dpp v25, v9, v15 row_newbcast:9 row_mask:0xf bank_mask:0xc
  v_add_u32_dpp v26, v9, v14 row_newbcast:10 row_mask:0xf bank_mask:0xc
  v_mfma_f32_16x16x32_bf16 v[220:223], v[156:159], v[92:95], v[220:223]
  v_add_u32_dpp v27, v9, v15 row_newbcast:11 row_mask:0xf bank_mask:0xc
  s_cmp_lt_u32 s73, 27
  s_cbranch_scc1 L_rem_loop
  s_waitcnt vmcnt(9)
  s_barrier
  s_waitcnt lgkmcnt(8)
  v_mfma_f32_16x16x32_bf16 v[160:163], v[96:99], v[64:67], v[160:163]
  ds_read_b128 v[92:95], v12 offset:6144
  ds_read_b128 v[88:91], v11 offset:6144
  v_mfma_f32_16x16x32_bf16 v[160:163], v[100:103], v[68:71], v[160:163]
  ds_read_b128 v[84:87], v12 offset:4096
  buffer_load_dwordx2 v[224:225], v248, s[48:51], 0 offen offset:3200
  v_mfma_f32_16x16x32_bf16 v[164:167], v[96:99], v[72:75], v[164:167]
  ds_read_b128 v[80:83], v11 offset:4096
  buffer_load_dwordx2 v[226:227], v248, s[48:51], 0 offen offset:3232
  v_mfma_f32_16x16x32_bf16 v[164:167], v[100:103], v[76:79], v[164:167]
  ds_read_b64_tr_b16 v[128:129], v1 offset:8192
  v_mfma_f32_16x16x32_bf16 v[176:179], v[104:107], v[64:67], v[176:179]
  ds_read_b64_tr_b16 v[130:131], v1 offset:8704
  buffer_load_dwordx2 v[228:229], v248, s[48:51], 0 offen offset:3264
  v_mfma_f32_16x16x32_bf16 v[176:179], v[108:111], v[68:71], v[176:179]
  ds_read_b64_tr_b16 v[132:133], v1 offset:12288
  v_mfma_f32_16x16x32_bf16 v[180:183], v[104:107], v[72:75], v[180:183]
  ds_read_b64_tr_b16 v[134:135], v1 offset:12800
  buffer_load_dwordx2 v[230:231], v248, s[48:51], 0 offen offset:3296
  v_mfma_f32_16x16x32_bf16 v[180:183], v[108:111], v[76:79], v[180:183]
  ds_read_b64_tr_b16 v[136:137], v2 offset:8192
  buffer_load_dwordx2 v[232:233], v248, s[52:55], 0 offen offset:3200
  s_waitcnt lgkmcnt(14)
  v_mfma_f32_16x16x32_bf16 v[192:195], v[112:115], v[64:67], v[192:195]
  ds_read_b64_tr_b16 v[138:139], v2 offset:8704
  s_waitcnt lgkmcnt(14)
  v_mfma_f32_16x16x32_bf16 v[192:195], v[116:119], v[68:71], v[192:195]
  ds_read_b64_tr_b16 v[140:141], v2 offset:12288
  buffer_load_dwordx2 v[234:235], v248, s[52:55], 0 offen offset:3232
  v_mfma_f32_16x16x32_bf16 v[196:199], v[112:115], v[72:75], v[196:199]
  ds_read_b64_tr_b16 v[142:143], v2 offset:12800
  v_mfma_f32_16x16x32_bf16 v[196:199], v[116:119], v[76:79], v[196:199]
  buffer_load_dwordx2 v[236:237], v248, s[52:55], 0 offen offset:3264
  s_waitcnt lgkmcnt(14)
  v_mfma_f32_16x16x32_bf16 v[208:211], v[120:123], v[64:67], v[208:211]
  buffer_load_dwordx2 v[238:239], v248, s[52:55], 0 offen offset:3296
  s_waitcnt lgkmcnt(12)
  v_mfma_f32_16x16x32_bf16 v[208:211], v[124:127], v[68:71], v[208:211]
  v_mfma_f32_16x16x32_bf16 v[212:215], v[120:123], v[72:75], v[212:215]
  buffer_load_dword v255, v3, s[56:59], s77 offen
  v_mfma_f32_16x16x32_bf16 v[212:215], v[124:127], v[76:79], v[212:215]
  s_waitcnt vmcnt(14)
  s_waitcnt lgkmcnt(8)
  v_mfma_f32_16x16x32_bf16 v[168:171], v[96:99], v[80:83], v[168:171]
  ds_read_b128 v[76:79], v12 offset:10240
  ds_read_b128 v[72:75], v11 offset:10240
  v_mfma_f32_16x16x32_bf16 v[168:171], v[100:103], v[84:87], v[168:171]
  ds_read_b128 v[68:71], v12 offset:8192
  v_mfma_f32_16x16x32_bf16 v[172:175], v[96:99], v[88:91], v[172:175]
  ds_read_b128 v[64:67], v11 offset:8192
  v_mfma_f32_16x16x32_bf16 v[172:175], v[100:103], v[92:95], v[172:175]
  ds_read_b64_tr_b16 v[144:145], v7 offset:8192
  v_mfma_f32_16x16x32_bf16 v[184:187], v[104:107], v[80:83], v[184:187]
  ds_read_b64_tr_b16 v[146:147], v7 offset:8704
  v_mfma_f32_16x16x32_bf16 v[184:187], v[108:111], v[84:87], v[184:187]
  ds_read_b64_tr_b16 v[148:149], v7 offset:12288
  v_mfma_f32_16x16x32_bf16 v[188:191], v[104:107], v[88:91], v[188:191]
  ds_read_b64_tr_b16 v[150:151], v7 offset:12800
  v_mfma_f32_16x16x32_bf16 v[188:191], v[108:111], v[92:95], v[188:191]
  ds_read_b64_tr_b16 v[152:153], v8 offset:8192
  v_mfma_f32_16x16x32_bf16 v[200:203], v[112:115], v[80:83], v[200:203]
  ds_read_b64_tr_b16 v[154:155], v8 offset:8704
  v_mfma_f32_16x16x32_bf16 v[200:203], v[116:119], v[84:87], v[200:203]
  ds_read_b64_tr_b16 v[156:157], v8 offset:12288
  v_mfma_f32_16x16x32_bf16 v[204:207], v[112:115], v[88:91], v[204:207]
  ds_read_b64_tr_b16 v[158:159], v8 offset:12800
  v_mfma_f32_16x16x32_bf16 v[204:207], v[116:119], v[92:95], v[204:207]
  v_mfma_f32_16x16x32_bf16 v[216:219], v[120:123], v[80:83], v[216:219]
  v_mfma_f32_16x16x32_bf16 v[216:219], v[124:127], v[84:87], v[216:219]
  v_mfma_f32_16x16x32_bf16 v[220:223], v[120:123], v[88:91], v[220:223]
  v_mfma_f32_16x16x32_bf16 v[220:223], v[124:127], v[92:95], v[220:223]
  s_waitcnt vmcnt(10)
  s_waitcnt lgkmcnt(8)
  v_mfma_f32_16x16x32_bf16 v[160:163], v[128:131], v[64:67], v[160:163]
  ds_read_b128 v[92:95], v12 offset:14336
  v_mfma_f32_16x16x32_bf16 v[160:163], v[132:135], v[68:71], v[160:163]
  v_mfma_f32_16x16x32_bf16 v[164:167], v[128:131], v[72:75], v[164:167]
  ds_read_b128 v[88:91], v11 offset:14336
  v_mfma_f32_16x16x32_bf16 v[164:167], v[132:135], v[76:79], v[164:167]
  s_waitcnt vmcnt(4)
  v_lshlrev_b32 v48, 16, v232
  v_and_b32 v49, 0xffff0000, v232
  v_mfma_f32_16x16x32_bf16 v[176:179], v[136:139], v[64:67], v[176:179]
  v_lshlrev_b32 v50, 16, v233
  v_and_b32 v51, 0xffff0000, v233
  v_mfma_f32_16x16x32_bf16 v[176:179], v[140:143], v[68:71], v[176:179]
  ds_read_b128 v[84:87], v12 offset:12288
  s_waitcnt vmcnt(3)
  v_lshlrev_b32 v52, 16, v234
  v_and_b32 v53, 0xffff0000, v234
  v_mfma_f32_16x16x32_bf16 v[180:183], v[136:139], v[72:75], v[180:183]
  v_lshlrev_b32 v54, 16, v235
  v_and_b32 v55, 0xffff0000, v235
  v_mfma_f32_16x16x32_bf16 v[180:183], v[140:143], v[76:79], v[180:183]
  s_waitcnt vmcnt(2)
  v_lshlrev_b32 v56, 16, v236
  v_and_b32 v57, 0xffff0000, v236
  s_waitcnt lgkmcnt(9)
  v_mfma_f32_16x16x32_bf16 v[192:195], v[144:147], v[64:67], v[192:195]
  ds_read_b128 v[80:83], v11 offset:12288
  v_lshlrev_b32 v58, 16, v237
  s_waitcnt lgkmcnt(8)
  v_mfma_f32_16x16x32_bf16 v[192:195], v[148:151], v[68:71], v[192:195]
  v_and_b32 v59, 0xffff0000, v237
  s_waitcnt vmcnt(1)
  v_lshlrev_b32 v60, 16, v238
  v_mfma_f32_16x16x32_bf16 v[196:199], v[144:147], v[72:75], v[196:199]
  v_and_b32 v61, 0xffff0000, v238
  v_lshlrev_b32 v62, 16, v239
  v_mfma_f32_16x16x32_bf16 v[196:199], v[148:151], v[76:79], v[196:199]
  v_and_b32 v63, 0xffff0000, v239
  v_lshlrev_b32 v32, 16, v224
  s_waitcnt lgkmcnt(6)
  v_mfma_f32_16x16x32_bf16 v[208:211], v[152:155], v[64:67], v[208:211]
  v_and_b32 v33, 0xffff0000, v224
  v_lshlrev_b32 v34, 16, v225
  s_waitcnt lgkmcnt(4)
  v_mfma_f32_16x16x32_bf16 v[208:211], v[156:159], v[68:71], v[208:211]
  v_and_b32 v35, 0xffff0000, v225
  v_lshlrev_b32 v36, 16, v226
  v_mfma_f32_16x16x32_bf16 v[212:215], v[152:155], v[72:75], v[212:215]
  v_and_b32 v37, 0xffff0000, v226
  v_mfma_f32_16x16x32_bf16 v[212:215], v[156:159], v[76:79], v[212:215]
  s_waitcnt lgkmcnt(0)
  v_mfma_f32_16x16x32_bf16 v[168:171], v[128:131], v[80:83], v[168:171]
  v_lshlrev_b32 v38, 16, v227
  v_and_b32 v39, 0xffff0000, v227
  v_mfma_f32_16x16x32_bf16 v[168:171], v[132:135], v[84:87], v[168:171]
  v_lshlrev_b32 v40, 16, v228
  v_mfma_f32_16x16x32_bf16 v[172:175], v[128:131], v[88:91], v[172:175]
  v_and_b32 v41, 0xffff0000, v228
  v_mfma_f32_16x16x32_bf16 v[172:175], v[132:135], v[92:95], v[172:175]
  v_lshlrev_b32 v42, 16, v229
  v_mfma_f32_16x16x32_bf16 v[184:187], v[136:139], v[80:83], v[184:187]
  v_and_b32 v43, 0xffff0000, v229
  v_lshlrev_b32 v44, 16, v230
  v_mfma_f32_16x16x32_bf16 v[184:187], v[140:143], v[84:87], v[184:187]
  v_and_b32 v45, 0xffff0000, v230
  v_mfma_f32_16x16x32_bf16 v[188:191], v[136:139], v[88:91], v[188:191]
  v_lshlrev_b32 v46, 16, v231
  v_mfma_f32_16x16x32_bf16 v[188:191], v[140:143], v[92:95], v[188:191]
  v_and_b32 v47, 0xffff0000, v231
  v_mfma_f32_16x16x32_bf16 v[200:203], v[144:147], v[80:83], v[200:203]
  v_rcp_f32 v48, v48
  v_rcp_f32 v49, v49
  v_mfma_f32_16x16x32_bf16 v[200:203], v[148:151], v[84:87], v[200:203]
  v_rcp_f32 v50, v50
  v_mfma_f32_16x16x32_bf16 v[204:207], v[144:147], v[88:91], v[204:207]
  v_rcp_f32 v51, v51
  v_mfma_f32_16x16x32_bf16 v[204:207], v[148:151], v[92:95], v[204:207]
  v_rcp_f32 v52, v52
  v_mfma_f32_16x16x32_bf16 v[216:219], v[152:155], v[80:83], v[216:219]
  v_rcp_f32 v53, v53
  v_rcp_f32 v54, v54
  v_mfma_f32_16x16x32_bf16 v[216:219], v[156:159], v[84:87], v[216:219]
  v_rcp_f32 v55, v55
  v_mfma_f32_16x16x32_bf16 v[220:223], v[152:155], v[88:91], v[220:223]
  v_rcp_f32 v56, v56
  v_mfma_f32_16x16x32_bf16 v[220:223], v[156:159], v[92:95], v[220:223]
  v_rcp_f32 v57, v57
L_repi:
  v_rcp_f32 v58, v58
  v_rcp_f32 v59, v59
  v_rcp_f32 v60, v60
  v_rcp_f32 v61, v61
  v_rcp_f32 v62, v62
  v_rcp_f32 v63, v63
  v_med3_f32 v48, v48, -v244, v244
  v_med3_f32 v49, v49, -v244, v244
  v_med3_f32 v50, v50, -v244, v244
  v_med3_f32 v51, v51, -v244, v244
  v_med3_f32 v52, v52, -v244, v244
  v_med3_f32 v53, v53, -v244, v244
  v_med3_f32 v54, v54, -v244, v244
  v_med3_f32 v55, v55, -v244, v244
  v_med3_f32 v56, v56, -v244, v244
  v_med3_f32 v57, v57, -v244, v244
  v_med3_f32 v58, v58, -v244, v244
  v_med3_f32 v59, v59, -v244, v244
  v_med3_f32 v60, v60, -v244, v244
  v_med3_f32 v61, v61, -v244, v244
  v_med3_f32 v62, v62, -v244, v244
  v_med3_f32 v63, v63, -v244, v244
  v_pk_add_f32 v[160:161], v[160:161], v[32:33]
  v_pk_add_f32 v[162:163], v[162:163], v[34:35]
  v_pk_add_f32 v[164:165], v[164:165], v[32:33]
  v_pk_add_f32 v[166:167], v[166:167], v[34:35]
  v_pk_add_f32 v[168:169], v[168:169], v[32:33]
  v_pk_add_f32 v[170:171], v[170:171], v[34:35]
  v_pk_add_f32 v[172:173], v[172:173], v[32:33]
  v_pk_add_f32 v[174:175], v[174:175], v[34:35]
  v_pk_add_f32 v[176:177], v[176:177], v[36:37]
  v_pk_add_f32 v[178:179], v[178:179], v[38:39]
  v_pk_add_f32 v[180:181], v[180:181], v[36:37]
  v_pk_add_f32 v[182:183], v[182:183], v[38:39]
  v_pk_add_f32 v[184:185], v[184:185], v[36:37]
  v_pk_add_f32 v[186:187], v[186:187], v[38:39]
  v_pk_add_f32 v[188:189], v[188:189], v[36:37]
  v_pk_add_f32 v[190:191], v[190:191], v[38:39]
  v_pk_add_f32 v[192:193], v[192:193], v[40:41]
  v_pk_add_f32 v[194:195], v[194:195], v[42:43]
  v_pk_add_f32 v[196:197], v[196:197], v[40:41]
  v_pk_add_f32 v[198:199], v[198:199], v[42:43]
  v_pk_add_f32 v[200:201], v[200:201], v[40:41]
  v_pk_add_f32 v[202:203], v[202:203], v[42:43]
  v_pk_add_f32 v[204:205], v[204:205], v[40:41]
  v_pk_add_f32 v[206:207], v[206:207], v[42:43]
  v_pk_add_f32 v[208:209], v[208:209], v[44:45]
  v_pk_add_f32 v[210:211], v[210:211], v[46:47]
  v_pk_add_f32 v[212:213], v[212:213], v[44:45]
  v_pk_add_f32 v[214:215], v[214:215], v[46:47]
  v_pk_add_f32 v[216:217], v[216:217], v[44:45]
  v_pk_add_f32 v[218:219], v[218:219], v[46:47]
  v_pk_add_f32 v[220:221], v[220:221], v[44:45]
  v_pk_add_f32 v[222:223], v[222:223], v[46:47]
  v_pk_mul_f32 v[64:65], v[160:161], v[160:161]
  v_pk_mul_f32 v[68:69], v[164:165], v[164:165]
  v_pk_mul_f32 v[72:73], v[168:169], v[168:169]
  v_pk_mul_f32 v[76:77], v[172:173], v[172:173]
  v_pk_fma_f32 v[64:65], v[64:65], v[242:243], v[240:241]
  v_pk_fma_f32 v[68:69], v[68:69], v[242:243], v[240:241]
  v_pk_fma_f32 v[72:73], v[72:73], v[242:243], v[240:241]
  v_pk_fma_f32 v[76:77], v[76:77], v[242:243], v[240:241]
  v_pk_mul_f32 v[64:65], v[64:65], v[160:161]
  v_pk_mul_f32 v[68:69], v[68:69], v[164:165]
  v_pk_mul_f32 v[72:73], v[72:73], v[168:169]
  v_pk_mul_f32 v[76:77], v[76:77], v[172:173]
  v_exp_f32 v64, v64
  v_exp_f32 v65, v65
  v_exp_f32 v68, v68
  v_exp_f32 v69, v69
  v_exp_f32 v72, v72
  v_exp_f32 v73, v73
  v_exp_f32 v76, v76
  v_exp_f32 v77, v77
  v_pk_fma_f32 v[64:65], v[64:65], v[48:49], v[48:49]
  v_pk_fma_f32 v[68:69], v[68:69], v[48:49], v[48:49]
  v_pk_fma_f32 v[72:73], v[72:73], v[48:49], v[48:49]
  v_pk_fma_f32 v[76:77], v[76:77], v[48:49], v[48:49]
  v_rcp_f32 v64, v64
  v_rcp_f32 v65, v65
  v_rcp_f32 v68, v68
  v_rcp_f32 v69, v69
  v_rcp_f32 v72, v72
  v_rcp_f32 v73, v73
  v_rcp_f32 v76, v76
  v_rcp_f32 v77, v77
  v_pk_mul_f32 v[16:17], v[64:65], v[160:161]
  v_pk_mul_f32 v[18:19], v[68:69], v[164:165]
  v_pk_mul_f32 v[20:21], v[72:73], v[168:169]
  v_pk_mul_f32 v[22:23], v[76:77], v[172:173]
  v_pk_mul_f32 v[80:81], v[162:163], v[162:163]
  v_pk_mul_f32 v[84:85], v[166:167], v[166:167]
  v_pk_mul_f32 v[88:89], v[170:171], v[170:171]
  v_pk_mul_f32 v[92:93], v[174:175], v[174:175]
  v_pk_fma_f32 v[80:81], v[80:81], v[242:243], v[240:241]
  v_pk_fma_f32 v[84:85], v[84:85], v[242:243], v[240:241]
  v_pk_fma_f32 v[88:89], v[88:89], v[242:243], v[240:241]
  v_pk_fma_f32 v[92:93], v[92:93], v[242:243], v[240:241]
  v_pk_mul_f32 v[80:81], v[80:81], v[162:163]
  v_pk_mul_f32 v[84:85], v[84:85], v[166:167]
  v_pk_mul_f32 v[88:89], v[88:89], v[170:171]
  v_pk_mul_f32 v[92:93], v[92:93], v[174:175]
  v_exp_f32 v80, v80
  v_exp_f32 v81, v81
  v_exp_f32 v84, v84
  v_exp_f32 v85, v85
  v_exp_f32 v88, v88
  v_exp_f32 v89, v89
  v_exp_f32 v92, v92
  v_exp_f32 v93, v93
  v_pk_fma_f32 v[80:81], v[80:81], v[50:51], v[50:51]
  v_pk_fma_f32 v[84:85], v[84:85], v[50:51], v[50:51]
  v_pk_fma_f32 v[88:89], v[88:89], v[50:51], v[50:51]
  v_pk_fma_f32 v[92:93], v[92:93], v[50:51], v[50:51]
  v_rcp_f32 v80, v80
  v_rcp_f32 v81, v81
  v_rcp_f32 v84, v84
  v_rcp_f32 v85, v85
  v_rcp_f32 v88, v88
  v_rcp_f32 v89, v89
  v_rcp_f32 v92, v92
  v_rcp_f32 v93, v93
  v_pk_fma_f32 v[16:17], v[80:81], v[162:163], v[16:17]
  v_pk_fma_f32 v[18:19], v[84:85], v[166:167], v[18:19]
  v_pk_fma_f32 v[20:21], v[88:89], v[170:171], v[20:21]
  v_pk_fma_f32 v[22:23], v[92:93], v[174:175], v[22:23]
  v_pk_mul_f32 v[64:65], v[176:177], v[176:177]
  v_pk_mul_f32 v[68:69], v[180:181], v[180:181]
  v_pk_mul_f32 v[72:73], v[184:185], v[184:185]
  v_pk_mul_f32 v[76:77], v[188:189], v[188:189]
  v_pk_fma_f32 v[64:65], v[64:65], v[242:243], v[240:241]
  v_pk_fma_f32 v[68:69], v[68:69], v[242:243], v[240:241]
  v_pk_fma_f32 v[72:73], v[72:73], v[242:243], v[240:241]
  v_pk_fma_f32 v[76:77], v[76:77], v[242:243], v[240:241]
  v_pk_mul_f32 v[64:65], v[64:65], v[176:177]
  v_pk_mul_f32 v[68:69], v[68:69], v[180:181]
  v_pk_mul_f32 v[72:73], v[72:73], v[184:185]
  v_pk_mul_f32 v[76:77], v[76:77], v[188:189]
  v_exp_f32 v64, v64
  v_exp_f32 v65, v65
  v_exp_f32 v68, v68
  v_exp_f32 v69, v69
  v_exp_f32 v72, v72
  v_exp_f32 v73, v73
  v_exp_f32 v76, v76
  v_exp_f32 v77, v77
  v_pk_fma_f32 v[64:65], v[64:65], v[52:53], v[52:53]
  v_pk_fma_f32 v[68:69], v[68:69], v[52:53], v[52:53]
  v_pk_fma_f32 v[72:73], v[72:73], v[52:53], v[52:53]
  v_pk_fma_f32 v[76:77], v[76:77], v[52:53], v[52:53]
  v_rcp_f32 v64, v64
  v_rcp_f32 v65, v65
  v_rcp_f32 v68, v68
  v_rcp_f32 v69, v69
  v_rcp_f32 v72, v72
  v_rcp_f32 v73, v73
  v_rcp_f32 v76, v76
  v_rcp_f32 v77, v77
  v_pk_fma_f32 v[16:17], v[64:65], v[176:177], v[16:17]
  v_pk_fma_f32 v[18:19], v[68:69], v[180:181], v[18:19]
  v_pk_fma_f32 v[20:21], v[72:73], v[184:185], v[20:21]
  v_pk_fma_f32 v[22:23], v[76:77], v[188:189], v[22:23]
  v_pk_mul_f32 v[80:81], v[178:179], v[178:179]
  v_pk_mul_f32 v[84:85], v[182:183], v[182:183]
  v_pk_mul_f32 v[88:89], v[186:187], v[186:187]
  v_pk_mul_f32 v[92:93], v[190:191], v[190:191]
  v_pk_fma_f32 v[80:81], v[80:81], v[242:243], v[240:241]
  v_pk_fma_f32 v[84:85], v[84:85], v[242:243], v[240:241]
  v_pk_fma_f32 v[88:89], v[88:89], v[242:243], v[240:241]
  v_pk_fma_f32 v[92:93], v[92:93], v[242:243], v[240:241]
  v_pk_mul_f32 v[80:81], v[80:81], v[178:179]
  v_pk_mul_f32 v[84:85], v[84:85], v[182:183]
  v_pk_mul_f32 v[88:89], v[88:89], v[186:187]
  v_pk_mul_f32 v[92:93], v[92:93], v[190:191]
  v_exp_f32 v80, v80
  v_exp_f32 v81, v81
  v_exp_f32 v84, v84
  v_exp_f32 v85, v85
  v_exp_f32 v88, v88
  v_exp_f32 v89, v89
  v_exp_f32 v92, v92
  v_exp_f32 v93, v93
  v_pk_fma_f32 v[80:81], v[80:81], v[54:55], v[54:55]
  v_pk_fma_f32 v[84:85], v[84:85], v[54:55], v[54:55]
  v_pk_fma_f32 v[88:89], v[88:89], v[54:55], v[54:55]
  v_pk_fma_f32 v[92:93], v[92:93], v[54:55], v[54:55]
  v_rcp_f32 v80, v80
  v_rcp_f32 v81, v81
  v_rcp_f32 v84, v84
  v_rcp_f32 v85, v85
  v_rcp_f32 v88, v88
  v_rcp_f32 v89, v89
  v_rcp_f32 v92, v92
  v_rcp_f32 v93, v93
  v_pk_fma_f32 v[16:17], v[80:81], v[178:179], v[16:17]
  v_pk_fma_f32 v[18:19], v[84:85], v[182:183], v[18:19]
  v_pk_fma_f32 v[20:21], v[88:89], v[186:187], v[20:21]
  v_pk_fma_f32 v[22:23], v[92:93], v[190:191], v[22:23]
  v_pk_mul_f32 v[64:65], v[192:193], v[192:193]
  v_pk_mul_f32 v[68:69], v[196:197], v[196:197]
  v_pk_mul_f32 v[72:73], v[200:201], v[200:201]
  v_pk_mul_f32 v[76:77], v[204:205], v[204:205]
  v_pk_fma_f32 v[64:65], v[64:65], v[242:243], v[240:241]
  v_pk_fma_f32 v[68:69], v[68:69], v[242:243], v[240:241]
  v_pk_fma_f32 v[72:73], v[72:73], v[242:243], v[240:241]
  v_pk_fma_f32 v[76:77], v[76:77], v[242:243], v[240:241]
  v_pk_mul_f32 v[64:65], v[64:65], v[192:193]
  v_pk_mul_f32 v[68:69], v[68:69], v[196:197]
  v_pk_mul_f32 v[72:73], v[72:73], v[200:201]
  v_pk_mul_f32 v[76:77], v[76:77], v[204:205]
  v_exp_f32 v64, v64
  v_exp_f32 v65, v65
  v_exp_f32 v68, v68
  v_exp_f32 v69, v69
  v_exp_f32 v72, v72
  v_exp_f32 v73, v73
  v_exp_f32 v76, v76
  v_exp_f32 v77, v77
  v_pk_fma_f32 v[64:65], v[64:65], v[56:57], v[56:57]
  v_pk_fma_f32 v[68:69], v[68:69], v[56:57], v[56:57]
  v_pk_fma_f32 v[72:73], v[72:73], v[56:57], v[56:57]
  v_pk_fma_f32 v[76:77], v[76:77], v[56:57], v[56:57]
  v_rcp_f32 v64, v64
  v_rcp_f32 v65, v65
  v_rcp_f32 v68, v68
  v_rcp_f32 v69, v69
  v_rcp_f32 v72, v72
  v_rcp_f32 v73, v73
  v_rcp_f32 v76, v76
  v_rcp_f32 v77, v77
  v_pk_fma_f32 v[16:17], v[64:65], v[192:193], v[16:17]
  v_pk_fma_f32 v[18:19], v[68:69], v[196:197], v[18:19]
  v_pk_fma_f32 v[20:21], v[72:73], v[200:201], v[20:21]
  v_pk_fma_f32 v[22:23], v[76:77], v[204:205], v[22:23]
  v_pk_mul_f32 v[80:81], v[194:195], v[194:195]
  v_pk_mul_f32 v[84:85], v[198:199], v[198:199]
  v_pk_mul_f32 v[88:89], v[202:203], v[202:203]
  v_pk_mul_f32 v[92:93], v[206:207], v[206:207]
  v_pk_fma_f32 v[80:81], v[80:81], v[242:243], v[240:241]
  v_pk_fma_f32 v[84:85], v[84:85], v[242:243], v[240:241]
  v_pk_fma_f32 v[88:89], v[88:89], v[242:243], v[240:241]
  v_pk_fma_f32 v[92:93], v[92:93], v[242:243], v[240:241]
  v_pk_mul_f32 v[80:81], v[80:81], v[194:195]
  v_pk_mul_f32 v[84:85], v[84:85], v[198:199]
  v_pk_mul_f32 v[88:89], v[88:89], v[202:203]
  v_pk_mul_f32 v[92:93], v[92:93], v[206:207]
  v_exp_f32 v80, v80
  v_exp_f32 v81, v81
  v_exp_f32 v84, v84
  v_exp_f32 v85, v85
  v_exp_f32 v88, v88
  v_exp_f32 v89, v89
  v_exp_f32 v92, v92
  v_exp_f32 v93, v93
  v_pk_fma_f32 v[80:81], v[80:81], v[58:59], v[58:59]
  v_pk_fma_f32 v[84:85], v[84:85], v[58:59], v[58:59]
  v_pk_fma_f32 v[88:89], v[88:89], v[58:59], v[58:59]
  v_pk_fma_f32 v[92:93], v[92:93], v[58:59], v[58:59]
  v_rcp_f32 v80, v80
  v_rcp_f32 v81, v81
  v_rcp_f32 v84, v84
  v_rcp_f32 v85, v85
  v_rcp_f32 v88, v88
  v_rcp_f32 v89, v89
  v_rcp_f32 v92, v92
  v_rcp_f32 v93, v93
  v_pk_fma_f32 v[16:17], v[80:81], v[194:195], v[16:17]
  v_pk_fma_f32 v[18:19], v[84:85], v[198:199], v[18:19]
  v_pk_fma_f32 v[20:21], v[88:89], v[202:203], v[20:21]
  v_pk_fma_f32 v[22:23], v[92:93], v[206:207], v[22:23]
  buffer_load_dword v128, v3, s[60:63], s68 offen offset:0 sc1
  buffer_load_dword v129, v3, s[60:63], s68 offen offset:2048 sc1
  buffer_load_dword v130, v3, s[60:63], s69 offen offset:0 sc1
  buffer_load_dword v131, v3, s[60:63], s69 offen offset:2048 sc1
  buffer_load_dword v132, v3, s[60:63], s71 offen offset:0 sc1
  buffer_load_dword v133, v3, s[60:63], s71 offen offset:2048 sc1
  buffer_load_dword v134, v5, s[60:63], s71 offen sc1
  v_pk_mul_f32 v[64:65], v[208:209], v[208:209]
  v_pk_mul_f32 v[68:69], v[212:213], v[212:213]
  v_pk_mul_f32 v[72:73], v[216:217], v[216:217]
  v_pk_mul_f32 v[76:77], v[220:221], v[220:221]
  v_pk_fma_f32 v[64:65], v[64:65], v[242:243], v[240:241]
  v_pk_fma_f32 v[68:69], v[68:69], v[242:243], v[240:241]
  v_pk_fma_f32 v[72:73], v[72:73], v[242:243], v[240:241]
  v_pk_fma_f32 v[76:77], v[76:77], v[242:243], v[240:241]
  v_pk_mul_f32 v[64:65], v[64:65], v[208:209]
  v_pk_mul_f32 v[68:69], v[68:69], v[212:213]
  v_pk_mul_f32 v[72:73], v[72:73], v[216:217]
  v_pk_mul_f32 v[76:77], v[76:77], v[220:221]
  v_exp_f32 v64, v64
  v_exp_f32 v65, v65
  v_exp_f32 v68, v68
  v_exp_f32 v69, v69
  v_exp_f32 v72, v72
  v_exp_f32 v73, v73
  v_exp_f32 v76, v76
  v_exp_f32 v77, v77
  v_pk_fma_f32 v[64:65], v[64:65], v[60:61], v[60:61]
  v_pk_fma_f32 v[68:69], v[68:69], v[60:61], v[60:61]
  v_pk_fma_f32 v[72:73], v[72:73], v[60:61], v[60:61]
  v_pk_fma_f32 v[76:77], v[76:77], v[60:61], v[60:61]
  v_rcp_f32 v64, v64
  v_rcp_f32 v65, v65
  v_rcp_f32 v68, v68
  v_rcp_f32 v69, v69
  v_rcp_f32 v72, v72
  v_rcp_f32 v73, v73
  v_rcp_f32 v76, v76
  v_rcp_f32 v77, v77
  v_pk_fma_f32 v[16:17], v[64:65], v[208:209], v[16:17]
  v_pk_fma_f32 v[18:19], v[68:69], v[212:213], v[18:19]
  v_pk_fma_f32 v[20:21], v[72:73], v[216:217], v[20:21]
  v_pk_fma_f32 v[22:23], v[76:77], v[220:221], v[22:23]
  v_pk_mul_f32 v[80:81], v[210:211], v[210:211]
  v_pk_mul_f32 v[84:85], v[214:215], v[214:215]
  v_pk_mul_f32 v[88:89], v[218:219], v[218:219]
  v_pk_mul_f32 v[92:93], v[222:223], v[222:223]
  v_pk_fma_f32 v[80:81], v[80:81], v[242:243], v[240:241]
  v_pk_fma_f32 v[84:85], v[84:85], v[242:243], v[240:241]
  v_pk_fma_f32 v[88:89], v[88:89], v[242:243], v[240:241]
  v_pk_fma_f32 v[92:93], v[92:93], v[242:243], v[240:241]
  v_pk_mul_f32 v[80:81], v[80:81], v[210:211]
  v_pk_mul_f32 v[84:85], v[84:85], v[214:215]
  v_pk_mul_f32 v[88:89], v[88:89], v[218:219]
  v_pk_mul_f32 v[92:93], v[92:93], v[222:223]
  v_exp_f32 v80, v80
  v_exp_f32 v81, v81
  v_exp_f32 v84, v84
  v_exp_f32 v85, v85
  v_exp_f32 v88, v88
  v_exp_f32 v89, v89
  v_exp_f32 v92, v92
  v_exp_f32 v93, v93
  v_pk_fma_f32 v[80:81], v[80:81], v[62:63], v[62:63]
  v_pk_fma_f32 v[84:85], v[84:85], v[62:63], v[62:63]
  v_pk_fma_f32 v[88:89], v[88:89], v[62:63], v[62:63]
  v_pk_fma_f32 v[92:93], v[92:93], v[62:63], v[62:63]
  v_rcp_f32 v80, v80
  v_rcp_f32 v81, v81
  v_rcp_f32 v84, v84
  v_rcp_f32 v85, v85
  v_rcp_f32 v88, v88
  v_rcp_f32 v89, v89
  v_rcp_f32 v92, v92
  v_rcp_f32 v93, v93
  v_pk_fma_f32 v[16:17], v[80:81], v[210:211], v[16:17]
  v_pk_fma_f32 v[18:19], v[84:85], v[214:215], v[18:19]
  v_pk_fma_f32 v[20:21], v[88:89], v[218:219], v[20:21]
  v_pk_fma_f32 v[22:23], v[92:93], v[222:223], v[22:23]
  v_add_f32 v16, v16, v17
  v_add_f32 v18, v18, v19
  v_add_f32 v20, v20, v21
  v_add_f32 v22, v22, v23
  s_nop 0
  v_permlane32_swap_b32 v16, v20
  v_permlane32_swap_b32 v18, v22
  v_add_f32 v16, v16, v20
  v_add_f32 v18, v18, v22
  s_nop 1
  v_permlane16_swap_b32 v16, v18
  v_add_f32 v16, v16, v18
  v_add_f32 v16, s80, v16
L_rclr:
  s_mov_b32 s72, 0x40000
  s_branch L_pchk
L_poll:
  s_sub_u32 s72, s72, 1
  s_cbranch_scc1 L_pollx
  buffer_load_dword v128, v3, s[60:63], s68 offen offset:0 sc1
  buffer_load_dword v129, v3, s[60:63], s68 offen offset:2048 sc1
  buffer_load_dword v130, v3, s[60:63], s69 offen offset:0 sc1
  buffer_load_dword v131, v3, s[60:63], s69 offen offset:2048 sc1
  buffer_load_dword v132, v3, s[60:63], s71 offen offset:0 sc1
  buffer_load_dword v133, v3, s[60:63], s71 offen offset:2048 sc1
  buffer_load_dword v134, v5, s[60:63], s71 offen sc1
L_pchk:
  s_waitcnt vmcnt(0)
  v_max3_u32 v136, v128, v129, v130
  v_max3_u32 v137, v131, v132, v133
  v_max3_u32 v136, v136, v137, v134
  v_cmp_eq_u32 vcc, -1, v136
  s_cbranch_vccnz L_poll
L_pollx:
  v_add_f32 v128, v128, v129
  v_add_f32 v130, v130, v131
  v_add_f32 v132, v132, v133
  v_add_f32 v16, v16, v134
  v_add_f32 v128, v128, v130
  v_add_f32 v132, v132, v16
  v_add_f32 v128, v128, v132
  v_cvt_pk_bf16_f32 v128, v128, v128
  buffer_store_short v128, v4, s[56:59], s77 offen
  s_endpgm
L_end:
  s_endpgm
.section .rodata,"a"
.p2align 6
.amdhsa_kernel standalone__deep_cross_xdeepfm__recsys_kernel
  .amdhsa_next_free_vgpr 256
  .amdhsa_next_free_sgpr 102
  .amdhsa_accum_offset 256
  .amdhsa_group_segment_fixed_size 0
  .amdhsa_kernarg_size 88
  .amdhsa_user_sgpr_count 2
  .amdhsa_user_sgpr_kernarg_segment_ptr 1
  .amdhsa_system_sgpr_workgroup_id_x 1
  .amdhsa_float_denorm_mode_32 3
.end_amdhsa_kernel
```

```asm
; @launch grid=(256,1,1) block=(512,1,1) lds=163840
.amdgcn_target "amdgcn-amd-amdhsa--gfx950"
.text
.globl standalone__deep_cross_xdeepfm__recsys_kernel
.p2align 8
.type standalone__deep_cross_xdeepfm__recsys_kernel,@function
standalone__deep_cross_xdeepfm__recsys_kernel:
  s_cmp_ge_u32 s2, 256
  s_cbranch_scc1 L_end
  s_load_dwordx16 s[4:19], s[0:1], 0
  s_load_dwordx4 s[20:23], s[0:1], 64
  s_load_dwordx2 s[24:25], s[0:1], 80
  v_lshrrev_b32 v1, 6, v0
  s_getpc_b64 s[92:93]
L_pc:
  s_and_b32 s68, s2, 0xf8
  v_add_u32 v2, s68, v1
  v_lshlrev_b32 v2, 7, v2
  v_and_b32 v3, 1, v0
  v_lshl_add_u32 v2, v3, 15, v2
  v_min_u32 v2, L_end-L_pc, v2
  v_mov_b32 v3, s93
  v_add_co_u32 v2, vcc, s92, v2
  s_nop 1
  v_addc_co_u32 v3, vcc, 0, v3, vcc
  global_load_dword v255, v[2:3], off
  v_and_b32 v0, 63, v0
  v_readfirstlane_b32 s3, v1
  s_and_b32 s68, s2, 7
  s_lshl_b32 s68, s68, 2
  s_lshr_b32 s26, s2, 6
  s_add_u32 s26, s26, s68
  s_bfe_u32 s27, s2, 0x30003
  s_and_b32 s80, s2, 0xf8
  s_add_u32 s80, s80, s3
  s_lshl_b32 s80, s80, 21
  s_lshr_b32 s68, s2, 3
  s_cmp_eq_u32 s68, 5
  s_cbranch_scc1 L_rem
  s_cmp_ge_u32 s27, 5
  s_cbranch_scc1 L_cin
  s_mul_i32 s77, s27, 640
  s_mul_i32 s70, s3, 7
  v_min_u32 v64, 6, v0
  v_add_u32 v64, s70, v64
  v_min_u32 v64, 51, v64
  v_lshrrev_b32 v62, 1, v64
  v_mul_u32_u24 v62, 96, v62
  v_lshl_add_u32 v64, v64, 2, v62
  s_mul_i32 s78, s27, 26
  s_min_u32 s78, s78, 102
  s_lshl_b32 s71, s26, 7
  s_add_u32 s78, s78, s71
  s_mul_i32 s78, s78, 104
  s_and_b32 s70, s26, 3
  s_lshl_b32 s70, s70, 3
  s_add_u32 s70, s70, s3
  s_mul_i32 s70, s70, 3328
  s_add_u32 s81, s70, s77
  v_min_u32 v56, 15, v0
  v_lshrrev_b32 v62, 3, v56
  s_mov_b32 s70, 106496
  v_mul_u32_u24 v62, s70, v62
  v_and_b32 v56, 7, v56
  v_min_u32 v56, 4, v56
  v_lshl_add_u32 v56, v56, 7, v62
  s_xor_b32 s70, s3, 4
  s_lshl_b32 s70, s70, 4
  s_add_u32 s70, s70, s71
  v_lshrrev_b32 v60, 3, v0
  v_add_u32 v60, s70, v60
  v_mul_u32_u24 v13, 104, v60
  s_waitcnt lgkmcnt(0)
  s_mov_b32 s28, s4
  s_and_b32 s29, s5, 0xffff
  s_mov_b32 s30, 425984
  s_mov_b32 s31, 0x20000
  buffer_load_dwordx3 v[52:54], v64, s[28:31], s78 offen
  buffer_load_dwordx2 v[44:45], v13, s[28:31], 0 offen offset:0
  buffer_load_dwordx2 v[48:49], v13, s[28:31], 0 offen offset:832
  s_mov_b32 s32, s6
  s_and_b32 s33, s7, 0xffff
  s_mov_b32 s34, 12800000
  s_mov_b32 s35, 0x20000
  v_mov_b32 v68, s80
  buffer_load_dword v255, v68, s[32:35], 0 offen
  v_lshlrev_b32 v37, 4, v0
  s_mov_b32 s48, s14
  s_and_b32 s49, s15, 0xffff
  s_mov_b32 s50, 3328
  s_mov_b32 s51, 0x20000
  s_mov_b32 s44, s12
  s_and_b32 s45, s13, 0xffff
  s_mov_b32 s46, 5537792
  s_mov_b32 s47, 0x20000
  buffer_load_dword v255, v56, s[44:47], s81 offen
  v_mov_b32 v57, v56
  s_add_u32 s85, s81, 212992
  s_mov_b32 m0, 155648
  s_mov_b32 exec_hi, 0xff
  buffer_load_dwordx4 v37, s[48:51], s77 offen lds
  s_mov_b64 exec, -1
  s_mul_i32 s81, s26, 5
  s_add_u32 s81, s81, s27
  s_lshl_b32 s81, s81, 3
  s_add_u32 s81, s81, s3
  s_add_u32 s81, s81, 1664
  s_lshl_b32 s81, s81, 7
  v_min_u32 v56, 2, v0
  v_mul_u32_u24 v56, 163840, v56
  buffer_load_dword v255, v56, s[44:47], s81 offen
  s_lshr_b32 s68, s3, 2
  s_and_b32 s69, s3, 3
  s_mov_b32 s70, 1639
  s_and_b32 s78, s69, 1
  s_lshl_b32 s78, s78, 2
  s_mov_b32 s81, 3328
  v_mov_b32 v60, v0
  v_mul_u32_u24 v61, s70, v60
  v_lshrrev_b32 v61, 16, v61
  v_mul_u32_u24 v64, 40, v61
  v_sub_u32 v64, v60, v64
  v_and_b32 v63, 2, v61
  v_or_b32 v63, s78, v63
  v_xor_b32 v64, v64, v63
  v_mul_u32_u24 v61, s81, v61
  v_lshl_add_u32 v29, v64, 4, v61
  v_add_u32 v60, 64, v60
  v_mul_u32_u24 v61, s70, v60
  v_lshrrev_b32 v61, 16, v61
  v_mul_u32_u24 v64, 40, v61
  v_sub_u32 v64, v60, v64
  v_and_b32 v63, 2, v61
  v_or_b32 v63, s78, v63
  v_xor_b32 v64, v64, v63
  v_mul_u32_u24 v61, s81, v61
  v_lshl_add_u32 v30, v64, 4, v61
  v_subrev_u32 v30, 1024, v30
  v_add_u32 v60, 64, v60
  v_mul_u32_u24 v61, s70, v60
  v_lshrrev_b32 v61, 16, v61
  v_mul_u32_u24 v64, 40, v61
  v_sub_u32 v64, v60, v64
  v_and_b32 v63, 2, v61
  v_or_b32 v63, s78, v63
  v_xor_b32 v64, v64, v63
  v_mul_u32_u24 v61, s81, v61
  v_lshl_add_u32 v31, v64, 4, v61
  v_subrev_u32 v31, 2048, v31
  v_add_u32 v60, 64, v60
  v_mul_u32_u24 v61, s70, v60
  v_lshrrev_b32 v61, 16, v61
  v_mul_u32_u24 v64, 40, v61
  v_sub_u32 v64, v60, v64
  v_and_b32 v63, 2, v61
  v_or_b32 v63, s78, v63
  v_xor_b32 v64, v64, v63
  v_mul_u32_u24 v61, s81, v61
  v_lshl_add_u32 v32, v64, 4, v61
  v_subrev_u32 v32, 3072, v32
  v_add_u32 v60, 64, v60
  v_mul_u32_u24 v61, s70, v60
  v_lshrrev_b32 v61, 16, v61
  v_mul_u32_u24 v64, 40, v61
  v_sub_u32 v64, v60, v64
  v_and_b32 v63, 2, v61
  v_or_b32 v63, s78, v63
  v_xor_b32 v64, v64, v63
  v_mul_u32_u24 v61, s81, v61
  v_lshl_add_u32 v33, v64, 4, v61
  s_mul_i32 s70, s3, 26624
  s_add_u32 s74, s70, s77
  s_mul_i32 s75, s3, 5120
  s_add_u32 s75, s75, 32768
  s_lshl_b32 s71, s68, 14
  s_lshl_b32 s76, s69, 11
  s_add_u32 s76, s76, s71
  s_xor_b32 s76, s76, 16384
  v_and_b32 v64, 7, v0
  v_lshrrev_b32 v62, 4, v0
  v_xor_b32 v64, v64, v62
  v_lshlrev_b32 v14, 4, v64
  v_xor_b32 v15, 64, v14
  v_and_b32 v64, 15, v0
  v_lshlrev_b32 v64, 7, v64
  s_lshl_b32 s71, s68, 14
  v_bfe_u32 v63, v0, 1, 3
  v_xor_b32 v63, v63, v62
  v_lshl_add_u32 v64, v63, 4, v64
  v_add_u32 v11, s71, v64
  v_xor_b32 v12, 64, v11
  s_mov_b32 s52, s16
  s_and_b32 s53, s17, 0xffff
  s_mov_b32 s54, 3328
  s_mov_b32 s55, 0x20000
  s_mul_i32 s71, s69, 5
  v_bfe_u32 v63, v0, 2, 2
  v_lshl_add_u32 v64, v62, 3, v63
  v_mul_u32_u24 v64, 640, v64
  v_and_b32 v63, 3, v0
  v_lshl_add_u32 v64, v63, 3, v64
  v_add_u32 v64, 32768, v64
  v_bfe_u32 v63, v0, 3, 2
  v_xor_b32 v60, s71, v63
  v_lshl_add_u32 v1, v60, 5, v64
  v_add_u32 v6, 61440, v1
  s_add_u32 s71, s71, 1
  v_xor_b32 v60, s71, v63
  v_lshl_add_u32 v2, v60, 5, v64
  v_add_u32 v7, 61440, v2
  s_add_u32 s71, s71, 1
  v_xor_b32 v60, s71, v63
  v_lshl_add_u32 v3, v60, 5, v64
  v_add_u32 v8, 61440, v3
  s_add_u32 s71, s71, 1
  v_xor_b32 v60, s71, v63
  v_lshl_add_u32 v4, v60, 5, v64
  v_add_u32 v9, 61440, v4
  s_add_u32 s71, s71, 1
  v_xor_b32 v60, s71, v63
  v_lshl_add_u32 v5, v60, 5, v64
  v_add_u32 v10, 61440, v5
  s_add_u32 s71, s71, 1
  s_mul_i32 s71, s69, 160
  s_add_u32 s71, s71, 155648
  v_lshlrev_b32 v64, 3, v62
  v_add_u32 v35, s71, v64
  s_lshl_b32 s70, s69, 1
  s_add_u32 s70, s70, s68
  s_lshl_b32 s70, s70, 8
  s_add_u32 s70, s70, 156928
  v_lshlrev_b32 v36, 2, v0
  v_add_u32 v36, s70, v36
  s_add_u32 m0, s75, 0
  s_nop 0
  buffer_load_dwordx4 v29, s[44:47], s74 offen offset:0 lds
  buffer_load_dwordx4 v30, s[44:47], s74 offen offset:1024 lds
  buffer_load_dwordx4 v31, s[44:47], s74 offen offset:2048 lds
  buffer_load_dwordx4 v32, s[44:47], s74 offen offset:3072 lds
  s_add_u32 m0, m0, 4096
  s_nop 0
  buffer_load_dwordx4 v33, s[44:47], s74 offen offset:0 lds
  s_add_u32 s74, s74, 212992
  buffer_load_dword v255, v57, s[44:47], s85 offen
  s_add_u32 s85, s85, 212992
  s_waitcnt vmcnt(12)
  v_lshlrev_b32 v52, 7, v52
  s_barrier
  buffer_load_dword v255, v52, s[32:35], 0 offen
  s_waitcnt vmcnt(11)
  v_lshl_add_u32 v34, v48, 7, v15
  v_lshl_add_u32 v28, v44, 7, v14
  s_add_u32 m0, s76, 0
  s_nop 0
  buffer_load_dwordx4 v28, s[32:35], 0 offen lds
  s_add_u32 m0, m0, 1024
  s_nop 0
  buffer_load_dwordx4 v34, s[32:35], 0 offen lds
  v_lshlrev_b32 v54, 7, v54
  buffer_load_dword v255, v54, s[32:35], 0 offen
  s_barrier
  s_waitcnt vmcnt(11)
  ds_read_b64 v[220:221], v35 offset:0
  ds_read_b64 v[222:223], v35 offset:32
  ds_read_b64 v[224:225], v35 offset:64
  ds_read_b64 v[226:227], v35 offset:96
  ds_read_b64 v[228:229], v35 offset:128
  s_waitcnt lgkmcnt(4)
  v_lshlrev_b32 v140, 16, v220
  v_and_b32 v141, 0xffff0000, v220
  v_lshlrev_b32 v142, 16, v221
  v_and_b32 v143, 0xffff0000, v221
  s_waitcnt lgkmcnt(3)
  v_lshlrev_b32 v156, 16, v222
  v_and_b32 v157, 0xffff0000, v222
  v_lshlrev_b32 v158, 16, v223
  v_and_b32 v159, 0xffff0000, v223
  s_waitcnt lgkmcnt(2)
  v_lshlrev_b32 v172, 16, v224
  v_and_b32 v173, 0xffff0000, v224
  v_lshlrev_b32 v174, 16, v225
  v_and_b32 v175, 0xffff0000, v225
  s_waitcnt lgkmcnt(1)
  v_lshlrev_b32 v188, 16, v226
  v_and_b32 v189, 0xffff0000, v226
  v_lshlrev_b32 v190, 16, v227
  v_and_b32 v191, 0xffff0000, v227
  s_waitcnt lgkmcnt(0)
  v_lshlrev_b32 v204, 16, v228
  v_and_b32 v205, 0xffff0000, v228
  v_lshlrev_b32 v206, 16, v229
  v_and_b32 v207, 0xffff0000, v229
  v_mov_b64 v[144:145], v[140:141]
  v_mov_b64 v[146:147], v[142:143]
  v_mov_b64 v[148:149], v[140:141]
  v_mov_b64 v[150:151], v[142:143]
  v_mov_b64 v[152:153], v[140:141]
  v_mov_b64 v[154:155], v[142:143]
  v_mov_b64 v[160:161], v[156:157]
  v_mov_b64 v[162:163], v[158:159]
  v_mov_b64 v[164:165], v[156:157]
  v_mov_b64 v[166:167], v[158:159]
  v_mov_b64 v[168:169], v[156:157]
  v_mov_b64 v[170:171], v[158:159]
  v_mov_b64 v[176:177], v[172:173]
  v_mov_b64 v[178:179], v[174:175]
  v_mov_b64 v[180:181], v[172:173]
  v_mov_b64 v[182:183], v[174:175]
  v_mov_b64 v[184:185], v[172:173]
  v_mov_b64 v[186:187], v[174:175]
  v_mov_b64 v[192:193], v[188:189]
  v_mov_b64 v[194:195], v[190:191]
  v_mov_b64 v[196:197], v[188:189]
  v_mov_b64 v[198:199], v[190:191]
  v_mov_b64 v[200:201], v[188:189]
  v_mov_b64 v[202:203], v[190:191]
  v_mov_b64 v[208:209], v[204:205]
  v_mov_b64 v[210:211], v[206:207]
  v_mov_b64 v[212:213], v[204:205]
  v_mov_b64 v[214:215], v[206:207]
  v_mov_b64 v[216:217], v[204:205]
  v_mov_b64 v[218:219], v[206:207]
  s_lshl_b32 s73, s68, 2
  s_add_u32 s73, s73, 4
  buffer_load_dwordx3 v[16:18], v13, s[28:31], s73 offen offset:0
  buffer_load_dwordx3 v[20:22], v13, s[28:31], s73 offen offset:832
  s_add_u32 s73, s73, 12
  s_mov_b32 s72, 0
  s_cmp_lg_u32 s68, 0
  s_cbranch_scc1 L_dnn_h1
L_dnn_h0:
  s_add_u32 m0, s75, 40960
  s_nop 0
  buffer_load_dwordx4 v29, s[44:47], s74 offen offset:0 lds
  buffer_load_dwordx4 v30, s[44:47], s74 offen offset:1024 lds
  buffer_load_dwordx4 v31, s[44:47], s74 offen offset:2048 lds
  buffer_load_dwordx4 v32, s[44:47], s74 offen offset:3072 lds
  s_add_u32 m0, m0, 4096
  s_nop 0
  buffer_load_dwordx4 v33, s[44:47], s74 offen offset:0 lds
  s_add_u32 s74, s74, 212992
  s_waitcnt vmcnt(12) lgkmcnt(0)
  s_barrier
  buffer_load_dwordx3 v[24:26], v13, s[28:31], s73 offen offset:0
  buffer_load_dwordx3 v[240:242], v13, s[28:31], s73 offen offset:832
  s_add_u32 s73, s73, 12
L_dnn_loop0:
  ds_read_b64_tr_b16 v[40:41], v1 offset:0
  s_add_u32 m0, s75, 81920
  s_nop 0
  buffer_load_dwordx4 v29, s[44:47], s74 offen offset:0 lds
  ds_read_b64_tr_b16 v[42:43], v1 offset:2560
  ds_read_b64_tr_b16 v[44:45], v1 offset:20480
  ds_read_b64_tr_b16 v[46:47], v1 offset:23040
  ds_read_b64_tr_b16 v[48:49], v2 offset:0
  buffer_load_dwordx4 v30, s[44:47], s74 offen offset:1024 lds
  ds_read_b64_tr_b16 v[50:51], v2 offset:2560
  ds_read_b64_tr_b16 v[52:53], v2 offset:20480
  ds_read_b64_tr_b16 v[54:55], v2 offset:23040
  ds_read_b64_tr_b16 v[56:57], v3 offset:0
  buffer_load_dwordx4 v31, s[44:47], s74 offen offset:2048 lds
  ds_read_b64_tr_b16 v[58:59], v3 offset:2560
  ds_read_b64_tr_b16 v[60:61], v3 offset:20480
  ds_read_b64_tr_b16 v[62:63], v3 offset:23040
  ds_read_b64_tr_b16 v[64:65], v4 offset:0
  buffer_load_dwordx4 v32, s[44:47], s74 offen offset:3072 lds
  ds_read_b64_tr_b16 v[66:67], v4 offset:2560
  ds_read_b64_tr_b16 v[68:69], v4 offset:20480
  ds_read_b64_tr_b16 v[70:71], v4 offset:23040
  ds_read_b128 v[80:83], v11 offset:0
  s_add_u32 m0, m0, 4096
  s_nop 0
  buffer_load_dwordx4 v33, s[44:47], s74 offen offset:0 lds
  s_add_u32 s74, s74, 212992
  ds_read_b128 v[84:87], v12 offset:0
  ds_read_b128 v[88:91], v11 offset:2048
  ds_read_b128 v[92:95], v12 offset:2048
  ds_read_b128 v[96:99], v11 offset:4096
  s_waitcnt vmcnt(12)
  v_lshl_add_u32 v34, v20, 7, v15
  v_lshl_add_u32 v28, v16, 7, v14
  s_add_u32 m0, s76, 8192
  s_nop 0
  buffer_load_dwordx4 v28, s[32:35], 0 offen lds
  ds_read_b128 v[100:103], v12 offset:4096
  ds_read_b128 v[104:107], v11 offset:6144
  ds_read_b128 v[108:111], v12 offset:6144
  ds_read_b64_tr_b16 v[72:73], v5 offset:0
  s_add_u32 m0, m0, 1024
  s_nop 0
  buffer_load_dwordx4 v34, s[32:35], 0 offen lds
  ds_read_b64_tr_b16 v[74:75], v5 offset:2560
  ds_read_b64_tr_b16 v[76:77], v5 offset:20480
  ds_read_b64_tr_b16 v[78:79], v5 offset:23040
L_dnn_in0:
  s_waitcnt vmcnt(9) lgkmcnt(0)
  s_barrier
  s_setprio 0
  v_mfma_f32_16x16x32_bf16 v[140:143], v[40:43], v[80:83], v[140:143]
  v_mfma_f32_16x16x32_bf16 v[140:143], v[44:47], v[84:87], v[140:143]
  v_mfma_f32_16x16x32_bf16 v[144:147], v[40:43], v[88:91], v[144:147]
  v_mfma_f32_16x16x32_bf16 v[144:147], v[44:47], v[92:95], v[144:147]
  v_mfma_f32_16x16x32_bf16 v[148:151], v[40:43], v[96:99], v[148:151]
  v_mfma_f32_16x16x32_bf16 v[148:151], v[44:47], v[100:103], v[148:151]
  v_mfma_f32_16x16x32_bf16 v[152:155], v[40:43], v[104:107], v[152:155]
  v_mfma_f32_16x16x32_bf16 v[152:155], v[44:47], v[108:111], v[152:155]
  v_mfma_f32_16x16x32_bf16 v[168:171], v[48:51], v[104:107], v[168:171]
  v_mfma_f32_16x16x32_bf16 v[168:171], v[52:55], v[108:111], v[168:171]
  v_mfma_f32_16x16x32_bf16 v[164:167], v[48:51], v[96:99], v[164:167]
  v_mfma_f32_16x16x32_bf16 v[164:167], v[52:55], v[100:103], v[164:167]
  v_mfma_f32_16x16x32_bf16 v[160:163], v[48:51], v[88:91], v[160:163]
  v_mfma_f32_16x16x32_bf16 v[160:163], v[52:55], v[92:95], v[160:163]
  v_mfma_f32_16x16x32_bf16 v[156:159], v[48:51], v[80:83], v[156:159]
  v_mfma_f32_16x16x32_bf16 v[156:159], v[52:55], v[84:87], v[156:159]
  v_mfma_f32_16x16x32_bf16 v[172:175], v[56:59], v[80:83], v[172:175]
  v_mfma_f32_16x16x32_bf16 v[172:175], v[60:63], v[84:87], v[172:175]
  v_mfma_f32_16x16x32_bf16 v[176:179], v[56:59], v[88:91], v[176:179]
  v_mfma_f32_16x16x32_bf16 v[176:179], v[60:63], v[92:95], v[176:179]
  v_mfma_f32_16x16x32_bf16 v[180:183], v[56:59], v[96:99], v[180:183]
  v_mfma_f32_16x16x32_bf16 v[180:183], v[60:63], v[100:103], v[180:183]
  v_mfma_f32_16x16x32_bf16 v[184:187], v[56:59], v[104:107], v[184:187]
  v_mfma_f32_16x16x32_bf16 v[184:187], v[60:63], v[108:111], v[184:187]
  v_mfma_f32_16x16x32_bf16 v[200:203], v[64:67], v[104:107], v[200:203]
  v_mfma_f32_16x16x32_bf16 v[200:203], v[68:71], v[108:111], v[200:203]
  v_mfma_f32_16x16x32_bf16 v[196:199], v[64:67], v[96:99], v[196:199]
  v_mfma_f32_16x16x32_bf16 v[196:199], v[68:71], v[100:103], v[196:199]
  v_mfma_f32_16x16x32_bf16 v[192:195], v[64:67], v[88:91], v[192:195]
  v_mfma_f32_16x16x32_bf16 v[192:195], v[68:71], v[92:95], v[192:195]
  v_mfma_f32_16x16x32_bf16 v[188:191], v[64:67], v[80:83], v[188:191]
  v_mfma_f32_16x16x32_bf16 v[188:191], v[68:71], v[84:87], v[188:191]
  v_mfma_f32_16x16x32_bf16 v[204:207], v[72:75], v[80:83], v[204:207]
  v_mfma_f32_16x16x32_bf16 v[204:207], v[76:79], v[84:87], v[204:207]
  v_mfma_f32_16x16x32_bf16 v[208:211], v[72:75], v[88:91], v[208:211]
  v_mfma_f32_16x16x32_bf16 v[208:211], v[76:79], v[92:95], v[208:211]
  v_mfma_f32_16x16x32_bf16 v[212:215], v[72:75], v[96:99], v[212:215]
  v_mfma_f32_16x16x32_bf16 v[212:215], v[76:79], v[100:103], v[212:215]
  v_mfma_f32_16x16x32_bf16 v[216:219], v[72:75], v[104:107], v[216:219]
  s_setprio 2
  s_waitcnt vmcnt(9)
  s_barrier
  v_mfma_f32_16x16x32_bf16 v[216:219], v[76:79], v[108:111], v[216:219]
  ds_read_b64_tr_b16 v[40:41], v1 offset:40960
  s_add_u32 m0, s75, 0
  s_nop 0
  buffer_load_dwordx4 v29, s[44:47], s74 offen offset:0 lds
  ds_read_b64_tr_b16 v[42:43], v1 offset:43520
  ds_read_b64_tr_b16 v[44:45], v6 offset:0
  ds_read_b64_tr_b16 v[46:47], v6 offset:2560
  ds_read_b64_tr_b16 v[48:49], v2 offset:40960
  buffer_load_dwordx4 v30, s[44:47], s74 offen offset:1024 lds
  ds_read_b64_tr_b16 v[50:51], v2 offset:43520
  ds_read_b64_tr_b16 v[52:53], v7 offset:0
  ds_read_b64_tr_b16 v[54:55], v7 offset:2560
  ds_read_b64_tr_b16 v[56:57], v3 offset:40960
  buffer_load_dwordx4 v31, s[44:47], s74 offen offset:2048 lds
  ds_read_b64_tr_b16 v[58:59], v3 offset:43520
  ds_read_b64_tr_b16 v[60:61], v8 offset:0
  ds_read_b64_tr_b16 v[62:63], v8 offset:2560
  ds_read_b64_tr_b16 v[64:65], v4 offset:40960
  buffer_load_dwordx4 v32, s[44:47], s74 offen offset:3072 lds
  ds_read_b64_tr_b16 v[66:67], v4 offset:43520
  ds_read_b64_tr_b16 v[68:69], v9 offset:0
  ds_read_b64_tr_b16 v[70:71], v9 offset:2560
  ds_read_b128 v[80:83], v11 offset:8192
  s_add_u32 m0, m0, 4096
  s_nop 0
  buffer_load_dwordx4 v33, s[44:47], s74 offen offset:0 lds
  s_add_u32 s74, s74, 212992
  ds_read_b128 v[84:87], v12 offset:8192
  ds_read_b128 v[88:91], v11 offset:10240
  ds_read_b128 v[92:95], v12 offset:10240
  ds_read_b128 v[96:99], v11 offset:12288
  v_lshl_add_u32 v34, v21, 7, v15
  v_lshl_add_u32 v28, v17, 7, v14
  s_add_u32 m0, s76, 0
  s_nop 0
  buffer_load_dwordx4 v28, s[32:35], 0 offen lds
  ds_read_b128 v[100:103], v12 offset:12288
  ds_read_b128 v[104:107], v11 offset:14336
  ds_read_b128 v[108:111], v12 offset:14336
  ds_read_b64_tr_b16 v[72:73], v5 offset:40960
  s_add_u32 m0, m0, 1024
  s_nop 0
  buffer_load_dwordx4 v34, s[32:35], 0 offen lds
  ds_read_b64_tr_b16 v[74:75], v5 offset:43520
  ds_read_b64_tr_b16 v[76:77], v10 offset:0
  ds_read_b64_tr_b16 v[78:79], v10 offset:2560
  s_waitcnt vmcnt(7) lgkmcnt(0)
  s_barrier
  s_setprio 0
  v_mfma_f32_16x16x32_bf16 v[140:143], v[40:43], v[80:83], v[140:143]
  v_mfma_f32_16x16x32_bf16 v[140:143], v[44:47], v[84:87], v[140:143]
  v_mfma_f32_16x16x32_bf16 v[144:147], v[40:43], v[88:91], v[144:147]
  v_mfma_f32_16x16x32_bf16 v[144:147], v[44:47], v[92:95], v[144:147]
  v_mfma_f32_16x16x32_bf16 v[148:151], v[40:43], v[96:99], v[148:151]
  v_mfma_f32_16x16x32_bf16 v[148:151], v[44:47], v[100:103], v[148:151]
  v_mfma_f32_16x16x32_bf16 v[152:155], v[40:43], v[104:107], v[152:155]
  v_mfma_f32_16x16x32_bf16 v[152:155], v[44:47], v[108:111], v[152:155]
  v_mfma_f32_16x16x32_bf16 v[168:171], v[48:51], v[104:107], v[168:171]
  v_mfma_f32_16x16x32_bf16 v[168:171], v[52:55], v[108:111], v[168:171]
  v_mfma_f32_16x16x32_bf16 v[164:167], v[48:51], v[96:99], v[164:167]
  v_mfma_f32_16x16x32_bf16 v[164:167], v[52:55], v[100:103], v[164:167]
  v_mfma_f32_16x16x32_bf16 v[160:163], v[48:51], v[88:91], v[160:163]
  v_mfma_f32_16x16x32_bf16 v[160:163], v[52:55], v[92:95], v[160:163]
  v_mfma_f32_16x16x32_bf16 v[156:159], v[48:51], v[80:83], v[156:159]
  v_mfma_f32_16x16x32_bf16 v[156:159], v[52:55], v[84:87], v[156:159]
  v_mfma_f32_16x16x32_bf16 v[172:175], v[56:59], v[80:83], v[172:175]
  v_mfma_f32_16x16x32_bf16 v[172:175], v[60:63], v[84:87], v[172:175]
  v_mfma_f32_16x16x32_bf16 v[176:179], v[56:59], v[88:91], v[176:179]
  v_mfma_f32_16x16x32_bf16 v[176:179], v[60:63], v[92:95], v[176:179]
  v_mfma_f32_16x16x32_bf16 v[180:183], v[56:59], v[96:99], v[180:183]
  v_mfma_f32_16x16x32_bf16 v[180:183], v[60:63], v[100:103], v[180:183]
  v_mfma_f32_16x16x32_bf16 v[184:187], v[56:59], v[104:107], v[184:187]
  v_mfma_f32_16x16x32_bf16 v[184:187], v[60:63], v[108:111], v[184:187]
  v_mfma_f32_16x16x32_bf16 v[200:203], v[64:67], v[104:107], v[200:203]
  v_mfma_f32_16x16x32_bf16 v[200:203], v[68:71], v[108:111], v[200:203]
  v_mfma_f32_16x16x32_bf16 v[196:199], v[64:67], v[96:99], v[196:199]
  v_mfma_f32_16x16x32_bf16 v[196:199], v[68:71], v[100:103], v[196:199]
  v_mfma_f32_16x16x32_bf16 v[192:195], v[64:67], v[88:91], v[192:195]
  v_mfma_f32_16x16x32_bf16 v[192:195], v[68:71], v[92:95], v[192:195]
  v_mfma_f32_16x16x32_bf16 v[188:191], v[64:67], v[80:83], v[188:191]
  v_mfma_f32_16x16x32_bf16 v[188:191], v[68:71], v[84:87], v[188:191]
  v_mfma_f32_16x16x32_bf16 v[204:207], v[72:75], v[80:83], v[204:207]
  v_mfma_f32_16x16x32_bf16 v[204:207], v[76:79], v[84:87], v[204:207]
  v_mfma_f32_16x16x32_bf16 v[208:211], v[72:75], v[88:91], v[208:211]
  v_mfma_f32_16x16x32_bf16 v[208:211], v[76:79], v[92:95], v[208:211]
  v_mfma_f32_16x16x32_bf16 v[212:215], v[72:75], v[96:99], v[212:215]
  v_mfma_f32_16x16x32_bf16 v[212:215], v[76:79], v[100:103], v[212:215]
  v_mfma_f32_16x16x32_bf16 v[216:219], v[72:75], v[104:107], v[216:219]
  s_setprio 2
  s_barrier
  v_mfma_f32_16x16x32_bf16 v[216:219], v[76:79], v[108:111], v[216:219]
  ds_read_b64_tr_b16 v[40:41], v6 offset:20480
  s_add_u32 m0, s75, 40960
  s_nop 0
  buffer_load_dwordx4 v29, s[44:47], s74 offen offset:0 lds
  ds_read_b64_tr_b16 v[42:43], v6 offset:23040
  ds_read_b64_tr_b16 v[44:45], v6 offset:40960
  ds_read_b64_tr_b16 v[46:47], v6 offset:43520
  ds_read_b64_tr_b16 v[48:49], v7 offset:20480
  buffer_load_dwordx4 v30, s[44:47], s74 offen offset:1024 lds
  ds_read_b64_tr_b16 v[50:51], v7 offset:23040
  ds_read_b64_tr_b16 v[52:53], v7 offset:40960
  ds_read_b64_tr_b16 v[54:55], v7 offset:43520
  ds_read_b64_tr_b16 v[56:57], v8 offset:20480
  buffer_load_dwordx4 v31, s[44:47], s74 offen offset:2048 lds
  ds_read_b64_tr_b16 v[58:59], v8 offset:23040
  ds_read_b64_tr_b16 v[60:61], v8 offset:40960
  ds_read_b64_tr_b16 v[62:63], v8 offset:43520
  ds_read_b64_tr_b16 v[64:65], v9 offset:20480
  buffer_load_dwordx4 v32, s[44:47], s74 offen offset:3072 lds
  ds_read_b64_tr_b16 v[66:67], v9 offset:23040
  ds_read_b64_tr_b16 v[68:69], v9 offset:40960
  ds_read_b64_tr_b16 v[70:71], v9 offset:43520
  ds_read_b128 v[80:83], v11 offset:0
  s_add_u32 m0, m0, 4096
  s_nop 0
  buffer_load_dwordx4 v33, s[44:47], s74 offen offset:0 lds
  s_add_u32 s74, s74, 212992
  ds_read_b128 v[84:87], v12 offset:0
  ds_read_b128 v[88:91], v11 offset:2048
  ds_read_b128 v[92:95], v12 offset:2048
  ds_read_b128 v[96:99], v11 offset:4096
  v_lshl_add_u32 v34, v22, 7, v15
  v_lshl_add_u32 v28, v18, 7, v14
  s_add_u32 m0, s76, 8192
  s_nop 0
  buffer_load_dwordx4 v28, s[32:35], 0 offen lds
  ds_read_b128 v[100:103], v12 offset:4096
  ds_read_b128 v[104:107], v11 offset:6144
  ds_read_b128 v[108:111], v12 offset:6144
  ds_read_b64_tr_b16 v[72:73], v10 offset:20480
  s_add_u32 m0, m0, 1024
  s_nop 0
  buffer_load_dwordx4 v34, s[32:35], 0 offen lds
  ds_read_b64_tr_b16 v[74:75], v10 offset:23040
  ds_read_b64_tr_b16 v[76:77], v10 offset:40960
  ds_read_b64_tr_b16 v[78:79], v10 offset:43520
  buffer_load_dwordx3 v[16:18], v13, s[28:31], s73 offen offset:0
  buffer_load_dwordx3 v[20:22], v13, s[28:31], s73 offen offset:832
  s_add_u32 s73, s73, 12
  s_waitcnt vmcnt(9) lgkmcnt(0)
  s_barrier
  s_setprio 0
  v_mfma_f32_16x16x32_bf16 v[140:143], v[40:43], v[80:83], v[140:143]
  v_mfma_f32_16x16x32_bf16 v[140:143], v[44:47], v[84:87], v[140:143]
  v_mfma_f32_16x16x32_bf16 v[144:147], v[40:43], v[88:91], v[144:147]
  v_mfma_f32_16x16x32_bf16 v[144:147], v[44:47], v[92:95], v[144:147]
  v_mfma_f32_16x16x32_bf16 v[148:151], v[40:43], v[96:99], v[148:151]
  v_mfma_f32_16x16x32_bf16 v[148:151], v[44:47], v[100:103], v[148:151]
  v_mfma_f32_16x16x32_bf16 v[152:155], v[40:43], v[104:107], v[152:155]
  v_mfma_f32_16x16x32_bf16 v[152:155], v[44:47], v[108:111], v[152:155]
  v_mfma_f32_16x16x32_bf16 v[168:171], v[48:51], v[104:107], v[168:171]
  v_mfma_f32_16x16x32_bf16 v[168:171], v[52:55], v[108:111], v[168:171]
  v_mfma_f32_16x16x32_bf16 v[164:167], v[48:51], v[96:99], v[164:167]
  v_mfma_f32_16x16x32_bf16 v[164:167], v[52:55], v[100:103], v[164:167]
  v_mfma_f32_16x16x32_bf16 v[160:163], v[48:51], v[88:91], v[160:163]
  v_mfma_f32_16x16x32_bf16 v[160:163], v[52:55], v[92:95], v[160:163]
  v_mfma_f32_16x16x32_bf16 v[156:159], v[48:51], v[80:83], v[156:159]
  v_mfma_f32_16x16x32_bf16 v[156:159], v[52:55], v[84:87], v[156:159]
  v_mfma_f32_16x16x32_bf16 v[172:175], v[56:59], v[80:83], v[172:175]
  v_mfma_f32_16x16x32_bf16 v[172:175], v[60:63], v[84:87], v[172:175]
  v_mfma_f32_16x16x32_bf16 v[176:179], v[56:59], v[88:91], v[176:179]
  v_mfma_f32_16x16x32_bf16 v[176:179], v[60:63], v[92:95], v[176:179]
  v_mfma_f32_16x16x32_bf16 v[180:183], v[56:59], v[96:99], v[180:183]
  v_mfma_f32_16x16x32_bf16 v[180:183], v[60:63], v[100:103], v[180:183]
  v_mfma_f32_16x16x32_bf16 v[184:187], v[56:59], v[104:107], v[184:187]
  v_mfma_f32_16x16x32_bf16 v[184:187], v[60:63], v[108:111], v[184:187]
  v_mfma_f32_16x16x32_bf16 v[200:203], v[64:67], v[104:107], v[200:203]
  v_mfma_f32_16x16x32_bf16 v[200:203], v[68:71], v[108:111], v[200:203]
  v_mfma_f32_16x16x32_bf16 v[196:199], v[64:67], v[96:99], v[196:199]
  v_mfma_f32_16x16x32_bf16 v[196:199], v[68:71], v[100:103], v[196:199]
  v_mfma_f32_16x16x32_bf16 v[192:195], v[64:67], v[88:91], v[192:195]
  v_mfma_f32_16x16x32_bf16 v[192:195], v[68:71], v[92:95], v[192:195]
  v_mfma_f32_16x16x32_bf16 v[188:191], v[64:67], v[80:83], v[188:191]
  v_mfma_f32_16x16x32_bf16 v[188:191], v[68:71], v[84:87], v[188:191]
  v_mfma_f32_16x16x32_bf16 v[204:207], v[72:75], v[80:83], v[204:207]
  v_mfma_f32_16x16x32_bf16 v[204:207], v[76:79], v[84:87], v[204:207]
  v_mfma_f32_16x16x32_bf16 v[208:211], v[72:75], v[88:91], v[208:211]
  v_mfma_f32_16x16x32_bf16 v[208:211], v[76:79], v[92:95], v[208:211]
  v_mfma_f32_16x16x32_bf16 v[212:215], v[72:75], v[96:99], v[212:215]
  v_mfma_f32_16x16x32_bf16 v[212:215], v[76:79], v[100:103], v[212:215]
  v_mfma_f32_16x16x32_bf16 v[216:219], v[72:75], v[104:107], v[216:219]
  s_setprio 2
  s_barrier
  v_mfma_f32_16x16x32_bf16 v[216:219], v[76:79], v[108:111], v[216:219]
  ds_read_b64_tr_b16 v[40:41], v1 offset:0
  s_add_u32 m0, s75, 81920
  s_nop 0
  buffer_load_dwordx4 v29, s[44:47], s74 offen offset:0 lds
  ds_read_b64_tr_b16 v[42:43], v1 offset:2560
  ds_read_b64_tr_b16 v[44:45], v1 offset:20480
  ds_read_b64_tr_b16 v[46:47], v1 offset:23040
  ds_read_b64_tr_b16 v[48:49], v2 offset:0
  buffer_load_dwordx4 v30, s[44:47], s74 offen offset:1024 lds
  ds_read_b64_tr_b16 v[50:51], v2 offset:2560
  ds_read_b64_tr_b16 v[52:53], v2 offset:20480
  ds_read_b64_tr_b16 v[54:55], v2 offset:23040
  ds_read_b64_tr_b16 v[56:57], v3 offset:0
  buffer_load_dwordx4 v31, s[44:47], s74 offen offset:2048 lds
  ds_read_b64_tr_b16 v[58:59], v3 offset:2560
  ds_read_b64_tr_b16 v[60:61], v3 offset:20480
  ds_read_b64_tr_b16 v[62:63], v3 offset:23040
  ds_read_b64_tr_b16 v[64:65], v4 offset:0
  buffer_load_dwordx4 v32, s[44:47], s74 offen offset:3072 lds
  ds_read_b64_tr_b16 v[66:67], v4 offset:2560
  ds_read_b64_tr_b16 v[68:69], v4 offset:20480
  ds_read_b64_tr_b16 v[70:71], v4 offset:23040
  ds_read_b128 v[80:83], v11 offset:8192
  s_add_u32 m0, m0, 4096
  s_nop 0
  buffer_load_dwordx4 v33, s[44:47], s74 offen offset:0 lds
  s_add_u32 s74, s74, 212992
  ds_read_b128 v[84:87], v12 offset:8192
  ds_read_b128 v[88:91], v11 offset:10240
  ds_read_b128 v[92:95], v12 offset:10240
  ds_read_b128 v[96:99], v11 offset:12288
  v_lshl_add_u32 v34, v240, 7, v15
  v_lshl_add_u32 v28, v24, 7, v14
  s_add_u32 m0, s76, 0
  s_nop 0
  buffer_load_dwordx4 v28, s[32:35], 0 offen lds
  ds_read_b128 v[100:103], v12 offset:12288
  ds_read_b128 v[104:107], v11 offset:14336
  ds_read_b128 v[108:111], v12 offset:14336
  ds_read_b64_tr_b16 v[72:73], v5 offset:0
  s_add_u32 m0, m0, 1024
  s_nop 0
  buffer_load_dwordx4 v34, s[32:35], 0 offen lds
  ds_read_b64_tr_b16 v[74:75], v5 offset:2560
  ds_read_b64_tr_b16 v[76:77], v5 offset:20480
  ds_read_b64_tr_b16 v[78:79], v5 offset:23040
  s_waitcnt vmcnt(9) lgkmcnt(0)
  s_barrier
  s_setprio 0
  v_mfma_f32_16x16x32_bf16 v[140:143], v[40:43], v[80:83], v[140:143]
  s_cmp_eq_u32 s72, 3
  v_mfma_f32_16x16x32_bf16 v[140:143], v[44:47], v[84:87], v[140:143]
  v_mfma_f32_16x16x32_bf16 v[144:147], v[40:43], v[88:91], v[144:147]
  v_mfma_f32_16x16x32_bf16 v[144:147], v[44:47], v[92:95], v[144:147]
  v_mfma_f32_16x16x32_bf16 v[148:151], v[40:43], v[96:99], v[148:151]
  v_mfma_f32_16x16x32_bf16 v[148:151], v[44:47], v[100:103], v[148:151]
  v_mfma_f32_16x16x32_bf16 v[152:155], v[40:43], v[104:107], v[152:155]
  v_mfma_f32_16x16x32_bf16 v[152:155], v[44:47], v[108:111], v[152:155]
  v_mfma_f32_16x16x32_bf16 v[168:171], v[48:51], v[104:107], v[168:171]
  v_mfma_f32_16x16x32_bf16 v[168:171], v[52:55], v[108:111], v[168:171]
  v_mfma_f32_16x16x32_bf16 v[164:167], v[48:51], v[96:99], v[164:167]
  v_mfma_f32_16x16x32_bf16 v[164:167], v[52:55], v[100:103], v[164:167]
  v_mfma_f32_16x16x32_bf16 v[160:163], v[48:51], v[88:91], v[160:163]
  v_mfma_f32_16x16x32_bf16 v[160:163], v[52:55], v[92:95], v[160:163]
  v_mfma_f32_16x16x32_bf16 v[156:159], v[48:51], v[80:83], v[156:159]
  v_mfma_f32_16x16x32_bf16 v[156:159], v[52:55], v[84:87], v[156:159]
  v_mfma_f32_16x16x32_bf16 v[172:175], v[56:59], v[80:83], v[172:175]
  v_mfma_f32_16x16x32_bf16 v[172:175], v[60:63], v[84:87], v[172:175]
  v_mfma_f32_16x16x32_bf16 v[176:179], v[56:59], v[88:91], v[176:179]
  v_mfma_f32_16x16x32_bf16 v[176:179], v[60:63], v[92:95], v[176:179]
  v_mfma_f32_16x16x32_bf16 v[180:183], v[56:59], v[96:99], v[180:183]
  v_mfma_f32_16x16x32_bf16 v[180:183], v[60:63], v[100:103], v[180:183]
  v_mfma_f32_16x16x32_bf16 v[184:187], v[56:59], v[104:107], v[184:187]
  v_mfma_f32_16x16x32_bf16 v[184:187], v[60:63], v[108:111], v[184:187]
  v_mfma_f32_16x16x32_bf16 v[200:203], v[64:67], v[104:107], v[200:203]
  v_mfma_f32_16x16x32_bf16 v[200:203], v[68:71], v[108:111], v[200:203]
  v_mfma_f32_16x16x32_bf16 v[196:199], v[64:67], v[96:99], v[196:199]
  v_mfma_f32_16x16x32_bf16 v[196:199], v[68:71], v[100:103], v[196:199]
  v_mfma_f32_16x16x32_bf16 v[192:195], v[64:67], v[88:91], v[192:195]
  v_mfma_f32_16x16x32_bf16 v[192:195], v[68:71], v[92:95], v[192:195]
  v_mfma_f32_16x16x32_bf16 v[188:191], v[64:67], v[80:83], v[188:191]
  v_mfma_f32_16x16x32_bf16 v[188:191], v[68:71], v[84:87], v[188:191]
  v_mfma_f32_16x16x32_bf16 v[204:207], v[72:75], v[80:83], v[204:207]
  v_mfma_f32_16x16x32_bf16 v[204:207], v[76:79], v[84:87], v[204:207]
  v_mfma_f32_16x16x32_bf16 v[208:211], v[72:75], v[88:91], v[208:211]
  v_mfma_f32_16x16x32_bf16 v[208:211], v[76:79], v[92:95], v[208:211]
  v_mfma_f32_16x16x32_bf16 v[212:215], v[72:75], v[96:99], v[212:215]
  v_mfma_f32_16x16x32_bf16 v[212:215], v[76:79], v[100:103], v[212:215]
  v_mfma_f32_16x16x32_bf16 v[216:219], v[72:75], v[104:107], v[216:219]
  s_setprio 2
  s_barrier
  v_mfma_f32_16x16x32_bf16 v[216:219], v[76:79], v[108:111], v[216:219]
  s_cbranch_scc1 L_dnn_x0
  ds_read_b64_tr_b16 v[40:41], v1 offset:40960
  s_add_u32 m0, s75, 0
  s_nop 0
  buffer_load_dwordx4 v29, s[44:47], s74 offen offset:0 lds
  ds_read_b64_tr_b16 v[42:43], v1 offset:43520
  ds_read_b64_tr_b16 v[44:45], v6 offset:0
  ds_read_b64_tr_b16 v[46:47], v6 offset:2560
  ds_read_b64_tr_b16 v[48:49], v2 offset:40960
  buffer_load_dwordx4 v30, s[44:47], s74 offen offset:1024 lds
  ds_read_b64_tr_b16 v[50:51], v2 offset:43520
  ds_read_b64_tr_b16 v[52:53], v7 offset:0
  ds_read_b64_tr_b16 v[54:55], v7 offset:2560
  ds_read_b64_tr_b16 v[56:57], v3 offset:40960
  buffer_load_dwordx4 v31, s[44:47], s74 offen offset:2048 lds
  ds_read_b64_tr_b16 v[58:59], v3 offset:43520
  ds_read_b64_tr_b16 v[60:61], v8 offset:0
  ds_read_b64_tr_b16 v[62:63], v8 offset:2560
  ds_read_b64_tr_b16 v[64:65], v4 offset:40960
  buffer_load_dwordx4 v32, s[44:47], s74 offen offset:3072 lds
  ds_read_b64_tr_b16 v[66:67], v4 offset:43520
  ds_read_b64_tr_b16 v[68:69], v9 offset:0
  ds_read_b64_tr_b16 v[70:71], v9 offset:2560
  ds_read_b128 v[80:83], v11 offset:0
  s_add_u32 m0, m0, 4096
  s_nop 0
  buffer_load_dwordx4 v33, s[44:47], s74 offen offset:0 lds
  s_add_u32 s74, s74, 212992
  ds_read_b128 v[84:87], v12 offset:0
  ds_read_b128 v[88:91], v11 offset:2048
  ds_read_b128 v[92:95], v12 offset:2048
  ds_read_b128 v[96:99], v11 offset:4096
  v_lshl_add_u32 v34, v241, 7, v15
  v_lshl_add_u32 v28, v25, 7, v14
  s_add_u32 m0, s76, 8192
  s_nop 0
  buffer_load_dwordx4 v28, s[32:35], 0 offen lds
  ds_read_b128 v[100:103], v12 offset:4096
  ds_read_b128 v[104:107], v11 offset:6144
  ds_read_b128 v[108:111], v12 offset:6144
  ds_read_b64_tr_b16 v[72:73], v5 offset:40960
  s_add_u32 m0, m0, 1024
  s_nop 0
  buffer_load_dwordx4 v34, s[32:35], 0 offen lds
  ds_read_b64_tr_b16 v[74:75], v5 offset:43520
  ds_read_b64_tr_b16 v[76:77], v10 offset:0
  ds_read_b64_tr_b16 v[78:79], v10 offset:2560
  s_waitcnt vmcnt(7) lgkmcnt(0)
  s_barrier
  s_setprio 0
  v_mfma_f32_16x16x32_bf16 v[140:143], v[40:43], v[80:83], v[140:143]
  v_mfma_f32_16x16x32_bf16 v[140:143], v[44:47], v[84:87], v[140:143]
  v_mfma_f32_16x16x32_bf16 v[144:147], v[40:43], v[88:91], v[144:147]
  v_mfma_f32_16x16x32_bf16 v[144:147], v[44:47], v[92:95], v[144:147]
  v_mfma_f32_16x16x32_bf16 v[148:151], v[40:43], v[96:99], v[148:151]
  v_mfma_f32_16x16x32_bf16 v[148:151], v[44:47], v[100:103], v[148:151]
  v_mfma_f32_16x16x32_bf16 v[152:155], v[40:43], v[104:107], v[152:155]
  v_mfma_f32_16x16x32_bf16 v[152:155], v[44:47], v[108:111], v[152:155]
  v_mfma_f32_16x16x32_bf16 v[168:171], v[48:51], v[104:107], v[168:171]
  v_mfma_f32_16x16x32_bf16 v[168:171], v[52:55], v[108:111], v[168:171]
  v_mfma_f32_16x16x32_bf16 v[164:167], v[48:51], v[96:99], v[164:167]
  v_mfma_f32_16x16x32_bf16 v[164:167], v[52:55], v[100:103], v[164:167]
  v_mfma_f32_16x16x32_bf16 v[160:163], v[48:51], v[88:91], v[160:163]
  v_mfma_f32_16x16x32_bf16 v[160:163], v[52:55], v[92:95], v[160:163]
  v_mfma_f32_16x16x32_bf16 v[156:159], v[48:51], v[80:83], v[156:159]
  v_mfma_f32_16x16x32_bf16 v[156:159], v[52:55], v[84:87], v[156:159]
  v_mfma_f32_16x16x32_bf16 v[172:175], v[56:59], v[80:83], v[172:175]
  v_mfma_f32_16x16x32_bf16 v[172:175], v[60:63], v[84:87], v[172:175]
  v_mfma_f32_16x16x32_bf16 v[176:179], v[56:59], v[88:91], v[176:179]
  v_mfma_f32_16x16x32_bf16 v[176:179], v[60:63], v[92:95], v[176:179]
  v_mfma_f32_16x16x32_bf16 v[180:183], v[56:59], v[96:99], v[180:183]
  v_mfma_f32_16x16x32_bf16 v[180:183], v[60:63], v[100:103], v[180:183]
  v_mfma_f32_16x16x32_bf16 v[184:187], v[56:59], v[104:107], v[184:187]
  v_mfma_f32_16x16x32_bf16 v[184:187], v[60:63], v[108:111], v[184:187]
  v_mfma_f32_16x16x32_bf16 v[200:203], v[64:67], v[104:107], v[200:203]
  v_mfma_f32_16x16x32_bf16 v[200:203], v[68:71], v[108:111], v[200:203]
  v_mfma_f32_16x16x32_bf16 v[196:199], v[64:67], v[96:99], v[196:199]
  v_mfma_f32_16x16x32_bf16 v[196:199], v[68:71], v[100:103], v[196:199]
  v_mfma_f32_16x16x32_bf16 v[192:195], v[64:67], v[88:91], v[192:195]
  v_mfma_f32_16x16x32_bf16 v[192:195], v[68:71], v[92:95], v[192:195]
  v_mfma_f32_16x16x32_bf16 v[188:191], v[64:67], v[80:83], v[188:191]
  v_mfma_f32_16x16x32_bf16 v[188:191], v[68:71], v[84:87], v[188:191]
  v_mfma_f32_16x16x32_bf16 v[204:207], v[72:75], v[80:83], v[204:207]
  v_mfma_f32_16x16x32_bf16 v[204:207], v[76:79], v[84:87], v[204:207]
  v_mfma_f32_16x16x32_bf16 v[208:211], v[72:75], v[88:91], v[208:211]
  v_mfma_f32_16x16x32_bf16 v[208:211], v[76:79], v[92:95], v[208:211]
  v_mfma_f32_16x16x32_bf16 v[212:215], v[72:75], v[96:99], v[212:215]
  v_mfma_f32_16x16x32_bf16 v[212:215], v[76:79], v[100:103], v[212:215]
  v_mfma_f32_16x16x32_bf16 v[216:219], v[72:75], v[104:107], v[216:219]
  s_setprio 2
  s_barrier
  v_mfma_f32_16x16x32_bf16 v[216:219], v[76:79], v[108:111], v[216:219]
  ds_read_b64_tr_b16 v[40:41], v6 offset:20480
  s_add_u32 m0, s75, 40960
  s_nop 0
  buffer_load_dwordx4 v29, s[44:47], s74 offen offset:0 lds
  ds_read_b64_tr_b16 v[42:43], v6 offset:23040
  ds_read_b64_tr_b16 v[44:45], v6 offset:40960
  ds_read_b64_tr_b16 v[46:47], v6 offset:43520
  ds_read_b64_tr_b16 v[48:49], v7 offset:20480
  buffer_load_dwordx4 v30, s[44:47], s74 offen offset:1024 lds
  ds_read_b64_tr_b16 v[50:51], v7 offset:23040
  ds_read_b64_tr_b16 v[52:53], v7 offset:40960
  ds_read_b64_tr_b16 v[54:55], v7 offset:43520
  ds_read_b64_tr_b16 v[56:57], v8 offset:20480
  buffer_load_dwordx4 v31, s[44:47], s74 offen offset:2048 lds
  ds_read_b64_tr_b16 v[58:59], v8 offset:23040
  ds_read_b64_tr_b16 v[60:61], v8 offset:40960
  ds_read_b64_tr_b16 v[62:63], v8 offset:43520
  ds_read_b64_tr_b16 v[64:65], v9 offset:20480
  buffer_load_dwordx4 v32, s[44:47], s74 offen offset:3072 lds
  ds_read_b64_tr_b16 v[66:67], v9 offset:23040
  ds_read_b64_tr_b16 v[68:69], v9 offset:40960
  ds_read_b64_tr_b16 v[70:71], v9 offset:43520
  ds_read_b128 v[80:83], v11 offset:8192
  s_add_u32 m0, m0, 4096
  s_nop 0
  buffer_load_dwordx4 v33, s[44:47], s74 offen offset:0 lds
  s_add_u32 s74, s74, 212992
  ds_read_b128 v[84:87], v12 offset:8192
  ds_read_b128 v[88:91], v11 offset:10240
  ds_read_b128 v[92:95], v12 offset:10240
  ds_read_b128 v[96:99], v11 offset:12288
  v_lshl_add_u32 v34, v242, 7, v15
  v_lshl_add_u32 v28, v26, 7, v14
  s_add_u32 m0, s76, 0
  s_nop 0
  buffer_load_dwordx4 v28, s[32:35], 0 offen lds
  ds_read_b128 v[100:103], v12 offset:12288
  ds_read_b128 v[104:107], v11 offset:14336
  ds_read_b128 v[108:111], v12 offset:14336
  ds_read_b64_tr_b16 v[72:73], v10 offset:20480
  s_add_u32 m0, m0, 1024
  s_nop 0
  buffer_load_dwordx4 v34, s[32:35], 0 offen lds
  ds_read_b64_tr_b16 v[74:75], v10 offset:23040
  ds_read_b64_tr_b16 v[76:77], v10 offset:40960
  ds_read_b64_tr_b16 v[78:79], v10 offset:43520
  buffer_load_dwordx3 v[24:26], v13, s[28:31], s73 offen offset:0
  buffer_load_dwordx3 v[240:242], v13, s[28:31], s73 offen offset:832
  s_add_u32 s73, s73, 12
  s_waitcnt vmcnt(9) lgkmcnt(0)
  s_barrier
  s_setprio 0
  v_mfma_f32_16x16x32_bf16 v[140:143], v[40:43], v[80:83], v[140:143]
  s_add_u32 s72, s72, 1
  v_mfma_f32_16x16x32_bf16 v[140:143], v[44:47], v[84:87], v[140:143]
  v_mfma_f32_16x16x32_bf16 v[144:147], v[40:43], v[88:91], v[144:147]
  v_mfma_f32_16x16x32_bf16 v[144:147], v[44:47], v[92:95], v[144:147]
  v_mfma_f32_16x16x32_bf16 v[148:151], v[40:43], v[96:99], v[148:151]
  v_mfma_f32_16x16x32_bf16 v[148:151], v[44:47], v[100:103], v[148:151]
  v_mfma_f32_16x16x32_bf16 v[152:155], v[40:43], v[104:107], v[152:155]
  v_mfma_f32_16x16x32_bf16 v[152:155], v[44:47], v[108:111], v[152:155]
  v_mfma_f32_16x16x32_bf16 v[168:171], v[48:51], v[104:107], v[168:171]
  v_mfma_f32_16x16x32_bf16 v[168:171], v[52:55], v[108:111], v[168:171]
  v_mfma_f32_16x16x32_bf16 v[164:167], v[48:51], v[96:99], v[164:167]
  v_mfma_f32_16x16x32_bf16 v[164:167], v[52:55], v[100:103], v[164:167]
  v_mfma_f32_16x16x32_bf16 v[160:163], v[48:51], v[88:91], v[160:163]
  v_mfma_f32_16x16x32_bf16 v[160:163], v[52:55], v[92:95], v[160:163]
  v_mfma_f32_16x16x32_bf16 v[156:159], v[48:51], v[80:83], v[156:159]
  v_mfma_f32_16x16x32_bf16 v[156:159], v[52:55], v[84:87], v[156:159]
  v_mfma_f32_16x16x32_bf16 v[172:175], v[56:59], v[80:83], v[172:175]
  v_mfma_f32_16x16x32_bf16 v[172:175], v[60:63], v[84:87], v[172:175]
  v_mfma_f32_16x16x32_bf16 v[176:179], v[56:59], v[88:91], v[176:179]
  v_mfma_f32_16x16x32_bf16 v[176:179], v[60:63], v[92:95], v[176:179]
  s_cmp_lt_u32 s72, 4
  v_mfma_f32_16x16x32_bf16 v[180:183], v[56:59], v[96:99], v[180:183]
  v_mfma_f32_16x16x32_bf16 v[180:183], v[60:63], v[100:103], v[180:183]
  v_mfma_f32_16x16x32_bf16 v[184:187], v[56:59], v[104:107], v[184:187]
  v_mfma_f32_16x16x32_bf16 v[184:187], v[60:63], v[108:111], v[184:187]
  v_mfma_f32_16x16x32_bf16 v[200:203], v[64:67], v[104:107], v[200:203]
  v_mfma_f32_16x16x32_bf16 v[200:203], v[68:71], v[108:111], v[200:203]
  v_mfma_f32_16x16x32_bf16 v[196:199], v[64:67], v[96:99], v[196:199]
  v_mfma_f32_16x16x32_bf16 v[196:199], v[68:71], v[100:103], v[196:199]
  v_mfma_f32_16x16x32_bf16 v[192:195], v[64:67], v[88:91], v[192:195]
  v_mfma_f32_16x16x32_bf16 v[192:195], v[68:71], v[92:95], v[192:195]
  v_mfma_f32_16x16x32_bf16 v[188:191], v[64:67], v[80:83], v[188:191]
  v_mfma_f32_16x16x32_bf16 v[188:191], v[68:71], v[84:87], v[188:191]
  v_mfma_f32_16x16x32_bf16 v[204:207], v[72:75], v[80:83], v[204:207]
  v_mfma_f32_16x16x32_bf16 v[204:207], v[76:79], v[84:87], v[204:207]
  v_mfma_f32_16x16x32_bf16 v[208:211], v[72:75], v[88:91], v[208:211]
  v_mfma_f32_16x16x32_bf16 v[208:211], v[76:79], v[92:95], v[208:211]
  v_mfma_f32_16x16x32_bf16 v[212:215], v[72:75], v[96:99], v[212:215]
  v_mfma_f32_16x16x32_bf16 v[212:215], v[76:79], v[100:103], v[212:215]
  v_mfma_f32_16x16x32_bf16 v[216:219], v[72:75], v[104:107], v[216:219]
  s_setprio 2
  s_barrier
  v_mfma_f32_16x16x32_bf16 v[216:219], v[76:79], v[108:111], v[216:219]
  s_cbranch_scc1 L_dnn_loop0
L_dnn_x0:
  ds_read_b64_tr_b16 v[40:41], v1 offset:40960
  s_add_u32 m0, s75, 0
  s_nop 0
  buffer_load_dwordx4 v29, s[44:47], s74 offen offset:0 lds
  ds_read_b64_tr_b16 v[42:43], v1 offset:43520
  ds_read_b64_tr_b16 v[44:45], v6 offset:0
  ds_read_b64_tr_b16 v[46:47], v6 offset:2560
  ds_read_b64_tr_b16 v[48:49], v2 offset:40960
  buffer_load_dwordx4 v30, s[44:47], s74 offen offset:1024 lds
  ds_read_b64_tr_b16 v[50:51], v2 offset:43520
  ds_read_b64_tr_b16 v[52:53], v7 offset:0
  ds_read_b64_tr_b16 v[54:55], v7 offset:2560
  ds_read_b64_tr_b16 v[56:57], v3 offset:40960
  ds_read_b64_tr_b16 v[58:59], v3 offset:43520
  buffer_load_dwordx4 v31, s[44:47], s74 offen offset:2048 lds
  ds_read_b64_tr_b16 v[60:61], v8 offset:0
  ds_read_b64_tr_b16 v[62:63], v8 offset:2560
  ds_read_b64_tr_b16 v[64:65], v4 offset:40960
  ds_read_b64_tr_b16 v[66:67], v4 offset:43520
  ds_read_b64_tr_b16 v[68:69], v9 offset:0
  buffer_load_dwordx4 v32, s[44:47], s74 offen offset:3072 lds
  ds_read_b64_tr_b16 v[70:71], v9 offset:2560
  ds_read_b128 v[80:83], v11 offset:0
  ds_read_b128 v[84:87], v12 offset:0
  ds_read_b128 v[88:91], v11 offset:2048
  s_add_u32 m0, m0, 4096
  s_nop 0
  buffer_load_dwordx4 v33, s[44:47], s74 offen offset:0 lds
  s_add_u32 s74, s74, 212992
  ds_read_b128 v[92:95], v12 offset:2048
  ds_read_b128 v[96:99], v11 offset:4096
  ds_read_b128 v[100:103], v12 offset:4096
  ds_read_b128 v[104:107], v11 offset:6144
  ds_read_b128 v[108:111], v12 offset:6144
  v_lshl_add_u32 v34, v241, 7, v15
  v_lshl_add_u32 v28, v25, 7, v14
  s_add_u32 m0, s76, 8192
  s_nop 0
  buffer_load_dwordx4 v28, s[32:35], 0 offen lds
  ds_read_b64_tr_b16 v[72:73], v5 offset:40960
  ds_read_b64_tr_b16 v[74:75], v5 offset:43520
  ds_read_b64_tr_b16 v[76:77], v10 offset:0
  ds_read_b64_tr_b16 v[78:79], v10 offset:2560
  ds_read_b64 v[220:221], v35 offset:640
  s_add_u32 m0, m0, 1024
  s_nop 0
  buffer_load_dwordx4 v34, s[32:35], 0 offen lds
  ds_read_b64 v[222:223], v35 offset:672
  ds_read_b64 v[224:225], v35 offset:704
  ds_read_b64 v[226:227], v35 offset:736
  ds_read_b64 v[228:229], v35 offset:768
  s_waitcnt vmcnt(7) lgkmcnt(0)
  s_barrier
  s_setprio 0
  v_mfma_f32_16x16x32_bf16 v[140:143], v[40:43], v[80:83], v[140:143]
  v_mov_b32 v232, 0xc0135761
  v_mov_b32 v233, 0xc0135761
  v_mfma_f32_16x16x32_bf16 v[140:143], v[44:47], v[84:87], v[140:143]
  v_mov_b32 v234, 0xbdd2d3e8
  v_mfma_f32_16x16x32_bf16 v[144:147], v[40:43], v[88:91], v[144:147]
  v_mov_b32 v235, 0xbdd2d3e8
  v_mfma_f32_16x16x32_bf16 v[144:147], v[44:47], v[92:95], v[144:147]
  v_mov_b32 v236, 0xc2b40000
  v_mfma_f32_16x16x32_bf16 v[148:151], v[40:43], v[96:99], v[148:151]
  v_mov_b32 v237, 0xc2b40000
  v_mfma_f32_16x16x32_bf16 v[148:151], v[44:47], v[100:103], v[148:151]
  v_lshlrev_b32 v112, 16, v220
  v_mfma_f32_16x16x32_bf16 v[152:155], v[40:43], v[104:107], v[152:155]
  v_and_b32 v113, 0xffff0000, v220
  v_mfma_f32_16x16x32_bf16 v[152:155], v[44:47], v[108:111], v[152:155]
  v_lshlrev_b32 v114, 16, v221
  v_mfma_f32_16x16x32_bf16 v[168:171], v[48:51], v[104:107], v[168:171]
  v_and_b32 v115, 0xffff0000, v221
  v_mfma_f32_16x16x32_bf16 v[168:171], v[52:55], v[108:111], v[168:171]
  v_lshlrev_b32 v116, 16, v222
  v_mfma_f32_16x16x32_bf16 v[164:167], v[48:51], v[96:99], v[164:167]
  v_and_b32 v117, 0xffff0000, v222
  v_mfma_f32_16x16x32_bf16 v[164:167], v[52:55], v[100:103], v[164:167]
  v_lshlrev_b32 v118, 16, v223
  v_mfma_f32_16x16x32_bf16 v[160:163], v[48:51], v[88:91], v[160:163]
  v_and_b32 v119, 0xffff0000, v223
  v_mfma_f32_16x16x32_bf16 v[160:163], v[52:55], v[92:95], v[160:163]
  v_lshlrev_b32 v120, 16, v224
  v_mfma_f32_16x16x32_bf16 v[156:159], v[48:51], v[80:83], v[156:159]
  v_and_b32 v121, 0xffff0000, v224
  v_mfma_f32_16x16x32_bf16 v[156:159], v[52:55], v[84:87], v[156:159]
  v_lshlrev_b32 v122, 16, v225
  v_mfma_f32_16x16x32_bf16 v[172:175], v[56:59], v[80:83], v[172:175]
  v_and_b32 v123, 0xffff0000, v225
  v_mfma_f32_16x16x32_bf16 v[172:175], v[60:63], v[84:87], v[172:175]
  v_lshlrev_b32 v124, 16, v226
  v_mfma_f32_16x16x32_bf16 v[176:179], v[56:59], v[88:91], v[176:179]
  v_and_b32 v125, 0xffff0000, v226
  v_mfma_f32_16x16x32_bf16 v[176:179], v[60:63], v[92:95], v[176:179]
  v_lshlrev_b32 v126, 16, v227
  v_and_b32 v127, 0xffff0000, v227
  v_mfma_f32_16x16x32_bf16 v[180:183], v[56:59], v[96:99], v[180:183]
  v_lshlrev_b32 v128, 16, v228
  v_mfma_f32_16x16x32_bf16 v[180:183], v[60:63], v[100:103], v[180:183]
  v_and_b32 v129, 0xffff0000, v228
  v_mfma_f32_16x16x32_bf16 v[184:187], v[56:59], v[104:107], v[184:187]
  v_lshlrev_b32 v130, 16, v229
  v_mfma_f32_16x16x32_bf16 v[184:187], v[60:63], v[108:111], v[184:187]
  v_and_b32 v131, 0xffff0000, v229
  v_mfma_f32_16x16x32_bf16 v[200:203], v[64:67], v[104:107], v[200:203]
  v_mov_b32 v239, 0x21800000
  v_mfma_f32_16x16x32_bf16 v[200:203], v[68:71], v[108:111], v[200:203]
  v_mov_b32 v238, 0x30800000
  v_mfma_f32_16x16x32_bf16 v[196:199], v[64:67], v[96:99], v[196:199]
  v_max3_f32 v239, v239, abs(v112), abs(v113)
  v_mfma_f32_16x16x32_bf16 v[196:199], v[68:71], v[100:103], v[196:199]
  v_max3_f32 v239, v239, abs(v114), abs(v115)
  v_mfma_f32_16x16x32_bf16 v[192:195], v[64:67], v[88:91], v[192:195]
  v_max3_f32 v239, v239, abs(v116), abs(v117)
  v_mfma_f32_16x16x32_bf16 v[192:195], v[68:71], v[92:95], v[192:195]
  v_max3_f32 v239, v239, abs(v118), abs(v119)
  v_mfma_f32_16x16x32_bf16 v[188:191], v[64:67], v[80:83], v[188:191]
  v_max3_f32 v239, v239, abs(v120), abs(v121)
  v_mfma_f32_16x16x32_bf16 v[188:191], v[68:71], v[84:87], v[188:191]
  v_max3_f32 v239, v239, abs(v122), abs(v123)
  v_mfma_f32_16x16x32_bf16 v[204:207], v[72:75], v[80:83], v[204:207]
  v_max3_f32 v239, v239, abs(v124), abs(v125)
  v_mfma_f32_16x16x32_bf16 v[204:207], v[76:79], v[84:87], v[204:207]
  v_max3_f32 v239, v239, abs(v126), abs(v127)
  v_mfma_f32_16x16x32_bf16 v[208:211], v[72:75], v[88:91], v[208:211]
  v_max3_f32 v239, v239, abs(v128), abs(v129)
  v_mfma_f32_16x16x32_bf16 v[208:211], v[76:79], v[92:95], v[208:211]
  v_max3_f32 v239, v239, abs(v130), abs(v131)
  v_mfma_f32_16x16x32_bf16 v[212:215], v[72:75], v[96:99], v[212:215]
  v_and_b32 v239, 0x7f800000, v239
  v_mfma_f32_16x16x32_bf16 v[212:215], v[76:79], v[100:103], v[212:215]
  v_mul_f32 v239, 0x22000000, v239
  v_mfma_f32_16x16x32_bf16 v[216:219], v[72:75], v[104:107], v[216:219]
  s_setprio 2
  s_barrier
  v_mfma_f32_16x16x32_bf16 v[216:219], v[76:79], v[108:111], v[216:219]
  ds_read_b64_tr_b16 v[40:41], v6 offset:20480
  s_add_u32 m0, s75, 40960
  s_nop 0
  buffer_load_dwordx4 v29, s[44:47], s74 offen offset:0 lds
  ds_read_b64_tr_b16 v[42:43], v6 offset:23040
  ds_read_b64_tr_b16 v[44:45], v6 offset:40960
  ds_read_b64_tr_b16 v[46:47], v6 offset:43520
  ds_read_b64_tr_b16 v[48:49], v7 offset:20480
  buffer_load_dwordx4 v30, s[44:47], s74 offen offset:1024 lds
  ds_read_b64_tr_b16 v[50:51], v7 offset:23040
  ds_read_b64_tr_b16 v[52:53], v7 offset:40960
  ds_read_b64_tr_b16 v[54:55], v7 offset:43520
  ds_read_b64_tr_b16 v[56:57], v8 offset:20480
  buffer_load_dwordx4 v31, s[44:47], s74 offen offset:2048 lds
  ds_read_b64_tr_b16 v[58:59], v8 offset:23040
  ds_read_b64_tr_b16 v[60:61], v8 offset:40960
  ds_read_b64_tr_b16 v[62:63], v8 offset:43520
  ds_read_b64_tr_b16 v[64:65], v9 offset:20480
  buffer_load_dwordx4 v32, s[44:47], s74 offen offset:3072 lds
  ds_read_b64_tr_b16 v[66:67], v9 offset:23040
  ds_read_b64_tr_b16 v[68:69], v9 offset:40960
  ds_read_b64_tr_b16 v[70:71], v9 offset:43520
  ds_read_b128 v[80:83], v11 offset:8192
  s_add_u32 m0, m0, 4096
  s_nop 0
  buffer_load_dwordx4 v33, s[44:47], s74 offen offset:0 lds
  s_add_u32 s74, s74, 212992
  ds_read_b128 v[84:87], v12 offset:8192
  ds_read_b128 v[88:91], v11 offset:10240
  ds_read_b128 v[92:95], v12 offset:10240
  ds_read_b128 v[96:99], v11 offset:12288
  v_lshl_add_u32 v34, v242, 7, v15
  v_lshl_add_u32 v28, v26, 7, v14
  s_add_u32 m0, s76, 0
  s_nop 0
  buffer_load_dwordx4 v28, s[32:35], 0 offen lds
  ds_read_b128 v[100:103], v12 offset:12288
  ds_read_b128 v[104:107], v11 offset:14336
  ds_read_b128 v[108:111], v12 offset:14336
  ds_read_b64_tr_b16 v[72:73], v10 offset:20480
  s_add_u32 m0, m0, 1024
  s_nop 0
  buffer_load_dwordx4 v34, s[32:35], 0 offen lds
  ds_read_b64_tr_b16 v[74:75], v10 offset:23040
  ds_read_b64_tr_b16 v[76:77], v10 offset:40960
  ds_read_b64_tr_b16 v[78:79], v10 offset:43520
  s_waitcnt vmcnt(7) lgkmcnt(0)
  s_barrier
  s_setprio 0
  v_mfma_f32_16x16x32_bf16 v[140:143], v[40:43], v[80:83], v[140:143]
  v_rcp_f32 v112, v112
  v_mfma_f32_16x16x32_bf16 v[140:143], v[44:47], v[84:87], v[140:143]
  v_rcp_f32 v113, v113
  v_mfma_f32_16x16x32_bf16 v[144:147], v[40:43], v[88:91], v[144:147]
  v_rcp_f32 v114, v114
  v_mfma_f32_16x16x32_bf16 v[144:147], v[44:47], v[92:95], v[144:147]
  v_rcp_f32 v115, v115
  v_mfma_f32_16x16x32_bf16 v[148:151], v[40:43], v[96:99], v[148:151]
  v_mfma_f32_16x16x32_bf16 v[148:151], v[44:47], v[100:103], v[148:151]
  v_rcp_f32 v116, v116
  v_mfma_f32_16x16x32_bf16 v[152:155], v[40:43], v[104:107], v[152:155]
  v_rcp_f32 v117, v117
  v_mfma_f32_16x16x32_bf16 v[152:155], v[44:47], v[108:111], v[152:155]
  v_rcp_f32 v118, v118
  v_mfma_f32_16x16x32_bf16 v[168:171], v[48:51], v[104:107], v[168:171]
  v_rcp_f32 v119, v119
  v_mfma_f32_16x16x32_bf16 v[168:171], v[52:55], v[108:111], v[168:171]
  v_mfma_f32_16x16x32_bf16 v[164:167], v[48:51], v[96:99], v[164:167]
  v_rcp_f32 v120, v120
  v_mfma_f32_16x16x32_bf16 v[164:167], v[52:55], v[100:103], v[164:167]
  v_rcp_f32 v121, v121
  v_mfma_f32_16x16x32_bf16 v[160:163], v[48:51], v[88:91], v[160:163]
  v_rcp_f32 v122, v122
  v_mfma_f32_16x16x32_bf16 v[160:163], v[52:55], v[92:95], v[160:163]
  v_rcp_f32 v123, v123
  v_mfma_f32_16x16x32_bf16 v[156:159], v[48:51], v[80:83], v[156:159]
  v_mfma_f32_16x16x32_bf16 v[156:159], v[52:55], v[84:87], v[156:159]
  v_rcp_f32 v124, v124
  v_mfma_f32_16x16x32_bf16 v[172:175], v[56:59], v[80:83], v[172:175]
  v_rcp_f32 v125, v125
  v_mfma_f32_16x16x32_bf16 v[172:175], v[60:63], v[84:87], v[172:175]
  v_rcp_f32 v126, v126
  v_mfma_f32_16x16x32_bf16 v[176:179], v[56:59], v[88:91], v[176:179]
  v_mfma_f32_16x16x32_bf16 v[176:179], v[60:63], v[92:95], v[176:179]
  v_rcp_f32 v127, v127
  v_mfma_f32_16x16x32_bf16 v[180:183], v[56:59], v[96:99], v[180:183]
  v_rcp_f32 v128, v128
  v_mfma_f32_16x16x32_bf16 v[180:183], v[60:63], v[100:103], v[180:183]
  v_rcp_f32 v129, v129
  v_mfma_f32_16x16x32_bf16 v[184:187], v[56:59], v[104:107], v[184:187]
  v_rcp_f32 v130, v130
  v_mfma_f32_16x16x32_bf16 v[184:187], v[60:63], v[108:111], v[184:187]
  v_mfma_f32_16x16x32_bf16 v[200:203], v[64:67], v[104:107], v[200:203]
  v_rcp_f32 v131, v131
  v_mfma_f32_16x16x32_bf16 v[200:203], v[68:71], v[108:111], v[200:203]
  v_mul_f32 v112, v239, v112
  v_mul_f32 v113, v239, v113
  v_mfma_f32_16x16x32_bf16 v[196:199], v[64:67], v[96:99], v[196:199]
  v_mul_f32 v114, v239, v114
  v_mfma_f32_16x16x32_bf16 v[196:199], v[68:71], v[100:103], v[196:199]
  v_mul_f32 v115, v239, v115
  v_mul_f32 v116, v239, v116
  v_mfma_f32_16x16x32_bf16 v[192:195], v[64:67], v[88:91], v[192:195]
  v_mul_f32 v117, v239, v117
  v_mfma_f32_16x16x32_bf16 v[192:195], v[68:71], v[92:95], v[192:195]
  v_mul_f32 v118, v239, v118
  v_mul_f32 v119, v239, v119
  v_mfma_f32_16x16x32_bf16 v[188:191], v[64:67], v[80:83], v[188:191]
  v_mul_f32 v120, v239, v120
  v_mfma_f32_16x16x32_bf16 v[188:191], v[68:71], v[84:87], v[188:191]
  v_mul_f32 v121, v239, v121
  v_mul_f32 v122, v239, v122
  v_mfma_f32_16x16x32_bf16 v[204:207], v[72:75], v[80:83], v[204:207]
  v_mul_f32 v123, v239, v123
  v_mul_f32 v124, v239, v124
  v_mfma_f32_16x16x32_bf16 v[204:207], v[76:79], v[84:87], v[204:207]
  v_mul_f32 v125, v239, v125
  v_mfma_f32_16x16x32_bf16 v[208:211], v[72:75], v[88:91], v[208:211]
  v_mul_f32 v126, v239, v126
  v_mul_f32 v127, v239, v127
  v_mfma_f32_16x16x32_bf16 v[208:211], v[76:79], v[92:95], v[208:211]
  v_mul_f32 v128, v239, v128
  v_mfma_f32_16x16x32_bf16 v[212:215], v[72:75], v[96:99], v[212:215]
  v_mul_f32 v129, v239, v129
  v_mul_f32 v130, v239, v130
  v_mfma_f32_16x16x32_bf16 v[212:215], v[76:79], v[100:103], v[212:215]
  v_mul_f32 v131, v239, v131
  v_mfma_f32_16x16x32_bf16 v[216:219], v[72:75], v[104:107], v[216:219]
  s_setprio 2
  s_barrier
  v_mfma_f32_16x16x32_bf16 v[216:219], v[76:79], v[108:111], v[216:219]
  ds_read_b64_tr_b16 v[40:41], v1 offset:0
  v_lshl_add_u32 v34, v20, 7, v15
  v_lshl_add_u32 v28, v16, 7, v14
  s_add_u32 m0, s76, 8192
  s_nop 0
  buffer_load_dwordx4 v28, s[32:35], 0 offen lds
  ds_read_b64_tr_b16 v[42:43], v1 offset:2560
  ds_read_b64_tr_b16 v[44:45], v1 offset:20480
  ds_read_b64_tr_b16 v[46:47], v1 offset:23040
  ds_read_b64_tr_b16 v[48:49], v2 offset:0
  ds_read_b64_tr_b16 v[50:51], v2 offset:2560
  ds_read_b64_tr_b16 v[52:53], v2 offset:20480
  ds_read_b64_tr_b16 v[54:55], v2 offset:23040
  ds_read_b64_tr_b16 v[56:57], v3 offset:0
  ds_read_b64_tr_b16 v[58:59], v3 offset:2560
  ds_read_b64_tr_b16 v[60:61], v3 offset:20480
  ds_read_b64_tr_b16 v[62:63], v3 offset:23040
  ds_read_b64_tr_b16 v[64:65], v4 offset:0
  ds_read_b64_tr_b16 v[66:67], v4 offset:2560
  ds_read_b64_tr_b16 v[68:69], v4 offset:20480
  s_add_u32 m0, m0, 1024
  s_nop 0
  buffer_load_dwordx4 v34, s[32:35], 0 offen lds
  ds_read_b64_tr_b16 v[70:71], v4 offset:23040
  ds_read_b128 v[80:83], v11 offset:0
  ds_read_b128 v[84:87], v12 offset:0
  ds_read_b128 v[88:91], v11 offset:2048
  ds_read_b128 v[92:95], v12 offset:2048
  ds_read_b128 v[96:99], v11 offset:4096
  ds_read_b128 v[100:103], v12 offset:4096
  ds_read_b128 v[104:107], v11 offset:6144
  ds_read_b128 v[108:111], v12 offset:6144
  ds_read_b64_tr_b16 v[72:73], v5 offset:0
  ds_read_b64_tr_b16 v[74:75], v5 offset:2560
  ds_read_b64_tr_b16 v[76:77], v5 offset:20480
  ds_read_b64_tr_b16 v[78:79], v5 offset:23040
  s_mov_b32 s60, s24
  s_and_b32 s61, s25, 0xffff
  s_mov_b32 s62, 268435456
  s_mov_b32 s63, 0x20000
  s_mov_b32 s64, s22
  s_and_b32 s65, s23, 0xffff
  s_mov_b32 s66, 256
  s_mov_b32 s67, 0x20000
  v_lshlrev_b32 v28, 2, v0
  s_mov_b64 exec, 0xff
  s_mov_b32 s81, 0x80000
  buffer_load_dword v255, v28, s[60:63], s81 offen
  buffer_load_dword v37, v28, s[64:67], 0 offen offset:128 sc1
  s_mov_b64 exec, -1
  v_mov_b32 v28, 0
  s_waitcnt vmcnt(4) lgkmcnt(0)
  s_barrier
  s_setprio 0
  v_mfma_f32_16x16x32_bf16 v[140:143], v[40:43], v[80:83], v[140:143]
  v_med3_f32 v112, v112, -v238, v238
  v_med3_f32 v113, v113, -v238, v238
  v_mfma_f32_16x16x32_bf16 v[140:143], v[44:47], v[84:87], v[140:143]
  v_med3_f32 v114, v114, -v238, v238
  v_mfma_f32_16x16x32_bf16 v[144:147], v[40:43], v[88:91], v[144:147]
  v_med3_f32 v115, v115, -v238, v238
  v_mfma_f32_16x16x32_bf16 v[144:147], v[44:47], v[92:95], v[144:147]
  v_med3_f32 v116, v116, -v238, v238
  v_mfma_f32_16x16x32_bf16 v[148:151], v[40:43], v[96:99], v[148:151]
  v_med3_f32 v117, v117, -v238, v238
  v_mfma_f32_16x16x32_bf16 v[148:151], v[44:47], v[100:103], v[148:151]
  v_med3_f32 v118, v118, -v238, v238
  v_mfma_f32_16x16x32_bf16 v[152:155], v[40:43], v[104:107], v[152:155]
  v_med3_f32 v119, v119, -v238, v238
  v_mfma_f32_16x16x32_bf16 v[152:155], v[44:47], v[108:111], v[152:155]
  v_med3_f32 v120, v120, -v238, v238
  v_mfma_f32_16x16x32_bf16 v[168:171], v[48:51], v[104:107], v[168:171]
  v_med3_f32 v121, v121, -v238, v238
  v_mfma_f32_16x16x32_bf16 v[168:171], v[52:55], v[108:111], v[168:171]
  v_med3_f32 v122, v122, -v238, v238
  v_mfma_f32_16x16x32_bf16 v[164:167], v[48:51], v[96:99], v[164:167]
  v_med3_f32 v123, v123, -v238, v238
  v_mfma_f32_16x16x32_bf16 v[164:167], v[52:55], v[100:103], v[164:167]
  v_med3_f32 v124, v124, -v238, v238
  v_mfma_f32_16x16x32_bf16 v[160:163], v[48:51], v[88:91], v[160:163]
  v_med3_f32 v125, v125, -v238, v238
  v_mfma_f32_16x16x32_bf16 v[160:163], v[52:55], v[92:95], v[160:163]
  v_med3_f32 v126, v126, -v238, v238
  v_mfma_f32_16x16x32_bf16 v[156:159], v[48:51], v[80:83], v[156:159]
  v_med3_f32 v127, v127, -v238, v238
  v_mfma_f32_16x16x32_bf16 v[156:159], v[52:55], v[84:87], v[156:159]
  v_med3_f32 v128, v128, -v238, v238
  v_mfma_f32_16x16x32_bf16 v[172:175], v[56:59], v[80:83], v[172:175]
  v_med3_f32 v129, v129, -v238, v238
  v_mfma_f32_16x16x32_bf16 v[172:175], v[60:63], v[84:87], v[172:175]
  v_med3_f32 v130, v130, -v238, v238
  v_mfma_f32_16x16x32_bf16 v[176:179], v[56:59], v[88:91], v[176:179]
  v_med3_f32 v131, v131, -v238, v238
  v_mfma_f32_16x16x32_bf16 v[176:179], v[60:63], v[92:95], v[176:179]
  v_mul_f32 v132, 0x6c800000, v112
  v_mul_f32 v133, 0x6c800000, v113
  v_mfma_f32_16x16x32_bf16 v[180:183], v[56:59], v[96:99], v[180:183]
  v_mul_f32 v134, 0x6c800000, v114
  v_mfma_f32_16x16x32_bf16 v[180:183], v[60:63], v[100:103], v[180:183]
  v_mul_f32 v135, 0x6c800000, v115
  v_mfma_f32_16x16x32_bf16 v[184:187], v[56:59], v[104:107], v[184:187]
  v_mul_f32 v136, 0x6c800000, v116
  v_mfma_f32_16x16x32_bf16 v[184:187], v[60:63], v[108:111], v[184:187]
  v_mul_f32 v137, 0x6c800000, v117
  v_mfma_f32_16x16x32_bf16 v[200:203], v[64:67], v[104:107], v[200:203]
  v_mul_f32 v138, 0x6c800000, v118
  v_mfma_f32_16x16x32_bf16 v[200:203], v[68:71], v[108:111], v[200:203]
  v_mul_f32 v139, 0x6c800000, v119
  v_mfma_f32_16x16x32_bf16 v[196:199], v[64:67], v[96:99], v[196:199]
  v_mul_f32 v220, 0x6c800000, v120
  v_mfma_f32_16x16x32_bf16 v[196:199], v[68:71], v[100:103], v[196:199]
  v_mul_f32 v221, 0x6c800000, v121
  v_mfma_f32_16x16x32_bf16 v[192:195], v[64:67], v[88:91], v[192:195]
  v_mul_f32 v222, 0x6c800000, v122
  v_mfma_f32_16x16x32_bf16 v[192:195], v[68:71], v[92:95], v[192:195]
  v_mul_f32 v223, 0x6c800000, v123
  v_mfma_f32_16x16x32_bf16 v[188:191], v[64:67], v[80:83], v[188:191]
  v_mul_f32 v224, 0x6c800000, v124
  v_mfma_f32_16x16x32_bf16 v[188:191], v[68:71], v[84:87], v[188:191]
  v_mul_f32 v225, 0x6c800000, v125
  v_mfma_f32_16x16x32_bf16 v[204:207], v[72:75], v[80:83], v[204:207]
  v_mul_f32 v226, 0x6c800000, v126
  v_mfma_f32_16x16x32_bf16 v[204:207], v[76:79], v[84:87], v[204:207]
  v_mul_f32 v227, 0x6c800000, v127
  v_mfma_f32_16x16x32_bf16 v[208:211], v[72:75], v[88:91], v[208:211]
  v_mul_f32 v228, 0x6c800000, v128
  v_mfma_f32_16x16x32_bf16 v[208:211], v[76:79], v[92:95], v[208:211]
  v_mul_f32 v229, 0x6c800000, v129
  v_mfma_f32_16x16x32_bf16 v[212:215], v[72:75], v[96:99], v[212:215]
  v_mul_f32 v230, 0x6c800000, v130
  v_mfma_f32_16x16x32_bf16 v[212:215], v[76:79], v[100:103], v[212:215]
  v_mul_f32 v231, 0x6c800000, v131
  v_mfma_f32_16x16x32_bf16 v[216:219], v[72:75], v[104:107], v[216:219]
  s_setprio 2
  s_barrier
  v_mfma_f32_16x16x32_bf16 v[216:219], v[76:79], v[108:111], v[216:219]
  ds_read_b64_tr_b16 v[40:41], v1 offset:40960
  ds_read_b64_tr_b16 v[42:43], v1 offset:43520
  ds_read_b64_tr_b16 v[44:45], v6 offset:0
  ds_read_b64_tr_b16 v[46:47], v6 offset:2560
  ds_read_b64_tr_b16 v[48:49], v2 offset:40960
  ds_read_b64_tr_b16 v[50:51], v2 offset:43520
  ds_read_b64_tr_b16 v[52:53], v7 offset:0
  ds_read_b64_tr_b16 v[54:55], v7 offset:2560
  ds_read_b64_tr_b16 v[56:57], v3 offset:40960
  ds_read_b64_tr_b16 v[58:59], v3 offset:43520
  ds_read_b64_tr_b16 v[60:61], v8 offset:0
  ds_read_b64_tr_b16 v[62:63], v8 offset:2560
  ds_read_b64_tr_b16 v[64:65], v4 offset:40960
  ds_read_b64_tr_b16 v[66:67], v4 offset:43520
  ds_read_b64_tr_b16 v[68:69], v9 offset:0
  ds_read_b64_tr_b16 v[70:71], v9 offset:2560
  ds_read_b128 v[80:83], v11 offset:8192
  ds_read_b128 v[84:87], v12 offset:8192
  ds_read_b128 v[88:91], v11 offset:10240
  ds_read_b128 v[92:95], v12 offset:10240
  ds_read_b128 v[96:99], v11 offset:12288
  ds_read_b128 v[100:103], v12 offset:12288
  ds_read_b128 v[104:107], v11 offset:14336
  ds_read_b128 v[108:111], v12 offset:14336
  ds_read_b64_tr_b16 v[72:73], v5 offset:40960
  ds_read_b64_tr_b16 v[74:75], v5 offset:43520
  ds_read_b64_tr_b16 v[76:77], v10 offset:0
  ds_read_b64_tr_b16 v[78:79], v10 offset:2560
  s_waitcnt vmcnt(2) lgkmcnt(0)
  s_barrier
  s_setprio 0
  v_mfma_f32_16x16x32_bf16 v[140:143], v[40:43], v[80:83], v[140:143]
  v_mfma_f32_16x16x32_bf16 v[140:143], v[44:47], v[84:87], v[140:143]
  v_mfma_f32_16x16x32_bf16 v[144:147], v[40:43], v[88:91], v[144:147]
  v_mfma_f32_16x16x32_bf16 v[144:147], v[44:47], v[92:95], v[144:147]
  s_nop 5
  v_mul_f32 v24, v140, v140
  v_mul_f32 v25, v141, v141
  v_mul_f32 v26, v142, v142
  v_mfma_f32_16x16x32_bf16 v[148:151], v[40:43], v[96:99], v[148:151]
  v_mul_f32 v27, v143, v143
  v_mul_f32 v28, v144, v144
  v_mfma_f32_16x16x32_bf16 v[148:151], v[44:47], v[100:103], v[148:151]
  v_mul_f32 v29, v145, v145
  v_mul_f32 v30, v146, v146
  v_mfma_f32_16x16x32_bf16 v[152:155], v[40:43], v[104:107], v[152:155]
  v_mul_f32 v31, v147, v147
  v_fma_f32 v24, v24, v234, v232
  v_mfma_f32_16x16x32_bf16 v[152:155], v[44:47], v[108:111], v[152:155]
  v_fma_f32 v25, v25, v234, v232
  v_fma_f32 v26, v26, v234, v232
  v_mfma_f32_16x16x32_bf16 v[168:171], v[48:51], v[104:107], v[168:171]
  v_fma_f32 v27, v27, v234, v232
  v_fma_f32 v28, v28, v234, v232
  v_mfma_f32_16x16x32_bf16 v[168:171], v[52:55], v[108:111], v[168:171]
  v_fma_f32 v29, v29, v234, v232
  v_fma_f32 v30, v30, v234, v232
  v_mfma_f32_16x16x32_bf16 v[164:167], v[48:51], v[96:99], v[164:167]
  v_fma_f32 v31, v31, v234, v232
  v_fma_f32 v24, v24, v140, v236
  v_mfma_f32_16x16x32_bf16 v[164:167], v[52:55], v[100:103], v[164:167]
  v_fma_f32 v25, v25, v141, v236
  v_fma_f32 v26, v26, v142, v236
  v_mfma_f32_16x16x32_bf16 v[160:163], v[48:51], v[88:91], v[160:163]
  v_fma_f32 v27, v27, v143, v236
  v_fma_f32 v28, v28, v144, v236
  v_mfma_f32_16x16x32_bf16 v[160:163], v[52:55], v[92:95], v[160:163]
  v_fma_f32 v29, v29, v145, v236
  v_fma_f32 v30, v30, v146, v236
  v_mfma_f32_16x16x32_bf16 v[156:159], v[48:51], v[80:83], v[156:159]
  v_fma_f32 v31, v31, v147, v236
  v_exp_f32 v24, v24 clamp
  v_mfma_f32_16x16x32_bf16 v[156:159], v[52:55], v[84:87], v[156:159]
  v_exp_f32 v25, v25 clamp
  v_mfma_f32_16x16x32_bf16 v[172:175], v[56:59], v[80:83], v[172:175]
  v_exp_f32 v26, v26 clamp
  v_mfma_f32_16x16x32_bf16 v[172:175], v[60:63], v[84:87], v[172:175]
  v_exp_f32 v27, v27 clamp
  v_mfma_f32_16x16x32_bf16 v[176:179], v[56:59], v[88:91], v[176:179]
  v_exp_f32 v28, v28 clamp
  v_mfma_f32_16x16x32_bf16 v[176:179], v[60:63], v[92:95], v[176:179]
  v_exp_f32 v29, v29 clamp
  v_mfma_f32_16x16x32_bf16 v[180:183], v[56:59], v[96:99], v[180:183]
  v_exp_f32 v30, v30 clamp
  v_mfma_f32_16x16x32_bf16 v[180:183], v[60:63], v[100:103], v[180:183]
  v_exp_f32 v31, v31 clamp
  v_mfma_f32_16x16x32_bf16 v[184:187], v[56:59], v[104:107], v[184:187]
  v_fma_f32 v24, v24, v132, v112
  v_fma_f32 v25, v25, v133, v113
  v_mfma_f32_16x16x32_bf16 v[184:187], v[60:63], v[108:111], v[184:187]
  v_fma_f32 v26, v26, v134, v114
  v_fma_f32 v27, v27, v135, v115
  v_mfma_f32_16x16x32_bf16 v[200:203], v[64:67], v[104:107], v[200:203]
  v_fma_f32 v28, v28, v132, v112
  v_fma_f32 v29, v29, v133, v113
  v_mfma_f32_16x16x32_bf16 v[200:203], v[68:71], v[108:111], v[200:203]
  v_fma_f32 v30, v30, v134, v114
  v_fma_f32 v31, v31, v135, v115
  v_mfma_f32_16x16x32_bf16 v[196:199], v[64:67], v[96:99], v[196:199]
  v_rcp_f32 v24, v24
  v_mfma_f32_16x16x32_bf16 v[196:199], v[68:71], v[100:103], v[196:199]
  v_rcp_f32 v25, v25
  v_mfma_f32_16x16x32_bf16 v[192:195], v[64:67], v[88:91], v[192:195]
  v_rcp_f32 v26, v26
  v_mfma_f32_16x16x32_bf16 v[192:195], v[68:71], v[92:95], v[192:195]
  v_rcp_f32 v27, v27
  v_mfma_f32_16x16x32_bf16 v[188:191], v[64:67], v[80:83], v[188:191]
  v_rcp_f32 v28, v28
  v_mfma_f32_16x16x32_bf16 v[188:191], v[68:71], v[84:87], v[188:191]
  v_rcp_f32 v29, v29
  v_mfma_f32_16x16x32_bf16 v[204:207], v[72:75], v[80:83], v[204:207]
  v_rcp_f32 v30, v30
  v_mfma_f32_16x16x32_bf16 v[204:207], v[76:79], v[84:87], v[204:207]
  v_rcp_f32 v31, v31
  v_mfma_f32_16x16x32_bf16 v[208:211], v[72:75], v[88:91], v[208:211]
  v_mul_f32 v16, v24, v140
  v_mul_f32 v17, v25, v141
  v_mfma_f32_16x16x32_bf16 v[208:211], v[76:79], v[92:95], v[208:211]
  v_fmac_f32 v16, v26, v142
  v_fmac_f32 v17, v27, v143
  v_mfma_f32_16x16x32_bf16 v[212:215], v[72:75], v[96:99], v[212:215]
  v_mul_f32 v18, v28, v144
  v_mul_f32 v19, v29, v145
  v_mfma_f32_16x16x32_bf16 v[212:215], v[76:79], v[100:103], v[212:215]
  v_fmac_f32 v18, v30, v146
  v_fmac_f32 v19, v31, v147
  v_mfma_f32_16x16x32_bf16 v[216:219], v[72:75], v[104:107], v[216:219]
  s_setprio 2
  s_barrier
  v_mfma_f32_16x16x32_bf16 v[216:219], v[76:79], v[108:111], v[216:219]
  s_setprio 0
  s_branch L_epi
L_dnn_h1:
  v_lshl_add_u32 v34, v49, 7, v15
  v_lshl_add_u32 v28, v45, 7, v14
  s_add_u32 m0, s76, 8192
  s_nop 0
  buffer_load_dwordx4 v28, s[32:35], 0 offen lds
  s_add_u32 m0, m0, 1024
  s_nop 0
  buffer_load_dwordx4 v34, s[32:35], 0 offen lds
  s_add_u32 m0, s75, 40960
  s_nop 0
  buffer_load_dwordx4 v29, s[44:47], s74 offen offset:0 lds
  buffer_load_dwordx4 v30, s[44:47], s74 offen offset:1024 lds
  buffer_load_dwordx4 v31, s[44:47], s74 offen offset:2048 lds
  buffer_load_dwordx4 v32, s[44:47], s74 offen offset:3072 lds
  s_add_u32 m0, m0, 4096
  s_nop 0
  buffer_load_dwordx4 v33, s[44:47], s74 offen offset:0 lds
  s_add_u32 s74, s74, 212992
  s_waitcnt vmcnt(14)
  s_waitcnt vmcnt(10) lgkmcnt(0)
  s_barrier
  buffer_load_dwordx3 v[24:26], v13, s[28:31], s73 offen offset:0
  buffer_load_dwordx3 v[240:242], v13, s[28:31], s73 offen offset:832
  s_add_u32 s73, s73, 12
  s_barrier
L_dnn_loop1:
  ds_read_b64_tr_b16 v[40:41], v1 offset:0
  s_add_u32 m0, s75, 81920
  s_nop 0
  buffer_load_dwordx4 v29, s[44:47], s74 offen offset:0 lds
  ds_read_b64_tr_b16 v[42:43], v1 offset:2560
  ds_read_b64_tr_b16 v[44:45], v1 offset:20480
  ds_read_b64_tr_b16 v[46:47], v1 offset:23040
  ds_read_b64_tr_b16 v[48:49], v2 offset:0
  buffer_load_dwordx4 v30, s[44:47], s74 offen offset:1024 lds
  ds_read_b64_tr_b16 v[50:51], v2 offset:2560
  ds_read_b64_tr_b16 v[52:53], v2 offset:20480
  ds_read_b64_tr_b16 v[54:55], v2 offset:23040
  ds_read_b64_tr_b16 v[56:57], v3 offset:0
  buffer_load_dwordx4 v31, s[44:47], s74 offen offset:2048 lds
  ds_read_b64_tr_b16 v[58:59], v3 offset:2560
  ds_read_b64_tr_b16 v[60:61], v3 offset:20480
  ds_read_b64_tr_b16 v[62:63], v3 offset:23040
  ds_read_b64_tr_b16 v[64:65], v4 offset:0
  buffer_load_dwordx4 v32, s[44:47], s74 offen offset:3072 lds
  ds_read_b64_tr_b16 v[66:67], v4 offset:2560
  ds_read_b64_tr_b16 v[68:69], v4 offset:20480
  ds_read_b64_tr_b16 v[70:71], v4 offset:23040
  ds_read_b128 v[80:83], v11 offset:0
  s_add_u32 m0, m0, 4096
  s_nop 0
  buffer_load_dwordx4 v33, s[44:47], s74 offen offset:0 lds
  s_add_u32 s74, s74, 212992
  ds_read_b128 v[84:87], v12 offset:0
  ds_read_b128 v[88:91], v11 offset:2048
  ds_read_b128 v[92:95], v12 offset:2048
  ds_read_b128 v[96:99], v11 offset:4096
  s_waitcnt vmcnt(14)
  v_lshl_add_u32 v34, v20, 7, v15
  v_lshl_add_u32 v28, v16, 7, v14
  s_add_u32 m0, s76, 0
  s_nop 0
  buffer_load_dwordx4 v28, s[32:35], 0 offen lds
  ds_read_b128 v[100:103], v12 offset:4096
  ds_read_b128 v[104:107], v11 offset:6144
  ds_read_b128 v[108:111], v12 offset:6144
  ds_read_b64_tr_b16 v[72:73], v5 offset:0
  s_add_u32 m0, m0, 1024
  s_nop 0
  buffer_load_dwordx4 v34, s[32:35], 0 offen lds
  ds_read_b64_tr_b16 v[74:75], v5 offset:2560
  ds_read_b64_tr_b16 v[76:77], v5 offset:20480
  ds_read_b64_tr_b16 v[78:79], v5 offset:23040
L_dnn_in1:
  s_waitcnt vmcnt(9) lgkmcnt(0)
  s_waitcnt vmcnt(9)
  s_barrier
  s_setprio 0
  v_mfma_f32_16x16x32_bf16 v[140:143], v[40:43], v[80:83], v[140:143]
  v_mfma_f32_16x16x32_bf16 v[140:143], v[44:47], v[84:87], v[140:143]
  v_mfma_f32_16x16x32_bf16 v[144:147], v[40:43], v[88:91], v[144:147]
  v_mfma_f32_16x16x32_bf16 v[144:147], v[44:47], v[92:95], v[144:147]
  v_mfma_f32_16x16x32_bf16 v[148:151], v[40:43], v[96:99], v[148:151]
  v_mfma_f32_16x16x32_bf16 v[148:151], v[44:47], v[100:103], v[148:151]
  v_mfma_f32_16x16x32_bf16 v[152:155], v[40:43], v[104:107], v[152:155]
  v_mfma_f32_16x16x32_bf16 v[152:155], v[44:47], v[108:111], v[152:155]
  v_mfma_f32_16x16x32_bf16 v[168:171], v[48:51], v[104:107], v[168:171]
  v_mfma_f32_16x16x32_bf16 v[168:171], v[52:55], v[108:111], v[168:171]
  v_mfma_f32_16x16x32_bf16 v[164:167], v[48:51], v[96:99], v[164:167]
  v_mfma_f32_16x16x32_bf16 v[164:167], v[52:55], v[100:103], v[164:167]
  v_mfma_f32_16x16x32_bf16 v[160:163], v[48:51], v[88:91], v[160:163]
  v_mfma_f32_16x16x32_bf16 v[160:163], v[52:55], v[92:95], v[160:163]
  v_mfma_f32_16x16x32_bf16 v[156:159], v[48:51], v[80:83], v[156:159]
  v_mfma_f32_16x16x32_bf16 v[156:159], v[52:55], v[84:87], v[156:159]
  v_mfma_f32_16x16x32_bf16 v[172:175], v[56:59], v[80:83], v[172:175]
  v_mfma_f32_16x16x32_bf16 v[172:175], v[60:63], v[84:87], v[172:175]
  v_mfma_f32_16x16x32_bf16 v[176:179], v[56:59], v[88:91], v[176:179]
  v_mfma_f32_16x16x32_bf16 v[176:179], v[60:63], v[92:95], v[176:179]
  v_mfma_f32_16x16x32_bf16 v[180:183], v[56:59], v[96:99], v[180:183]
  v_mfma_f32_16x16x32_bf16 v[180:183], v[60:63], v[100:103], v[180:183]
  v_mfma_f32_16x16x32_bf16 v[184:187], v[56:59], v[104:107], v[184:187]
  v_mfma_f32_16x16x32_bf16 v[184:187], v[60:63], v[108:111], v[184:187]
  v_mfma_f32_16x16x32_bf16 v[200:203], v[64:67], v[104:107], v[200:203]
  v_mfma_f32_16x16x32_bf16 v[200:203], v[68:71], v[108:111], v[200:203]
  v_mfma_f32_16x16x32_bf16 v[196:199], v[64:67], v[96:99], v[196:199]
  v_mfma_f32_16x16x32_bf16 v[196:199], v[68:71], v[100:103], v[196:199]
  v_mfma_f32_16x16x32_bf16 v[192:195], v[64:67], v[88:91], v[192:195]
  v_mfma_f32_16x16x32_bf16 v[192:195], v[68:71], v[92:95], v[192:195]
  v_mfma_f32_16x16x32_bf16 v[188:191], v[64:67], v[80:83], v[188:191]
  v_mfma_f32_16x16x32_bf16 v[188:191], v[68:71], v[84:87], v[188:191]
  v_mfma_f32_16x16x32_bf16 v[204:207], v[72:75], v[80:83], v[204:207]
  v_mfma_f32_16x16x32_bf16 v[204:207], v[76:79], v[84:87], v[204:207]
  v_mfma_f32_16x16x32_bf16 v[208:211], v[72:75], v[88:91], v[208:211]
  v_mfma_f32_16x16x32_bf16 v[208:211], v[76:79], v[92:95], v[208:211]
  v_mfma_f32_16x16x32_bf16 v[212:215], v[72:75], v[96:99], v[212:215]
  v_mfma_f32_16x16x32_bf16 v[212:215], v[76:79], v[100:103], v[212:215]
  v_mfma_f32_16x16x32_bf16 v[216:219], v[72:75], v[104:107], v[216:219]
  s_setprio 2
  s_barrier
  v_mfma_f32_16x16x32_bf16 v[216:219], v[76:79], v[108:111], v[216:219]
  ds_read_b64_tr_b16 v[40:41], v1 offset:40960
  s_add_u32 m0, s75, 0
  s_nop 0
  buffer_load_dwordx4 v29, s[44:47], s74 offen offset:0 lds
  ds_read_b64_tr_b16 v[42:43], v1 offset:43520
  ds_read_b64_tr_b16 v[44:45], v6 offset:0
  ds_read_b64_tr_b16 v[46:47], v6 offset:2560
  ds_read_b64_tr_b16 v[48:49], v2 offset:40960
  buffer_load_dwordx4 v30, s[44:47], s74 offen offset:1024 lds
  ds_read_b64_tr_b16 v[50:51], v2 offset:43520
  ds_read_b64_tr_b16 v[52:53], v7 offset:0
  ds_read_b64_tr_b16 v[54:55], v7 offset:2560
  ds_read_b64_tr_b16 v[56:57], v3 offset:40960
  buffer_load_dwordx4 v31, s[44:47], s74 offen offset:2048 lds
  ds_read_b64_tr_b16 v[58:59], v3 offset:43520
  ds_read_b64_tr_b16 v[60:61], v8 offset:0
  ds_read_b64_tr_b16 v[62:63], v8 offset:2560
  ds_read_b64_tr_b16 v[64:65], v4 offset:40960
  buffer_load_dwordx4 v32, s[44:47], s74 offen offset:3072 lds
  ds_read_b64_tr_b16 v[66:67], v4 offset:43520
  ds_read_b64_tr_b16 v[68:69], v9 offset:0
  ds_read_b64_tr_b16 v[70:71], v9 offset:2560
  ds_read_b128 v[80:83], v11 offset:8192
  s_add_u32 m0, m0, 4096
  s_nop 0
  buffer_load_dwordx4 v33, s[44:47], s74 offen offset:0 lds
  s_add_u32 s74, s74, 212992
  ds_read_b128 v[84:87], v12 offset:8192
  ds_read_b128 v[88:91], v11 offset:10240
  ds_read_b128 v[92:95], v12 offset:10240
  ds_read_b128 v[96:99], v11 offset:12288
  v_lshl_add_u32 v34, v21, 7, v15
  v_lshl_add_u32 v28, v17, 7, v14
  s_add_u32 m0, s76, 8192
  s_nop 0
  buffer_load_dwordx4 v28, s[32:35], 0 offen lds
  ds_read_b128 v[100:103], v12 offset:12288
  ds_read_b128 v[104:107], v11 offset:14336
  ds_read_b128 v[108:111], v12 offset:14336
  ds_read_b64_tr_b16 v[72:73], v5 offset:40960
  s_add_u32 m0, m0, 1024
  s_nop 0
  buffer_load_dwordx4 v34, s[32:35], 0 offen lds
  ds_read_b64_tr_b16 v[74:75], v5 offset:43520
  ds_read_b64_tr_b16 v[76:77], v10 offset:0
  ds_read_b64_tr_b16 v[78:79], v10 offset:2560
  s_waitcnt vmcnt(7) lgkmcnt(0)
  s_barrier
  s_setprio 0
  v_mfma_f32_16x16x32_bf16 v[140:143], v[40:43], v[80:83], v[140:143]
  v_mfma_f32_16x16x32_bf16 v[140:143], v[44:47], v[84:87], v[140:143]
  v_mfma_f32_16x16x32_bf16 v[144:147], v[40:43], v[88:91], v[144:147]
  v_mfma_f32_16x16x32_bf16 v[144:147], v[44:47], v[92:95], v[144:147]
  v_mfma_f32_16x16x32_bf16 v[148:151], v[40:43], v[96:99], v[148:151]
  v_mfma_f32_16x16x32_bf16 v[148:151], v[44:47], v[100:103], v[148:151]
  v_mfma_f32_16x16x32_bf16 v[152:155], v[40:43], v[104:107], v[152:155]
  v_mfma_f32_16x16x32_bf16 v[152:155], v[44:47], v[108:111], v[152:155]
  v_mfma_f32_16x16x32_bf16 v[168:171], v[48:51], v[104:107], v[168:171]
  v_mfma_f32_16x16x32_bf16 v[168:171], v[52:55], v[108:111], v[168:171]
  v_mfma_f32_16x16x32_bf16 v[164:167], v[48:51], v[96:99], v[164:167]
  v_mfma_f32_16x16x32_bf16 v[164:167], v[52:55], v[100:103], v[164:167]
  v_mfma_f32_16x16x32_bf16 v[160:163], v[48:51], v[88:91], v[160:163]
  v_mfma_f32_16x16x32_bf16 v[160:163], v[52:55], v[92:95], v[160:163]
  v_mfma_f32_16x16x32_bf16 v[156:159], v[48:51], v[80:83], v[156:159]
  v_mfma_f32_16x16x32_bf16 v[156:159], v[52:55], v[84:87], v[156:159]
  v_mfma_f32_16x16x32_bf16 v[172:175], v[56:59], v[80:83], v[172:175]
  v_mfma_f32_16x16x32_bf16 v[172:175], v[60:63], v[84:87], v[172:175]
  v_mfma_f32_16x16x32_bf16 v[176:179], v[56:59], v[88:91], v[176:179]
  v_mfma_f32_16x16x32_bf16 v[176:179], v[60:63], v[92:95], v[176:179]
  v_mfma_f32_16x16x32_bf16 v[180:183], v[56:59], v[96:99], v[180:183]
  v_mfma_f32_16x16x32_bf16 v[180:183], v[60:63], v[100:103], v[180:183]
  v_mfma_f32_16x16x32_bf16 v[184:187], v[56:59], v[104:107], v[184:187]
  v_mfma_f32_16x16x32_bf16 v[184:187], v[60:63], v[108:111], v[184:187]
  v_mfma_f32_16x16x32_bf16 v[200:203], v[64:67], v[104:107], v[200:203]
  v_mfma_f32_16x16x32_bf16 v[200:203], v[68:71], v[108:111], v[200:203]
  v_mfma_f32_16x16x32_bf16 v[196:199], v[64:67], v[96:99], v[196:199]
  v_mfma_f32_16x16x32_bf16 v[196:199], v[68:71], v[100:103], v[196:199]
  v_mfma_f32_16x16x32_bf16 v[192:195], v[64:67], v[88:91], v[192:195]
  v_mfma_f32_16x16x32_bf16 v[192:195], v[68:71], v[92:95], v[192:195]
  v_mfma_f32_16x16x32_bf16 v[188:191], v[64:67], v[80:83], v[188:191]
  v_mfma_f32_16x16x32_bf16 v[188:191], v[68:71], v[84:87], v[188:191]
  v_mfma_f32_16x16x32_bf16 v[204:207], v[72:75], v[80:83], v[204:207]
  v_mfma_f32_16x16x32_bf16 v[204:207], v[76:79], v[84:87], v[204:207]
  v_mfma_f32_16x16x32_bf16 v[208:211], v[72:75], v[88:91], v[208:211]
  v_mfma_f32_16x16x32_bf16 v[208:211], v[76:79], v[92:95], v[208:211]
  v_mfma_f32_16x16x32_bf16 v[212:215], v[72:75], v[96:99], v[212:215]
  v_mfma_f32_16x16x32_bf16 v[212:215], v[76:79], v[100:103], v[212:215]
  v_mfma_f32_16x16x32_bf16 v[216:219], v[72:75], v[104:107], v[216:219]
  s_setprio 2
  s_barrier
  v_mfma_f32_16x16x32_bf16 v[216:219], v[76:79], v[108:111], v[216:219]
  ds_read_b64_tr_b16 v[40:41], v6 offset:20480
  s_add_u32 m0, s75, 40960
  s_nop 0
  buffer_load_dwordx4 v29, s[44:47], s74 offen offset:0 lds
  ds_read_b64_tr_b16 v[42:43], v6 offset:23040
  ds_read_b64_tr_b16 v[44:45], v6 offset:40960
  ds_read_b64_tr_b16 v[46:47], v6 offset:43520
  ds_read_b64_tr_b16 v[48:49], v7 offset:20480
  buffer_load_dwordx4 v30, s[44:47], s74 offen offset:1024 lds
  ds_read_b64_tr_b16 v[50:51], v7 offset:23040
  ds_read_b64_tr_b16 v[52:53], v7 offset:40960
  ds_read_b64_tr_b16 v[54:55], v7 offset:43520
  ds_read_b64_tr_b16 v[56:57], v8 offset:20480
  buffer_load_dwordx4 v31, s[44:47], s74 offen offset:2048 lds
  ds_read_b64_tr_b16 v[58:59], v8 offset:23040
  ds_read_b64_tr_b16 v[60:61], v8 offset:40960
  ds_read_b64_tr_b16 v[62:63], v8 offset:43520
  ds_read_b64_tr_b16 v[64:65], v9 offset:20480
  buffer_load_dwordx4 v32, s[44:47], s74 offen offset:3072 lds
  ds_read_b64_tr_b16 v[66:67], v9 offset:23040
  ds_read_b64_tr_b16 v[68:69], v9 offset:40960
  ds_read_b64_tr_b16 v[70:71], v9 offset:43520
  ds_read_b128 v[80:83], v11 offset:0
  s_add_u32 m0, m0, 4096
  s_nop 0
  buffer_load_dwordx4 v33, s[44:47], s74 offen offset:0 lds
  s_add_u32 s74, s74, 212992
  ds_read_b128 v[84:87], v12 offset:0
  ds_read_b128 v[88:91], v11 offset:2048
  ds_read_b128 v[92:95], v12 offset:2048
  ds_read_b128 v[96:99], v11 offset:4096
  v_lshl_add_u32 v34, v22, 7, v15
  v_lshl_add_u32 v28, v18, 7, v14
  s_add_u32 m0, s76, 0
  s_nop 0
  buffer_load_dwordx4 v28, s[32:35], 0 offen lds
  ds_read_b128 v[100:103], v12 offset:4096
  ds_read_b128 v[104:107], v11 offset:6144
  ds_read_b128 v[108:111], v12 offset:6144
  ds_read_b64_tr_b16 v[72:73], v10 offset:20480
  s_add_u32 m0, m0, 1024
  s_nop 0
  buffer_load_dwordx4 v34, s[32:35], 0 offen lds
  ds_read_b64_tr_b16 v[74:75], v10 offset:23040
  ds_read_b64_tr_b16 v[76:77], v10 offset:40960
  ds_read_b64_tr_b16 v[78:79], v10 offset:43520
  buffer_load_dwordx3 v[16:18], v13, s[28:31], s73 offen offset:0
  buffer_load_dwordx3 v[20:22], v13, s[28:31], s73 offen offset:832
  s_add_u32 s73, s73, 12
  s_waitcnt vmcnt(9) lgkmcnt(0)
  s_barrier
  s_setprio 0
  v_mfma_f32_16x16x32_bf16 v[140:143], v[40:43], v[80:83], v[140:143]
  v_mfma_f32_16x16x32_bf16 v[140:143], v[44:47], v[84:87], v[140:143]
  v_mfma_f32_16x16x32_bf16 v[144:147], v[40:43], v[88:91], v[144:147]
  v_mfma_f32_16x16x32_bf16 v[144:147], v[44:47], v[92:95], v[144:147]
  v_mfma_f32_16x16x32_bf16 v[148:151], v[40:43], v[96:99], v[148:151]
  v_mfma_f32_16x16x32_bf16 v[148:151], v[44:47], v[100:103], v[148:151]
  v_mfma_f32_16x16x32_bf16 v[152:155], v[40:43], v[104:107], v[152:155]
  v_mfma_f32_16x16x32_bf16 v[152:155], v[44:47], v[108:111], v[152:155]
  v_mfma_f32_16x16x32_bf16 v[168:171], v[48:51], v[104:107], v[168:171]
  v_mfma_f32_16x16x32_bf16 v[168:171], v[52:55], v[108:111], v[168:171]
  v_mfma_f32_16x16x32_bf16 v[164:167], v[48:51], v[96:99], v[164:167]
  v_mfma_f32_16x16x32_bf16 v[164:167], v[52:55], v[100:103], v[164:167]
  v_mfma_f32_16x16x32_bf16 v[160:163], v[48:51], v[88:91], v[160:163]
  v_mfma_f32_16x16x32_bf16 v[160:163], v[52:55], v[92:95], v[160:163]
  v_mfma_f32_16x16x32_bf16 v[156:159], v[48:51], v[80:83], v[156:159]
  v_mfma_f32_16x16x32_bf16 v[156:159], v[52:55], v[84:87], v[156:159]
  v_mfma_f32_16x16x32_bf16 v[172:175], v[56:59], v[80:83], v[172:175]
  v_mfma_f32_16x16x32_bf16 v[172:175], v[60:63], v[84:87], v[172:175]
  v_mfma_f32_16x16x32_bf16 v[176:179], v[56:59], v[88:91], v[176:179]
  v_mfma_f32_16x16x32_bf16 v[176:179], v[60:63], v[92:95], v[176:179]
  v_mfma_f32_16x16x32_bf16 v[180:183], v[56:59], v[96:99], v[180:183]
  v_mfma_f32_16x16x32_bf16 v[180:183], v[60:63], v[100:103], v[180:183]
  v_mfma_f32_16x16x32_bf16 v[184:187], v[56:59], v[104:107], v[184:187]
  v_mfma_f32_16x16x32_bf16 v[184:187], v[60:63], v[108:111], v[184:187]
  v_mfma_f32_16x16x32_bf16 v[200:203], v[64:67], v[104:107], v[200:203]
  v_mfma_f32_16x16x32_bf16 v[200:203], v[68:71], v[108:111], v[200:203]
  v_mfma_f32_16x16x32_bf16 v[196:199], v[64:67], v[96:99], v[196:199]
  v_mfma_f32_16x16x32_bf16 v[196:199], v[68:71], v[100:103], v[196:199]
  v_mfma_f32_16x16x32_bf16 v[192:195], v[64:67], v[88:91], v[192:195]
  v_mfma_f32_16x16x32_bf16 v[192:195], v[68:71], v[92:95], v[192:195]
  v_mfma_f32_16x16x32_bf16 v[188:191], v[64:67], v[80:83], v[188:191]
  v_mfma_f32_16x16x32_bf16 v[188:191], v[68:71], v[84:87], v[188:191]
  v_mfma_f32_16x16x32_bf16 v[204:207], v[72:75], v[80:83], v[204:207]
  v_mfma_f32_16x16x32_bf16 v[204:207], v[76:79], v[84:87], v[204:207]
  v_mfma_f32_16x16x32_bf16 v[208:211], v[72:75], v[88:91], v[208:211]
  v_mfma_f32_16x16x32_bf16 v[208:211], v[76:79], v[92:95], v[208:211]
  v_mfma_f32_16x16x32_bf16 v[212:215], v[72:75], v[96:99], v[212:215]
  v_mfma_f32_16x16x32_bf16 v[212:215], v[76:79], v[100:103], v[212:215]
  v_mfma_f32_16x16x32_bf16 v[216:219], v[72:75], v[104:107], v[216:219]
  s_setprio 2
  s_barrier
  v_mfma_f32_16x16x32_bf16 v[216:219], v[76:79], v[108:111], v[216:219]
  ds_read_b64_tr_b16 v[40:41], v1 offset:0
  s_add_u32 m0, s75, 81920
  s_nop 0
  buffer_load_dwordx4 v29, s[44:47], s74 offen offset:0 lds
  ds_read_b64_tr_b16 v[42:43], v1 offset:2560
  ds_read_b64_tr_b16 v[44:45], v1 offset:20480
  ds_read_b64_tr_b16 v[46:47], v1 offset:23040
  ds_read_b64_tr_b16 v[48:49], v2 offset:0
  buffer_load_dwordx4 v30, s[44:47], s74 offen offset:1024 lds
  ds_read_b64_tr_b16 v[50:51], v2 offset:2560
  ds_read_b64_tr_b16 v[52:53], v2 offset:20480
  ds_read_b64_tr_b16 v[54:55], v2 offset:23040
  ds_read_b64_tr_b16 v[56:57], v3 offset:0
  buffer_load_dwordx4 v31, s[44:47], s74 offen offset:2048 lds
  ds_read_b64_tr_b16 v[58:59], v3 offset:2560
  ds_read_b64_tr_b16 v[60:61], v3 offset:20480
  ds_read_b64_tr_b16 v[62:63], v3 offset:23040
  ds_read_b64_tr_b16 v[64:65], v4 offset:0
  buffer_load_dwordx4 v32, s[44:47], s74 offen offset:3072 lds
  ds_read_b64_tr_b16 v[66:67], v4 offset:2560
  ds_read_b64_tr_b16 v[68:69], v4 offset:20480
  ds_read_b64_tr_b16 v[70:71], v4 offset:23040
  ds_read_b128 v[80:83], v11 offset:8192
  s_add_u32 m0, m0, 4096
  s_nop 0
  buffer_load_dwordx4 v33, s[44:47], s74 offen offset:0 lds
  s_add_u32 s74, s74, 212992
  ds_read_b128 v[84:87], v12 offset:8192
  ds_read_b128 v[88:91], v11 offset:10240
  ds_read_b128 v[92:95], v12 offset:10240
  ds_read_b128 v[96:99], v11 offset:12288
  v_lshl_add_u32 v34, v240, 7, v15
  v_lshl_add_u32 v28, v24, 7, v14
  s_add_u32 m0, s76, 8192
  s_nop 0
  buffer_load_dwordx4 v28, s[32:35], 0 offen lds
  ds_read_b128 v[100:103], v12 offset:12288
  ds_read_b128 v[104:107], v11 offset:14336
  ds_read_b128 v[108:111], v12 offset:14336
  ds_read_b64_tr_b16 v[72:73], v5 offset:0
  s_add_u32 m0, m0, 1024
  s_nop 0
  buffer_load_dwordx4 v34, s[32:35], 0 offen lds
  ds_read_b64_tr_b16 v[74:75], v5 offset:2560
  ds_read_b64_tr_b16 v[76:77], v5 offset:20480
  ds_read_b64_tr_b16 v[78:79], v5 offset:23040
  s_waitcnt vmcnt(9) lgkmcnt(0)
  s_barrier
  s_setprio 0
  v_mfma_f32_16x16x32_bf16 v[140:143], v[40:43], v[80:83], v[140:143]
  s_cmp_eq_u32 s72, 3
  v_mfma_f32_16x16x32_bf16 v[140:143], v[44:47], v[84:87], v[140:143]
  v_mfma_f32_16x16x32_bf16 v[144:147], v[40:43], v[88:91], v[144:147]
  v_mfma_f32_16x16x32_bf16 v[144:147], v[44:47], v[92:95], v[144:147]
  v_mfma_f32_16x16x32_bf16 v[148:151], v[40:43], v[96:99], v[148:151]
  v_mfma_f32_16x16x32_bf16 v[148:151], v[44:47], v[100:103], v[148:151]
  v_mfma_f32_16x16x32_bf16 v[152:155], v[40:43], v[104:107], v[152:155]
  v_mfma_f32_16x16x32_bf16 v[152:155], v[44:47], v[108:111], v[152:155]
  v_mfma_f32_16x16x32_bf16 v[168:171], v[48:51], v[104:107], v[168:171]
  v_mfma_f32_16x16x32_bf16 v[168:171], v[52:55], v[108:111], v[168:171]
  v_mfma_f32_16x16x32_bf16 v[164:167], v[48:51], v[96:99], v[164:167]
  v_mfma_f32_16x16x32_bf16 v[164:167], v[52:55], v[100:103], v[164:167]
  v_mfma_f32_16x16x32_bf16 v[160:163], v[48:51], v[88:91], v[160:163]
  v_mfma_f32_16x16x32_bf16 v[160:163], v[52:55], v[92:95], v[160:163]
  v_mfma_f32_16x16x32_bf16 v[156:159], v[48:51], v[80:83], v[156:159]
  v_mfma_f32_16x16x32_bf16 v[156:159], v[52:55], v[84:87], v[156:159]
  v_mfma_f32_16x16x32_bf16 v[172:175], v[56:59], v[80:83], v[172:175]
  v_mfma_f32_16x16x32_bf16 v[172:175], v[60:63], v[84:87], v[172:175]
  v_mfma_f32_16x16x32_bf16 v[176:179], v[56:59], v[88:91], v[176:179]
  v_mfma_f32_16x16x32_bf16 v[176:179], v[60:63], v[92:95], v[176:179]
  v_mfma_f32_16x16x32_bf16 v[180:183], v[56:59], v[96:99], v[180:183]
  v_mfma_f32_16x16x32_bf16 v[180:183], v[60:63], v[100:103], v[180:183]
  v_mfma_f32_16x16x32_bf16 v[184:187], v[56:59], v[104:107], v[184:187]
  v_mfma_f32_16x16x32_bf16 v[184:187], v[60:63], v[108:111], v[184:187]
  v_mfma_f32_16x16x32_bf16 v[200:203], v[64:67], v[104:107], v[200:203]
  v_mfma_f32_16x16x32_bf16 v[200:203], v[68:71], v[108:111], v[200:203]
  v_mfma_f32_16x16x32_bf16 v[196:199], v[64:67], v[96:99], v[196:199]
  v_mfma_f32_16x16x32_bf16 v[196:199], v[68:71], v[100:103], v[196:199]
  v_mfma_f32_16x16x32_bf16 v[192:195], v[64:67], v[88:91], v[192:195]
  v_mfma_f32_16x16x32_bf16 v[192:195], v[68:71], v[92:95], v[192:195]
  v_mfma_f32_16x16x32_bf16 v[188:191], v[64:67], v[80:83], v[188:191]
  v_mfma_f32_16x16x32_bf16 v[188:191], v[68:71], v[84:87], v[188:191]
  v_mfma_f32_16x16x32_bf16 v[204:207], v[72:75], v[80:83], v[204:207]
  v_mfma_f32_16x16x32_bf16 v[204:207], v[76:79], v[84:87], v[204:207]
  v_mfma_f32_16x16x32_bf16 v[208:211], v[72:75], v[88:91], v[208:211]
  v_mfma_f32_16x16x32_bf16 v[208:211], v[76:79], v[92:95], v[208:211]
  v_mfma_f32_16x16x32_bf16 v[212:215], v[72:75], v[96:99], v[212:215]
  v_mfma_f32_16x16x32_bf16 v[212:215], v[76:79], v[100:103], v[212:215]
  v_mfma_f32_16x16x32_bf16 v[216:219], v[72:75], v[104:107], v[216:219]
  s_setprio 2
  s_barrier
  v_mfma_f32_16x16x32_bf16 v[216:219], v[76:79], v[108:111], v[216:219]
  s_cbranch_scc1 L_dnn_x1
  ds_read_b64_tr_b16 v[40:41], v1 offset:40960
  s_add_u32 m0, s75, 0
  s_nop 0
  buffer_load_dwordx4 v29, s[44:47], s74 offen offset:0 lds
  ds_read_b64_tr_b16 v[42:43], v1 offset:43520
  ds_read_b64_tr_b16 v[44:45], v6 offset:0
  ds_read_b64_tr_b16 v[46:47], v6 offset:2560
  ds_read_b64_tr_b16 v[48:49], v2 offset:40960
  buffer_load_dwordx4 v30, s[44:47], s74 offen offset:1024 lds
  ds_read_b64_tr_b16 v[50:51], v2 offset:43520
  ds_read_b64_tr_b16 v[52:53], v7 offset:0
  ds_read_b64_tr_b16 v[54:55], v7 offset:2560
  ds_read_b64_tr_b16 v[56:57], v3 offset:40960
  buffer_load_dwordx4 v31, s[44:47], s74 offen offset:2048 lds
  ds_read_b64_tr_b16 v[58:59], v3 offset:43520
  ds_read_b64_tr_b16 v[60:61], v8 offset:0
  ds_read_b64_tr_b16 v[62:63], v8 offset:2560
  ds_read_b64_tr_b16 v[64:65], v4 offset:40960
  buffer_load_dwordx4 v32, s[44:47], s74 offen offset:3072 lds
  ds_read_b64_tr_b16 v[66:67], v4 offset:43520
  ds_read_b64_tr_b16 v[68:69], v9 offset:0
  ds_read_b64_tr_b16 v[70:71], v9 offset:2560
  ds_read_b128 v[80:83], v11 offset:0
  s_add_u32 m0, m0, 4096
  s_nop 0
  buffer_load_dwordx4 v33, s[44:47], s74 offen offset:0 lds
  s_add_u32 s74, s74, 212992
  ds_read_b128 v[84:87], v12 offset:0
  ds_read_b128 v[88:91], v11 offset:2048
  ds_read_b128 v[92:95], v12 offset:2048
  ds_read_b128 v[96:99], v11 offset:4096
  v_lshl_add_u32 v34, v241, 7, v15
  v_lshl_add_u32 v28, v25, 7, v14
  s_add_u32 m0, s76, 0
  s_nop 0
  buffer_load_dwordx4 v28, s[32:35], 0 offen lds
  ds_read_b128 v[100:103], v12 offset:4096
  ds_read_b128 v[104:107], v11 offset:6144
  ds_read_b128 v[108:111], v12 offset:6144
  ds_read_b64_tr_b16 v[72:73], v5 offset:40960
  s_add_u32 m0, m0, 1024
  s_nop 0
  buffer_load_dwordx4 v34, s[32:35], 0 offen lds
  ds_read_b64_tr_b16 v[74:75], v5 offset:43520
  ds_read_b64_tr_b16 v[76:77], v10 offset:0
  ds_read_b64_tr_b16 v[78:79], v10 offset:2560
  s_mov_b32 m0, 156288
  s_mov_b32 exec_hi, 0xff
  buffer_load_dwordx4 v37, s[52:55], s77 offen lds
  s_mov_b64 exec, -1
  s_waitcnt vmcnt(8) lgkmcnt(0)
  s_barrier
  s_setprio 0
  v_mfma_f32_16x16x32_bf16 v[140:143], v[40:43], v[80:83], v[140:143]
  v_mfma_f32_16x16x32_bf16 v[140:143], v[44:47], v[84:87], v[140:143]
  v_mfma_f32_16x16x32_bf16 v[144:147], v[40:43], v[88:91], v[144:147]
  v_mfma_f32_16x16x32_bf16 v[144:147], v[44:47], v[92:95], v[144:147]
  v_mfma_f32_16x16x32_bf16 v[148:151], v[40:43], v[96:99], v[148:151]
  v_mfma_f32_16x16x32_bf16 v[148:151], v[44:47], v[100:103], v[148:151]
  v_mfma_f32_16x16x32_bf16 v[152:155], v[40:43], v[104:107], v[152:155]
  v_mfma_f32_16x16x32_bf16 v[152:155], v[44:47], v[108:111], v[152:155]
  v_mfma_f32_16x16x32_bf16 v[168:171], v[48:51], v[104:107], v[168:171]
  v_mfma_f32_16x16x32_bf16 v[168:171], v[52:55], v[108:111], v[168:171]
  v_mfma_f32_16x16x32_bf16 v[164:167], v[48:51], v[96:99], v[164:167]
  v_mfma_f32_16x16x32_bf16 v[164:167], v[52:55], v[100:103], v[164:167]
  v_mfma_f32_16x16x32_bf16 v[160:163], v[48:51], v[88:91], v[160:163]
  v_mfma_f32_16x16x32_bf16 v[160:163], v[52:55], v[92:95], v[160:163]
  v_mfma_f32_16x16x32_bf16 v[156:159], v[48:51], v[80:83], v[156:159]
  v_mfma_f32_16x16x32_bf16 v[156:159], v[52:55], v[84:87], v[156:159]
  v_mfma_f32_16x16x32_bf16 v[172:175], v[56:59], v[80:83], v[172:175]
  v_mfma_f32_16x16x32_bf16 v[172:175], v[60:63], v[84:87], v[172:175]
  v_mfma_f32_16x16x32_bf16 v[176:179], v[56:59], v[88:91], v[176:179]
  v_mfma_f32_16x16x32_bf16 v[176:179], v[60:63], v[92:95], v[176:179]
  v_mfma_f32_16x16x32_bf16 v[180:183], v[56:59], v[96:99], v[180:183]
  v_mfma_f32_16x16x32_bf16 v[180:183], v[60:63], v[100:103], v[180:183]
  v_mfma_f32_16x16x32_bf16 v[184:187], v[56:59], v[104:107], v[184:187]
  v_mfma_f32_16x16x32_bf16 v[184:187], v[60:63], v[108:111], v[184:187]
  v_mfma_f32_16x16x32_bf16 v[200:203], v[64:67], v[104:107], v[200:203]
  v_mfma_f32_16x16x32_bf16 v[200:203], v[68:71], v[108:111], v[200:203]
  v_mfma_f32_16x16x32_bf16 v[196:199], v[64:67], v[96:99], v[196:199]
  v_mfma_f32_16x16x32_bf16 v[196:199], v[68:71], v[100:103], v[196:199]
  v_mfma_f32_16x16x32_bf16 v[192:195], v[64:67], v[88:91], v[192:195]
  v_mfma_f32_16x16x32_bf16 v[192:195], v[68:71], v[92:95], v[192:195]
  v_mfma_f32_16x16x32_bf16 v[188:191], v[64:67], v[80:83], v[188:191]
  v_mfma_f32_16x16x32_bf16 v[188:191], v[68:71], v[84:87], v[188:191]
  v_mfma_f32_16x16x32_bf16 v[204:207], v[72:75], v[80:83], v[204:207]
  v_mfma_f32_16x16x32_bf16 v[204:207], v[76:79], v[84:87], v[204:207]
  v_mfma_f32_16x16x32_bf16 v[208:211], v[72:75], v[88:91], v[208:211]
  v_mfma_f32_16x16x32_bf16 v[208:211], v[76:79], v[92:95], v[208:211]
  v_mfma_f32_16x16x32_bf16 v[212:215], v[72:75], v[96:99], v[212:215]
  v_mfma_f32_16x16x32_bf16 v[212:215], v[76:79], v[100:103], v[212:215]
  v_mfma_f32_16x16x32_bf16 v[216:219], v[72:75], v[104:107], v[216:219]
  s_setprio 2
  s_barrier
  v_mfma_f32_16x16x32_bf16 v[216:219], v[76:79], v[108:111], v[216:219]
  ds_read_b64_tr_b16 v[40:41], v6 offset:20480
  s_add_u32 m0, s75, 40960
  s_nop 0
  buffer_load_dwordx4 v29, s[44:47], s74 offen offset:0 lds
  ds_read_b64_tr_b16 v[42:43], v6 offset:23040
  ds_read_b64_tr_b16 v[44:45], v6 offset:40960
  ds_read_b64_tr_b16 v[46:47], v6 offset:43520
  ds_read_b64_tr_b16 v[48:49], v7 offset:20480
  buffer_load_dwordx4 v30, s[44:47], s74 offen offset:1024 lds
  ds_read_b64_tr_b16 v[50:51], v7 offset:23040
  ds_read_b64_tr_b16 v[52:53], v7 offset:40960
  ds_read_b64_tr_b16 v[54:55], v7 offset:43520
  ds_read_b64_tr_b16 v[56:57], v8 offset:20480
  buffer_load_dwordx4 v31, s[44:47], s74 offen offset:2048 lds
  ds_read_b64_tr_b16 v[58:59], v8 offset:23040
  ds_read_b64_tr_b16 v[60:61], v8 offset:40960
  ds_read_b64_tr_b16 v[62:63], v8 offset:43520
  ds_read_b64_tr_b16 v[64:65], v9 offset:20480
  buffer_load_dwordx4 v32, s[44:47], s74 offen offset:3072 lds
  ds_read_b64_tr_b16 v[66:67], v9 offset:23040
  ds_read_b64_tr_b16 v[68:69], v9 offset:40960
  ds_read_b64_tr_b16 v[70:71], v9 offset:43520
  ds_read_b128 v[80:83], v11 offset:8192
  s_add_u32 m0, m0, 4096
  s_nop 0
  buffer_load_dwordx4 v33, s[44:47], s74 offen offset:0 lds
  s_add_u32 s74, s74, 212992
  ds_read_b128 v[84:87], v12 offset:8192
  ds_read_b128 v[88:91], v11 offset:10240
  ds_read_b128 v[92:95], v12 offset:10240
  ds_read_b128 v[96:99], v11 offset:12288
  v_lshl_add_u32 v34, v242, 7, v15
  v_lshl_add_u32 v28, v26, 7, v14
  s_add_u32 m0, s76, 8192
  s_nop 0
  buffer_load_dwordx4 v28, s[32:35], 0 offen lds
  ds_read_b128 v[100:103], v12 offset:12288
  ds_read_b128 v[104:107], v11 offset:14336
  ds_read_b128 v[108:111], v12 offset:14336
  ds_read_b64_tr_b16 v[72:73], v10 offset:20480
  s_add_u32 m0, m0, 1024
  s_nop 0
  buffer_load_dwordx4 v34, s[32:35], 0 offen lds
  ds_read_b64_tr_b16 v[74:75], v10 offset:23040
  ds_read_b64_tr_b16 v[76:77], v10 offset:40960
  ds_read_b64_tr_b16 v[78:79], v10 offset:43520
  buffer_load_dwordx3 v[24:26], v13, s[28:31], s73 offen offset:0
  buffer_load_dwordx3 v[240:242], v13, s[28:31], s73 offen offset:832
  s_add_u32 s73, s73, 12
  s_waitcnt vmcnt(10) lgkmcnt(0)
  s_barrier
  s_setprio 0
  v_mfma_f32_16x16x32_bf16 v[140:143], v[40:43], v[80:83], v[140:143]
  s_add_u32 s72, s72, 1
  v_mfma_f32_16x16x32_bf16 v[140:143], v[44:47], v[84:87], v[140:143]
  v_mfma_f32_16x16x32_bf16 v[144:147], v[40:43], v[88:91], v[144:147]
  v_mfma_f32_16x16x32_bf16 v[144:147], v[44:47], v[92:95], v[144:147]
  v_mfma_f32_16x16x32_bf16 v[148:151], v[40:43], v[96:99], v[148:151]
  v_mfma_f32_16x16x32_bf16 v[148:151], v[44:47], v[100:103], v[148:151]
  v_mfma_f32_16x16x32_bf16 v[152:155], v[40:43], v[104:107], v[152:155]
  v_mfma_f32_16x16x32_bf16 v[152:155], v[44:47], v[108:111], v[152:155]
  v_mfma_f32_16x16x32_bf16 v[168:171], v[48:51], v[104:107], v[168:171]
  v_mfma_f32_16x16x32_bf16 v[168:171], v[52:55], v[108:111], v[168:171]
  v_mfma_f32_16x16x32_bf16 v[164:167], v[48:51], v[96:99], v[164:167]
  v_mfma_f32_16x16x32_bf16 v[164:167], v[52:55], v[100:103], v[164:167]
  v_mfma_f32_16x16x32_bf16 v[160:163], v[48:51], v[88:91], v[160:163]
  v_mfma_f32_16x16x32_bf16 v[160:163], v[52:55], v[92:95], v[160:163]
  v_mfma_f32_16x16x32_bf16 v[156:159], v[48:51], v[80:83], v[156:159]
  v_mfma_f32_16x16x32_bf16 v[156:159], v[52:55], v[84:87], v[156:159]
  v_mfma_f32_16x16x32_bf16 v[172:175], v[56:59], v[80:83], v[172:175]
  v_mfma_f32_16x16x32_bf16 v[172:175], v[60:63], v[84:87], v[172:175]
  v_mfma_f32_16x16x32_bf16 v[176:179], v[56:59], v[88:91], v[176:179]
  v_mfma_f32_16x16x32_bf16 v[176:179], v[60:63], v[92:95], v[176:179]
  s_cmp_lt_u32 s72, 4
  v_mfma_f32_16x16x32_bf16 v[180:183], v[56:59], v[96:99], v[180:183]
  v_mfma_f32_16x16x32_bf16 v[180:183], v[60:63], v[100:103], v[180:183]
  v_mfma_f32_16x16x32_bf16 v[184:187], v[56:59], v[104:107], v[184:187]
  v_mfma_f32_16x16x32_bf16 v[184:187], v[60:63], v[108:111], v[184:187]
  v_mfma_f32_16x16x32_bf16 v[200:203], v[64:67], v[104:107], v[200:203]
  v_mfma_f32_16x16x32_bf16 v[200:203], v[68:71], v[108:111], v[200:203]
  v_mfma_f32_16x16x32_bf16 v[196:199], v[64:67], v[96:99], v[196:199]
  v_mfma_f32_16x16x32_bf16 v[196:199], v[68:71], v[100:103], v[196:199]
  v_mfma_f32_16x16x32_bf16 v[192:195], v[64:67], v[88:91], v[192:195]
  v_mfma_f32_16x16x32_bf16 v[192:195], v[68:71], v[92:95], v[192:195]
  v_mfma_f32_16x16x32_bf16 v[188:191], v[64:67], v[80:83], v[188:191]
  v_mfma_f32_16x16x32_bf16 v[188:191], v[68:71], v[84:87], v[188:191]
  v_mfma_f32_16x16x32_bf16 v[204:207], v[72:75], v[80:83], v[204:207]
  v_mfma_f32_16x16x32_bf16 v[204:207], v[76:79], v[84:87], v[204:207]
  v_mfma_f32_16x16x32_bf16 v[208:211], v[72:75], v[88:91], v[208:211]
  v_mfma_f32_16x16x32_bf16 v[208:211], v[76:79], v[92:95], v[208:211]
  v_mfma_f32_16x16x32_bf16 v[212:215], v[72:75], v[96:99], v[212:215]
  v_mfma_f32_16x16x32_bf16 v[212:215], v[76:79], v[100:103], v[212:215]
  v_mfma_f32_16x16x32_bf16 v[216:219], v[72:75], v[104:107], v[216:219]
  s_setprio 2
  s_barrier
  v_mfma_f32_16x16x32_bf16 v[216:219], v[76:79], v[108:111], v[216:219]
  s_cbranch_scc1 L_dnn_loop1
L_dnn_x1:
  ds_read_b64_tr_b16 v[40:41], v1 offset:40960
  s_add_u32 m0, s75, 0
  s_nop 0
  buffer_load_dwordx4 v29, s[44:47], s74 offen offset:0 lds
  ds_read_b64_tr_b16 v[42:43], v1 offset:43520
  ds_read_b64_tr_b16 v[44:45], v6 offset:0
  ds_read_b64_tr_b16 v[46:47], v6 offset:2560
  ds_read_b64_tr_b16 v[48:49], v2 offset:40960
  buffer_load_dwordx4 v30, s[44:47], s74 offen offset:1024 lds
  ds_read_b64_tr_b16 v[50:51], v2 offset:43520
  ds_read_b64_tr_b16 v[52:53], v7 offset:0
  ds_read_b64_tr_b16 v[54:55], v7 offset:2560
  ds_read_b64_tr_b16 v[56:57], v3 offset:40960
  ds_read_b64_tr_b16 v[58:59], v3 offset:43520
  buffer_load_dwordx4 v31, s[44:47], s74 offen offset:2048 lds
  ds_read_b64_tr_b16 v[60:61], v8 offset:0
  ds_read_b64_tr_b16 v[62:63], v8 offset:2560
  ds_read_b64_tr_b16 v[64:65], v4 offset:40960
  ds_read_b64_tr_b16 v[66:67], v4 offset:43520
  ds_read_b64_tr_b16 v[68:69], v9 offset:0
  buffer_load_dwordx4 v32, s[44:47], s74 offen offset:3072 lds
  ds_read_b64_tr_b16 v[70:71], v9 offset:2560
  ds_read_b128 v[80:83], v11 offset:0
  ds_read_b128 v[84:87], v12 offset:0
  ds_read_b128 v[88:91], v11 offset:2048
  s_add_u32 m0, m0, 4096
  s_nop 0
  buffer_load_dwordx4 v33, s[44:47], s74 offen offset:0 lds
  s_add_u32 s74, s74, 212992
  ds_read_b128 v[92:95], v12 offset:2048
  ds_read_b128 v[96:99], v11 offset:4096
  ds_read_b128 v[100:103], v12 offset:4096
  ds_read_b128 v[104:107], v11 offset:6144
  ds_read_b128 v[108:111], v12 offset:6144
  v_lshl_add_u32 v34, v241, 7, v15
  v_lshl_add_u32 v28, v25, 7, v14
  s_add_u32 m0, s76, 0
  s_nop 0
  buffer_load_dwordx4 v28, s[32:35], 0 offen lds
  ds_read_b64_tr_b16 v[72:73], v5 offset:40960
  ds_read_b64_tr_b16 v[74:75], v5 offset:43520
  ds_read_b64_tr_b16 v[76:77], v10 offset:0
  ds_read_b64_tr_b16 v[78:79], v10 offset:2560
  ds_read_b64 v[220:221], v35 offset:640
  s_add_u32 m0, m0, 1024
  s_nop 0
  buffer_load_dwordx4 v34, s[32:35], 0 offen lds
  ds_read_b64 v[222:223], v35 offset:672
  ds_read_b64 v[224:225], v35 offset:704
  ds_read_b64 v[226:227], v35 offset:736
  ds_read_b64 v[228:229], v35 offset:768
  s_waitcnt vmcnt(7) lgkmcnt(0)
  s_barrier
  s_setprio 0
  v_mfma_f32_16x16x32_bf16 v[140:143], v[40:43], v[80:83], v[140:143]
  v_mov_b32 v232, 0xc0135761
  v_mov_b32 v233, 0xc0135761
  v_mfma_f32_16x16x32_bf16 v[140:143], v[44:47], v[84:87], v[140:143]
  v_mov_b32 v234, 0xbdd2d3e8
  v_mfma_f32_16x16x32_bf16 v[144:147], v[40:43], v[88:91], v[144:147]
  v_mov_b32 v235, 0xbdd2d3e8
  v_mfma_f32_16x16x32_bf16 v[144:147], v[44:47], v[92:95], v[144:147]
  v_mov_b32 v236, 0xc2b40000
  v_mfma_f32_16x16x32_bf16 v[148:151], v[40:43], v[96:99], v[148:151]
  v_mov_b32 v237, 0xc2b40000
  v_mfma_f32_16x16x32_bf16 v[148:151], v[44:47], v[100:103], v[148:151]
  v_lshlrev_b32 v112, 16, v220
  v_mfma_f32_16x16x32_bf16 v[152:155], v[40:43], v[104:107], v[152:155]
  v_and_b32 v113, 0xffff0000, v220
  v_mfma_f32_16x16x32_bf16 v[152:155], v[44:47], v[108:111], v[152:155]
  v_lshlrev_b32 v114, 16, v221
  v_mfma_f32_16x16x32_bf16 v[168:171], v[48:51], v[104:107], v[168:171]
  v_and_b32 v115, 0xffff0000, v221
  v_mfma_f32_16x16x32_bf16 v[168:171], v[52:55], v[108:111], v[168:171]
  v_lshlrev_b32 v116, 16, v222
  v_mfma_f32_16x16x32_bf16 v[164:167], v[48:51], v[96:99], v[164:167]
  v_and_b32 v117, 0xffff0000, v222
  v_mfma_f32_16x16x32_bf16 v[164:167], v[52:55], v[100:103], v[164:167]
  v_lshlrev_b32 v118, 16, v223
  v_mfma_f32_16x16x32_bf16 v[160:163], v[48:51], v[88:91], v[160:163]
  v_and_b32 v119, 0xffff0000, v223
  v_mfma_f32_16x16x32_bf16 v[160:163], v[52:55], v[92:95], v[160:163]
  v_lshlrev_b32 v120, 16, v224
  v_mfma_f32_16x16x32_bf16 v[156:159], v[48:51], v[80:83], v[156:159]
  v_and_b32 v121, 0xffff0000, v224
  v_mfma_f32_16x16x32_bf16 v[156:159], v[52:55], v[84:87], v[156:159]
  v_lshlrev_b32 v122, 16, v225
  v_mfma_f32_16x16x32_bf16 v[172:175], v[56:59], v[80:83], v[172:175]
  v_and_b32 v123, 0xffff0000, v225
  v_mfma_f32_16x16x32_bf16 v[172:175], v[60:63], v[84:87], v[172:175]
  v_lshlrev_b32 v124, 16, v226
  v_mfma_f32_16x16x32_bf16 v[176:179], v[56:59], v[88:91], v[176:179]
  v_and_b32 v125, 0xffff0000, v226
  v_mfma_f32_16x16x32_bf16 v[176:179], v[60:63], v[92:95], v[176:179]
  v_lshlrev_b32 v126, 16, v227
  v_and_b32 v127, 0xffff0000, v227
  v_mfma_f32_16x16x32_bf16 v[180:183], v[56:59], v[96:99], v[180:183]
  v_lshlrev_b32 v128, 16, v228
  v_mfma_f32_16x16x32_bf16 v[180:183], v[60:63], v[100:103], v[180:183]
  v_and_b32 v129, 0xffff0000, v228
  v_mfma_f32_16x16x32_bf16 v[184:187], v[56:59], v[104:107], v[184:187]
  v_lshlrev_b32 v130, 16, v229
  v_mfma_f32_16x16x32_bf16 v[184:187], v[60:63], v[108:111], v[184:187]
  v_and_b32 v131, 0xffff0000, v229
  v_mfma_f32_16x16x32_bf16 v[200:203], v[64:67], v[104:107], v[200:203]
  v_mov_b32 v239, 0x21800000
  v_mfma_f32_16x16x32_bf16 v[200:203], v[68:71], v[108:111], v[200:203]
  v_mov_b32 v238, 0x30800000
  v_mfma_f32_16x16x32_bf16 v[196:199], v[64:67], v[96:99], v[196:199]
  v_max3_f32 v239, v239, abs(v112), abs(v113)
  v_mfma_f32_16x16x32_bf16 v[196:199], v[68:71], v[100:103], v[196:199]
  v_max3_f32 v239, v239, abs(v114), abs(v115)
  v_mfma_f32_16x16x32_bf16 v[192:195], v[64:67], v[88:91], v[192:195]
  v_max3_f32 v239, v239, abs(v116), abs(v117)
  v_mfma_f32_16x16x32_bf16 v[192:195], v[68:71], v[92:95], v[192:195]
  v_max3_f32 v239, v239, abs(v118), abs(v119)
  v_mfma_f32_16x16x32_bf16 v[188:191], v[64:67], v[80:83], v[188:191]
  v_max3_f32 v239, v239, abs(v120), abs(v121)
  v_mfma_f32_16x16x32_bf16 v[188:191], v[68:71], v[84:87], v[188:191]
  v_max3_f32 v239, v239, abs(v122), abs(v123)
  v_mfma_f32_16x16x32_bf16 v[204:207], v[72:75], v[80:83], v[204:207]
  v_max3_f32 v239, v239, abs(v124), abs(v125)
  v_mfma_f32_16x16x32_bf16 v[204:207], v[76:79], v[84:87], v[204:207]
  v_max3_f32 v239, v239, abs(v126), abs(v127)
  v_mfma_f32_16x16x32_bf16 v[208:211], v[72:75], v[88:91], v[208:211]
  v_max3_f32 v239, v239, abs(v128), abs(v129)
  v_mfma_f32_16x16x32_bf16 v[208:211], v[76:79], v[92:95], v[208:211]
  v_max3_f32 v239, v239, abs(v130), abs(v131)
  v_mfma_f32_16x16x32_bf16 v[212:215], v[72:75], v[96:99], v[212:215]
  v_and_b32 v239, 0x7f800000, v239
  v_mfma_f32_16x16x32_bf16 v[212:215], v[76:79], v[100:103], v[212:215]
  v_mul_f32 v239, 0x22000000, v239
  v_mfma_f32_16x16x32_bf16 v[216:219], v[72:75], v[104:107], v[216:219]
  s_setprio 2
  s_barrier
  v_mfma_f32_16x16x32_bf16 v[216:219], v[76:79], v[108:111], v[216:219]
  ds_read_b64_tr_b16 v[40:41], v6 offset:20480
  s_add_u32 m0, s75, 40960
  s_nop 0
  buffer_load_dwordx4 v29, s[44:47], s74 offen offset:0 lds
  ds_read_b64_tr_b16 v[42:43], v6 offset:23040
  ds_read_b64_tr_b16 v[44:45], v6 offset:40960
  ds_read_b64_tr_b16 v[46:47], v6 offset:43520
  ds_read_b64_tr_b16 v[48:49], v7 offset:20480
  buffer_load_dwordx4 v30, s[44:47], s74 offen offset:1024 lds
  ds_read_b64_tr_b16 v[50:51], v7 offset:23040
  ds_read_b64_tr_b16 v[52:53], v7 offset:40960
  ds_read_b64_tr_b16 v[54:55], v7 offset:43520
  ds_read_b64_tr_b16 v[56:57], v8 offset:20480
  buffer_load_dwordx4 v31, s[44:47], s74 offen offset:2048 lds
  ds_read_b64_tr_b16 v[58:59], v8 offset:23040
  ds_read_b64_tr_b16 v[60:61], v8 offset:40960
  ds_read_b64_tr_b16 v[62:63], v8 offset:43520
  ds_read_b64_tr_b16 v[64:65], v9 offset:20480
  buffer_load_dwordx4 v32, s[44:47], s74 offen offset:3072 lds
  ds_read_b64_tr_b16 v[66:67], v9 offset:23040
  ds_read_b64_tr_b16 v[68:69], v9 offset:40960
  ds_read_b64_tr_b16 v[70:71], v9 offset:43520
  ds_read_b128 v[80:83], v11 offset:8192
  s_add_u32 m0, m0, 4096
  s_nop 0
  buffer_load_dwordx4 v33, s[44:47], s74 offen offset:0 lds
  s_add_u32 s74, s74, 212992
  ds_read_b128 v[84:87], v12 offset:8192
  ds_read_b128 v[88:91], v11 offset:10240
  ds_read_b128 v[92:95], v12 offset:10240
  ds_read_b128 v[96:99], v11 offset:12288
  v_lshl_add_u32 v34, v242, 7, v15
  v_lshl_add_u32 v28, v26, 7, v14
  s_add_u32 m0, s76, 8192
  s_nop 0
  buffer_load_dwordx4 v28, s[32:35], 0 offen lds
  ds_read_b128 v[100:103], v12 offset:12288
  ds_read_b128 v[104:107], v11 offset:14336
  ds_read_b128 v[108:111], v12 offset:14336
  ds_read_b64_tr_b16 v[72:73], v10 offset:20480
  s_add_u32 m0, m0, 1024
  s_nop 0
  buffer_load_dwordx4 v34, s[32:35], 0 offen lds
  ds_read_b64_tr_b16 v[74:75], v10 offset:23040
  ds_read_b64_tr_b16 v[76:77], v10 offset:40960
  ds_read_b64_tr_b16 v[78:79], v10 offset:43520
  s_waitcnt vmcnt(7) lgkmcnt(0)
  s_barrier
  s_setprio 0
  v_mfma_f32_16x16x32_bf16 v[140:143], v[40:43], v[80:83], v[140:143]
  v_rcp_f32 v112, v112
  v_mfma_f32_16x16x32_bf16 v[140:143], v[44:47], v[84:87], v[140:143]
  v_rcp_f32 v113, v113
  v_mfma_f32_16x16x32_bf16 v[144:147], v[40:43], v[88:91], v[144:147]
  v_rcp_f32 v114, v114
  v_mfma_f32_16x16x32_bf16 v[144:147], v[44:47], v[92:95], v[144:147]
  v_rcp_f32 v115, v115
  v_mfma_f32_16x16x32_bf16 v[148:151], v[40:43], v[96:99], v[148:151]
  v_mfma_f32_16x16x32_bf16 v[148:151], v[44:47], v[100:103], v[148:151]
  v_rcp_f32 v116, v116
  v_mfma_f32_16x16x32_bf16 v[152:155], v[40:43], v[104:107], v[152:155]
  v_rcp_f32 v117, v117
  v_mfma_f32_16x16x32_bf16 v[152:155], v[44:47], v[108:111], v[152:155]
  v_rcp_f32 v118, v118
  v_mfma_f32_16x16x32_bf16 v[168:171], v[48:51], v[104:107], v[168:171]
  v_rcp_f32 v119, v119
  v_mfma_f32_16x16x32_bf16 v[168:171], v[52:55], v[108:111], v[168:171]
  v_mfma_f32_16x16x32_bf16 v[164:167], v[48:51], v[96:99], v[164:167]
  v_rcp_f32 v120, v120
  v_mfma_f32_16x16x32_bf16 v[164:167], v[52:55], v[100:103], v[164:167]
  v_rcp_f32 v121, v121
  v_mfma_f32_16x16x32_bf16 v[160:163], v[48:51], v[88:91], v[160:163]
  v_rcp_f32 v122, v122
  v_mfma_f32_16x16x32_bf16 v[160:163], v[52:55], v[92:95], v[160:163]
  v_rcp_f32 v123, v123
  v_mfma_f32_16x16x32_bf16 v[156:159], v[48:51], v[80:83], v[156:159]
  v_mfma_f32_16x16x32_bf16 v[156:159], v[52:55], v[84:87], v[156:159]
  v_rcp_f32 v124, v124
  v_mfma_f32_16x16x32_bf16 v[172:175], v[56:59], v[80:83], v[172:175]
  v_rcp_f32 v125, v125
  v_mfma_f32_16x16x32_bf16 v[172:175], v[60:63], v[84:87], v[172:175]
  v_rcp_f32 v126, v126
  v_mfma_f32_16x16x32_bf16 v[176:179], v[56:59], v[88:91], v[176:179]
  v_mfma_f32_16x16x32_bf16 v[176:179], v[60:63], v[92:95], v[176:179]
  v_rcp_f32 v127, v127
  v_mfma_f32_16x16x32_bf16 v[180:183], v[56:59], v[96:99], v[180:183]
  v_rcp_f32 v128, v128
  v_mfma_f32_16x16x32_bf16 v[180:183], v[60:63], v[100:103], v[180:183]
  v_rcp_f32 v129, v129
  v_mfma_f32_16x16x32_bf16 v[184:187], v[56:59], v[104:107], v[184:187]
  v_rcp_f32 v130, v130
  v_mfma_f32_16x16x32_bf16 v[184:187], v[60:63], v[108:111], v[184:187]
  v_mfma_f32_16x16x32_bf16 v[200:203], v[64:67], v[104:107], v[200:203]
  v_rcp_f32 v131, v131
  v_mfma_f32_16x16x32_bf16 v[200:203], v[68:71], v[108:111], v[200:203]
  v_mul_f32 v112, v239, v112
  v_mul_f32 v113, v239, v113
  v_mfma_f32_16x16x32_bf16 v[196:199], v[64:67], v[96:99], v[196:199]
  v_mul_f32 v114, v239, v114
  v_mfma_f32_16x16x32_bf16 v[196:199], v[68:71], v[100:103], v[196:199]
  v_mul_f32 v115, v239, v115
  v_mul_f32 v116, v239, v116
  v_mfma_f32_16x16x32_bf16 v[192:195], v[64:67], v[88:91], v[192:195]
  v_mul_f32 v117, v239, v117
  v_mfma_f32_16x16x32_bf16 v[192:195], v[68:71], v[92:95], v[192:195]
  v_mul_f32 v118, v239, v118
  v_mul_f32 v119, v239, v119
  v_mfma_f32_16x16x32_bf16 v[188:191], v[64:67], v[80:83], v[188:191]
  v_mul_f32 v120, v239, v120
  v_mfma_f32_16x16x32_bf16 v[188:191], v[68:71], v[84:87], v[188:191]
  v_mul_f32 v121, v239, v121
  v_mul_f32 v122, v239, v122
  v_mfma_f32_16x16x32_bf16 v[204:207], v[72:75], v[80:83], v[204:207]
  v_mul_f32 v123, v239, v123
  v_mul_f32 v124, v239, v124
  v_mfma_f32_16x16x32_bf16 v[204:207], v[76:79], v[84:87], v[204:207]
  v_mul_f32 v125, v239, v125
  v_mfma_f32_16x16x32_bf16 v[208:211], v[72:75], v[88:91], v[208:211]
  v_mul_f32 v126, v239, v126
  v_mul_f32 v127, v239, v127
  v_mfma_f32_16x16x32_bf16 v[208:211], v[76:79], v[92:95], v[208:211]
  v_mul_f32 v128, v239, v128
  v_mfma_f32_16x16x32_bf16 v[212:215], v[72:75], v[96:99], v[212:215]
  v_mul_f32 v129, v239, v129
  v_mul_f32 v130, v239, v130
  v_mfma_f32_16x16x32_bf16 v[212:215], v[76:79], v[100:103], v[212:215]
  v_mul_f32 v131, v239, v131
  v_mfma_f32_16x16x32_bf16 v[216:219], v[72:75], v[104:107], v[216:219]
  s_setprio 2
  s_barrier
  v_mfma_f32_16x16x32_bf16 v[216:219], v[76:79], v[108:111], v[216:219]
  ds_read_b64_tr_b16 v[40:41], v1 offset:0
  ds_read_b64_tr_b16 v[42:43], v1 offset:2560
  ds_read_b64_tr_b16 v[44:45], v1 offset:20480
  ds_read_b64_tr_b16 v[46:47], v1 offset:23040
  ds_read_b64_tr_b16 v[48:49], v2 offset:0
  ds_read_b64_tr_b16 v[50:51], v2 offset:2560
  ds_read_b64_tr_b16 v[52:53], v2 offset:20480
  ds_read_b64_tr_b16 v[54:55], v2 offset:23040
  ds_read_b64_tr_b16 v[56:57], v3 offset:0
  ds_read_b64_tr_b16 v[58:59], v3 offset:2560
  ds_read_b64_tr_b16 v[60:61], v3 offset:20480
  ds_read_b64_tr_b16 v[62:63], v3 offset:23040
  ds_read_b64_tr_b16 v[64:65], v4 offset:0
  ds_read_b64_tr_b16 v[66:67], v4 offset:2560
  ds_read_b64_tr_b16 v[68:69], v4 offset:20480
  ds_read_b64_tr_b16 v[70:71], v4 offset:23040
  ds_read_b128 v[80:83], v11 offset:0
  ds_read_b128 v[84:87], v12 offset:0
  ds_read_b128 v[88:91], v11 offset:2048
  ds_read_b128 v[92:95], v12 offset:2048
  ds_read_b128 v[96:99], v11 offset:4096
  ds_read_b128 v[100:103], v12 offset:4096
  ds_read_b128 v[104:107], v11 offset:6144
  ds_read_b128 v[108:111], v12 offset:6144
  ds_read_b64_tr_b16 v[72:73], v5 offset:0
  ds_read_b64_tr_b16 v[74:75], v5 offset:2560
  ds_read_b64_tr_b16 v[76:77], v5 offset:20480
  ds_read_b64_tr_b16 v[78:79], v5 offset:23040
  s_waitcnt vmcnt(0) lgkmcnt(0)
  s_barrier
  s_setprio 0
  v_mfma_f32_16x16x32_bf16 v[140:143], v[40:43], v[80:83], v[140:143]
  v_med3_f32 v112, v112, -v238, v238
  v_med3_f32 v113, v113, -v238, v238
  v_mfma_f32_16x16x32_bf16 v[140:143], v[44:47], v[84:87], v[140:143]
  v_med3_f32 v114, v114, -v238, v238
  v_mfma_f32_16x16x32_bf16 v[144:147], v[40:43], v[88:91], v[144:147]
  v_med3_f32 v115, v115, -v238, v238
  v_mfma_f32_16x16x32_bf16 v[144:147], v[44:47], v[92:95], v[144:147]
  v_med3_f32 v116, v116, -v238, v238
  v_mfma_f32_16x16x32_bf16 v[148:151], v[40:43], v[96:99], v[148:151]
  v_med3_f32 v117, v117, -v238, v238
  v_mfma_f32_16x16x32_bf16 v[148:151], v[44:47], v[100:103], v[148:151]
  v_med3_f32 v118, v118, -v238, v238
  v_mfma_f32_16x16x32_bf16 v[152:155], v[40:43], v[104:107], v[152:155]
  v_med3_f32 v119, v119, -v238, v238
  v_mfma_f32_16x16x32_bf16 v[152:155], v[44:47], v[108:111], v[152:155]
  v_med3_f32 v120, v120, -v238, v238
  v_mfma_f32_16x16x32_bf16 v[168:171], v[48:51], v[104:107], v[168:171]
  v_med3_f32 v121, v121, -v238, v238
  v_mfma_f32_16x16x32_bf16 v[168:171], v[52:55], v[108:111], v[168:171]
  v_med3_f32 v122, v122, -v238, v238
  v_mfma_f32_16x16x32_bf16 v[164:167], v[48:51], v[96:99], v[164:167]
  v_med3_f32 v123, v123, -v238, v238
  v_mfma_f32_16x16x32_bf16 v[164:167], v[52:55], v[100:103], v[164:167]
  v_med3_f32 v124, v124, -v238, v238
  v_mfma_f32_16x16x32_bf16 v[160:163], v[48:51], v[88:91], v[160:163]
  v_med3_f32 v125, v125, -v238, v238
  v_mfma_f32_16x16x32_bf16 v[160:163], v[52:55], v[92:95], v[160:163]
  v_med3_f32 v126, v126, -v238, v238
  v_mfma_f32_16x16x32_bf16 v[156:159], v[48:51], v[80:83], v[156:159]
  v_med3_f32 v127, v127, -v238, v238
  v_mfma_f32_16x16x32_bf16 v[156:159], v[52:55], v[84:87], v[156:159]
  v_med3_f32 v128, v128, -v238, v238
  v_mfma_f32_16x16x32_bf16 v[172:175], v[56:59], v[80:83], v[172:175]
  v_med3_f32 v129, v129, -v238, v238
  v_mfma_f32_16x16x32_bf16 v[172:175], v[60:63], v[84:87], v[172:175]
  v_med3_f32 v130, v130, -v238, v238
  v_mfma_f32_16x16x32_bf16 v[176:179], v[56:59], v[88:91], v[176:179]
  v_med3_f32 v131, v131, -v238, v238
  v_mfma_f32_16x16x32_bf16 v[176:179], v[60:63], v[92:95], v[176:179]
  v_mul_f32 v132, 0x6c800000, v112
  v_mul_f32 v133, 0x6c800000, v113
  v_mfma_f32_16x16x32_bf16 v[180:183], v[56:59], v[96:99], v[180:183]
  v_mul_f32 v134, 0x6c800000, v114
  v_mfma_f32_16x16x32_bf16 v[180:183], v[60:63], v[100:103], v[180:183]
  v_mul_f32 v135, 0x6c800000, v115
  v_mfma_f32_16x16x32_bf16 v[184:187], v[56:59], v[104:107], v[184:187]
  v_mul_f32 v136, 0x6c800000, v116
  v_mfma_f32_16x16x32_bf16 v[184:187], v[60:63], v[108:111], v[184:187]
  v_mul_f32 v137, 0x6c800000, v117
  v_mfma_f32_16x16x32_bf16 v[200:203], v[64:67], v[104:107], v[200:203]
  v_mul_f32 v138, 0x6c800000, v118
  v_mfma_f32_16x16x32_bf16 v[200:203], v[68:71], v[108:111], v[200:203]
  v_mul_f32 v139, 0x6c800000, v119
  v_mfma_f32_16x16x32_bf16 v[196:199], v[64:67], v[96:99], v[196:199]
  v_mul_f32 v220, 0x6c800000, v120
  v_mfma_f32_16x16x32_bf16 v[196:199], v[68:71], v[100:103], v[196:199]
  v_mul_f32 v221, 0x6c800000, v121
  v_mfma_f32_16x16x32_bf16 v[192:195], v[64:67], v[88:91], v[192:195]
  v_mul_f32 v222, 0x6c800000, v122
  v_mfma_f32_16x16x32_bf16 v[192:195], v[68:71], v[92:95], v[192:195]
  v_mul_f32 v223, 0x6c800000, v123
  v_mfma_f32_16x16x32_bf16 v[188:191], v[64:67], v[80:83], v[188:191]
  v_mul_f32 v224, 0x6c800000, v124
  v_mfma_f32_16x16x32_bf16 v[188:191], v[68:71], v[84:87], v[188:191]
  v_mul_f32 v225, 0x6c800000, v125
  v_mfma_f32_16x16x32_bf16 v[204:207], v[72:75], v[80:83], v[204:207]
  v_mul_f32 v226, 0x6c800000, v126
  v_mfma_f32_16x16x32_bf16 v[204:207], v[76:79], v[84:87], v[204:207]
  v_mul_f32 v227, 0x6c800000, v127
  v_mfma_f32_16x16x32_bf16 v[208:211], v[72:75], v[88:91], v[208:211]
  v_mul_f32 v228, 0x6c800000, v128
  v_mfma_f32_16x16x32_bf16 v[208:211], v[76:79], v[92:95], v[208:211]
  v_mul_f32 v229, 0x6c800000, v129
  v_mfma_f32_16x16x32_bf16 v[212:215], v[72:75], v[96:99], v[212:215]
  v_mul_f32 v230, 0x6c800000, v130
  v_mfma_f32_16x16x32_bf16 v[212:215], v[76:79], v[100:103], v[212:215]
  v_mul_f32 v231, 0x6c800000, v131
  v_mfma_f32_16x16x32_bf16 v[216:219], v[72:75], v[104:107], v[216:219]
  s_setprio 2
  s_barrier
  v_mfma_f32_16x16x32_bf16 v[216:219], v[76:79], v[108:111], v[216:219]
  ds_read_b64_tr_b16 v[40:41], v1 offset:40960
  ds_read_b64_tr_b16 v[42:43], v1 offset:43520
  ds_read_b64_tr_b16 v[44:45], v6 offset:0
  ds_read_b64_tr_b16 v[46:47], v6 offset:2560
  ds_read_b64_tr_b16 v[48:49], v2 offset:40960
  ds_read_b64_tr_b16 v[50:51], v2 offset:43520
  ds_read_b64_tr_b16 v[52:53], v7 offset:0
  ds_read_b64_tr_b16 v[54:55], v7 offset:2560
  ds_read_b64_tr_b16 v[56:57], v3 offset:40960
  ds_read_b64_tr_b16 v[58:59], v3 offset:43520
  ds_read_b64_tr_b16 v[60:61], v8 offset:0
  ds_read_b64_tr_b16 v[62:63], v8 offset:2560
  ds_read_b64_tr_b16 v[64:65], v4 offset:40960
  ds_read_b64_tr_b16 v[66:67], v4 offset:43520
  ds_read_b64_tr_b16 v[68:69], v9 offset:0
  ds_read_b64_tr_b16 v[70:71], v9 offset:2560
  ds_read_b128 v[80:83], v11 offset:8192
  ds_read_b128 v[84:87], v12 offset:8192
  ds_read_b128 v[88:91], v11 offset:10240
  ds_read_b128 v[92:95], v12 offset:10240
  ds_read_b128 v[96:99], v11 offset:12288
  ds_read_b128 v[100:103], v12 offset:12288
  ds_read_b128 v[104:107], v11 offset:14336
  ds_read_b128 v[108:111], v12 offset:14336
  ds_read_b64_tr_b16 v[72:73], v5 offset:40960
  ds_read_b64_tr_b16 v[74:75], v5 offset:43520
  ds_read_b64_tr_b16 v[76:77], v10 offset:0
  ds_read_b64_tr_b16 v[78:79], v10 offset:2560
  s_waitcnt lgkmcnt(0)
  s_barrier
  v_mfma_f32_16x16x32_bf16 v[140:143], v[40:43], v[80:83], v[140:143]
  v_mfma_f32_16x16x32_bf16 v[140:143], v[44:47], v[84:87], v[140:143]
  v_mfma_f32_16x16x32_bf16 v[144:147], v[40:43], v[88:91], v[144:147]
  v_mfma_f32_16x16x32_bf16 v[144:147], v[44:47], v[92:95], v[144:147]
  s_nop 5
  v_mul_f32 v24, v140, v140
  v_mul_f32 v25, v141, v141
  v_mul_f32 v26, v142, v142
  v_mfma_f32_16x16x32_bf16 v[148:151], v[40:43], v[96:99], v[148:151]
  v_mul_f32 v27, v143, v143
  v_mul_f32 v28, v144, v144
  v_mfma_f32_16x16x32_bf16 v[148:151], v[44:47], v[100:103], v[148:151]
  v_mul_f32 v29, v145, v145
  v_mul_f32 v30, v146, v146
  v_mfma_f32_16x16x32_bf16 v[152:155], v[40:43], v[104:107], v[152:155]
  v_mul_f32 v31, v147, v147
  v_fma_f32 v24, v24, v234, v232
  v_mfma_f32_16x16x32_bf16 v[152:155], v[44:47], v[108:111], v[152:155]
  v_fma_f32 v25, v25, v234, v232
  v_fma_f32 v26, v26, v234, v232
  v_mfma_f32_16x16x32_bf16 v[168:171], v[48:51], v[104:107], v[168:171]
  v_fma_f32 v27, v27, v234, v232
  v_fma_f32 v28, v28, v234, v232
  v_mfma_f32_16x16x32_bf16 v[168:171], v[52:55], v[108:111], v[168:171]
  v_fma_f32 v29, v29, v234, v232
  v_fma_f32 v30, v30, v234, v232
  v_mfma_f32_16x16x32_bf16 v[164:167], v[48:51], v[96:99], v[164:167]
  v_fma_f32 v31, v31, v234, v232
  v_fma_f32 v24, v24, v140, v236
  v_mfma_f32_16x16x32_bf16 v[164:167], v[52:55], v[100:103], v[164:167]
  v_fma_f32 v25, v25, v141, v236
  v_fma_f32 v26, v26, v142, v236
  v_mfma_f32_16x16x32_bf16 v[160:163], v[48:51], v[88:91], v[160:163]
  v_fma_f32 v27, v27, v143, v236
  v_fma_f32 v28, v28, v144, v236
  v_mfma_f32_16x16x32_bf16 v[160:163], v[52:55], v[92:95], v[160:163]
  v_fma_f32 v29, v29, v145, v236
  v_fma_f32 v30, v30, v146, v236
  v_mfma_f32_16x16x32_bf16 v[156:159], v[48:51], v[80:83], v[156:159]
  v_fma_f32 v31, v31, v147, v236
  v_exp_f32 v24, v24 clamp
  v_mfma_f32_16x16x32_bf16 v[156:159], v[52:55], v[84:87], v[156:159]
  v_exp_f32 v25, v25 clamp
  v_mfma_f32_16x16x32_bf16 v[172:175], v[56:59], v[80:83], v[172:175]
  v_exp_f32 v26, v26 clamp
  v_mfma_f32_16x16x32_bf16 v[172:175], v[60:63], v[84:87], v[172:175]
  v_exp_f32 v27, v27 clamp
  v_mfma_f32_16x16x32_bf16 v[176:179], v[56:59], v[88:91], v[176:179]
  v_exp_f32 v28, v28 clamp
  v_mfma_f32_16x16x32_bf16 v[176:179], v[60:63], v[92:95], v[176:179]
  v_exp_f32 v29, v29 clamp
  v_mfma_f32_16x16x32_bf16 v[180:183], v[56:59], v[96:99], v[180:183]
  v_exp_f32 v30, v30 clamp
  v_mfma_f32_16x16x32_bf16 v[180:183], v[60:63], v[100:103], v[180:183]
  v_exp_f32 v31, v31 clamp
  v_mfma_f32_16x16x32_bf16 v[184:187], v[56:59], v[104:107], v[184:187]
  v_fma_f32 v24, v24, v132, v112
  v_fma_f32 v25, v25, v133, v113
  v_mfma_f32_16x16x32_bf16 v[184:187], v[60:63], v[108:111], v[184:187]
  v_fma_f32 v26, v26, v134, v114
  v_fma_f32 v27, v27, v135, v115
  v_mfma_f32_16x16x32_bf16 v[200:203], v[64:67], v[104:107], v[200:203]
  v_fma_f32 v28, v28, v132, v112
  v_fma_f32 v29, v29, v133, v113
  v_mfma_f32_16x16x32_bf16 v[200:203], v[68:71], v[108:111], v[200:203]
  v_fma_f32 v30, v30, v134, v114
  v_fma_f32 v31, v31, v135, v115
  v_mfma_f32_16x16x32_bf16 v[196:199], v[64:67], v[96:99], v[196:199]
  v_rcp_f32 v24, v24
  v_mfma_f32_16x16x32_bf16 v[196:199], v[68:71], v[100:103], v[196:199]
  v_rcp_f32 v25, v25
  v_mfma_f32_16x16x32_bf16 v[192:195], v[64:67], v[88:91], v[192:195]
  v_rcp_f32 v26, v26
  v_mfma_f32_16x16x32_bf16 v[192:195], v[68:71], v[92:95], v[192:195]
  v_rcp_f32 v27, v27
  v_mfma_f32_16x16x32_bf16 v[188:191], v[64:67], v[80:83], v[188:191]
  v_rcp_f32 v28, v28
  v_mfma_f32_16x16x32_bf16 v[188:191], v[68:71], v[84:87], v[188:191]
  v_rcp_f32 v29, v29
  v_mfma_f32_16x16x32_bf16 v[204:207], v[72:75], v[80:83], v[204:207]
  v_rcp_f32 v30, v30
  v_mfma_f32_16x16x32_bf16 v[204:207], v[76:79], v[84:87], v[204:207]
  v_rcp_f32 v31, v31
  v_mfma_f32_16x16x32_bf16 v[208:211], v[72:75], v[88:91], v[208:211]
  v_mul_f32 v16, v24, v140
  v_mul_f32 v17, v25, v141
  v_mfma_f32_16x16x32_bf16 v[208:211], v[76:79], v[92:95], v[208:211]
  v_fmac_f32 v16, v26, v142
  v_fmac_f32 v17, v27, v143
  v_mfma_f32_16x16x32_bf16 v[212:215], v[72:75], v[96:99], v[212:215]
  v_mul_f32 v18, v28, v144
  v_mul_f32 v19, v29, v145
  v_mfma_f32_16x16x32_bf16 v[212:215], v[76:79], v[100:103], v[212:215]
  v_fmac_f32 v18, v30, v146
  v_fmac_f32 v19, v31, v147
  v_mfma_f32_16x16x32_bf16 v[216:219], v[72:75], v[104:107], v[216:219]
  v_mfma_f32_16x16x32_bf16 v[216:219], v[76:79], v[108:111], v[216:219]
  s_setprio 0
L_epi:
  s_lshl_b32 s69, s27, 11
  s_and_b32 s71, s26, 3
  s_lshl_b32 s71, s71, 9
  s_add_u32 s69, s69, s71
  s_lshr_b32 s68, s26, 2
  s_lshl_b32 s68, s68, 14
  s_add_u32 s69, s69, s68
  v_lshlrev_b32 v3, 3, v0
  v_add_u32 v2, 156928, v3
  v_pk_mul_f32 v[40:41], v[148:149], v[148:149]
  v_pk_mul_f32 v[42:43], v[150:151], v[150:151]
  v_pk_mul_f32 v[46:47], v[152:153], v[152:153]
  v_pk_mul_f32 v[48:49], v[154:155], v[154:155]
  v_pk_fma_f32 v[40:41], v[40:41], v[234:235], v[232:233]
  v_pk_fma_f32 v[42:43], v[42:43], v[234:235], v[232:233]
  v_pk_fma_f32 v[46:47], v[46:47], v[234:235], v[232:233]
  v_pk_fma_f32 v[48:49], v[48:49], v[234:235], v[232:233]
  v_pk_fma_f32 v[40:41], v[40:41], v[148:149], v[236:237]
  v_pk_fma_f32 v[42:43], v[42:43], v[150:151], v[236:237]
  v_pk_fma_f32 v[46:47], v[46:47], v[152:153], v[236:237]
  v_pk_fma_f32 v[48:49], v[48:49], v[154:155], v[236:237]
  v_exp_f32 v40, v40 clamp
  v_exp_f32 v41, v41 clamp
  v_exp_f32 v42, v42 clamp
  v_exp_f32 v43, v43 clamp
  v_exp_f32 v46, v46 clamp
  v_exp_f32 v47, v47 clamp
  v_exp_f32 v48, v48 clamp
  v_exp_f32 v49, v49 clamp
  v_pk_fma_f32 v[40:41], v[40:41], v[132:133], v[112:113]
  v_pk_fma_f32 v[42:43], v[42:43], v[134:135], v[114:115]
  v_pk_fma_f32 v[46:47], v[46:47], v[132:133], v[112:113]
  v_pk_fma_f32 v[48:49], v[48:49], v[134:135], v[114:115]
  v_pk_mul_f32 v[44:45], v[148:149], v[42:43]
  v_pk_mul_f32 v[50:51], v[152:153], v[48:49]
  v_pk_fma_f32 v[44:45], v[150:151], v[40:41], v[44:45]
  v_pk_fma_f32 v[50:51], v[154:155], v[46:47], v[50:51]
  v_pk_mul_f32 v[40:41], v[40:41], v[42:43]
  v_pk_mul_f32 v[46:47], v[46:47], v[48:49]
  v_rcp_f32 v40, v40
  v_rcp_f32 v41, v41
  v_rcp_f32 v46, v46
  v_rcp_f32 v47, v47
  v_pk_mul_f32 v[20:21], v[40:41], v[44:45]
  v_pk_mul_f32 v[22:23], v[46:47], v[50:51]
  v_pk_mul_f32 v[64:65], v[156:157], v[156:157]
  v_pk_mul_f32 v[66:67], v[158:159], v[158:159]
  v_pk_mul_f32 v[70:71], v[160:161], v[160:161]
  v_pk_mul_f32 v[72:73], v[162:163], v[162:163]
  v_pk_mul_f32 v[76:77], v[164:165], v[164:165]
  v_pk_mul_f32 v[78:79], v[166:167], v[166:167]
  v_pk_mul_f32 v[82:83], v[168:169], v[168:169]
  v_pk_mul_f32 v[84:85], v[170:171], v[170:171]
  v_pk_fma_f32 v[64:65], v[64:65], v[234:235], v[232:233]
  v_pk_fma_f32 v[66:67], v[66:67], v[234:235], v[232:233]
  v_pk_fma_f32 v[70:71], v[70:71], v[234:235], v[232:233]
  v_pk_fma_f32 v[72:73], v[72:73], v[234:235], v[232:233]
  v_pk_fma_f32 v[76:77], v[76:77], v[234:235], v[232:233]
  v_pk_fma_f32 v[78:79], v[78:79], v[234:235], v[232:233]
  v_pk_fma_f32 v[82:83], v[82:83], v[234:235], v[232:233]
  v_pk_fma_f32 v[84:85], v[84:85], v[234:235], v[232:233]
  v_pk_fma_f32 v[64:65], v[64:65], v[156:157], v[236:237]
  v_pk_fma_f32 v[66:67], v[66:67], v[158:159], v[236:237]
  v_pk_fma_f32 v[70:71], v[70:71], v[160:161], v[236:237]
  v_pk_fma_f32 v[72:73], v[72:73], v[162:163], v[236:237]
  v_pk_fma_f32 v[76:77], v[76:77], v[164:165], v[236:237]
  v_pk_fma_f32 v[78:79], v[78:79], v[166:167], v[236:237]
  v_pk_fma_f32 v[82:83], v[82:83], v[168:169], v[236:237]
  v_pk_fma_f32 v[84:85], v[84:85], v[170:171], v[236:237]
  v_exp_f32 v64, v64 clamp
  v_exp_f32 v65, v65 clamp
  v_exp_f32 v66, v66 clamp
  v_exp_f32 v67, v67 clamp
  v_exp_f32 v70, v70 clamp
  v_exp_f32 v71, v71 clamp
  v_exp_f32 v72, v72 clamp
  v_exp_f32 v73, v73 clamp
  v_exp_f32 v76, v76 clamp
  v_exp_f32 v77, v77 clamp
  v_exp_f32 v78, v78 clamp
  v_exp_f32 v79, v79 clamp
  v_exp_f32 v82, v82 clamp
  v_exp_f32 v83, v83 clamp
  v_exp_f32 v84, v84 clamp
  v_exp_f32 v85, v85 clamp
  v_pk_fma_f32 v[64:65], v[64:65], v[136:137], v[116:117]
  v_pk_fma_f32 v[66:67], v[66:67], v[138:139], v[118:119]
  v_pk_fma_f32 v[70:71], v[70:71], v[136:137], v[116:117]
  v_pk_fma_f32 v[72:73], v[72:73], v[138:139], v[118:119]
  v_pk_fma_f32 v[76:77], v[76:77], v[136:137], v[116:117]
  v_pk_fma_f32 v[78:79], v[78:79], v[138:139], v[118:119]
  v_pk_fma_f32 v[82:83], v[82:83], v[136:137], v[116:117]
  v_pk_fma_f32 v[84:85], v[84:85], v[138:139], v[118:119]
  v_pk_mul_f32 v[68:69], v[156:157], v[66:67]
  v_pk_mul_f32 v[74:75], v[160:161], v[72:73]
  v_pk_mul_f32 v[80:81], v[164:165], v[78:79]
  v_pk_mul_f32 v[86:87], v[168:169], v[84:85]
  v_pk_fma_f32 v[68:69], v[158:159], v[64:65], v[68:69]
  v_pk_fma_f32 v[74:75], v[162:163], v[70:71], v[74:75]
  v_pk_fma_f32 v[80:81], v[166:167], v[76:77], v[80:81]
  v_pk_fma_f32 v[86:87], v[170:171], v[82:83], v[86:87]
  v_pk_mul_f32 v[64:65], v[64:65], v[66:67]
  v_pk_mul_f32 v[70:71], v[70:71], v[72:73]
  v_pk_mul_f32 v[76:77], v[76:77], v[78:79]
  v_pk_mul_f32 v[82:83], v[82:83], v[84:85]
  v_rcp_f32 v64, v64
  v_rcp_f32 v65, v65
  v_rcp_f32 v70, v70
  v_rcp_f32 v71, v71
  v_rcp_f32 v76, v76
  v_rcp_f32 v77, v77
  v_rcp_f32 v82, v82
  v_rcp_f32 v83, v83
  v_pk_fma_f32 v[16:17], v[64:65], v[68:69], v[16:17]
  v_pk_fma_f32 v[18:19], v[70:71], v[74:75], v[18:19]
  v_pk_fma_f32 v[20:21], v[76:77], v[80:81], v[20:21]
  v_pk_fma_f32 v[22:23], v[82:83], v[86:87], v[22:23]
  v_pk_mul_f32 v[40:41], v[172:173], v[172:173]
  v_pk_mul_f32 v[42:43], v[174:175], v[174:175]
  v_pk_mul_f32 v[46:47], v[176:177], v[176:177]
  v_pk_mul_f32 v[48:49], v[178:179], v[178:179]
  v_pk_mul_f32 v[52:53], v[180:181], v[180:181]
  v_pk_mul_f32 v[54:55], v[182:183], v[182:183]
  v_pk_mul_f32 v[58:59], v[184:185], v[184:185]
  v_pk_mul_f32 v[60:61], v[186:187], v[186:187]
  v_pk_fma_f32 v[40:41], v[40:41], v[234:235], v[232:233]
  v_pk_fma_f32 v[42:43], v[42:43], v[234:235], v[232:233]
  v_pk_fma_f32 v[46:47], v[46:47], v[234:235], v[232:233]
  v_pk_fma_f32 v[48:49], v[48:49], v[234:235], v[232:233]
  v_pk_fma_f32 v[52:53], v[52:53], v[234:235], v[232:233]
  v_pk_fma_f32 v[54:55], v[54:55], v[234:235], v[232:233]
  v_pk_fma_f32 v[58:59], v[58:59], v[234:235], v[232:233]
  v_pk_fma_f32 v[60:61], v[60:61], v[234:235], v[232:233]
  v_pk_fma_f32 v[40:41], v[40:41], v[172:173], v[236:237]
  v_pk_fma_f32 v[42:43], v[42:43], v[174:175], v[236:237]
  v_pk_fma_f32 v[46:47], v[46:47], v[176:177], v[236:237]
  v_pk_fma_f32 v[48:49], v[48:49], v[178:179], v[236:237]
  v_pk_fma_f32 v[52:53], v[52:53], v[180:181], v[236:237]
  v_pk_fma_f32 v[54:55], v[54:55], v[182:183], v[236:237]
  v_pk_fma_f32 v[58:59], v[58:59], v[184:185], v[236:237]
  v_pk_fma_f32 v[60:61], v[60:61], v[186:187], v[236:237]
  v_exp_f32 v40, v40 clamp
  v_exp_f32 v41, v41 clamp
  v_exp_f32 v42, v42 clamp
  v_exp_f32 v43, v43 clamp
  v_exp_f32 v46, v46 clamp
  v_exp_f32 v47, v47 clamp
  v_exp_f32 v48, v48 clamp
  v_exp_f32 v49, v49 clamp
  v_exp_f32 v52, v52 clamp
  v_exp_f32 v53, v53 clamp
  v_exp_f32 v54, v54 clamp
  v_exp_f32 v55, v55 clamp
  v_exp_f32 v58, v58 clamp
  v_exp_f32 v59, v59 clamp
  v_exp_f32 v60, v60 clamp
  v_exp_f32 v61, v61 clamp
  v_pk_fma_f32 v[40:41], v[40:41], v[220:221], v[120:121]
  v_pk_fma_f32 v[42:43], v[42:43], v[222:223], v[122:123]
  v_pk_fma_f32 v[46:47], v[46:47], v[220:221], v[120:121]
  v_pk_fma_f32 v[48:49], v[48:49], v[222:223], v[122:123]
  v_pk_fma_f32 v[52:53], v[52:53], v[220:221], v[120:121]
  v_pk_fma_f32 v[54:55], v[54:55], v[222:223], v[122:123]
  v_pk_fma_f32 v[58:59], v[58:59], v[220:221], v[120:121]
  v_pk_fma_f32 v[60:61], v[60:61], v[222:223], v[122:123]
  v_pk_mul_f32 v[44:45], v[172:173], v[42:43]
  v_pk_mul_f32 v[50:51], v[176:177], v[48:49]
  v_pk_mul_f32 v[56:57], v[180:181], v[54:55]
  v_pk_mul_f32 v[62:63], v[184:185], v[60:61]
  v_pk_fma_f32 v[44:45], v[174:175], v[40:41], v[44:45]
  v_pk_fma_f32 v[50:51], v[178:179], v[46:47], v[50:51]
  v_pk_fma_f32 v[56:57], v[182:183], v[52:53], v[56:57]
  v_pk_fma_f32 v[62:63], v[186:187], v[58:59], v[62:63]
  v_pk_mul_f32 v[40:41], v[40:41], v[42:43]
  v_pk_mul_f32 v[46:47], v[46:47], v[48:49]
  v_pk_mul_f32 v[52:53], v[52:53], v[54:55]
  v_pk_mul_f32 v[58:59], v[58:59], v[60:61]
  v_rcp_f32 v40, v40
  v_rcp_f32 v41, v41
  v_rcp_f32 v46, v46
  v_rcp_f32 v47, v47
  v_rcp_f32 v52, v52
  v_rcp_f32 v53, v53
  v_rcp_f32 v58, v58
  v_rcp_f32 v59, v59
  v_pk_fma_f32 v[16:17], v[40:41], v[44:45], v[16:17]
  v_pk_fma_f32 v[18:19], v[46:47], v[50:51], v[18:19]
  v_pk_fma_f32 v[20:21], v[52:53], v[56:57], v[20:21]
  v_pk_fma_f32 v[22:23], v[58:59], v[62:63], v[22:23]
  v_pk_mul_f32 v[64:65], v[188:189], v[188:189]
  v_pk_mul_f32 v[66:67], v[190:191], v[190:191]
  v_pk_mul_f32 v[70:71], v[192:193], v[192:193]
  v_pk_mul_f32 v[72:73], v[194:195], v[194:195]
  v_pk_mul_f32 v[76:77], v[196:197], v[196:197]
  v_pk_mul_f32 v[78:79], v[198:199], v[198:199]
  v_pk_mul_f32 v[82:83], v[200:201], v[200:201]
  v_pk_mul_f32 v[84:85], v[202:203], v[202:203]
  v_pk_fma_f32 v[64:65], v[64:65], v[234:235], v[232:233]
  v_pk_fma_f32 v[66:67], v[66:67], v[234:235], v[232:233]
  v_pk_fma_f32 v[70:71], v[70:71], v[234:235], v[232:233]
  v_pk_fma_f32 v[72:73], v[72:73], v[234:235], v[232:233]
  v_pk_fma_f32 v[76:77], v[76:77], v[234:235], v[232:233]
  v_pk_fma_f32 v[78:79], v[78:79], v[234:235], v[232:233]
  v_pk_fma_f32 v[82:83], v[82:83], v[234:235], v[232:233]
  v_pk_fma_f32 v[84:85], v[84:85], v[234:235], v[232:233]
  v_pk_fma_f32 v[64:65], v[64:65], v[188:189], v[236:237]
  v_pk_fma_f32 v[66:67], v[66:67], v[190:191], v[236:237]
  v_pk_fma_f32 v[70:71], v[70:71], v[192:193], v[236:237]
  v_pk_fma_f32 v[72:73], v[72:73], v[194:195], v[236:237]
  v_pk_fma_f32 v[76:77], v[76:77], v[196:197], v[236:237]
  v_pk_fma_f32 v[78:79], v[78:79], v[198:199], v[236:237]
  v_pk_fma_f32 v[82:83], v[82:83], v[200:201], v[236:237]
  v_pk_fma_f32 v[84:85], v[84:85], v[202:203], v[236:237]
  v_exp_f32 v64, v64 clamp
  v_exp_f32 v65, v65 clamp
  v_exp_f32 v66, v66 clamp
  v_exp_f32 v67, v67 clamp
  v_exp_f32 v70, v70 clamp
  v_exp_f32 v71, v71 clamp
  v_exp_f32 v72, v72 clamp
  v_exp_f32 v73, v73 clamp
  v_exp_f32 v76, v76 clamp
  v_exp_f32 v77, v77 clamp
  v_exp_f32 v78, v78 clamp
  v_exp_f32 v79, v79 clamp
  v_exp_f32 v82, v82 clamp
  v_exp_f32 v83, v83 clamp
  v_exp_f32 v84, v84 clamp
  v_exp_f32 v85, v85 clamp
  v_pk_fma_f32 v[64:65], v[64:65], v[224:225], v[124:125]
  v_pk_fma_f32 v[66:67], v[66:67], v[226:227], v[126:127]
  v_pk_fma_f32 v[70:71], v[70:71], v[224:225], v[124:125]
  v_pk_fma_f32 v[72:73], v[72:73], v[226:227], v[126:127]
  v_pk_fma_f32 v[76:77], v[76:77], v[224:225], v[124:125]
  v_pk_fma_f32 v[78:79], v[78:79], v[226:227], v[126:127]
  v_pk_fma_f32 v[82:83], v[82:83], v[224:225], v[124:125]
  v_pk_fma_f32 v[84:85], v[84:85], v[226:227], v[126:127]
  v_pk_mul_f32 v[68:69], v[188:189], v[66:67]
  v_pk_mul_f32 v[74:75], v[192:193], v[72:73]
  v_pk_mul_f32 v[80:81], v[196:197], v[78:79]
  v_pk_mul_f32 v[86:87], v[200:201], v[84:85]
  v_pk_fma_f32 v[68:69], v[190:191], v[64:65], v[68:69]
  v_pk_fma_f32 v[74:75], v[194:195], v[70:71], v[74:75]
  v_pk_fma_f32 v[80:81], v[198:199], v[76:77], v[80:81]
  v_pk_fma_f32 v[86:87], v[202:203], v[82:83], v[86:87]
  v_pk_mul_f32 v[64:65], v[64:65], v[66:67]
  v_pk_mul_f32 v[70:71], v[70:71], v[72:73]
  v_pk_mul_f32 v[76:77], v[76:77], v[78:79]
  v_pk_mul_f32 v[82:83], v[82:83], v[84:85]
  v_rcp_f32 v64, v64
  v_rcp_f32 v65, v65
  v_rcp_f32 v70, v70
  v_rcp_f32 v71, v71
  v_rcp_f32 v76, v76
  v_rcp_f32 v77, v77
  v_rcp_f32 v82, v82
  v_rcp_f32 v83, v83
  v_pk_fma_f32 v[16:17], v[64:65], v[68:69], v[16:17]
  v_pk_fma_f32 v[18:19], v[70:71], v[74:75], v[18:19]
  v_pk_fma_f32 v[20:21], v[76:77], v[80:81], v[20:21]
  v_pk_fma_f32 v[22:23], v[82:83], v[86:87], v[22:23]
  v_pk_mul_f32 v[40:41], v[204:205], v[204:205]
  v_pk_mul_f32 v[42:43], v[206:207], v[206:207]
  v_pk_mul_f32 v[46:47], v[208:209], v[208:209]
  v_pk_mul_f32 v[48:49], v[210:211], v[210:211]
  v_pk_mul_f32 v[52:53], v[212:213], v[212:213]
  v_pk_mul_f32 v[54:55], v[214:215], v[214:215]
  v_pk_mul_f32 v[58:59], v[216:217], v[216:217]
  v_pk_mul_f32 v[60:61], v[218:219], v[218:219]
  v_pk_fma_f32 v[40:41], v[40:41], v[234:235], v[232:233]
  v_pk_fma_f32 v[42:43], v[42:43], v[234:235], v[232:233]
  v_pk_fma_f32 v[46:47], v[46:47], v[234:235], v[232:233]
  v_pk_fma_f32 v[48:49], v[48:49], v[234:235], v[232:233]
  v_pk_fma_f32 v[52:53], v[52:53], v[234:235], v[232:233]
  v_pk_fma_f32 v[54:55], v[54:55], v[234:235], v[232:233]
  v_pk_fma_f32 v[58:59], v[58:59], v[234:235], v[232:233]
  v_pk_fma_f32 v[60:61], v[60:61], v[234:235], v[232:233]
  v_pk_fma_f32 v[40:41], v[40:41], v[204:205], v[236:237]
  v_pk_fma_f32 v[42:43], v[42:43], v[206:207], v[236:237]
  v_pk_fma_f32 v[46:47], v[46:47], v[208:209], v[236:237]
  v_pk_fma_f32 v[48:49], v[48:49], v[210:211], v[236:237]
  v_pk_fma_f32 v[52:53], v[52:53], v[212:213], v[236:237]
  v_pk_fma_f32 v[54:55], v[54:55], v[214:215], v[236:237]
  v_pk_fma_f32 v[58:59], v[58:59], v[216:217], v[236:237]
  v_pk_fma_f32 v[60:61], v[60:61], v[218:219], v[236:237]
  v_exp_f32 v40, v40 clamp
  v_exp_f32 v41, v41 clamp
  v_exp_f32 v42, v42 clamp
  v_exp_f32 v43, v43 clamp
  v_exp_f32 v46, v46 clamp
  v_exp_f32 v47, v47 clamp
  v_exp_f32 v48, v48 clamp
  v_exp_f32 v49, v49 clamp
  v_exp_f32 v52, v52 clamp
  v_exp_f32 v53, v53 clamp
  v_exp_f32 v54, v54 clamp
  v_exp_f32 v55, v55 clamp
  v_exp_f32 v58, v58 clamp
  v_exp_f32 v59, v59 clamp
  v_exp_f32 v60, v60 clamp
  v_exp_f32 v61, v61 clamp
  v_pk_fma_f32 v[40:41], v[40:41], v[228:229], v[128:129]
  v_pk_fma_f32 v[42:43], v[42:43], v[230:231], v[130:131]
  v_pk_fma_f32 v[46:47], v[46:47], v[228:229], v[128:129]
  v_pk_fma_f32 v[48:49], v[48:49], v[230:231], v[130:131]
  v_pk_fma_f32 v[52:53], v[52:53], v[228:229], v[128:129]
  v_pk_fma_f32 v[54:55], v[54:55], v[230:231], v[130:131]
  v_pk_fma_f32 v[58:59], v[58:59], v[228:229], v[128:129]
  v_pk_fma_f32 v[60:61], v[60:61], v[230:231], v[130:131]
  v_pk_mul_f32 v[44:45], v[204:205], v[42:43]
  v_pk_mul_f32 v[50:51], v[208:209], v[48:49]
  v_pk_mul_f32 v[56:57], v[212:213], v[54:55]
  v_pk_mul_f32 v[62:63], v[216:217], v[60:61]
  v_pk_fma_f32 v[44:45], v[206:207], v[40:41], v[44:45]
  v_pk_fma_f32 v[50:51], v[210:211], v[46:47], v[50:51]
  v_pk_fma_f32 v[56:57], v[214:215], v[52:53], v[56:57]
  v_pk_fma_f32 v[62:63], v[218:219], v[58:59], v[62:63]
  v_pk_mul_f32 v[40:41], v[40:41], v[42:43]
  v_pk_mul_f32 v[46:47], v[46:47], v[48:49]
  v_pk_mul_f32 v[52:53], v[52:53], v[54:55]
  v_pk_mul_f32 v[58:59], v[58:59], v[60:61]
  v_rcp_f32 v40, v40
  v_rcp_f32 v41, v41
  v_rcp_f32 v46, v46
  v_rcp_f32 v47, v47
  v_rcp_f32 v52, v52
  v_rcp_f32 v53, v53
  v_rcp_f32 v58, v58
  v_rcp_f32 v59, v59
  v_pk_fma_f32 v[16:17], v[40:41], v[44:45], v[16:17]
  v_pk_fma_f32 v[18:19], v[46:47], v[50:51], v[18:19]
  v_pk_fma_f32 v[20:21], v[52:53], v[56:57], v[20:21]
  v_pk_fma_f32 v[22:23], v[58:59], v[62:63], v[22:23]
  v_add_f32 v16, v16, v17
  v_add_f32 v18, v18, v19
  v_add_f32 v20, v20, v21
  v_add_f32 v22, v22, v23
  v_mul_f32 v16, v239, v16
  v_mul_f32 v18, v239, v18
  v_mul_f32 v20, v239, v20
  v_mul_f32 v22, v239, v22
  s_nop 0
  v_permlane32_swap_b32 v16, v20
  v_permlane32_swap_b32 v18, v22
  v_add_f32 v16, v16, v20
  v_add_f32 v18, v18, v22
  s_nop 1
  v_permlane16_swap_b32 v16, v18
  v_add_f32 v16, v16, v18
  ds_write_b32 v36, v16
  s_waitcnt lgkmcnt(0)
  s_cmp_eq_u32 s3, 0
  s_cbranch_scc1 L_dpub
  s_barrier
  s_endpgm
L_dpub:
  s_mov_b32 s60, s24
  s_and_b32 s61, s25, 0xffff
  s_mov_b32 s62, 268435456
  s_mov_b32 s63, 0x20000
  s_mov_b32 s64, s22
  s_and_b32 s65, s23, 0xffff
  s_mov_b32 s66, 256
  s_mov_b32 s67, 0x20000
  s_and_b32 s81, s2, 7
  s_waitcnt vmcnt(0)
  v_cmp_eq_u32 vcc, 0, v37
  s_nop 0
  s_bitcmp1_b32 vcc_lo, s81
  s_cbranch_scc0 L_dclr_ok
  s_mov_b32 s78, 0x40000
L_dclr:
  s_sub_u32 s78, s78, 1
  s_cbranch_scc1 L_dclr_ok
  v_lshlrev_b32 v37, 2, v0
  v_and_b32 v37, 31, v37
  buffer_load_dword v37, v37, s[64:67], 0 offen offset:128 sc1
  s_waitcnt vmcnt(0)
  v_cmp_eq_u32 vcc, 0, v37
  s_nop 0
  s_bitcmp1_b32 vcc_lo, s81
  s_cbranch_scc1 L_dclr
L_dclr_ok:
  s_barrier
  ds_read_b64 v[64:65], v2 offset:0
  ds_read_b64 v[66:67], v2 offset:512
  ds_read_b64 v[68:69], v2 offset:1024
  ds_read_b64 v[70:71], v2 offset:1536
  s_waitcnt lgkmcnt(2)
  v_pk_add_f32 v[64:65], v[64:65], v[66:67]
  s_waitcnt lgkmcnt(0)
  v_pk_add_f32 v[68:69], v[68:69], v[70:71]
  v_pk_add_f32 v[64:65], v[64:65], v[68:69]
  v_and_b32 v64, -2, v64
  v_and_b32 v65, -2, v65
  buffer_store_dwordx2 v[64:65], v3, s[60:63], s69 offen sc1
  s_endpgm
L_cin:
  s_and_b32 s68, s26, 3
  s_mul_i32 s68, s68, 3
  s_add_u32 s27, s68, s27
  s_sub_u32 s27, s27, 6
  s_and_b32 s79, s3, 3
  s_lshr_b32 s84, s3, 2
  s_lshl_b32 s100, s27, 3
  s_add_u32 s100, s100, s3
  s_mul_i32 s68, s100, 1280
  v_min_u32 v40, 9, v0
  v_lshlrev_b32 v40, 7, v40
  v_lshlrev_b32 v48, 4, v0
  s_lshl_b32 s95, s79, 10
  s_cmp_eq_u32 s79, 2
  s_cselect_b64 s[82:83], 0x3fffff, -1
  s_cmp_eq_u32 s79, 3
  s_cselect_b32 s96, 0, 32768
  s_add_u32 s96, s96, s95
  v_mov_b32 v2, 110464
  v_lshlrev_b32 v1, 20, v0
  v_add_u32 v1, 110464, v1
  v_and_b32 v44, 7, v0
  v_lshlrev_b32 v18, 4, v44
  v_and_b32 v44, 15, v0
  v_lshl_add_u32 v44, v44, 2, v2
  v_mov_b32 v3, 0
  ds_write_b32 v44, v3
  v_lshrrev_b32 v41, 5, v0
  v_and_b32 v42, 31, v0
  s_waitcnt lgkmcnt(0)
  v_mov_b32 v3, 1
  s_mov_b32 s36, s8
  s_and_b32 s37, s9, 0xffff
  s_mov_b32 s38, 105456
  s_mov_b32 s39, 0x20000
  buffer_load_dword v255, v40, s[36:39], s68 offen
  s_barrier
  v_add_u32 v248, s95, v48
  v_cmp_gt_u32 vcc, 1152, v248
  s_nop 1
  v_cndmask_b32 v248, 0, 4, vcc
  v_add_u32 v248, v248, v48
  s_cmp_lg_u32 s84, 0
  s_cbranch_scc1 L_g1a
  s_branch L_g0pf
L_g1a:
  s_setprio 1
  v_bfe_u32 v43, v0, 2, 2
  v_lshl_add_u32 v43, v41, 3, v43
  v_bfe_u32 v44, v0, 4, 1
  v_lshlrev_b32 v44, 5, v44
  v_and_b32 v45, 3, v0
  v_lshl_add_u32 v44, v45, 3, v44
  v_lshl_add_u32 v240, v43, 6, v44
  v_add_u32 v240, 106816, v240
  s_lshl_b32 s68, s79, 6
  s_add_u32 s68, s68, 36288
  v_add_u32 v44, s68, v44
  v_mul_u32_u24 v45, 1352, v43
  v_add_u32 v241, v44, v45
  v_add_u32 v45, 16, v43
  v_min_u32 v45, 25, v45
  v_mul_u32_u24 v45, 1352, v45
  v_add_u32 v242, v44, v45
  v_add_u32 v45, 20, v43
  v_min_u32 v45, 25, v45
  v_mul_u32_u24 v45, 1352, v45
  v_add_u32 v243, v44, v45
  s_lshl_b32 s68, s79, 5
  v_add_u32 v246, s68, v42
  v_mul_u32_u24 v43, 52, v246
  v_lshl_add_u32 v43, v41, 3, v43
  v_add_u32 v244, 71552, v43
  v_lshlrev_b32 v43, 1, v246
  v_add_u32 v245, 108864, v43
  v_mov_b32 v216, 0
  v_mov_b32 v217, 0
  v_lshlrev_b32 v43, 3, v0
  v_add_u32 v44, 106816, v43
  s_lshl_b32 s68, s79, 9
  v_add_u32 v44, s68, v44
  ds_write_b64 v44, v[216:217]
  v_lshl_add_u32 v43, v41, 7, v246
  s_mov_b32 s69, 2521
  s_mov_b32 s70, 106816
  v_mul_u32_u24 v44, s69, v43
  v_lshrrev_b32 v44, 16, v44
  v_mad_u32_u24 v44, v44, 12, s70
  v_lshl_add_u32 v68, v43, 1, v44
  v_add_u32 v43, 256, v43
  v_mul_u32_u24 v44, s69, v43
  v_lshrrev_b32 v44, 16, v44
  v_mad_u32_u24 v44, v44, 12, s70
  v_lshl_add_u32 v69, v43, 1, v44
  v_add_u32 v43, 256, v43
  v_mul_u32_u24 v44, s69, v43
  v_lshrrev_b32 v44, 16, v44
  v_mad_u32_u24 v44, v44, 12, s70
  v_lshl_add_u32 v70, v43, 1, v44
  v_mov_b32 v44, 676
  v_cmp_gt_u32 s[92:93], v44, v43
  v_add_u32 v43, 0, v246
  v_mul_u32_u24 v44, s69, v43
  v_lshrrev_b32 v44, 16, v44
  v_lshl_add_u32 v44, v44, 2, v244
  v_add_u32 v72, 0, v44
  v_add_u32 v43, 128, v246
  v_mul_u32_u24 v44, s69, v43
  v_lshrrev_b32 v44, 16, v44
  v_lshl_add_u32 v44, v44, 2, v244
  v_add_u32 v73, 6656, v44
  v_add_u32 v43, 256, v246
  v_mul_u32_u24 v44, s69, v43
  v_lshrrev_b32 v44, 16, v44
  v_lshl_add_u32 v44, v44, 2, v244
  v_add_u32 v74, 13312, v44
  v_add_u32 v43, 384, v246
  v_mul_u32_u24 v44, s69, v43
  v_lshrrev_b32 v44, 16, v44
  v_lshl_add_u32 v44, v44, 2, v244
  v_add_u32 v75, 19968, v44
  v_add_u32 v43, 512, v246
  v_mul_u32_u24 v44, s69, v43
  v_lshrrev_b32 v44, 16, v44
  v_lshl_add_u32 v44, v44, 2, v244
  v_add_u32 v76, 26624, v44
  v_add_u32 v43, 640, v246
  v_mul_u32_u24 v44, s69, v43
  v_lshrrev_b32 v44, 16, v44
  v_lshl_add_u32 v44, v44, 2, v244
  v_add_u32 v77, 33280, v44
  v_lshlrev_b32 v78, 4, v41
  v_add_u32 v78, 110376, v78
  v_lshlrev_b32 v79, 1, v0
  v_add_u32 v79, 110272, v79
  v_lshlrev_b32 v80, 6, v0
  v_add_u32 v80, 106868, v80
L_addrc:
  s_mul_i32 s69, s27, 2979
  s_lshr_b32 s69, s69, 6
  s_mul_i32 s98, s27, 44
  s_and_b32 s70, s2, 7
  s_add_u32 s85, s98, s3
  s_lshl_b32 s85, s85, 2
  s_lshl_b32 s98, s70, 14
  s_add_u32 s85, s85, s98
  s_add_u32 s85, s85, 10240
  s_mul_i32 s98, s27, 44
  s_lshl_b32 s77, s70, 9
  s_add_u32 s94, s77, s98
  s_add_u32 s77, s77, s69
  s_add_u32 s94, s94, s3
  s_mul_i32 s94, s94, 104
  s_lshl_b32 s98, s27, 2
  s_add_u32 s98, s98, s3
  s_add_u32 s98, s98, s70
  s_and_b32 s98, s98, 7
  s_mul_i32 s98, s98, 16640
  s_add_u32 s98, s98, 12288
  s_sub_u32 s72, 6, s84
  s_lshl_b32 s99, s84, 1
  s_mov_b32 s26, -1
  v_lshrrev_b32 v43, 3, v0
  v_min_u32 v43, 6, v43
  v_lshlrev_b32 v17, 4, v43
  s_mul_i32 s70, s70, 88
  s_add_u32 s70, s100, s70
  s_mov_b32 s71, 704
  v_mov_b32 v44, s70
  v_mad_u32_u24 v19, v0, s71, v44
  s_mul_i32 s70, s100, 104
  s_sub_u32 s70, s70, 313
  v_min_u32 v44, 16, v0
  v_mul_u32_u24 v45, 26, v44
  v_add_u32 v45, s70, v45
  v_cmp_lt_u32 vcc, 12, v44
  s_nop 1
  v_cndmask_b32 v19, v19, v45, vcc
  v_lshlrev_b32 v19, 7, v19
  s_mov_b32 s101, 638976
  s_mov_b32 s32, s6
  s_and_b32 s33, s7, 0xffff
  s_mov_b32 s34, 12800000
  s_mov_b32 s35, 0x20000
  s_mov_b32 s44, s12
  s_and_b32 s45, s13, 0xffff
  s_mov_b32 s46, 5537792
  s_mov_b32 s47, 0x20000
  s_mov_b32 s28, s4
  s_and_b32 s29, s5, 0xffff
  s_mov_b32 s30, 425984
  s_mov_b32 s31, 0x20000
  s_and_b32 s70, s3, 1
  s_lshl_b32 s70, s70, 1
  v_add_u32 v46, s70, v41
  v_min_u32 v43, 25, v42
  s_mul_i32 s68, s84, 4
  s_add_u32 s68, s68, 1352
  s_mul_i32 s69, s84, 70528
  s_add_u32 s69, s69, 1024
  v_mul_u32_u24 v44, s68, v43
  v_add_u32 v44, s69, v44
  v_lshlrev_b32 v247, 2, v43
  v_add_u32 v247, 70528, v247
  s_lshl_b32 s68, s84, 2
  s_xor_b32 s68, s68, 4
  v_lshrrev_b32 v45, 2, v43
  v_and_b32 v45, s68, v45
  v_add_u32 v44, v44, v45
  v_sub_u32 v247, v247, v45
  v_mul_u32_u24 v65, 52, v43
  v_lshl_add_u32 v65, v46, 1, v65
  v_add_u32 v65, 108864, v65
  v_lshlrev_b32 v67, 1, v43
  v_add_u32 v67, 110272, v67
  v_mad_u32_u24 v60, v46, 52, v44
  v_lshl_add_u32 v61, v46, 1, v44
  v_lshl_add_u32 v49, v46, 1, v60
  v_lshlrev_b32 v43, 3, v46
  s_mov_b32 s68, 0x01000100
  v_bfe_i32 v45, s68, v43, 8
  v_lshl_add_u32 v50, v45, 1, v60
  v_mad_i32_i24 v51, v45, 52, v61
  s_mov_b32 s68, 0xff00ff00
  v_bfe_i32 v45, s68, v43, 8
  v_lshl_add_u32 v52, v45, 1, v60
  v_mad_i32_i24 v53, v45, 52, v61
  s_mov_b32 s68, 0xff020100
  v_bfe_i32 v45, s68, v43, 8
  v_lshl_add_u32 v54, v45, 1, v60
  v_mad_i32_i24 v55, v45, 52, v61
  s_mov_b32 s68, 0x0b0a0100
  v_bfe_i32 v45, s68, v43, 8
  v_lshl_add_u32 v56, v45, 1, v60
  v_mad_i32_i24 v57, v45, 52, v61
  s_mov_b32 s68, 0xf3f20100
  v_bfe_i32 v45, s68, v43, 8
  v_lshl_add_u32 v58, v45, 1, v60
  v_mad_i32_i24 v59, v45, 52, v61
  s_mov_b32 s68, 0x00023600
  v_bfe_u32 v45, s68, v43, 8
  v_add_u32 v60, v45, v44
  v_add_u32 v61, 52, v44
  v_mov_b32 v47, 1048576
  v_cmp_eq_u32 vcc, 3, v46
  s_nop 1
  v_cndmask_b32 v60, v60, v47, vcc
  v_cndmask_b32 v67, v47, v67, vcc
  v_cmp_eq_u32 vcc, 2, v46
  s_nop 1
  v_cndmask_b32 v61, v47, v61, vcc
  v_cmp_gt_u32 vcc, 2, v46
  s_nop 1
  v_cndmask_b32 v64, v47, v65, vcc
  s_lshr_b32 s69, s79, 1
  s_mul_i32 s69, s69, 6144
  s_mul_i32 s68, s84, 6144
  v_lshlrev_b32 v45, 8, v46
  v_lshl_add_u32 v43, v42, 4, v45
  v_add_u32 v63, 1024, v43
  v_add_u32 v66, 36288, v43
  v_bfe_u32 v43, v0, 2, 2
  v_lshl_add_u32 v45, v43, 4, v45
  v_and_b32 v43, 3, v0
  v_lshl_add_u32 v44, v43, 6, v45
  v_add_u32 v44, 12288, v44
  v_cmp_lt_u32 vcc, 15, v42
  s_nop 1
  v_cndmask_b32 v63, v63, v44, vcc
  v_add_u32 v44, 16, v44
  v_cndmask_b32 v66, v66, v44, vcc
  v_lshl_add_u32 v44, v43, 5, v45
  v_add_u32 v44, 24560, v44
  v_cmp_lt_u32 vcc, 19, v42
  s_nop 1
  v_cndmask_b32 v63, v63, v44, vcc
  v_add_u32 v63, s69, v63
  v_add_u32 v66, s68, v66
  v_cmp_lt_u32 vcc, 25, v42
  s_nop 1
  v_cndmask_b32 v63, v63, v47, vcc
  v_cndmask_b32 v66, v66, v47, vcc
  v_mov_b32 v62, 0
  s_mul_i32 s74, s3, 4224
  s_add_u32 s74, s74, 111040
  s_mov_b32 s75, -39488
  v_add_u32 v28, 1024, v48
  v_and_b32 v43, 11, v0
  v_cmp_eq_u32 vcc, 11, v43
  s_nop 1
  v_cndmask_b32 v31, v28, v47, vcc
  v_and_b32 v43, 3, v0
  v_cmp_eq_u32 vcc, 0, v43
  s_nop 1
  v_cndmask_b32 v30, v31, v47, vcc
  v_lshrrev_b32 v46, 4, v0
  v_bfe_u32 v43, v0, 1, 3
  v_lshlrev_b32 v45, 4, v43
  v_add_u32 v45, 24576, v45
  v_and_b32 v43, 10, v0
  v_cmp_eq_u32 vcc, 10, v43
  s_nop 1
  v_cndmask_b32 v45, v45, v47, vcc
  v_and_b32 v44, 1, v0
  v_lshl_add_u32 v29, v46, 9, v45
  v_lshl_add_u32 v29, v44, 2, v29
  v_add_u32 v29, 1024, v29
  v_lshl_add_u32 v22, v46, 8, v45
  v_lshl_add_u32 v22, v44, 20, v22
  v_and_b32 v47, 15, v0
  s_mov_b32 s68, 1056
  v_lshlrev_b32 v43, 1, v47
  v_add_u32 v43, s74, v43
  v_mad_u32_u24 v7, v46, s68, v43
  s_lshl_b32 s68, s3, 10
  s_add_u32 s68, s68, 144832
  v_add_u32 v10, s68, v48
  v_add_u32 v43, 256, v48
  v_and_b32 v43, 1023, v43
  v_add_u32 v11, s68, v43
  v_xor_b32 v43, 512, v48
  v_add_u32 v12, s68, v43
  v_lshlrev_b32 v13, 4, v41
  v_mov_b32 v32, 0
  v_mov_b32 v33, 0
  v_mov_b32 v34, 0
  v_mov_b32 v35, 0
  v_mov_b32 v36, 0
  v_mov_b32 v37, 0
  v_mov_b32 v38, 0
  v_mov_b32 v39, 0
  v_mov_b32 v216, 0
  v_mov_b32 v217, 0
  v_mov_b32 v218, 0
  v_mov_b32 v219, 0
  v_mov_b32 v220, 0
  v_mov_b32 v221, 0
  v_mov_b32 v222, 0
  v_mov_b32 v223, 0
  v_mov_b32 v224, 0
  v_mov_b32 v225, 0
  v_mov_b32 v226, 0
  v_mov_b32 v227, 0
  v_mov_b32 v228, 0
  v_mov_b32 v229, 0
  v_mov_b32 v230, 0
  v_mov_b32 v231, 0
  v_mov_b32 v232, 0
  v_mov_b32 v233, 0
  v_mov_b32 v234, 0
  v_mov_b32 v235, 0
  v_mov_b32 v236, 0
  v_mov_b32 v237, 0
  v_mov_b32 v238, 0
  v_mov_b32 v239, 0
  v_mul_u32_u24 v44, 1056, v46
  v_bfe_u32 v45, v0, 2, 2
  v_lshl_add_u32 v44, v45, 7, v44
  v_and_b32 v45, 3, v0
  v_lshl_add_u32 v9, v45, 3, v44
  v_add_u32 v8, s74, v9
  v_and_b32 v45, 1, v0
  s_mov_b32 s68, 0xaaaaaaaa
  v_mul_lo_u32 v16, s68, v45
  v_or_b32 v16, 0x44444444, v16
  v_lshlrev_b32 v15, 1, v0
  v_add_u32 v15, s74, v15
  v_mov_b32 v14, 0x3f80
  ds_write_b16 v15, v14 offset:4064
  v_add_u32 v15, s75, v15
  s_mul_i32 s71, s3, 6
  s_add_u32 s77, s77, s71
  s_mul_i32 s77, s77, 104
  s_add_u32 s73, s77, 80
  s_add_u32 s77, s77, 16
  s_mov_b32 s71, 10923
  v_min_u32 v43, 35, v0
  v_mul_u32_u24 v44, s71, v43
  v_lshrrev_b32 v44, 16, v44
  v_mul_u32_u24 v44, 80, v44
  v_lshl_add_u32 v20, v43, 2, v44
  s_waitcnt lgkmcnt(0)
  ds_add_u32 v1, v3 offset:0
  s_sub_u32 s94, s94, 416
  buffer_load_dwordx4 v[204:207], v17, s[28:31], s94 offen offset:0
  s_add_u32 s94, s94, 416
  buffer_load_dwordx4 v[24:27], v17, s[28:31], s94 offen offset:0
  s_add_u32 s94, s94, 832
  s_sub_u32 s68, s77, 2496
  buffer_load_dword v208, v20, s[28:31], s68 offen
  buffer_load_dword v209, v20, s[28:31], s77 offen
  s_add_u32 s77, s77, 24
  buffer_load_dword v21, v20, s[28:31], s77 offen
  s_cmp_eq_u32 s77, s73
  s_cselect_b32 s73, 0x7000000, s73
  s_cselect_b32 s77, 0x7000000, s77
  s_add_u32 s77, s77, 24
  s_min_u32 s77, s77, s73
L_csync1:
  ds_read_b32 v4, v2 offset:0
  s_waitcnt lgkmcnt(0)
  v_cmp_gt_u32 vcc, 8, v4
  s_cbranch_vccnz L_csync1
  ds_read_b64 v[132:133], v78 offset:0
  ds_read_b64 v[134:135], v78 offset:8
  ds_read_b64 v[136:137], v78 offset:32
  ds_read_b64 v[138:139], v78 offset:40
  ds_read_u16 v45, v79 offset:52
  ds_read_b64_tr_b16 v[84:85], v241 offset:35264
  ds_read_b64_tr_b16 v[86:87], v241 offset:40672
  ds_read_b64_tr_b16 v[88:89], v242 offset:35264
  ds_read_b64_tr_b16 v[90:91], v243 offset:35264
  ds_read_b64_tr_b16 v[92:93], v241 offset:35520
  ds_read_b64_tr_b16 v[94:95], v241 offset:40928
  ds_read_b64_tr_b16 v[96:97], v242 offset:35520
  ds_read_b64_tr_b16 v[98:99], v243 offset:35520
  ds_read_b64_tr_b16 v[100:101], v241 offset:35776
  ds_read_b64_tr_b16 v[102:103], v241 offset:41184
  ds_read_b64_tr_b16 v[104:105], v242 offset:35776
  ds_read_b64_tr_b16 v[106:107], v243 offset:35776
  ds_read_b64_tr_b16 v[108:109], v241 offset:36032
  ds_read_b64_tr_b16 v[110:111], v241 offset:41440
  ds_read_b64_tr_b16 v[112:113], v242 offset:36032
  ds_read_b64_tr_b16 v[114:115], v243 offset:36032
  s_waitcnt lgkmcnt(14)
  v_mfma_f32_32x32x16_bf16 v[140:155], v[132:135], v[84:87], 0
  s_waitcnt lgkmcnt(12)
  v_mfma_f32_32x32x16_bf16 v[140:155], v[136:139], v[88:91], v[140:155]
  ds_read_b64_tr_b16 v[116:117], v241 offset:36288
  ds_read_b64_tr_b16 v[118:119], v241 offset:41696
  ds_read_b64_tr_b16 v[120:121], v242 offset:36288
  ds_read_b64_tr_b16 v[122:123], v243 offset:36288
  s_waitcnt lgkmcnt(14)
  v_mfma_f32_32x32x16_bf16 v[156:171], v[132:135], v[92:95], 0
  s_waitcnt lgkmcnt(12)
  v_mfma_f32_32x32x16_bf16 v[156:171], v[136:139], v[96:99], v[156:171]
  ds_read_b64_tr_b16 v[124:125], v241 offset:36544
  ds_read_b64_tr_b16 v[126:127], v241 offset:41952
  ds_read_b64_tr_b16 v[128:129], v242 offset:36544
  ds_read_b64_tr_b16 v[130:131], v243 offset:36544
  s_waitcnt lgkmcnt(14)
  v_mfma_f32_32x32x16_bf16 v[172:187], v[132:135], v[100:103], 0
  s_waitcnt lgkmcnt(12)
  v_mfma_f32_32x32x16_bf16 v[172:187], v[136:139], v[104:107], v[172:187]
  v_cvt_pk_bf16_f32 v81, v140, 0
  s_waitcnt lgkmcnt(10)
  v_mfma_f32_32x32x16_bf16 v[188:203], v[132:135], v[108:111], 0
  s_waitcnt lgkmcnt(8)
  v_mfma_f32_32x32x16_bf16 v[188:203], v[136:139], v[112:115], v[188:203]
  s_mov_b32 exec_lo, 0
  v_cvt_pk_bf16_f32 v81, v156, 0
  s_mov_b32 exec_lo, -1
  ds_write_b16 v68, v81
  s_waitcnt lgkmcnt(7)
  v_mfma_f32_32x32x16_bf16 v[140:155], v[132:135], v[116:119], 0
  s_waitcnt lgkmcnt(5)
  v_mfma_f32_32x32x16_bf16 v[140:155], v[136:139], v[120:123], v[140:155]
  v_cvt_pk_bf16_f32 v82, v172, 0
  s_waitcnt lgkmcnt(3)
  v_mfma_f32_32x32x16_bf16 v[156:171], v[132:135], v[124:127], 0
  s_waitcnt lgkmcnt(1)
  v_mfma_f32_32x32x16_bf16 v[156:171], v[136:139], v[128:131], v[156:171]
  s_mov_b32 exec_lo, 0
  v_cvt_pk_bf16_f32 v82, v188, 0
  s_mov_b32 exec_lo, -1
  ds_write_b16 v69, v82
  s_nop 2
  v_cvt_pk_bf16_f32 v83, v140, 0
  s_mov_b32 exec_lo, 0
  s_nop 2
  v_cvt_pk_bf16_f32 v83, v156, 0
  s_mov_b64 exec, s[92:93]
  ds_write_b16 v70, v83
  s_mov_b64 exec, 0x3ffffff
  ds_write_b16 v80, v45
  s_mov_b64 exec, -1
  s_waitcnt lgkmcnt(0)
  ds_add_u32 v1, v3 offset:32
  v_cmp_gt_u32 s[92:93], 36, v246
L_csync2:
  ds_read_b32 v4, v2 offset:4
  s_waitcnt lgkmcnt(0)
  v_cmp_gt_u32 vcc, 4, v4
  s_cbranch_vccnz L_csync2
  ds_read_b64_tr_b16 v[84:85], v241 offset:0
  ds_read_b64_tr_b16 v[86:87], v241 offset:5408
  ds_read_b64_tr_b16 v[88:89], v242 offset:0
  ds_read_b64_tr_b16 v[90:91], v243 offset:0
  ds_read_b64_tr_b16 v[92:93], v241 offset:256
  ds_read_b64_tr_b16 v[94:95], v241 offset:5664
  ds_read_b64_tr_b16 v[96:97], v242 offset:256
  ds_read_b64_tr_b16 v[98:99], v243 offset:256
  ds_read_b64_tr_b16 v[100:101], v241 offset:512
  ds_read_b64_tr_b16 v[102:103], v241 offset:5920
  ds_read_b64_tr_b16 v[104:105], v242 offset:512
  ds_read_b64_tr_b16 v[106:107], v243 offset:512
  ds_read_b64_tr_b16 v[108:109], v241 offset:768
  ds_read_b64_tr_b16 v[110:111], v241 offset:6176
  ds_read_b64_tr_b16 v[112:113], v242 offset:768
  ds_read_b64_tr_b16 v[114:115], v243 offset:768
  ds_read_b64_tr_b16 v[116:117], v241 offset:1024
  ds_read_b64_tr_b16 v[118:119], v241 offset:6432
  ds_read_b64_tr_b16 v[120:121], v242 offset:1024
  ds_read_b64_tr_b16 v[122:123], v243 offset:1024
  ds_read_b64_tr_b16 v[124:125], v241 offset:1280
  ds_read_b64_tr_b16 v[126:127], v241 offset:6688
  ds_read_b64_tr_b16 v[128:129], v242 offset:1280
  ds_read_b64_tr_b16 v[130:131], v243 offset:1280
L_csync3:
  ds_read_b32 v4, v2 offset:32
  s_waitcnt lgkmcnt(0)
  v_cmp_gt_u32 vcc, 4, v4
  s_cbranch_vccnz L_csync3
  s_setprio 0
  s_waitcnt vmcnt(2)
  v_lshlrev_b32 v208, 7, v208
  buffer_load_dword v255, v208, s[32:35], 0 offen
  s_waitcnt vmcnt(2)
  v_lshlrev_b32 v209, 7, v209
  buffer_load_dword v255, v209, s[32:35], 0 offen
  s_mov_b64 exec, 131071
  buffer_load_dword v255, v19, s[44:47], s101 offen
  s_mov_b64 exec, -1
  s_add_u32 s101, s101, 1171456
  ds_read_b64_tr_b16 v[132:133], v240 offset:0
  ds_read_b64_tr_b16 v[134:135], v240 offset:256
  ds_read_b64_tr_b16 v[136:137], v240 offset:1024
  ds_read_b64_tr_b16 v[138:139], v240 offset:1280
  s_waitcnt lgkmcnt(2)
  v_mfma_f32_32x32x16_bf16 v[140:155], v[132:135], v[84:87], 0
  s_waitcnt lgkmcnt(0)
  v_mfma_f32_32x32x16_bf16 v[140:155], v[136:139], v[88:91], v[140:155]
  v_mfma_f32_32x32x16_bf16 v[156:171], v[132:135], v[92:95], 0
  v_mfma_f32_32x32x16_bf16 v[156:171], v[136:139], v[96:99], v[156:171]
  v_mfma_f32_32x32x16_bf16 v[172:187], v[132:135], v[100:103], 0
  v_mfma_f32_32x32x16_bf16 v[172:187], v[136:139], v[104:107], v[172:187]
  s_nop 7
  v_cvt_pk_bf16_f32 v84, v140, v141
  v_cvt_pk_bf16_f32 v85, v142, v143
  v_cvt_pk_bf16_f32 v86, v144, v145
  v_cvt_pk_bf16_f32 v87, v146, v147
  v_cvt_pk_bf16_f32 v88, v148, v149
  v_cvt_pk_bf16_f32 v89, v150, v151
  v_cvt_pk_bf16_f32 v90, v152, v153
  v_cvt_pk_bf16_f32 v91, v154, v155
  ds_write2_b32 v72, v84, v85 offset0:0 offset1:1
  v_max3_f32 v62, v62, abs(v140), abs(v141)
  v_max3_f32 v62, v62, abs(v142), abs(v143)
  v_max3_f32 v62, v62, abs(v144), abs(v145)
  ds_write2_b32 v72, v86, v87 offset0:4 offset1:5
  v_max3_f32 v62, v62, abs(v146), abs(v147)
  v_max3_f32 v62, v62, abs(v148), abs(v149)
  ds_write2_b32 v72, v88, v89 offset0:8 offset1:9
  v_max3_f32 v62, v62, abs(v150), abs(v151)
  v_max3_f32 v62, v62, abs(v152), abs(v153)
  v_mfma_f32_32x32x16_bf16 v[188:203], v[132:135], v[108:111], 0
  v_mfma_f32_32x32x16_bf16 v[188:203], v[136:139], v[112:115], v[188:203]
  v_cvt_pk_bf16_f32 v92, v156, v157
  v_cvt_pk_bf16_f32 v93, v158, v159
  v_cvt_pk_bf16_f32 v94, v160, v161
  v_cvt_pk_bf16_f32 v95, v162, v163
  v_cvt_pk_bf16_f32 v96, v164, v165
  v_cvt_pk_bf16_f32 v97, v166, v167
  v_cvt_pk_bf16_f32 v98, v168, v169
  v_cvt_pk_bf16_f32 v99, v170, v171
  ds_write2_b32 v73, v92, v93 offset0:0 offset1:1
  v_max3_f32 v62, v62, abs(v156), abs(v157)
  v_max3_f32 v62, v62, abs(v158), abs(v159)
  v_max3_f32 v62, v62, abs(v160), abs(v161)
  ds_write2_b32 v73, v94, v95 offset0:4 offset1:5
  v_max3_f32 v62, v62, abs(v162), abs(v163)
  v_max3_f32 v62, v62, abs(v164), abs(v165)
  ds_write2_b32 v73, v96, v97 offset0:8 offset1:9
  v_max3_f32 v62, v62, abs(v166), abs(v167)
  v_max3_f32 v62, v62, abs(v168), abs(v169)
  v_mfma_f32_32x32x16_bf16 v[140:155], v[132:135], v[116:119], 0
  v_mfma_f32_32x32x16_bf16 v[140:155], v[136:139], v[120:123], v[140:155]
  v_cvt_pk_bf16_f32 v100, v172, v173
  v_cvt_pk_bf16_f32 v101, v174, v175
  v_cvt_pk_bf16_f32 v102, v176, v177
  v_cvt_pk_bf16_f32 v103, v178, v179
  v_cvt_pk_bf16_f32 v104, v180, v181
  v_cvt_pk_bf16_f32 v105, v182, v183
  v_cvt_pk_bf16_f32 v106, v184, v185
  v_cvt_pk_bf16_f32 v107, v186, v187
  ds_write2_b32 v74, v100, v101 offset0:0 offset1:1
  v_max3_f32 v62, v62, abs(v172), abs(v173)
  v_max3_f32 v62, v62, abs(v174), abs(v175)
  v_max3_f32 v62, v62, abs(v176), abs(v177)
  ds_write2_b32 v74, v102, v103 offset0:4 offset1:5
  v_max3_f32 v62, v62, abs(v178), abs(v179)
  v_max3_f32 v62, v62, abs(v180), abs(v181)
  ds_write2_b32 v74, v104, v105 offset0:8 offset1:9
  v_max3_f32 v62, v62, abs(v182), abs(v183)
  v_max3_f32 v62, v62, abs(v184), abs(v185)
  v_mfma_f32_32x32x16_bf16 v[156:171], v[132:135], v[124:127], 0
  v_mfma_f32_32x32x16_bf16 v[156:171], v[136:139], v[128:131], v[156:171]
  v_cvt_pk_bf16_f32 v108, v188, v189
  v_cvt_pk_bf16_f32 v109, v190, v191
  v_cvt_pk_bf16_f32 v110, v192, v193
  v_cvt_pk_bf16_f32 v111, v194, v195
  v_cvt_pk_bf16_f32 v112, v196, v197
  v_cvt_pk_bf16_f32 v113, v198, v199
  v_cvt_pk_bf16_f32 v114, v200, v201
  v_cvt_pk_bf16_f32 v115, v202, v203
  ds_write2_b32 v75, v108, v109 offset0:0 offset1:1
  v_max3_f32 v62, v62, abs(v188), abs(v189)
  v_max3_f32 v62, v62, abs(v190), abs(v191)
  v_max3_f32 v62, v62, abs(v192), abs(v193)
  ds_write2_b32 v75, v110, v111 offset0:4 offset1:5
  v_max3_f32 v62, v62, abs(v194), abs(v195)
  v_max3_f32 v62, v62, abs(v196), abs(v197)
  ds_write2_b32 v75, v112, v113 offset0:8 offset1:9
  v_max3_f32 v62, v62, abs(v198), abs(v199)
  v_max3_f32 v62, v62, abs(v200), abs(v201)
  v_cvt_pk_bf16_f32 v116, v140, v141
  v_cvt_pk_bf16_f32 v117, v142, v143
  v_cvt_pk_bf16_f32 v118, v144, v145
  v_cvt_pk_bf16_f32 v119, v146, v147
  v_cvt_pk_bf16_f32 v120, v148, v149
  v_cvt_pk_bf16_f32 v121, v150, v151
  v_cvt_pk_bf16_f32 v122, v152, v153
  v_cvt_pk_bf16_f32 v123, v154, v155
  ds_write2_b32 v76, v116, v117 offset0:0 offset1:1
  v_max3_f32 v62, v62, abs(v140), abs(v141)
  v_max3_f32 v62, v62, abs(v142), abs(v143)
  v_max3_f32 v62, v62, abs(v144), abs(v145)
  ds_write2_b32 v76, v118, v119 offset0:4 offset1:5
  v_max3_f32 v62, v62, abs(v146), abs(v147)
  v_max3_f32 v62, v62, abs(v148), abs(v149)
  ds_write2_b32 v76, v120, v121 offset0:8 offset1:9
  v_max3_f32 v62, v62, abs(v150), abs(v151)
  v_max3_f32 v62, v62, abs(v152), abs(v153)
  v_cvt_pk_bf16_f32 v124, v156, v157
  v_cvt_pk_bf16_f32 v125, v158, v159
  v_cvt_pk_bf16_f32 v126, v160, v161
  v_cvt_pk_bf16_f32 v127, v162, v163
  v_cvt_pk_bf16_f32 v128, v164, v165
  v_cvt_pk_bf16_f32 v129, v166, v167
  v_cvt_pk_bf16_f32 v130, v168, v169
  v_cvt_pk_bf16_f32 v131, v170, v171
  s_mov_b64 exec, s[92:93]
  ds_write2_b32 v77, v124, v125 offset0:0 offset1:1
  v_max3_f32 v62, v62, abs(v156), abs(v157)
  v_max3_f32 v62, v62, abs(v158), abs(v159)
  v_max3_f32 v62, v62, abs(v160), abs(v161)
  ds_write2_b32 v77, v126, v127 offset0:4 offset1:5
  v_max3_f32 v62, v62, abs(v162), abs(v163)
  v_max3_f32 v62, v62, abs(v164), abs(v165)
  ds_write2_b32 v77, v128, v129 offset0:8 offset1:9
  v_max3_f32 v62, v62, abs(v166), abs(v167)
  v_max3_f32 v62, v62, abs(v168), abs(v169)
  s_mov_b32 exec_hi, 0
  ds_write_b32 v77, v130 offset:48
  ds_write_b16 v245, v131 offset:1280
  s_mov_b32 exec_lo, -1
  ds_write_b32 v76, v122 offset:48
  ds_write_b16 v245, v123 offset:1024
  ds_write_b32 v75, v114 offset:48
  ds_write_b16 v245, v115 offset:768
  ds_write_b32 v74, v106 offset:48
  ds_write_b16 v245, v107 offset:512
  ds_write_b32 v73, v98 offset:48
  ds_write_b16 v245, v99 offset:256
  ds_write_b32 v72, v90 offset:48
  ds_write_b16 v245, v91 offset:0
  s_mov_b64 exec, -1
  v_max_u32_dpp v62, v62, v62 row_shr:1 row_mask:0xf bank_mask:0xf
  s_nop 1
  v_max_u32_dpp v62, v62, v62 row_shr:2 row_mask:0xf bank_mask:0xf
  s_nop 1
  v_max_u32_dpp v62, v62, v62 row_shr:4 row_mask:0xf bank_mask:0xf
  s_nop 1
  v_max_u32_dpp v62, v62, v62 row_shr:8 row_mask:0xf bank_mask:0xf
  s_nop 1
  v_max_u32_dpp v62, v62, v62 row_bcast:15 row_mask:0xa bank_mask:0xf
  s_nop 1
  v_max_u32_dpp v62, v62, v62 row_bcast:31 row_mask:0xc bank_mask:0xf
  s_nop 0
  v_readlane_b32 s68, v62, 63
  s_nop 1
  v_mov_b32 v62, s68
  ds_max_u32 v1, v62 offset:28
  ds_add_u32 v1, v3 offset:24
  s_setprio 0
  v_lshl_add_u32 v24, v24, 7, v18
  v_lshl_add_u32 v25, v25, 7, v18
  s_mov_b32 exec_hi, 0x0000ffff
  v_lshl_add_u32 v26, v26, 7, v18
  v_lshl_add_u32 v27, v27, 7, v18
  s_mov_b32 exec_lo, 0
  s_mov_b32 exec_hi, 0xffff0000
  v_mov_b32 v27, v25
  v_mov_b32 v26, v25
  s_mov_b32 exec_hi, 0x00ff0000
  v_mov_b32 v26, v24
  s_mov_b64 exec, -1
  s_add_u32 m0, s74, 0
  s_nop 0
  buffer_load_dwordx4 v24, s[32:35], 0 offen lds
  s_add_u32 m0, s74, 1056
  s_nop 0
  buffer_load_dwordx4 v25, s[32:35], 0 offen lds
  s_add_u32 m0, s74, 2112
  s_nop 0
  buffer_load_dwordx4 v26, s[32:35], 0 offen lds
  s_add_u32 m0, s74, 3168
  s_mov_b32 exec_hi, 0x00ffffff
  buffer_load_dwordx4 v27, s[32:35], 0 offen lds
  s_mov_b32 exec_hi, -1
  v_lshl_add_u32 v204, v204, 7, v18
  v_lshl_add_u32 v205, v205, 7, v18
  s_mov_b32 exec_hi, 0x0000ffff
  v_lshl_add_u32 v206, v206, 7, v18
  v_lshl_add_u32 v207, v207, 7, v18
  s_mov_b32 exec_lo, 0
  s_mov_b32 exec_hi, 0xffff0000
  v_mov_b32 v207, v205
  v_mov_b32 v206, v205
  s_mov_b32 exec_hi, 0x00ff0000
  v_mov_b32 v206, v204
  s_mov_b64 exec, -1
  s_add_u32 m0, s74, -16896
  s_nop 0
  buffer_load_dwordx4 v204, s[32:35], 0 offen lds
  s_add_u32 m0, s74, -15840
  s_nop 0
  buffer_load_dwordx4 v205, s[32:35], 0 offen lds
  s_add_u32 m0, s74, -14784
  s_nop 0
  buffer_load_dwordx4 v206, s[32:35], 0 offen lds
  s_add_u32 m0, s74, -13728
  s_mov_b32 exec_hi, 0x00ffffff
  buffer_load_dwordx4 v207, s[32:35], 0 offen lds
  s_mov_b32 exec_hi, -1
  buffer_load_dwordx4 v[24:27], v17, s[28:31], s94 offen offset:0
  s_add_u32 s94, s94, 832
  s_branch L_uph
L_g0pf:
  s_mov_b32 s40, s10
  s_and_b32 s41, s11, 0xffff
  s_mov_b32 s42, 156
  s_mov_b32 s43, 0x20000
  s_mov_b32 m0, 110272
  s_mov_b64 exec, 0x7ff
  buffer_load_dwordx4 v48, s[40:43], 0 offen lds
  s_mov_b64 exec, -1
  s_add_u32 m0, s95, 71552
  s_add_u32 s81, s95, 70304
  buffer_load_dwordx4 v48, s[36:39], s81 offen lds
  s_add_u32 m0, s95, 75648
  s_add_u32 s81, s95, 74400
  buffer_load_dwordx4 v48, s[36:39], s81 offen lds
  s_add_u32 m0, s95, 79744
  s_add_u32 s81, s95, 78496
  buffer_load_dwordx4 v48, s[36:39], s81 offen lds
  s_add_u32 m0, s95, 83840
  s_add_u32 s81, s95, 82592
  buffer_load_dwordx4 v48, s[36:39], s81 offen lds
  s_add_u32 m0, s95, 87936
  s_add_u32 s81, s95, 86688
  buffer_load_dwordx4 v48, s[36:39], s81 offen lds
  s_add_u32 m0, s95, 92032
  s_add_u32 s81, s95, 90784
  buffer_load_dwordx4 v48, s[36:39], s81 offen lds
  s_add_u32 m0, s95, 96128
  s_add_u32 s81, s95, 94880
  buffer_load_dwordx4 v48, s[36:39], s81 offen lds
  s_add_u32 m0, s95, 100224
  s_add_u32 s81, s95, 98976
  buffer_load_dwordx4 v48, s[36:39], s81 offen lds
  s_add_u32 m0, s96, 71552
  s_add_u32 s81, s96, 70304
  s_mov_b64 exec, s[82:83]
  buffer_load_dwordx4 v48, s[36:39], s81 offen lds
  s_mov_b64 exec, -1
  s_mul_i32 s69, s27, 2979
  s_add_u32 m0, s95, 36288
  s_add_u32 s81, s95, 35152
  buffer_load_dwordx4 v48, s[36:39], s81 offen lds
  s_lshr_b32 s69, s69, 6
  s_mul_i32 s98, s27, 44
  s_and_b32 s70, s2, 7
  s_add_u32 s85, s98, s3
  s_lshl_b32 s85, s85, 2
  s_lshl_b32 s98, s70, 14
  s_add_u32 s85, s85, s98
  s_add_u32 m0, s95, 40384
  s_add_u32 s81, s95, 39248
  buffer_load_dwordx4 v48, s[36:39], s81 offen lds
  s_add_u32 s85, s85, 10240
  s_mul_i32 s98, s27, 44
  s_lshl_b32 s77, s70, 9
  s_add_u32 s94, s77, s98
  s_add_u32 s77, s77, s69
  s_add_u32 s94, s94, s3
  s_mul_i32 s94, s94, 104
  s_lshl_b32 s98, s27, 2
  s_add_u32 m0, s95, 44480
  s_add_u32 s81, s95, 43344
  buffer_load_dwordx4 v48, s[36:39], s81 offen lds
  s_add_u32 s98, s98, s3
  s_add_u32 s98, s98, s70
  s_and_b32 s98, s98, 7
  s_mul_i32 s98, s98, 16640
  s_add_u32 s98, s98, 12288
  s_sub_u32 s72, 6, s84
  s_lshl_b32 s99, s84, 1
  s_add_u32 m0, s95, 48576
  s_add_u32 s81, s95, 47440
  buffer_load_dwordx4 v48, s[36:39], s81 offen lds
  s_mov_b32 s26, -1
  v_lshrrev_b32 v43, 3, v0
  v_min_u32 v43, 6, v43
  v_lshlrev_b32 v17, 4, v43
  s_mul_i32 s70, s70, 88
  s_add_u32 s70, s100, s70
  s_mov_b32 s71, 704
  v_mov_b32 v44, s70
  s_add_u32 m0, s95, 52672
  s_add_u32 s81, s95, 51536
  buffer_load_dwordx4 v48, s[36:39], s81 offen lds
  v_mad_u32_u24 v19, v0, s71, v44
  s_mul_i32 s70, s100, 104
  s_sub_u32 s70, s70, 313
  v_min_u32 v44, 16, v0
  v_mul_u32_u24 v45, 26, v44
  v_add_u32 v45, s70, v45
  v_cmp_lt_u32 vcc, 12, v44
  s_nop 1
  v_cndmask_b32 v19, v19, v45, vcc
  s_add_u32 m0, s95, 56768
  s_add_u32 s81, s95, 55632
  buffer_load_dwordx4 v48, s[36:39], s81 offen lds
  v_lshlrev_b32 v19, 7, v19
  s_mov_b32 s101, 638976
  s_mov_b32 s32, s6
  s_and_b32 s33, s7, 0xffff
  s_mov_b32 s34, 12800000
  s_mov_b32 s35, 0x20000
  s_mov_b32 s44, s12
  s_waitcnt vmcnt(6) lgkmcnt(0)
  ds_add_u32 v1, v3 offset:0
  s_and_b32 s45, s13, 0xffff
  s_mov_b32 s46, 5537792
  s_mov_b32 s47, 0x20000
  s_mov_b32 s28, s4
  s_and_b32 s29, s5, 0xffff
  s_mov_b32 s30, 425984
  s_mov_b32 s31, 0x20000
  s_and_b32 s70, s3, 1
  s_add_u32 m0, s95, 60864
  s_add_u32 s81, s95, 59728
  buffer_load_dwordx4 v48, s[36:39], s81 offen lds
  s_lshl_b32 s70, s70, 1
  v_add_u32 v46, s70, v41
  v_min_u32 v43, 25, v42
  s_mul_i32 s68, s84, 4
  s_add_u32 s68, s68, 1352
  s_mul_i32 s69, s84, 70528
  s_add_u32 s69, s69, 1024
  v_mul_u32_u24 v44, s68, v43
  s_add_u32 m0, s95, 64960
  s_add_u32 s81, s95, 63824
  buffer_load_dwordx4 v48, s[36:39], s81 offen lds
  v_add_u32 v44, s69, v44
  v_lshlrev_b32 v247, 2, v43
  v_add_u32 v247, 70528, v247
  s_lshl_b32 s68, s84, 2
  s_xor_b32 s68, s68, 4
  v_lshrrev_b32 v45, 2, v43
  v_and_b32 v45, s68, v45
  s_add_u32 m0, s96, 36288
  s_add_u32 s81, s96, 35152
  s_mov_b64 exec, s[82:83]
  buffer_load_dwordx4 v48, s[36:39], s81 offen lds
  s_mov_b64 exec, -1
  v_add_u32 v44, v44, v45
  v_sub_u32 v247, v247, v45
  v_mul_u32_u24 v65, 52, v43
  v_lshl_add_u32 v65, v46, 1, v65
  v_add_u32 v65, 108864, v65
  v_lshlrev_b32 v67, 1, v43
  v_add_u32 v67, 110272, v67
  v_mad_u32_u24 v60, v46, 52, v44
  s_add_u32 m0, s95, 1024
  s_add_u32 s81, s95, 0
  buffer_load_dwordx4 v48, s[36:39], s81 offen lds
  v_lshl_add_u32 v61, v46, 1, v44
  v_lshl_add_u32 v49, v46, 1, v60
  v_lshlrev_b32 v43, 3, v46
  s_mov_b32 s68, 0x01000100
  v_bfe_i32 v45, s68, v43, 8
  v_lshl_add_u32 v50, v45, 1, v60
  v_mad_i32_i24 v51, v45, 52, v61
  s_mov_b32 s68, 0xff00ff00
  s_add_u32 m0, s95, 5120
  s_add_u32 s81, s95, 4096
  buffer_load_dwordx4 v48, s[36:39], s81 offen lds
  v_bfe_i32 v45, s68, v43, 8
  v_lshl_add_u32 v52, v45, 1, v60
  v_mad_i32_i24 v53, v45, 52, v61
  s_mov_b32 s68, 0xff020100
  v_bfe_i32 v45, s68, v43, 8
  v_lshl_add_u32 v54, v45, 1, v60
  v_mad_i32_i24 v55, v45, 52, v61
  s_add_u32 m0, s95, 9216
  s_add_u32 s81, s95, 8192
  buffer_load_dwordx4 v48, s[36:39], s81 offen lds
  s_mov_b32 s68, 0x0b0a0100
  v_bfe_i32 v45, s68, v43, 8
  v_lshl_add_u32 v56, v45, 1, v60
  v_mad_i32_i24 v57, v45, 52, v61
  s_mov_b32 s68, 0xf3f20100
  v_bfe_i32 v45, s68, v43, 8
  v_lshl_add_u32 v58, v45, 1, v60
  v_mad_i32_i24 v59, v45, 52, v61
  s_waitcnt vmcnt(3) lgkmcnt(0)
  ds_add_u32 v1, v3 offset:4
  s_mov_b32 s68, 0x00023600
  v_bfe_u32 v45, s68, v43, 8
  v_add_u32 v60, v45, v44
  v_add_u32 v61, 52, v44
  v_mov_b32 v47, 1048576
  v_cmp_eq_u32 vcc, 3, v46
  s_nop 1
  v_cndmask_b32 v60, v60, v47, vcc
  v_cndmask_b32 v67, v47, v67, vcc
  s_add_u32 m0, s95, 13312
  s_add_u32 s81, s95, 12288
  buffer_load_dwordx4 v48, s[36:39], s81 offen lds
  v_cmp_eq_u32 vcc, 2, v46
  s_nop 1
  v_cndmask_b32 v61, v47, v61, vcc
  v_cmp_gt_u32 vcc, 2, v46
  s_nop 1
  v_cndmask_b32 v64, v47, v65, vcc
  s_lshr_b32 s69, s79, 1
  s_mul_i32 s69, s69, 6144
  s_mul_i32 s68, s84, 6144
  s_add_u32 m0, s95, 17408
  s_add_u32 s81, s95, 16384
  buffer_load_dwordx4 v48, s[36:39], s81 offen lds
  v_lshlrev_b32 v45, 8, v46
  v_lshl_add_u32 v43, v42, 4, v45
  v_add_u32 v63, 1024, v43
  v_add_u32 v66, 36288, v43
  v_bfe_u32 v43, v0, 2, 2
  v_lshl_add_u32 v45, v43, 4, v45
  v_and_b32 v43, 3, v0
  v_lshl_add_u32 v44, v43, 6, v45
  s_add_u32 m0, s95, 21504
  s_add_u32 s81, s95, 20476
  buffer_load_dwordx4 v248, s[36:39], s81 offen lds
  v_add_u32 v44, 12288, v44
  v_cmp_lt_u32 vcc, 15, v42
  s_nop 1
  v_cndmask_b32 v63, v63, v44, vcc
  v_add_u32 v44, 16, v44
  v_cndmask_b32 v66, v66, v44, vcc
  v_lshl_add_u32 v44, v43, 5, v45
  v_add_u32 v44, 24560, v44
  v_cmp_lt_u32 vcc, 19, v42
  s_add_u32 m0, s95, 25600
  s_add_u32 s81, s95, 24572
  buffer_load_dwordx4 v48, s[36:39], s81 offen lds
  v_cndmask_b32 v63, v63, v44, vcc
  v_add_u32 v63, s69, v63
  v_add_u32 v66, s68, v66
  v_cmp_lt_u32 vcc, 25, v42
  s_nop 1
  v_cndmask_b32 v63, v63, v47, vcc
  v_cndmask_b32 v66, v66, v47, vcc
  v_mov_b32 v62, 0
  s_add_u32 m0, s95, 29696
  s_add_u32 s81, s95, 28668
  buffer_load_dwordx4 v48, s[36:39], s81 offen lds
  s_mul_i32 s74, s3, 4224
  s_add_u32 s74, s74, 111040
  s_mov_b32 s75, -39488
  v_add_u32 v28, 1024, v48
  v_and_b32 v43, 11, v0
  v_cmp_eq_u32 vcc, 11, v43
  s_nop 1
  v_cndmask_b32 v31, v28, v47, vcc
  v_and_b32 v43, 3, v0
  s_add_u32 m0, s96, 1024
  s_lshr_b32 s81, s96, 13
  s_sub_u32 s81, s96, s81
  s_mov_b64 exec, s[82:83]
  buffer_load_dwordx4 v48, s[36:39], s81 offen lds
  s_mov_b64 exec, -1
  v_cmp_eq_u32 vcc, 0, v43
  s_nop 1
  v_cndmask_b32 v30, v31, v47, vcc
  v_lshrrev_b32 v46, 4, v0
  v_bfe_u32 v43, v0, 1, 3
  v_lshlrev_b32 v45, 4, v43
  v_add_u32 v45, 24576, v45
  v_and_b32 v43, 10, v0
  v_cmp_eq_u32 vcc, 10, v43
  s_nop 1
  v_cndmask_b32 v45, v45, v47, vcc
  v_and_b32 v44, 1, v0
  v_lshl_add_u32 v29, v46, 9, v45
  v_lshl_add_u32 v29, v44, 2, v29
  v_add_u32 v29, 1024, v29
  v_lshl_add_u32 v22, v46, 8, v45
  v_lshl_add_u32 v22, v44, 20, v22
  v_and_b32 v47, 15, v0
  s_mov_b32 s68, 1056
  v_lshlrev_b32 v43, 1, v47
  v_add_u32 v43, s74, v43
  v_mad_u32_u24 v7, v46, s68, v43
  s_lshl_b32 s68, s3, 10
  s_add_u32 s68, s68, 144832
  v_add_u32 v10, s68, v48
  v_add_u32 v43, 256, v48
  v_and_b32 v43, 1023, v43
  v_add_u32 v11, s68, v43
  v_xor_b32 v43, 512, v48
  v_add_u32 v12, s68, v43
  v_lshlrev_b32 v13, 4, v41
  v_mov_b32 v32, 0
  v_mov_b32 v33, 0
  v_mov_b32 v34, 0
  v_mov_b32 v35, 0
  v_mov_b32 v36, 0
  v_mov_b32 v37, 0
  v_mov_b32 v38, 0
  v_mov_b32 v39, 0
  v_mov_b32 v216, 0
  v_mov_b32 v217, 0
  v_mov_b32 v218, 0
  v_mov_b32 v219, 0
  v_mov_b32 v220, 0
  v_mov_b32 v221, 0
  v_mov_b32 v222, 0
  v_mov_b32 v223, 0
  v_mov_b32 v224, 0
  v_mov_b32 v225, 0
  v_mov_b32 v226, 0
  v_mov_b32 v227, 0
  v_mov_b32 v228, 0
  v_mov_b32 v229, 0
  v_mov_b32 v230, 0
  v_mov_b32 v231, 0
  v_mov_b32 v232, 0
  v_mov_b32 v233, 0
  v_mov_b32 v234, 0
  v_mov_b32 v235, 0
  v_mov_b32 v236, 0
  v_mov_b32 v237, 0
  v_mov_b32 v238, 0
  v_mov_b32 v239, 0
  v_mul_u32_u24 v44, 1056, v46
  v_bfe_u32 v45, v0, 2, 2
  v_lshl_add_u32 v44, v45, 7, v44
  v_and_b32 v45, 3, v0
  v_lshl_add_u32 v9, v45, 3, v44
  v_add_u32 v8, s74, v9
  v_and_b32 v45, 1, v0
  s_mov_b32 s68, 0xaaaaaaaa
  v_mul_lo_u32 v16, s68, v45
  v_or_b32 v16, 0x44444444, v16
  v_lshlrev_b32 v15, 1, v0
  v_add_u32 v15, s74, v15
  v_mov_b32 v14, 0x3f80
  ds_write_b16 v15, v14 offset:4064
  v_add_u32 v15, s75, v15
  s_mul_i32 s71, s3, 6
  s_add_u32 s77, s77, s71
  s_mul_i32 s77, s77, 104
  s_add_u32 s73, s77, 80
  s_add_u32 s77, s77, 16
  s_mov_b32 s71, 10923
  v_min_u32 v43, 35, v0
  v_mul_u32_u24 v44, s71, v43
  v_lshrrev_b32 v44, 16, v44
  v_mul_u32_u24 v44, 80, v44
  v_lshl_add_u32 v20, v43, 2, v44
  s_add_u32 s94, s94, 832
  s_add_u32 s77, s77, 24
  buffer_load_dwordx4 v[24:27], v17, s[28:31], s94 offen offset:0
  s_add_u32 s94, s94, 832
  buffer_load_dword v21, v20, s[28:31], s77 offen
  s_cmp_eq_u32 s77, s73
  s_cselect_b32 s73, 0x7000000, s73
  s_cselect_b32 s77, 0x7000000, s77
  s_add_u32 s77, s77, 24
  s_min_u32 s77, s77, s73
  s_mov_b64 exec, 131071
  buffer_load_dword v255, v19, s[44:47], s101 offen
  s_mov_b64 exec, -1
  s_add_u32 s101, s101, 1171456
  s_waitcnt vmcnt(3) lgkmcnt(0)
  ds_add_u32 v1, v3 offset:8
  s_mov_b32 s97, 0
L_csync4:
  ds_read_b32 v4, v2 offset:8
  s_waitcnt lgkmcnt(0)
  v_cmp_gt_u32 vcc, 4, v4
  s_cbranch_vccnz L_csync4
  s_cmp_ge_u32 s79, 2
  s_cbranch_scc1 L_chunk2
L_chunk0:
  ds_read_u16_d16_hi v216, v49 offset:0
  ds_read_u16_d16_hi v218, v49 offset:648
  ds_read_u16_d16_hi v220, v49 offset:216
  ds_read_u16_d16_hi v222, v49 offset:864
  ds_read_u16_d16_hi v224, v49 offset:432
  ds_read_u16_d16_hi v226, v49 offset:1080
  ds_read_u16_d16_hi v228, v49 offset:8
  ds_read_u16_d16_hi v229, v49 offset:208
  ds_read_u16_d16_hi v230, v49 offset:656
  ds_read_u16_d16_hi v231, v49 offset:856
  ds_read_u16_d16_hi v232, v49 offset:32
  ds_read_u16_d16_hi v233, v49 offset:832
  ds_read_u16_d16_hi v234, v49 offset:632
  ds_read_u16_d16_hi v235, v49 offset:232
  s_waitcnt lgkmcnt(12)
  v_mov_b32 v85, v218
  v_mov_b32 v84, v216
  v_max3_f32 v62, v62, abs(v84), abs(v85)
  ds_read_u16_d16_hi v236, v49 offset:16
  ds_read_u16_d16_hi v237, v49 offset:416
  ds_read_u16_d16_hi v238, v49 offset:664
  ds_read_u16_d16_hi v239, v49 offset:1064
  s_waitcnt lgkmcnt(14)
  v_mov_b32 v87, v222
  v_mov_b32 v86, v220
  v_max3_f32 v62, v62, abs(v86), abs(v87)
  ds_read_u16_d16_hi v216, v49 offset:40
  ds_read_u16_d16_hi v217, v49 offset:1040
  ds_read_u16_d16_hi v218, v49 offset:640
  ds_read_u16_d16_hi v219, v49 offset:440
  s_waitcnt lgkmcnt(14)
  v_mov_b32 v89, v226
  v_mov_b32 v88, v224
  v_max3_f32 v62, v62, abs(v88), abs(v89)
  ds_read_u16_d16_hi v220, v49 offset:224
  ds_read_u16_d16_hi v221, v49 offset:424
  ds_read_u16_d16_hi v222, v49 offset:872
  ds_read_u16_d16_hi v223, v49 offset:1072
  s_waitcnt lgkmcnt(14)
  v_add_f32 v91, v230, v231
  v_add_f32 v90, v228, v229
  v_max3_f32 v62, v62, abs(v90), abs(v91)
  ds_read_u16_d16_hi v224, v49 offset:248
  ds_read_u16_d16_hi v225, v49 offset:1048
  ds_read_u16_d16_hi v226, v49 offset:848
  ds_read_u16_d16_hi v227, v49 offset:448
  s_waitcnt lgkmcnt(14)
  v_add_f32 v93, v234, v235
  v_add_f32 v92, v232, v233
  v_max3_f32 v62, v62, abs(v92), abs(v93)
  ds_read_u16_d16_hi v228, v50 offset:48
  ds_read_u16_d16_hi v229, v51 offset:1248
  ds_read_u16_d16_hi v230, v50 offset:672
  ds_read_u16_d16_hi v231, v51 offset:1272
  s_waitcnt lgkmcnt(14)
  v_add_f32 v95, v238, v239
  v_add_f32 v94, v236, v237
  v_max3_f32 v62, v62, abs(v94), abs(v95)
  ds_read_u16_d16_hi v232, v50 offset:256
  ds_read_u16_d16_hi v233, v51 offset:1256
  ds_read_u16_d16_hi v234, v50 offset:880
  ds_read_u16_d16_hi v235, v51 offset:1280
  s_waitcnt lgkmcnt(14)
  v_add_f32 v97, v218, v219
  v_add_f32 v96, v216, v217
  v_max3_f32 v62, v62, abs(v96), abs(v97)
  ds_read_u16_d16_hi v236, v50 offset:464
  ds_read_u16_d16_hi v237, v51 offset:1264
  ds_read_u16_d16_hi v238, v50 offset:1088
  ds_read_u16_d16_hi v239, v51 offset:1288
  s_waitcnt lgkmcnt(14)
  v_add_f32 v99, v222, v223
  v_add_f32 v98, v220, v221
  v_max3_f32 v62, v62, abs(v98), abs(v99)
  s_waitcnt lgkmcnt(12)
  v_add_f32 v101, v226, v227
  v_add_f32 v100, v224, v225
  v_max3_f32 v62, v62, abs(v100), abs(v101)
  s_waitcnt lgkmcnt(8)
  v_add_f32 v103, v230, v231
  v_add_f32 v102, v228, v229
  v_max3_f32 v62, v62, abs(v102), abs(v103)
  s_waitcnt lgkmcnt(4)
  v_add_f32 v105, v234, v235
  v_add_f32 v104, v232, v233
  v_max3_f32 v62, v62, abs(v104), abs(v105)
  s_waitcnt lgkmcnt(0)
  v_add_f32 v107, v238, v239
  v_add_f32 v106, v236, v237
  v_max3_f32 v62, v62, abs(v106), abs(v107)
  s_cmp_lg_u32 s97, 0
  s_cbranch_scc1 L_uconv0
L_chunk1:
  ds_read_u16_d16_hi v216, v49 offset:24
  ds_read_u16_d16_hi v217, v49 offset:624
  ds_read_u16_d16_hi v218, v49 offset:240
  ds_read_u16_d16_hi v219, v49 offset:840
  ds_read_u16_d16_hi v220, v49 offset:456
  ds_read_u16_d16_hi v221, v49 offset:1056
  ds_read_u16_d16_hi v222, v60 offset:1296
  ds_read_u16_d16_hi v223, v61 offset:1296
  ds_read_u16_d16_hi v224, v52 offset:50
  ds_read_u16_d16_hi v225, v53 offset:1300
  ds_read_u16_d16_hi v226, v52 offset:674
  ds_read_u16_d16_hi v227, v53 offset:1324
  ds_read_u16_d16_hi v228, v52 offset:258
  ds_read_u16_d16_hi v229, v53 offset:1308
  ds_read_u16_d16_hi v230, v52 offset:882
  ds_read_u16_d16_hi v231, v53 offset:1332
  ds_read_u16_d16_hi v232, v52 offset:466
  ds_read_u16_d16_hi v233, v53 offset:1316
  ds_read_u16_d16_hi v234, v52 offset:1090
  ds_read_u16_d16_hi v235, v53 offset:1340
  s_waitcnt lgkmcnt(14)
  v_add_f32 v109, v218, v219
  v_add_f32 v108, v216, v217
  v_max3_f32 v62, v62, abs(v108), abs(v109)
  ds_read_u16_d16_hi v236, v54 offset:2
  ds_read_u16_d16_hi v237, v55 offset:52
  ds_read_u16_d16_hi v238, v54 offset:650
  ds_read_u16_d16_hi v239, v55 offset:700
  s_waitcnt lgkmcnt(14)
  v_add_f32 v111, v222, v223
  v_add_f32 v110, v220, v221
  v_max3_f32 v62, v62, abs(v110), abs(v111)
  ds_read_u16_d16_hi v216, v54 offset:26
  ds_read_u16_d16_hi v217, v55 offset:676
  ds_read_u16_d16_hi v218, v54 offset:626
  ds_read_u16_d16_hi v219, v55 offset:76
  s_waitcnt lgkmcnt(14)
  v_add_f32 v113, v226, v227
  v_add_f32 v112, v224, v225
  v_max3_f32 v62, v62, abs(v112), abs(v113)
  ds_read_u16_d16_hi v220, v54 offset:10
  ds_read_u16_d16_hi v221, v55 offset:260
  ds_read_u16_d16_hi v222, v54 offset:658
  ds_read_u16_d16_hi v223, v55 offset:908
  s_waitcnt lgkmcnt(14)
  v_add_f32 v115, v230, v231
  v_add_f32 v114, v228, v229
  v_max3_f32 v62, v62, abs(v114), abs(v115)
  ds_read_u16_d16_hi v224, v54 offset:34
  ds_read_u16_d16_hi v225, v55 offset:884
  ds_read_u16_d16_hi v226, v54 offset:634
  ds_read_u16_d16_hi v227, v55 offset:284
  s_waitcnt lgkmcnt(14)
  v_add_f32 v117, v234, v235
  v_add_f32 v116, v232, v233
  v_max3_f32 v62, v62, abs(v116), abs(v117)
  ds_read_u16_d16_hi v228, v54 offset:18
  ds_read_u16_d16_hi v229, v55 offset:468
  ds_read_u16_d16_hi v230, v54 offset:666
  ds_read_u16_d16_hi v231, v55 offset:1116
  s_waitcnt lgkmcnt(14)
  v_add_f32 v119, v238, v239
  v_add_f32 v118, v236, v237
  v_max3_f32 v62, v62, abs(v118), abs(v119)
  ds_read_u16_d16_hi v232, v54 offset:42
  ds_read_u16_d16_hi v233, v55 offset:1092
  ds_read_u16_d16_hi v234, v54 offset:642
  ds_read_u16_d16_hi v235, v55 offset:492
  s_waitcnt lgkmcnt(14)
  v_add_f32 v121, v218, v219
  v_add_f32 v120, v216, v217
  v_max3_f32 v62, v62, abs(v120), abs(v121)
  ds_read_u16_d16_hi v236, v54 offset:210
  ds_read_u16_d16_hi v237, v55 offset:60
  ds_read_u16_d16_hi v238, v54 offset:858
  ds_read_u16_d16_hi v239, v55 offset:708
  s_waitcnt lgkmcnt(14)
  v_add_f32 v123, v222, v223
  v_add_f32 v122, v220, v221
  v_max3_f32 v62, v62, abs(v122), abs(v123)
  s_waitcnt lgkmcnt(12)
  v_add_f32 v125, v226, v227
  v_add_f32 v124, v224, v225
  v_max3_f32 v62, v62, abs(v124), abs(v125)
  s_waitcnt lgkmcnt(8)
  v_add_f32 v127, v230, v231
  v_add_f32 v126, v228, v229
  v_max3_f32 v62, v62, abs(v126), abs(v127)
  s_waitcnt lgkmcnt(4)
  v_add_f32 v129, v234, v235
  v_add_f32 v128, v232, v233
  v_max3_f32 v62, v62, abs(v128), abs(v129)
  s_waitcnt lgkmcnt(0)
  v_add_f32 v131, v238, v239
  v_add_f32 v130, v236, v237
  v_max3_f32 v62, v62, abs(v130), abs(v131)
  s_cmp_lg_u32 s97, 0
  s_cbranch_scc1 L_uconv1
  s_branch L_w1conv
L_chunk2:
  ds_read_u16_d16_hi v216, v54 offset:234
  ds_read_u16_d16_hi v217, v55 offset:684
  ds_read_u16_d16_hi v218, v54 offset:834
  ds_read_u16_d16_hi v219, v55 offset:84
  ds_read_u16_d16_hi v220, v54 offset:218
  ds_read_u16_d16_hi v221, v55 offset:268
  ds_read_u16_d16_hi v222, v54 offset:866
  ds_read_u16_d16_hi v223, v55 offset:916
  ds_read_u16_d16_hi v224, v54 offset:242
  ds_read_u16_d16_hi v225, v55 offset:892
  ds_read_u16_d16_hi v226, v54 offset:842
  ds_read_u16_d16_hi v227, v55 offset:292
  ds_read_u16_d16_hi v228, v54 offset:226
  ds_read_u16_d16_hi v229, v55 offset:476
  ds_read_u16_d16_hi v230, v54 offset:874
  ds_read_u16_d16_hi v231, v55 offset:1124
  ds_read_u16_d16_hi v232, v54 offset:250
  ds_read_u16_d16_hi v233, v55 offset:1100
  ds_read_u16_d16_hi v234, v54 offset:850
  ds_read_u16_d16_hi v235, v55 offset:500
  s_waitcnt lgkmcnt(14)
  v_add_f32 v85, v218, v219
  v_add_f32 v84, v216, v217
  v_max3_f32 v62, v62, abs(v84), abs(v85)
  ds_read_u16_d16_hi v236, v54 offset:418
  ds_read_u16_d16_hi v237, v55 offset:68
  ds_read_u16_d16_hi v238, v54 offset:1066
  ds_read_u16_d16_hi v239, v55 offset:716
  s_waitcnt lgkmcnt(14)
  v_add_f32 v87, v222, v223
  v_add_f32 v86, v220, v221
  v_max3_f32 v62, v62, abs(v86), abs(v87)
  ds_read_u16_d16_hi v216, v54 offset:442
  ds_read_u16_d16_hi v217, v55 offset:692
  ds_read_u16_d16_hi v218, v54 offset:1042
  ds_read_u16_d16_hi v219, v55 offset:92
  s_waitcnt lgkmcnt(14)
  v_add_f32 v89, v226, v227
  v_add_f32 v88, v224, v225
  v_max3_f32 v62, v62, abs(v88), abs(v89)
  ds_read_u16_d16_hi v220, v54 offset:426
  ds_read_u16_d16_hi v221, v55 offset:276
  ds_read_u16_d16_hi v222, v54 offset:1074
  ds_read_u16_d16_hi v223, v55 offset:924
  s_waitcnt lgkmcnt(14)
  v_add_f32 v91, v230, v231
  v_add_f32 v90, v228, v229
  v_max3_f32 v62, v62, abs(v90), abs(v91)
  ds_read_u16_d16_hi v224, v54 offset:450
  ds_read_u16_d16_hi v225, v55 offset:900
  ds_read_u16_d16_hi v226, v54 offset:1050
  ds_read_u16_d16_hi v227, v55 offset:300
  s_waitcnt lgkmcnt(14)
  v_add_f32 v93, v234, v235
  v_add_f32 v92, v232, v233
  v_max3_f32 v62, v62, abs(v92), abs(v93)
  ds_read_u16_d16_hi v228, v54 offset:434
  ds_read_u16_d16_hi v229, v55 offset:484
  ds_read_u16_d16_hi v230, v54 offset:1082
  ds_read_u16_d16_hi v231, v55 offset:1132
  s_waitcnt lgkmcnt(14)
  v_add_f32 v95, v238, v239
  v_add_f32 v94, v236, v237
  v_max3_f32 v62, v62, abs(v94), abs(v95)
  ds_read_u16_d16_hi v232, v54 offset:458
  ds_read_u16_d16_hi v233, v55 offset:1108
  ds_read_u16_d16_hi v234, v54 offset:1058
  ds_read_u16_d16_hi v235, v55 offset:508
  s_waitcnt lgkmcnt(14)
  v_add_f32 v97, v218, v219
  v_add_f32 v96, v216, v217
  v_max3_f32 v62, v62, abs(v96), abs(v97)
  ds_read_u16_d16_hi v236, v56 offset:4
  ds_read_u16_d16_hi v237, v57 offset:104
  ds_read_u16_d16_hi v238, v58 offset:652
  ds_read_u16_d16_hi v239, v59 offset:752
  s_waitcnt lgkmcnt(14)
  v_add_f32 v99, v222, v223
  v_add_f32 v98, v220, v221
  v_max3_f32 v62, v62, abs(v98), abs(v99)
  s_waitcnt lgkmcnt(12)
  v_add_f32 v101, v226, v227
  v_add_f32 v100, v224, v225
  v_max3_f32 v62, v62, abs(v100), abs(v101)
  s_waitcnt lgkmcnt(8)
  v_add_f32 v103, v230, v231
  v_add_f32 v102, v228, v229
  v_max3_f32 v62, v62, abs(v102), abs(v103)
  s_waitcnt lgkmcnt(4)
  v_add_f32 v105, v234, v235
  v_add_f32 v104, v232, v233
  v_max3_f32 v62, v62, abs(v104), abs(v105)
  s_waitcnt lgkmcnt(0)
  v_add_f32 v107, v238, v239
  v_add_f32 v106, v236, v237
  v_max3_f32 v62, v62, abs(v106), abs(v107)
  s_cmp_lg_u32 s97, 0
  s_cbranch_scc1 L_uconv0
L_chunk3:
  ds_read_u16_d16_hi v216, v56 offset:220
  ds_read_u16_d16_hi v217, v57 offset:320
  ds_read_u16_d16_hi v218, v58 offset:868
  ds_read_u16_d16_hi v219, v59 offset:968
  ds_read_u16_d16_hi v220, v56 offset:436
  ds_read_u16_d16_hi v221, v57 offset:536
  ds_read_u16_d16_hi v222, v58 offset:1084
  ds_read_u16_d16_hi v223, v59 offset:1184
  ds_read_u16_d16_hi v224, v56 offset:12
  ds_read_u16_d16_hi v225, v57 offset:312
  ds_read_u16_d16_hi v226, v58 offset:660
  ds_read_u16_d16_hi v227, v59 offset:960
  ds_read_u16_d16_hi v228, v58 offset:36
  ds_read_u16_d16_hi v229, v59 offset:936
  ds_read_u16_d16_hi v230, v56 offset:636
  ds_read_u16_d16_hi v231, v57 offset:336
  ds_read_u16_d16_hi v232, v56 offset:20
  ds_read_u16_d16_hi v233, v57 offset:520
  ds_read_u16_d16_hi v234, v58 offset:668
  ds_read_u16_d16_hi v235, v59 offset:1168
  s_waitcnt lgkmcnt(14)
  v_add_f32 v109, v218, v219
  v_add_f32 v108, v216, v217
  v_max3_f32 v62, v62, abs(v108), abs(v109)
  ds_read_u16_d16_hi v236, v58 offset:44
  ds_read_u16_d16_hi v237, v59 offset:1144
  ds_read_u16_d16_hi v238, v56 offset:644
  ds_read_u16_d16_hi v239, v57 offset:544
  s_waitcnt lgkmcnt(14)
  v_add_f32 v111, v222, v223
  v_add_f32 v110, v220, v221
  v_max3_f32 v62, v62, abs(v110), abs(v111)
  ds_read_u16_d16_hi v216, v56 offset:228
  ds_read_u16_d16_hi v217, v57 offset:528
  ds_read_u16_d16_hi v218, v58 offset:876
  ds_read_u16_d16_hi v219, v59 offset:1176
  s_waitcnt lgkmcnt(14)
  v_add_f32 v113, v226, v227
  v_add_f32 v112, v224, v225
  v_max3_f32 v62, v62, abs(v112), abs(v113)
  ds_read_u16_d16_hi v220, v58 offset:252
  ds_read_u16_d16_hi v221, v59 offset:1152
  ds_read_u16_d16_hi v222, v56 offset:852
  ds_read_u16_d16_hi v223, v57 offset:552
  s_waitcnt lgkmcnt(14)
  v_add_f32 v115, v230, v231
  v_add_f32 v114, v228, v229
  v_max3_f32 v62, v62, abs(v114), abs(v115)
  ds_read_u16_d16_hi v224, v65 offset:0
  ds_read_u16_d16_hi v225, v65 offset:8
  ds_read_u16_d16_hi v226, v65 offset:16
  ds_read_u16_d16_hi v227, v65 offset:24
  ds_read_u16_d16_hi v228, v65 offset:32
  ds_read_u16_d16_hi v229, v65 offset:40
  ds_read_u16_d16_hi v230, v64 offset:48
  ds_read_u16_d16_hi v231, v67
  s_waitcnt lgkmcnt(14)
  v_add_f32 v117, v234, v235
  v_add_f32 v116, v232, v233
  v_max3_f32 v62, v62, abs(v116), abs(v117)
  v_add_f32 v119, v238, v239
  v_add_f32 v118, v236, v237
  v_max3_f32 v62, v62, abs(v118), abs(v119)
  s_waitcnt lgkmcnt(12)
  v_add_f32 v121, v218, v219
  v_add_f32 v120, v216, v217
  v_max3_f32 v62, v62, abs(v120), abs(v121)
  s_waitcnt lgkmcnt(8)
  v_add_f32 v123, v222, v223
  v_add_f32 v122, v220, v221
  v_max3_f32 v62, v62, abs(v122), abs(v123)
  s_cmp_lg_u32 s97, 0
  s_cbranch_scc1 L_uconv1
L_w1conv:
  v_max_u32_dpp v62, v62, v62 row_shr:1 row_mask:0xf bank_mask:0xf
  s_nop 1
  v_max_u32_dpp v62, v62, v62 row_shr:2 row_mask:0xf bank_mask:0xf
  s_nop 1
  v_max_u32_dpp v62, v62, v62 row_shr:4 row_mask:0xf bank_mask:0xf
  s_nop 1
  v_max_u32_dpp v62, v62, v62 row_shr:8 row_mask:0xf bank_mask:0xf
  s_nop 1
  v_max_u32_dpp v62, v62, v62 row_bcast:15 row_mask:0xa bank_mask:0xf
  s_nop 1
  v_max_u32_dpp v62, v62, v62 row_bcast:31 row_mask:0xc bank_mask:0xf
  s_nop 0
  v_readlane_b32 s68, v62, 63
  s_nop 1
  v_mov_b32 v62, s68
  ds_max_u32 v1, v62 offset:20
  ds_add_u32 v1, v3 offset:16
  v_add_u32 v49, v49, v247
  v_add_u32 v50, v50, v247
  v_add_u32 v51, v51, v247
  v_add_u32 v52, v52, v247
  v_add_u32 v53, v53, v247
  v_add_u32 v54, v54, v247
  v_add_u32 v55, v55, v247
  v_add_u32 v56, v56, v247
  v_add_u32 v57, v57, v247
  v_add_u32 v58, v58, v247
  v_add_u32 v59, v59, v247
  v_add_u32 v60, v60, v247
  v_add_u32 v61, v61, v247
L_csync5:
  ds_read_b64 v[40:41], v2 offset:16
  s_waitcnt lgkmcnt(0)
  v_cmp_gt_u32 vcc, 4, v40
  s_cbranch_vccnz L_csync5
  v_readfirstlane_b32 s70, v41
  s_nop 0
  s_lshr_b32 s70, s70, 23
  s_sub_i32 s70, 141, s70
  s_min_i32 s70, s70, 40
  s_add_i32 s51, s70, 127
  s_lshl_b32 s51, s51, 23
  v_fma_mixlo_f16 v132, v84, s51, 0
  v_fma_mixlo_f16 v133, v86, s51, 0
  v_fma_mixlo_f16 v134, v88, s51, 0
  v_fma_mixlo_f16 v135, v90, s51, 0
  v_fma_mixhi_f16 v132, v85, s51, 0
  v_fma_mixhi_f16 v133, v87, s51, 0
  v_fma_mixhi_f16 v134, v89, s51, 0
  v_fma_mixhi_f16 v135, v91, s51, 0
  v_fma_mixlo_f16 v136, v92, s51, 0
  v_fma_mixlo_f16 v137, v94, s51, 0
  v_fma_mixlo_f16 v138, v96, s51, 0
  v_fma_mixlo_f16 v139, v98, s51, 0
  v_fma_mixhi_f16 v136, v93, s51, 0
  v_fma_mixhi_f16 v137, v95, s51, 0
  v_fma_mixhi_f16 v138, v97, s51, 0
  v_fma_mixhi_f16 v139, v99, s51, 0
  ds_write_b128 v63, v[132:135] offset:0
  v_fma_mixlo_f16 v140, v100, s51, 0
  v_fma_mixlo_f16 v141, v102, s51, 0
  v_fma_mixlo_f16 v142, v104, s51, 0
  v_fma_mixlo_f16 v143, v106, s51, 0
  v_fma_mixhi_f16 v140, v101, s51, 0
  v_fma_mixhi_f16 v141, v103, s51, 0
  v_fma_mixhi_f16 v142, v105, s51, 0
  v_fma_mixhi_f16 v143, v107, s51, 0
  ds_write_b128 v63, v[136:139] offset:1024
  v_fma_mixlo_f16 v144, v108, s51, 0
  v_fma_mixlo_f16 v145, v110, s51, 0
  v_fma_mixlo_f16 v146, v112, s51, 0
  v_fma_mixlo_f16 v147, v114, s51, 0
  v_fma_mixhi_f16 v144, v109, s51, 0
  v_fma_mixhi_f16 v145, v111, s51, 0
  v_fma_mixhi_f16 v146, v113, s51, 0
  v_fma_mixhi_f16 v147, v115, s51, 0
  ds_write_b128 v63, v[140:143] offset:2048
  v_fma_mixlo_f16 v148, v116, s51, 0
  v_fma_mixlo_f16 v149, v118, s51, 0
  v_fma_mixlo_f16 v150, v120, s51, 0
  v_fma_mixlo_f16 v151, v122, s51, 0
  v_fma_mixhi_f16 v148, v117, s51, 0
  v_fma_mixhi_f16 v149, v119, s51, 0
  v_fma_mixhi_f16 v150, v121, s51, 0
  v_fma_mixhi_f16 v151, v123, s51, 0
  ds_write_b128 v63, v[144:147] offset:3072
  ds_write_b128 v63, v[148:151] offset:4096
  s_cmp_ge_u32 s79, 2
  s_cbranch_scc1 L_w1x
  v_fma_mixlo_f16 v152, v124, s51, 0
  v_fma_mixlo_f16 v153, v126, s51, 0
  v_fma_mixlo_f16 v154, v128, s51, 0
  v_fma_mixlo_f16 v155, v130, s51, 0
  v_fma_mixhi_f16 v152, v125, s51, 0
  v_fma_mixhi_f16 v153, v127, s51, 0
  v_fma_mixhi_f16 v154, v129, s51, 0
  v_fma_mixhi_f16 v155, v131, s51, 0
  ds_write_b128 v63, v[152:155] offset:5120
L_w1x:
L_uph:
L_csync6:
  ds_read_b64 v[40:41], v2 offset:24
  s_waitcnt lgkmcnt(0)
  v_cmp_gt_u32 vcc, 4, v40
  s_cbranch_vccnz L_csync6
  v_readfirstlane_b32 s71, v41
  s_nop 0
  s_lshr_b32 s71, s71, 23
  s_sub_i32 s71, 140, s71
  s_min_i32 s71, s71, 40
  s_add_i32 s51, s71, 127
  s_lshl_b32 s51, s51, 23
  s_mov_b32 s97, 1
  s_lshr_b32 s69, s3, 1
  s_cmp_eq_u32 s69, 0
  s_cbranch_scc1 L_chunk0
  s_cmp_eq_u32 s69, 1
  s_cbranch_scc1 L_chunk1
  s_cmp_eq_u32 s69, 2
  s_cbranch_scc1 L_chunk2
  s_branch L_chunk3
L_uconv0:
  v_fma_mixlo_f16 v132, v84, s51, 0
  v_fma_mixlo_f16 v133, v86, s51, 0
  v_fma_mixlo_f16 v134, v88, s51, 0
  v_fma_mixlo_f16 v135, v90, s51, 0
  v_fma_mixhi_f16 v132, v85, s51, 0
  v_fma_mixhi_f16 v133, v87, s51, 0
  v_fma_mixhi_f16 v134, v89, s51, 0
  v_fma_mixhi_f16 v135, v91, s51, 0
L_csync7:
  ds_read_b64 v[40:41], v2 offset:16
  s_waitcnt lgkmcnt(0)
  v_cmp_gt_u32 vcc, 4, v40
  s_cbranch_vccnz L_csync7
  v_readfirstlane_b32 s70, v41
  s_nop 0
  s_lshr_b32 s70, s70, 23
  s_sub_i32 s70, 141, s70
  s_min_i32 s70, s70, 40
  ds_write_b128 v66, v[132:135] offset:0
  v_fma_mixlo_f16 v136, v92, s51, 0
  v_fma_mixlo_f16 v137, v94, s51, 0
  v_fma_mixlo_f16 v138, v96, s51, 0
  v_fma_mixlo_f16 v139, v98, s51, 0
  v_fma_mixhi_f16 v136, v93, s51, 0
  v_fma_mixhi_f16 v137, v95, s51, 0
  v_fma_mixhi_f16 v138, v97, s51, 0
  v_fma_mixhi_f16 v139, v99, s51, 0
  ds_write_b128 v66, v[136:139] offset:1024
  v_fma_mixlo_f16 v140, v100, s51, 0
  v_fma_mixlo_f16 v141, v102, s51, 0
  v_fma_mixlo_f16 v142, v104, s51, 0
  v_fma_mixlo_f16 v143, v106, s51, 0
  v_fma_mixhi_f16 v140, v101, s51, 0
  v_fma_mixhi_f16 v141, v103, s51, 0
  v_fma_mixhi_f16 v142, v105, s51, 0
  v_fma_mixhi_f16 v143, v107, s51, 0
  ds_write_b128 v66, v[140:143] offset:2048
  s_branch L_built
L_uconv1:
  v_fma_mixlo_f16 v144, v108, s51, 0
  v_fma_mixlo_f16 v145, v110, s51, 0
  v_fma_mixlo_f16 v146, v112, s51, 0
  v_fma_mixlo_f16 v147, v114, s51, 0
  v_fma_mixhi_f16 v144, v109, s51, 0
  v_fma_mixhi_f16 v145, v111, s51, 0
  v_fma_mixhi_f16 v146, v113, s51, 0
  v_fma_mixhi_f16 v147, v115, s51, 0
L_csync8:
  ds_read_b64 v[40:41], v2 offset:16
  s_waitcnt lgkmcnt(0)
  v_cmp_gt_u32 vcc, 4, v40
  s_cbranch_vccnz L_csync8
  v_readfirstlane_b32 s70, v41
  s_nop 0
  s_lshr_b32 s70, s70, 23
  s_sub_i32 s70, 141, s70
  s_min_i32 s70, s70, 40
  ds_write_b128 v66, v[144:147] offset:3072
  v_fma_mixlo_f16 v148, v116, s51, 0
  v_fma_mixlo_f16 v149, v118, s51, 0
  v_fma_mixlo_f16 v150, v120, s51, 0
  v_fma_mixlo_f16 v151, v122, s51, 0
  v_fma_mixhi_f16 v148, v117, s51, 0
  v_fma_mixhi_f16 v149, v119, s51, 0
  v_fma_mixhi_f16 v150, v121, s51, 0
  v_fma_mixhi_f16 v151, v123, s51, 0
  ds_write_b128 v66, v[148:151] offset:4096
  s_cmp_lg_u32 s84, 0
  s_cbranch_scc1 L_ulin
  v_fma_mixlo_f16 v152, v124, s51, 0
  v_fma_mixlo_f16 v153, v126, s51, 0
  v_fma_mixlo_f16 v154, v128, s51, 0
  v_fma_mixlo_f16 v155, v130, s51, 0
  v_fma_mixhi_f16 v152, v125, s51, 0
  v_fma_mixhi_f16 v153, v127, s51, 0
  v_fma_mixhi_f16 v154, v129, s51, 0
  v_fma_mixhi_f16 v155, v131, s51, 0
  ds_write_b128 v66, v[152:155] offset:5120
  s_branch L_built
L_ulin:
  v_mul_f32 v224, s51, v224
  v_mul_f32 v225, s51, v225
  v_mul_f32 v226, s51, v226
  v_mul_f32 v227, s51, v227
  v_mul_f32 v228, s51, v228
  v_mul_f32 v229, s51, v229
  v_mul_f32 v230, s51, v230
  v_mul_f32 v231, s51, v231
  v_cvt_pk_bf16_f32 v152, v224, v225
  v_cvt_pk_bf16_f32 v153, v226, v227
  v_cvt_pk_bf16_f32 v154, v228, v229
  v_cvt_pk_bf16_f32 v155, v230, v231
  ds_write_b128 v66, v[152:155] offset:5120
L_built:
  s_waitcnt vmcnt(1)
  v_mov_b32 v4, s84
  ds_add_u32 v1, v4 offset:36
  s_mov_b32 s60, s24
  s_and_b32 s61, s25, 0xffff
  s_mov_b32 s62, 268435456
  s_mov_b32 s63, 0x20000
  s_mov_b32 s64, s22
  s_and_b32 s65, s23, 0xffff
  s_mov_b32 s66, 256
  s_mov_b32 s67, 0x20000
  v_lshlrev_b32 v251, 2, v0
  s_mov_b64 exec, 0xff
  s_mov_b32 s81, 0x80000
  buffer_load_dword v255, v251, s[60:63], s81 offen
  buffer_load_dword v249, v251, s[64:67], 0 offen offset:128 sc1
  s_mov_b64 exec, -1
  v_mov_b32 v251, 0
  s_add_i32 s48, s70, s71
L_csync9:
  ds_read_b32 v4, v2 offset:36
  s_waitcnt lgkmcnt(0)
  v_cmp_gt_u32 vcc, 4, v4
  s_cbranch_vccnz L_csync9
  ds_read_u16_d16_hi v32, v7 offset:0
  ds_read_u16_d16_hi v33, v7 offset:128
  ds_read_u16_d16_hi v34, v7 offset:256
  ds_read_u16_d16_hi v35, v7 offset:384
  ds_read_u16_d16_hi v36, v7 offset:512
  ds_read_u16_d16_hi v37, v7 offset:640
  ds_read_u16_d16_hi v38, v7 offset:768
  ds_read_u16_d16_hi v39, v7 offset:896
  s_waitcnt lgkmcnt(0)
  v_cvt_pk_f16_f32 v43, v38, v39
  v_cvt_pk_f16_f32 v40, v32, v35
  v_cvt_pk_f16_f32 v41, v33, v36
  v_cvt_pk_f16_f32 v42, v34, v37
  ds_write_b128 v10, v[40:43]
  ds_read_b128 v[44:47], v11
  ds_read_b128 v[48:51], v12
  ds_read_b64_tr_b16 v[52:53], v8 offset:0
  ds_read_b64_tr_b16 v[54:55], v8 offset:512
  v_pk_mul_f16 v56, v40, v40 op_sel:[0,0] op_sel_hi:[1,1]
  v_pk_mul_f16 v57, v41, v41 op_sel:[0,0] op_sel_hi:[1,1]
  v_pk_mul_f16 v58, v42, v42 op_sel:[0,0] op_sel_hi:[1,1]
  v_pk_mul_f16 v59, v40, v41 op_sel:[0,0] op_sel_hi:[1,1]
  ds_read_u16_d16_hi v32, v7 offset:32
  ds_read_u16_d16_hi v33, v7 offset:160
  s_waitcnt vmcnt(3)
  v_lshlrev_b32 v21, 7, v21
  buffer_load_dword v255, v21, s[32:35], 0 offen
  s_mov_b64 exec, 131071
  buffer_load_dword v255, v19, s[44:47], s101 offen
  s_mov_b64 exec, -1
  s_add_u32 s101, s101, 1171456
  s_waitcnt lgkmcnt(0)
  s_barrier
  s_setprio 1
  ds_read_b128 v[240:243], v28 offset:46528
  ds_read_b128 v[128:131], v28 offset:35264
  ds_read_b128 v[84:87], v28 offset:0
  ds_read_b128 v[216:219], v22
  ds_read_b128 v[244:247], v30 offset:22528
  ds_read_b128 v[172:175], v31 offset:11264
  ds_read_b128 v[176:179], v31 offset:12288
  ds_read_b128 v[180:183], v31 offset:13312
  ds_read2_b32 v[220:221], v29 offset0:0 offset1:2
  ds_read2_b32 v[222:223], v29 offset0:64 offset1:66
  v_add_u32 v29, 2048, v29
  ds_read_b128 v[88:91], v28 offset:1024
  ds_read_b128 v[92:95], v28 offset:2048
  ds_read_b128 v[132:135], v28 offset:36288
  ds_read_b128 v[136:139], v28 offset:37312
  ds_read_b128 v[140:143], v28 offset:38336
  ds_read_b128 v[144:147], v28 offset:39360
  ds_read2_b32 v[224:225], v29 offset0:0 offset1:2
  ds_read2_b32 v[226:227], v29 offset0:64 offset1:66
  v_add_u32 v29, 2048, v29
  s_cmp_lg_u32 s84, 0
  s_cbranch_scc1 L_prf
  s_setprio 2
L_prf:
  s_waitcnt lgkmcnt(14)
  v_mfma_f32_16x16x32_bf16 v[72:75], v[240:243], v[52:55], 0
  ds_read_b128 v[184:187], v31 offset:14336
  v_mfma_f32_16x16x32_f16 v[72:75], v[128:131], v[56:59], v[72:75]
  ds_read_b128 v[188:191], v31 offset:15360
  v_mfma_f32_16x16x32_f16 v[68:71], v[84:87], v[56:59], 0
  ds_read_b128 v[96:99], v28 offset:3072
  v_pk_mul_f16 v60, v40, v41 op_sel:[0,1] op_sel_hi:[1,0]
  v_mfma_f32_16x16x32_f16 v[80:83], v[216:219], v[56:59], 0
  ds_read_b128 v[100:103], v28 offset:4096
  v_pk_mul_f16 v61, v40, v42 op_sel:[0,0] op_sel_hi:[1,1]
  v_pk_mul_f16 v62, v40, v42 op_sel:[0,1] op_sel_hi:[1,0]
  s_waitcnt lgkmcnt(14)
  v_mfma_f32_16x16x32_bf16 v[76:79], v[244:247], v[52:55], 0
  ds_read_b128 v[104:107], v28 offset:5120
  v_pk_mul_f16 v63, v41, v42 op_sel:[0,0] op_sel_hi:[1,1]
  v_pk_mul_f16 v64, v41, v42 op_sel:[0,1] op_sel_hi:[1,0]
  v_mfma_f32_16x16x32_f16 v[76:79], v[172:175], v[56:59], v[76:79]
  ds_read_b128 v[108:111], v28 offset:6144
  v_pk_mul_f16 v65, v40, v43 op_sel:[0,0] op_sel_hi:[1,0]
  v_pk_mul_f16 v66, v41, v43 op_sel:[0,0] op_sel_hi:[1,0]
  v_pk_mul_f16 v67, v42, v43 op_sel:[0,0] op_sel_hi:[1,0]
  v_mfma_f32_16x16x32_f16 v[76:79], v[176:179], v[60:63], v[76:79]
  ds_read2_b32 v[228:229], v29 offset0:0 offset1:2
  ds_read2_b32 v[230:231], v29 offset0:64 offset1:66
  v_add_u32 v29, 2048, v29
  v_alignbit_b32 v48, v48, v48, v13
  v_mfma_f32_16x16x32_f16 v[76:79], v[180:183], v[64:67], v[76:79]
  ds_read_b128 v[148:151], v28 offset:40384
  v_mul_f16_sdwa v52, v40, v40 dst_sel:WORD_0 dst_unused:UNUSED_PAD src0_sel:WORD_0 src1_sel:WORD_1
  v_mul_f16_sdwa v53, v42, v42 dst_sel:WORD_0 dst_unused:UNUSED_PAD src0_sel:WORD_0 src1_sel:WORD_1
  s_waitcnt lgkmcnt(14)
  v_smfmac_f32_16x16x64_f16 v[80:83], v[220:223], v[60:67], v16
  ds_read_b128 v[152:155], v28 offset:41408
  v_alignbit_b32 v49, v49, v49, v13
  v_mfma_f32_16x16x32_f16 v[68:71], v[88:91], v[60:63], v[68:71]
  ds_read_b128 v[192:195], v31 offset:16384
  v_mul_f16_sdwa v52, v41, v41 dst_sel:WORD_1 dst_unused:UNUSED_PRESERVE src0_sel:WORD_0 src1_sel:WORD_1
  v_mul_f16_sdwa v53, v43, v43 dst_sel:WORD_1 dst_unused:UNUSED_PRESERVE src0_sel:WORD_0 src1_sel:WORD_1
  v_mfma_f32_16x16x32_f16 v[68:71], v[92:95], v[64:67], v[68:71]
  ds_read_b128 v[196:199], v31 offset:17408
  v_pk_mul_f16 v54, v40, v47 op_sel:[0,0] op_sel_hi:[1,0]
  v_mfma_f32_16x16x32_f16 v[72:75], v[132:135], v[60:63], v[72:75]
  ds_read_b128 v[200:203], v31 offset:18432
  v_pk_mul_f16 v55, v41, v47 op_sel:[0,0] op_sel_hi:[1,0]
  v_pk_mul_f16 v56, v42, v47 op_sel:[0,0] op_sel_hi:[1,0]
  s_waitcnt lgkmcnt(14)
  v_mfma_f32_16x16x32_f16 v[72:75], v[136:139], v[64:67], v[72:75]
  ds_read_b128 v[204:207], v31 offset:19456
  v_pk_mul_f16 v57, v40, v44 op_sel:[0,0] op_sel_hi:[1,1]
  v_pk_mul_f16 v58, v40, v44 op_sel:[0,1] op_sel_hi:[1,0]
  v_pk_mul_f16 v59, v40, v45 op_sel:[0,0] op_sel_hi:[1,1]
  v_mfma_f32_16x16x32_f16 v[72:75], v[140:143], v[52:55], v[72:75]
  ds_read2_b32 v[232:233], v29 offset0:0 offset1:2
  ds_read2_b32 v[234:235], v29 offset0:64 offset1:66
  v_add_u32 v29, 2048, v29
  v_pk_mul_f16 v60, v40, v45 op_sel:[0,1] op_sel_hi:[1,0]
  v_mfma_f32_16x16x32_f16 v[72:75], v[144:147], v[56:59], v[72:75]
  ds_read_b128 v[156:159], v28 offset:42432
  v_pk_mul_f16 v61, v40, v46 op_sel:[0,0] op_sel_hi:[1,1]
  v_pk_mul_f16 v62, v40, v46 op_sel:[0,1] op_sel_hi:[1,0]
  s_waitcnt lgkmcnt(14)
  v_smfmac_f32_16x16x64_f16 v[80:83], v[224:227], v[52:59], v16
  ds_read_b128 v[160:163], v28 offset:43456
  v_pk_mul_f16 v63, v41, v44 op_sel:[0,0] op_sel_hi:[1,1]
  v_mfma_f32_16x16x32_f16 v[76:79], v[184:187], v[52:55], v[76:79]
  ds_read_b128 v[112:115], v28 offset:7168
  v_pk_mul_f16 v64, v41, v44 op_sel:[0,1] op_sel_hi:[1,0]
  v_pk_mul_f16 v65, v41, v45 op_sel:[0,0] op_sel_hi:[1,1]
  v_mfma_f32_16x16x32_f16 v[76:79], v[188:191], v[56:59], v[76:79]
  ds_read_b128 v[116:119], v28 offset:8192
  v_pk_mul_f16 v66, v41, v45 op_sel:[0,1] op_sel_hi:[1,0]
  v_mfma_f32_16x16x32_f16 v[68:71], v[96:99], v[52:55], v[68:71]
  ds_read_b128 v[120:123], v28 offset:9216
  v_pk_mul_f16 v67, v41, v46 op_sel:[0,0] op_sel_hi:[1,1]
  ds_write_b16 v15, v14 offset:4064
  s_and_b32 s81, s2, 7
  s_waitcnt vmcnt(2)
  v_cmp_eq_u32 vcc, 0, v249
  s_nop 0
  s_bitcmp1_b32 vcc_lo, s81
  s_cbranch_scc0 L_cclr_ok
  s_mov_b32 s78, 0x40000
L_cclr:
  s_sub_u32 s78, s78, 1
  s_cbranch_scc1 L_cclr_ok
  v_lshlrev_b32 v249, 2, v0
  v_and_b32 v249, 31, v249
  buffer_load_dword v249, v249, s[64:67], 0 offen offset:128 sc1
  s_waitcnt vmcnt(0)
  v_cmp_eq_u32 vcc, 0, v249
  s_nop 0
  s_bitcmp1_b32 vcc_lo, s81
  s_cbranch_scc1 L_cclr
L_cclr_ok:
  v_lshl_add_u32 v24, v24, 7, v18
  v_lshl_add_u32 v25, v25, 7, v18
  s_mov_b32 exec_hi, 0x0000ffff
  v_lshl_add_u32 v26, v26, 7, v18
  v_lshl_add_u32 v27, v27, 7, v18
  s_mov_b32 exec_lo, 0
  s_mov_b32 exec_hi, 0xffff0000
  v_mov_b32 v27, v25
  v_mov_b32 v26, v25
  s_mov_b32 exec_hi, 0x00ff0000
  v_mov_b32 v26, v24
  s_mov_b64 exec, -1
  s_add_u32 m0, s74, -39488
  s_nop 0
  buffer_load_dwordx4 v24, s[32:35], 0 offen lds
  s_add_u32 m0, s74, -38432
  s_nop 0
  buffer_load_dwordx4 v25, s[32:35], 0 offen lds
  s_add_u32 m0, s74, -37376
  s_nop 0
  buffer_load_dwordx4 v26, s[32:35], 0 offen lds
  s_add_u32 m0, s74, -36320
  s_mov_b32 exec_hi, 0x00ffffff
  buffer_load_dwordx4 v27, s[32:35], 0 offen lds
  s_mov_b32 exec_hi, -1
  s_mov_b64 exec, 131071
  buffer_load_dword v255, v19, s[44:47], s101 offen
  s_mov_b64 exec, -1
  s_add_u32 s101, s101, 1171456
  s_sub_i32 s48, 0, s48
  s_mov_b32 s49, s48
  s_mov_b32 s97, 1
  s_mov_b32 s50, 1
  s_mov_b32 s96, 0
  s_cmp_lg_u32 s3, 7
  s_cbranch_scc1 L_nw0
  s_mov_b32 s52, s16
  s_and_b32 s53, s17, 0xffff
  s_mov_b32 s54, 3328
  s_mov_b32 s55, 0x20000
  v_lshlrev_b32 v22, 7, v0
  buffer_load_dword v255, v22, s[52:55], 0 offen
L_nw0:
  v_alignbit_b32 v50, v50, v50, v13
  s_waitcnt lgkmcnt(14)
  v_mfma_f32_16x16x32_f16 v[68:71], v[100:103], v[56:59], v[68:71]
  ds_read_b128 v[124:127], v28 offset:10240
  v_pk_mul_f16 v52, v41, v46 op_sel:[0,1] op_sel_hi:[1,0]
  v_pk_mul_f16 v53, v42, v44 op_sel:[0,0] op_sel_hi:[1,1]
  v_mfma_f32_16x16x32_f16 v[68:71], v[104:107], v[60:63], v[68:71]
  ds_read_b128 v[164:167], v28 offset:44480
  v_pk_mul_f16 v54, v42, v44 op_sel:[0,1] op_sel_hi:[1,0]
  v_pk_mul_f16 v55, v42, v45 op_sel:[0,0] op_sel_hi:[1,1]
  v_mfma_f32_16x16x32_f16 v[68:71], v[108:111], v[64:67], v[68:71]
  ds_read_b128 v[168:171], v28 offset:45504
  v_pk_mul_f16 v56, v42, v45 op_sel:[0,1] op_sel_hi:[1,0]
  v_pk_mul_f16 v57, v42, v46 op_sel:[0,0] op_sel_hi:[1,1]
  v_smfmac_f32_16x16x64_f16 v[80:83], v[228:231], v[60:67], v16
  ds_read2_b32 v[236:237], v29 offset0:0 offset1:2
  ds_read2_b32 v[238:239], v29 offset0:64 offset1:66
  v_add_u32 v29, 2048, v29
  v_pk_mul_f16 v58, v42, v46 op_sel:[0,1] op_sel_hi:[1,0]
  v_pk_mul_f16 v59, v40, v48 op_sel:[0,0] op_sel_hi:[1,1]
  s_waitcnt lgkmcnt(14)
  v_mfma_f32_16x16x32_f16 v[72:75], v[148:151], v[60:63], v[72:75]
  ds_read_b128 v[208:211], v31 offset:20480
  ds_read_u16_d16_hi v34, v7 offset:288
  ds_read_u16_d16_hi v35, v7 offset:416
  v_mfma_f32_16x16x32_f16 v[72:75], v[152:155], v[64:67], v[72:75]
  ds_read_b128 v[212:215], v31 offset:21504
  ds_read_u16_d16_hi v36, v7 offset:544
  ds_read_u16_d16_hi v37, v7 offset:672
  v_mfma_f32_16x16x32_f16 v[76:79], v[192:195], v[60:63], v[76:79]
  ds_read_u16_d16_hi v38, v7 offset:800
  ds_read_u16_d16_hi v39, v7 offset:928
  v_mfma_f32_16x16x32_f16 v[76:79], v[196:199], v[64:67], v[76:79]
  v_pk_mul_f16 v60, v41, v49 op_sel:[0,0] op_sel_hi:[1,1]
  v_pk_mul_f16 v61, v42, v50 op_sel:[0,0] op_sel_hi:[1,1]
  v_mfma_f32_16x16x32_f16 v[76:79], v[200:203], v[52:55], v[76:79]
  v_pk_mul_f16 v62, v40, v49 op_sel:[0,0] op_sel_hi:[1,1]
  v_pk_mul_f16 v63, v40, v49 op_sel:[0,1] op_sel_hi:[1,0]
  s_waitcnt lgkmcnt(14)
  v_mfma_f32_16x16x32_f16 v[76:79], v[204:207], v[56:59], v[76:79]
  v_pk_mul_f16 v64, v40, v50 op_sel:[0,0] op_sel_hi:[1,1]
  v_pk_mul_f16 v65, v40, v50 op_sel:[0,1] op_sel_hi:[1,0]
  v_smfmac_f32_16x16x64_f16 v[80:83], v[232:235], v[52:59], v16
  v_pk_mul_f16 v66, v41, v50 op_sel:[0,0] op_sel_hi:[1,1]
  v_pk_mul_f16 v67, v41, v50 op_sel:[0,1] op_sel_hi:[1,0]
  v_mfma_f32_16x16x32_f16 v[72:75], v[156:159], v[52:55], v[72:75]
  s_waitcnt lgkmcnt(0)
  v_cvt_pk_f16_f32 v43, v38, v39
  v_mfma_f32_16x16x32_f16 v[72:75], v[160:163], v[56:59], v[72:75]
  v_cvt_pk_f16_f32 v40, v32, v35
  v_cvt_pk_f16_f32 v41, v33, v36
  v_mfma_f32_16x16x32_f16 v[68:71], v[112:115], v[52:55], v[68:71]
  v_cvt_pk_f16_f32 v42, v34, v37
  v_mfma_f32_16x16x32_f16 v[68:71], v[116:119], v[56:59], v[68:71]
  ds_write_b128 v10, v[40:43]
  v_mfma_f32_16x16x32_f16 v[68:71], v[120:123], v[60:63], v[68:71]
  v_mfma_f32_16x16x32_f16 v[68:71], v[124:127], v[64:67], v[68:71]
  ds_read_b128 v[44:47], v11
  ds_read_b128 v[48:51], v12
  v_mfma_f32_16x16x32_f16 v[72:75], v[164:167], v[60:63], v[72:75]
  ds_read_b64_tr_b16 v[52:53], v8 offset:32
  ds_read_b64_tr_b16 v[54:55], v8 offset:544
  v_mfma_f32_16x16x32_f16 v[72:75], v[168:171], v[64:67], v[72:75]
  v_pk_mul_f16 v56, v40, v40 op_sel:[0,0] op_sel_hi:[1,1]
  v_pk_mul_f16 v57, v41, v41 op_sel:[0,0] op_sel_hi:[1,1]
  v_smfmac_f32_16x16x64_f16 v[80:83], v[236:239], v[60:67], v16
  v_pk_mul_f16 v58, v42, v42 op_sel:[0,0] op_sel_hi:[1,1]
  v_pk_mul_f16 v59, v40, v41 op_sel:[0,0] op_sel_hi:[1,1]
  v_mfma_f32_16x16x32_f16 v[76:79], v[208:211], v[60:63], v[76:79]
  s_nop 1
  v_mul_f32 v14, v68, v72
  v_fmac_f32 v14, v69, v73
  v_mfma_f32_16x16x32_f16 v[76:79], v[212:215], v[64:67], v[76:79]
  v_fmac_f32 v14, v70, v74
  v_fmac_f32 v14, v71, v75
  ds_add_u32 v1, v3 offset:12
  s_branch L_grp1
L_prime:
  v_mov_b32 v68, 0
  v_mov_b32 v69, 0
  v_mov_b32 v70, 0
  v_mov_b32 v71, 0
  v_mov_b32 v72, 0
  v_mov_b32 v73, 0
  v_mov_b32 v74, 0
  v_mov_b32 v75, 0
  v_mov_b32 v76, 0
  v_mov_b32 v77, 0
  v_mov_b32 v78, 0
  v_mov_b32 v79, 0
  v_mov_b32 v80, 0
  v_mov_b32 v81, 0
  v_mov_b32 v82, 0
  v_mov_b32 v83, 0
  v_mov_b32 v22, 0
  v_mov_b32 v23, 0
  ds_read_u16_d16_hi v32, v7 offset:0
  ds_read_u16_d16_hi v33, v7 offset:128
  ds_read_u16_d16_hi v34, v7 offset:256
  ds_read_u16_d16_hi v35, v7 offset:384
  ds_read_u16_d16_hi v36, v7 offset:512
  ds_read_u16_d16_hi v37, v7 offset:640
  ds_read_u16_d16_hi v38, v7 offset:768
  ds_read_u16_d16_hi v39, v7 offset:896
  s_waitcnt lgkmcnt(0)
  v_cvt_pk_f16_f32 v43, v38, v39
  v_cvt_pk_f16_f32 v40, v32, v35
  v_cvt_pk_f16_f32 v41, v33, v36
  v_cvt_pk_f16_f32 v42, v34, v37
  ds_write_b128 v10, v[40:43]
  ds_read_b128 v[44:47], v11
  ds_read_b128 v[48:51], v12
  ds_read_b64_tr_b16 v[52:53], v8 offset:0
  ds_read_b64_tr_b16 v[54:55], v8 offset:512
  v_pk_mul_f16 v56, v40, v40 op_sel:[0,0] op_sel_hi:[1,1]
  v_pk_mul_f16 v57, v41, v41 op_sel:[0,0] op_sel_hi:[1,1]
  v_pk_mul_f16 v58, v42, v42 op_sel:[0,0] op_sel_hi:[1,1]
  v_pk_mul_f16 v59, v40, v41 op_sel:[0,0] op_sel_hi:[1,1]
  ds_read_u16_d16_hi v32, v7 offset:32
  ds_read_u16_d16_hi v33, v7 offset:160
L_cin_loop:
  s_cmp_lg_u32 s84, 0
  s_cbranch_scc1 L_pr0
  s_setprio 2
L_pr0:
  s_waitcnt lgkmcnt(2)
  v_mfma_f32_16x16x32_bf16 v[72:75], v[240:243], v[52:55], 0
  v_add_f32 v22, v80, v81
  v_add_f32 v23, v82, v83
  v_mfma_f32_16x16x32_f16 v[72:75], v[128:131], v[56:59], v[72:75]
  v_fmac_f32 v14, v76, v77
  v_fmac_f32 v14, v22, v78
  v_mfma_f32_16x16x32_f16 v[68:71], v[84:87], v[56:59], 0
  v_fmac_f32 v14, v23, v79
  v_pk_mul_f16 v60, v40, v41 op_sel:[0,1] op_sel_hi:[1,0]
  v_mfma_f32_16x16x32_f16 v[80:83], v[216:219], v[56:59], 0
  v_pk_mul_f16 v61, v40, v42 op_sel:[0,0] op_sel_hi:[1,1]
  v_pk_mul_f16 v62, v40, v42 op_sel:[0,1] op_sel_hi:[1,0]
  v_mfma_f32_16x16x32_bf16 v[76:79], v[244:247], v[52:55], 0
  v_pk_mul_f16 v63, v41, v42 op_sel:[0,0] op_sel_hi:[1,1]
  v_pk_mul_f16 v64, v41, v42 op_sel:[0,1] op_sel_hi:[1,0]
  v_mfma_f32_16x16x32_f16 v[76:79], v[172:175], v[56:59], v[76:79]
  v_pk_mul_f16 v65, v40, v43 op_sel:[0,0] op_sel_hi:[1,0]
  v_pk_mul_f16 v66, v41, v43 op_sel:[0,0] op_sel_hi:[1,0]
  v_pk_mul_f16 v67, v42, v43 op_sel:[0,0] op_sel_hi:[1,0]
  v_mfma_f32_16x16x32_f16 v[76:79], v[176:179], v[60:63], v[76:79]
  v_add_f32_dpp v14, v14, v14 row_shr:1 row_mask:0xf bank_mask:0xf
  v_alignbit_b32 v48, v48, v48, v13
  v_mfma_f32_16x16x32_f16 v[76:79], v[180:183], v[64:67], v[76:79]
  v_mul_f16_sdwa v52, v40, v40 dst_sel:WORD_0 dst_unused:UNUSED_PAD src0_sel:WORD_0 src1_sel:WORD_1
  v_mul_f16_sdwa v53, v42, v42 dst_sel:WORD_0 dst_unused:UNUSED_PAD src0_sel:WORD_0 src1_sel:WORD_1
  v_smfmac_f32_16x16x64_f16 v[80:83], v[220:223], v[60:67], v16
  v_add_f32_dpp v14, v14, v14 row_shr:2 row_mask:0xf bank_mask:0xf
  v_alignbit_b32 v49, v49, v49, v13
  v_mfma_f32_16x16x32_f16 v[68:71], v[88:91], v[60:63], v[68:71]
  v_mul_f16_sdwa v52, v41, v41 dst_sel:WORD_1 dst_unused:UNUSED_PRESERVE src0_sel:WORD_0 src1_sel:WORD_1
  v_mul_f16_sdwa v53, v43, v43 dst_sel:WORD_1 dst_unused:UNUSED_PRESERVE src0_sel:WORD_0 src1_sel:WORD_1
  v_mfma_f32_16x16x32_f16 v[68:71], v[92:95], v[64:67], v[68:71]
  v_add_f32_dpp v14, v14, v14 row_shr:4 row_mask:0xf bank_mask:0xf
  v_pk_mul_f16 v54, v40, v47 op_sel:[0,0] op_sel_hi:[1,0]
  v_mfma_f32_16x16x32_f16 v[72:75], v[132:135], v[60:63], v[72:75]
  v_pk_mul_f16 v55, v41, v47 op_sel:[0,0] op_sel_hi:[1,0]
  v_pk_mul_f16 v56, v42, v47 op_sel:[0,0] op_sel_hi:[1,0]
  v_mfma_f32_16x16x32_f16 v[72:75], v[136:139], v[64:67], v[72:75]
  v_pk_mul_f16 v57, v40, v44 op_sel:[0,0] op_sel_hi:[1,1]
  v_pk_mul_f16 v58, v40, v44 op_sel:[0,1] op_sel_hi:[1,0]
  v_pk_mul_f16 v59, v40, v45 op_sel:[0,0] op_sel_hi:[1,1]
  v_mfma_f32_16x16x32_f16 v[72:75], v[140:143], v[52:55], v[72:75]
  v_add_f32_dpp v14, v14, v14 row_shr:8 row_mask:0xf bank_mask:0xf
  v_pk_mul_f16 v60, v40, v45 op_sel:[0,1] op_sel_hi:[1,0]
  v_mfma_f32_16x16x32_f16 v[72:75], v[144:147], v[56:59], v[72:75]
  v_pk_mul_f16 v61, v40, v46 op_sel:[0,0] op_sel_hi:[1,1]
  v_pk_mul_f16 v62, v40, v46 op_sel:[0,1] op_sel_hi:[1,0]
  v_smfmac_f32_16x16x64_f16 v[80:83], v[224:227], v[52:59], v16
  v_add_f32_dpp v14, v14, v14 row_bcast:15 row_mask:0xa bank_mask:0xf
  v_pk_mul_f16 v63, v41, v44 op_sel:[0,0] op_sel_hi:[1,1]
  v_mfma_f32_16x16x32_f16 v[76:79], v[184:187], v[52:55], v[76:79]
  v_pk_mul_f16 v64, v41, v44 op_sel:[0,1] op_sel_hi:[1,0]
  v_pk_mul_f16 v65, v41, v45 op_sel:[0,0] op_sel_hi:[1,1]
  v_mfma_f32_16x16x32_f16 v[76:79], v[188:191], v[56:59], v[76:79]
  v_add_f32_dpp v14, v14, v14 row_bcast:31 row_mask:0xc bank_mask:0xf
  v_pk_mul_f16 v66, v41, v45 op_sel:[0,1] op_sel_hi:[1,0]
  v_mfma_f32_16x16x32_f16 v[68:71], v[96:99], v[52:55], v[68:71]
  v_pk_mul_f16 v67, v41, v46 op_sel:[0,0] op_sel_hi:[1,1]
  s_waitcnt vmcnt(0)
L_blk:
  s_cmp_eq_u32 s50, 0
  s_cbranch_scc1 L_blkend
  v_readlane_b32 s81, v14, 63
  v_ldexp_f32 v14, v14, s49
  v_and_b32 v14, -2, v14
  s_cmp_ge_u32 s50, 2
  s_cbranch_scc1 L_good
  s_cmp_eq_u64 s[90:91], 0
  s_cbranch_scc1 L_slow
  s_bfe_u32 s81, s81, 0x80017
  s_cmp_eq_u32 s81, 255
  s_cbranch_scc1 L_slow
L_good:
  s_mov_b32 exec_lo, 0
  s_mov_b32 exec_hi, 0x80000000
  buffer_store_dword v14, v251, s[60:63], s85 offen sc1
  s_mov_b64 exec, -1
  s_add_u32 s85, s85, 32
  s_sub_u32 s72, s72, 1
  s_cmp_eq_u32 s72, 0
  s_cbranch_scc1 L_cin_done
  s_cmp_eq_u32 s72, 1
  s_cbranch_scc1 L_lastnext
  v_lshl_add_u32 v24, v24, 7, v18
  v_lshl_add_u32 v25, v25, 7, v18
  s_mov_b32 exec_hi, 0x0000ffff
  v_lshl_add_u32 v26, v26, 7, v18
  v_lshl_add_u32 v27, v27, 7, v18
  s_mov_b32 exec_lo, 0
  s_mov_b32 exec_hi, 0xffff0000
  v_mov_b32 v27, v25
  v_mov_b32 v26, v25
  s_mov_b32 exec_hi, 0x00ff0000
  v_mov_b32 v26, v24
  s_mov_b64 exec, -1
  s_add_u32 m0, s74, 0
  s_nop 0
  buffer_load_dwordx4 v24, s[32:35], 0 offen lds
  s_add_u32 m0, s74, 1056
  s_nop 0
  buffer_load_dwordx4 v25, s[32:35], 0 offen lds
  s_add_u32 m0, s74, 2112
  s_nop 0
  buffer_load_dwordx4 v26, s[32:35], 0 offen lds
  s_add_u32 m0, s74, 3168
  s_mov_b32 exec_hi, 0x00ffffff
  buffer_load_dwordx4 v27, s[32:35], 0 offen lds
  s_mov_b32 exec_hi, -1
  s_add_u32 s94, s94, 832
  s_cmp_lg_u32 s72, s99
  s_cbranch_scc1 L_nodma
  s_lshr_b32 s81, s98, 14
  v_cmp_eq_u32 vcc, 0, v249
  s_nop 0
  s_bitcmp1_b32 vcc_lo, s81
  s_cbranch_scc0 L_tclr_ok
  s_mov_b32 s78, 0x40000
L_tclr:
  s_sub_u32 s78, s78, 1
  s_cbranch_scc1 L_tclr_ok
  v_lshlrev_b32 v249, 2, v0
  v_and_b32 v249, 31, v249
  buffer_load_dword v249, v249, s[64:67], 0 offen offset:128 sc1
  s_waitcnt vmcnt(0)
  v_cmp_eq_u32 vcc, 0, v249
  s_nop 0
  s_bitcmp1_b32 vcc_lo, s81
  s_cbranch_scc1 L_tclr
L_tclr_ok:
  v_mov_b32 v250, 1
  s_mov_b64 exec, 1
  buffer_atomic_add v250, v251, s[60:63], s98 offen sc0
  s_mov_b64 exec, -1
  s_mov_b32 s99, 8
  s_branch L_nodma
L_lastnext:
  s_cmp_lt_i32 s26, 0
  s_cselect_b32 s85, s85, s26
L_nodma:
  s_add_u32 s74, s74, s75
  s_sub_u32 s75, 0, s75
  s_mov_b32 s49, s48
  s_mov_b32 s97, 1
  s_cmp_eq_u32 s50, 3
  s_cbranch_scc1 L_slow2
L_blkend:
  s_mov_b32 s50, s97
  s_cmp_ge_u32 s101, 5537792
  s_cbranch_scc1 L_npf
  s_mov_b64 exec, 131071
  buffer_load_dword v255, v19, s[44:47], s101 offen
  s_mov_b64 exec, -1
  s_add_u32 s101, s101, 1171456
L_npf:
  v_alignbit_b32 v50, v50, v50, v13
  v_mfma_f32_16x16x32_f16 v[68:71], v[100:103], v[56:59], v[68:71]
  v_pk_mul_f16 v52, v41, v46 op_sel:[0,1] op_sel_hi:[1,0]
  v_pk_mul_f16 v53, v42, v44 op_sel:[0,0] op_sel_hi:[1,1]
  v_mfma_f32_16x16x32_f16 v[68:71], v[104:107], v[60:63], v[68:71]
  v_pk_mul_f16 v54, v42, v44 op_sel:[0,1] op_sel_hi:[1,0]
  v_pk_mul_f16 v55, v42, v45 op_sel:[0,0] op_sel_hi:[1,1]
  v_mfma_f32_16x16x32_f16 v[68:71], v[108:111], v[64:67], v[68:71]
  v_pk_mul_f16 v56, v42, v45 op_sel:[0,1] op_sel_hi:[1,0]
  v_pk_mul_f16 v57, v42, v46 op_sel:[0,0] op_sel_hi:[1,1]
  v_smfmac_f32_16x16x64_f16 v[80:83], v[228:231], v[60:67], v16
  v_pk_mul_f16 v58, v42, v46 op_sel:[0,1] op_sel_hi:[1,0]
  v_pk_mul_f16 v59, v40, v48 op_sel:[0,0] op_sel_hi:[1,1]
  v_mfma_f32_16x16x32_f16 v[72:75], v[148:151], v[60:63], v[72:75]
  ds_read_u16_d16_hi v34, v7 offset:288
  ds_read_u16_d16_hi v35, v7 offset:416
  v_mfma_f32_16x16x32_f16 v[72:75], v[152:155], v[64:67], v[72:75]
  ds_read_u16_d16_hi v36, v7 offset:544
  ds_read_u16_d16_hi v37, v7 offset:672
  v_mfma_f32_16x16x32_f16 v[76:79], v[192:195], v[60:63], v[76:79]
  ds_read_u16_d16_hi v38, v7 offset:800
  ds_read_u16_d16_hi v39, v7 offset:928
  v_mfma_f32_16x16x32_f16 v[76:79], v[196:199], v[64:67], v[76:79]
  v_pk_mul_f16 v60, v41, v49 op_sel:[0,0] op_sel_hi:[1,1]
  v_pk_mul_f16 v61, v42, v50 op_sel:[0,0] op_sel_hi:[1,1]
  v_mfma_f32_16x16x32_f16 v[76:79], v[200:203], v[52:55], v[76:79]
  v_pk_mul_f16 v62, v40, v49 op_sel:[0,0] op_sel_hi:[1,1]
  v_pk_mul_f16 v63, v40, v49 op_sel:[0,1] op_sel_hi:[1,0]
  v_mfma_f32_16x16x32_f16 v[76:79], v[204:207], v[56:59], v[76:79]
  v_pk_mul_f16 v64, v40, v50 op_sel:[0,0] op_sel_hi:[1,1]
  v_pk_mul_f16 v65, v40, v50 op_sel:[0,1] op_sel_hi:[1,0]
  v_smfmac_f32_16x16x64_f16 v[80:83], v[232:235], v[52:59], v16
  v_pk_mul_f16 v66, v41, v50 op_sel:[0,0] op_sel_hi:[1,1]
  v_pk_mul_f16 v67, v41, v50 op_sel:[0,1] op_sel_hi:[1,0]
  v_mfma_f32_16x16x32_f16 v[72:75], v[156:159], v[52:55], v[72:75]
  s_waitcnt lgkmcnt(0)
  v_cvt_pk_f16_f32 v43, v38, v39
  v_mfma_f32_16x16x32_f16 v[72:75], v[160:163], v[56:59], v[72:75]
  v_cvt_pk_f16_f32 v40, v32, v35
  v_cvt_pk_f16_f32 v41, v33, v36
  v_mfma_f32_16x16x32_f16 v[68:71], v[112:115], v[52:55], v[68:71]
  v_cvt_pk_f16_f32 v42, v34, v37
  v_mfma_f32_16x16x32_f16 v[68:71], v[116:119], v[56:59], v[68:71]
  ds_write_b128 v10, v[40:43]
  v_mfma_f32_16x16x32_f16 v[68:71], v[120:123], v[60:63], v[68:71]
  v_mfma_f32_16x16x32_f16 v[68:71], v[124:127], v[64:67], v[68:71]
  ds_read_b128 v[44:47], v11
  ds_read_b128 v[48:51], v12
  v_mfma_f32_16x16x32_f16 v[72:75], v[164:167], v[60:63], v[72:75]
  ds_read_b64_tr_b16 v[52:53], v8 offset:32
  ds_read_b64_tr_b16 v[54:55], v8 offset:544
  v_mfma_f32_16x16x32_f16 v[72:75], v[168:171], v[64:67], v[72:75]
  v_pk_mul_f16 v56, v40, v40 op_sel:[0,0] op_sel_hi:[1,1]
  v_pk_mul_f16 v57, v41, v41 op_sel:[0,0] op_sel_hi:[1,1]
  v_smfmac_f32_16x16x64_f16 v[80:83], v[236:239], v[60:67], v16
  v_pk_mul_f16 v58, v42, v42 op_sel:[0,0] op_sel_hi:[1,1]
  v_pk_mul_f16 v59, v40, v41 op_sel:[0,0] op_sel_hi:[1,1]
  v_mfma_f32_16x16x32_f16 v[76:79], v[208:211], v[60:63], v[76:79]
  s_nop 1
  v_mul_f32 v14, v68, v72
  v_fmac_f32 v14, v69, v73
  v_mfma_f32_16x16x32_f16 v[76:79], v[212:215], v[64:67], v[76:79]
  v_fmac_f32 v14, v70, v74
  v_fmac_f32 v14, v71, v75
L_grp1:
  s_waitcnt lgkmcnt(0)
  v_mfma_f32_16x16x32_bf16 v[72:75], v[240:243], v[52:55], 0
  v_add_f32 v22, v80, v81
  v_add_f32 v23, v82, v83
  v_mfma_f32_16x16x32_f16 v[72:75], v[128:131], v[56:59], v[72:75]
  s_nop 0
  v_fmac_f32 v14, v76, v77
  v_fmac_f32 v14, v22, v78
  v_mfma_f32_16x16x32_f16 v[68:71], v[84:87], v[56:59], 0
  v_fmac_f32 v14, v23, v79
  v_pk_mul_f16 v60, v40, v41 op_sel:[0,1] op_sel_hi:[1,0]
  v_mfma_f32_16x16x32_f16 v[80:83], v[216:219], v[56:59], 0
  v_pk_mul_f16 v61, v40, v42 op_sel:[0,0] op_sel_hi:[1,1]
  v_pk_mul_f16 v62, v40, v42 op_sel:[0,1] op_sel_hi:[1,0]
  v_mfma_f32_16x16x32_bf16 v[76:79], v[244:247], v[52:55], 0
  v_pk_mul_f16 v63, v41, v42 op_sel:[0,0] op_sel_hi:[1,1]
  v_pk_mul_f16 v64, v41, v42 op_sel:[0,1] op_sel_hi:[1,0]
  v_mfma_f32_16x16x32_f16 v[76:79], v[172:175], v[56:59], v[76:79]
  v_pk_mul_f16 v65, v40, v43 op_sel:[0,0] op_sel_hi:[1,0]
  v_pk_mul_f16 v66, v41, v43 op_sel:[0,0] op_sel_hi:[1,0]
  v_pk_mul_f16 v67, v42, v43 op_sel:[0,0] op_sel_hi:[1,0]
  v_mfma_f32_16x16x32_f16 v[76:79], v[176:179], v[60:63], v[76:79]
  v_or3_b32 v15, v56, v57, v58
  v_alignbit_b32 v48, v48, v48, v13
  v_mfma_f32_16x16x32_f16 v[76:79], v[180:183], v[64:67], v[76:79]
  v_mul_f16_sdwa v52, v40, v40 dst_sel:WORD_0 dst_unused:UNUSED_PAD src0_sel:WORD_0 src1_sel:WORD_1
  v_mul_f16_sdwa v53, v42, v42 dst_sel:WORD_0 dst_unused:UNUSED_PAD src0_sel:WORD_0 src1_sel:WORD_1
  v_smfmac_f32_16x16x64_f16 v[80:83], v[220:223], v[60:67], v16
  v_mul_f16_sdwa v52, v41, v41 dst_sel:WORD_1 dst_unused:UNUSED_PRESERVE src0_sel:WORD_0 src1_sel:WORD_1
  v_mul_f16_sdwa v53, v43, v43 dst_sel:WORD_1 dst_unused:UNUSED_PRESERVE src0_sel:WORD_0 src1_sel:WORD_1
  v_mfma_f32_16x16x32_f16 v[68:71], v[88:91], v[60:63], v[68:71]
  v_pk_mul_f16 v54, v40, v47 op_sel:[0,0] op_sel_hi:[1,0]
  v_pk_mul_f16 v55, v41, v47 op_sel:[0,0] op_sel_hi:[1,0]
  v_mfma_f32_16x16x32_f16 v[68:71], v[92:95], v[64:67], v[68:71]
  v_pk_mul_f16 v56, v42, v47 op_sel:[0,0] op_sel_hi:[1,0]
  v_pk_mul_f16 v57, v40, v44 op_sel:[0,0] op_sel_hi:[1,1]
  v_mfma_f32_16x16x32_f16 v[72:75], v[132:135], v[60:63], v[72:75]
  v_pk_mul_f16 v58, v40, v44 op_sel:[0,1] op_sel_hi:[1,0]
  v_pk_mul_f16 v59, v40, v45 op_sel:[0,0] op_sel_hi:[1,1]
  v_mfma_f32_16x16x32_f16 v[72:75], v[136:139], v[64:67], v[72:75]
  v_pk_mul_f16 v60, v40, v45 op_sel:[0,1] op_sel_hi:[1,0]
  v_pk_mul_f16 v61, v40, v46 op_sel:[0,0] op_sel_hi:[1,1]
  v_mfma_f32_16x16x32_f16 v[72:75], v[140:143], v[52:55], v[72:75]
  v_pk_mul_f16 v62, v40, v46 op_sel:[0,1] op_sel_hi:[1,0]
  v_pk_mul_f16 v63, v41, v44 op_sel:[0,0] op_sel_hi:[1,1]
  v_mfma_f32_16x16x32_f16 v[72:75], v[144:147], v[56:59], v[72:75]
  v_pk_mul_f16 v64, v41, v44 op_sel:[0,1] op_sel_hi:[1,0]
  v_pk_mul_f16 v65, v41, v45 op_sel:[0,0] op_sel_hi:[1,1]
  v_smfmac_f32_16x16x64_f16 v[80:83], v[224:227], v[52:59], v16
  v_pk_mul_f16 v66, v41, v45 op_sel:[0,1] op_sel_hi:[1,0]
  v_pk_mul_f16 v67, v41, v46 op_sel:[0,0] op_sel_hi:[1,1]
  v_mfma_f32_16x16x32_f16 v[76:79], v[184:187], v[52:55], v[76:79]
  v_alignbit_b32 v49, v49, v49, v13
  v_alignbit_b32 v50, v50, v50, v13
  v_mfma_f32_16x16x32_f16 v[76:79], v[188:191], v[56:59], v[76:79]
  ds_read_u16_d16_hi v32, v7 offset:64
  ds_read_u16_d16_hi v33, v7 offset:192
  v_mfma_f32_16x16x32_f16 v[68:71], v[96:99], v[52:55], v[68:71]
  v_pk_mul_f16 v52, v41, v46 op_sel:[0,1] op_sel_hi:[1,0]
  v_pk_mul_f16 v53, v42, v44 op_sel:[0,0] op_sel_hi:[1,1]
  v_mfma_f32_16x16x32_f16 v[68:71], v[100:103], v[56:59], v[68:71]
  v_pk_mul_f16 v54, v42, v44 op_sel:[0,1] op_sel_hi:[1,0]
  v_pk_mul_f16 v55, v42, v45 op_sel:[0,0] op_sel_hi:[1,1]
  v_mfma_f32_16x16x32_f16 v[68:71], v[104:107], v[60:63], v[68:71]
  v_pk_mul_f16 v56, v42, v45 op_sel:[0,1] op_sel_hi:[1,0]
  v_pk_mul_f16 v57, v42, v46 op_sel:[0,0] op_sel_hi:[1,1]
  v_mfma_f32_16x16x32_f16 v[68:71], v[108:111], v[64:67], v[68:71]
  v_pk_mul_f16 v58, v42, v46 op_sel:[0,1] op_sel_hi:[1,0]
  v_pk_mul_f16 v59, v40, v48 op_sel:[0,0] op_sel_hi:[1,1]
  v_smfmac_f32_16x16x64_f16 v[80:83], v[228:231], v[60:67], v16
  ds_read_u16_d16_hi v34, v7 offset:320
  ds_read_u16_d16_hi v35, v7 offset:448
  v_mfma_f32_16x16x32_f16 v[72:75], v[148:151], v[60:63], v[72:75]
  ds_read_u16_d16_hi v36, v7 offset:576
  ds_read_u16_d16_hi v37, v7 offset:704
  v_mfma_f32_16x16x32_f16 v[72:75], v[152:155], v[64:67], v[72:75]
  ds_read_u16_d16_hi v38, v7 offset:832
  ds_read_u16_d16_hi v39, v7 offset:960
  v_mfma_f32_16x16x32_f16 v[76:79], v[192:195], v[60:63], v[76:79]
  v_and_b32 v15, 0x60006000, v15
  v_cmp_ne_u32 s[90:91], 0, v15
  v_mfma_f32_16x16x32_f16 v[76:79], v[196:199], v[64:67], v[76:79]
  v_pk_mul_f16 v60, v41, v49 op_sel:[0,0] op_sel_hi:[1,1]
  v_pk_mul_f16 v61, v42, v50 op_sel:[0,0] op_sel_hi:[1,1]
  v_mfma_f32_16x16x32_f16 v[76:79], v[200:203], v[52:55], v[76:79]
  v_pk_mul_f16 v62, v40, v49 op_sel:[0,0] op_sel_hi:[1,1]
  v_pk_mul_f16 v63, v40, v49 op_sel:[0,1] op_sel_hi:[1,0]
  v_mfma_f32_16x16x32_f16 v[76:79], v[204:207], v[56:59], v[76:79]
  v_pk_mul_f16 v64, v40, v50 op_sel:[0,0] op_sel_hi:[1,1]
  v_pk_mul_f16 v65, v40, v50 op_sel:[0,1] op_sel_hi:[1,0]
  v_smfmac_f32_16x16x64_f16 v[80:83], v[232:235], v[52:59], v16
  v_pk_mul_f16 v66, v41, v50 op_sel:[0,0] op_sel_hi:[1,1]
  v_pk_mul_f16 v67, v41, v50 op_sel:[0,1] op_sel_hi:[1,0]
  v_mfma_f32_16x16x32_f16 v[72:75], v[156:159], v[52:55], v[72:75]
  s_waitcnt lgkmcnt(0)
  v_cvt_pk_f16_f32 v43, v38, v39
  v_mfma_f32_16x16x32_f16 v[72:75], v[160:163], v[56:59], v[72:75]
  v_cvt_pk_f16_f32 v40, v32, v35
  v_cvt_pk_f16_f32 v41, v33, v36
  v_mfma_f32_16x16x32_f16 v[68:71], v[112:115], v[52:55], v[68:71]
  v_cvt_pk_f16_f32 v42, v34, v37
  v_mfma_f32_16x16x32_f16 v[68:71], v[116:119], v[56:59], v[68:71]
  ds_write_b128 v10, v[40:43]
  v_mfma_f32_16x16x32_f16 v[68:71], v[120:123], v[60:63], v[68:71]
  v_mfma_f32_16x16x32_f16 v[68:71], v[124:127], v[64:67], v[68:71]
  ds_read_b128 v[44:47], v11
  ds_read_b128 v[48:51], v12
  v_mfma_f32_16x16x32_f16 v[72:75], v[164:167], v[60:63], v[72:75]
  ds_read_b64_tr_b16 v[52:53], v8 offset:64
  ds_read_b64_tr_b16 v[54:55], v8 offset:576
  v_mfma_f32_16x16x32_f16 v[72:75], v[168:171], v[64:67], v[72:75]
  v_pk_mul_f16 v56, v40, v40 op_sel:[0,0] op_sel_hi:[1,1]
  v_pk_mul_f16 v57, v41, v41 op_sel:[0,0] op_sel_hi:[1,1]
  v_smfmac_f32_16x16x64_f16 v[80:83], v[236:239], v[60:67], v16
  v_pk_mul_f16 v58, v42, v42 op_sel:[0,0] op_sel_hi:[1,1]
  v_pk_mul_f16 v59, v40, v41 op_sel:[0,0] op_sel_hi:[1,1]
  v_mfma_f32_16x16x32_f16 v[76:79], v[208:211], v[60:63], v[76:79]
  s_nop 1
  v_fmac_f32 v14, v68, v72
  v_fmac_f32 v14, v69, v73
  v_mfma_f32_16x16x32_f16 v[76:79], v[212:215], v[64:67], v[76:79]
  v_fmac_f32 v14, v70, v74
  v_fmac_f32 v14, v71, v75
  s_cmp_eq_u32 s72, s96
  s_cbranch_scc1 L_htail
  s_waitcnt lgkmcnt(0)
  v_mfma_f32_16x16x32_bf16 v[72:75], v[240:243], v[52:55], 0
  v_add_f32 v22, v80, v81
  v_add_f32 v23, v82, v83
  v_mfma_f32_16x16x32_f16 v[72:75], v[128:131], v[56:59], v[72:75]
  v_fmac_f32 v14, v76, v77
  v_fmac_f32 v14, v22, v78
  v_mfma_f32_16x16x32_f16 v[68:71], v[84:87], v[56:59], 0
  v_fmac_f32 v14, v23, v79
  v_pk_mul_f16 v60, v40, v41 op_sel:[0,1] op_sel_hi:[1,0]
  v_mfma_f32_16x16x32_f16 v[80:83], v[216:219], v[56:59], 0
  v_pk_mul_f16 v61, v40, v42 op_sel:[0,0] op_sel_hi:[1,1]
  v_pk_mul_f16 v62, v40, v42 op_sel:[0,1] op_sel_hi:[1,0]
  v_mfma_f32_16x16x32_bf16 v[76:79], v[244:247], v[52:55], 0
  v_pk_mul_f16 v63, v41, v42 op_sel:[0,0] op_sel_hi:[1,1]
  v_pk_mul_f16 v64, v41, v42 op_sel:[0,1] op_sel_hi:[1,0]
  v_mfma_f32_16x16x32_f16 v[76:79], v[172:175], v[56:59], v[76:79]
  v_pk_mul_f16 v65, v40, v43 op_sel:[0,0] op_sel_hi:[1,0]
  v_pk_mul_f16 v66, v41, v43 op_sel:[0,0] op_sel_hi:[1,0]
  v_pk_mul_f16 v67, v42, v43 op_sel:[0,0] op_sel_hi:[1,0]
  v_mfma_f32_16x16x32_f16 v[76:79], v[176:179], v[60:63], v[76:79]
  v_mul_f16_sdwa v52, v40, v40 dst_sel:WORD_0 dst_unused:UNUSED_PAD src0_sel:WORD_0 src1_sel:WORD_1
  v_mul_f16_sdwa v53, v42, v42 dst_sel:WORD_0 dst_unused:UNUSED_PAD src0_sel:WORD_0 src1_sel:WORD_1
  v_mfma_f32_16x16x32_f16 v[76:79], v[180:183], v[64:67], v[76:79]
  v_mul_f16_sdwa v52, v41, v41 dst_sel:WORD_1 dst_unused:UNUSED_PRESERVE src0_sel:WORD_0 src1_sel:WORD_1
  v_mul_f16_sdwa v53, v43, v43 dst_sel:WORD_1 dst_unused:UNUSED_PRESERVE src0_sel:WORD_0 src1_sel:WORD_1
  v_smfmac_f32_16x16x64_f16 v[80:83], v[220:223], v[60:67], v16
  v_pk_mul_f16 v54, v40, v47 op_sel:[0,0] op_sel_hi:[1,0]
  v_pk_mul_f16 v55, v41, v47 op_sel:[0,0] op_sel_hi:[1,0]
  v_mfma_f32_16x16x32_f16 v[68:71], v[88:91], v[60:63], v[68:71]
  v_pk_mul_f16 v56, v42, v47 op_sel:[0,0] op_sel_hi:[1,0]
  v_pk_mul_f16 v57, v40, v44 op_sel:[0,0] op_sel_hi:[1,1]
  v_mfma_f32_16x16x32_f16 v[68:71], v[92:95], v[64:67], v[68:71]
  v_pk_mul_f16 v58, v40, v44 op_sel:[0,1] op_sel_hi:[1,0]
  v_pk_mul_f16 v59, v40, v45 op_sel:[0,0] op_sel_hi:[1,1]
  v_mfma_f32_16x16x32_f16 v[72:75], v[132:135], v[60:63], v[72:75]
  v_pk_mul_f16 v60, v40, v45 op_sel:[0,1] op_sel_hi:[1,0]
  v_pk_mul_f16 v61, v40, v46 op_sel:[0,0] op_sel_hi:[1,1]
  v_mfma_f32_16x16x32_f16 v[72:75], v[136:139], v[64:67], v[72:75]
  v_pk_mul_f16 v62, v40, v46 op_sel:[0,1] op_sel_hi:[1,0]
  v_pk_mul_f16 v63, v41, v44 op_sel:[0,0] op_sel_hi:[1,1]
  v_mfma_f32_16x16x32_f16 v[72:75], v[140:143], v[52:55], v[72:75]
  v_pk_mul_f16 v64, v41, v44 op_sel:[0,1] op_sel_hi:[1,0]
  v_pk_mul_f16 v65, v41, v45 op_sel:[0,0] op_sel_hi:[1,1]
  v_mfma_f32_16x16x32_f16 v[72:75], v[144:147], v[56:59], v[72:75]
  v_pk_mul_f16 v66, v41, v45 op_sel:[0,1] op_sel_hi:[1,0]
  v_pk_mul_f16 v67, v41, v46 op_sel:[0,0] op_sel_hi:[1,1]
  v_smfmac_f32_16x16x64_f16 v[80:83], v[224:227], v[52:59], v16
  v_alignbit_b32 v48, v48, v48, v13
  v_alignbit_b32 v49, v49, v49, v13
  v_mfma_f32_16x16x32_f16 v[76:79], v[184:187], v[52:55], v[76:79]
  v_alignbit_b32 v50, v50, v50, v13
  ds_read_u16_d16_hi v32, v7 offset:96
  v_mfma_f32_16x16x32_f16 v[76:79], v[188:191], v[56:59], v[76:79]
  ds_read_u16_d16_hi v33, v7 offset:224
  ds_read_u16_d16_hi v34, v7 offset:352
  s_cmp_lg_u32 s99, 8
  s_cbranch_scc1 L_hk
  s_waitcnt vmcnt(0)
  v_readfirstlane_b32 s81, v250
  s_mov_b32 s99, 0
  s_add_u32 s81, s81, 1
  s_cmp_ge_u32 s81, 32
  s_cbranch_scc1 L_hk
  s_add_u32 s72, s72, 1
  s_mov_b32 s26, 10240
  s_cmp_lt_u32 s81, 24
  s_cbranch_scc1 L_hkf
  s_add_u32 s81, s81, 24
  s_and_b32 s94, s81, 1
  s_lshr_b32 s81, s81, 1
  s_mov_b32 s96, 1
  s_lshl_b32 s94, s94, 6
  v_xor_b32 v18, s94, v18
  s_lshl_b32 s94, s94, 5
  s_add_u32 s26, s26, s94
L_hkf:
  s_add_u32 s81, s81, 484
  s_lshl_b32 s94, s81, 2
  s_add_u32 s26, s26, s94
  s_andn2_b32 s94, s98, 0x3fff
  s_add_u32 s26, s26, s94
  s_lshr_b32 s94, s94, 5
  s_add_u32 s94, s94, s81
  s_mul_i32 s94, s94, 104
L_hk:
  buffer_load_dwordx4 v[24:27], v17, s[28:31], s94 offen offset:0
  v_mfma_f32_16x16x32_f16 v[68:71], v[96:99], v[52:55], v[68:71]
  v_pk_mul_f16 v52, v41, v46 op_sel:[0,1] op_sel_hi:[1,0]
  v_pk_mul_f16 v53, v42, v44 op_sel:[0,0] op_sel_hi:[1,1]
  v_mfma_f32_16x16x32_f16 v[68:71], v[100:103], v[56:59], v[68:71]
  v_pk_mul_f16 v54, v42, v44 op_sel:[0,1] op_sel_hi:[1,0]
  v_pk_mul_f16 v55, v42, v45 op_sel:[0,0] op_sel_hi:[1,1]
  v_mfma_f32_16x16x32_f16 v[68:71], v[104:107], v[60:63], v[68:71]
  v_pk_mul_f16 v56, v42, v45 op_sel:[0,1] op_sel_hi:[1,0]
  v_pk_mul_f16 v57, v42, v46 op_sel:[0,0] op_sel_hi:[1,1]
  v_mfma_f32_16x16x32_f16 v[68:71], v[108:111], v[64:67], v[68:71]
  v_pk_mul_f16 v58, v42, v46 op_sel:[0,1] op_sel_hi:[1,0]
  v_pk_mul_f16 v59, v40, v48 op_sel:[0,0] op_sel_hi:[1,1]
  v_smfmac_f32_16x16x64_f16 v[80:83], v[228:231], v[60:67], v16
  ds_read_u16_d16_hi v35, v7 offset:480
  ds_read_u16_d16_hi v36, v7 offset:608
  v_mfma_f32_16x16x32_f16 v[72:75], v[148:151], v[60:63], v[72:75]
  ds_read_u16_d16_hi v37, v7 offset:736
  ds_read_u16_d16_hi v38, v7 offset:864
  v_mfma_f32_16x16x32_f16 v[72:75], v[152:155], v[64:67], v[72:75]
  ds_read_u16_d16_hi v39, v7 offset:992
  v_mfma_f32_16x16x32_f16 v[76:79], v[192:195], v[60:63], v[76:79]
  v_pk_mul_f16 v60, v41, v49 op_sel:[0,0] op_sel_hi:[1,1]
  v_pk_mul_f16 v61, v42, v50 op_sel:[0,0] op_sel_hi:[1,1]
  v_mfma_f32_16x16x32_f16 v[76:79], v[196:199], v[64:67], v[76:79]
  v_pk_mul_f16 v62, v40, v49 op_sel:[0,0] op_sel_hi:[1,1]
  v_pk_mul_f16 v63, v40, v49 op_sel:[0,1] op_sel_hi:[1,0]
  v_mfma_f32_16x16x32_f16 v[76:79], v[200:203], v[52:55], v[76:79]
  v_pk_mul_f16 v64, v40, v50 op_sel:[0,0] op_sel_hi:[1,1]
  v_pk_mul_f16 v65, v40, v50 op_sel:[0,1] op_sel_hi:[1,0]
  s_cmp_lg_u32 s84, 0
  s_cbranch_scc1 L_pr110
  s_setprio 0
L_pr110:
  v_mfma_f32_16x16x32_f16 v[76:79], v[204:207], v[56:59], v[76:79]
  v_pk_mul_f16 v66, v41, v50 op_sel:[0,0] op_sel_hi:[1,1]
  v_pk_mul_f16 v67, v41, v50 op_sel:[0,1] op_sel_hi:[1,0]
  v_smfmac_f32_16x16x64_f16 v[80:83], v[232:235], v[52:59], v16
  s_waitcnt lgkmcnt(0)
  v_cvt_pk_f16_f32 v43, v38, v39
  v_mfma_f32_16x16x32_f16 v[72:75], v[156:159], v[52:55], v[72:75]
  v_cvt_pk_f16_f32 v40, v32, v35
  v_cvt_pk_f16_f32 v41, v33, v36
  v_mfma_f32_16x16x32_f16 v[72:75], v[160:163], v[56:59], v[72:75]
  v_cvt_pk_f16_f32 v42, v34, v37
  v_mfma_f32_16x16x32_f16 v[68:71], v[112:115], v[52:55], v[68:71]
  ds_write_b128 v10, v[40:43]
  v_mfma_f32_16x16x32_f16 v[68:71], v[116:119], v[56:59], v[68:71]
  v_add_u32 v7, s75, v7
  s_waitcnt vmcnt(1)
  v_mfma_f32_16x16x32_f16 v[68:71], v[120:123], v[60:63], v[68:71]
  ds_read_b128 v[44:47], v11
  ds_read_b128 v[48:51], v12
  v_mfma_f32_16x16x32_f16 v[68:71], v[124:127], v[64:67], v[68:71]
  ds_read_b64_tr_b16 v[52:53], v8 offset:96
  ds_read_b64_tr_b16 v[54:55], v8 offset:608
  v_mfma_f32_16x16x32_f16 v[72:75], v[164:167], v[60:63], v[72:75]
  v_pk_mul_f16 v56, v40, v40 op_sel:[0,0] op_sel_hi:[1,1]
  v_pk_mul_f16 v57, v41, v41 op_sel:[0,0] op_sel_hi:[1,1]
  v_mfma_f32_16x16x32_f16 v[72:75], v[168:171], v[64:67], v[72:75]
  v_pk_mul_f16 v58, v42, v42 op_sel:[0,0] op_sel_hi:[1,1]
  v_pk_mul_f16 v59, v40, v41 op_sel:[0,0] op_sel_hi:[1,1]
  v_smfmac_f32_16x16x64_f16 v[80:83], v[236:239], v[60:67], v16
  ds_read_u16_d16_hi v32, v7 offset:0
  ds_read_u16_d16_hi v33, v7 offset:128
  v_mfma_f32_16x16x32_f16 v[76:79], v[208:211], v[60:63], v[76:79]
  s_nop 1
  v_fmac_f32 v14, v68, v72
  v_fmac_f32 v14, v69, v73
  v_mfma_f32_16x16x32_f16 v[76:79], v[212:215], v[64:67], v[76:79]
  v_fmac_f32 v14, v70, v74
  v_fmac_f32 v14, v71, v75
  s_waitcnt lgkmcnt(2)
  v_mfma_f32_16x16x32_bf16 v[72:75], v[240:243], v[52:55], 0
  v_add_f32 v22, v80, v81
  v_add_f32 v23, v82, v83
  v_mfma_f32_16x16x32_f16 v[72:75], v[128:131], v[56:59], v[72:75]
  s_nop 0
  v_fmac_f32 v14, v76, v77
  v_fmac_f32 v14, v22, v78
  v_mfma_f32_16x16x32_f16 v[68:71], v[84:87], v[56:59], 0
  v_fmac_f32 v14, v23, v79
  v_pk_mul_f16 v60, v40, v41 op_sel:[0,1] op_sel_hi:[1,0]
  v_mfma_f32_16x16x32_f16 v[80:83], v[216:219], v[56:59], 0
  v_pk_mul_f16 v61, v40, v42 op_sel:[0,0] op_sel_hi:[1,1]
  v_pk_mul_f16 v62, v40, v42 op_sel:[0,1] op_sel_hi:[1,0]
  v_mfma_f32_16x16x32_bf16 v[76:79], v[244:247], v[52:55], 0
  v_pk_mul_f16 v63, v41, v42 op_sel:[0,0] op_sel_hi:[1,1]
  v_pk_mul_f16 v64, v41, v42 op_sel:[0,1] op_sel_hi:[1,0]
  v_mfma_f32_16x16x32_f16 v[76:79], v[172:175], v[56:59], v[76:79]
  v_pk_mul_f16 v65, v40, v43 op_sel:[0,0] op_sel_hi:[1,0]
  v_pk_mul_f16 v66, v41, v43 op_sel:[0,0] op_sel_hi:[1,0]
  v_pk_mul_f16 v67, v42, v43 op_sel:[0,0] op_sel_hi:[1,0]
  v_mfma_f32_16x16x32_f16 v[76:79], v[176:179], v[60:63], v[76:79]
  v_mul_f16_sdwa v52, v40, v40 dst_sel:WORD_0 dst_unused:UNUSED_PAD src0_sel:WORD_0 src1_sel:WORD_1
  v_mul_f16_sdwa v53, v42, v42 dst_sel:WORD_0 dst_unused:UNUSED_PAD src0_sel:WORD_0 src1_sel:WORD_1
  v_mfma_f32_16x16x32_f16 v[76:79], v[180:183], v[64:67], v[76:79]
  v_mul_f16_sdwa v52, v41, v41 dst_sel:WORD_1 dst_unused:UNUSED_PRESERVE src0_sel:WORD_0 src1_sel:WORD_1
  v_mul_f16_sdwa v53, v43, v43 dst_sel:WORD_1 dst_unused:UNUSED_PRESERVE src0_sel:WORD_0 src1_sel:WORD_1
  v_smfmac_f32_16x16x64_f16 v[80:83], v[220:223], v[60:67], v16
  v_pk_mul_f16 v54, v40, v47 op_sel:[0,0] op_sel_hi:[1,0]
  v_pk_mul_f16 v55, v41, v47 op_sel:[0,0] op_sel_hi:[1,0]
  v_mfma_f32_16x16x32_f16 v[68:71], v[88:91], v[60:63], v[68:71]
  v_pk_mul_f16 v56, v42, v47 op_sel:[0,0] op_sel_hi:[1,0]
  v_pk_mul_f16 v57, v40, v44 op_sel:[0,0] op_sel_hi:[1,1]
  v_mfma_f32_16x16x32_f16 v[68:71], v[92:95], v[64:67], v[68:71]
  v_pk_mul_f16 v58, v40, v44 op_sel:[0,1] op_sel_hi:[1,0]
  v_pk_mul_f16 v59, v40, v45 op_sel:[0,0] op_sel_hi:[1,1]
  v_mfma_f32_16x16x32_f16 v[72:75], v[132:135], v[60:63], v[72:75]
  v_pk_mul_f16 v60, v40, v45 op_sel:[0,1] op_sel_hi:[1,0]
  v_pk_mul_f16 v61, v40, v46 op_sel:[0,0] op_sel_hi:[1,1]
  v_mfma_f32_16x16x32_f16 v[72:75], v[136:139], v[64:67], v[72:75]
  v_pk_mul_f16 v62, v40, v46 op_sel:[0,1] op_sel_hi:[1,0]
  v_pk_mul_f16 v63, v41, v44 op_sel:[0,0] op_sel_hi:[1,1]
  v_mfma_f32_16x16x32_f16 v[72:75], v[140:143], v[52:55], v[72:75]
  v_pk_mul_f16 v64, v41, v44 op_sel:[0,1] op_sel_hi:[1,0]
  v_pk_mul_f16 v65, v41, v45 op_sel:[0,0] op_sel_hi:[1,1]
  v_mfma_f32_16x16x32_f16 v[72:75], v[144:147], v[56:59], v[72:75]
  v_pk_mul_f16 v66, v41, v45 op_sel:[0,1] op_sel_hi:[1,0]
  v_pk_mul_f16 v67, v41, v46 op_sel:[0,0] op_sel_hi:[1,1]
  v_smfmac_f32_16x16x64_f16 v[80:83], v[224:227], v[52:59], v16
  v_alignbit_b32 v48, v48, v48, v13
  v_alignbit_b32 v49, v49, v49, v13
  v_mfma_f32_16x16x32_f16 v[76:79], v[184:187], v[52:55], v[76:79]
  v_alignbit_b32 v50, v50, v50, v13
  ds_read_u16_d16_hi v34, v7 offset:256
  v_mfma_f32_16x16x32_f16 v[76:79], v[188:191], v[56:59], v[76:79]
  ds_read_u16_d16_hi v35, v7 offset:384
  ds_read_u16_d16_hi v36, v7 offset:512
  v_mfma_f32_16x16x32_f16 v[68:71], v[96:99], v[52:55], v[68:71]
  v_pk_mul_f16 v52, v41, v46 op_sel:[0,1] op_sel_hi:[1,0]
  v_pk_mul_f16 v53, v42, v44 op_sel:[0,0] op_sel_hi:[1,1]
  v_mfma_f32_16x16x32_f16 v[68:71], v[100:103], v[56:59], v[68:71]
  v_pk_mul_f16 v54, v42, v44 op_sel:[0,1] op_sel_hi:[1,0]
  v_pk_mul_f16 v55, v42, v45 op_sel:[0,0] op_sel_hi:[1,1]
  v_mfma_f32_16x16x32_f16 v[68:71], v[104:107], v[60:63], v[68:71]
  v_pk_mul_f16 v56, v42, v45 op_sel:[0,1] op_sel_hi:[1,0]
  v_pk_mul_f16 v57, v42, v46 op_sel:[0,0] op_sel_hi:[1,1]
  v_mfma_f32_16x16x32_f16 v[68:71], v[108:111], v[64:67], v[68:71]
  v_pk_mul_f16 v58, v42, v46 op_sel:[0,1] op_sel_hi:[1,0]
  v_pk_mul_f16 v59, v40, v48 op_sel:[0,0] op_sel_hi:[1,1]
  v_smfmac_f32_16x16x64_f16 v[80:83], v[228:231], v[60:67], v16
  ds_read_u16_d16_hi v37, v7 offset:640
  ds_read_u16_d16_hi v38, v7 offset:768
  v_mfma_f32_16x16x32_f16 v[72:75], v[148:151], v[60:63], v[72:75]
  ds_read_u16_d16_hi v39, v7 offset:896
  s_add_u32 s81, s74, s75
  v_add_u32 v8, s81, v9
  v_mfma_f32_16x16x32_f16 v[72:75], v[152:155], v[64:67], v[72:75]
  v_mfma_f32_16x16x32_f16 v[76:79], v[192:195], v[60:63], v[76:79]
  v_pk_mul_f16 v60, v41, v49 op_sel:[0,0] op_sel_hi:[1,1]
  v_pk_mul_f16 v61, v42, v50 op_sel:[0,0] op_sel_hi:[1,1]
  v_mfma_f32_16x16x32_f16 v[76:79], v[196:199], v[64:67], v[76:79]
  v_pk_mul_f16 v62, v40, v49 op_sel:[0,0] op_sel_hi:[1,1]
  v_pk_mul_f16 v63, v40, v49 op_sel:[0,1] op_sel_hi:[1,0]
  v_mfma_f32_16x16x32_f16 v[76:79], v[200:203], v[52:55], v[76:79]
  v_pk_mul_f16 v64, v40, v50 op_sel:[0,0] op_sel_hi:[1,1]
  v_pk_mul_f16 v65, v40, v50 op_sel:[0,1] op_sel_hi:[1,0]
  v_mfma_f32_16x16x32_f16 v[76:79], v[204:207], v[56:59], v[76:79]
  v_pk_mul_f16 v66, v41, v50 op_sel:[0,0] op_sel_hi:[1,1]
  v_pk_mul_f16 v67, v41, v50 op_sel:[0,1] op_sel_hi:[1,0]
  v_smfmac_f32_16x16x64_f16 v[80:83], v[232:235], v[52:59], v16
  s_waitcnt lgkmcnt(0)
  v_cvt_pk_f16_f32 v43, v38, v39
  v_mfma_f32_16x16x32_f16 v[72:75], v[156:159], v[52:55], v[72:75]
  v_cvt_pk_f16_f32 v40, v32, v35
  v_cvt_pk_f16_f32 v41, v33, v36
  v_mfma_f32_16x16x32_f16 v[72:75], v[160:163], v[56:59], v[72:75]
  v_cvt_pk_f16_f32 v42, v34, v37
  v_mfma_f32_16x16x32_f16 v[68:71], v[112:115], v[52:55], v[68:71]
  ds_write_b128 v10, v[40:43]
  v_mfma_f32_16x16x32_f16 v[68:71], v[116:119], v[56:59], v[68:71]
  v_mfma_f32_16x16x32_f16 v[68:71], v[120:123], v[60:63], v[68:71]
  ds_read_b128 v[44:47], v11
  ds_read_b128 v[48:51], v12
  v_mfma_f32_16x16x32_f16 v[68:71], v[124:127], v[64:67], v[68:71]
  ds_read_b64_tr_b16 v[52:53], v8 offset:0
  ds_read_b64_tr_b16 v[54:55], v8 offset:512
  v_mfma_f32_16x16x32_f16 v[72:75], v[164:167], v[60:63], v[72:75]
  v_pk_mul_f16 v56, v40, v40 op_sel:[0,0] op_sel_hi:[1,1]
  v_pk_mul_f16 v57, v41, v41 op_sel:[0,0] op_sel_hi:[1,1]
  v_mfma_f32_16x16x32_f16 v[72:75], v[168:171], v[64:67], v[72:75]
  v_pk_mul_f16 v58, v42, v42 op_sel:[0,0] op_sel_hi:[1,1]
  v_pk_mul_f16 v59, v40, v41 op_sel:[0,0] op_sel_hi:[1,1]
  v_smfmac_f32_16x16x64_f16 v[80:83], v[236:239], v[60:67], v16
  ds_read_u16_d16_hi v32, v7 offset:32
  ds_read_u16_d16_hi v33, v7 offset:160
  v_mfma_f32_16x16x32_f16 v[76:79], v[208:211], v[60:63], v[76:79]
  s_nop 1
  v_fmac_f32 v14, v68, v72
  v_fmac_f32 v14, v69, v73
  v_mfma_f32_16x16x32_f16 v[76:79], v[212:215], v[64:67], v[76:79]
  v_fmac_f32 v14, v70, v74
  v_fmac_f32 v14, v71, v75
  s_cmp_lg_u32 s72, 1
  s_cbranch_scc1 L_cin_loop
  v_add_f32 v22, v80, v81
  v_add_f32 v23, v82, v83
  s_nop 1
  v_fmac_f32 v14, v76, v77
  v_fmac_f32 v14, v22, v78
  v_fmac_f32 v14, v23, v79
  s_nop 1
  v_add_f32_dpp v14, v14, v14 row_shr:1 row_mask:0xf bank_mask:0xf
  s_nop 1
  v_add_f32_dpp v14, v14, v14 row_shr:2 row_mask:0xf bank_mask:0xf
  s_nop 1
  v_add_f32_dpp v14, v14, v14 row_shr:4 row_mask:0xf bank_mask:0xf
  s_nop 1
  v_add_f32_dpp v14, v14, v14 row_shr:8 row_mask:0xf bank_mask:0xf
  s_nop 1
  v_add_f32_dpp v14, v14, v14 row_bcast:15 row_mask:0xa bank_mask:0xf
  s_nop 1
  v_add_f32_dpp v14, v14, v14 row_bcast:31 row_mask:0xc bank_mask:0xf
  s_branch L_blk
L_htail:
  v_add_f32 v22, v80, v81
  v_add_f32 v23, v82, v83
  s_nop 1
  v_fmac_f32 v14, v76, v77
  v_fmac_f32 v14, v22, v78
  v_fmac_f32 v14, v23, v79
  s_nop 1
  v_add_f32_dpp v14, v14, v14 row_shr:1 row_mask:0xf bank_mask:0xf
  s_nop 1
  v_add_f32_dpp v14, v14, v14 row_shr:2 row_mask:0xf bank_mask:0xf
  s_nop 1
  v_add_f32_dpp v14, v14, v14 row_shr:4 row_mask:0xf bank_mask:0xf
  s_nop 1
  v_add_f32_dpp v14, v14, v14 row_shr:8 row_mask:0xf bank_mask:0xf
  s_nop 1
  v_add_f32_dpp v14, v14, v14 row_bcast:15 row_mask:0xa bank_mask:0xf
  s_nop 1
  v_add_f32_dpp v14, v14, v14 row_bcast:31 row_mask:0xc bank_mask:0xf
  v_add_u32 v7, s75, v7
  s_branch L_blk
L_slow:
  v_subrev_u32 v7, s75, v7
L_slow2:
  v_lshlrev_b32 v22, 1, v0
  v_add_u32 v23, s74, v22
  s_mul_i32 s81, s3, 4224
  s_add_u32 s81, s81, 1024
  v_add_u32 v22, s81, v22
  v_add_u32 v8, s81, v9
L_csync10:
  ds_read_b32 v4, v2 offset:12
  s_waitcnt lgkmcnt(0)
  v_cmp_gt_u32 vcc, 8, v4
  s_cbranch_vccnz L_csync10
  ds_read_u16 v52, v23 offset:0
  ds_read_u16 v53, v23 offset:128
  ds_read_u16 v54, v23 offset:256
  ds_read_u16 v55, v23 offset:384
  ds_read_u16 v56, v23 offset:512
  ds_read_u16 v57, v23 offset:640
  ds_read_u16 v58, v23 offset:768
  ds_read_u16 v59, v23 offset:896
  ds_read_u16 v60, v23 offset:1056
  ds_read_u16 v61, v23 offset:1184
  ds_read_u16 v62, v23 offset:1312
  ds_read_u16 v63, v23 offset:1440
  ds_read_u16 v64, v23 offset:1568
  ds_read_u16 v65, v23 offset:1696
  ds_read_u16 v66, v23 offset:1824
  ds_read_u16 v67, v23 offset:1952
  ds_read_u16 v68, v23 offset:2112
  ds_read_u16 v69, v23 offset:2240
  ds_read_u16 v70, v23 offset:2368
  ds_read_u16 v71, v23 offset:2496
  ds_read_u16 v72, v23 offset:2624
  ds_read_u16 v73, v23 offset:2752
  ds_read_u16 v74, v23 offset:2880
  ds_read_u16 v75, v23 offset:3008
  ds_read_u16 v76, v23 offset:3168
  ds_read_u16 v77, v23 offset:3296
  ds_read_u16 v78, v23 offset:3424
  ds_read_u16 v79, v23 offset:3552
  ds_read_u16 v80, v23 offset:3680
  ds_read_u16 v81, v23 offset:3808
  ds_read_u16 v82, v23 offset:3936
  s_waitcnt lgkmcnt(14)
  v_lshlrev_b32 v52, 16, v52
  v_lshlrev_b32 v53, 16, v53
  v_lshlrev_b32 v54, 16, v54
  v_lshlrev_b32 v55, 16, v55
  v_lshlrev_b32 v56, 16, v56
  v_lshlrev_b32 v57, 16, v57
  v_lshlrev_b32 v58, 16, v58
  v_lshlrev_b32 v59, 16, v59
  v_lshlrev_b32 v60, 16, v60
  v_lshlrev_b32 v61, 16, v61
  v_lshlrev_b32 v62, 16, v62
  v_lshlrev_b32 v63, 16, v63
  v_lshlrev_b32 v64, 16, v64
  v_lshlrev_b32 v65, 16, v65
  v_lshlrev_b32 v66, 16, v66
  v_lshlrev_b32 v67, 16, v67
  v_lshlrev_b32 v68, 16, v68
  s_waitcnt lgkmcnt(13)
  v_lshlrev_b32 v69, 16, v69
  s_waitcnt lgkmcnt(12)
  v_lshlrev_b32 v70, 16, v70
  s_waitcnt lgkmcnt(11)
  v_lshlrev_b32 v71, 16, v71
  s_waitcnt lgkmcnt(10)
  v_lshlrev_b32 v72, 16, v72
  s_waitcnt lgkmcnt(9)
  v_lshlrev_b32 v73, 16, v73
  s_waitcnt lgkmcnt(8)
  v_lshlrev_b32 v74, 16, v74
  s_waitcnt lgkmcnt(7)
  v_lshlrev_b32 v75, 16, v75
  s_waitcnt lgkmcnt(6)
  v_lshlrev_b32 v76, 16, v76
  s_waitcnt lgkmcnt(5)
  v_lshlrev_b32 v77, 16, v77
  s_waitcnt lgkmcnt(4)
  v_lshlrev_b32 v78, 16, v78
  s_waitcnt lgkmcnt(3)
  v_lshlrev_b32 v79, 16, v79
  s_waitcnt lgkmcnt(2)
  v_lshlrev_b32 v80, 16, v80
  s_waitcnt lgkmcnt(1)
  v_lshlrev_b32 v81, 16, v81
  s_waitcnt lgkmcnt(0)
  v_lshlrev_b32 v82, 16, v82
  v_max3_f32 v14, abs(v52), abs(v53), abs(v54)
  v_max3_f32 v14, v14, abs(v55), abs(v56)
  v_max3_f32 v14, v14, abs(v57), abs(v58)
  v_max3_f32 v14, v14, abs(v59), abs(v60)
  v_max3_f32 v14, v14, abs(v61), abs(v62)
  v_max3_f32 v14, v14, abs(v63), abs(v64)
  v_max3_f32 v14, v14, abs(v65), abs(v66)
  v_max3_f32 v14, v14, abs(v67), abs(v68)
  v_max3_f32 v14, v14, abs(v69), abs(v70)
  v_max3_f32 v14, v14, abs(v71), abs(v72)
  v_max3_f32 v14, v14, abs(v73), abs(v74)
  v_max3_f32 v14, v14, abs(v75), abs(v76)
  v_max3_f32 v14, v14, abs(v77), abs(v78)
  v_max3_f32 v14, v14, abs(v79), abs(v80)
  v_max3_f32 v14, v14, abs(v81), abs(v82)
  s_nop 1
  v_max_u32_dpp v14, v14, v14 row_shr:1 row_mask:0xf bank_mask:0xf
  s_nop 1
  v_max_u32_dpp v14, v14, v14 row_shr:2 row_mask:0xf bank_mask:0xf
  s_nop 1
  v_max_u32_dpp v14, v14, v14 row_shr:4 row_mask:0xf bank_mask:0xf
  s_nop 1
  v_max_u32_dpp v14, v14, v14 row_shr:8 row_mask:0xf bank_mask:0xf
  s_nop 1
  v_max_u32_dpp v14, v14, v14 row_bcast:15 row_mask:0xa bank_mask:0xf
  s_nop 1
  v_max_u32_dpp v14, v14, v14 row_bcast:31 row_mask:0xc bank_mask:0xf
  s_nop 0
  v_readlane_b32 s81, v14, 63
  s_nop 0
  s_lshr_b32 s81, s81, 23
  s_sub_i32 s81, 134, s81
  s_cmp_le_u32 s81, 9
  s_cselect_b32 s97, 2, 3
  s_min_i32 s81, s81, 16
  s_lshl_b32 s49, s81, 2
  s_sub_i32 s49, s48, s49
  s_add_i32 s81, s81, 127
  s_lshl_b32 s81, s81, 23
  v_mov_b32 v83, s81
  v_mul_f32 v52, s81, v52
  v_mul_f32 v53, s81, v53
  v_mul_f32 v54, s81, v54
  v_mul_f32 v55, s81, v55
  v_mul_f32 v56, s81, v56
  v_mul_f32 v57, s81, v57
  v_mul_f32 v58, s81, v58
  v_mul_f32 v59, s81, v59
  v_mul_f32 v60, s81, v60
  v_mul_f32 v61, s81, v61
  v_mul_f32 v62, s81, v62
  v_mul_f32 v63, s81, v63
  v_mul_f32 v64, s81, v64
  v_mul_f32 v65, s81, v65
  v_mul_f32 v66, s81, v66
  v_mul_f32 v67, s81, v67
  v_mul_f32 v68, s81, v68
  v_mul_f32 v69, s81, v69
  v_mul_f32 v70, s81, v70
  v_mul_f32 v71, s81, v71
  v_mul_f32 v72, s81, v72
  v_mul_f32 v73, s81, v73
  v_mul_f32 v74, s81, v74
  v_mul_f32 v75, s81, v75
  v_mul_f32 v76, s81, v76
  v_mul_f32 v77, s81, v77
  v_mul_f32 v78, s81, v78
  v_mul_f32 v79, s81, v79
  v_mul_f32 v80, s81, v80
  v_mul_f32 v81, s81, v81
  v_mul_f32 v82, s81, v82
  ds_write_b16_d16_hi v23, v52 offset:0
  ds_write_b16_d16_hi v23, v53 offset:128
  ds_write_b16_d16_hi v23, v54 offset:256
  ds_write_b16_d16_hi v23, v55 offset:384
  ds_write_b16_d16_hi v23, v56 offset:512
  ds_write_b16_d16_hi v23, v57 offset:640
  ds_write_b16_d16_hi v23, v58 offset:768
  ds_write_b16_d16_hi v23, v59 offset:896
  ds_write_b16_d16_hi v23, v60 offset:1056
  ds_write_b16_d16_hi v23, v61 offset:1184
  ds_write_b16_d16_hi v23, v62 offset:1312
  ds_write_b16_d16_hi v23, v63 offset:1440
  ds_write_b16_d16_hi v23, v64 offset:1568
  ds_write_b16_d16_hi v23, v65 offset:1696
  ds_write_b16_d16_hi v23, v66 offset:1824
  ds_write_b16_d16_hi v23, v67 offset:1952
  ds_write_b16_d16_hi v23, v68 offset:2112
  ds_write_b16_d16_hi v23, v69 offset:2240
  ds_write_b16_d16_hi v23, v70 offset:2368
  ds_write_b16_d16_hi v23, v71 offset:2496
  ds_write_b16_d16_hi v23, v72 offset:2624
  ds_write_b16_d16_hi v23, v73 offset:2752
  ds_write_b16_d16_hi v23, v74 offset:2880
  ds_write_b16_d16_hi v23, v75 offset:3008
  ds_write_b16_d16_hi v23, v76 offset:3168
  ds_write_b16_d16_hi v23, v77 offset:3296
  ds_write_b16_d16_hi v23, v78 offset:3424
  ds_write_b16_d16_hi v23, v79 offset:3552
  ds_write_b16_d16_hi v23, v80 offset:3680
  ds_write_b16_d16_hi v23, v81 offset:3808
  ds_write_b16_d16_hi v23, v82 offset:3936
  v_mul_f32 v52, s81, v52
  v_mul_f32 v53, s81, v53
  v_mul_f32 v54, s81, v54
  v_mul_f32 v55, s81, v55
  v_mul_f32 v56, s81, v56
  v_mul_f32 v57, s81, v57
  v_mul_f32 v58, s81, v58
  v_mul_f32 v59, s81, v59
  v_mul_f32 v60, s81, v60
  v_mul_f32 v61, s81, v61
  v_mul_f32 v62, s81, v62
  v_mul_f32 v63, s81, v63
  v_mul_f32 v64, s81, v64
  v_mul_f32 v65, s81, v65
  v_mul_f32 v66, s81, v66
  v_mul_f32 v67, s81, v67
  v_mul_f32 v68, s81, v68
  v_mul_f32 v69, s81, v69
  v_mul_f32 v70, s81, v70
  v_mul_f32 v71, s81, v71
  v_mul_f32 v72, s81, v72
  v_mul_f32 v73, s81, v73
  v_mul_f32 v74, s81, v74
  v_mul_f32 v75, s81, v75
  v_mul_f32 v76, s81, v76
  v_mul_f32 v77, s81, v77
  v_mul_f32 v78, s81, v78
  v_mul_f32 v79, s81, v79
  v_mul_f32 v80, s81, v80
  v_mul_f32 v81, s81, v81
  v_mul_f32 v82, s81, v82
  v_mul_f32 v83, s81, v83
  ds_write_b16_d16_hi v22, v52 offset:0
  ds_write_b16_d16_hi v22, v53 offset:128
  ds_write_b16_d16_hi v22, v54 offset:256
  ds_write_b16_d16_hi v22, v55 offset:384
  ds_write_b16_d16_hi v22, v56 offset:512
  ds_write_b16_d16_hi v22, v57 offset:640
  ds_write_b16_d16_hi v22, v58 offset:768
  ds_write_b16_d16_hi v22, v59 offset:896
  ds_write_b16_d16_hi v22, v60 offset:1056
  ds_write_b16_d16_hi v22, v61 offset:1184
  ds_write_b16_d16_hi v22, v62 offset:1312
  ds_write_b16_d16_hi v22, v63 offset:1440
  ds_write_b16_d16_hi v22, v64 offset:1568
  ds_write_b16_d16_hi v22, v65 offset:1696
  ds_write_b16_d16_hi v22, v66 offset:1824
  ds_write_b16_d16_hi v22, v67 offset:1952
  ds_write_b16_d16_hi v22, v68 offset:2112
  ds_write_b16_d16_hi v22, v69 offset:2240
  ds_write_b16_d16_hi v22, v70 offset:2368
  ds_write_b16_d16_hi v22, v71 offset:2496
  ds_write_b16_d16_hi v22, v72 offset:2624
  ds_write_b16_d16_hi v22, v73 offset:2752
  ds_write_b16_d16_hi v22, v74 offset:2880
  ds_write_b16_d16_hi v22, v75 offset:3008
  ds_write_b16_d16_hi v22, v76 offset:3168
  ds_write_b16_d16_hi v22, v77 offset:3296
  ds_write_b16_d16_hi v22, v78 offset:3424
  ds_write_b16_d16_hi v22, v79 offset:3552
  ds_write_b16_d16_hi v22, v80 offset:3680
  ds_write_b16_d16_hi v22, v81 offset:3808
  ds_write_b16_d16_hi v22, v82 offset:3936
  ds_write_b16_d16_hi v22, v83 offset:4064
  s_mov_b32 s50, 0
  s_waitcnt lgkmcnt(0)
  s_branch L_prime
L_cin_done:
  s_endpgm
L_rem:
  s_lshr_b32 s84, s3, 2
  s_and_b32 s68, s2, 7
  s_lshl_b32 s68, s68, 3
  s_add_u32 s68, s68, s3
  s_mul_i32 s68, s68, 6656
  s_lshl_b32 s76, s3, 14
  v_lshlrev_b32 v248, 4, v0
  v_lshrrev_b32 v246, 4, v0
  v_lshrrev_b32 v247, 3, v0
  v_mul_u32_u24 v13, 3328, v247
  v_and_b32 v247, 2, v247
  s_and_b32 s69, s3, 1
  s_lshl_b32 s69, s69, 2
  v_or_b32 v247, s69, v247
  v_and_b32 v9, 7, v0
  v_xor_b32 v247, v247, v9
  v_lshl_add_u32 v13, v247, 4, v13
  s_mul_i32 s74, s3, 26624
  s_add_u32 s74, s74, 3200
  s_lshl_b32 s75, s3, 10
  s_add_u32 s75, s75, 131072
  s_waitcnt lgkmcnt(0)
  s_load_dword s80, s[18:19], 0
  s_mov_b32 s28, s4
  s_and_b32 s29, s5, 0xffff
  s_mov_b32 s30, 425984
  s_mov_b32 s31, 0x20000
  s_add_u32 m0, s76, 8192
  s_nop 0
  buffer_load_dwordx4 v248, s[28:31], s68 offen lds
  s_add_u32 s68, s68, 1024
  s_add_u32 m0, s76, 9216
  s_nop 0
  buffer_load_dwordx4 v248, s[28:31], s68 offen lds
  s_add_u32 s68, s68, 1024
  s_add_u32 m0, s76, 10240
  s_nop 0
  buffer_load_dwordx4 v248, s[28:31], s68 offen lds
  s_add_u32 s68, s68, 1024
  s_add_u32 m0, s76, 11264
  s_nop 0
  buffer_load_dwordx4 v248, s[28:31], s68 offen lds
  s_add_u32 s68, s68, 1024
  s_add_u32 m0, s76, 12288
  s_nop 0
  buffer_load_dwordx4 v248, s[28:31], s68 offen lds
  s_add_u32 s68, s68, 1024
  s_add_u32 m0, s76, 13312
  s_nop 0
  buffer_load_dwordx4 v248, s[28:31], s68 offen lds
  s_add_u32 s68, s68, 1024
  s_add_u32 m0, s76, 14336
  s_nop 0
  buffer_load_dwordx4 v248, s[28:31], s68 offen lds
  s_add_u32 s68, s68, 1024
  s_mov_b32 s44, s12
  s_and_b32 s45, s13, 0xffff
  s_mov_b32 s46, 5537792
  s_mov_b32 s47, 0x20000
  s_add_u32 m0, s75, 0
  s_nop 0
  buffer_load_dwordx4 v13, s[44:47], s74 offen lds
  s_add_u32 s74, s74, 212992
  s_mov_b32 s60, s24
  s_and_b32 s61, s25, 0xffff
  s_mov_b32 s62, 268435456
  s_mov_b32 s63, 0x20000
  s_mov_b32 s64, s22
  s_and_b32 s65, s23, 0xffff
  s_mov_b32 s66, 256
  s_mov_b32 s67, 0x20000
  v_mov_b32 v64, -1
  v_mov_b32 v65, -1
  v_mov_b32 v66, -1
  v_mov_b32 v67, -1
  s_and_b32 s70, s2, 7
  s_lshl_b32 s68, s70, 3
  s_add_u32 s68, s68, s3
  s_lshl_b32 s68, s68, 11
  s_lshl_b32 s70, s70, 2
  buffer_store_dwordx4 v[64:67], v248, s[60:63], s68 offen sc1
  buffer_store_dwordx4 v[64:67], v248, s[60:63], s68 offen offset:1024 sc1
  s_mov_b32 s48, s14
  s_and_b32 s49, s15, 0xffff
  s_mov_b32 s50, 3328
  s_mov_b32 s51, 0x20000
  s_mov_b32 s52, s16
  s_and_b32 s53, s17, 0xffff
  s_mov_b32 s54, 3328
  s_mov_b32 s55, 0x20000
  s_mov_b32 s32, s6
  s_and_b32 s33, s7, 0xffff
  s_mov_b32 s34, 12800000
  s_mov_b32 s35, 0x20000
  v_xor_b32 v248, v9, v246
  v_lshlrev_b32 v14, 4, v248
  v_xor_b32 v15, 64, v14
  v_bfe_u32 v247, v0, 2, 2
  v_lshl_add_u32 v248, v246, 3, v247
  v_lshlrev_b32 v248, 7, v248
  v_and_b32 v247, 3, v0
  v_lshl_add_u32 v248, v247, 3, v248
  v_add_u32 v248, 131072, v248
  v_bfe_u32 v247, v0, 3, 2
  v_lshl_add_u32 v1, v247, 5, v248
  v_xor_b32 v2, 32, v1
  v_xor_b32 v7, 64, v1
  v_xor_b32 v8, 96, v1
  v_and_b32 v248, 15, v0
  v_lshlrev_b32 v248, 7, v248
  v_bfe_u32 v247, v0, 1, 3
  v_xor_b32 v247, v247, v246
  v_lshl_add_u32 v248, v247, 4, v248
  v_add_u32 v11, s76, v248
  v_xor_b32 v12, 64, v11
  v_lshrrev_b32 v247, 3, v0
  v_lshl_add_u32 v248, v9, 3, v247
  v_mul_u32_u24 v248, 104, v248
  v_add_u32 v248, s76, v248
  s_mov_b32 s56, s20
  s_and_b32 s57, s21, 0xffff
  s_mov_b32 s58, 8192
  s_mov_b32 s59, 0x20000
  s_and_b32 s77, s2, 7
  s_lshl_b32 s68, s77, 14
  s_lshl_b32 s69, s3, 8
  s_add_u32 s68, s68, s69
  s_add_u32 s69, s68, 4096
  s_add_u32 s71, s68, 8192
  s_lshl_b32 s77, s77, 3
  s_add_u32 s77, s77, s3
  s_lshl_b32 s77, s77, 7
  v_lshlrev_b32 v3, 2, v0
  v_lshlrev_b32 v4, 1, v0
  s_lshl_b32 s81, s3, 6
  v_add_u32 v5, s81, v0
  v_cmp_lt_u32 vcc, 507, v5
  v_add_u32 v5, 4096, v3
  v_mov_b32 v6, 0x7f000000
  v_cndmask_b32 v5, v6, v5, vcc
  v_mov_b32 v240, 0xc0135761
  v_mov_b32 v241, 0xc0135761
  v_mov_b32 v242, 0xbdd2d3e8
  v_mov_b32 v243, 0xbdd2d3e8
  v_mov_b32 v244, 0x71800000
  v_mov_b32 v160, 0
  v_mov_b32 v161, 0
  v_mov_b32 v162, 0
  v_mov_b32 v163, 0
  v_mov_b32 v164, 0
  v_mov_b32 v165, 0
  v_mov_b32 v166, 0
  v_mov_b32 v167, 0
  v_mov_b32 v168, 0
  v_mov_b32 v169, 0
  v_mov_b32 v170, 0
  v_mov_b32 v171, 0
  v_mov_b32 v172, 0
  v_mov_b32 v173, 0
  v_mov_b32 v174, 0
  v_mov_b32 v175, 0
  v_mov_b32 v176, 0
  v_mov_b32 v177, 0
  v_mov_b32 v178, 0
  v_mov_b32 v179, 0
  v_mov_b32 v180, 0
  v_mov_b32 v181, 0
  v_mov_b32 v182, 0
  v_mov_b32 v183, 0
  v_mov_b32 v184, 0
  v_mov_b32 v185, 0
  v_mov_b32 v186, 0
  v_mov_b32 v187, 0
  v_mov_b32 v188, 0
  v_mov_b32 v189, 0
  v_mov_b32 v190, 0
  v_mov_b32 v191, 0
  v_mov_b32 v192, 0
  v_mov_b32 v193, 0
  v_mov_b32 v194, 0
  v_mov_b32 v195, 0
  v_mov_b32 v196, 0
  v_mov_b32 v197, 0
  v_mov_b32 v198, 0
  v_mov_b32 v199, 0
  v_mov_b32 v200, 0
  v_mov_b32 v201, 0
  v_mov_b32 v202, 0
  v_mov_b32 v203, 0
  v_mov_b32 v204, 0
  v_mov_b32 v205, 0
  v_mov_b32 v206, 0
  v_mov_b32 v207, 0
  v_mov_b32 v208, 0
  v_mov_b32 v209, 0
  v_mov_b32 v210, 0
  v_mov_b32 v211, 0
  v_mov_b32 v212, 0
  v_mov_b32 v213, 0
  v_mov_b32 v214, 0
  v_mov_b32 v215, 0
  v_mov_b32 v216, 0
  v_mov_b32 v217, 0
  v_mov_b32 v218, 0
  v_mov_b32 v219, 0
  v_mov_b32 v220, 0
  v_mov_b32 v221, 0
  v_mov_b32 v222, 0
  v_mov_b32 v223, 0
  s_waitcnt vmcnt(0) lgkmcnt(0)
  s_lshl_b32 s80, s80, 16
  ds_read_b64 v[32:33], v248 offset:8192
  ds_read_b64 v[34:35], v248 offset:8200
  ds_read_b64 v[36:37], v248 offset:8208
  ds_read_b64 v[38:39], v248 offset:8216
  ds_read_b64 v[40:41], v248 offset:8224
  ds_read_b64 v[42:43], v248 offset:8232
  ds_read_b64 v[44:45], v248 offset:8240
  ds_read_b64 v[46:47], v248 offset:8248
  ds_read_b64 v[48:49], v248 offset:8256
  ds_read_b64 v[50:51], v248 offset:8264
  ds_read_b64 v[52:53], v248 offset:8272
  ds_read_b64 v[54:55], v248 offset:8280
  ds_read_b64 v[56:57], v248 offset:8288
  v_mov_b32 v24, 0
  v_mov_b32 v25, 0
  v_mov_b32 v26, 0
  v_mov_b32 v27, 0
  v_mov_b32 v28, 0
  v_mov_b32 v29, 0
  v_mov_b32 v30, 0
  v_mov_b32 v31, 0
  v_mov_b32 v58, 0x7f000000
  v_mov_b32 v59, 0x7f000000
  s_waitcnt lgkmcnt(12)
  v_lshlrev_b32 v32, 7, v32
  s_nop 1
  v_add_u32_dpp v24, v32, v14 row_newbcast:0 row_mask:0xf bank_mask:0x3
  v_add_u32_dpp v25, v32, v15 row_newbcast:1 row_mask:0xf bank_mask:0x3
  v_add_u32_dpp v26, v32, v14 row_newbcast:2 row_mask:0xf bank_mask:0x3
  v_add_u32_dpp v27, v32, v15 row_newbcast:3 row_mask:0xf bank_mask:0x3
  v_add_u32_dpp v24, v32, v14 row_newbcast:8 row_mask:0xf bank_mask:0xc
  v_add_u32_dpp v25, v32, v15 row_newbcast:9 row_mask:0xf bank_mask:0xc
  v_add_u32_dpp v26, v32, v14 row_newbcast:10 row_mask:0xf bank_mask:0xc
  v_add_u32_dpp v27, v32, v15 row_newbcast:11 row_mask:0xf bank_mask:0xc
  s_add_u32 m0, s76, 0
  s_nop 0
  buffer_load_dwordx4 v24, s[32:35], 0 offen lds
  s_add_u32 m0, s76, 1024
  s_nop 0
  buffer_load_dwordx4 v25, s[32:35], 0 offen lds
  s_add_u32 m0, s76, 2048
  s_nop 0
  buffer_load_dwordx4 v26, s[32:35], 0 offen lds
  s_add_u32 m0, s76, 3072
  s_nop 0
  buffer_load_dwordx4 v27, s[32:35], 0 offen lds
  v_add_u32_dpp v28, v32, v14 row_newbcast:4 row_mask:0xf bank_mask:0x3
  v_add_u32_dpp v29, v32, v15 row_newbcast:5 row_mask:0xf bank_mask:0x3
  v_add_u32_dpp v30, v32, v14 row_newbcast:6 row_mask:0xf bank_mask:0x3
  v_add_u32_dpp v31, v32, v15 row_newbcast:7 row_mask:0xf bank_mask:0x3
  v_add_u32_dpp v28, v32, v14 row_newbcast:12 row_mask:0xf bank_mask:0xc
  v_add_u32_dpp v29, v32, v15 row_newbcast:13 row_mask:0xf bank_mask:0xc
  v_add_u32_dpp v30, v32, v14 row_newbcast:14 row_mask:0xf bank_mask:0xc
  v_add_u32_dpp v31, v32, v15 row_newbcast:15 row_mask:0xf bank_mask:0xc
  s_add_u32 m0, s76, 4096
  s_nop 0
  buffer_load_dwordx4 v28, s[32:35], 0 offen lds
  s_add_u32 m0, s76, 5120
  s_nop 0
  buffer_load_dwordx4 v29, s[32:35], 0 offen lds
  s_add_u32 m0, s76, 6144
  s_nop 0
  buffer_load_dwordx4 v30, s[32:35], 0 offen lds
  s_add_u32 m0, s76, 7168
  s_nop 0
  buffer_load_dwordx4 v31, s[32:35], 0 offen lds
  s_add_u32 m0, s75, 8192
  s_nop 0
  buffer_load_dwordx4 v13, s[44:47], s74 offen lds
  s_add_u32 s74, s74, 212992
  s_waitcnt lgkmcnt(0)
  v_lshlrev_b32 v57, 7, v57
  v_lshlrev_b32 v56, 7, v56
  v_lshlrev_b32 v55, 7, v55
  v_lshlrev_b32 v54, 7, v54
  v_lshlrev_b32 v53, 7, v53
  v_lshlrev_b32 v52, 7, v52
  v_lshlrev_b32 v51, 7, v51
  v_lshlrev_b32 v50, 7, v50
  v_lshlrev_b32 v49, 7, v49
  v_lshlrev_b32 v48, 7, v48
  v_lshlrev_b32 v47, 7, v47
  v_lshlrev_b32 v46, 7, v46
  v_lshlrev_b32 v45, 7, v45
  v_lshlrev_b32 v44, 7, v44
  v_lshlrev_b32 v43, 7, v43
  v_lshlrev_b32 v42, 7, v42
  v_lshlrev_b32 v41, 7, v41
  v_lshlrev_b32 v40, 7, v40
  v_lshlrev_b32 v39, 7, v39
  v_lshlrev_b32 v38, 7, v38
  v_lshlrev_b32 v37, 7, v37
  v_lshlrev_b32 v36, 7, v36
  v_lshlrev_b32 v35, 7, v35
  v_lshlrev_b32 v34, 7, v34
  v_lshlrev_b32 v33, 7, v33
  s_nop 1
  v_add_u32_dpp v24, v33, v14 row_newbcast:0 row_mask:0xf bank_mask:0x3
  v_add_u32_dpp v25, v33, v15 row_newbcast:1 row_mask:0xf bank_mask:0x3
  v_add_u32_dpp v26, v33, v14 row_newbcast:2 row_mask:0xf bank_mask:0x3
  v_add_u32_dpp v27, v33, v15 row_newbcast:3 row_mask:0xf bank_mask:0x3
  v_add_u32_dpp v24, v33, v14 row_newbcast:8 row_mask:0xf bank_mask:0xc
  v_add_u32_dpp v25, v33, v15 row_newbcast:9 row_mask:0xf bank_mask:0xc
  v_add_u32_dpp v26, v33, v14 row_newbcast:10 row_mask:0xf bank_mask:0xc
  v_add_u32_dpp v27, v33, v15 row_newbcast:11 row_mask:0xf bank_mask:0xc
  s_add_u32 m0, s76, 8192
  s_nop 0
  buffer_load_dwordx4 v24, s[32:35], 0 offen lds
  s_add_u32 m0, s76, 9216
  s_nop 0
  buffer_load_dwordx4 v25, s[32:35], 0 offen lds
  s_add_u32 m0, s76, 10240
  s_nop 0
  buffer_load_dwordx4 v26, s[32:35], 0 offen lds
  s_add_u32 m0, s76, 11264
  s_nop 0
  buffer_load_dwordx4 v27, s[32:35], 0 offen lds
  v_add_u32_dpp v28, v33, v14 row_newbcast:4 row_mask:0xf bank_mask:0x3
  v_add_u32_dpp v29, v33, v15 row_newbcast:5 row_mask:0xf bank_mask:0x3
  v_add_u32_dpp v30, v33, v14 row_newbcast:6 row_mask:0xf bank_mask:0x3
  v_add_u32_dpp v31, v33, v15 row_newbcast:7 row_mask:0xf bank_mask:0x3
  v_add_u32_dpp v28, v33, v14 row_newbcast:12 row_mask:0xf bank_mask:0xc
  v_add_u32_dpp v29, v33, v15 row_newbcast:13 row_mask:0xf bank_mask:0xc
  v_add_u32_dpp v30, v33, v14 row_newbcast:14 row_mask:0xf bank_mask:0xc
  v_add_u32_dpp v31, v33, v15 row_newbcast:15 row_mask:0xf bank_mask:0xc
  s_add_u32 m0, s76, 12288
  s_nop 0
  buffer_load_dwordx4 v28, s[32:35], 0 offen lds
  s_add_u32 m0, s76, 13312
  s_nop 0
  buffer_load_dwordx4 v29, s[32:35], 0 offen lds
  s_add_u32 m0, s76, 14336
  s_nop 0
  buffer_load_dwordx4 v30, s[32:35], 0 offen lds
  s_add_u32 m0, s76, 15360
  s_nop 0
  buffer_load_dwordx4 v31, s[32:35], 0 offen lds
  s_add_u32 m0, s75, 16384
  s_nop 0
  buffer_load_dwordx4 v13, s[44:47], s74 offen lds
  s_add_u32 s74, s74, 212992
  v_lshlrev_b32 v248, 3, v246
  s_mov_b32 s73, 3
  v_mov_b32 v9, v34
  s_nop 1
  v_add_u32_dpp v24, v9, v14 row_newbcast:0 row_mask:0xf bank_mask:0x3
  v_add_u32_dpp v25, v9, v15 row_newbcast:1 row_mask:0xf bank_mask:0x3
  v_add_u32_dpp v26, v9, v14 row_newbcast:2 row_mask:0xf bank_mask:0x3
  v_add_u32_dpp v27, v9, v15 row_newbcast:3 row_mask:0xf bank_mask:0x3
  v_add_u32_dpp v24, v9, v14 row_newbcast:8 row_mask:0xf bank_mask:0xc
  v_add_u32_dpp v25, v9, v15 row_newbcast:9 row_mask:0xf bank_mask:0xc
  v_add_u32_dpp v26, v9, v14 row_newbcast:10 row_mask:0xf bank_mask:0xc
  v_add_u32_dpp v27, v9, v15 row_newbcast:11 row_mask:0xf bank_mask:0xc
  s_waitcnt vmcnt(14)
  s_barrier
  ds_read_b128 v[76:79], v12 offset:2048
  ds_read_b128 v[72:75], v11 offset:2048
  ds_read_b128 v[68:71], v12 offset:0
  ds_read_b128 v[64:67], v11 offset:0
  ds_read_b64_tr_b16 v[96:97], v1 offset:0
  ds_read_b64_tr_b16 v[98:99], v1 offset:512
  ds_read_b64_tr_b16 v[100:101], v1 offset:4096
  ds_read_b64_tr_b16 v[102:103], v1 offset:4608
  ds_read_b64_tr_b16 v[104:105], v2 offset:0
  ds_read_b64_tr_b16 v[106:107], v2 offset:512
  ds_read_b64_tr_b16 v[108:109], v2 offset:4096
  ds_read_b64_tr_b16 v[110:111], v2 offset:4608
  ds_read_b64_tr_b16 v[112:113], v7 offset:0
  ds_read_b64_tr_b16 v[114:115], v7 offset:512
  ds_read_b64_tr_b16 v[116:117], v7 offset:4096
  ds_read_b64_tr_b16 v[118:119], v7 offset:4608
  ds_read_b64_tr_b16 v[120:121], v8 offset:0
  ds_read_b64_tr_b16 v[122:123], v8 offset:512
  ds_read_b64_tr_b16 v[124:125], v8 offset:4096
  ds_read_b64_tr_b16 v[126:127], v8 offset:4608
  s_cmp_lg_u32 s3, 7
  s_cbranch_scc1 L_rem_loop
  s_mov_b64 exec, 1
  buffer_store_dword v240, v14, s[64:67], s70 offen offset:128 sc1
  s_mov_b64 exec, -1
L_rem_loop:
  s_waitcnt vmcnt(9)
  s_barrier
  s_waitcnt lgkmcnt(8)
  v_mfma_f32_16x16x32_bf16 v[160:163], v[96:99], v[64:67], v[160:163]
  ds_read_b128 v[92:95], v12 offset:6144
  ds_read_b128 v[88:91], v11 offset:6144
  s_waitcnt lgkmcnt(14)
  v_mfma_f32_16x16x32_bf16 v[160:163], v[100:103], v[68:71], v[160:163]
  ds_read_b128 v[84:87], v12 offset:4096
  s_add_u32 m0, s76, 0
  s_nop 0
  buffer_load_dwordx4 v24, s[32:35], 0 offen lds
  v_mfma_f32_16x16x32_bf16 v[164:167], v[96:99], v[72:75], v[164:167]
  ds_read_b128 v[80:83], v11 offset:4096
  v_mfma_f32_16x16x32_bf16 v[164:167], v[100:103], v[76:79], v[164:167]
  ds_read_b64_tr_b16 v[128:129], v1 offset:8192
  s_waitcnt lgkmcnt(14)
  v_mfma_f32_16x16x32_bf16 v[176:179], v[104:107], v[64:67], v[176:179]
  ds_read_b64_tr_b16 v[130:131], v1 offset:8704
  s_add_u32 m0, s76, 1024
  s_nop 0
  buffer_load_dwordx4 v25, s[32:35], 0 offen lds
  s_waitcnt lgkmcnt(14)
  v_mfma_f32_16x16x32_bf16 v[176:179], v[108:111], v[68:71], v[176:179]
  ds_read_b64_tr_b16 v[132:133], v1 offset:12288
  v_mfma_f32_16x16x32_bf16 v[180:183], v[104:107], v[72:75], v[180:183]
  ds_read_b64_tr_b16 v[134:135], v1 offset:12800
  v_mfma_f32_16x16x32_bf16 v[180:183], v[108:111], v[76:79], v[180:183]
  ds_read_b64_tr_b16 v[136:137], v2 offset:8192
  s_waitcnt lgkmcnt(14)
  v_mfma_f32_16x16x32_bf16 v[192:195], v[112:115], v[64:67], v[192:195]
  ds_read_b64_tr_b16 v[138:139], v2 offset:8704
  s_add_u32 m0, s76, 2048
  s_nop 0
  buffer_load_dwordx4 v26, s[32:35], 0 offen lds
  s_waitcnt lgkmcnt(14)
  v_mfma_f32_16x16x32_bf16 v[192:195], v[116:119], v[68:71], v[192:195]
  ds_read_b64_tr_b16 v[140:141], v2 offset:12288
  v_mfma_f32_16x16x32_bf16 v[196:199], v[112:115], v[72:75], v[196:199]
  ds_read_b64_tr_b16 v[142:143], v2 offset:12800
  v_mfma_f32_16x16x32_bf16 v[196:199], v[116:119], v[76:79], v[196:199]
  v_add_u32_dpp v28, v9, v14 row_newbcast:4 row_mask:0xf bank_mask:0x3
  v_add_u32_dpp v29, v9, v15 row_newbcast:5 row_mask:0xf bank_mask:0x3
  s_waitcnt lgkmcnt(14)
  v_mfma_f32_16x16x32_bf16 v[208:211], v[120:123], v[64:67], v[208:211]
  s_add_u32 m0, s76, 3072
  s_nop 0
  buffer_load_dwordx4 v27, s[32:35], 0 offen lds
  v_add_u32_dpp v30, v9, v14 row_newbcast:6 row_mask:0xf bank_mask:0x3
  v_add_u32_dpp v31, v9, v15 row_newbcast:7 row_mask:0xf bank_mask:0x3
  s_waitcnt lgkmcnt(12)
  v_mfma_f32_16x16x32_bf16 v[208:211], v[124:127], v[68:71], v[208:211]
  v_add_u32_dpp v28, v9, v14 row_newbcast:12 row_mask:0xf bank_mask:0xc
  v_mfma_f32_16x16x32_bf16 v[212:215], v[120:123], v[72:75], v[212:215]
  v_add_u32_dpp v29, v9, v15 row_newbcast:13 row_mask:0xf bank_mask:0xc
  v_add_u32_dpp v30, v9, v14 row_newbcast:14 row_mask:0xf bank_mask:0xc
  v_mfma_f32_16x16x32_bf16 v[212:215], v[124:127], v[76:79], v[212:215]
  v_add_u32_dpp v31, v9, v15 row_newbcast:15 row_mask:0xf bank_mask:0xc
  s_waitcnt vmcnt(9)
  s_waitcnt lgkmcnt(8)
  v_mfma_f32_16x16x32_bf16 v[168:171], v[96:99], v[80:83], v[168:171]
  ds_read_b128 v[76:79], v12 offset:10240
  ds_read_b128 v[72:75], v11 offset:10240
  v_mfma_f32_16x16x32_bf16 v[168:171], v[100:103], v[84:87], v[168:171]
  ds_read_b128 v[68:71], v12 offset:8192
  s_add_u32 m0, s76, 4096
  s_nop 0
  buffer_load_dwordx4 v28, s[32:35], 0 offen lds
  v_mfma_f32_16x16x32_bf16 v[172:175], v[96:99], v[88:91], v[172:175]
  ds_read_b128 v[64:67], v11 offset:8192
  v_mfma_f32_16x16x32_bf16 v[172:175], v[100:103], v[92:95], v[172:175]
  ds_read_b64_tr_b16 v[144:145], v7 offset:8192
  v_mfma_f32_16x16x32_bf16 v[184:187], v[104:107], v[80:83], v[184:187]
  ds_read_b64_tr_b16 v[146:147], v7 offset:8704
  s_add_u32 m0, s76, 5120
  s_nop 0
  buffer_load_dwordx4 v29, s[32:35], 0 offen lds
  v_mfma_f32_16x16x32_bf16 v[184:187], v[108:111], v[84:87], v[184:187]
  ds_read_b64_tr_b16 v[148:149], v7 offset:12288
  v_mfma_f32_16x16x32_bf16 v[188:191], v[104:107], v[88:91], v[188:191]
  ds_read_b64_tr_b16 v[150:151], v7 offset:12800
  v_mfma_f32_16x16x32_bf16 v[188:191], v[108:111], v[92:95], v[188:191]
  ds_read_b64_tr_b16 v[152:153], v8 offset:8192
  s_add_u32 m0, s76, 6144
  s_nop 0
  buffer_load_dwordx4 v30, s[32:35], 0 offen lds
  v_mfma_f32_16x16x32_bf16 v[200:203], v[112:115], v[80:83], v[200:203]
  ds_read_b64_tr_b16 v[154:155], v8 offset:8704
  v_mfma_f32_16x16x32_bf16 v[200:203], v[116:119], v[84:87], v[200:203]
  ds_read_b64_tr_b16 v[156:157], v8 offset:12288
  v_mfma_f32_16x16x32_bf16 v[204:207], v[112:115], v[88:91], v[204:207]
  ds_read_b64_tr_b16 v[158:159], v8 offset:12800
  s_add_u32 m0, s76, 7168
  s_nop 0
  buffer_load_dwordx4 v31, s[32:35], 0 offen lds
  v_mfma_f32_16x16x32_bf16 v[204:207], v[116:119], v[92:95], v[204:207]
  s_set_gpr_idx_on s73, gpr_idx(SRC0)
  s_nop 0
  v_mov_b32 v9, v32
  s_set_gpr_idx_off
  s_add_u32 s73, s73, 1
  v_add_u32_dpp v24, v9, v14 row_newbcast:0 row_mask:0xf bank_mask:0x3
  v_mfma_f32_16x16x32_bf16 v[216:219], v[120:123], v[80:83], v[216:219]
  v_add_u32_dpp v25, v9, v15 row_newbcast:1 row_mask:0xf bank_mask:0x3
  v_add_u32_dpp v26, v9, v14 row_newbcast:2 row_mask:0xf bank_mask:0x3
  v_mfma_f32_16x16x32_bf16 v[216:219], v[124:127], v[84:87], v[216:219]
  s_xor_b32 s75, s75, 16384
  s_add_u32 m0, s75, 8192
  s_nop 0
  buffer_load_dwordx4 v13, s[44:47], s74 offen lds
  s_add_u32 s74, s74, 212992
  s_xor_b32 s75, s75, 16384
  v_add_u32_dpp v27, v9, v15 row_newbcast:3 row_mask:0xf bank_mask:0x3
  v_add_u32_dpp v24, v9, v14 row_newbcast:8 row_mask:0xf bank_mask:0xc
  v_mfma_f32_16x16x32_bf16 v[220:223], v[120:123], v[88:91], v[220:223]
  v_add_u32_dpp v25, v9, v15 row_newbcast:9 row_mask:0xf bank_mask:0xc
  v_add_u32_dpp v26, v9, v14 row_newbcast:10 row_mask:0xf bank_mask:0xc
  v_mfma_f32_16x16x32_bf16 v[220:223], v[124:127], v[92:95], v[220:223]
  v_add_u32_dpp v27, v9, v15 row_newbcast:11 row_mask:0xf bank_mask:0xc
L_rnv:
  s_waitcnt vmcnt(9)
  s_barrier
  v_xor_b32 v1, 16384, v1
  v_xor_b32 v2, 16384, v2
  v_xor_b32 v7, 16384, v7
  v_xor_b32 v8, 16384, v8
  s_waitcnt lgkmcnt(8)
  v_mfma_f32_16x16x32_bf16 v[160:163], v[128:131], v[64:67], v[160:163]
  ds_read_b128 v[92:95], v12 offset:14336
  ds_read_b128 v[88:91], v11 offset:14336
  v_mfma_f32_16x16x32_bf16 v[160:163], v[132:135], v[68:71], v[160:163]
  ds_read_b128 v[84:87], v12 offset:12288
  s_add_u32 m0, s76, 8192
  s_nop 0
  buffer_load_dwordx4 v24, s[32:35], 0 offen lds
  v_mfma_f32_16x16x32_bf16 v[164:167], v[128:131], v[72:75], v[164:167]
  ds_read_b128 v[80:83], v11 offset:12288
  v_mfma_f32_16x16x32_bf16 v[164:167], v[132:135], v[76:79], v[164:167]
  ds_read_b64_tr_b16 v[96:97], v1 offset:0
  v_mfma_f32_16x16x32_bf16 v[176:179], v[136:139], v[64:67], v[176:179]
  ds_read_b64_tr_b16 v[98:99], v1 offset:512
  s_add_u32 m0, s76, 9216
  s_nop 0
  buffer_load_dwordx4 v25, s[32:35], 0 offen lds
  v_mfma_f32_16x16x32_bf16 v[176:179], v[140:143], v[68:71], v[176:179]
  ds_read_b64_tr_b16 v[100:101], v1 offset:4096
  v_mfma_f32_16x16x32_bf16 v[180:183], v[136:139], v[72:75], v[180:183]
  ds_read_b64_tr_b16 v[102:103], v1 offset:4608
  v_mfma_f32_16x16x32_bf16 v[180:183], v[140:143], v[76:79], v[180:183]
  ds_read_b64_tr_b16 v[104:105], v2 offset:0
  s_waitcnt lgkmcnt(14)
  v_mfma_f32_16x16x32_bf16 v[192:195], v[144:147], v[64:67], v[192:195]
  ds_read_b64_tr_b16 v[106:107], v2 offset:512
  s_add_u32 m0, s76, 10240
  s_nop 0
  buffer_load_dwordx4 v26, s[32:35], 0 offen lds
  s_waitcnt lgkmcnt(14)
  v_mfma_f32_16x16x32_bf16 v[192:195], v[148:151], v[68:71], v[192:195]
  ds_read_b64_tr_b16 v[108:109], v2 offset:4096
  v_mfma_f32_16x16x32_bf16 v[196:199], v[144:147], v[72:75], v[196:199]
  ds_read_b64_tr_b16 v[110:111], v2 offset:4608
  v_mfma_f32_16x16x32_bf16 v[196:199], v[148:151], v[76:79], v[196:199]
  v_add_u32_dpp v28, v9, v14 row_newbcast:4 row_mask:0xf bank_mask:0x3
  v_add_u32_dpp v29, v9, v15 row_newbcast:5 row_mask:0xf bank_mask:0x3
  s_waitcnt lgkmcnt(14)
  v_mfma_f32_16x16x32_bf16 v[208:211], v[152:155], v[64:67], v[208:211]
  s_add_u32 m0, s76, 11264
  s_nop 0
  buffer_load_dwordx4 v27, s[32:35], 0 offen lds
  v_add_u32_dpp v30, v9, v14 row_newbcast:6 row_mask:0xf bank_mask:0x3
  v_add_u32_dpp v31, v9, v15 row_newbcast:7 row_mask:0xf bank_mask:0x3
  s_waitcnt lgkmcnt(12)
  v_mfma_f32_16x16x32_bf16 v[208:211], v[156:159], v[68:71], v[208:211]
  v_add_u32_dpp v28, v9, v14 row_newbcast:12 row_mask:0xf bank_mask:0xc
  v_mfma_f32_16x16x32_bf16 v[212:215], v[152:155], v[72:75], v[212:215]
  v_add_u32_dpp v29, v9, v15 row_newbcast:13 row_mask:0xf bank_mask:0xc
  v_add_u32_dpp v30, v9, v14 row_newbcast:14 row_mask:0xf bank_mask:0xc
  v_mfma_f32_16x16x32_bf16 v[212:215], v[156:159], v[76:79], v[212:215]
  v_add_u32_dpp v31, v9, v15 row_newbcast:15 row_mask:0xf bank_mask:0xc
  s_waitcnt vmcnt(9)
  s_waitcnt lgkmcnt(8)
  v_mfma_f32_16x16x32_bf16 v[168:171], v[128:131], v[80:83], v[168:171]
  ds_read_b128 v[76:79], v12 offset:2048
  ds_read_b128 v[72:75], v11 offset:2048
  v_mfma_f32_16x16x32_bf16 v[168:171], v[132:135], v[84:87], v[168:171]
  ds_read_b128 v[68:71], v12 offset:0
  s_add_u32 m0, s76, 12288
  s_nop 0
  buffer_load_dwordx4 v28, s[32:35], 0 offen lds
  v_mfma_f32_16x16x32_bf16 v[172:175], v[128:131], v[88:91], v[172:175]
  ds_read_b128 v[64:67], v11 offset:0
  v_mfma_f32_16x16x32_bf16 v[172:175], v[132:135], v[92:95], v[172:175]
  ds_read_b64_tr_b16 v[112:113], v7 offset:0
  v_mfma_f32_16x16x32_bf16 v[184:187], v[136:139], v[80:83], v[184:187]
  ds_read_b64_tr_b16 v[114:115], v7 offset:512
  s_add_u32 m0, s76, 13312
  s_nop 0
  buffer_load_dwordx4 v29, s[32:35], 0 offen lds
  v_mfma_f32_16x16x32_bf16 v[184:187], v[140:143], v[84:87], v[184:187]
  ds_read_b64_tr_b16 v[116:117], v7 offset:4096
  v_mfma_f32_16x16x32_bf16 v[188:191], v[136:139], v[88:91], v[188:191]
  ds_read_b64_tr_b16 v[118:119], v7 offset:4608
  v_mfma_f32_16x16x32_bf16 v[188:191], v[140:143], v[92:95], v[188:191]
  ds_read_b64_tr_b16 v[120:121], v8 offset:0
  s_add_u32 m0, s76, 14336
  s_nop 0
  buffer_load_dwordx4 v30, s[32:35], 0 offen lds
  v_mfma_f32_16x16x32_bf16 v[200:203], v[144:147], v[80:83], v[200:203]
  ds_read_b64_tr_b16 v[122:123], v8 offset:512
  v_mfma_f32_16x16x32_bf16 v[200:203], v[148:151], v[84:87], v[200:203]
  ds_read_b64_tr_b16 v[124:125], v8 offset:4096
  v_mfma_f32_16x16x32_bf16 v[204:207], v[144:147], v[88:91], v[204:207]
  ds_read_b64_tr_b16 v[126:127], v8 offset:4608
  s_add_u32 m0, s76, 15360
  s_nop 0
  buffer_load_dwordx4 v31, s[32:35], 0 offen lds
  v_mfma_f32_16x16x32_bf16 v[204:207], v[148:151], v[92:95], v[204:207]
  s_set_gpr_idx_on s73, gpr_idx(SRC0)
  s_nop 0
  v_mov_b32 v9, v32
  s_set_gpr_idx_off
  s_add_u32 s73, s73, 1
  v_add_u32_dpp v24, v9, v14 row_newbcast:0 row_mask:0xf bank_mask:0x3
  v_mfma_f32_16x16x32_bf16 v[216:219], v[152:155], v[80:83], v[216:219]
  v_add_u32_dpp v25, v9, v15 row_newbcast:1 row_mask:0xf bank_mask:0x3
  v_add_u32_dpp v26, v9, v14 row_newbcast:2 row_mask:0xf bank_mask:0x3
  v_mfma_f32_16x16x32_bf16 v[216:219], v[156:159], v[84:87], v[216:219]
  s_add_u32 m0, s75, 0
  s_nop 0
  buffer_load_dwordx4 v13, s[44:47], s74 offen lds
  s_add_u32 s74, s74, 212992
  s_xor_b32 s75, s75, 16384
  v_add_u32_dpp v27, v9, v15 row_newbcast:3 row_mask:0xf bank_mask:0x3
  v_add_u32_dpp v24, v9, v14 row_newbcast:8 row_mask:0xf bank_mask:0xc
  v_mfma_f32_16x16x32_bf16 v[220:223], v[152:155], v[88:91], v[220:223]
  v_add_u32_dpp v25, v9, v15 row_newbcast:9 row_mask:0xf bank_mask:0xc
  v_add_u32_dpp v26, v9, v14 row_newbcast:10 row_mask:0xf bank_mask:0xc
  v_mfma_f32_16x16x32_bf16 v[220:223], v[156:159], v[92:95], v[220:223]
  v_add_u32_dpp v27, v9, v15 row_newbcast:11 row_mask:0xf bank_mask:0xc
  s_cmp_lt_u32 s73, 27
  s_cbranch_scc1 L_rem_loop
  s_waitcnt vmcnt(9)
  s_barrier
  s_waitcnt lgkmcnt(8)
  v_mfma_f32_16x16x32_bf16 v[160:163], v[96:99], v[64:67], v[160:163]
  ds_read_b128 v[92:95], v12 offset:6144
  ds_read_b128 v[88:91], v11 offset:6144
  v_mfma_f32_16x16x32_bf16 v[160:163], v[100:103], v[68:71], v[160:163]
  ds_read_b128 v[84:87], v12 offset:4096
  buffer_load_dwordx2 v[224:225], v248, s[48:51], 0 offen offset:3200
  v_mfma_f32_16x16x32_bf16 v[164:167], v[96:99], v[72:75], v[164:167]
  ds_read_b128 v[80:83], v11 offset:4096
  buffer_load_dwordx2 v[226:227], v248, s[48:51], 0 offen offset:3232
  v_mfma_f32_16x16x32_bf16 v[164:167], v[100:103], v[76:79], v[164:167]
  ds_read_b64_tr_b16 v[128:129], v1 offset:8192
  v_mfma_f32_16x16x32_bf16 v[176:179], v[104:107], v[64:67], v[176:179]
  ds_read_b64_tr_b16 v[130:131], v1 offset:8704
  buffer_load_dwordx2 v[228:229], v248, s[48:51], 0 offen offset:3264
  v_mfma_f32_16x16x32_bf16 v[176:179], v[108:111], v[68:71], v[176:179]
  ds_read_b64_tr_b16 v[132:133], v1 offset:12288
  v_mfma_f32_16x16x32_bf16 v[180:183], v[104:107], v[72:75], v[180:183]
  ds_read_b64_tr_b16 v[134:135], v1 offset:12800
  buffer_load_dwordx2 v[230:231], v248, s[48:51], 0 offen offset:3296
  v_mfma_f32_16x16x32_bf16 v[180:183], v[108:111], v[76:79], v[180:183]
  ds_read_b64_tr_b16 v[136:137], v2 offset:8192
  buffer_load_dwordx2 v[232:233], v248, s[52:55], 0 offen offset:3200
  s_waitcnt lgkmcnt(14)
  v_mfma_f32_16x16x32_bf16 v[192:195], v[112:115], v[64:67], v[192:195]
  ds_read_b64_tr_b16 v[138:139], v2 offset:8704
  s_waitcnt lgkmcnt(14)
  v_mfma_f32_16x16x32_bf16 v[192:195], v[116:119], v[68:71], v[192:195]
  ds_read_b64_tr_b16 v[140:141], v2 offset:12288
  buffer_load_dwordx2 v[234:235], v248, s[52:55], 0 offen offset:3232
  v_mfma_f32_16x16x32_bf16 v[196:199], v[112:115], v[72:75], v[196:199]
  ds_read_b64_tr_b16 v[142:143], v2 offset:12800
  v_mfma_f32_16x16x32_bf16 v[196:199], v[116:119], v[76:79], v[196:199]
  buffer_load_dwordx2 v[236:237], v248, s[52:55], 0 offen offset:3264
  s_waitcnt lgkmcnt(14)
  v_mfma_f32_16x16x32_bf16 v[208:211], v[120:123], v[64:67], v[208:211]
  buffer_load_dwordx2 v[238:239], v248, s[52:55], 0 offen offset:3296
  s_waitcnt lgkmcnt(12)
  v_mfma_f32_16x16x32_bf16 v[208:211], v[124:127], v[68:71], v[208:211]
  v_mfma_f32_16x16x32_bf16 v[212:215], v[120:123], v[72:75], v[212:215]
  buffer_load_dword v255, v3, s[56:59], s77 offen
  v_mfma_f32_16x16x32_bf16 v[212:215], v[124:127], v[76:79], v[212:215]
  s_waitcnt vmcnt(14)
  s_waitcnt lgkmcnt(8)
  v_mfma_f32_16x16x32_bf16 v[168:171], v[96:99], v[80:83], v[168:171]
  ds_read_b128 v[76:79], v12 offset:10240
  ds_read_b128 v[72:75], v11 offset:10240
  v_mfma_f32_16x16x32_bf16 v[168:171], v[100:103], v[84:87], v[168:171]
  ds_read_b128 v[68:71], v12 offset:8192
  v_mfma_f32_16x16x32_bf16 v[172:175], v[96:99], v[88:91], v[172:175]
  ds_read_b128 v[64:67], v11 offset:8192
  v_mfma_f32_16x16x32_bf16 v[172:175], v[100:103], v[92:95], v[172:175]
  ds_read_b64_tr_b16 v[144:145], v7 offset:8192
  v_mfma_f32_16x16x32_bf16 v[184:187], v[104:107], v[80:83], v[184:187]
  ds_read_b64_tr_b16 v[146:147], v7 offset:8704
  v_mfma_f32_16x16x32_bf16 v[184:187], v[108:111], v[84:87], v[184:187]
  ds_read_b64_tr_b16 v[148:149], v7 offset:12288
  v_mfma_f32_16x16x32_bf16 v[188:191], v[104:107], v[88:91], v[188:191]
  ds_read_b64_tr_b16 v[150:151], v7 offset:12800
  v_mfma_f32_16x16x32_bf16 v[188:191], v[108:111], v[92:95], v[188:191]
  ds_read_b64_tr_b16 v[152:153], v8 offset:8192
  v_mfma_f32_16x16x32_bf16 v[200:203], v[112:115], v[80:83], v[200:203]
  ds_read_b64_tr_b16 v[154:155], v8 offset:8704
  v_mfma_f32_16x16x32_bf16 v[200:203], v[116:119], v[84:87], v[200:203]
  ds_read_b64_tr_b16 v[156:157], v8 offset:12288
  v_mfma_f32_16x16x32_bf16 v[204:207], v[112:115], v[88:91], v[204:207]
  ds_read_b64_tr_b16 v[158:159], v8 offset:12800
  v_mfma_f32_16x16x32_bf16 v[204:207], v[116:119], v[92:95], v[204:207]
  v_mfma_f32_16x16x32_bf16 v[216:219], v[120:123], v[80:83], v[216:219]
  v_mfma_f32_16x16x32_bf16 v[216:219], v[124:127], v[84:87], v[216:219]
  v_mfma_f32_16x16x32_bf16 v[220:223], v[120:123], v[88:91], v[220:223]
  v_mfma_f32_16x16x32_bf16 v[220:223], v[124:127], v[92:95], v[220:223]
  s_waitcnt vmcnt(10)
  s_waitcnt lgkmcnt(8)
  v_mfma_f32_16x16x32_bf16 v[160:163], v[128:131], v[64:67], v[160:163]
  ds_read_b128 v[92:95], v12 offset:14336
  v_mfma_f32_16x16x32_bf16 v[160:163], v[132:135], v[68:71], v[160:163]
  v_mfma_f32_16x16x32_bf16 v[164:167], v[128:131], v[72:75], v[164:167]
  ds_read_b128 v[88:91], v11 offset:14336
  v_mfma_f32_16x16x32_bf16 v[164:167], v[132:135], v[76:79], v[164:167]
  s_waitcnt vmcnt(4)
  v_lshlrev_b32 v48, 16, v232
  v_and_b32 v49, 0xffff0000, v232
  v_mfma_f32_16x16x32_bf16 v[176:179], v[136:139], v[64:67], v[176:179]
  v_lshlrev_b32 v50, 16, v233
  v_and_b32 v51, 0xffff0000, v233
  v_mfma_f32_16x16x32_bf16 v[176:179], v[140:143], v[68:71], v[176:179]
  ds_read_b128 v[84:87], v12 offset:12288
  s_waitcnt vmcnt(3)
  v_lshlrev_b32 v52, 16, v234
  v_and_b32 v53, 0xffff0000, v234
  v_mfma_f32_16x16x32_bf16 v[180:183], v[136:139], v[72:75], v[180:183]
  v_lshlrev_b32 v54, 16, v235
  v_and_b32 v55, 0xffff0000, v235
  v_mfma_f32_16x16x32_bf16 v[180:183], v[140:143], v[76:79], v[180:183]
  s_waitcnt vmcnt(2)
  v_lshlrev_b32 v56, 16, v236
  v_and_b32 v57, 0xffff0000, v236
  s_waitcnt lgkmcnt(9)
  v_mfma_f32_16x16x32_bf16 v[192:195], v[144:147], v[64:67], v[192:195]
  ds_read_b128 v[80:83], v11 offset:12288
  v_lshlrev_b32 v58, 16, v237
  s_waitcnt lgkmcnt(8)
  v_mfma_f32_16x16x32_bf16 v[192:195], v[148:151], v[68:71], v[192:195]
  v_and_b32 v59, 0xffff0000, v237
  s_waitcnt vmcnt(1)
  v_lshlrev_b32 v60, 16, v238
  v_mfma_f32_16x16x32_bf16 v[196:199], v[144:147], v[72:75], v[196:199]
  v_and_b32 v61, 0xffff0000, v238
  v_lshlrev_b32 v62, 16, v239
  v_mfma_f32_16x16x32_bf16 v[196:199], v[148:151], v[76:79], v[196:199]
  v_and_b32 v63, 0xffff0000, v239
  v_lshlrev_b32 v32, 16, v224
  s_waitcnt lgkmcnt(6)
  v_mfma_f32_16x16x32_bf16 v[208:211], v[152:155], v[64:67], v[208:211]
  v_and_b32 v33, 0xffff0000, v224
  v_lshlrev_b32 v34, 16, v225
  s_waitcnt lgkmcnt(4)
  v_mfma_f32_16x16x32_bf16 v[208:211], v[156:159], v[68:71], v[208:211]
  v_and_b32 v35, 0xffff0000, v225
  v_lshlrev_b32 v36, 16, v226
  v_mfma_f32_16x16x32_bf16 v[212:215], v[152:155], v[72:75], v[212:215]
  v_and_b32 v37, 0xffff0000, v226
  v_mfma_f32_16x16x32_bf16 v[212:215], v[156:159], v[76:79], v[212:215]
  s_waitcnt lgkmcnt(0)
  v_mfma_f32_16x16x32_bf16 v[168:171], v[128:131], v[80:83], v[168:171]
  v_lshlrev_b32 v38, 16, v227
  v_and_b32 v39, 0xffff0000, v227
  v_mfma_f32_16x16x32_bf16 v[168:171], v[132:135], v[84:87], v[168:171]
  v_lshlrev_b32 v40, 16, v228
  v_mfma_f32_16x16x32_bf16 v[172:175], v[128:131], v[88:91], v[172:175]
  v_and_b32 v41, 0xffff0000, v228
  v_mfma_f32_16x16x32_bf16 v[172:175], v[132:135], v[92:95], v[172:175]
  v_lshlrev_b32 v42, 16, v229
  v_mfma_f32_16x16x32_bf16 v[184:187], v[136:139], v[80:83], v[184:187]
  v_and_b32 v43, 0xffff0000, v229
  v_lshlrev_b32 v44, 16, v230
  v_mfma_f32_16x16x32_bf16 v[184:187], v[140:143], v[84:87], v[184:187]
  v_and_b32 v45, 0xffff0000, v230
  v_mfma_f32_16x16x32_bf16 v[188:191], v[136:139], v[88:91], v[188:191]
  v_lshlrev_b32 v46, 16, v231
  v_mfma_f32_16x16x32_bf16 v[188:191], v[140:143], v[92:95], v[188:191]
  v_and_b32 v47, 0xffff0000, v231
  v_mfma_f32_16x16x32_bf16 v[200:203], v[144:147], v[80:83], v[200:203]
  v_rcp_f32 v48, v48
  v_rcp_f32 v49, v49
  v_mfma_f32_16x16x32_bf16 v[200:203], v[148:151], v[84:87], v[200:203]
  v_rcp_f32 v50, v50
  v_mfma_f32_16x16x32_bf16 v[204:207], v[144:147], v[88:91], v[204:207]
  v_rcp_f32 v51, v51
  v_mfma_f32_16x16x32_bf16 v[204:207], v[148:151], v[92:95], v[204:207]
  v_rcp_f32 v52, v52
  v_mfma_f32_16x16x32_bf16 v[216:219], v[152:155], v[80:83], v[216:219]
  v_rcp_f32 v53, v53
  v_rcp_f32 v54, v54
  v_mfma_f32_16x16x32_bf16 v[216:219], v[156:159], v[84:87], v[216:219]
  v_rcp_f32 v55, v55
  v_mfma_f32_16x16x32_bf16 v[220:223], v[152:155], v[88:91], v[220:223]
  v_rcp_f32 v56, v56
  v_mfma_f32_16x16x32_bf16 v[220:223], v[156:159], v[92:95], v[220:223]
  v_rcp_f32 v57, v57
L_repi:
  v_rcp_f32 v58, v58
  v_rcp_f32 v59, v59
  v_rcp_f32 v60, v60
  v_rcp_f32 v61, v61
  v_rcp_f32 v62, v62
  v_rcp_f32 v63, v63
  v_med3_f32 v48, v48, -v244, v244
  v_med3_f32 v49, v49, -v244, v244
  v_med3_f32 v50, v50, -v244, v244
  v_med3_f32 v51, v51, -v244, v244
  v_med3_f32 v52, v52, -v244, v244
  v_med3_f32 v53, v53, -v244, v244
  v_med3_f32 v54, v54, -v244, v244
  v_med3_f32 v55, v55, -v244, v244
  v_med3_f32 v56, v56, -v244, v244
  v_med3_f32 v57, v57, -v244, v244
  v_med3_f32 v58, v58, -v244, v244
  v_med3_f32 v59, v59, -v244, v244
  v_med3_f32 v60, v60, -v244, v244
  v_med3_f32 v61, v61, -v244, v244
  v_med3_f32 v62, v62, -v244, v244
  v_med3_f32 v63, v63, -v244, v244
  v_pk_add_f32 v[160:161], v[160:161], v[32:33]
  v_pk_add_f32 v[162:163], v[162:163], v[34:35]
  v_pk_add_f32 v[164:165], v[164:165], v[32:33]
  v_pk_add_f32 v[166:167], v[166:167], v[34:35]
  v_pk_add_f32 v[168:169], v[168:169], v[32:33]
  v_pk_add_f32 v[170:171], v[170:171], v[34:35]
  v_pk_add_f32 v[172:173], v[172:173], v[32:33]
  v_pk_add_f32 v[174:175], v[174:175], v[34:35]
  v_pk_add_f32 v[176:177], v[176:177], v[36:37]
  v_pk_add_f32 v[178:179], v[178:179], v[38:39]
  v_pk_add_f32 v[180:181], v[180:181], v[36:37]
  v_pk_add_f32 v[182:183], v[182:183], v[38:39]
  v_pk_add_f32 v[184:185], v[184:185], v[36:37]
  v_pk_add_f32 v[186:187], v[186:187], v[38:39]
  v_pk_add_f32 v[188:189], v[188:189], v[36:37]
  v_pk_add_f32 v[190:191], v[190:191], v[38:39]
  v_pk_add_f32 v[192:193], v[192:193], v[40:41]
  v_pk_add_f32 v[194:195], v[194:195], v[42:43]
  v_pk_add_f32 v[196:197], v[196:197], v[40:41]
  v_pk_add_f32 v[198:199], v[198:199], v[42:43]
  v_pk_add_f32 v[200:201], v[200:201], v[40:41]
  v_pk_add_f32 v[202:203], v[202:203], v[42:43]
  v_pk_add_f32 v[204:205], v[204:205], v[40:41]
  v_pk_add_f32 v[206:207], v[206:207], v[42:43]
  v_pk_add_f32 v[208:209], v[208:209], v[44:45]
  v_pk_add_f32 v[210:211], v[210:211], v[46:47]
  v_pk_add_f32 v[212:213], v[212:213], v[44:45]
  v_pk_add_f32 v[214:215], v[214:215], v[46:47]
  v_pk_add_f32 v[216:217], v[216:217], v[44:45]
  v_pk_add_f32 v[218:219], v[218:219], v[46:47]
  v_pk_add_f32 v[220:221], v[220:221], v[44:45]
  v_pk_add_f32 v[222:223], v[222:223], v[46:47]
  v_pk_mul_f32 v[64:65], v[160:161], v[160:161]
  v_pk_mul_f32 v[68:69], v[164:165], v[164:165]
  v_pk_mul_f32 v[72:73], v[168:169], v[168:169]
  v_pk_mul_f32 v[76:77], v[172:173], v[172:173]
  v_pk_fma_f32 v[64:65], v[64:65], v[242:243], v[240:241]
  v_pk_fma_f32 v[68:69], v[68:69], v[242:243], v[240:241]
  v_pk_fma_f32 v[72:73], v[72:73], v[242:243], v[240:241]
  v_pk_fma_f32 v[76:77], v[76:77], v[242:243], v[240:241]
  v_pk_mul_f32 v[64:65], v[64:65], v[160:161]
  v_pk_mul_f32 v[68:69], v[68:69], v[164:165]
  v_pk_mul_f32 v[72:73], v[72:73], v[168:169]
  v_pk_mul_f32 v[76:77], v[76:77], v[172:173]
  v_exp_f32 v64, v64
  v_exp_f32 v65, v65
  v_exp_f32 v68, v68
  v_exp_f32 v69, v69
  v_exp_f32 v72, v72
  v_exp_f32 v73, v73
  v_exp_f32 v76, v76
  v_exp_f32 v77, v77
  v_pk_fma_f32 v[64:65], v[64:65], v[48:49], v[48:49]
  v_pk_fma_f32 v[68:69], v[68:69], v[48:49], v[48:49]
  v_pk_fma_f32 v[72:73], v[72:73], v[48:49], v[48:49]
  v_pk_fma_f32 v[76:77], v[76:77], v[48:49], v[48:49]
  v_rcp_f32 v64, v64
  v_rcp_f32 v65, v65
  v_rcp_f32 v68, v68
  v_rcp_f32 v69, v69
  v_rcp_f32 v72, v72
  v_rcp_f32 v73, v73
  v_rcp_f32 v76, v76
  v_rcp_f32 v77, v77
  v_pk_mul_f32 v[16:17], v[64:65], v[160:161]
  v_pk_mul_f32 v[18:19], v[68:69], v[164:165]
  v_pk_mul_f32 v[20:21], v[72:73], v[168:169]
  v_pk_mul_f32 v[22:23], v[76:77], v[172:173]
  v_pk_mul_f32 v[80:81], v[162:163], v[162:163]
  v_pk_mul_f32 v[84:85], v[166:167], v[166:167]
  v_pk_mul_f32 v[88:89], v[170:171], v[170:171]
  v_pk_mul_f32 v[92:93], v[174:175], v[174:175]
  v_pk_fma_f32 v[80:81], v[80:81], v[242:243], v[240:241]
  v_pk_fma_f32 v[84:85], v[84:85], v[242:243], v[240:241]
  v_pk_fma_f32 v[88:89], v[88:89], v[242:243], v[240:241]
  v_pk_fma_f32 v[92:93], v[92:93], v[242:243], v[240:241]
  v_pk_mul_f32 v[80:81], v[80:81], v[162:163]
  v_pk_mul_f32 v[84:85], v[84:85], v[166:167]
  v_pk_mul_f32 v[88:89], v[88:89], v[170:171]
  v_pk_mul_f32 v[92:93], v[92:93], v[174:175]
  v_exp_f32 v80, v80
  v_exp_f32 v81, v81
  v_exp_f32 v84, v84
  v_exp_f32 v85, v85
  v_exp_f32 v88, v88
  v_exp_f32 v89, v89
  v_exp_f32 v92, v92
  v_exp_f32 v93, v93
  v_pk_fma_f32 v[80:81], v[80:81], v[50:51], v[50:51]
  v_pk_fma_f32 v[84:85], v[84:85], v[50:51], v[50:51]
  v_pk_fma_f32 v[88:89], v[88:89], v[50:51], v[50:51]
  v_pk_fma_f32 v[92:93], v[92:93], v[50:51], v[50:51]
  v_rcp_f32 v80, v80
  v_rcp_f32 v81, v81
  v_rcp_f32 v84, v84
  v_rcp_f32 v85, v85
  v_rcp_f32 v88, v88
  v_rcp_f32 v89, v89
  v_rcp_f32 v92, v92
  v_rcp_f32 v93, v93
  v_pk_fma_f32 v[16:17], v[80:81], v[162:163], v[16:17]
  v_pk_fma_f32 v[18:19], v[84:85], v[166:167], v[18:19]
  v_pk_fma_f32 v[20:21], v[88:89], v[170:171], v[20:21]
  v_pk_fma_f32 v[22:23], v[92:93], v[174:175], v[22:23]
  v_pk_mul_f32 v[64:65], v[176:177], v[176:177]
  v_pk_mul_f32 v[68:69], v[180:181], v[180:181]
  v_pk_mul_f32 v[72:73], v[184:185], v[184:185]
  v_pk_mul_f32 v[76:77], v[188:189], v[188:189]
  v_pk_fma_f32 v[64:65], v[64:65], v[242:243], v[240:241]
  v_pk_fma_f32 v[68:69], v[68:69], v[242:243], v[240:241]
  v_pk_fma_f32 v[72:73], v[72:73], v[242:243], v[240:241]
  v_pk_fma_f32 v[76:77], v[76:77], v[242:243], v[240:241]
  v_pk_mul_f32 v[64:65], v[64:65], v[176:177]
  v_pk_mul_f32 v[68:69], v[68:69], v[180:181]
  v_pk_mul_f32 v[72:73], v[72:73], v[184:185]
  v_pk_mul_f32 v[76:77], v[76:77], v[188:189]
  v_exp_f32 v64, v64
  v_exp_f32 v65, v65
  v_exp_f32 v68, v68
  v_exp_f32 v69, v69
  v_exp_f32 v72, v72
  v_exp_f32 v73, v73
  v_exp_f32 v76, v76
  v_exp_f32 v77, v77
  v_pk_fma_f32 v[64:65], v[64:65], v[52:53], v[52:53]
  v_pk_fma_f32 v[68:69], v[68:69], v[52:53], v[52:53]
  v_pk_fma_f32 v[72:73], v[72:73], v[52:53], v[52:53]
  v_pk_fma_f32 v[76:77], v[76:77], v[52:53], v[52:53]
  v_rcp_f32 v64, v64
  v_rcp_f32 v65, v65
  v_rcp_f32 v68, v68
  v_rcp_f32 v69, v69
  v_rcp_f32 v72, v72
  v_rcp_f32 v73, v73
  v_rcp_f32 v76, v76
  v_rcp_f32 v77, v77
  v_pk_fma_f32 v[16:17], v[64:65], v[176:177], v[16:17]
  v_pk_fma_f32 v[18:19], v[68:69], v[180:181], v[18:19]
  v_pk_fma_f32 v[20:21], v[72:73], v[184:185], v[20:21]
  v_pk_fma_f32 v[22:23], v[76:77], v[188:189], v[22:23]
  v_pk_mul_f32 v[80:81], v[178:179], v[178:179]
  v_pk_mul_f32 v[84:85], v[182:183], v[182:183]
  v_pk_mul_f32 v[88:89], v[186:187], v[186:187]
  v_pk_mul_f32 v[92:93], v[190:191], v[190:191]
  v_pk_fma_f32 v[80:81], v[80:81], v[242:243], v[240:241]
  v_pk_fma_f32 v[84:85], v[84:85], v[242:243], v[240:241]
  v_pk_fma_f32 v[88:89], v[88:89], v[242:243], v[240:241]
  v_pk_fma_f32 v[92:93], v[92:93], v[242:243], v[240:241]
  v_pk_mul_f32 v[80:81], v[80:81], v[178:179]
  v_pk_mul_f32 v[84:85], v[84:85], v[182:183]
  v_pk_mul_f32 v[88:89], v[88:89], v[186:187]
  v_pk_mul_f32 v[92:93], v[92:93], v[190:191]
  v_exp_f32 v80, v80
  v_exp_f32 v81, v81
  v_exp_f32 v84, v84
  v_exp_f32 v85, v85
  v_exp_f32 v88, v88
  v_exp_f32 v89, v89
  v_exp_f32 v92, v92
  v_exp_f32 v93, v93
  v_pk_fma_f32 v[80:81], v[80:81], v[54:55], v[54:55]
  v_pk_fma_f32 v[84:85], v[84:85], v[54:55], v[54:55]
  v_pk_fma_f32 v[88:89], v[88:89], v[54:55], v[54:55]
  v_pk_fma_f32 v[92:93], v[92:93], v[54:55], v[54:55]
  v_rcp_f32 v80, v80
  v_rcp_f32 v81, v81
  v_rcp_f32 v84, v84
  v_rcp_f32 v85, v85
  v_rcp_f32 v88, v88
  v_rcp_f32 v89, v89
  v_rcp_f32 v92, v92
  v_rcp_f32 v93, v93
  v_pk_fma_f32 v[16:17], v[80:81], v[178:179], v[16:17]
  v_pk_fma_f32 v[18:19], v[84:85], v[182:183], v[18:19]
  v_pk_fma_f32 v[20:21], v[88:89], v[186:187], v[20:21]
  v_pk_fma_f32 v[22:23], v[92:93], v[190:191], v[22:23]
  v_pk_mul_f32 v[64:65], v[192:193], v[192:193]
  v_pk_mul_f32 v[68:69], v[196:197], v[196:197]
  v_pk_mul_f32 v[72:73], v[200:201], v[200:201]
  v_pk_mul_f32 v[76:77], v[204:205], v[204:205]
  v_pk_fma_f32 v[64:65], v[64:65], v[242:243], v[240:241]
  v_pk_fma_f32 v[68:69], v[68:69], v[242:243], v[240:241]
  v_pk_fma_f32 v[72:73], v[72:73], v[242:243], v[240:241]
  v_pk_fma_f32 v[76:77], v[76:77], v[242:243], v[240:241]
  v_pk_mul_f32 v[64:65], v[64:65], v[192:193]
  v_pk_mul_f32 v[68:69], v[68:69], v[196:197]
  v_pk_mul_f32 v[72:73], v[72:73], v[200:201]
  v_pk_mul_f32 v[76:77], v[76:77], v[204:205]
  v_exp_f32 v64, v64
  v_exp_f32 v65, v65
  v_exp_f32 v68, v68
  v_exp_f32 v69, v69
  v_exp_f32 v72, v72
  v_exp_f32 v73, v73
  v_exp_f32 v76, v76
  v_exp_f32 v77, v77
  v_pk_fma_f32 v[64:65], v[64:65], v[56:57], v[56:57]
  v_pk_fma_f32 v[68:69], v[68:69], v[56:57], v[56:57]
  v_pk_fma_f32 v[72:73], v[72:73], v[56:57], v[56:57]
  v_pk_fma_f32 v[76:77], v[76:77], v[56:57], v[56:57]
  v_rcp_f32 v64, v64
  v_rcp_f32 v65, v65
  v_rcp_f32 v68, v68
  v_rcp_f32 v69, v69
  v_rcp_f32 v72, v72
  v_rcp_f32 v73, v73
  v_rcp_f32 v76, v76
  v_rcp_f32 v77, v77
  v_pk_fma_f32 v[16:17], v[64:65], v[192:193], v[16:17]
  v_pk_fma_f32 v[18:19], v[68:69], v[196:197], v[18:19]
  v_pk_fma_f32 v[20:21], v[72:73], v[200:201], v[20:21]
  v_pk_fma_f32 v[22:23], v[76:77], v[204:205], v[22:23]
  v_pk_mul_f32 v[80:81], v[194:195], v[194:195]
  v_pk_mul_f32 v[84:85], v[198:199], v[198:199]
  v_pk_mul_f32 v[88:89], v[202:203], v[202:203]
  v_pk_mul_f32 v[92:93], v[206:207], v[206:207]
  v_pk_fma_f32 v[80:81], v[80:81], v[242:243], v[240:241]
  v_pk_fma_f32 v[84:85], v[84:85], v[242:243], v[240:241]
  v_pk_fma_f32 v[88:89], v[88:89], v[242:243], v[240:241]
  v_pk_fma_f32 v[92:93], v[92:93], v[242:243], v[240:241]
  v_pk_mul_f32 v[80:81], v[80:81], v[194:195]
  v_pk_mul_f32 v[84:85], v[84:85], v[198:199]
  v_pk_mul_f32 v[88:89], v[88:89], v[202:203]
  v_pk_mul_f32 v[92:93], v[92:93], v[206:207]
  v_exp_f32 v80, v80
  v_exp_f32 v81, v81
  v_exp_f32 v84, v84
  v_exp_f32 v85, v85
  v_exp_f32 v88, v88
  v_exp_f32 v89, v89
  v_exp_f32 v92, v92
  v_exp_f32 v93, v93
  v_pk_fma_f32 v[80:81], v[80:81], v[58:59], v[58:59]
  v_pk_fma_f32 v[84:85], v[84:85], v[58:59], v[58:59]
  v_pk_fma_f32 v[88:89], v[88:89], v[58:59], v[58:59]
  v_pk_fma_f32 v[92:93], v[92:93], v[58:59], v[58:59]
  v_rcp_f32 v80, v80
  v_rcp_f32 v81, v81
  v_rcp_f32 v84, v84
  v_rcp_f32 v85, v85
  v_rcp_f32 v88, v88
  v_rcp_f32 v89, v89
  v_rcp_f32 v92, v92
  v_rcp_f32 v93, v93
  v_pk_fma_f32 v[16:17], v[80:81], v[194:195], v[16:17]
  v_pk_fma_f32 v[18:19], v[84:85], v[198:199], v[18:19]
  v_pk_fma_f32 v[20:21], v[88:89], v[202:203], v[20:21]
  v_pk_fma_f32 v[22:23], v[92:93], v[206:207], v[22:23]
  buffer_load_dword v128, v3, s[60:63], s68 offen offset:0 sc1
  buffer_load_dword v129, v3, s[60:63], s68 offen offset:2048 sc1
  buffer_load_dword v130, v3, s[60:63], s69 offen offset:0 sc1
  buffer_load_dword v131, v3, s[60:63], s69 offen offset:2048 sc1
  buffer_load_dword v132, v3, s[60:63], s71 offen offset:0 sc1
  buffer_load_dword v133, v3, s[60:63], s71 offen offset:2048 sc1
  buffer_load_dword v134, v5, s[60:63], s71 offen sc1
  v_pk_mul_f32 v[64:65], v[208:209], v[208:209]
  v_pk_mul_f32 v[68:69], v[212:213], v[212:213]
  v_pk_mul_f32 v[72:73], v[216:217], v[216:217]
  v_pk_mul_f32 v[76:77], v[220:221], v[220:221]
  v_pk_fma_f32 v[64:65], v[64:65], v[242:243], v[240:241]
  v_pk_fma_f32 v[68:69], v[68:69], v[242:243], v[240:241]
  v_pk_fma_f32 v[72:73], v[72:73], v[242:243], v[240:241]
  v_pk_fma_f32 v[76:77], v[76:77], v[242:243], v[240:241]
  v_pk_mul_f32 v[64:65], v[64:65], v[208:209]
  v_pk_mul_f32 v[68:69], v[68:69], v[212:213]
  v_pk_mul_f32 v[72:73], v[72:73], v[216:217]
  v_pk_mul_f32 v[76:77], v[76:77], v[220:221]
  v_exp_f32 v64, v64
  v_exp_f32 v65, v65
  v_exp_f32 v68, v68
  v_exp_f32 v69, v69
  v_exp_f32 v72, v72
  v_exp_f32 v73, v73
  v_exp_f32 v76, v76
  v_exp_f32 v77, v77
  v_pk_fma_f32 v[64:65], v[64:65], v[60:61], v[60:61]
  v_pk_fma_f32 v[68:69], v[68:69], v[60:61], v[60:61]
  v_pk_fma_f32 v[72:73], v[72:73], v[60:61], v[60:61]
  v_pk_fma_f32 v[76:77], v[76:77], v[60:61], v[60:61]
  v_rcp_f32 v64, v64
  v_rcp_f32 v65, v65
  v_rcp_f32 v68, v68
  v_rcp_f32 v69, v69
  v_rcp_f32 v72, v72
  v_rcp_f32 v73, v73
  v_rcp_f32 v76, v76
  v_rcp_f32 v77, v77
  v_pk_fma_f32 v[16:17], v[64:65], v[208:209], v[16:17]
  v_pk_fma_f32 v[18:19], v[68:69], v[212:213], v[18:19]
  v_pk_fma_f32 v[20:21], v[72:73], v[216:217], v[20:21]
  v_pk_fma_f32 v[22:23], v[76:77], v[220:221], v[22:23]
  v_pk_mul_f32 v[80:81], v[210:211], v[210:211]
  v_pk_mul_f32 v[84:85], v[214:215], v[214:215]
  v_pk_mul_f32 v[88:89], v[218:219], v[218:219]
  v_pk_mul_f32 v[92:93], v[222:223], v[222:223]
  v_pk_fma_f32 v[80:81], v[80:81], v[242:243], v[240:241]
  v_pk_fma_f32 v[84:85], v[84:85], v[242:243], v[240:241]
  v_pk_fma_f32 v[88:89], v[88:89], v[242:243], v[240:241]
  v_pk_fma_f32 v[92:93], v[92:93], v[242:243], v[240:241]
  v_pk_mul_f32 v[80:81], v[80:81], v[210:211]
  v_pk_mul_f32 v[84:85], v[84:85], v[214:215]
  v_pk_mul_f32 v[88:89], v[88:89], v[218:219]
  v_pk_mul_f32 v[92:93], v[92:93], v[222:223]
  v_exp_f32 v80, v80
  v_exp_f32 v81, v81
  v_exp_f32 v84, v84
  v_exp_f32 v85, v85
  v_exp_f32 v88, v88
  v_exp_f32 v89, v89
  v_exp_f32 v92, v92
  v_exp_f32 v93, v93
  v_pk_fma_f32 v[80:81], v[80:81], v[62:63], v[62:63]
  v_pk_fma_f32 v[84:85], v[84:85], v[62:63], v[62:63]
  v_pk_fma_f32 v[88:89], v[88:89], v[62:63], v[62:63]
  v_pk_fma_f32 v[92:93], v[92:93], v[62:63], v[62:63]
  v_rcp_f32 v80, v80
  v_rcp_f32 v81, v81
  v_rcp_f32 v84, v84
  v_rcp_f32 v85, v85
  v_rcp_f32 v88, v88
  v_rcp_f32 v89, v89
  v_rcp_f32 v92, v92
  v_rcp_f32 v93, v93
  v_pk_fma_f32 v[16:17], v[80:81], v[210:211], v[16:17]
  v_pk_fma_f32 v[18:19], v[84:85], v[214:215], v[18:19]
  v_pk_fma_f32 v[20:21], v[88:89], v[218:219], v[20:21]
  v_pk_fma_f32 v[22:23], v[92:93], v[222:223], v[22:23]
  v_add_f32 v16, v16, v17
  v_add_f32 v18, v18, v19
  v_add_f32 v20, v20, v21
  v_add_f32 v22, v22, v23
  s_nop 0
  v_permlane32_swap_b32 v16, v20
  v_permlane32_swap_b32 v18, v22
  v_add_f32 v16, v16, v20
  v_add_f32 v18, v18, v22
  s_nop 1
  v_permlane16_swap_b32 v16, v18
  v_add_f32 v16, v16, v18
  v_add_f32 v16, s80, v16
L_rclr:
  s_mov_b32 s72, 0x40000
  s_branch L_pchk
L_poll:
  s_sub_u32 s72, s72, 1
  s_cbranch_scc1 L_pollx
  buffer_load_dword v128, v3, s[60:63], s68 offen offset:0 sc1
  buffer_load_dword v129, v3, s[60:63], s68 offen offset:2048 sc1
  buffer_load_dword v130, v3, s[60:63], s69 offen offset:0 sc1
  buffer_load_dword v131, v3, s[60:63], s69 offen offset:2048 sc1
  buffer_load_dword v132, v3, s[60:63], s71 offen offset:0 sc1
  buffer_load_dword v133, v3, s[60:63], s71 offen offset:2048 sc1
  buffer_load_dword v134, v5, s[60:63], s71 offen sc1
L_pchk:
  s_waitcnt vmcnt(0)
  v_max3_u32 v136, v128, v129, v130
  v_max3_u32 v137, v131, v132, v133
  v_max3_u32 v136, v136, v137, v134
  v_cmp_eq_u32 vcc, -1, v136
  s_cbranch_vccnz L_poll
L_pollx:
  v_add_f32 v128, v128, v129
  v_add_f32 v130, v130, v131
  v_add_f32 v132, v132, v133
  v_add_f32 v16, v16, v134
  v_add_f32 v128, v128, v130
  v_add_f32 v132, v132, v16
  v_add_f32 v128, v128, v132
  v_cvt_pk_bf16_f32 v128, v128, v128
  buffer_store_short v128, v4, s[56:59], s77 offen
  s_endpgm
L_end:
  s_endpgm
.section .rodata,"a"
.p2align 6
.amdhsa_kernel standalone__deep_cross_xdeepfm__recsys_kernel
  .amdhsa_next_free_vgpr 256
  .amdhsa_next_free_sgpr 102
  .amdhsa_accum_offset 256
  .amdhsa_group_segment_fixed_size 0
  .amdhsa_kernarg_size 88
  .amdhsa_user_sgpr_count 2
  .amdhsa_user_sgpr_kernarg_segment_ptr 1
  .amdhsa_system_sgpr_workgroup_id_x 1
  .amdhsa_float_denorm_mode_32 3
.end_amdhsa_kernel
```
